```python
import torch

def _softmax(x, axis=-1):
    return torch.softmax(x, dim=axis)
def _gelu(x):
    return torch.nn.functional.gelu(x, approximate="tanh")
def _silu(x):
    return torch.nn.functional.silu(x)
def _sigmoid(x):
    return torch.sigmoid(x)
def _layernorm(x, axis=-1, eps=1e-5):
    m = x.mean(dim=axis, keepdim=True)
    v = x.var(dim=axis, keepdim=True, unbiased=False)
    return (x - m) / torch.sqrt(v + eps)
def _scatter_add(tgt, idx, src, axis=0):
    return tgt.clone().index_add_(axis, idx, src)
def _segment_sum(src, seg, n):
    out = torch.zeros((n,) + src.shape[1:], dtype=src.dtype)
    return out.index_add_(0, seg, src)
def _pad(x, pw):
    flat = tuple(v for pair in reversed(pw) for v in pair)
    return torch.nn.functional.pad(x, flat)

kernel_name = 'parallel_sum__compressed_kv_cla__moe_arch_mod__prompt'

def setup_inputs():

    _w = (lambda a: (lambda t: t.to(torch.bfloat16) if t.is_floating_point() else t)(torch.as_tensor(a)))
    def _A_setup():
        B, H, Sq, Sk, D, M = 1, 32, 2048, 2048, 128, 640
        Dc = 4 * D
        return {
            "x": _w((lambda *s: torch.randn(*s, dtype=torch.bfloat16) * 0.05)(B, Sq, M)),
            "c_kv": _w((lambda *s: torch.randn(*s, dtype=torch.bfloat16) * 1.6)(B, Sk, Dc)),
            "w_q": _w((lambda *s: torch.randn(*s, dtype=torch.bfloat16) * 0.8)(M, H, D) * (M ** -0.5)),
            "w_uk": _w((lambda *s: torch.randn(*s, dtype=torch.bfloat16) * 0.8)(Dc, H, D) * (Dc ** -0.5)),
            "w_uv": _w((lambda *s: torch.randn(*s, dtype=torch.bfloat16) * 1.6)(Dc, H, D) * (Dc ** -0.5)),
            "w_o": _w((lambda *s: torch.randn(*s, dtype=torch.bfloat16) * 1.6)(H, D, M) * ((H * D) ** -0.5)),
        }
    _A_in = _A_setup()

    def _B_setup():
        B, S, D, F, C = 1, 2048, 640, 1728, 8
        return {
            "x": _w((lambda *s: torch.randn(*s, dtype=torch.bfloat16) * 0.05)(B, S, D)),
            "w_r": _w((lambda *s: torch.randn(*s, dtype=torch.bfloat16) * 0.05)(D)),
            "w_gate": _w((lambda *s: torch.randn(*s, dtype=torch.bfloat16) * 0.05)(D, F)),
            "w_up": _w((lambda *s: torch.randn(*s, dtype=torch.bfloat16) * 0.05)(D, F)),
            "w_down": _w((lambda *s: torch.randn(*s, dtype=torch.bfloat16) * 0.05)(F, D)),
        }
    _B_in = _B_setup()

    return {
        "A_x": _A_in["x"],
        "A_c_kv": _A_in["c_kv"],
        "A_w_q": _A_in["w_q"],
        "A_w_uk": _A_in["w_uk"],
        "A_w_uv": _A_in["w_uv"],
        "A_w_o": _A_in["w_o"],
        "B_x": _B_in["x"],
        "B_w_r": _B_in["w_r"],
        "B_w_gate": _B_in["w_gate"],
        "B_w_up": _B_in["w_up"],
        "B_w_down": _B_in["w_down"],
    }

def reference(A_x, A_c_kv, A_w_q, A_w_uk, A_w_uv, A_w_o, B_x, B_w_r, B_w_gate, B_w_up, B_w_down):
    def _A_ref(x, c_kv, w_q, w_uk, w_uv, w_o):
        B, Sq, M = x.shape[0], x.shape[1], x.shape[2]
        Sk = c_kv.shape[1]
        H, D = w_q.shape[1], w_q.shape[2]
        q = torch.einsum("bqm,mhd->bhqd", x, w_q)
        k = torch.einsum("bkc,chd->bhkd", c_kv, w_uk)
        v = torch.einsum("bkc,chd->bhkd", c_kv, w_uv)
        scores = torch.einsum("bhqd,bhkd->bhqk", q, k) * (D ** -0.5)
        off = Sk - Sq
        qi = torch.arange(Sq)[:, None]
        kj = torch.arange(Sk)[None, :]
        cmask = kj <= (qi + off)
        scores = torch.where(cmask[None, None], scores, -1e9)
        p = _softmax(scores, axis=-1)
        ctx = torch.einsum("bhqk,bhkd->bhqd", p, v)
        return torch.einsum("bhqd,hdm->bqm", ctx, w_o)

    def _B_ref(x, w_r, w_gate, w_up, w_down):
        B, S, D = x.shape
        C = 8
        r = x @ w_r
        idx = torch.argsort(-r, axis=-1)[:, :C]
        idx_e = (lambda x, n, axis: torch.repeat_interleave(x, n, dim=axis))(idx.reshape(B, C, 1), D, axis=2)
        x_sel = (lambda x, i, axis: torch.take_along_dim(x, i, dim=axis))(x, idx_e, axis=1)
        g = _silu(x_sel @ w_gate)
        u = x_sel @ w_up
        y = (g * u) @ w_down
        r_sel = _sigmoid((lambda x, i, axis: torch.take_along_dim(x, i, dim=axis))(r, idx, axis=1))
        y = y * r_sel.reshape(B, C, 1)
        b_off = (torch.arange(B) * S).reshape(B, 1)
        flat_idx = (idx + b_off).reshape(B * C)
        zero = (x * 0.0).reshape(B * S, D)
        upd = _scatter_add(zero, flat_idx, y.reshape(B * C, D), axis=0)
        return x + upd.reshape(B, S, D)

    x = A_x
    xn = _layernorm(x, axis=-1)
    return x + _A_ref(xn, A_c_kv, A_w_q, A_w_uk, A_w_uv, A_w_o) + _B_ref(xn, B_w_r, B_w_gate, B_w_up, B_w_down)
```

```asm
; @launch kernel=k1_kernel grid=(256,1,1) block=(512,1,1) lds=163840
; @launch kernel=k2_kernel grid=(256,1,1) block=(512,1,1) lds=163840
; @launch kernel=k3_kernel grid=(256,1,1) block=(512,1,1) lds=98304
.amdgcn_target "amdgcn-amd-amdhsa--gfx950"
.text
.globl k1_kernel
.p2align 8
.type k1_kernel,@function
k1_kernel:
    s_cmp_ge_u32 s2, 256
    s_cbranch_scc1 L_k1_end
    s_load_dwordx16 s[32:47], s[0:1], 0
    s_load_dwordx8 s[48:55], s[0:1], 64
    s_load_dwordx4 s[56:59], s[0:1], 96
    v_lshrrev_b32 v2, 6, v0
    v_and_b32 v1, 63, v0
    v_readfirstlane_b32 s3, v2
    s_and_b32 s6, s2, 7
    s_lshl_b32 s6, s6, 2
    s_lshr_b32 s7, s2, 3
    s_and_b32 s7, s7, 3
    s_add_u32 s4, s6, s7
    s_lshr_b32 s5, s2, 5
    s_waitcnt lgkmcnt(0)
    s_mov_b32 s8, s58
    s_mov_b32 s9, s59
    s_mov_b32 s10, 0x4000000
    s_mov_b32 s11, 0x20000
    s_mov_b32 s12, s34
    s_mov_b32 s13, s35
    s_mov_b32 s14, 0x200000
    s_mov_b32 s15, 0x20000
    s_mov_b32 s16, s38
    s_mov_b32 s17, s39
    s_mov_b32 s18, 0x400000
    s_mov_b32 s19, 0x20000
    s_mov_b32 s20, s40
    s_mov_b32 s21, s41
    s_mov_b32 s22, 0x400000
    s_mov_b32 s23, 0x20000
    s_mov_b32 s24, s42
    s_mov_b32 s25, s43
    s_mov_b32 s26, 0x500000
    s_mov_b32 s27, 0x20000
    s_mov_b32 s28, s32
    s_mov_b32 s29, s33
    s_mov_b32 s30, 0x280000
    s_mov_b32 s31, 0x20000
    s_lshr_b32 s60, s2, 1
    s_mul_i32 s60, s60, 40960
    s_and_b32 s61, s2, 1
    s_mul_i32 s61, s61, 640
    s_add_u32 s60, s60, s61
    s_movk_i32 s62, 1639
    v_add_u32 v2, 0, v0
    v_mul_lo_u32 v3, v2, s62
    v_lshrrev_b32 v3, 16, v3
    v_mul_u32_u24 v4, 40, v3
    v_sub_u32 v4, v2, v4
    v_mul_u32_u24 v3, 1280, v3
    v_lshl_add_u32 v3, v4, 4, v3
    s_lshl_b32 s63, s3, 10
    s_add_u32 m0, s63, 141312
    s_nop 0
    buffer_load_dwordx4 v3, s[24:27], s60 offen lds
    v_add_u32 v2, 512, v0
    v_mul_lo_u32 v3, v2, s62
    v_lshrrev_b32 v3, 16, v3
    v_mul_u32_u24 v4, 40, v3
    v_sub_u32 v4, v2, v4
    v_mul_u32_u24 v3, 1280, v3
    v_lshl_add_u32 v3, v4, 4, v3
    s_lshl_b32 s63, s3, 10
    s_add_u32 m0, s63, 149504
    s_nop 0
    buffer_load_dwordx4 v3, s[24:27], s60 offen lds
    s_cmp_ge_u32 s3, 4
    s_cbranch_scc1 L_wot_skip_3
    v_add_u32 v2, 1024, v0
    v_mul_lo_u32 v3, v2, s62
    v_lshrrev_b32 v3, 16, v3
    v_mul_u32_u24 v4, 40, v3
    v_sub_u32 v4, v2, v4
    v_mul_u32_u24 v3, 1280, v3
    v_lshl_add_u32 v3, v4, 4, v3
    s_lshl_b32 s63, s3, 10
    s_add_u32 m0, s63, 157696
    s_nop 0
    buffer_load_dwordx4 v3, s[24:27], s60 offen lds
L_wot_skip_3:
    s_lshl_b32 s64, s2, 3
    s_add_u32 s64, s64, s3
    s_mul_i32 s65, s64, 1280
    v_lshlrev_b32 v2, 2, v1
    buffer_load_dword v16, v2, s[28:31], s65 offen offset:0
    buffer_load_dword v17, v2, s[28:31], s65 offen offset:256
    buffer_load_dword v18, v2, s[28:31], s65 offen offset:512
    buffer_load_dword v19, v2, s[28:31], s65 offen offset:768
    buffer_load_dword v20, v2, s[28:31], s65 offen offset:1024
    s_mov_b32 s24, s46
    s_mov_b32 s25, s47
    s_mov_b32 s26, 0x500
    s_mov_b32 s27, 0x20000
    buffer_load_dword v21, v2, s[24:27], 0 offen offset:0
    buffer_load_dword v22, v2, s[24:27], 0 offen offset:256
    buffer_load_dword v23, v2, s[24:27], 0 offen offset:512
    buffer_load_dword v24, v2, s[24:27], 0 offen offset:768
    buffer_load_dword v25, v2, s[24:27], 0 offen offset:1024
    v_lshrrev_b32 v2, 3, v1
    v_and_b32 v3, 7, v1
    v_lshrrev_b32 v4, 4, v1
    s_lshl_b32 s6, s3, 5
    v_add_u32 v5, 0, v4
    v_xor_b32 v5, v3, v5
    v_lshlrev_b32 v5, 4, v5
    s_add_u32 s7, s6, 0
    v_add_u32 v6, s7, v2
    v_lshl_add_u32 v40, v6, 10, v5
    v_add_u32 v5, 4, v4
    v_xor_b32 v5, v3, v5
    v_lshlrev_b32 v5, 4, v5
    s_add_u32 s7, s6, 8
    v_add_u32 v6, s7, v2
    v_lshl_add_u32 v41, v6, 10, v5
    v_subrev_u32 v41, 1024, v41
    v_add_u32 v5, 0, v4
    v_xor_b32 v5, v3, v5
    v_lshlrev_b32 v5, 4, v5
    s_add_u32 s7, s6, 16
    v_add_u32 v6, s7, v2
    v_lshl_add_u32 v42, v6, 10, v5
    v_subrev_u32 v42, 2048, v42
    v_add_u32 v5, 4, v4
    v_xor_b32 v5, v3, v5
    v_lshlrev_b32 v5, 4, v5
    s_add_u32 s7, s6, 24
    v_add_u32 v6, s7, v2
    v_lshl_add_u32 v43, v6, 10, v5
    v_subrev_u32 v43, 3072, v43
    s_and_b32 s7, s3, 1
    s_lshl_b32 s7, s7, 2
    v_or_b32 v5, s7, v4
    v_lshlrev_b32 v5, 1, v5
    v_and_b32 v6, 15, v1
    v_xor_b32 v5, v6, v5
    v_lshlrev_b32 v5, 4, v5
    s_lshl_b32 s6, s3, 3
    v_add_u32 v6, s6, v4
    v_lshl_add_u32 v44, v6, 13, v5
    v_add_u32 v45, 31744, v44
    s_lshl_b32 s66, s5, 18
    s_lshl_b32 s67, s4, 8
    s_lshl_b32 s68, s3, 12
    s_lshl_b32 s69, s3, 11
    s_add_u32 s69, s69, 65536
    s_mov_b32 m0, s68
    s_nop 0
    buffer_load_dwordx4 v40, s[12:15], s66 offen offset:0 lds
    buffer_load_dwordx4 v41, s[12:15], s66 offen offset:1024 lds
    buffer_load_dwordx4 v42, s[12:15], s66 offen offset:2048 lds
    buffer_load_dwordx4 v43, s[12:15], s66 offen offset:3072 lds
    s_mov_b32 m0, s69
    s_add_u32 s66, s66, 128
    buffer_load_dwordx4 v44, s[16:19], s67 offen offset:0 lds
    buffer_load_dwordx4 v45, s[16:19], s67 offen offset:1024 lds
    s_add_u32 m0, s69, 16384
    s_xor_b32 s68, s68, 0x8000
    buffer_load_dwordx4 v44, s[20:23], s67 offen offset:0 lds
    buffer_load_dwordx4 v45, s[20:23], s67 offen offset:1024 lds
    s_xor_b32 s69, s69, 0x8000
    s_add_u32 s67, s67, 524288
    s_mov_b32 m0, s68
    s_nop 0
    buffer_load_dwordx4 v40, s[12:15], s66 offen offset:0 lds
    buffer_load_dwordx4 v41, s[12:15], s66 offen offset:1024 lds
    buffer_load_dwordx4 v42, s[12:15], s66 offen offset:2048 lds
    buffer_load_dwordx4 v43, s[12:15], s66 offen offset:3072 lds
    s_mov_b32 m0, s69
    s_add_u32 s66, s66, 128
    buffer_load_dwordx4 v44, s[16:19], s67 offen offset:0 lds
    buffer_load_dwordx4 v45, s[16:19], s67 offen offset:1024 lds
    s_add_u32 m0, s69, 16384
    s_xor_b32 s68, s68, 0x8000
    buffer_load_dwordx4 v44, s[20:23], s67 offen offset:0 lds
    buffer_load_dwordx4 v45, s[20:23], s67 offen offset:1024 lds
    s_xor_b32 s69, s69, 0x8000
    s_add_u32 s67, s67, 524288
    v_and_b32 v2, 15, v1
    v_lshrrev_b32 v3, 4, v1
    s_and_b32 s6, s3, 1
    s_lshl_b32 s6, s6, 7
    v_add_u32 v4, s6, v2
    v_lshlrev_b32 v4, 7, v4
    v_lshrrev_b32 v5, 1, v2
    v_add_u32 v6, 0, v3
    v_xor_b32 v6, v6, v5
    v_lshl_add_u32 v46, v6, 4, v4
    v_add_u32 v6, 4, v3
    v_xor_b32 v6, v6, v5
    v_lshl_add_u32 v47, v6, 4, v4
    v_lshrrev_b32 v4, 2, v2
    v_lshl_add_u32 v5, v3, 3, v4
    v_lshlrev_b32 v5, 8, v5
    v_and_b32 v6, 1, v2
    v_lshl_add_u32 v5, v6, 3, v5
    v_and_b32 v6, 1, v3
    v_lshl_or_b32 v4, v6, 2, v4
    v_lshlrev_b32 v4, 1, v4
    v_bfe_u32 v6, v2, 1, 1
    s_lshr_b32 s6, s3, 2
    s_lshl_b32 s6, s6, 14
    s_add_u32 s6, s6, 65536
    v_add_u32 v5, s6, v5
    s_lshr_b32 s7, s3, 1
    s_and_b32 s7, s7, 1
    s_lshl_b32 s7, s7, 3
    s_add_u32 s6, s7, 0
    v_add_u32 v7, s6, v6
    v_xor_b32 v7, v7, v4
    v_lshl_add_u32 v48, v7, 4, v5
    s_add_u32 s6, s7, 2
    v_add_u32 v7, s6, v6
    v_xor_b32 v7, v7, v4
    v_lshl_add_u32 v49, v7, 4, v5
    s_add_u32 s6, s7, 4
    v_add_u32 v7, s6, v6
    v_xor_b32 v7, v7, v4
    v_lshl_add_u32 v50, v7, 4, v5
    s_add_u32 s6, s7, 6
    v_add_u32 v7, s6, v6
    v_xor_b32 v7, v7, v4
    v_lshl_add_u32 v51, v7, 4, v5
    v_mov_b32 v128, 0
    v_mov_b32 v129, 0
    v_mov_b32 v130, 0
    v_mov_b32 v131, 0
    v_mov_b32 v132, 0
    v_mov_b32 v133, 0
    v_mov_b32 v134, 0
    v_mov_b32 v135, 0
    v_mov_b32 v136, 0
    v_mov_b32 v137, 0
    v_mov_b32 v138, 0
    v_mov_b32 v139, 0
    v_mov_b32 v140, 0
    v_mov_b32 v141, 0
    v_mov_b32 v142, 0
    v_mov_b32 v143, 0
    v_mov_b32 v144, 0
    v_mov_b32 v145, 0
    v_mov_b32 v146, 0
    v_mov_b32 v147, 0
    v_mov_b32 v148, 0
    v_mov_b32 v149, 0
    v_mov_b32 v150, 0
    v_mov_b32 v151, 0
    v_mov_b32 v152, 0
    v_mov_b32 v153, 0
    v_mov_b32 v154, 0
    v_mov_b32 v155, 0
    v_mov_b32 v156, 0
    v_mov_b32 v157, 0
    v_mov_b32 v158, 0
    v_mov_b32 v159, 0
    v_mov_b32 v160, 0
    v_mov_b32 v161, 0
    v_mov_b32 v162, 0
    v_mov_b32 v163, 0
    v_mov_b32 v164, 0
    v_mov_b32 v165, 0
    v_mov_b32 v166, 0
    v_mov_b32 v167, 0
    v_mov_b32 v168, 0
    v_mov_b32 v169, 0
    v_mov_b32 v170, 0
    v_mov_b32 v171, 0
    v_mov_b32 v172, 0
    v_mov_b32 v173, 0
    v_mov_b32 v174, 0
    v_mov_b32 v175, 0
    v_mov_b32 v176, 0
    v_mov_b32 v177, 0
    v_mov_b32 v178, 0
    v_mov_b32 v179, 0
    v_mov_b32 v180, 0
    v_mov_b32 v181, 0
    v_mov_b32 v182, 0
    v_mov_b32 v183, 0
    v_mov_b32 v184, 0
    v_mov_b32 v185, 0
    v_mov_b32 v186, 0
    v_mov_b32 v187, 0
    v_mov_b32 v188, 0
    v_mov_b32 v189, 0
    v_mov_b32 v190, 0
    v_mov_b32 v191, 0
    v_mov_b32 v192, 0
    v_mov_b32 v193, 0
    v_mov_b32 v194, 0
    v_mov_b32 v195, 0
    v_mov_b32 v196, 0
    v_mov_b32 v197, 0
    v_mov_b32 v198, 0
    v_mov_b32 v199, 0
    v_mov_b32 v200, 0
    v_mov_b32 v201, 0
    v_mov_b32 v202, 0
    v_mov_b32 v203, 0
    v_mov_b32 v204, 0
    v_mov_b32 v205, 0
    v_mov_b32 v206, 0
    v_mov_b32 v207, 0
    v_mov_b32 v208, 0
    v_mov_b32 v209, 0
    v_mov_b32 v210, 0
    v_mov_b32 v211, 0
    v_mov_b32 v212, 0
    v_mov_b32 v213, 0
    v_mov_b32 v214, 0
    v_mov_b32 v215, 0
    v_mov_b32 v216, 0
    v_mov_b32 v217, 0
    v_mov_b32 v218, 0
    v_mov_b32 v219, 0
    v_mov_b32 v220, 0
    v_mov_b32 v221, 0
    v_mov_b32 v222, 0
    v_mov_b32 v223, 0
    v_mov_b32 v224, 0
    v_mov_b32 v225, 0
    v_mov_b32 v226, 0
    v_mov_b32 v227, 0
    v_mov_b32 v228, 0
    v_mov_b32 v229, 0
    v_mov_b32 v230, 0
    v_mov_b32 v231, 0
    v_mov_b32 v232, 0
    v_mov_b32 v233, 0
    v_mov_b32 v234, 0
    v_mov_b32 v235, 0
    v_mov_b32 v236, 0
    v_mov_b32 v237, 0
    v_mov_b32 v238, 0
    v_mov_b32 v239, 0
    v_mov_b32 v240, 0
    v_mov_b32 v241, 0
    v_mov_b32 v242, 0
    v_mov_b32 v243, 0
    v_mov_b32 v244, 0
    v_mov_b32 v245, 0
    v_mov_b32 v246, 0
    v_mov_b32 v247, 0
    v_mov_b32 v248, 0
    v_mov_b32 v249, 0
    v_mov_b32 v250, 0
    v_mov_b32 v251, 0
    v_mov_b32 v252, 0
    v_mov_b32 v253, 0
    v_mov_b32 v254, 0
    v_mov_b32 v255, 0
    s_waitcnt vmcnt(16)
    v_lshlrev_b32 v26, 16, v16
    v_and_b32 v27, 0xffff0000, v16
    v_lshlrev_b32 v28, 16, v17
    v_and_b32 v29, 0xffff0000, v17
    v_lshlrev_b32 v30, 16, v18
    v_and_b32 v31, 0xffff0000, v18
    v_lshlrev_b32 v32, 16, v19
    v_and_b32 v33, 0xffff0000, v19
    v_lshlrev_b32 v34, 16, v20
    v_and_b32 v35, 0xffff0000, v20
    v_add_f32 v2, v26, v27
    v_add_f32 v2, v2, v28
    v_add_f32 v2, v2, v29
    v_add_f32 v2, v2, v30
    v_add_f32 v2, v2, v31
    v_add_f32 v2, v2, v32
    v_add_f32 v2, v2, v33
    v_add_f32 v2, v2, v34
    v_add_f32 v2, v2, v35
    s_nop 1
    v_add_f32_dpp v2, v2, v2 quad_perm:[1,0,3,2] row_mask:0xf bank_mask:0xf
    s_nop 1
    v_add_f32_dpp v2, v2, v2 quad_perm:[2,3,0,1] row_mask:0xf bank_mask:0xf
    s_nop 1
    v_add_f32_dpp v2, v2, v2 row_half_mirror row_mask:0xf bank_mask:0xf
    s_nop 1
    v_add_f32_dpp v2, v2, v2 row_mirror row_mask:0xf bank_mask:0xf
    s_nop 1
    v_add_f32_dpp v2, v2, v2 row_bcast:15 row_mask:0xa bank_mask:0xf
    s_nop 1
    v_add_f32_dpp v2, v2, v2 row_bcast:31 row_mask:0xc bank_mask:0xf
    s_nop 1
    v_readlane_b32 s6, v2, 63
    s_mov_b32 s7, 0x3acccccd
    s_nop 1
    v_mov_b32 v3, s6
    v_mul_f32 v3, s7, v3
    v_sub_f32 v4, v26, v3
    v_mul_f32 v2, v4, v4
    v_sub_f32 v4, v27, v3
    v_fmac_f32 v2, v4, v4
    v_sub_f32 v4, v28, v3
    v_fmac_f32 v2, v4, v4
    v_sub_f32 v4, v29, v3
    v_fmac_f32 v2, v4, v4
    v_sub_f32 v4, v30, v3
    v_fmac_f32 v2, v4, v4
    v_sub_f32 v4, v31, v3
    v_fmac_f32 v2, v4, v4
    v_sub_f32 v4, v32, v3
    v_fmac_f32 v2, v4, v4
    v_sub_f32 v4, v33, v3
    v_fmac_f32 v2, v4, v4
    v_sub_f32 v4, v34, v3
    v_fmac_f32 v2, v4, v4
    v_sub_f32 v4, v35, v3
    v_fmac_f32 v2, v4, v4
    s_nop 1
    v_add_f32_dpp v2, v2, v2 quad_perm:[1,0,3,2] row_mask:0xf bank_mask:0xf
    s_nop 1
    v_add_f32_dpp v2, v2, v2 quad_perm:[2,3,0,1] row_mask:0xf bank_mask:0xf
    s_nop 1
    v_add_f32_dpp v2, v2, v2 row_half_mirror row_mask:0xf bank_mask:0xf
    s_nop 1
    v_add_f32_dpp v2, v2, v2 row_mirror row_mask:0xf bank_mask:0xf
    s_nop 1
    v_add_f32_dpp v2, v2, v2 row_bcast:15 row_mask:0xa bank_mask:0xf
    s_nop 1
    v_add_f32_dpp v2, v2, v2 row_bcast:31 row_mask:0xc bank_mask:0xf
    s_nop 1
    v_readlane_b32 s6, v2, 63
    s_nop 1
    v_mov_b32 v4, s6
    v_mul_f32 v4, s7, v4
    v_cvt_pk_bf16_f32 v3, v3, v3
    v_lshlrev_b32 v3, 16, v3
    v_cvt_pk_bf16_f32 v4, v4, v4
    v_lshlrev_b32 v4, 16, v4
    v_add_f32 v4, 0x3727c5ac, v4
    v_cvt_pk_bf16_f32 v4, v4, v4
    v_lshlrev_b32 v4, 16, v4
    v_sqrt_f32 v4, v4
    s_nop 0
    v_cvt_pk_bf16_f32 v4, v4, v4
    v_lshlrev_b32 v4, 16, v4
    v_rcp_f32 v5, v4
    s_nop 0
    v_fma_f32 v6, -v4, v5, 1.0
    v_fmac_f32 v5, v6, v5
    v_sub_f32 v26, v26, v3
    v_sub_f32 v27, v27, v3
    v_cvt_pk_bf16_f32 v6, v26, v27
    v_lshlrev_b32 v26, 16, v6
    v_and_b32 v27, 0xffff0000, v6
    v_mul_f32 v6, v26, v5
    v_mul_f32 v7, v27, v5
    v_fma_f32 v26, -v4, v6, v26
    v_fma_f32 v27, -v4, v7, v27
    v_fmac_f32 v6, v26, v5
    v_fmac_f32 v7, v27, v5
    v_cvt_pk_bf16_f32 v16, v6, v7
    v_sub_f32 v28, v28, v3
    v_sub_f32 v29, v29, v3
    v_cvt_pk_bf16_f32 v6, v28, v29
    v_lshlrev_b32 v28, 16, v6
    v_and_b32 v29, 0xffff0000, v6
    v_mul_f32 v6, v28, v5
    v_mul_f32 v7, v29, v5
    v_fma_f32 v28, -v4, v6, v28
    v_fma_f32 v29, -v4, v7, v29
    v_fmac_f32 v6, v28, v5
    v_fmac_f32 v7, v29, v5
    v_cvt_pk_bf16_f32 v17, v6, v7
    v_sub_f32 v30, v30, v3
    v_sub_f32 v31, v31, v3
    v_cvt_pk_bf16_f32 v6, v30, v31
    v_lshlrev_b32 v30, 16, v6
    v_and_b32 v31, 0xffff0000, v6
    v_mul_f32 v6, v30, v5
    v_mul_f32 v7, v31, v5
    v_fma_f32 v30, -v4, v6, v30
    v_fma_f32 v31, -v4, v7, v31
    v_fmac_f32 v6, v30, v5
    v_fmac_f32 v7, v31, v5
    v_cvt_pk_bf16_f32 v18, v6, v7
    v_sub_f32 v32, v32, v3
    v_sub_f32 v33, v33, v3
    v_cvt_pk_bf16_f32 v6, v32, v33
    v_lshlrev_b32 v32, 16, v6
    v_and_b32 v33, 0xffff0000, v6
    v_mul_f32 v6, v32, v5
    v_mul_f32 v7, v33, v5
    v_fma_f32 v32, -v4, v6, v32
    v_fma_f32 v33, -v4, v7, v33
    v_fmac_f32 v6, v32, v5
    v_fmac_f32 v7, v33, v5
    v_cvt_pk_bf16_f32 v19, v6, v7
    v_sub_f32 v34, v34, v3
    v_sub_f32 v35, v35, v3
    v_cvt_pk_bf16_f32 v6, v34, v35
    v_lshlrev_b32 v34, 16, v6
    v_and_b32 v35, 0xffff0000, v6
    v_mul_f32 v6, v34, v5
    v_mul_f32 v7, v35, v5
    v_fma_f32 v34, -v4, v6, v34
    v_fma_f32 v35, -v4, v7, v35
    v_fmac_f32 v6, v34, v5
    v_fmac_f32 v7, v35, v5
    v_cvt_pk_bf16_f32 v20, v6, v7
    s_mul_i32 s6, s3, 1280
    s_add_u32 s6, s6, 131072
    v_lshl_add_u32 v8, v1, 2, s6
    ds_write_b32 v8, v16 offset:0
    ds_write_b32 v8, v17 offset:256
    ds_write_b32 v8, v18 offset:512
    ds_write_b32 v8, v19 offset:768
    ds_write_b32 v8, v20 offset:1024
    v_mov_b32 v2, 0
    v_lshlrev_b32 v4, 16, v16
    v_lshlrev_b32 v5, 16, v21
    v_fmac_f32 v2, v4, v5
    v_and_b32 v4, 0xffff0000, v16
    v_and_b32 v5, 0xffff0000, v21
    v_fmac_f32 v2, v4, v5
    v_lshlrev_b32 v4, 16, v17
    v_lshlrev_b32 v5, 16, v22
    v_fmac_f32 v2, v4, v5
    v_and_b32 v4, 0xffff0000, v17
    v_and_b32 v5, 0xffff0000, v22
    v_fmac_f32 v2, v4, v5
    v_lshlrev_b32 v4, 16, v18
    v_lshlrev_b32 v5, 16, v23
    v_fmac_f32 v2, v4, v5
    v_and_b32 v4, 0xffff0000, v18
    v_and_b32 v5, 0xffff0000, v23
    v_fmac_f32 v2, v4, v5
    v_lshlrev_b32 v4, 16, v19
    v_lshlrev_b32 v5, 16, v24
    v_fmac_f32 v2, v4, v5
    v_and_b32 v4, 0xffff0000, v19
    v_and_b32 v5, 0xffff0000, v24
    v_fmac_f32 v2, v4, v5
    v_lshlrev_b32 v4, 16, v20
    v_lshlrev_b32 v5, 16, v25
    v_fmac_f32 v2, v4, v5
    v_and_b32 v4, 0xffff0000, v20
    v_and_b32 v5, 0xffff0000, v25
    v_fmac_f32 v2, v4, v5
    s_nop 1
    v_add_f32_dpp v2, v2, v2 quad_perm:[1,0,3,2] row_mask:0xf bank_mask:0xf
    s_nop 1
    v_add_f32_dpp v2, v2, v2 quad_perm:[2,3,0,1] row_mask:0xf bank_mask:0xf
    s_nop 1
    v_add_f32_dpp v2, v2, v2 row_half_mirror row_mask:0xf bank_mask:0xf
    s_nop 1
    v_add_f32_dpp v2, v2, v2 row_mirror row_mask:0xf bank_mask:0xf
    s_nop 1
    v_add_f32_dpp v2, v2, v2 row_bcast:15 row_mask:0xa bank_mask:0xf
    s_nop 1
    v_add_f32_dpp v2, v2, v2 row_bcast:31 row_mask:0xc bank_mask:0xf
    s_nop 1
    v_cvt_pk_bf16_f32 v2, v2, v2
    v_and_b32 v2, 0xffff, v2
    v_bfe_i32 v3, v2, 15, 1
    v_and_b32 v3, 0x7fff, v3
    v_or_b32 v3, 0x8000, v3
    v_xor_b32 v2, v2, v3
    s_sub_u32 s6, 2047, s64
    v_lshlrev_b32 v2, 11, v2
    v_or_b32 v2, s6, v2
    s_lshl_b32 s6, s64, 2
    s_add_u32 s6, s6, 2621440
    v_mov_b32 v3, 0
    v_cmp_eq_u32 vcc, 63, v1
    s_and_saveexec_b64 s[72:73], vcc
    s_waitcnt vmcnt(8)
    buffer_store_dword v2, v3, s[8:11], s6 offen
    s_mov_b64 exec, s[72:73]
    s_waitcnt lgkmcnt(0)
    s_barrier
    s_lshr_b32 s6, s2, 1
    s_mul_i32 s6, s6, 20480
    s_and_b32 s7, s2, 1
    s_lshl_b32 s7, s7, 7
    s_add_u32 s6, s6, s7
    v_add_u32 v2, 0, v0
    v_lshrrev_b32 v3, 3, v2
    v_and_b32 v4, 7, v2
    v_mul_u32_u24 v5, 1280, v4
    v_lshl_add_u32 v5, v3, 4, v5
    v_add_u32 v5, 131072, v5
    ds_read_b128 v[8:11], v5
    v_lshlrev_b32 v5, 8, v3
    v_lshl_add_u32 v5, v4, 4, v5
    s_waitcnt lgkmcnt(0)
    buffer_store_dwordx4 v[8:11], v5, s[8:11], s6 offen
    s_cmp_ge_u32 s3, 2
    s_cbranch_scc1 L_xn_skip_5
    v_add_u32 v2, 512, v0
    v_lshrrev_b32 v3, 3, v2
    v_and_b32 v4, 7, v2
    v_mul_u32_u24 v5, 1280, v4
    v_lshl_add_u32 v5, v3, 4, v5
    v_add_u32 v5, 131072, v5
    ds_read_b128 v[8:11], v5
    v_lshlrev_b32 v5, 8, v3
    v_lshl_add_u32 v5, v4, 4, v5
    s_waitcnt lgkmcnt(0)
    buffer_store_dwordx4 v[8:11], v5, s[8:11], s6 offen
L_xn_skip_5:
    v_and_b32 v2, 15, v1
    v_lshrrev_b32 v3, 4, v1
    v_lshrrev_b32 v4, 2, v2
    v_lshl_add_u32 v4, v3, 2, v4
    v_mul_u32_u24 v4, 640, v4
    v_and_b32 v2, 3, v2
    v_lshl_add_u32 v4, v2, 3, v4
    s_lshl_b32 s6, s3, 5
    s_add_u32 s6, s6, 141312
    v_add_u32 v4, s6, v4
    s_mul_i32 s6, s2, 20480
    s_lshl_b32 s7, s3, 10
    s_add_u32 s6, s6, s7
    s_add_u32 s6, s6, 4194304
    v_lshlrev_b32 v5, 4, v1
    ds_read_b64_tr_b16 v[12:13], v4 offset:0
    ds_read_b64_tr_b16 v[14:15], v4 offset:10240
    s_waitcnt lgkmcnt(0)
    buffer_store_dwordx4 v[12:15], v5, s[8:11], s6 offen
    s_add_u32 s6, s6, 8192
    ds_read_b64_tr_b16 v[16:17], v4 offset:256
    ds_read_b64_tr_b16 v[18:19], v4 offset:10496
    s_waitcnt lgkmcnt(0)
    buffer_store_dwordx4 v[16:19], v5, s[8:11], s6 offen
    s_add_u32 s6, s6, 8192
    s_cmp_ge_u32 s3, 4
    s_cbranch_scc1 L_wof_skip_8
    ds_read_b64_tr_b16 v[20:21], v4 offset:512
    ds_read_b64_tr_b16 v[22:23], v4 offset:10752
    s_waitcnt lgkmcnt(0)
    buffer_store_dwordx4 v[20:23], v5, s[8:11], s6 offen
    s_add_u32 s6, s6, 8192
L_wof_skip_8:
    s_mov_b32 s70, 0
    ds_read_b128 v[64:67], v46 offset:0
    ds_read_b128 v[68:71], v46 offset:2048
    ds_read_b64_tr_b16 v[96:97], v48 offset:0
    ds_read_b64_tr_b16 v[98:99], v48 offset:1024
    ds_read_b64_tr_b16 v[100:101], v49 offset:0
    ds_read_b64_tr_b16 v[102:103], v49 offset:1024
    ds_read_b64_tr_b16 v[104:105], v50 offset:0
    ds_read_b64_tr_b16 v[106:107], v50 offset:1024
    ds_read_b64_tr_b16 v[108:109], v51 offset:0
    ds_read_b64_tr_b16 v[110:111], v51 offset:1024
    ds_read_b128 v[72:75], v46 offset:4096
    ds_read_b128 v[76:79], v46 offset:6144
    ds_read_b128 v[80:83], v46 offset:8192
    ds_read_b128 v[84:87], v46 offset:10240
    ds_read_b128 v[88:91], v46 offset:12288
    ds_read_b128 v[92:95], v46 offset:14336
    s_lshl_b32 s6, s4, 20
    s_lshl_b32 s7, s5, 17
    s_add_u32 s6, s6, s7
    s_and_b32 s7, s3, 1
    s_lshl_b32 s7, s7, 16
    s_add_u32 s6, s6, s7
    s_add_u32 s71, s6, 16777216
    v_lshlrev_b32 v2, 4, v1
    s_cmp_ge_u32 s3, 4
    s_cbranch_scc1 L_k1_v
L_k1_kloop:
    s_waitcnt lgkmcnt(12)
    v_mfma_f32_16x16x32_bf16 v[128:131], v[96:99], v[64:67], v[128:131]
    ds_read_b64_tr_b16 v[112:113], v48 offset:8192
    s_waitcnt lgkmcnt(11)
    v_mfma_f32_16x16x32_bf16 v[132:135], v[100:103], v[64:67], v[132:135]
    ds_read_b64_tr_b16 v[114:115], v48 offset:9216
    s_waitcnt lgkmcnt(10)
    v_mfma_f32_16x16x32_bf16 v[136:139], v[104:107], v[64:67], v[136:139]
    ds_read_b64_tr_b16 v[116:117], v49 offset:8192
    s_waitcnt lgkmcnt(9)
    v_mfma_f32_16x16x32_bf16 v[140:143], v[108:111], v[64:67], v[140:143]
    ds_read_b64_tr_b16 v[118:119], v49 offset:9216
    ds_read_b128 v[64:67], v47 offset:0
    v_mfma_f32_16x16x32_bf16 v[144:147], v[96:99], v[68:71], v[144:147]
    ds_read_b64_tr_b16 v[120:121], v50 offset:8192
    v_mfma_f32_16x16x32_bf16 v[148:151], v[100:103], v[68:71], v[148:151]
    ds_read_b64_tr_b16 v[122:123], v50 offset:9216
    v_mfma_f32_16x16x32_bf16 v[152:155], v[104:107], v[68:71], v[152:155]
    ds_read_b64_tr_b16 v[124:125], v51 offset:8192
    v_mfma_f32_16x16x32_bf16 v[156:159], v[108:111], v[68:71], v[156:159]
    ds_read_b64_tr_b16 v[126:127], v51 offset:9216
    ds_read_b128 v[68:71], v47 offset:2048
    s_waitcnt lgkmcnt(15)
    v_mfma_f32_16x16x32_bf16 v[160:163], v[96:99], v[72:75], v[160:163]
    v_mfma_f32_16x16x32_bf16 v[164:167], v[100:103], v[72:75], v[164:167]
    v_mfma_f32_16x16x32_bf16 v[168:171], v[104:107], v[72:75], v[168:171]
    v_mfma_f32_16x16x32_bf16 v[172:175], v[108:111], v[72:75], v[172:175]
    ds_read_b128 v[72:75], v47 offset:4096
    s_waitcnt lgkmcnt(15)
    v_mfma_f32_16x16x32_bf16 v[176:179], v[96:99], v[76:79], v[176:179]
    v_mfma_f32_16x16x32_bf16 v[180:183], v[100:103], v[76:79], v[180:183]
    v_mfma_f32_16x16x32_bf16 v[184:187], v[104:107], v[76:79], v[184:187]
    v_mfma_f32_16x16x32_bf16 v[188:191], v[108:111], v[76:79], v[188:191]
    ds_read_b128 v[76:79], v47 offset:6144
    s_waitcnt lgkmcnt(15)
    v_mfma_f32_16x16x32_bf16 v[192:195], v[96:99], v[80:83], v[192:195]
    v_mfma_f32_16x16x32_bf16 v[196:199], v[100:103], v[80:83], v[196:199]
    v_mfma_f32_16x16x32_bf16 v[200:203], v[104:107], v[80:83], v[200:203]
    v_mfma_f32_16x16x32_bf16 v[204:207], v[108:111], v[80:83], v[204:207]
    ds_read_b128 v[80:83], v47 offset:8192
    s_waitcnt lgkmcnt(15)
    v_mfma_f32_16x16x32_bf16 v[208:211], v[96:99], v[84:87], v[208:211]
    v_mfma_f32_16x16x32_bf16 v[212:215], v[100:103], v[84:87], v[212:215]
    v_mfma_f32_16x16x32_bf16 v[216:219], v[104:107], v[84:87], v[216:219]
    v_mfma_f32_16x16x32_bf16 v[220:223], v[108:111], v[84:87], v[220:223]
    ds_read_b128 v[84:87], v47 offset:10240
    s_waitcnt lgkmcnt(15)
    v_mfma_f32_16x16x32_bf16 v[224:227], v[96:99], v[88:91], v[224:227]
    v_mfma_f32_16x16x32_bf16 v[228:231], v[100:103], v[88:91], v[228:231]
    v_mfma_f32_16x16x32_bf16 v[232:235], v[104:107], v[88:91], v[232:235]
    v_mfma_f32_16x16x32_bf16 v[236:239], v[108:111], v[88:91], v[236:239]
    ds_read_b128 v[88:91], v47 offset:12288
    s_waitcnt lgkmcnt(15)
    v_mfma_f32_16x16x32_bf16 v[240:243], v[96:99], v[92:95], v[240:243]
    v_mfma_f32_16x16x32_bf16 v[244:247], v[100:103], v[92:95], v[244:247]
    v_mfma_f32_16x16x32_bf16 v[248:251], v[104:107], v[92:95], v[248:251]
    v_mfma_f32_16x16x32_bf16 v[252:255], v[108:111], v[92:95], v[252:255]
    ds_read_b128 v[92:95], v47 offset:14336
    s_waitcnt lgkmcnt(11)
    v_mfma_f32_16x16x32_bf16 v[128:131], v[112:115], v[64:67], v[128:131]
    v_mfma_f32_16x16x32_bf16 v[132:135], v[116:119], v[64:67], v[132:135]
    s_waitcnt lgkmcnt(9)
    v_mfma_f32_16x16x32_bf16 v[136:139], v[120:123], v[64:67], v[136:139]
    s_waitcnt lgkmcnt(7)
    v_mfma_f32_16x16x32_bf16 v[140:143], v[124:127], v[64:67], v[140:143]
    s_waitcnt lgkmcnt(6)
    v_mfma_f32_16x16x32_bf16 v[144:147], v[112:115], v[68:71], v[144:147]
    v_mfma_f32_16x16x32_bf16 v[148:151], v[116:119], v[68:71], v[148:151]
    v_mfma_f32_16x16x32_bf16 v[152:155], v[120:123], v[68:71], v[152:155]
    v_mfma_f32_16x16x32_bf16 v[156:159], v[124:127], v[68:71], v[156:159]
    s_waitcnt vmcnt(0) lgkmcnt(0)
    s_barrier
    v_xor_b32 v46, 0x8000, v46
    v_xor_b32 v47, 0x8000, v47
    v_xor_b32 v48, 0x8000, v48
    v_xor_b32 v49, 0x8000, v49
    v_xor_b32 v50, 0x8000, v50
    v_xor_b32 v51, 0x8000, v51
    ds_read_b128 v[64:67], v46 offset:0
    ds_read_b128 v[68:71], v46 offset:2048
    ds_read_b64_tr_b16 v[96:97], v48 offset:0
    ds_read_b64_tr_b16 v[98:99], v48 offset:1024
    ds_read_b64_tr_b16 v[100:101], v49 offset:0
    ds_read_b64_tr_b16 v[102:103], v49 offset:1024
    ds_read_b64_tr_b16 v[104:105], v50 offset:0
    ds_read_b64_tr_b16 v[106:107], v50 offset:1024
    ds_read_b64_tr_b16 v[108:109], v51 offset:0
    ds_read_b64_tr_b16 v[110:111], v51 offset:1024
    s_cmp_ge_u32 s70, 6
    s_cbranch_scc1 L_dma_skip_9
    s_mov_b32 m0, s68
    s_nop 0
    buffer_load_dwordx4 v40, s[12:15], s66 offen offset:0 lds
    buffer_load_dwordx4 v41, s[12:15], s66 offen offset:1024 lds
    buffer_load_dwordx4 v42, s[12:15], s66 offen offset:2048 lds
    buffer_load_dwordx4 v43, s[12:15], s66 offen offset:3072 lds
    s_mov_b32 m0, s69
    s_add_u32 s66, s66, 128
    buffer_load_dwordx4 v44, s[16:19], s67 offen offset:0 lds
    buffer_load_dwordx4 v45, s[16:19], s67 offen offset:1024 lds
    s_add_u32 m0, s69, 16384
    s_xor_b32 s68, s68, 0x8000
    buffer_load_dwordx4 v44, s[20:23], s67 offen offset:0 lds
    buffer_load_dwordx4 v45, s[20:23], s67 offen offset:1024 lds
    s_xor_b32 s69, s69, 0x8000
    s_add_u32 s67, s67, 524288
L_dma_skip_9:
    v_mfma_f32_16x16x32_bf16 v[160:163], v[112:115], v[72:75], v[160:163]
    v_mfma_f32_16x16x32_bf16 v[164:167], v[116:119], v[72:75], v[164:167]
    v_mfma_f32_16x16x32_bf16 v[168:171], v[120:123], v[72:75], v[168:171]
    v_mfma_f32_16x16x32_bf16 v[172:175], v[124:127], v[72:75], v[172:175]
    ds_read_b128 v[72:75], v46 offset:4096
    v_mfma_f32_16x16x32_bf16 v[176:179], v[112:115], v[76:79], v[176:179]
    v_mfma_f32_16x16x32_bf16 v[180:183], v[116:119], v[76:79], v[180:183]
    v_mfma_f32_16x16x32_bf16 v[184:187], v[120:123], v[76:79], v[184:187]
    v_mfma_f32_16x16x32_bf16 v[188:191], v[124:127], v[76:79], v[188:191]
    ds_read_b128 v[76:79], v46 offset:6144
    v_mfma_f32_16x16x32_bf16 v[192:195], v[112:115], v[80:83], v[192:195]
    v_mfma_f32_16x16x32_bf16 v[196:199], v[116:119], v[80:83], v[196:199]
    v_mfma_f32_16x16x32_bf16 v[200:203], v[120:123], v[80:83], v[200:203]
    v_mfma_f32_16x16x32_bf16 v[204:207], v[124:127], v[80:83], v[204:207]
    ds_read_b128 v[80:83], v46 offset:8192
    v_mfma_f32_16x16x32_bf16 v[208:211], v[112:115], v[84:87], v[208:211]
    v_mfma_f32_16x16x32_bf16 v[212:215], v[116:119], v[84:87], v[212:215]
    v_mfma_f32_16x16x32_bf16 v[216:219], v[120:123], v[84:87], v[216:219]
    v_mfma_f32_16x16x32_bf16 v[220:223], v[124:127], v[84:87], v[220:223]
    ds_read_b128 v[84:87], v46 offset:10240
    v_mfma_f32_16x16x32_bf16 v[224:227], v[112:115], v[88:91], v[224:227]
    v_mfma_f32_16x16x32_bf16 v[228:231], v[116:119], v[88:91], v[228:231]
    v_mfma_f32_16x16x32_bf16 v[232:235], v[120:123], v[88:91], v[232:235]
    v_mfma_f32_16x16x32_bf16 v[236:239], v[124:127], v[88:91], v[236:239]
    ds_read_b128 v[88:91], v46 offset:12288
    v_mfma_f32_16x16x32_bf16 v[240:243], v[112:115], v[92:95], v[240:243]
    v_mfma_f32_16x16x32_bf16 v[244:247], v[116:119], v[92:95], v[244:247]
    v_mfma_f32_16x16x32_bf16 v[248:251], v[120:123], v[92:95], v[248:251]
    v_mfma_f32_16x16x32_bf16 v[252:255], v[124:127], v[92:95], v[252:255]
    ds_read_b128 v[92:95], v46 offset:14336
    s_add_u32 s70, s70, 1
    s_cmp_lt_u32 s70, 8
    s_cbranch_scc1 L_k1_kloop
    s_lshr_b32 s7, s3, 1
    s_and_b32 s7, s7, 1
    s_lshl_b32 s7, s7, 11
    s_add_u32 s71, s71, s7
    s_waitcnt lgkmcnt(0)
    s_nop 7
    v_cvt_pk_bf16_f32 v64, v128, v129
    v_cvt_pk_bf16_f32 v65, v130, v131
    v_cvt_pk_bf16_f32 v66, v132, v133
    v_cvt_pk_bf16_f32 v67, v134, v135
    s_add_u32 s6, s71, 0
    buffer_store_dwordx4 v[64:67], v2, s[8:11], s6 offen offset:0
    v_cvt_pk_bf16_f32 v68, v136, v137
    v_cvt_pk_bf16_f32 v69, v138, v139
    v_cvt_pk_bf16_f32 v70, v140, v141
    v_cvt_pk_bf16_f32 v71, v142, v143
    buffer_store_dwordx4 v[68:71], v2, s[8:11], s6 offen offset:1024
    v_cvt_pk_bf16_f32 v72, v144, v145
    v_cvt_pk_bf16_f32 v73, v146, v147
    v_cvt_pk_bf16_f32 v74, v148, v149
    v_cvt_pk_bf16_f32 v75, v150, v151
    s_add_u32 s6, s71, 4096
    buffer_store_dwordx4 v[72:75], v2, s[8:11], s6 offen offset:0
    v_cvt_pk_bf16_f32 v76, v152, v153
    v_cvt_pk_bf16_f32 v77, v154, v155
    v_cvt_pk_bf16_f32 v78, v156, v157
    v_cvt_pk_bf16_f32 v79, v158, v159
    buffer_store_dwordx4 v[76:79], v2, s[8:11], s6 offen offset:1024
    v_cvt_pk_bf16_f32 v80, v160, v161
    v_cvt_pk_bf16_f32 v81, v162, v163
    v_cvt_pk_bf16_f32 v82, v164, v165
    v_cvt_pk_bf16_f32 v83, v166, v167
    s_add_u32 s6, s71, 8192
    buffer_store_dwordx4 v[80:83], v2, s[8:11], s6 offen offset:0
    v_cvt_pk_bf16_f32 v84, v168, v169
    v_cvt_pk_bf16_f32 v85, v170, v171
    v_cvt_pk_bf16_f32 v86, v172, v173
    v_cvt_pk_bf16_f32 v87, v174, v175
    buffer_store_dwordx4 v[84:87], v2, s[8:11], s6 offen offset:1024
    v_cvt_pk_bf16_f32 v88, v176, v177
    v_cvt_pk_bf16_f32 v89, v178, v179
    v_cvt_pk_bf16_f32 v90, v180, v181
    v_cvt_pk_bf16_f32 v91, v182, v183
    s_add_u32 s6, s71, 12288
    buffer_store_dwordx4 v[88:91], v2, s[8:11], s6 offen offset:0
    v_cvt_pk_bf16_f32 v92, v184, v185
    v_cvt_pk_bf16_f32 v93, v186, v187
    v_cvt_pk_bf16_f32 v94, v188, v189
    v_cvt_pk_bf16_f32 v95, v190, v191
    buffer_store_dwordx4 v[92:95], v2, s[8:11], s6 offen offset:1024
    v_cvt_pk_bf16_f32 v64, v192, v193
    v_cvt_pk_bf16_f32 v65, v194, v195
    v_cvt_pk_bf16_f32 v66, v196, v197
    v_cvt_pk_bf16_f32 v67, v198, v199
    s_add_u32 s6, s71, 32768
    buffer_store_dwordx4 v[64:67], v2, s[8:11], s6 offen offset:0
    v_cvt_pk_bf16_f32 v68, v200, v201
    v_cvt_pk_bf16_f32 v69, v202, v203
    v_cvt_pk_bf16_f32 v70, v204, v205
    v_cvt_pk_bf16_f32 v71, v206, v207
    buffer_store_dwordx4 v[68:71], v2, s[8:11], s6 offen offset:1024
    v_cvt_pk_bf16_f32 v72, v208, v209
    v_cvt_pk_bf16_f32 v73, v210, v211
    v_cvt_pk_bf16_f32 v74, v212, v213
    v_cvt_pk_bf16_f32 v75, v214, v215
    s_add_u32 s6, s71, 36864
    buffer_store_dwordx4 v[72:75], v2, s[8:11], s6 offen offset:0
    v_cvt_pk_bf16_f32 v76, v216, v217
    v_cvt_pk_bf16_f32 v77, v218, v219
    v_cvt_pk_bf16_f32 v78, v220, v221
    v_cvt_pk_bf16_f32 v79, v222, v223
    buffer_store_dwordx4 v[76:79], v2, s[8:11], s6 offen offset:1024
    v_cvt_pk_bf16_f32 v80, v224, v225
    v_cvt_pk_bf16_f32 v81, v226, v227
    v_cvt_pk_bf16_f32 v82, v228, v229
    v_cvt_pk_bf16_f32 v83, v230, v231
    s_add_u32 s6, s71, 40960
    buffer_store_dwordx4 v[80:83], v2, s[8:11], s6 offen offset:0
    v_cvt_pk_bf16_f32 v84, v232, v233
    v_cvt_pk_bf16_f32 v85, v234, v235
    v_cvt_pk_bf16_f32 v86, v236, v237
    v_cvt_pk_bf16_f32 v87, v238, v239
    buffer_store_dwordx4 v[84:87], v2, s[8:11], s6 offen offset:1024
    v_cvt_pk_bf16_f32 v88, v240, v241
    v_cvt_pk_bf16_f32 v89, v242, v243
    v_cvt_pk_bf16_f32 v90, v244, v245
    v_cvt_pk_bf16_f32 v91, v246, v247
    s_add_u32 s6, s71, 45056
    buffer_store_dwordx4 v[88:91], v2, s[8:11], s6 offen offset:0
    v_cvt_pk_bf16_f32 v92, v248, v249
    v_cvt_pk_bf16_f32 v93, v250, v251
    v_cvt_pk_bf16_f32 v94, v252, v253
    v_cvt_pk_bf16_f32 v95, v254, v255
    buffer_store_dwordx4 v[92:95], v2, s[8:11], s6 offen offset:1024
    s_branch L_k1_end
L_k1_v:
L_k1_vloop:
    s_waitcnt lgkmcnt(12)
    v_mfma_f32_16x16x32_bf16 v[128:131], v[64:67], v[96:99], v[128:131]
    ds_read_b64_tr_b16 v[112:113], v48 offset:8192
    s_waitcnt lgkmcnt(11)
    v_mfma_f32_16x16x32_bf16 v[132:135], v[64:67], v[100:103], v[132:135]
    ds_read_b64_tr_b16 v[114:115], v48 offset:9216
    s_waitcnt lgkmcnt(10)
    v_mfma_f32_16x16x32_bf16 v[136:139], v[64:67], v[104:107], v[136:139]
    ds_read_b64_tr_b16 v[116:117], v49 offset:8192
    s_waitcnt lgkmcnt(9)
    v_mfma_f32_16x16x32_bf16 v[140:143], v[64:67], v[108:111], v[140:143]
    ds_read_b64_tr_b16 v[118:119], v49 offset:9216
    ds_read_b128 v[64:67], v47 offset:0
    v_mfma_f32_16x16x32_bf16 v[144:147], v[68:71], v[96:99], v[144:147]
    ds_read_b64_tr_b16 v[120:121], v50 offset:8192
    v_mfma_f32_16x16x32_bf16 v[148:151], v[68:71], v[100:103], v[148:151]
    ds_read_b64_tr_b16 v[122:123], v50 offset:9216
    v_mfma_f32_16x16x32_bf16 v[152:155], v[68:71], v[104:107], v[152:155]
    ds_read_b64_tr_b16 v[124:125], v51 offset:8192
    v_mfma_f32_16x16x32_bf16 v[156:159], v[68:71], v[108:111], v[156:159]
    ds_read_b64_tr_b16 v[126:127], v51 offset:9216
    ds_read_b128 v[68:71], v47 offset:2048
    s_waitcnt lgkmcnt(15)
    v_mfma_f32_16x16x32_bf16 v[160:163], v[72:75], v[96:99], v[160:163]
    v_mfma_f32_16x16x32_bf16 v[164:167], v[72:75], v[100:103], v[164:167]
    v_mfma_f32_16x16x32_bf16 v[168:171], v[72:75], v[104:107], v[168:171]
    v_mfma_f32_16x16x32_bf16 v[172:175], v[72:75], v[108:111], v[172:175]
    ds_read_b128 v[72:75], v47 offset:4096
    s_waitcnt lgkmcnt(15)
    v_mfma_f32_16x16x32_bf16 v[176:179], v[76:79], v[96:99], v[176:179]
    v_mfma_f32_16x16x32_bf16 v[180:183], v[76:79], v[100:103], v[180:183]
    v_mfma_f32_16x16x32_bf16 v[184:187], v[76:79], v[104:107], v[184:187]
    v_mfma_f32_16x16x32_bf16 v[188:191], v[76:79], v[108:111], v[188:191]
    ds_read_b128 v[76:79], v47 offset:6144
    s_waitcnt lgkmcnt(15)
    v_mfma_f32_16x16x32_bf16 v[192:195], v[80:83], v[96:99], v[192:195]
    v_mfma_f32_16x16x32_bf16 v[196:199], v[80:83], v[100:103], v[196:199]
    v_mfma_f32_16x16x32_bf16 v[200:203], v[80:83], v[104:107], v[200:203]
    v_mfma_f32_16x16x32_bf16 v[204:207], v[80:83], v[108:111], v[204:207]
    ds_read_b128 v[80:83], v47 offset:8192
    s_waitcnt lgkmcnt(15)
    v_mfma_f32_16x16x32_bf16 v[208:211], v[84:87], v[96:99], v[208:211]
    v_mfma_f32_16x16x32_bf16 v[212:215], v[84:87], v[100:103], v[212:215]
    v_mfma_f32_16x16x32_bf16 v[216:219], v[84:87], v[104:107], v[216:219]
    v_mfma_f32_16x16x32_bf16 v[220:223], v[84:87], v[108:111], v[220:223]
    ds_read_b128 v[84:87], v47 offset:10240
    s_waitcnt lgkmcnt(15)
    v_mfma_f32_16x16x32_bf16 v[224:227], v[88:91], v[96:99], v[224:227]
    v_mfma_f32_16x16x32_bf16 v[228:231], v[88:91], v[100:103], v[228:231]
    v_mfma_f32_16x16x32_bf16 v[232:235], v[88:91], v[104:107], v[232:235]
    v_mfma_f32_16x16x32_bf16 v[236:239], v[88:91], v[108:111], v[236:239]
    ds_read_b128 v[88:91], v47 offset:12288
    s_waitcnt lgkmcnt(15)
    v_mfma_f32_16x16x32_bf16 v[240:243], v[92:95], v[96:99], v[240:243]
    v_mfma_f32_16x16x32_bf16 v[244:247], v[92:95], v[100:103], v[244:247]
    v_mfma_f32_16x16x32_bf16 v[248:251], v[92:95], v[104:107], v[248:251]
    v_mfma_f32_16x16x32_bf16 v[252:255], v[92:95], v[108:111], v[252:255]
    ds_read_b128 v[92:95], v47 offset:14336
    s_waitcnt lgkmcnt(11)
    v_mfma_f32_16x16x32_bf16 v[128:131], v[64:67], v[112:115], v[128:131]
    v_mfma_f32_16x16x32_bf16 v[132:135], v[64:67], v[116:119], v[132:135]
    s_waitcnt lgkmcnt(9)
    v_mfma_f32_16x16x32_bf16 v[136:139], v[64:67], v[120:123], v[136:139]
    s_waitcnt lgkmcnt(7)
    v_mfma_f32_16x16x32_bf16 v[140:143], v[64:67], v[124:127], v[140:143]
    s_waitcnt lgkmcnt(6)
    v_mfma_f32_16x16x32_bf16 v[144:147], v[68:71], v[112:115], v[144:147]
    v_mfma_f32_16x16x32_bf16 v[148:151], v[68:71], v[116:119], v[148:151]
    v_mfma_f32_16x16x32_bf16 v[152:155], v[68:71], v[120:123], v[152:155]
    v_mfma_f32_16x16x32_bf16 v[156:159], v[68:71], v[124:127], v[156:159]
    s_waitcnt vmcnt(0) lgkmcnt(0)
    s_barrier
    v_xor_b32 v46, 0x8000, v46
    v_xor_b32 v47, 0x8000, v47
    v_xor_b32 v48, 0x8000, v48
    v_xor_b32 v49, 0x8000, v49
    v_xor_b32 v50, 0x8000, v50
    v_xor_b32 v51, 0x8000, v51
    ds_read_b128 v[64:67], v46 offset:0
    ds_read_b128 v[68:71], v46 offset:2048
    ds_read_b64_tr_b16 v[96:97], v48 offset:0
    ds_read_b64_tr_b16 v[98:99], v48 offset:1024
    ds_read_b64_tr_b16 v[100:101], v49 offset:0
    ds_read_b64_tr_b16 v[102:103], v49 offset:1024
    ds_read_b64_tr_b16 v[104:105], v50 offset:0
    ds_read_b64_tr_b16 v[106:107], v50 offset:1024
    ds_read_b64_tr_b16 v[108:109], v51 offset:0
    ds_read_b64_tr_b16 v[110:111], v51 offset:1024
    s_cmp_ge_u32 s70, 6
    s_cbranch_scc1 L_dma_skip_10
    s_mov_b32 m0, s68
    s_nop 0
    buffer_load_dwordx4 v40, s[12:15], s66 offen offset:0 lds
    buffer_load_dwordx4 v41, s[12:15], s66 offen offset:1024 lds
    buffer_load_dwordx4 v42, s[12:15], s66 offen offset:2048 lds
    buffer_load_dwordx4 v43, s[12:15], s66 offen offset:3072 lds
    s_mov_b32 m0, s69
    s_add_u32 s66, s66, 128
    buffer_load_dwordx4 v44, s[16:19], s67 offen offset:0 lds
    buffer_load_dwordx4 v45, s[16:19], s67 offen offset:1024 lds
    s_add_u32 m0, s69, 16384
    s_xor_b32 s68, s68, 0x8000
    buffer_load_dwordx4 v44, s[20:23], s67 offen offset:0 lds
    buffer_load_dwordx4 v45, s[20:23], s67 offen offset:1024 lds
    s_xor_b32 s69, s69, 0x8000
    s_add_u32 s67, s67, 524288
L_dma_skip_10:
    v_mfma_f32_16x16x32_bf16 v[160:163], v[72:75], v[112:115], v[160:163]
    v_mfma_f32_16x16x32_bf16 v[164:167], v[72:75], v[116:119], v[164:167]
    v_mfma_f32_16x16x32_bf16 v[168:171], v[72:75], v[120:123], v[168:171]
    v_mfma_f32_16x16x32_bf16 v[172:175], v[72:75], v[124:127], v[172:175]
    ds_read_b128 v[72:75], v46 offset:4096
    v_mfma_f32_16x16x32_bf16 v[176:179], v[76:79], v[112:115], v[176:179]
    v_mfma_f32_16x16x32_bf16 v[180:183], v[76:79], v[116:119], v[180:183]
    v_mfma_f32_16x16x32_bf16 v[184:187], v[76:79], v[120:123], v[184:187]
    v_mfma_f32_16x16x32_bf16 v[188:191], v[76:79], v[124:127], v[188:191]
    ds_read_b128 v[76:79], v46 offset:6144
    v_mfma_f32_16x16x32_bf16 v[192:195], v[80:83], v[112:115], v[192:195]
    v_mfma_f32_16x16x32_bf16 v[196:199], v[80:83], v[116:119], v[196:199]
    v_mfma_f32_16x16x32_bf16 v[200:203], v[80:83], v[120:123], v[200:203]
    v_mfma_f32_16x16x32_bf16 v[204:207], v[80:83], v[124:127], v[204:207]
    ds_read_b128 v[80:83], v46 offset:8192
    v_mfma_f32_16x16x32_bf16 v[208:211], v[84:87], v[112:115], v[208:211]
    v_mfma_f32_16x16x32_bf16 v[212:215], v[84:87], v[116:119], v[212:215]
    v_mfma_f32_16x16x32_bf16 v[216:219], v[84:87], v[120:123], v[216:219]
    v_mfma_f32_16x16x32_bf16 v[220:223], v[84:87], v[124:127], v[220:223]
    ds_read_b128 v[84:87], v46 offset:10240
    v_mfma_f32_16x16x32_bf16 v[224:227], v[88:91], v[112:115], v[224:227]
    v_mfma_f32_16x16x32_bf16 v[228:231], v[88:91], v[116:119], v[228:231]
    v_mfma_f32_16x16x32_bf16 v[232:235], v[88:91], v[120:123], v[232:235]
    v_mfma_f32_16x16x32_bf16 v[236:239], v[88:91], v[124:127], v[236:239]
    ds_read_b128 v[88:91], v46 offset:12288
    v_mfma_f32_16x16x32_bf16 v[240:243], v[92:95], v[112:115], v[240:243]
    v_mfma_f32_16x16x32_bf16 v[244:247], v[92:95], v[116:119], v[244:247]
    v_mfma_f32_16x16x32_bf16 v[248:251], v[92:95], v[120:123], v[248:251]
    v_mfma_f32_16x16x32_bf16 v[252:255], v[92:95], v[124:127], v[252:255]
    ds_read_b128 v[92:95], v46 offset:14336
    s_add_u32 s70, s70, 1
    s_cmp_lt_u32 s70, 8
    s_cbranch_scc1 L_k1_vloop
    s_lshr_b32 s7, s3, 1
    s_and_b32 s7, s7, 1
    s_lshl_b32 s7, s7, 12
    s_add_u32 s71, s71, s7
    s_add_u32 s71, s71, 16384
    s_waitcnt lgkmcnt(0)
    s_nop 7
    v_cvt_pk_bf16_f32 v64, v128, v129
    v_cvt_pk_bf16_f32 v65, v130, v131
    v_cvt_pk_bf16_f32 v66, v144, v145
    v_cvt_pk_bf16_f32 v67, v146, v147
    s_add_u32 s6, s71, 0
    buffer_store_dwordx4 v[64:67], v2, s[8:11], s6 offen offset:0
    v_cvt_pk_bf16_f32 v68, v132, v133
    v_cvt_pk_bf16_f32 v69, v134, v135
    v_cvt_pk_bf16_f32 v70, v148, v149
    v_cvt_pk_bf16_f32 v71, v150, v151
    buffer_store_dwordx4 v[68:71], v2, s[8:11], s6 offen offset:1024
    v_cvt_pk_bf16_f32 v72, v136, v137
    v_cvt_pk_bf16_f32 v73, v138, v139
    v_cvt_pk_bf16_f32 v74, v152, v153
    v_cvt_pk_bf16_f32 v75, v154, v155
    buffer_store_dwordx4 v[72:75], v2, s[8:11], s6 offen offset:2048
    v_cvt_pk_bf16_f32 v76, v140, v141
    v_cvt_pk_bf16_f32 v77, v142, v143
    v_cvt_pk_bf16_f32 v78, v156, v157
    v_cvt_pk_bf16_f32 v79, v158, v159
    buffer_store_dwordx4 v[76:79], v2, s[8:11], s6 offen offset:3072
    v_cvt_pk_bf16_f32 v80, v160, v161
    v_cvt_pk_bf16_f32 v81, v162, v163
    v_cvt_pk_bf16_f32 v82, v176, v177
    v_cvt_pk_bf16_f32 v83, v178, v179
    s_add_u32 s6, s71, 8192
    buffer_store_dwordx4 v[80:83], v2, s[8:11], s6 offen offset:0
    v_cvt_pk_bf16_f32 v84, v164, v165
    v_cvt_pk_bf16_f32 v85, v166, v167
    v_cvt_pk_bf16_f32 v86, v180, v181
    v_cvt_pk_bf16_f32 v87, v182, v183
    buffer_store_dwordx4 v[84:87], v2, s[8:11], s6 offen offset:1024
    v_cvt_pk_bf16_f32 v88, v168, v169
    v_cvt_pk_bf16_f32 v89, v170, v171
    v_cvt_pk_bf16_f32 v90, v184, v185
    v_cvt_pk_bf16_f32 v91, v186, v187
    buffer_store_dwordx4 v[88:91], v2, s[8:11], s6 offen offset:2048
    v_cvt_pk_bf16_f32 v92, v172, v173
    v_cvt_pk_bf16_f32 v93, v174, v175
    v_cvt_pk_bf16_f32 v94, v188, v189
    v_cvt_pk_bf16_f32 v95, v190, v191
    buffer_store_dwordx4 v[92:95], v2, s[8:11], s6 offen offset:3072
    v_cvt_pk_bf16_f32 v64, v192, v193
    v_cvt_pk_bf16_f32 v65, v194, v195
    v_cvt_pk_bf16_f32 v66, v208, v209
    v_cvt_pk_bf16_f32 v67, v210, v211
    s_add_u32 s6, s71, 32768
    buffer_store_dwordx4 v[64:67], v2, s[8:11], s6 offen offset:0
    v_cvt_pk_bf16_f32 v68, v196, v197
    v_cvt_pk_bf16_f32 v69, v198, v199
    v_cvt_pk_bf16_f32 v70, v212, v213
    v_cvt_pk_bf16_f32 v71, v214, v215
    buffer_store_dwordx4 v[68:71], v2, s[8:11], s6 offen offset:1024
    v_cvt_pk_bf16_f32 v72, v200, v201
    v_cvt_pk_bf16_f32 v73, v202, v203
    v_cvt_pk_bf16_f32 v74, v216, v217
    v_cvt_pk_bf16_f32 v75, v218, v219
    buffer_store_dwordx4 v[72:75], v2, s[8:11], s6 offen offset:2048
    v_cvt_pk_bf16_f32 v76, v204, v205
    v_cvt_pk_bf16_f32 v77, v206, v207
    v_cvt_pk_bf16_f32 v78, v220, v221
    v_cvt_pk_bf16_f32 v79, v222, v223
    buffer_store_dwordx4 v[76:79], v2, s[8:11], s6 offen offset:3072
    v_cvt_pk_bf16_f32 v80, v224, v225
    v_cvt_pk_bf16_f32 v81, v226, v227
    v_cvt_pk_bf16_f32 v82, v240, v241
    v_cvt_pk_bf16_f32 v83, v242, v243
    s_add_u32 s6, s71, 40960
    buffer_store_dwordx4 v[80:83], v2, s[8:11], s6 offen offset:0
    v_cvt_pk_bf16_f32 v84, v228, v229
    v_cvt_pk_bf16_f32 v85, v230, v231
    v_cvt_pk_bf16_f32 v86, v244, v245
    v_cvt_pk_bf16_f32 v87, v246, v247
    buffer_store_dwordx4 v[84:87], v2, s[8:11], s6 offen offset:1024
    v_cvt_pk_bf16_f32 v88, v232, v233
    v_cvt_pk_bf16_f32 v89, v234, v235
    v_cvt_pk_bf16_f32 v90, v248, v249
    v_cvt_pk_bf16_f32 v91, v250, v251
    buffer_store_dwordx4 v[88:91], v2, s[8:11], s6 offen offset:2048
    v_cvt_pk_bf16_f32 v92, v236, v237
    v_cvt_pk_bf16_f32 v93, v238, v239
    v_cvt_pk_bf16_f32 v94, v252, v253
    v_cvt_pk_bf16_f32 v95, v254, v255
    buffer_store_dwordx4 v[92:95], v2, s[8:11], s6 offen offset:3072
L_k1_end:
    s_endpgm
.text
.globl k2_kernel
.p2align 8
.type k2_kernel,@function
k2_kernel:
    s_cmp_ge_u32 s2, 256
    s_cbranch_scc1 L_k2_end
    s_load_dwordx16 s[32:47], s[0:1], 0
    s_load_dwordx8 s[48:55], s[0:1], 64
    s_load_dwordx4 s[56:59], s[0:1], 96
    v_lshrrev_b32 v2, 6, v0
    v_and_b32 v1, 63, v0
    v_readfirstlane_b32 s3, v2
    s_and_b32 s6, s2, 7
    s_lshl_b32 s6, s6, 2
    s_lshr_b32 s7, s2, 3
    s_and_b32 s7, s7, 3
    s_add_u32 s4, s6, s7
    s_lshr_b32 s5, s2, 5
    s_waitcnt lgkmcnt(0)
    s_mov_b32 s8, s58
    s_mov_b32 s9, s59
    s_mov_b32 s10, 0x4000000
    s_mov_b32 s11, 0x20000
    s_mov_b32 s12, s36
    s_mov_b32 s13, s37
    s_mov_b32 s14, 0x500000
    s_mov_b32 s15, 0x20000
    s_lshl_b32 s6, s5, 2
    s_add_u32 s7, s6, s3
    s_sub_u32 s6, 56, s6
    s_add_u32 s6, s6, s3
    s_cmp_lt_u32 s3, 4
    s_cselect_b32 s60, s7, s6
    s_cselect_b32 s65, 1, 0
    s_lshl_b32 s6, s5, 1
    s_sub_u32 s62, 31, s6
    v_lshlrev_b32 v222, 4, v1
    v_lshrrev_b32 v4, 4, v1
    v_and_b32 v6, 15, v1
    s_lshl_b32 s6, s3, 4
    v_add_u32 v7, s6, v4
    v_or_b32 v5, 0, v4
    v_lshlrev_b32 v5, 1, v5
    v_xor_b32 v5, v6, v5
    v_lshlrev_b32 v5, 4, v5
    v_lshl_add_u32 v232, v7, 13, v5
    v_or_b32 v5, 0, v4
    v_lshlrev_b32 v5, 1, v5
    v_xor_b32 v5, v6, v5
    v_lshlrev_b32 v5, 4, v5
    v_lshl_add_u32 v233, v7, 13, v5
    v_add_u32 v233, 31744, v233
    v_or_b32 v5, 4, v4
    v_lshlrev_b32 v5, 1, v5
    v_xor_b32 v5, v6, v5
    v_lshlrev_b32 v5, 4, v5
    v_lshl_add_u32 v234, v7, 13, v5
    v_add_u32 v234, 63488, v234
    v_or_b32 v5, 4, v4
    v_lshlrev_b32 v5, 1, v5
    v_xor_b32 v5, v6, v5
    v_lshlrev_b32 v5, 4, v5
    v_lshl_add_u32 v235, v7, 13, v5
    v_add_u32 v235, 95232, v235
    s_lshl_b32 s68, s4, 8
    s_lshl_b32 s69, s3, 12
    s_add_u32 s69, s69, 98304
    v_add_u32 v236, 20480, v222
    s_mul_i32 s70, s60, 40960
    s_mov_b32 m0, s69
    s_nop 0
    buffer_load_dwordx4 v232, s[12:15], s68 offen offset:0 lds
    buffer_load_dwordx4 v233, s[12:15], s68 offen offset:1024 lds
    buffer_load_dwordx4 v234, s[12:15], s68 offen offset:2048 lds
    buffer_load_dwordx4 v235, s[12:15], s68 offen offset:3072 lds
    s_xor_b32 s69, s69, 0x38000
    s_add_u32 s68, s68, 1048576
    buffer_load_dwordx4 v[112:115], v222, s[8:11], s70 offen offset:0
    buffer_load_dwordx4 v[116:119], v236, s[8:11], s70 offen offset:0
    buffer_load_dwordx4 v[120:123], v222, s[8:11], s70 offen offset:1024
    buffer_load_dwordx4 v[124:127], v236, s[8:11], s70 offen offset:1024
    buffer_load_dwordx4 v[128:131], v222, s[8:11], s70 offen offset:2048
    buffer_load_dwordx4 v[132:135], v236, s[8:11], s70 offen offset:2048
    s_mov_b32 m0, s69
    s_nop 0
    buffer_load_dwordx4 v232, s[12:15], s68 offen offset:0 lds
    buffer_load_dwordx4 v233, s[12:15], s68 offen offset:1024 lds
    buffer_load_dwordx4 v234, s[12:15], s68 offen offset:2048 lds
    buffer_load_dwordx4 v235, s[12:15], s68 offen offset:3072 lds
    s_xor_b32 s69, s69, 0x38000
    s_add_u32 s68, s68, 1048576
    buffer_load_dwordx4 v[136:139], v222, s[8:11], s70 offen offset:3072
    buffer_load_dwordx4 v[140:143], v236, s[8:11], s70 offen offset:3072
    s_add_u32 s70, s70, 4096
    s_lshl_b32 s6, s3, 13
    v_add_u32 v223, s6, v222
    s_lshl_b32 s63, s4, 20
    s_add_u32 s63, s63, 16777216
    s_lshl_b32 s64, s3, 13
    s_cmp_eq_u32 s65, 0
    s_cbranch_scc1 L_k2_nold
    s_add_u32 m0, s64, 0
    s_add_u32 s66, s63, 0
    buffer_load_dwordx4 v223, s[8:11], s66 offen offset:0 lds
    buffer_load_dwordx4 v223, s[8:11], s66 offen offset:1024 lds
    buffer_load_dwordx4 v223, s[8:11], s66 offen offset:2048 lds
    buffer_load_dwordx4 v223, s[8:11], s66 offen offset:3072 lds
    s_add_u32 m0, s64, 4096
    s_add_u32 s66, s63, 4096
    buffer_load_dwordx4 v223, s[8:11], s66 offen offset:0 lds
    buffer_load_dwordx4 v223, s[8:11], s66 offen offset:1024 lds
    buffer_load_dwordx4 v223, s[8:11], s66 offen offset:2048 lds
    buffer_load_dwordx4 v223, s[8:11], s66 offen offset:3072 lds
    s_add_u32 s64, s64, 32768
    s_and_b32 s64, s64, 0x1ffff
    s_add_u32 s63, s63, 32768
    s_add_u32 m0, s64, 0
    s_add_u32 s66, s63, 0
    buffer_load_dwordx4 v223, s[8:11], s66 offen offset:0 lds
    buffer_load_dwordx4 v223, s[8:11], s66 offen offset:1024 lds
    buffer_load_dwordx4 v223, s[8:11], s66 offen offset:2048 lds
    buffer_load_dwordx4 v223, s[8:11], s66 offen offset:3072 lds
    s_add_u32 m0, s64, 4096
    s_add_u32 s66, s63, 4096
    buffer_load_dwordx4 v223, s[8:11], s66 offen offset:0 lds
    buffer_load_dwordx4 v223, s[8:11], s66 offen offset:1024 lds
    buffer_load_dwordx4 v223, s[8:11], s66 offen offset:2048 lds
    buffer_load_dwordx4 v223, s[8:11], s66 offen offset:3072 lds
    s_add_u32 s64, s64, 32768
    s_and_b32 s64, s64, 0x1ffff
    s_add_u32 s63, s63, 32768
L_k2_nold:
    v_and_b32 v2, 15, v1
    v_lshrrev_b32 v3, 4, v1
    v_lshrrev_b32 v4, 2, v2
    v_lshl_add_u32 v5, v3, 3, v4
    v_lshlrev_b32 v5, 8, v5
    v_and_b32 v6, 1, v2
    v_lshl_add_u32 v5, v6, 3, v5
    v_add_u32 v5, 98304, v5
    v_and_b32 v6, 1, v3
    v_lshl_or_b32 v4, v6, 2, v4
    v_lshlrev_b32 v4, 1, v4
    v_bfe_u32 v6, v2, 1, 1
    v_add_u32 v7, 0, v6
    v_xor_b32 v7, v7, v4
    v_lshl_add_u32 v224, v7, 4, v5
    v_add_u32 v7, 2, v6
    v_xor_b32 v7, v7, v4
    v_lshl_add_u32 v225, v7, 4, v5
    v_add_u32 v7, 4, v6
    v_xor_b32 v7, v7, v4
    v_lshl_add_u32 v226, v7, 4, v5
    v_add_u32 v7, 6, v6
    v_xor_b32 v7, v7, v4
    v_lshl_add_u32 v227, v7, 4, v5
    v_add_u32 v7, 8, v6
    v_xor_b32 v7, v7, v4
    v_lshl_add_u32 v228, v7, 4, v5
    v_add_u32 v7, 10, v6
    v_xor_b32 v7, v7, v4
    v_lshl_add_u32 v229, v7, 4, v5
    v_add_u32 v7, 12, v6
    v_xor_b32 v7, v7, v4
    v_lshl_add_u32 v230, v7, 4, v5
    v_add_u32 v7, 14, v6
    v_xor_b32 v7, v7, v4
    v_lshl_add_u32 v231, v7, 4, v5
    v_mov_b32 v48, 0
    v_mov_b32 v49, 0
    v_mov_b32 v50, 0
    v_mov_b32 v51, 0
    v_mov_b32 v52, 0
    v_mov_b32 v53, 0
    v_mov_b32 v54, 0
    v_mov_b32 v55, 0
    v_mov_b32 v56, 0
    v_mov_b32 v57, 0
    v_mov_b32 v58, 0
    v_mov_b32 v59, 0
    v_mov_b32 v60, 0
    v_mov_b32 v61, 0
    v_mov_b32 v62, 0
    v_mov_b32 v63, 0
    v_mov_b32 v64, 0
    v_mov_b32 v65, 0
    v_mov_b32 v66, 0
    v_mov_b32 v67, 0
    v_mov_b32 v68, 0
    v_mov_b32 v69, 0
    v_mov_b32 v70, 0
    v_mov_b32 v71, 0
    v_mov_b32 v72, 0
    v_mov_b32 v73, 0
    v_mov_b32 v74, 0
    v_mov_b32 v75, 0
    v_mov_b32 v76, 0
    v_mov_b32 v77, 0
    v_mov_b32 v78, 0
    v_mov_b32 v79, 0
    v_mov_b32 v80, 0
    v_mov_b32 v81, 0
    v_mov_b32 v82, 0
    v_mov_b32 v83, 0
    v_mov_b32 v84, 0
    v_mov_b32 v85, 0
    v_mov_b32 v86, 0
    v_mov_b32 v87, 0
    v_mov_b32 v88, 0
    v_mov_b32 v89, 0
    v_mov_b32 v90, 0
    v_mov_b32 v91, 0
    v_mov_b32 v92, 0
    v_mov_b32 v93, 0
    v_mov_b32 v94, 0
    v_mov_b32 v95, 0
    v_mov_b32 v96, 0
    v_mov_b32 v97, 0
    v_mov_b32 v98, 0
    v_mov_b32 v99, 0
    v_mov_b32 v100, 0
    v_mov_b32 v101, 0
    v_mov_b32 v102, 0
    v_mov_b32 v103, 0
    v_mov_b32 v104, 0
    v_mov_b32 v105, 0
    v_mov_b32 v106, 0
    v_mov_b32 v107, 0
    v_mov_b32 v108, 0
    v_mov_b32 v109, 0
    v_mov_b32 v110, 0
    v_mov_b32 v111, 0
    s_waitcnt vmcnt(12)
    s_barrier
    ds_read_b64_tr_b16 v[144:145], v224 offset:0
    ds_read_b64_tr_b16 v[146:147], v224 offset:1024
    ds_read_b64_tr_b16 v[148:149], v225 offset:0
    ds_read_b64_tr_b16 v[150:151], v225 offset:1024
    ds_read_b64_tr_b16 v[152:153], v226 offset:0
    ds_read_b64_tr_b16 v[154:155], v226 offset:1024
    ds_read_b64_tr_b16 v[156:157], v227 offset:0
    ds_read_b64_tr_b16 v[158:159], v227 offset:1024
    ds_read_b64_tr_b16 v[160:161], v228 offset:0
    ds_read_b64_tr_b16 v[162:163], v228 offset:1024
    ds_read_b64_tr_b16 v[164:165], v229 offset:0
    ds_read_b64_tr_b16 v[166:167], v229 offset:1024
    ds_read_b64_tr_b16 v[168:169], v230 offset:0
    ds_read_b64_tr_b16 v[170:171], v230 offset:1024
    ds_read_b64_tr_b16 v[172:173], v231 offset:0
    ds_read_b64_tr_b16 v[174:175], v231 offset:1024
    s_mov_b32 s71, 0
L_k2_qloop:
    s_cmp_ge_u32 s71, 4
    s_cselect_b32 s70, 0x4000000, s70
    s_waitcnt vmcnt(10)
    s_waitcnt lgkmcnt(14)
    v_mfma_f32_16x16x32_bf16 v[48:51], v[144:147], v[112:115], v[48:51]
    v_mfma_f32_16x16x32_bf16 v[52:55], v[144:147], v[116:119], v[52:55]
    ds_read_b64_tr_b16 v[144:145], v224 offset:8192
    ds_read_b64_tr_b16 v[146:147], v224 offset:9216
    s_waitcnt lgkmcnt(14)
    v_mfma_f32_16x16x32_bf16 v[56:59], v[148:151], v[112:115], v[56:59]
    v_mfma_f32_16x16x32_bf16 v[60:63], v[148:151], v[116:119], v[60:63]
    ds_read_b64_tr_b16 v[148:149], v225 offset:8192
    ds_read_b64_tr_b16 v[150:151], v225 offset:9216
    s_waitcnt lgkmcnt(14)
    v_mfma_f32_16x16x32_bf16 v[64:67], v[152:155], v[112:115], v[64:67]
    v_mfma_f32_16x16x32_bf16 v[68:71], v[152:155], v[116:119], v[68:71]
    ds_read_b64_tr_b16 v[152:153], v226 offset:8192
    ds_read_b64_tr_b16 v[154:155], v226 offset:9216
    s_waitcnt lgkmcnt(14)
    v_mfma_f32_16x16x32_bf16 v[72:75], v[156:159], v[112:115], v[72:75]
    v_mfma_f32_16x16x32_bf16 v[76:79], v[156:159], v[116:119], v[76:79]
    ds_read_b64_tr_b16 v[156:157], v227 offset:8192
    ds_read_b64_tr_b16 v[158:159], v227 offset:9216
    s_waitcnt lgkmcnt(14)
    v_mfma_f32_16x16x32_bf16 v[80:83], v[160:163], v[112:115], v[80:83]
    v_mfma_f32_16x16x32_bf16 v[84:87], v[160:163], v[116:119], v[84:87]
    ds_read_b64_tr_b16 v[160:161], v228 offset:8192
    ds_read_b64_tr_b16 v[162:163], v228 offset:9216
    s_waitcnt lgkmcnt(14)
    v_mfma_f32_16x16x32_bf16 v[88:91], v[164:167], v[112:115], v[88:91]
    v_mfma_f32_16x16x32_bf16 v[92:95], v[164:167], v[116:119], v[92:95]
    ds_read_b64_tr_b16 v[164:165], v229 offset:8192
    ds_read_b64_tr_b16 v[166:167], v229 offset:9216
    s_waitcnt lgkmcnt(14)
    v_mfma_f32_16x16x32_bf16 v[96:99], v[168:171], v[112:115], v[96:99]
    v_mfma_f32_16x16x32_bf16 v[100:103], v[168:171], v[116:119], v[100:103]
    ds_read_b64_tr_b16 v[168:169], v230 offset:8192
    ds_read_b64_tr_b16 v[170:171], v230 offset:9216
    s_waitcnt lgkmcnt(14)
    v_mfma_f32_16x16x32_bf16 v[104:107], v[172:175], v[112:115], v[104:107]
    v_mfma_f32_16x16x32_bf16 v[108:111], v[172:175], v[116:119], v[108:111]
    ds_read_b64_tr_b16 v[172:173], v231 offset:8192
    ds_read_b64_tr_b16 v[174:175], v231 offset:9216
    buffer_load_dwordx4 v[112:115], v222, s[8:11], s70 offen offset:0
    buffer_load_dwordx4 v[116:119], v236, s[8:11], s70 offen offset:0
    s_waitcnt vmcnt(10)
    s_waitcnt lgkmcnt(14)
    v_mfma_f32_16x16x32_bf16 v[48:51], v[144:147], v[120:123], v[48:51]
    v_mfma_f32_16x16x32_bf16 v[52:55], v[144:147], v[124:127], v[52:55]
    ds_read_b64_tr_b16 v[144:145], v224 offset:16384
    ds_read_b64_tr_b16 v[146:147], v224 offset:17408
    s_waitcnt lgkmcnt(14)
    v_mfma_f32_16x16x32_bf16 v[56:59], v[148:151], v[120:123], v[56:59]
    v_mfma_f32_16x16x32_bf16 v[60:63], v[148:151], v[124:127], v[60:63]
    ds_read_b64_tr_b16 v[148:149], v225 offset:16384
    ds_read_b64_tr_b16 v[150:151], v225 offset:17408
    s_waitcnt lgkmcnt(14)
    v_mfma_f32_16x16x32_bf16 v[64:67], v[152:155], v[120:123], v[64:67]
    v_mfma_f32_16x16x32_bf16 v[68:71], v[152:155], v[124:127], v[68:71]
    ds_read_b64_tr_b16 v[152:153], v226 offset:16384
    ds_read_b64_tr_b16 v[154:155], v226 offset:17408
    s_waitcnt lgkmcnt(14)
    v_mfma_f32_16x16x32_bf16 v[72:75], v[156:159], v[120:123], v[72:75]
    v_mfma_f32_16x16x32_bf16 v[76:79], v[156:159], v[124:127], v[76:79]
    ds_read_b64_tr_b16 v[156:157], v227 offset:16384
    ds_read_b64_tr_b16 v[158:159], v227 offset:17408
    s_waitcnt lgkmcnt(14)
    v_mfma_f32_16x16x32_bf16 v[80:83], v[160:163], v[120:123], v[80:83]
    v_mfma_f32_16x16x32_bf16 v[84:87], v[160:163], v[124:127], v[84:87]
    ds_read_b64_tr_b16 v[160:161], v228 offset:16384
    ds_read_b64_tr_b16 v[162:163], v228 offset:17408
    s_waitcnt lgkmcnt(14)
    v_mfma_f32_16x16x32_bf16 v[88:91], v[164:167], v[120:123], v[88:91]
    v_mfma_f32_16x16x32_bf16 v[92:95], v[164:167], v[124:127], v[92:95]
    ds_read_b64_tr_b16 v[164:165], v229 offset:16384
    ds_read_b64_tr_b16 v[166:167], v229 offset:17408
    s_waitcnt lgkmcnt(14)
    v_mfma_f32_16x16x32_bf16 v[96:99], v[168:171], v[120:123], v[96:99]
    v_mfma_f32_16x16x32_bf16 v[100:103], v[168:171], v[124:127], v[100:103]
    ds_read_b64_tr_b16 v[168:169], v230 offset:16384
    ds_read_b64_tr_b16 v[170:171], v230 offset:17408
    s_waitcnt lgkmcnt(14)
    v_mfma_f32_16x16x32_bf16 v[104:107], v[172:175], v[120:123], v[104:107]
    v_mfma_f32_16x16x32_bf16 v[108:111], v[172:175], v[124:127], v[108:111]
    ds_read_b64_tr_b16 v[172:173], v231 offset:16384
    ds_read_b64_tr_b16 v[174:175], v231 offset:17408
    buffer_load_dwordx4 v[120:123], v222, s[8:11], s70 offen offset:1024
    buffer_load_dwordx4 v[124:127], v236, s[8:11], s70 offen offset:1024
    s_waitcnt vmcnt(10)
    s_waitcnt lgkmcnt(14)
    v_mfma_f32_16x16x32_bf16 v[48:51], v[144:147], v[128:131], v[48:51]
    v_mfma_f32_16x16x32_bf16 v[52:55], v[144:147], v[132:135], v[52:55]
    ds_read_b64_tr_b16 v[144:145], v224 offset:24576
    ds_read_b64_tr_b16 v[146:147], v224 offset:25600
    s_waitcnt lgkmcnt(14)
    v_mfma_f32_16x16x32_bf16 v[56:59], v[148:151], v[128:131], v[56:59]
    v_mfma_f32_16x16x32_bf16 v[60:63], v[148:151], v[132:135], v[60:63]
    ds_read_b64_tr_b16 v[148:149], v225 offset:24576
    ds_read_b64_tr_b16 v[150:151], v225 offset:25600
    s_waitcnt lgkmcnt(14)
    v_mfma_f32_16x16x32_bf16 v[64:67], v[152:155], v[128:131], v[64:67]
    v_mfma_f32_16x16x32_bf16 v[68:71], v[152:155], v[132:135], v[68:71]
    ds_read_b64_tr_b16 v[152:153], v226 offset:24576
    ds_read_b64_tr_b16 v[154:155], v226 offset:25600
    s_waitcnt lgkmcnt(14)
    v_mfma_f32_16x16x32_bf16 v[72:75], v[156:159], v[128:131], v[72:75]
    v_mfma_f32_16x16x32_bf16 v[76:79], v[156:159], v[132:135], v[76:79]
    ds_read_b64_tr_b16 v[156:157], v227 offset:24576
    ds_read_b64_tr_b16 v[158:159], v227 offset:25600
    s_waitcnt lgkmcnt(14)
    v_mfma_f32_16x16x32_bf16 v[80:83], v[160:163], v[128:131], v[80:83]
    v_mfma_f32_16x16x32_bf16 v[84:87], v[160:163], v[132:135], v[84:87]
    ds_read_b64_tr_b16 v[160:161], v228 offset:24576
    ds_read_b64_tr_b16 v[162:163], v228 offset:25600
    s_waitcnt lgkmcnt(14)
    v_mfma_f32_16x16x32_bf16 v[88:91], v[164:167], v[128:131], v[88:91]
    v_mfma_f32_16x16x32_bf16 v[92:95], v[164:167], v[132:135], v[92:95]
    ds_read_b64_tr_b16 v[164:165], v229 offset:24576
    ds_read_b64_tr_b16 v[166:167], v229 offset:25600
    s_waitcnt lgkmcnt(14)
    v_mfma_f32_16x16x32_bf16 v[96:99], v[168:171], v[128:131], v[96:99]
    v_mfma_f32_16x16x32_bf16 v[100:103], v[168:171], v[132:135], v[100:103]
    ds_read_b64_tr_b16 v[168:169], v230 offset:24576
    ds_read_b64_tr_b16 v[170:171], v230 offset:25600
    s_waitcnt lgkmcnt(14)
    v_mfma_f32_16x16x32_bf16 v[104:107], v[172:175], v[128:131], v[104:107]
    v_mfma_f32_16x16x32_bf16 v[108:111], v[172:175], v[132:135], v[108:111]
    ds_read_b64_tr_b16 v[172:173], v231 offset:24576
    ds_read_b64_tr_b16 v[174:175], v231 offset:25600
    buffer_load_dwordx4 v[128:131], v222, s[8:11], s70 offen offset:2048
    buffer_load_dwordx4 v[132:135], v236, s[8:11], s70 offen offset:2048
    s_waitcnt vmcnt(6)
    s_waitcnt lgkmcnt(14)
    v_mfma_f32_16x16x32_bf16 v[48:51], v[144:147], v[136:139], v[48:51]
    v_mfma_f32_16x16x32_bf16 v[52:55], v[144:147], v[140:143], v[52:55]
    s_waitcnt lgkmcnt(12)
    v_mfma_f32_16x16x32_bf16 v[56:59], v[148:151], v[136:139], v[56:59]
    v_mfma_f32_16x16x32_bf16 v[60:63], v[148:151], v[140:143], v[60:63]
    s_waitcnt lgkmcnt(0)
    s_barrier
    v_xor_b32 v224, 0x38000, v224
    v_xor_b32 v225, 0x38000, v225
    v_xor_b32 v226, 0x38000, v226
    v_xor_b32 v227, 0x38000, v227
    v_xor_b32 v228, 0x38000, v228
    v_xor_b32 v229, 0x38000, v229
    v_xor_b32 v230, 0x38000, v230
    v_xor_b32 v231, 0x38000, v231
    ds_read_b64_tr_b16 v[144:145], v224 offset:0
    ds_read_b64_tr_b16 v[146:147], v224 offset:1024
    ds_read_b64_tr_b16 v[148:149], v225 offset:0
    ds_read_b64_tr_b16 v[150:151], v225 offset:1024
    s_mov_b32 m0, s69
    s_nop 0
    buffer_load_dwordx4 v232, s[12:15], s68 offen offset:0 lds
    buffer_load_dwordx4 v233, s[12:15], s68 offen offset:1024 lds
    buffer_load_dwordx4 v234, s[12:15], s68 offen offset:2048 lds
    buffer_load_dwordx4 v235, s[12:15], s68 offen offset:3072 lds
    s_xor_b32 s69, s69, 0x38000
    s_add_u32 s68, s68, 1048576
    v_mfma_f32_16x16x32_bf16 v[64:67], v[152:155], v[136:139], v[64:67]
    v_mfma_f32_16x16x32_bf16 v[68:71], v[152:155], v[140:143], v[68:71]
    ds_read_b64_tr_b16 v[152:153], v226 offset:0
    ds_read_b64_tr_b16 v[154:155], v226 offset:1024
    v_mfma_f32_16x16x32_bf16 v[72:75], v[156:159], v[136:139], v[72:75]
    v_mfma_f32_16x16x32_bf16 v[76:79], v[156:159], v[140:143], v[76:79]
    ds_read_b64_tr_b16 v[156:157], v227 offset:0
    ds_read_b64_tr_b16 v[158:159], v227 offset:1024
    v_mfma_f32_16x16x32_bf16 v[80:83], v[160:163], v[136:139], v[80:83]
    v_mfma_f32_16x16x32_bf16 v[84:87], v[160:163], v[140:143], v[84:87]
    ds_read_b64_tr_b16 v[160:161], v228 offset:0
    ds_read_b64_tr_b16 v[162:163], v228 offset:1024
    v_mfma_f32_16x16x32_bf16 v[88:91], v[164:167], v[136:139], v[88:91]
    v_mfma_f32_16x16x32_bf16 v[92:95], v[164:167], v[140:143], v[92:95]
    ds_read_b64_tr_b16 v[164:165], v229 offset:0
    ds_read_b64_tr_b16 v[166:167], v229 offset:1024
    v_mfma_f32_16x16x32_bf16 v[96:99], v[168:171], v[136:139], v[96:99]
    v_mfma_f32_16x16x32_bf16 v[100:103], v[168:171], v[140:143], v[100:103]
    ds_read_b64_tr_b16 v[168:169], v230 offset:0
    ds_read_b64_tr_b16 v[170:171], v230 offset:1024
    v_mfma_f32_16x16x32_bf16 v[104:107], v[172:175], v[136:139], v[104:107]
    v_mfma_f32_16x16x32_bf16 v[108:111], v[172:175], v[140:143], v[108:111]
    ds_read_b64_tr_b16 v[172:173], v231 offset:0
    ds_read_b64_tr_b16 v[174:175], v231 offset:1024
    buffer_load_dwordx4 v[136:139], v222, s[8:11], s70 offen offset:3072
    buffer_load_dwordx4 v[140:143], v236, s[8:11], s70 offen offset:3072
    s_add_u32 s70, s70, 4096
    s_add_u32 s71, s71, 1
    s_cmp_lt_u32 s71, 5
    s_cbranch_scc1 L_k2_qloop
    s_mov_b32 s6, 0x3e0293ee
    s_nop 7
    v_mul_f32 v48, s6, v48
    v_mul_f32 v49, s6, v49
    v_mul_f32 v50, s6, v50
    v_mul_f32 v51, s6, v51
    v_cvt_pk_bf16_f32 v16, v48, v49
    v_cvt_pk_bf16_f32 v17, v50, v51
    v_mul_f32 v56, s6, v56
    v_mul_f32 v57, s6, v57
    v_mul_f32 v58, s6, v58
    v_mul_f32 v59, s6, v59
    v_cvt_pk_bf16_f32 v18, v56, v57
    v_cvt_pk_bf16_f32 v19, v58, v59
    v_mul_f32 v64, s6, v64
    v_mul_f32 v65, s6, v65
    v_mul_f32 v66, s6, v66
    v_mul_f32 v67, s6, v67
    v_cvt_pk_bf16_f32 v20, v64, v65
    v_cvt_pk_bf16_f32 v21, v66, v67
    v_mul_f32 v72, s6, v72
    v_mul_f32 v73, s6, v73
    v_mul_f32 v74, s6, v74
    v_mul_f32 v75, s6, v75
    v_cvt_pk_bf16_f32 v22, v72, v73
    v_cvt_pk_bf16_f32 v23, v74, v75
    v_mul_f32 v80, s6, v80
    v_mul_f32 v81, s6, v81
    v_mul_f32 v82, s6, v82
    v_mul_f32 v83, s6, v83
    v_cvt_pk_bf16_f32 v24, v80, v81
    v_cvt_pk_bf16_f32 v25, v82, v83
    v_mul_f32 v88, s6, v88
    v_mul_f32 v89, s6, v89
    v_mul_f32 v90, s6, v90
    v_mul_f32 v91, s6, v91
    v_cvt_pk_bf16_f32 v26, v88, v89
    v_cvt_pk_bf16_f32 v27, v90, v91
    v_mul_f32 v96, s6, v96
    v_mul_f32 v97, s6, v97
    v_mul_f32 v98, s6, v98
    v_mul_f32 v99, s6, v99
    v_cvt_pk_bf16_f32 v28, v96, v97
    v_cvt_pk_bf16_f32 v29, v98, v99
    v_mul_f32 v104, s6, v104
    v_mul_f32 v105, s6, v105
    v_mul_f32 v106, s6, v106
    v_mul_f32 v107, s6, v107
    v_cvt_pk_bf16_f32 v30, v104, v105
    v_cvt_pk_bf16_f32 v31, v106, v107
    v_mul_f32 v52, s6, v52
    v_mul_f32 v53, s6, v53
    v_mul_f32 v54, s6, v54
    v_mul_f32 v55, s6, v55
    v_cvt_pk_bf16_f32 v32, v52, v53
    v_cvt_pk_bf16_f32 v33, v54, v55
    v_mul_f32 v60, s6, v60
    v_mul_f32 v61, s6, v61
    v_mul_f32 v62, s6, v62
    v_mul_f32 v63, s6, v63
    v_cvt_pk_bf16_f32 v34, v60, v61
    v_cvt_pk_bf16_f32 v35, v62, v63
    v_mul_f32 v68, s6, v68
    v_mul_f32 v69, s6, v69
    v_mul_f32 v70, s6, v70
    v_mul_f32 v71, s6, v71
    v_cvt_pk_bf16_f32 v36, v68, v69
    v_cvt_pk_bf16_f32 v37, v70, v71
    v_mul_f32 v76, s6, v76
    v_mul_f32 v77, s6, v77
    v_mul_f32 v78, s6, v78
    v_mul_f32 v79, s6, v79
    v_cvt_pk_bf16_f32 v38, v76, v77
    v_cvt_pk_bf16_f32 v39, v78, v79
    v_mul_f32 v84, s6, v84
    v_mul_f32 v85, s6, v85
    v_mul_f32 v86, s6, v86
    v_mul_f32 v87, s6, v87
    v_cvt_pk_bf16_f32 v40, v84, v85
    v_cvt_pk_bf16_f32 v41, v86, v87
    v_mul_f32 v92, s6, v92
    v_mul_f32 v93, s6, v93
    v_mul_f32 v94, s6, v94
    v_mul_f32 v95, s6, v95
    v_cvt_pk_bf16_f32 v42, v92, v93
    v_cvt_pk_bf16_f32 v43, v94, v95
    v_mul_f32 v100, s6, v100
    v_mul_f32 v101, s6, v101
    v_mul_f32 v102, s6, v102
    v_mul_f32 v103, s6, v103
    v_cvt_pk_bf16_f32 v44, v100, v101
    v_cvt_pk_bf16_f32 v45, v102, v103
    v_mul_f32 v108, s6, v108
    v_mul_f32 v109, s6, v109
    v_mul_f32 v110, s6, v110
    v_mul_f32 v111, s6, v111
    v_cvt_pk_bf16_f32 v46, v108, v109
    v_cvt_pk_bf16_f32 v47, v110, v111
    s_waitcnt vmcnt(0) lgkmcnt(0)
    v_mov_b32 v48, 0
    v_mov_b32 v49, 0
    v_mov_b32 v50, 0
    v_mov_b32 v51, 0
    v_mov_b32 v52, 0
    v_mov_b32 v53, 0
    v_mov_b32 v54, 0
    v_mov_b32 v55, 0
    v_mov_b32 v56, 0
    v_mov_b32 v57, 0
    v_mov_b32 v58, 0
    v_mov_b32 v59, 0
    v_mov_b32 v60, 0
    v_mov_b32 v61, 0
    v_mov_b32 v62, 0
    v_mov_b32 v63, 0
    v_mov_b32 v64, 0
    v_mov_b32 v65, 0
    v_mov_b32 v66, 0
    v_mov_b32 v67, 0
    v_mov_b32 v68, 0
    v_mov_b32 v69, 0
    v_mov_b32 v70, 0
    v_mov_b32 v71, 0
    v_mov_b32 v72, 0
    v_mov_b32 v73, 0
    v_mov_b32 v74, 0
    v_mov_b32 v75, 0
    v_mov_b32 v76, 0
    v_mov_b32 v77, 0
    v_mov_b32 v78, 0
    v_mov_b32 v79, 0
    v_mov_b32 v80, 0
    v_mov_b32 v81, 0
    v_mov_b32 v82, 0
    v_mov_b32 v83, 0
    v_mov_b32 v84, 0
    v_mov_b32 v85, 0
    v_mov_b32 v86, 0
    v_mov_b32 v87, 0
    v_mov_b32 v88, 0
    v_mov_b32 v89, 0
    v_mov_b32 v90, 0
    v_mov_b32 v91, 0
    v_mov_b32 v92, 0
    v_mov_b32 v93, 0
    v_mov_b32 v94, 0
    v_mov_b32 v95, 0
    v_mov_b32 v96, 0
    v_mov_b32 v97, 0
    v_mov_b32 v98, 0
    v_mov_b32 v99, 0
    v_mov_b32 v100, 0
    v_mov_b32 v101, 0
    v_mov_b32 v102, 0
    v_mov_b32 v103, 0
    v_mov_b32 v104, 0
    v_mov_b32 v105, 0
    v_mov_b32 v106, 0
    v_mov_b32 v107, 0
    v_mov_b32 v108, 0
    v_mov_b32 v109, 0
    v_mov_b32 v110, 0
    v_mov_b32 v111, 0
    v_mov_b32 v192, 0
    v_mov_b32 v193, 0
    v_mov_b32 v194, 0
    v_mov_b32 v195, 0
    v_mov_b32 v196, 0
    v_mov_b32 v197, 0
    v_mov_b32 v198, 0
    v_mov_b32 v199, 0
    v_mov_b32 v200, 0
    v_mov_b32 v201, 0
    v_mov_b32 v202, 0
    v_mov_b32 v203, 0
    v_mov_b32 v204, 0
    v_mov_b32 v205, 0
    v_mov_b32 v206, 0
    v_mov_b32 v207, 0
    v_mov_b32 v208, 0
    v_mov_b32 v209, 0
    v_mov_b32 v210, 0
    v_mov_b32 v211, 0
    v_mov_b32 v220, v222
    s_mov_b32 s61, 0
    s_mov_b32 s72, 0x4b800000
    s_waitcnt vmcnt(8)
    s_barrier
    s_cmp_eq_u32 s65, 0
    s_cbranch_scc1 L_noload_12
    s_add_u32 s66, s61, 2
    s_cmp_gt_u32 s66, s62
    s_cselect_b32 s63, 0x4000000, s63
    s_add_u32 m0, s64, 0
    s_add_u32 s66, s63, 0
    buffer_load_dwordx4 v223, s[8:11], s66 offen offset:0 lds
    buffer_load_dwordx4 v223, s[8:11], s66 offen offset:1024 lds
    buffer_load_dwordx4 v223, s[8:11], s66 offen offset:2048 lds
    buffer_load_dwordx4 v223, s[8:11], s66 offen offset:3072 lds
    s_add_u32 m0, s64, 4096
    s_add_u32 s66, s63, 4096
    buffer_load_dwordx4 v223, s[8:11], s66 offen offset:0 lds
    buffer_load_dwordx4 v223, s[8:11], s66 offen offset:1024 lds
    buffer_load_dwordx4 v223, s[8:11], s66 offen offset:2048 lds
    buffer_load_dwordx4 v223, s[8:11], s66 offen offset:3072 lds
    s_add_u32 s64, s64, 32768
    s_and_b32 s64, s64, 0x1ffff
    s_add_u32 s63, s63, 32768
L_noload_12:
    ds_read_b128 v[144:147], v220 offset:0
    ds_read_b128 v[148:151], v220 offset:1024
    ds_read_b128 v[152:155], v220 offset:2048
    ds_read_b128 v[156:159], v220 offset:3072
    ds_read_b128 v[160:163], v220 offset:4096
    ds_read_b128 v[164:167], v220 offset:5120
    ds_read_b128 v[168:171], v220 offset:6144
    ds_read_b128 v[172:175], v220 offset:7168
    s_cmp_lg_u32 s60, 0
    s_cbranch_scc1 L_nm0
    s_call_b64 s[82:83], L_mask
L_nm0:
    s_waitcnt lgkmcnt(7)
    v_mfma_f32_16x16x32_bf16 v[112:115], v[144:147], v[16:19], v[192:195]
    v_mfma_f32_16x16x32_bf16 v[116:119], v[144:147], v[32:35], v[196:199]
    ds_read_b128 v[144:147], v220 offset:8192
    s_waitcnt lgkmcnt(7)
    v_mfma_f32_16x16x32_bf16 v[112:115], v[148:151], v[20:23], v[112:115]
    v_mfma_f32_16x16x32_bf16 v[116:119], v[148:151], v[36:39], v[116:119]
    ds_read_b128 v[148:151], v220 offset:9216
    s_waitcnt lgkmcnt(7)
    v_mfma_f32_16x16x32_bf16 v[112:115], v[152:155], v[24:27], v[112:115]
    v_mfma_f32_16x16x32_bf16 v[116:119], v[152:155], v[40:43], v[116:119]
    ds_read_b128 v[152:155], v220 offset:10240
    s_waitcnt lgkmcnt(7)
    v_mfma_f32_16x16x32_bf16 v[112:115], v[156:159], v[28:31], v[112:115]
    v_mfma_f32_16x16x32_bf16 v[116:119], v[156:159], v[44:47], v[116:119]
    ds_read_b128 v[156:159], v220 offset:11264
    s_waitcnt lgkmcnt(7)
    v_mfma_f32_16x16x32_bf16 v[120:123], v[160:163], v[16:19], v[200:203]
    v_mfma_f32_16x16x32_bf16 v[124:127], v[160:163], v[32:35], v[204:207]
    ds_read_b128 v[160:163], v220 offset:12288
    s_waitcnt lgkmcnt(7)
    v_mfma_f32_16x16x32_bf16 v[120:123], v[164:167], v[20:23], v[120:123]
    v_mfma_f32_16x16x32_bf16 v[124:127], v[164:167], v[36:39], v[124:127]
    ds_read_b128 v[164:167], v220 offset:13312
    s_waitcnt lgkmcnt(7)
    v_mfma_f32_16x16x32_bf16 v[120:123], v[168:171], v[24:27], v[120:123]
    v_mfma_f32_16x16x32_bf16 v[124:127], v[168:171], v[40:43], v[124:127]
    ds_read_b128 v[168:171], v220 offset:14336
    s_waitcnt lgkmcnt(7)
    v_mfma_f32_16x16x32_bf16 v[120:123], v[172:175], v[28:31], v[120:123]
    v_mfma_f32_16x16x32_bf16 v[124:127], v[172:175], v[44:47], v[124:127]
    ds_read_b128 v[172:175], v220 offset:15360
    s_nop 7
    v_max3_f32 v212, v112, v113, v114
    v_max3_f32 v212, v212, v115, v120
    v_max3_f32 v212, v212, v121, v122
    v_max_f32 v212, v212, v123
    v_mov_b32 v214, v212
    s_nop 1
    v_permlane16_swap_b32 v212, v214
    s_nop 1
    v_max_f32 v212, v212, v214
    v_mov_b32 v214, v212
    s_nop 1
    v_permlane32_swap_b32 v212, v214
    s_nop 1
    v_max_f32 v212, v212, v214
    v_sub_f32 v112, v112, v212
    v_sub_f32 v192, 0, v212
    v_sub_f32 v113, v113, v212
    v_sub_f32 v193, 0, v212
    v_sub_f32 v114, v114, v212
    v_sub_f32 v194, 0, v212
    v_sub_f32 v115, v115, v212
    v_sub_f32 v195, 0, v212
    v_sub_f32 v120, v120, v212
    v_sub_f32 v200, 0, v212
    v_sub_f32 v121, v121, v212
    v_sub_f32 v201, 0, v212
    v_sub_f32 v122, v122, v212
    v_sub_f32 v202, 0, v212
    v_sub_f32 v123, v123, v212
    v_sub_f32 v203, 0, v212
    v_max3_f32 v213, v116, v117, v118
    v_max3_f32 v213, v213, v119, v124
    v_max3_f32 v213, v213, v125, v126
    v_max_f32 v213, v213, v127
    v_mov_b32 v214, v213
    s_nop 1
    v_permlane16_swap_b32 v213, v214
    s_nop 1
    v_max_f32 v213, v213, v214
    v_mov_b32 v214, v213
    s_nop 1
    v_permlane32_swap_b32 v213, v214
    s_nop 1
    v_max_f32 v213, v213, v214
    v_sub_f32 v116, v116, v213
    v_sub_f32 v196, 0, v213
    v_sub_f32 v117, v117, v213
    v_sub_f32 v197, 0, v213
    v_sub_f32 v118, v118, v213
    v_sub_f32 v198, 0, v213
    v_sub_f32 v119, v119, v213
    v_sub_f32 v199, 0, v213
    v_sub_f32 v124, v124, v213
    v_sub_f32 v204, 0, v213
    v_sub_f32 v125, v125, v213
    v_sub_f32 v205, 0, v213
    v_sub_f32 v126, v126, v213
    v_sub_f32 v206, 0, v213
    v_sub_f32 v127, v127, v213
    v_sub_f32 v207, 0, v213
    s_cmp_lg_u32 s60, 1
    s_cbranch_scc1 L_nm1
    s_call_b64 s[82:83], L_mask
L_nm1:
    s_nop 1
    s_waitcnt lgkmcnt(7)
    v_mfma_f32_16x16x32_bf16 v[128:131], v[144:147], v[16:19], v[192:195]
    s_waitcnt lgkmcnt(6)
    v_exp_f32 v212, v112
    v_exp_f32 v213, v113
    v_mfma_f32_16x16x32_bf16 v[132:135], v[144:147], v[32:35], v[196:199]
    ds_read_b128 v[144:147], v220 offset:16384
    v_add_f32 v208, v212, v210
    v_add_f32 v208, v213, v208
    v_cvt_pk_bf16_f32 v176, v212, v213
    v_mfma_f32_16x16x32_bf16 v[128:131], v[148:151], v[20:23], v[128:131]
    s_waitcnt lgkmcnt(6)
    v_exp_f32 v214, v114
    v_exp_f32 v215, v115
    v_mfma_f32_16x16x32_bf16 v[132:135], v[148:151], v[36:39], v[132:135]
    ds_read_b128 v[148:151], v220 offset:17408
    v_add_f32 v208, v214, v208
    v_add_f32 v208, v215, v208
    v_cvt_pk_bf16_f32 v177, v214, v215
    v_mfma_f32_16x16x32_bf16 v[128:131], v[152:155], v[24:27], v[128:131]
    s_waitcnt lgkmcnt(6)
    v_exp_f32 v212, v116
    v_exp_f32 v213, v117
    v_mfma_f32_16x16x32_bf16 v[132:135], v[152:155], v[40:43], v[132:135]
    ds_read_b128 v[152:155], v220 offset:18432
    v_add_f32 v209, v212, v211
    v_add_f32 v209, v213, v209
    v_cvt_pk_bf16_f32 v180, v212, v213
    v_mfma_f32_16x16x32_bf16 v[128:131], v[156:159], v[28:31], v[128:131]
    s_waitcnt lgkmcnt(6)
    v_exp_f32 v214, v118
    v_exp_f32 v215, v119
    v_mfma_f32_16x16x32_bf16 v[132:135], v[156:159], v[44:47], v[132:135]
    ds_read_b128 v[156:159], v220 offset:19456
    v_add_f32 v209, v214, v209
    v_add_f32 v209, v215, v209
    v_cvt_pk_bf16_f32 v181, v214, v215
    v_mfma_f32_16x16x32_bf16 v[136:139], v[160:163], v[16:19], v[200:203]
    s_waitcnt lgkmcnt(6)
    v_exp_f32 v212, v120
    v_exp_f32 v213, v121
    v_mfma_f32_16x16x32_bf16 v[140:143], v[160:163], v[32:35], v[204:207]
    ds_read_b128 v[160:163], v220 offset:20480
    v_add_f32 v208, v212, v208
    v_add_f32 v208, v213, v208
    v_cvt_pk_bf16_f32 v178, v212, v213
    v_mfma_f32_16x16x32_bf16 v[136:139], v[164:167], v[20:23], v[136:139]
    s_waitcnt lgkmcnt(6)
    v_exp_f32 v214, v122
    v_exp_f32 v215, v123
    v_mfma_f32_16x16x32_bf16 v[140:143], v[164:167], v[36:39], v[140:143]
    ds_read_b128 v[164:167], v220 offset:21504
    v_add_f32 v208, v214, v208
    v_add_f32 v208, v215, v208
    v_cvt_pk_bf16_f32 v179, v214, v215
    v_mfma_f32_16x16x32_bf16 v[136:139], v[168:171], v[24:27], v[136:139]
    s_waitcnt lgkmcnt(6)
    v_exp_f32 v212, v124
    v_exp_f32 v213, v125
    v_mfma_f32_16x16x32_bf16 v[140:143], v[168:171], v[40:43], v[140:143]
    ds_read_b128 v[168:171], v220 offset:22528
    v_add_f32 v209, v212, v209
    v_add_f32 v209, v213, v209
    v_cvt_pk_bf16_f32 v182, v212, v213
    v_mfma_f32_16x16x32_bf16 v[136:139], v[172:175], v[28:31], v[136:139]
    v_exp_f32 v214, v126
    v_exp_f32 v215, v127
    v_mfma_f32_16x16x32_bf16 v[140:143], v[172:175], v[44:47], v[140:143]
    ds_read_b128 v[172:175], v220 offset:23552
    v_add_f32 v209, v214, v209
    v_add_f32 v209, v215, v209
    v_cvt_pk_bf16_f32 v183, v214, v215
    v_add_f32 v212, v208, v209
    v_cmp_nge_f32 vcc, s72, v212
    s_cbranch_vccnz L_stub_13
L_back_14:
    s_mov_b32 s61, 1
.p2align 6
L_aloop:
    s_cmp_gt_u32 s61, s62
    s_cbranch_scc1 L_nobar_15
    s_waitcnt vmcnt(8)
    s_barrier
    s_cmp_eq_u32 s65, 0
    s_cbranch_scc1 L_noload_16
    s_add_u32 s66, s61, 2
    s_cmp_gt_u32 s66, s62
    s_cselect_b32 s63, 0x4000000, s63
    s_add_u32 m0, s64, 0
    s_add_u32 s66, s63, 0
    buffer_load_dwordx4 v223, s[8:11], s66 offen offset:0 lds
    buffer_load_dwordx4 v223, s[8:11], s66 offen offset:1024 lds
    buffer_load_dwordx4 v223, s[8:11], s66 offen offset:2048 lds
    buffer_load_dwordx4 v223, s[8:11], s66 offen offset:3072 lds
    s_add_u32 m0, s64, 4096
    s_add_u32 s66, s63, 4096
    buffer_load_dwordx4 v223, s[8:11], s66 offen offset:0 lds
    buffer_load_dwordx4 v223, s[8:11], s66 offen offset:1024 lds
    buffer_load_dwordx4 v223, s[8:11], s66 offen offset:2048 lds
    buffer_load_dwordx4 v223, s[8:11], s66 offen offset:3072 lds
    s_add_u32 s64, s64, 32768
    s_and_b32 s64, s64, 0x1ffff
    s_add_u32 s63, s63, 32768
L_noload_16:
L_nobar_15:
    v_mov_b32 v221, v220
    v_add_u32 v220, 0x8000, v220
    v_and_b32 v220, 0x1ffff, v220
    s_lshl_b32 s6, s61, 1
    s_cmp_gt_u32 s6, s60
    s_cbranch_scc1 L_tail
    s_cmp_eq_u32 s6, s60
    s_cbranch_scc1 L_mask0
L_mask0_back:
    s_waitcnt lgkmcnt(7)
    v_mfma_f32_16x16x32_bf16 v[48:51], v[144:147], v[176:179], v[48:51]
    s_waitcnt lgkmcnt(6)
    v_exp_f32 v212, v128
    v_mfma_f32_16x16x32_bf16 v[52:55], v[144:147], v[180:183], v[52:55]
    ds_read_b128 v[144:147], v220 offset:0
    v_add_f32 v210, v212, v208
    v_mfma_f32_16x16x32_bf16 v[56:59], v[148:151], v[176:179], v[56:59]
    s_waitcnt lgkmcnt(6)
    v_exp_f32 v213, v129
    v_mfma_f32_16x16x32_bf16 v[60:63], v[148:151], v[180:183], v[60:63]
    ds_read_b128 v[148:151], v220 offset:1024
    v_add_f32 v210, v213, v210
    v_cvt_pk_bf16_f32 v184, v212, v213
    v_mfma_f32_16x16x32_bf16 v[64:67], v[152:155], v[176:179], v[64:67]
    s_waitcnt lgkmcnt(6)
    v_exp_f32 v214, v130
    v_mfma_f32_16x16x32_bf16 v[68:71], v[152:155], v[180:183], v[68:71]
    ds_read_b128 v[152:155], v220 offset:2048
    v_add_f32 v210, v214, v210
    v_mfma_f32_16x16x32_bf16 v[72:75], v[156:159], v[176:179], v[72:75]
    s_waitcnt lgkmcnt(6)
    v_exp_f32 v215, v131
    v_mfma_f32_16x16x32_bf16 v[76:79], v[156:159], v[180:183], v[76:79]
    ds_read_b128 v[156:159], v220 offset:3072
    v_add_f32 v210, v215, v210
    v_cvt_pk_bf16_f32 v185, v214, v215
    v_mfma_f32_16x16x32_bf16 v[80:83], v[160:163], v[176:179], v[80:83]
    s_waitcnt lgkmcnt(6)
    v_exp_f32 v212, v132
    v_mfma_f32_16x16x32_bf16 v[84:87], v[160:163], v[180:183], v[84:87]
    ds_read_b128 v[160:163], v220 offset:4096
    v_add_f32 v211, v212, v209
    v_mfma_f32_16x16x32_bf16 v[88:91], v[164:167], v[176:179], v[88:91]
    s_waitcnt lgkmcnt(6)
    v_exp_f32 v213, v133
    v_mfma_f32_16x16x32_bf16 v[92:95], v[164:167], v[180:183], v[92:95]
    ds_read_b128 v[164:167], v220 offset:5120
    v_add_f32 v211, v213, v211
    v_cvt_pk_bf16_f32 v188, v212, v213
    v_mfma_f32_16x16x32_bf16 v[96:99], v[168:171], v[176:179], v[96:99]
    s_waitcnt lgkmcnt(6)
    v_exp_f32 v214, v134
    v_mfma_f32_16x16x32_bf16 v[100:103], v[168:171], v[180:183], v[100:103]
    ds_read_b128 v[168:171], v220 offset:6144
    v_add_f32 v211, v214, v211
    v_mfma_f32_16x16x32_bf16 v[104:107], v[172:175], v[176:179], v[104:107]
    s_waitcnt lgkmcnt(6)
    v_exp_f32 v215, v135
    v_mfma_f32_16x16x32_bf16 v[108:111], v[172:175], v[180:183], v[108:111]
    ds_read_b128 v[172:175], v220 offset:7168
    v_add_f32 v211, v215, v211
    v_cvt_pk_bf16_f32 v189, v214, v215
    v_mfma_f32_16x16x32_bf16 v[112:115], v[144:147], v[16:19], v[192:195]
    s_waitcnt lgkmcnt(6)
    v_exp_f32 v212, v136
    v_mfma_f32_16x16x32_bf16 v[116:119], v[144:147], v[32:35], v[196:199]
    ds_read_b128 v[144:147], v221 offset:24576
    v_add_f32 v210, v212, v210
    v_mfma_f32_16x16x32_bf16 v[112:115], v[148:151], v[20:23], v[112:115]
    s_waitcnt lgkmcnt(6)
    v_exp_f32 v213, v137
    v_mfma_f32_16x16x32_bf16 v[116:119], v[148:151], v[36:39], v[116:119]
    ds_read_b128 v[148:151], v221 offset:25600
    v_add_f32 v210, v213, v210
    v_cvt_pk_bf16_f32 v186, v212, v213
    v_mfma_f32_16x16x32_bf16 v[112:115], v[152:155], v[24:27], v[112:115]
    s_waitcnt lgkmcnt(6)
    v_exp_f32 v214, v138
    v_mfma_f32_16x16x32_bf16 v[116:119], v[152:155], v[40:43], v[116:119]
    ds_read_b128 v[152:155], v221 offset:26624
    v_add_f32 v210, v214, v210
    v_mfma_f32_16x16x32_bf16 v[112:115], v[156:159], v[28:31], v[112:115]
    s_waitcnt lgkmcnt(6)
    v_exp_f32 v215, v139
    v_mfma_f32_16x16x32_bf16 v[116:119], v[156:159], v[44:47], v[116:119]
    ds_read_b128 v[156:159], v221 offset:27648
    v_add_f32 v210, v215, v210
    v_cvt_pk_bf16_f32 v187, v214, v215
    v_mfma_f32_16x16x32_bf16 v[120:123], v[160:163], v[16:19], v[200:203]
    s_waitcnt lgkmcnt(6)
    v_exp_f32 v212, v140
    v_mfma_f32_16x16x32_bf16 v[124:127], v[160:163], v[32:35], v[204:207]
    ds_read_b128 v[160:163], v221 offset:28672
    v_add_f32 v211, v212, v211
    v_mfma_f32_16x16x32_bf16 v[120:123], v[164:167], v[20:23], v[120:123]
    s_waitcnt lgkmcnt(6)
    v_exp_f32 v213, v141
    v_mfma_f32_16x16x32_bf16 v[124:127], v[164:167], v[36:39], v[124:127]
    ds_read_b128 v[164:167], v221 offset:29696
    v_add_f32 v211, v213, v211
    v_cvt_pk_bf16_f32 v190, v212, v213
    v_mfma_f32_16x16x32_bf16 v[120:123], v[168:171], v[24:27], v[120:123]
    s_waitcnt lgkmcnt(6)
    v_exp_f32 v214, v142
    v_mfma_f32_16x16x32_bf16 v[124:127], v[168:171], v[40:43], v[124:127]
    ds_read_b128 v[168:171], v221 offset:30720
    v_add_f32 v211, v214, v211
    v_mfma_f32_16x16x32_bf16 v[120:123], v[172:175], v[28:31], v[120:123]
    v_exp_f32 v215, v143
    v_mfma_f32_16x16x32_bf16 v[124:127], v[172:175], v[44:47], v[124:127]
    ds_read_b128 v[172:175], v221 offset:31744
    v_add_f32 v211, v215, v211
    v_cvt_pk_bf16_f32 v191, v214, v215
    v_add_f32 v212, v210, v211
    v_cmp_nge_f32 vcc, s72, v212
    s_cbranch_vccnz L_stub_17
L_back_18:
    s_add_u32 s61, s61, 1
    s_cmp_eq_u32 s6, s60
    s_cbranch_scc1 L_even_h1
    s_add_u32 s6, s6, 1
    s_cmp_eq_u32 s6, s60
    s_cbranch_scc1 L_mask1
L_mask1_back:
    s_waitcnt lgkmcnt(7)
    v_mfma_f32_16x16x32_bf16 v[48:51], v[144:147], v[184:187], v[48:51]
    s_waitcnt lgkmcnt(6)
    v_exp_f32 v212, v112
    v_mfma_f32_16x16x32_bf16 v[52:55], v[144:147], v[188:191], v[52:55]
    ds_read_b128 v[144:147], v220 offset:8192
    v_add_f32 v208, v212, v210
    v_mfma_f32_16x16x32_bf16 v[56:59], v[148:151], v[184:187], v[56:59]
    s_waitcnt lgkmcnt(6)
    v_exp_f32 v213, v113
    v_mfma_f32_16x16x32_bf16 v[60:63], v[148:151], v[188:191], v[60:63]
    ds_read_b128 v[148:151], v220 offset:9216
    v_add_f32 v208, v213, v208
    v_cvt_pk_bf16_f32 v176, v212, v213
    v_mfma_f32_16x16x32_bf16 v[64:67], v[152:155], v[184:187], v[64:67]
    s_waitcnt lgkmcnt(6)
    v_exp_f32 v214, v114
    v_mfma_f32_16x16x32_bf16 v[68:71], v[152:155], v[188:191], v[68:71]
    ds_read_b128 v[152:155], v220 offset:10240
    v_add_f32 v208, v214, v208
    v_mfma_f32_16x16x32_bf16 v[72:75], v[156:159], v[184:187], v[72:75]
    s_waitcnt lgkmcnt(6)
    v_exp_f32 v215, v115
    v_mfma_f32_16x16x32_bf16 v[76:79], v[156:159], v[188:191], v[76:79]
    ds_read_b128 v[156:159], v220 offset:11264
    v_add_f32 v208, v215, v208
    v_cvt_pk_bf16_f32 v177, v214, v215
    v_mfma_f32_16x16x32_bf16 v[80:83], v[160:163], v[184:187], v[80:83]
    s_waitcnt lgkmcnt(6)
    v_exp_f32 v212, v116
    v_mfma_f32_16x16x32_bf16 v[84:87], v[160:163], v[188:191], v[84:87]
    ds_read_b128 v[160:163], v220 offset:12288
    v_add_f32 v209, v212, v211
    v_mfma_f32_16x16x32_bf16 v[88:91], v[164:167], v[184:187], v[88:91]
    s_waitcnt lgkmcnt(6)
    v_exp_f32 v213, v117
    v_mfma_f32_16x16x32_bf16 v[92:95], v[164:167], v[188:191], v[92:95]
    ds_read_b128 v[164:167], v220 offset:13312
    v_add_f32 v209, v213, v209
    v_cvt_pk_bf16_f32 v180, v212, v213
    v_mfma_f32_16x16x32_bf16 v[96:99], v[168:171], v[184:187], v[96:99]
    s_waitcnt lgkmcnt(6)
    v_exp_f32 v214, v118
    v_mfma_f32_16x16x32_bf16 v[100:103], v[168:171], v[188:191], v[100:103]
    ds_read_b128 v[168:171], v220 offset:14336
    v_add_f32 v209, v214, v209
    v_mfma_f32_16x16x32_bf16 v[104:107], v[172:175], v[184:187], v[104:107]
    s_waitcnt lgkmcnt(6)
    v_exp_f32 v215, v119
    v_mfma_f32_16x16x32_bf16 v[108:111], v[172:175], v[188:191], v[108:111]
    ds_read_b128 v[172:175], v220 offset:15360
    v_add_f32 v209, v215, v209
    v_cvt_pk_bf16_f32 v181, v214, v215
    v_mfma_f32_16x16x32_bf16 v[128:131], v[144:147], v[16:19], v[192:195]
    s_waitcnt lgkmcnt(6)
    v_exp_f32 v212, v120
    v_mfma_f32_16x16x32_bf16 v[132:135], v[144:147], v[32:35], v[196:199]
    ds_read_b128 v[144:147], v220 offset:16384
    v_add_f32 v208, v212, v208
    v_mfma_f32_16x16x32_bf16 v[128:131], v[148:151], v[20:23], v[128:131]
    s_waitcnt lgkmcnt(6)
    v_exp_f32 v213, v121
    v_mfma_f32_16x16x32_bf16 v[132:135], v[148:151], v[36:39], v[132:135]
    ds_read_b128 v[148:151], v220 offset:17408
    v_add_f32 v208, v213, v208
    v_cvt_pk_bf16_f32 v178, v212, v213
    v_mfma_f32_16x16x32_bf16 v[128:131], v[152:155], v[24:27], v[128:131]
    s_waitcnt lgkmcnt(6)
    v_exp_f32 v214, v122
    v_mfma_f32_16x16x32_bf16 v[132:135], v[152:155], v[40:43], v[132:135]
    ds_read_b128 v[152:155], v220 offset:18432
    v_add_f32 v208, v214, v208
    v_mfma_f32_16x16x32_bf16 v[128:131], v[156:159], v[28:31], v[128:131]
    s_waitcnt lgkmcnt(6)
    v_exp_f32 v215, v123
    v_mfma_f32_16x16x32_bf16 v[132:135], v[156:159], v[44:47], v[132:135]
    ds_read_b128 v[156:159], v220 offset:19456
    v_add_f32 v208, v215, v208
    v_cvt_pk_bf16_f32 v179, v214, v215
    v_mfma_f32_16x16x32_bf16 v[136:139], v[160:163], v[16:19], v[200:203]
    s_waitcnt lgkmcnt(6)
    v_exp_f32 v212, v124
    v_mfma_f32_16x16x32_bf16 v[140:143], v[160:163], v[32:35], v[204:207]
    ds_read_b128 v[160:163], v220 offset:20480
    v_add_f32 v209, v212, v209
    v_mfma_f32_16x16x32_bf16 v[136:139], v[164:167], v[20:23], v[136:139]
    s_waitcnt lgkmcnt(6)
    v_exp_f32 v213, v125
    v_mfma_f32_16x16x32_bf16 v[140:143], v[164:167], v[36:39], v[140:143]
    ds_read_b128 v[164:167], v220 offset:21504
    v_add_f32 v209, v213, v209
    v_cvt_pk_bf16_f32 v182, v212, v213
    v_mfma_f32_16x16x32_bf16 v[136:139], v[168:171], v[24:27], v[136:139]
    s_waitcnt lgkmcnt(6)
    v_exp_f32 v214, v126
    v_mfma_f32_16x16x32_bf16 v[140:143], v[168:171], v[40:43], v[140:143]
    ds_read_b128 v[168:171], v220 offset:22528
    v_add_f32 v209, v214, v209
    v_mfma_f32_16x16x32_bf16 v[136:139], v[172:175], v[28:31], v[136:139]
    v_exp_f32 v215, v127
    v_mfma_f32_16x16x32_bf16 v[140:143], v[172:175], v[44:47], v[140:143]
    ds_read_b128 v[172:175], v220 offset:23552
    v_add_f32 v209, v215, v209
    v_cvt_pk_bf16_f32 v183, v214, v215
    v_add_f32 v212, v208, v209
    v_cmp_nge_f32 vcc, s72, v212
    s_cbranch_vccnz L_stub_19
L_back_20:
    s_branch L_aloop
L_mask0:
    s_call_b64 s[82:83], L_mask
    s_branch L_mask0_back
L_mask1:
    s_call_b64 s[82:83], L_mask
    s_branch L_mask1_back
L_even_h1:
    s_waitcnt lgkmcnt(7)
    v_mfma_f32_16x16x32_bf16 v[48:51], v[144:147], v[184:187], v[48:51]
    s_waitcnt lgkmcnt(6)
    v_exp_f32 v212, v112
    v_exp_f32 v213, v113
    v_mfma_f32_16x16x32_bf16 v[52:55], v[144:147], v[188:191], v[52:55]
    ds_read_b128 v[144:147], v220 offset:16384
    v_add_f32 v208, v212, v210
    v_add_f32 v208, v213, v208
    v_cvt_pk_bf16_f32 v176, v212, v213
    v_mfma_f32_16x16x32_bf16 v[56:59], v[148:151], v[184:187], v[56:59]
    s_waitcnt lgkmcnt(6)
    v_exp_f32 v214, v114
    v_exp_f32 v215, v115
    v_mfma_f32_16x16x32_bf16 v[60:63], v[148:151], v[188:191], v[60:63]
    ds_read_b128 v[148:151], v220 offset:17408
    v_add_f32 v208, v214, v208
    v_add_f32 v208, v215, v208
    v_cvt_pk_bf16_f32 v177, v214, v215
    v_mfma_f32_16x16x32_bf16 v[64:67], v[152:155], v[184:187], v[64:67]
    s_waitcnt lgkmcnt(6)
    v_exp_f32 v212, v116
    v_exp_f32 v213, v117
    v_mfma_f32_16x16x32_bf16 v[68:71], v[152:155], v[188:191], v[68:71]
    ds_read_b128 v[152:155], v220 offset:18432
    v_add_f32 v209, v212, v211
    v_add_f32 v209, v213, v209
    v_cvt_pk_bf16_f32 v180, v212, v213
    v_mfma_f32_16x16x32_bf16 v[72:75], v[156:159], v[184:187], v[72:75]
    s_waitcnt lgkmcnt(6)
    v_exp_f32 v214, v118
    v_exp_f32 v215, v119
    v_mfma_f32_16x16x32_bf16 v[76:79], v[156:159], v[188:191], v[76:79]
    ds_read_b128 v[156:159], v220 offset:19456
    v_add_f32 v209, v214, v209
    v_add_f32 v209, v215, v209
    v_cvt_pk_bf16_f32 v181, v214, v215
    v_mfma_f32_16x16x32_bf16 v[80:83], v[160:163], v[184:187], v[80:83]
    s_waitcnt lgkmcnt(6)
    v_exp_f32 v212, v120
    v_exp_f32 v213, v121
    v_mfma_f32_16x16x32_bf16 v[84:87], v[160:163], v[188:191], v[84:87]
    ds_read_b128 v[160:163], v220 offset:20480
    v_add_f32 v208, v212, v208
    v_add_f32 v208, v213, v208
    v_cvt_pk_bf16_f32 v178, v212, v213
    v_mfma_f32_16x16x32_bf16 v[88:91], v[164:167], v[184:187], v[88:91]
    s_waitcnt lgkmcnt(6)
    v_exp_f32 v214, v122
    v_exp_f32 v215, v123
    v_mfma_f32_16x16x32_bf16 v[92:95], v[164:167], v[188:191], v[92:95]
    ds_read_b128 v[164:167], v220 offset:21504
    v_add_f32 v208, v214, v208
    v_add_f32 v208, v215, v208
    v_cvt_pk_bf16_f32 v179, v214, v215
    v_mfma_f32_16x16x32_bf16 v[96:99], v[168:171], v[184:187], v[96:99]
    s_waitcnt lgkmcnt(6)
    v_exp_f32 v212, v124
    v_exp_f32 v213, v125
    v_mfma_f32_16x16x32_bf16 v[100:103], v[168:171], v[188:191], v[100:103]
    ds_read_b128 v[168:171], v220 offset:22528
    v_add_f32 v209, v212, v209
    v_add_f32 v209, v213, v209
    v_cvt_pk_bf16_f32 v182, v212, v213
    v_mfma_f32_16x16x32_bf16 v[104:107], v[172:175], v[184:187], v[104:107]
    v_exp_f32 v214, v126
    v_exp_f32 v215, v127
    v_mfma_f32_16x16x32_bf16 v[108:111], v[172:175], v[188:191], v[108:111]
    ds_read_b128 v[172:175], v220 offset:23552
    v_add_f32 v209, v214, v209
    v_add_f32 v209, v215, v209
    v_cvt_pk_bf16_f32 v183, v214, v215
    v_add_f32 v212, v208, v209
    v_cmp_nge_f32 vcc, s72, v212
    s_cbranch_vccnz L_stub_21
L_back_22:
    s_branch L_aloop
L_tail:
    s_add_u32 s61, s61, 1
    s_bitcmp1_b32 s60, 0
    s_cbranch_scc1 L_tail_odd
    s_waitcnt lgkmcnt(7)
    v_mfma_f32_16x16x32_bf16 v[48:51], v[144:147], v[176:179], v[48:51]
    s_waitcnt lgkmcnt(6)
    v_mfma_f32_16x16x32_bf16 v[52:55], v[144:147], v[180:183], v[52:55]
    v_mfma_f32_16x16x32_bf16 v[56:59], v[148:151], v[176:179], v[56:59]
    s_waitcnt lgkmcnt(5)
    v_mfma_f32_16x16x32_bf16 v[60:63], v[148:151], v[180:183], v[60:63]
    v_mfma_f32_16x16x32_bf16 v[64:67], v[152:155], v[176:179], v[64:67]
    s_waitcnt lgkmcnt(4)
    v_mfma_f32_16x16x32_bf16 v[68:71], v[152:155], v[180:183], v[68:71]
    v_mfma_f32_16x16x32_bf16 v[72:75], v[156:159], v[176:179], v[72:75]
    s_waitcnt lgkmcnt(3)
    v_mfma_f32_16x16x32_bf16 v[76:79], v[156:159], v[180:183], v[76:79]
    v_mfma_f32_16x16x32_bf16 v[80:83], v[160:163], v[176:179], v[80:83]
    s_waitcnt lgkmcnt(2)
    v_mfma_f32_16x16x32_bf16 v[84:87], v[160:163], v[180:183], v[84:87]
    v_mfma_f32_16x16x32_bf16 v[88:91], v[164:167], v[176:179], v[88:91]
    s_waitcnt lgkmcnt(1)
    v_mfma_f32_16x16x32_bf16 v[92:95], v[164:167], v[180:183], v[92:95]
    v_mfma_f32_16x16x32_bf16 v[96:99], v[168:171], v[176:179], v[96:99]
    s_waitcnt lgkmcnt(0)
    v_mfma_f32_16x16x32_bf16 v[100:103], v[168:171], v[180:183], v[100:103]
    v_mfma_f32_16x16x32_bf16 v[104:107], v[172:175], v[176:179], v[104:107]
    v_mfma_f32_16x16x32_bf16 v[108:111], v[172:175], v[180:183], v[108:111]
    s_branch L_fin
L_tail_odd:
    s_waitcnt lgkmcnt(7)
    v_mfma_f32_16x16x32_bf16 v[48:51], v[144:147], v[176:179], v[48:51]
    s_waitcnt lgkmcnt(6)
    v_exp_f32 v212, v128
    v_exp_f32 v213, v129
    v_mfma_f32_16x16x32_bf16 v[52:55], v[144:147], v[180:183], v[52:55]
    ds_read_b128 v[144:147], v221 offset:24576
    v_add_f32 v210, v212, v208
    v_add_f32 v210, v213, v210
    v_cvt_pk_bf16_f32 v184, v212, v213
    v_mfma_f32_16x16x32_bf16 v[56:59], v[148:151], v[176:179], v[56:59]
    s_waitcnt lgkmcnt(6)
    v_exp_f32 v214, v130
    v_exp_f32 v215, v131
    v_mfma_f32_16x16x32_bf16 v[60:63], v[148:151], v[180:183], v[60:63]
    ds_read_b128 v[148:151], v221 offset:25600
    v_add_f32 v210, v214, v210
    v_add_f32 v210, v215, v210
    v_cvt_pk_bf16_f32 v185, v214, v215
    v_mfma_f32_16x16x32_bf16 v[64:67], v[152:155], v[176:179], v[64:67]
    s_waitcnt lgkmcnt(6)
    v_exp_f32 v212, v132
    v_exp_f32 v213, v133
    v_mfma_f32_16x16x32_bf16 v[68:71], v[152:155], v[180:183], v[68:71]
    ds_read_b128 v[152:155], v221 offset:26624
    v_add_f32 v211, v212, v209
    v_add_f32 v211, v213, v211
    v_cvt_pk_bf16_f32 v188, v212, v213
    v_mfma_f32_16x16x32_bf16 v[72:75], v[156:159], v[176:179], v[72:75]
    s_waitcnt lgkmcnt(6)
    v_exp_f32 v214, v134
    v_exp_f32 v215, v135
    v_mfma_f32_16x16x32_bf16 v[76:79], v[156:159], v[180:183], v[76:79]
    ds_read_b128 v[156:159], v221 offset:27648
    v_add_f32 v211, v214, v211
    v_add_f32 v211, v215, v211
    v_cvt_pk_bf16_f32 v189, v214, v215
    v_mfma_f32_16x16x32_bf16 v[80:83], v[160:163], v[176:179], v[80:83]
    s_waitcnt lgkmcnt(6)
    v_exp_f32 v212, v136
    v_exp_f32 v213, v137
    v_mfma_f32_16x16x32_bf16 v[84:87], v[160:163], v[180:183], v[84:87]
    ds_read_b128 v[160:163], v221 offset:28672
    v_add_f32 v210, v212, v210
    v_add_f32 v210, v213, v210
    v_cvt_pk_bf16_f32 v186, v212, v213
    v_mfma_f32_16x16x32_bf16 v[88:91], v[164:167], v[176:179], v[88:91]
    s_waitcnt lgkmcnt(6)
    v_exp_f32 v214, v138
    v_exp_f32 v215, v139
    v_mfma_f32_16x16x32_bf16 v[92:95], v[164:167], v[180:183], v[92:95]
    ds_read_b128 v[164:167], v221 offset:29696
    v_add_f32 v210, v214, v210
    v_add_f32 v210, v215, v210
    v_cvt_pk_bf16_f32 v187, v214, v215
    v_mfma_f32_16x16x32_bf16 v[96:99], v[168:171], v[176:179], v[96:99]
    s_waitcnt lgkmcnt(6)
    v_exp_f32 v212, v140
    v_exp_f32 v213, v141
    v_mfma_f32_16x16x32_bf16 v[100:103], v[168:171], v[180:183], v[100:103]
    ds_read_b128 v[168:171], v221 offset:30720
    v_add_f32 v211, v212, v211
    v_add_f32 v211, v213, v211
    v_cvt_pk_bf16_f32 v190, v212, v213
    v_mfma_f32_16x16x32_bf16 v[104:107], v[172:175], v[176:179], v[104:107]
    v_exp_f32 v214, v142
    v_exp_f32 v215, v143
    v_mfma_f32_16x16x32_bf16 v[108:111], v[172:175], v[180:183], v[108:111]
    ds_read_b128 v[172:175], v221 offset:31744
    v_add_f32 v211, v214, v211
    v_add_f32 v211, v215, v211
    v_cvt_pk_bf16_f32 v191, v214, v215
    v_add_f32 v212, v210, v211
    v_cmp_nge_f32 vcc, s72, v212
    s_cbranch_vccnz L_stub_23
L_back_24:
    s_waitcnt lgkmcnt(7)
    v_mfma_f32_16x16x32_bf16 v[48:51], v[144:147], v[184:187], v[48:51]
    s_waitcnt lgkmcnt(6)
    v_mfma_f32_16x16x32_bf16 v[52:55], v[144:147], v[188:191], v[52:55]
    v_mfma_f32_16x16x32_bf16 v[56:59], v[148:151], v[184:187], v[56:59]
    s_waitcnt lgkmcnt(5)
    v_mfma_f32_16x16x32_bf16 v[60:63], v[148:151], v[188:191], v[60:63]
    v_mfma_f32_16x16x32_bf16 v[64:67], v[152:155], v[184:187], v[64:67]
    s_waitcnt lgkmcnt(4)
    v_mfma_f32_16x16x32_bf16 v[68:71], v[152:155], v[188:191], v[68:71]
    v_mfma_f32_16x16x32_bf16 v[72:75], v[156:159], v[184:187], v[72:75]
    s_waitcnt lgkmcnt(3)
    v_mfma_f32_16x16x32_bf16 v[76:79], v[156:159], v[188:191], v[76:79]
    v_mfma_f32_16x16x32_bf16 v[80:83], v[160:163], v[184:187], v[80:83]
    s_waitcnt lgkmcnt(2)
    v_mfma_f32_16x16x32_bf16 v[84:87], v[160:163], v[188:191], v[84:87]
    v_mfma_f32_16x16x32_bf16 v[88:91], v[164:167], v[184:187], v[88:91]
    s_waitcnt lgkmcnt(1)
    v_mfma_f32_16x16x32_bf16 v[92:95], v[164:167], v[188:191], v[92:95]
    v_mfma_f32_16x16x32_bf16 v[96:99], v[168:171], v[184:187], v[96:99]
    s_waitcnt lgkmcnt(0)
    v_mfma_f32_16x16x32_bf16 v[100:103], v[168:171], v[188:191], v[100:103]
    v_mfma_f32_16x16x32_bf16 v[104:107], v[172:175], v[184:187], v[104:107]
    v_mfma_f32_16x16x32_bf16 v[108:111], v[172:175], v[188:191], v[108:111]
    v_mov_b32 v208, v210
    v_mov_b32 v209, v211
L_fin:
    v_mov_b32 v212, v208
    s_nop 1
    v_permlane16_swap_b32 v208, v212
    s_nop 1
    v_add_f32 v208, v208, v212
    v_mov_b32 v212, v208
    s_nop 1
    v_permlane32_swap_b32 v208, v212
    s_nop 1
    v_add_f32 v208, v208, v212
    v_rcp_f32 v208, v208
    v_mov_b32 v212, v209
    s_nop 1
    v_permlane16_swap_b32 v209, v212
    s_nop 1
    v_add_f32 v209, v209, v212
    v_mov_b32 v212, v209
    s_nop 1
    v_permlane32_swap_b32 v209, v212
    s_nop 1
    v_add_f32 v209, v209, v212
    v_rcp_f32 v209, v209
    s_lshl_b32 s6, s60, 18
    s_lshl_b32 s7, s4, 12
    s_add_u32 s6, s6, s7
    s_add_u32 s6, s6, 50331648
    s_nop 4
    v_mul_f32 v48, v208, v48
    v_mul_f32 v49, v208, v49
    v_mul_f32 v50, v208, v50
    v_mul_f32 v51, v208, v51
    v_cvt_pk_bf16_f32 v112, v48, v49
    v_cvt_pk_bf16_f32 v113, v50, v51
    v_mul_f32 v56, v208, v56
    v_mul_f32 v57, v208, v57
    v_mul_f32 v58, v208, v58
    v_mul_f32 v59, v208, v59
    v_cvt_pk_bf16_f32 v114, v56, v57
    v_cvt_pk_bf16_f32 v115, v58, v59
    buffer_store_dwordx4 v[112:115], v222, s[8:11], s6 offen offset:0
    v_mul_f32 v64, v208, v64
    v_mul_f32 v65, v208, v65
    v_mul_f32 v66, v208, v66
    v_mul_f32 v67, v208, v67
    v_cvt_pk_bf16_f32 v116, v64, v65
    v_cvt_pk_bf16_f32 v117, v66, v67
    v_mul_f32 v72, v208, v72
    v_mul_f32 v73, v208, v73
    v_mul_f32 v74, v208, v74
    v_mul_f32 v75, v208, v75
    v_cvt_pk_bf16_f32 v118, v72, v73
    v_cvt_pk_bf16_f32 v119, v74, v75
    buffer_store_dwordx4 v[116:119], v222, s[8:11], s6 offen offset:1024
    v_mul_f32 v80, v208, v80
    v_mul_f32 v81, v208, v81
    v_mul_f32 v82, v208, v82
    v_mul_f32 v83, v208, v83
    v_cvt_pk_bf16_f32 v120, v80, v81
    v_cvt_pk_bf16_f32 v121, v82, v83
    v_mul_f32 v88, v208, v88
    v_mul_f32 v89, v208, v89
    v_mul_f32 v90, v208, v90
    v_mul_f32 v91, v208, v91
    v_cvt_pk_bf16_f32 v122, v88, v89
    v_cvt_pk_bf16_f32 v123, v90, v91
    buffer_store_dwordx4 v[120:123], v222, s[8:11], s6 offen offset:2048
    v_mul_f32 v96, v208, v96
    v_mul_f32 v97, v208, v97
    v_mul_f32 v98, v208, v98
    v_mul_f32 v99, v208, v99
    v_cvt_pk_bf16_f32 v124, v96, v97
    v_cvt_pk_bf16_f32 v125, v98, v99
    v_mul_f32 v104, v208, v104
    v_mul_f32 v105, v208, v105
    v_mul_f32 v106, v208, v106
    v_mul_f32 v107, v208, v107
    v_cvt_pk_bf16_f32 v126, v104, v105
    v_cvt_pk_bf16_f32 v127, v106, v107
    buffer_store_dwordx4 v[124:127], v222, s[8:11], s6 offen offset:3072
    s_add_u32 s6, s6, 0x20000
    v_mul_f32 v52, v209, v52
    v_mul_f32 v53, v209, v53
    v_mul_f32 v54, v209, v54
    v_mul_f32 v55, v209, v55
    v_cvt_pk_bf16_f32 v128, v52, v53
    v_cvt_pk_bf16_f32 v129, v54, v55
    v_mul_f32 v60, v209, v60
    v_mul_f32 v61, v209, v61
    v_mul_f32 v62, v209, v62
    v_mul_f32 v63, v209, v63
    v_cvt_pk_bf16_f32 v130, v60, v61
    v_cvt_pk_bf16_f32 v131, v62, v63
    buffer_store_dwordx4 v[128:131], v222, s[8:11], s6 offen offset:0
    v_mul_f32 v68, v209, v68
    v_mul_f32 v69, v209, v69
    v_mul_f32 v70, v209, v70
    v_mul_f32 v71, v209, v71
    v_cvt_pk_bf16_f32 v132, v68, v69
    v_cvt_pk_bf16_f32 v133, v70, v71
    v_mul_f32 v76, v209, v76
    v_mul_f32 v77, v209, v77
    v_mul_f32 v78, v209, v78
    v_mul_f32 v79, v209, v79
    v_cvt_pk_bf16_f32 v134, v76, v77
    v_cvt_pk_bf16_f32 v135, v78, v79
    buffer_store_dwordx4 v[132:135], v222, s[8:11], s6 offen offset:1024
    v_mul_f32 v84, v209, v84
    v_mul_f32 v85, v209, v85
    v_mul_f32 v86, v209, v86
    v_mul_f32 v87, v209, v87
    v_cvt_pk_bf16_f32 v136, v84, v85
    v_cvt_pk_bf16_f32 v137, v86, v87
    v_mul_f32 v92, v209, v92
    v_mul_f32 v93, v209, v93
    v_mul_f32 v94, v209, v94
    v_mul_f32 v95, v209, v95
    v_cvt_pk_bf16_f32 v138, v92, v93
    v_cvt_pk_bf16_f32 v139, v94, v95
    buffer_store_dwordx4 v[136:139], v222, s[8:11], s6 offen offset:2048
    v_mul_f32 v100, v209, v100
    v_mul_f32 v101, v209, v101
    v_mul_f32 v102, v209, v102
    v_mul_f32 v103, v209, v103
    v_cvt_pk_bf16_f32 v140, v100, v101
    v_cvt_pk_bf16_f32 v141, v102, v103
    v_mul_f32 v108, v209, v108
    v_mul_f32 v109, v209, v109
    v_mul_f32 v110, v209, v110
    v_mul_f32 v111, v209, v111
    v_cvt_pk_bf16_f32 v142, v108, v109
    v_cvt_pk_bf16_f32 v143, v110, v111
    buffer_store_dwordx4 v[140:143], v222, s[8:11], s6 offen offset:3072
L_idle:
    s_cmp_gt_u32 s61, s62
    s_cbranch_scc1 L_adone
    s_waitcnt vmcnt(8)
    s_barrier
    s_cmp_eq_u32 s65, 0
    s_cbranch_scc1 L_noload_26
    s_add_u32 s66, s61, 2
    s_cmp_gt_u32 s66, s62
    s_cselect_b32 s63, 0x4000000, s63
    s_add_u32 m0, s64, 0
    s_add_u32 s66, s63, 0
    buffer_load_dwordx4 v223, s[8:11], s66 offen offset:0 lds
    buffer_load_dwordx4 v223, s[8:11], s66 offen offset:1024 lds
    buffer_load_dwordx4 v223, s[8:11], s66 offen offset:2048 lds
    buffer_load_dwordx4 v223, s[8:11], s66 offen offset:3072 lds
    s_add_u32 m0, s64, 4096
    s_add_u32 s66, s63, 4096
    buffer_load_dwordx4 v223, s[8:11], s66 offen offset:0 lds
    buffer_load_dwordx4 v223, s[8:11], s66 offen offset:1024 lds
    buffer_load_dwordx4 v223, s[8:11], s66 offen offset:2048 lds
    buffer_load_dwordx4 v223, s[8:11], s66 offen offset:3072 lds
    s_add_u32 s64, s64, 32768
    s_and_b32 s64, s64, 0x1ffff
    s_add_u32 s63, s63, 32768
L_noload_26:
    s_add_u32 s61, s61, 1
    s_branch L_idle
L_stub_13:
    s_call_b64 s[80:81], L_rare0
    s_branch L_back_14
L_stub_17:
    s_call_b64 s[80:81], L_rare1
    s_branch L_back_18
L_stub_19:
    s_call_b64 s[80:81], L_rare0
    s_branch L_back_20
L_stub_21:
    s_call_b64 s[80:81], L_rare0
    s_branch L_back_22
L_stub_23:
    s_call_b64 s[80:81], L_rare1
    s_branch L_back_24
L_mask:
    v_and_b32 v2, 15, v1
    v_lshrrev_b32 v3, 4, v1
    v_lshlrev_b32 v3, 2, v3
    v_sub_u32 v2, v2, v3
    v_mov_b32 v3, 0xff800000
    v_cmp_gt_i32 vcc, 0, v2
    v_mov_b32 v200, v3
    s_nop 0
    v_cndmask_b32 v192, v192, v3, vcc
    v_cndmask_b32 v204, v204, v3, vcc
    v_cmp_gt_i32 vcc, 1, v2
    v_mov_b32 v201, v3
    s_nop 0
    v_cndmask_b32 v193, v193, v3, vcc
    v_cndmask_b32 v205, v205, v3, vcc
    v_cmp_gt_i32 vcc, 2, v2
    v_mov_b32 v202, v3
    s_nop 0
    v_cndmask_b32 v194, v194, v3, vcc
    v_cndmask_b32 v206, v206, v3, vcc
    v_cmp_gt_i32 vcc, 3, v2
    v_mov_b32 v203, v3
    s_nop 0
    v_cndmask_b32 v195, v195, v3, vcc
    v_cndmask_b32 v207, v207, v3, vcc
    s_nop 1
    s_setpc_b64 s[82:83]
L_rare0:
    s_nop 15
    v_log_f32 v216, v210
    s_nop 0
    v_max_f32 v216, 0, v216
    v_max3_f32 v216, v216, v112, v113
    v_max3_f32 v216, v216, v114, v115
    v_max3_f32 v216, v216, v120, v121
    v_max3_f32 v216, v216, v122, v123
    v_mov_b32 v212, v216
    s_nop 1
    v_permlane16_swap_b32 v216, v212
    s_nop 1
    v_max_f32 v216, v216, v212
    v_mov_b32 v212, v216
    s_nop 1
    v_permlane32_swap_b32 v216, v212
    s_nop 1
    v_max_f32 v216, v216, v212
    v_exp_f32 v212, -v216
    v_sub_f32 v112, v112, v216
    v_sub_f32 v128, v128, v216
    v_sub_f32 v192, v192, v216
    v_sub_f32 v113, v113, v216
    v_sub_f32 v129, v129, v216
    v_sub_f32 v193, v193, v216
    v_sub_f32 v114, v114, v216
    v_sub_f32 v130, v130, v216
    v_sub_f32 v194, v194, v216
    v_sub_f32 v115, v115, v216
    v_sub_f32 v131, v131, v216
    v_sub_f32 v195, v195, v216
    v_sub_f32 v120, v120, v216
    v_sub_f32 v136, v136, v216
    v_sub_f32 v200, v200, v216
    v_sub_f32 v121, v121, v216
    v_sub_f32 v137, v137, v216
    v_sub_f32 v201, v201, v216
    v_sub_f32 v122, v122, v216
    v_sub_f32 v138, v138, v216
    v_sub_f32 v202, v202, v216
    v_sub_f32 v123, v123, v216
    v_sub_f32 v139, v139, v216
    v_sub_f32 v203, v203, v216
    v_mul_f32 v210, v212, v210
    v_mul_f32 v48, v212, v48
    v_mul_f32 v49, v212, v49
    v_mul_f32 v50, v212, v50
    v_mul_f32 v51, v212, v51
    v_mul_f32 v56, v212, v56
    v_mul_f32 v57, v212, v57
    v_mul_f32 v58, v212, v58
    v_mul_f32 v59, v212, v59
    v_mul_f32 v64, v212, v64
    v_mul_f32 v65, v212, v65
    v_mul_f32 v66, v212, v66
    v_mul_f32 v67, v212, v67
    v_mul_f32 v72, v212, v72
    v_mul_f32 v73, v212, v73
    v_mul_f32 v74, v212, v74
    v_mul_f32 v75, v212, v75
    v_mul_f32 v80, v212, v80
    v_mul_f32 v81, v212, v81
    v_mul_f32 v82, v212, v82
    v_mul_f32 v83, v212, v83
    v_mul_f32 v88, v212, v88
    v_mul_f32 v89, v212, v89
    v_mul_f32 v90, v212, v90
    v_mul_f32 v91, v212, v91
    v_mul_f32 v96, v212, v96
    v_mul_f32 v97, v212, v97
    v_mul_f32 v98, v212, v98
    v_mul_f32 v99, v212, v99
    v_mul_f32 v104, v212, v104
    v_mul_f32 v105, v212, v105
    v_mul_f32 v106, v212, v106
    v_mul_f32 v107, v212, v107
    v_log_f32 v217, v211
    s_nop 0
    v_max_f32 v217, 0, v217
    v_max3_f32 v217, v217, v116, v117
    v_max3_f32 v217, v217, v118, v119
    v_max3_f32 v217, v217, v124, v125
    v_max3_f32 v217, v217, v126, v127
    v_mov_b32 v212, v217
    s_nop 1
    v_permlane16_swap_b32 v217, v212
    s_nop 1
    v_max_f32 v217, v217, v212
    v_mov_b32 v212, v217
    s_nop 1
    v_permlane32_swap_b32 v217, v212
    s_nop 1
    v_max_f32 v217, v217, v212
    v_exp_f32 v212, -v217
    v_sub_f32 v116, v116, v217
    v_sub_f32 v132, v132, v217
    v_sub_f32 v196, v196, v217
    v_sub_f32 v117, v117, v217
    v_sub_f32 v133, v133, v217
    v_sub_f32 v197, v197, v217
    v_sub_f32 v118, v118, v217
    v_sub_f32 v134, v134, v217
    v_sub_f32 v198, v198, v217
    v_sub_f32 v119, v119, v217
    v_sub_f32 v135, v135, v217
    v_sub_f32 v199, v199, v217
    v_sub_f32 v124, v124, v217
    v_sub_f32 v140, v140, v217
    v_sub_f32 v204, v204, v217
    v_sub_f32 v125, v125, v217
    v_sub_f32 v141, v141, v217
    v_sub_f32 v205, v205, v217
    v_sub_f32 v126, v126, v217
    v_sub_f32 v142, v142, v217
    v_sub_f32 v206, v206, v217
    v_sub_f32 v127, v127, v217
    v_sub_f32 v143, v143, v217
    v_sub_f32 v207, v207, v217
    v_mul_f32 v211, v212, v211
    v_mul_f32 v52, v212, v52
    v_mul_f32 v53, v212, v53
    v_mul_f32 v54, v212, v54
    v_mul_f32 v55, v212, v55
    v_mul_f32 v60, v212, v60
    v_mul_f32 v61, v212, v61
    v_mul_f32 v62, v212, v62
    v_mul_f32 v63, v212, v63
    v_mul_f32 v68, v212, v68
    v_mul_f32 v69, v212, v69
    v_mul_f32 v70, v212, v70
    v_mul_f32 v71, v212, v71
    v_mul_f32 v76, v212, v76
    v_mul_f32 v77, v212, v77
    v_mul_f32 v78, v212, v78
    v_mul_f32 v79, v212, v79
    v_mul_f32 v84, v212, v84
    v_mul_f32 v85, v212, v85
    v_mul_f32 v86, v212, v86
    v_mul_f32 v87, v212, v87
    v_mul_f32 v92, v212, v92
    v_mul_f32 v93, v212, v93
    v_mul_f32 v94, v212, v94
    v_mul_f32 v95, v212, v95
    v_mul_f32 v100, v212, v100
    v_mul_f32 v101, v212, v101
    v_mul_f32 v102, v212, v102
    v_mul_f32 v103, v212, v103
    v_mul_f32 v108, v212, v108
    v_mul_f32 v109, v212, v109
    v_mul_f32 v110, v212, v110
    v_mul_f32 v111, v212, v111
    v_exp_f32 v212, v112
    s_nop 0
    v_add_f32 v208, v212, v210
    v_exp_f32 v213, v113
    s_nop 0
    v_add_f32 v208, v213, v208
    v_cvt_pk_bf16_f32 v176, v212, v213
    v_exp_f32 v214, v114
    s_nop 0
    v_add_f32 v208, v214, v208
    v_exp_f32 v215, v115
    s_nop 0
    v_add_f32 v208, v215, v208
    v_cvt_pk_bf16_f32 v177, v214, v215
    v_exp_f32 v212, v116
    s_nop 0
    v_add_f32 v209, v212, v211
    v_exp_f32 v213, v117
    s_nop 0
    v_add_f32 v209, v213, v209
    v_cvt_pk_bf16_f32 v180, v212, v213
    v_exp_f32 v214, v118
    s_nop 0
    v_add_f32 v209, v214, v209
    v_exp_f32 v215, v119
    s_nop 0
    v_add_f32 v209, v215, v209
    v_cvt_pk_bf16_f32 v181, v214, v215
    v_exp_f32 v212, v120
    s_nop 0
    v_add_f32 v208, v212, v208
    v_exp_f32 v213, v121
    s_nop 0
    v_add_f32 v208, v213, v208
    v_cvt_pk_bf16_f32 v178, v212, v213
    v_exp_f32 v214, v122
    s_nop 0
    v_add_f32 v208, v214, v208
    v_exp_f32 v215, v123
    s_nop 0
    v_add_f32 v208, v215, v208
    v_cvt_pk_bf16_f32 v179, v214, v215
    v_exp_f32 v212, v124
    s_nop 0
    v_add_f32 v209, v212, v209
    v_exp_f32 v213, v125
    s_nop 0
    v_add_f32 v209, v213, v209
    v_cvt_pk_bf16_f32 v182, v212, v213
    v_exp_f32 v214, v126
    s_nop 0
    v_add_f32 v209, v214, v209
    v_exp_f32 v215, v127
    s_nop 0
    v_add_f32 v209, v215, v209
    v_cvt_pk_bf16_f32 v183, v214, v215
    s_nop 1
    s_setpc_b64 s[80:81]
L_rare1:
    s_nop 15
    v_log_f32 v216, v208
    s_nop 0
    v_max_f32 v216, 0, v216
    v_max3_f32 v216, v216, v128, v129
    v_max3_f32 v216, v216, v130, v131
    v_max3_f32 v216, v216, v136, v137
    v_max3_f32 v216, v216, v138, v139
    v_mov_b32 v212, v216
    s_nop 1
    v_permlane16_swap_b32 v216, v212
    s_nop 1
    v_max_f32 v216, v216, v212
    v_mov_b32 v212, v216
    s_nop 1
    v_permlane32_swap_b32 v216, v212
    s_nop 1
    v_max_f32 v216, v216, v212
    v_exp_f32 v212, -v216
    v_sub_f32 v112, v112, v216
    v_sub_f32 v128, v128, v216
    v_sub_f32 v192, v192, v216
    v_sub_f32 v113, v113, v216
    v_sub_f32 v129, v129, v216
    v_sub_f32 v193, v193, v216
    v_sub_f32 v114, v114, v216
    v_sub_f32 v130, v130, v216
    v_sub_f32 v194, v194, v216
    v_sub_f32 v115, v115, v216
    v_sub_f32 v131, v131, v216
    v_sub_f32 v195, v195, v216
    v_sub_f32 v120, v120, v216
    v_sub_f32 v136, v136, v216
    v_sub_f32 v200, v200, v216
    v_sub_f32 v121, v121, v216
    v_sub_f32 v137, v137, v216
    v_sub_f32 v201, v201, v216
    v_sub_f32 v122, v122, v216
    v_sub_f32 v138, v138, v216
    v_sub_f32 v202, v202, v216
    v_sub_f32 v123, v123, v216
    v_sub_f32 v139, v139, v216
    v_sub_f32 v203, v203, v216
    v_mul_f32 v208, v212, v208
    v_mul_f32 v48, v212, v48
    v_mul_f32 v49, v212, v49
    v_mul_f32 v50, v212, v50
    v_mul_f32 v51, v212, v51
    v_mul_f32 v56, v212, v56
    v_mul_f32 v57, v212, v57
    v_mul_f32 v58, v212, v58
    v_mul_f32 v59, v212, v59
    v_mul_f32 v64, v212, v64
    v_mul_f32 v65, v212, v65
    v_mul_f32 v66, v212, v66
    v_mul_f32 v67, v212, v67
    v_mul_f32 v72, v212, v72
    v_mul_f32 v73, v212, v73
    v_mul_f32 v74, v212, v74
    v_mul_f32 v75, v212, v75
    v_mul_f32 v80, v212, v80
    v_mul_f32 v81, v212, v81
    v_mul_f32 v82, v212, v82
    v_mul_f32 v83, v212, v83
    v_mul_f32 v88, v212, v88
    v_mul_f32 v89, v212, v89
    v_mul_f32 v90, v212, v90
    v_mul_f32 v91, v212, v91
    v_mul_f32 v96, v212, v96
    v_mul_f32 v97, v212, v97
    v_mul_f32 v98, v212, v98
    v_mul_f32 v99, v212, v99
    v_mul_f32 v104, v212, v104
    v_mul_f32 v105, v212, v105
    v_mul_f32 v106, v212, v106
    v_mul_f32 v107, v212, v107
    v_log_f32 v217, v209
    s_nop 0
    v_max_f32 v217, 0, v217
    v_max3_f32 v217, v217, v132, v133
    v_max3_f32 v217, v217, v134, v135
    v_max3_f32 v217, v217, v140, v141
    v_max3_f32 v217, v217, v142, v143
    v_mov_b32 v212, v217
    s_nop 1
    v_permlane16_swap_b32 v217, v212
    s_nop 1
    v_max_f32 v217, v217, v212
    v_mov_b32 v212, v217
    s_nop 1
    v_permlane32_swap_b32 v217, v212
    s_nop 1
    v_max_f32 v217, v217, v212
    v_exp_f32 v212, -v217
    v_sub_f32 v116, v116, v217
    v_sub_f32 v132, v132, v217
    v_sub_f32 v196, v196, v217
    v_sub_f32 v117, v117, v217
    v_sub_f32 v133, v133, v217
    v_sub_f32 v197, v197, v217
    v_sub_f32 v118, v118, v217
    v_sub_f32 v134, v134, v217
    v_sub_f32 v198, v198, v217
    v_sub_f32 v119, v119, v217
    v_sub_f32 v135, v135, v217
    v_sub_f32 v199, v199, v217
    v_sub_f32 v124, v124, v217
    v_sub_f32 v140, v140, v217
    v_sub_f32 v204, v204, v217
    v_sub_f32 v125, v125, v217
    v_sub_f32 v141, v141, v217
    v_sub_f32 v205, v205, v217
    v_sub_f32 v126, v126, v217
    v_sub_f32 v142, v142, v217
    v_sub_f32 v206, v206, v217
    v_sub_f32 v127, v127, v217
    v_sub_f32 v143, v143, v217
    v_sub_f32 v207, v207, v217
    v_mul_f32 v209, v212, v209
    v_mul_f32 v52, v212, v52
    v_mul_f32 v53, v212, v53
    v_mul_f32 v54, v212, v54
    v_mul_f32 v55, v212, v55
    v_mul_f32 v60, v212, v60
    v_mul_f32 v61, v212, v61
    v_mul_f32 v62, v212, v62
    v_mul_f32 v63, v212, v63
    v_mul_f32 v68, v212, v68
    v_mul_f32 v69, v212, v69
    v_mul_f32 v70, v212, v70
    v_mul_f32 v71, v212, v71
    v_mul_f32 v76, v212, v76
    v_mul_f32 v77, v212, v77
    v_mul_f32 v78, v212, v78
    v_mul_f32 v79, v212, v79
    v_mul_f32 v84, v212, v84
    v_mul_f32 v85, v212, v85
    v_mul_f32 v86, v212, v86
    v_mul_f32 v87, v212, v87
    v_mul_f32 v92, v212, v92
    v_mul_f32 v93, v212, v93
    v_mul_f32 v94, v212, v94
    v_mul_f32 v95, v212, v95
    v_mul_f32 v100, v212, v100
    v_mul_f32 v101, v212, v101
    v_mul_f32 v102, v212, v102
    v_mul_f32 v103, v212, v103
    v_mul_f32 v108, v212, v108
    v_mul_f32 v109, v212, v109
    v_mul_f32 v110, v212, v110
    v_mul_f32 v111, v212, v111
    v_exp_f32 v212, v128
    s_nop 0
    v_add_f32 v210, v212, v208
    v_exp_f32 v213, v129
    s_nop 0
    v_add_f32 v210, v213, v210
    v_cvt_pk_bf16_f32 v184, v212, v213
    v_exp_f32 v214, v130
    s_nop 0
    v_add_f32 v210, v214, v210
    v_exp_f32 v215, v131
    s_nop 0
    v_add_f32 v210, v215, v210
    v_cvt_pk_bf16_f32 v185, v214, v215
    v_exp_f32 v212, v132
    s_nop 0
    v_add_f32 v211, v212, v209
    v_exp_f32 v213, v133
    s_nop 0
    v_add_f32 v211, v213, v211
    v_cvt_pk_bf16_f32 v188, v212, v213
    v_exp_f32 v214, v134
    s_nop 0
    v_add_f32 v211, v214, v211
    v_exp_f32 v215, v135
    s_nop 0
    v_add_f32 v211, v215, v211
    v_cvt_pk_bf16_f32 v189, v214, v215
    v_exp_f32 v212, v136
    s_nop 0
    v_add_f32 v210, v212, v210
    v_exp_f32 v213, v137
    s_nop 0
    v_add_f32 v210, v213, v210
    v_cvt_pk_bf16_f32 v186, v212, v213
    v_exp_f32 v214, v138
    s_nop 0
    v_add_f32 v210, v214, v210
    v_exp_f32 v215, v139
    s_nop 0
    v_add_f32 v210, v215, v210
    v_cvt_pk_bf16_f32 v187, v214, v215
    v_exp_f32 v212, v140
    s_nop 0
    v_add_f32 v211, v212, v211
    v_exp_f32 v213, v141
    s_nop 0
    v_add_f32 v211, v213, v211
    v_cvt_pk_bf16_f32 v190, v212, v213
    v_exp_f32 v214, v142
    s_nop 0
    v_add_f32 v211, v214, v211
    v_exp_f32 v215, v143
    s_nop 0
    v_add_f32 v211, v215, v211
    v_cvt_pk_bf16_f32 v191, v214, v215
    s_nop 1
    s_setpc_b64 s[80:81]
L_adone:
    s_sub_u32 s6, s5, 6
    s_lshl_b32 s6, s6, 5
    s_add_u32 s60, s6, s4
    s_cmp_lt_u32 s5, 6
    s_cbranch_scc1 L_k2_end
    s_cmp_ge_u32 s60, 54
    s_cbranch_scc1 L_k2_end
    s_mov_b32 s12, s48
    s_mov_b32 s13, s49
    s_mov_b32 s14, 0x21c000
    s_mov_b32 s15, 0x20000
    s_cmp_ge_u32 s3, 4
    s_cselect_b32 s12, s50, s12
    s_cselect_b32 s13, s51, s13
    s_mov_b32 s16, s52
    s_mov_b32 s17, s53
    s_mov_b32 s18, 0x21c000
    s_mov_b32 s19, 0x20000
    s_mov_b32 s73, 0x280000
    v_lshlrev_b32 v2, 4, v0
    s_waitcnt vmcnt(0)
    s_barrier
    buffer_load_dwordx4 v[16:19], v2, s[8:11], s73 offen
    v_lshrrev_b32 v3, 2, v1
    v_mul_u32_u24 v3, 3456, v3
    v_and_b32 v4, 3, v1
    v_lshl_add_u32 v3, v4, 4, v3
    s_and_b32 s61, s3, 3
    s_mul_i32 s62, s61, 552960
    s_lshl_b32 s6, s60, 6
    s_add_u32 s62, s62, s6
    s_mul_i32 s63, s3, 10240
    s_add_u32 m0, s63, 0
    s_nop 0
    buffer_load_dwordx4 v3, s[12:15], s62 offen lds
    s_add_u32 s62, s62, 55296
    s_add_u32 m0, s63, 1024
    s_nop 0
    buffer_load_dwordx4 v3, s[12:15], s62 offen lds
    s_add_u32 s62, s62, 55296
    s_add_u32 m0, s63, 2048
    s_nop 0
    buffer_load_dwordx4 v3, s[12:15], s62 offen lds
    s_add_u32 s62, s62, 55296
    s_add_u32 m0, s63, 3072
    s_nop 0
    buffer_load_dwordx4 v3, s[12:15], s62 offen lds
    s_add_u32 s62, s62, 55296
    s_add_u32 m0, s63, 4096
    s_nop 0
    buffer_load_dwordx4 v3, s[12:15], s62 offen lds
    s_add_u32 s62, s62, 55296
    s_add_u32 m0, s63, 5120
    s_nop 0
    buffer_load_dwordx4 v3, s[12:15], s62 offen lds
    s_add_u32 s62, s62, 55296
    s_add_u32 m0, s63, 6144
    s_nop 0
    buffer_load_dwordx4 v3, s[12:15], s62 offen lds
    s_add_u32 s62, s62, 55296
    s_add_u32 m0, s63, 7168
    s_nop 0
    buffer_load_dwordx4 v3, s[12:15], s62 offen lds
    s_add_u32 s62, s62, 55296
    s_add_u32 m0, s63, 8192
    s_nop 0
    buffer_load_dwordx4 v3, s[12:15], s62 offen lds
    s_add_u32 s62, s62, 55296
    s_add_u32 m0, s63, 9216
    s_nop 0
    buffer_load_dwordx4 v3, s[12:15], s62 offen lds
    s_add_u32 s62, s62, 55296
    s_mul_i32 s62, s60, 40960
    s_mul_i32 s6, s3, 5120
    s_add_u32 s62, s62, s6
    s_add_u32 s6, s6, 81920
    s_add_u32 m0, s6, 0
    s_nop 0
    buffer_load_dwordx4 v222, s[16:19], s62 offen lds
    s_add_u32 s62, s62, 1024
    s_add_u32 m0, s6, 1024
    s_nop 0
    buffer_load_dwordx4 v222, s[16:19], s62 offen lds
    s_add_u32 s62, s62, 1024
    s_add_u32 m0, s6, 2048
    s_nop 0
    buffer_load_dwordx4 v222, s[16:19], s62 offen lds
    s_add_u32 s62, s62, 1024
    s_add_u32 m0, s6, 3072
    s_nop 0
    buffer_load_dwordx4 v222, s[16:19], s62 offen lds
    s_add_u32 s62, s62, 1024
    s_add_u32 m0, s6, 4096
    s_nop 0
    buffer_load_dwordx4 v222, s[16:19], s62 offen lds
    s_add_u32 s62, s62, 1024
    s_waitcnt vmcnt(15)
    v_mov_b32 v20, 0
    v_max_u32 v4, v16, v17
    v_max3_u32 v4, v4, v18, v19
    s_nop 1
    v_max_u32_dpp v4, v4, v4 quad_perm:[1,0,3,2] row_mask:0xf bank_mask:0xf
    s_nop 1
    v_max_u32_dpp v4, v4, v4 quad_perm:[2,3,0,1] row_mask:0xf bank_mask:0xf
    s_nop 1
    v_max_u32_dpp v4, v4, v4 row_half_mirror row_mask:0xf bank_mask:0xf
    s_nop 1
    v_max_u32_dpp v4, v4, v4 row_mirror row_mask:0xf bank_mask:0xf
    s_nop 1
    v_max_u32_dpp v4, v4, v4 row_bcast:15 row_mask:0xa bank_mask:0xf
    s_nop 1
    v_max_u32_dpp v4, v4, v4 row_bcast:31 row_mask:0xc bank_mask:0xf
    s_nop 1
    v_readlane_b32 s6, v4, 63
    s_nop 1
    v_writelane_b32 v20, s6, 0
    v_cmp_ne_u32 vcc, s6, v16
    s_nop 1
    v_cndmask_b32 v16, 0, v16, vcc
    v_cmp_ne_u32 vcc, s6, v17
    s_nop 1
    v_cndmask_b32 v17, 0, v17, vcc
    v_cmp_ne_u32 vcc, s6, v18
    s_nop 1
    v_cndmask_b32 v18, 0, v18, vcc
    v_cmp_ne_u32 vcc, s6, v19
    s_nop 1
    v_cndmask_b32 v19, 0, v19, vcc
    v_max_u32 v4, v16, v17
    v_max3_u32 v4, v4, v18, v19
    s_nop 1
    v_max_u32_dpp v4, v4, v4 quad_perm:[1,0,3,2] row_mask:0xf bank_mask:0xf
    s_nop 1
    v_max_u32_dpp v4, v4, v4 quad_perm:[2,3,0,1] row_mask:0xf bank_mask:0xf
    s_nop 1
    v_max_u32_dpp v4, v4, v4 row_half_mirror row_mask:0xf bank_mask:0xf
    s_nop 1
    v_max_u32_dpp v4, v4, v4 row_mirror row_mask:0xf bank_mask:0xf
    s_nop 1
    v_max_u32_dpp v4, v4, v4 row_bcast:15 row_mask:0xa bank_mask:0xf
    s_nop 1
    v_max_u32_dpp v4, v4, v4 row_bcast:31 row_mask:0xc bank_mask:0xf
    s_nop 1
    v_readlane_b32 s6, v4, 63
    s_nop 1
    v_writelane_b32 v20, s6, 1
    v_cmp_ne_u32 vcc, s6, v16
    s_nop 1
    v_cndmask_b32 v16, 0, v16, vcc
    v_cmp_ne_u32 vcc, s6, v17
    s_nop 1
    v_cndmask_b32 v17, 0, v17, vcc
    v_cmp_ne_u32 vcc, s6, v18
    s_nop 1
    v_cndmask_b32 v18, 0, v18, vcc
    v_cmp_ne_u32 vcc, s6, v19
    s_nop 1
    v_cndmask_b32 v19, 0, v19, vcc
    v_max_u32 v4, v16, v17
    v_max3_u32 v4, v4, v18, v19
    s_nop 1
    v_max_u32_dpp v4, v4, v4 quad_perm:[1,0,3,2] row_mask:0xf bank_mask:0xf
    s_nop 1
    v_max_u32_dpp v4, v4, v4 quad_perm:[2,3,0,1] row_mask:0xf bank_mask:0xf
    s_nop 1
    v_max_u32_dpp v4, v4, v4 row_half_mirror row_mask:0xf bank_mask:0xf
    s_nop 1
    v_max_u32_dpp v4, v4, v4 row_mirror row_mask:0xf bank_mask:0xf
    s_nop 1
    v_max_u32_dpp v4, v4, v4 row_bcast:15 row_mask:0xa bank_mask:0xf
    s_nop 1
    v_max_u32_dpp v4, v4, v4 row_bcast:31 row_mask:0xc bank_mask:0xf
    s_nop 1
    v_readlane_b32 s6, v4, 63
    s_nop 1
    v_writelane_b32 v20, s6, 2
    v_cmp_ne_u32 vcc, s6, v16
    s_nop 1
    v_cndmask_b32 v16, 0, v16, vcc
    v_cmp_ne_u32 vcc, s6, v17
    s_nop 1
    v_cndmask_b32 v17, 0, v17, vcc
    v_cmp_ne_u32 vcc, s6, v18
    s_nop 1
    v_cndmask_b32 v18, 0, v18, vcc
    v_cmp_ne_u32 vcc, s6, v19
    s_nop 1
    v_cndmask_b32 v19, 0, v19, vcc
    v_max_u32 v4, v16, v17
    v_max3_u32 v4, v4, v18, v19
    s_nop 1
    v_max_u32_dpp v4, v4, v4 quad_perm:[1,0,3,2] row_mask:0xf bank_mask:0xf
    s_nop 1
    v_max_u32_dpp v4, v4, v4 quad_perm:[2,3,0,1] row_mask:0xf bank_mask:0xf
    s_nop 1
    v_max_u32_dpp v4, v4, v4 row_half_mirror row_mask:0xf bank_mask:0xf
    s_nop 1
    v_max_u32_dpp v4, v4, v4 row_mirror row_mask:0xf bank_mask:0xf
    s_nop 1
    v_max_u32_dpp v4, v4, v4 row_bcast:15 row_mask:0xa bank_mask:0xf
    s_nop 1
    v_max_u32_dpp v4, v4, v4 row_bcast:31 row_mask:0xc bank_mask:0xf
    s_nop 1
    v_readlane_b32 s6, v4, 63
    s_nop 1
    v_writelane_b32 v20, s6, 3
    v_cmp_ne_u32 vcc, s6, v16
    s_nop 1
    v_cndmask_b32 v16, 0, v16, vcc
    v_cmp_ne_u32 vcc, s6, v17
    s_nop 1
    v_cndmask_b32 v17, 0, v17, vcc
    v_cmp_ne_u32 vcc, s6, v18
    s_nop 1
    v_cndmask_b32 v18, 0, v18, vcc
    v_cmp_ne_u32 vcc, s6, v19
    s_nop 1
    v_cndmask_b32 v19, 0, v19, vcc
    v_max_u32 v4, v16, v17
    v_max3_u32 v4, v4, v18, v19
    s_nop 1
    v_max_u32_dpp v4, v4, v4 quad_perm:[1,0,3,2] row_mask:0xf bank_mask:0xf
    s_nop 1
    v_max_u32_dpp v4, v4, v4 quad_perm:[2,3,0,1] row_mask:0xf bank_mask:0xf
    s_nop 1
    v_max_u32_dpp v4, v4, v4 row_half_mirror row_mask:0xf bank_mask:0xf
    s_nop 1
    v_max_u32_dpp v4, v4, v4 row_mirror row_mask:0xf bank_mask:0xf
    s_nop 1
    v_max_u32_dpp v4, v4, v4 row_bcast:15 row_mask:0xa bank_mask:0xf
    s_nop 1
    v_max_u32_dpp v4, v4, v4 row_bcast:31 row_mask:0xc bank_mask:0xf
    s_nop 1
    v_readlane_b32 s6, v4, 63
    s_nop 1
    v_writelane_b32 v20, s6, 4
    v_cmp_ne_u32 vcc, s6, v16
    s_nop 1
    v_cndmask_b32 v16, 0, v16, vcc
    v_cmp_ne_u32 vcc, s6, v17
    s_nop 1
    v_cndmask_b32 v17, 0, v17, vcc
    v_cmp_ne_u32 vcc, s6, v18
    s_nop 1
    v_cndmask_b32 v18, 0, v18, vcc
    v_cmp_ne_u32 vcc, s6, v19
    s_nop 1
    v_cndmask_b32 v19, 0, v19, vcc
    v_max_u32 v4, v16, v17
    v_max3_u32 v4, v4, v18, v19
    s_nop 1
    v_max_u32_dpp v4, v4, v4 quad_perm:[1,0,3,2] row_mask:0xf bank_mask:0xf
    s_nop 1
    v_max_u32_dpp v4, v4, v4 quad_perm:[2,3,0,1] row_mask:0xf bank_mask:0xf
    s_nop 1
    v_max_u32_dpp v4, v4, v4 row_half_mirror row_mask:0xf bank_mask:0xf
    s_nop 1
    v_max_u32_dpp v4, v4, v4 row_mirror row_mask:0xf bank_mask:0xf
    s_nop 1
    v_max_u32_dpp v4, v4, v4 row_bcast:15 row_mask:0xa bank_mask:0xf
    s_nop 1
    v_max_u32_dpp v4, v4, v4 row_bcast:31 row_mask:0xc bank_mask:0xf
    s_nop 1
    v_readlane_b32 s6, v4, 63
    s_nop 1
    v_writelane_b32 v20, s6, 5
    v_cmp_ne_u32 vcc, s6, v16
    s_nop 1
    v_cndmask_b32 v16, 0, v16, vcc
    v_cmp_ne_u32 vcc, s6, v17
    s_nop 1
    v_cndmask_b32 v17, 0, v17, vcc
    v_cmp_ne_u32 vcc, s6, v18
    s_nop 1
    v_cndmask_b32 v18, 0, v18, vcc
    v_cmp_ne_u32 vcc, s6, v19
    s_nop 1
    v_cndmask_b32 v19, 0, v19, vcc
    v_max_u32 v4, v16, v17
    v_max3_u32 v4, v4, v18, v19
    s_nop 1
    v_max_u32_dpp v4, v4, v4 quad_perm:[1,0,3,2] row_mask:0xf bank_mask:0xf
    s_nop 1
    v_max_u32_dpp v4, v4, v4 quad_perm:[2,3,0,1] row_mask:0xf bank_mask:0xf
    s_nop 1
    v_max_u32_dpp v4, v4, v4 row_half_mirror row_mask:0xf bank_mask:0xf
    s_nop 1
    v_max_u32_dpp v4, v4, v4 row_mirror row_mask:0xf bank_mask:0xf
    s_nop 1
    v_max_u32_dpp v4, v4, v4 row_bcast:15 row_mask:0xa bank_mask:0xf
    s_nop 1
    v_max_u32_dpp v4, v4, v4 row_bcast:31 row_mask:0xc bank_mask:0xf
    s_nop 1
    v_readlane_b32 s6, v4, 63
    s_nop 1
    v_writelane_b32 v20, s6, 6
    v_cmp_ne_u32 vcc, s6, v16
    s_nop 1
    v_cndmask_b32 v16, 0, v16, vcc
    v_cmp_ne_u32 vcc, s6, v17
    s_nop 1
    v_cndmask_b32 v17, 0, v17, vcc
    v_cmp_ne_u32 vcc, s6, v18
    s_nop 1
    v_cndmask_b32 v18, 0, v18, vcc
    v_cmp_ne_u32 vcc, s6, v19
    s_nop 1
    v_cndmask_b32 v19, 0, v19, vcc
    v_max_u32 v4, v16, v17
    v_max3_u32 v4, v4, v18, v19
    s_nop 1
    v_max_u32_dpp v4, v4, v4 quad_perm:[1,0,3,2] row_mask:0xf bank_mask:0xf
    s_nop 1
    v_max_u32_dpp v4, v4, v4 quad_perm:[2,3,0,1] row_mask:0xf bank_mask:0xf
    s_nop 1
    v_max_u32_dpp v4, v4, v4 row_half_mirror row_mask:0xf bank_mask:0xf
    s_nop 1
    v_max_u32_dpp v4, v4, v4 row_mirror row_mask:0xf bank_mask:0xf
    s_nop 1
    v_max_u32_dpp v4, v4, v4 row_bcast:15 row_mask:0xa bank_mask:0xf
    s_nop 1
    v_max_u32_dpp v4, v4, v4 row_bcast:31 row_mask:0xc bank_mask:0xf
    s_nop 1
    v_readlane_b32 s6, v4, 63
    s_nop 1
    v_writelane_b32 v20, s6, 7
    s_lshl_b32 s6, s3, 5
    s_add_u32 s6, s6, 139264
    v_lshl_add_u32 v5, v1, 2, s6
    v_cmp_gt_u32 vcc, 8, v1
    s_and_saveexec_b64 s[74:75], vcc
    ds_write_b32 v5, v20
    s_mov_b64 exec, s[74:75]
    s_waitcnt lgkmcnt(0)
    s_barrier
    v_lshlrev_b32 v5, 2, v1
    v_add_u32 v5, 139264, v5
    ds_read_b32 v16, v5
    s_waitcnt lgkmcnt(0)
    v_and_b32 v6, 7, v1
    v_mov_b32 v20, 0
    v_mov_b32 v4, v16
    s_nop 1
    v_max_u32_dpp v4, v4, v4 quad_perm:[1,0,3,2] row_mask:0xf bank_mask:0xf
    s_nop 1
    v_max_u32_dpp v4, v4, v4 quad_perm:[2,3,0,1] row_mask:0xf bank_mask:0xf
    s_nop 1
    v_max_u32_dpp v4, v4, v4 row_half_mirror row_mask:0xf bank_mask:0xf
    s_nop 1
    v_max_u32_dpp v4, v4, v4 row_mirror row_mask:0xf bank_mask:0xf
    s_nop 1
    v_max_u32_dpp v4, v4, v4 row_bcast:15 row_mask:0xa bank_mask:0xf
    s_nop 1
    v_max_u32_dpp v4, v4, v4 row_bcast:31 row_mask:0xc bank_mask:0xf
    s_nop 1
    v_readlane_b32 s6, v4, 63
    v_cmp_eq_u32 vcc, 0, v6
    s_nop 1
    v_mov_b32 v5, s6
    v_cndmask_b32 v20, v20, v5, vcc
    v_cmp_ne_u32 vcc, s6, v16
    s_nop 1
    v_cndmask_b32 v16, 0, v16, vcc
    v_mov_b32 v4, v16
    s_nop 1
    v_max_u32_dpp v4, v4, v4 quad_perm:[1,0,3,2] row_mask:0xf bank_mask:0xf
    s_nop 1
    v_max_u32_dpp v4, v4, v4 quad_perm:[2,3,0,1] row_mask:0xf bank_mask:0xf
    s_nop 1
    v_max_u32_dpp v4, v4, v4 row_half_mirror row_mask:0xf bank_mask:0xf
    s_nop 1
    v_max_u32_dpp v4, v4, v4 row_mirror row_mask:0xf bank_mask:0xf
    s_nop 1
    v_max_u32_dpp v4, v4, v4 row_bcast:15 row_mask:0xa bank_mask:0xf
    s_nop 1
    v_max_u32_dpp v4, v4, v4 row_bcast:31 row_mask:0xc bank_mask:0xf
    s_nop 1
    v_readlane_b32 s6, v4, 63
    v_cmp_eq_u32 vcc, 1, v6
    s_nop 1
    v_mov_b32 v5, s6
    v_cndmask_b32 v20, v20, v5, vcc
    v_cmp_ne_u32 vcc, s6, v16
    s_nop 1
    v_cndmask_b32 v16, 0, v16, vcc
    v_mov_b32 v4, v16
    s_nop 1
    v_max_u32_dpp v4, v4, v4 quad_perm:[1,0,3,2] row_mask:0xf bank_mask:0xf
    s_nop 1
    v_max_u32_dpp v4, v4, v4 quad_perm:[2,3,0,1] row_mask:0xf bank_mask:0xf
    s_nop 1
    v_max_u32_dpp v4, v4, v4 row_half_mirror row_mask:0xf bank_mask:0xf
    s_nop 1
    v_max_u32_dpp v4, v4, v4 row_mirror row_mask:0xf bank_mask:0xf
    s_nop 1
    v_max_u32_dpp v4, v4, v4 row_bcast:15 row_mask:0xa bank_mask:0xf
    s_nop 1
    v_max_u32_dpp v4, v4, v4 row_bcast:31 row_mask:0xc bank_mask:0xf
    s_nop 1
    v_readlane_b32 s6, v4, 63
    v_cmp_eq_u32 vcc, 2, v6
    s_nop 1
    v_mov_b32 v5, s6
    v_cndmask_b32 v20, v20, v5, vcc
    v_cmp_ne_u32 vcc, s6, v16
    s_nop 1
    v_cndmask_b32 v16, 0, v16, vcc
    v_mov_b32 v4, v16
    s_nop 1
    v_max_u32_dpp v4, v4, v4 quad_perm:[1,0,3,2] row_mask:0xf bank_mask:0xf
    s_nop 1
    v_max_u32_dpp v4, v4, v4 quad_perm:[2,3,0,1] row_mask:0xf bank_mask:0xf
    s_nop 1
    v_max_u32_dpp v4, v4, v4 row_half_mirror row_mask:0xf bank_mask:0xf
    s_nop 1
    v_max_u32_dpp v4, v4, v4 row_mirror row_mask:0xf bank_mask:0xf
    s_nop 1
    v_max_u32_dpp v4, v4, v4 row_bcast:15 row_mask:0xa bank_mask:0xf
    s_nop 1
    v_max_u32_dpp v4, v4, v4 row_bcast:31 row_mask:0xc bank_mask:0xf
    s_nop 1
    v_readlane_b32 s6, v4, 63
    v_cmp_eq_u32 vcc, 3, v6
    s_nop 1
    v_mov_b32 v5, s6
    v_cndmask_b32 v20, v20, v5, vcc
    v_cmp_ne_u32 vcc, s6, v16
    s_nop 1
    v_cndmask_b32 v16, 0, v16, vcc
    v_mov_b32 v4, v16
    s_nop 1
    v_max_u32_dpp v4, v4, v4 quad_perm:[1,0,3,2] row_mask:0xf bank_mask:0xf
    s_nop 1
    v_max_u32_dpp v4, v4, v4 quad_perm:[2,3,0,1] row_mask:0xf bank_mask:0xf
    s_nop 1
    v_max_u32_dpp v4, v4, v4 row_half_mirror row_mask:0xf bank_mask:0xf
    s_nop 1
    v_max_u32_dpp v4, v4, v4 row_mirror row_mask:0xf bank_mask:0xf
    s_nop 1
    v_max_u32_dpp v4, v4, v4 row_bcast:15 row_mask:0xa bank_mask:0xf
    s_nop 1
    v_max_u32_dpp v4, v4, v4 row_bcast:31 row_mask:0xc bank_mask:0xf
    s_nop 1
    v_readlane_b32 s6, v4, 63
    v_cmp_eq_u32 vcc, 4, v6
    s_nop 1
    v_mov_b32 v5, s6
    v_cndmask_b32 v20, v20, v5, vcc
    v_cmp_ne_u32 vcc, s6, v16
    s_nop 1
    v_cndmask_b32 v16, 0, v16, vcc
    v_mov_b32 v4, v16
    s_nop 1
    v_max_u32_dpp v4, v4, v4 quad_perm:[1,0,3,2] row_mask:0xf bank_mask:0xf
    s_nop 1
    v_max_u32_dpp v4, v4, v4 quad_perm:[2,3,0,1] row_mask:0xf bank_mask:0xf
    s_nop 1
    v_max_u32_dpp v4, v4, v4 row_half_mirror row_mask:0xf bank_mask:0xf
    s_nop 1
    v_max_u32_dpp v4, v4, v4 row_mirror row_mask:0xf bank_mask:0xf
    s_nop 1
    v_max_u32_dpp v4, v4, v4 row_bcast:15 row_mask:0xa bank_mask:0xf
    s_nop 1
    v_max_u32_dpp v4, v4, v4 row_bcast:31 row_mask:0xc bank_mask:0xf
    s_nop 1
    v_readlane_b32 s6, v4, 63
    v_cmp_eq_u32 vcc, 5, v6
    s_nop 1
    v_mov_b32 v5, s6
    v_cndmask_b32 v20, v20, v5, vcc
    v_cmp_ne_u32 vcc, s6, v16
    s_nop 1
    v_cndmask_b32 v16, 0, v16, vcc
    v_mov_b32 v4, v16
    s_nop 1
    v_max_u32_dpp v4, v4, v4 quad_perm:[1,0,3,2] row_mask:0xf bank_mask:0xf
    s_nop 1
    v_max_u32_dpp v4, v4, v4 quad_perm:[2,3,0,1] row_mask:0xf bank_mask:0xf
    s_nop 1
    v_max_u32_dpp v4, v4, v4 row_half_mirror row_mask:0xf bank_mask:0xf
    s_nop 1
    v_max_u32_dpp v4, v4, v4 row_mirror row_mask:0xf bank_mask:0xf
    s_nop 1
    v_max_u32_dpp v4, v4, v4 row_bcast:15 row_mask:0xa bank_mask:0xf
    s_nop 1
    v_max_u32_dpp v4, v4, v4 row_bcast:31 row_mask:0xc bank_mask:0xf
    s_nop 1
    v_readlane_b32 s6, v4, 63
    v_cmp_eq_u32 vcc, 6, v6
    s_nop 1
    v_mov_b32 v5, s6
    v_cndmask_b32 v20, v20, v5, vcc
    v_cmp_ne_u32 vcc, s6, v16
    s_nop 1
    v_cndmask_b32 v16, 0, v16, vcc
    v_mov_b32 v4, v16
    s_nop 1
    v_max_u32_dpp v4, v4, v4 quad_perm:[1,0,3,2] row_mask:0xf bank_mask:0xf
    s_nop 1
    v_max_u32_dpp v4, v4, v4 quad_perm:[2,3,0,1] row_mask:0xf bank_mask:0xf
    s_nop 1
    v_max_u32_dpp v4, v4, v4 row_half_mirror row_mask:0xf bank_mask:0xf
    s_nop 1
    v_max_u32_dpp v4, v4, v4 row_mirror row_mask:0xf bank_mask:0xf
    s_nop 1
    v_max_u32_dpp v4, v4, v4 row_bcast:15 row_mask:0xa bank_mask:0xf
    s_nop 1
    v_max_u32_dpp v4, v4, v4 row_bcast:31 row_mask:0xc bank_mask:0xf
    s_nop 1
    v_readlane_b32 s6, v4, 63
    v_cmp_eq_u32 vcc, 7, v6
    s_nop 1
    v_mov_b32 v5, s6
    v_cndmask_b32 v20, v20, v5, vcc
    s_mov_b32 s73, 0x3a0000
    v_lshlrev_b32 v5, 2, v6
    buffer_store_dword v20, v5, s[8:11], s73 offen
    v_and_b32 v4, 0x7ff, v20
    v_sub_u32 v4, 0x7ff, v4
    v_lshrrev_b32 v5, 4, v4
    v_mul_u32_u24 v5, 20480, v5
    v_and_b32 v4, 15, v4
    v_lshl_add_u32 v5, v4, 4, v5
    v_lshrrev_b32 v7, 4, v1
    v_lshl_add_u32 v5, v7, 8, v5
    s_mul_i32 s62, s61, 5120
    buffer_load_dwordx4 v[24:27], v5, s[8:11], s62 offen offset:0
    buffer_load_dwordx4 v[28:31], v5, s[8:11], s62 offen offset:1024
    buffer_load_dwordx4 v[32:35], v5, s[8:11], s62 offen offset:2048
    buffer_load_dwordx4 v[36:39], v5, s[8:11], s62 offen offset:3072
    s_add_u32 s62, s62, 4096
    buffer_load_dwordx4 v[40:43], v5, s[8:11], s62 offen offset:0
    v_and_b32 v2, 15, v1
    v_lshrrev_b32 v3, 2, v2
    v_lshl_add_u32 v8, v7, 3, v3
    v_lshlrev_b32 v8, 6, v8
    v_and_b32 v2, 3, v2
    v_lshl_add_u32 v8, v2, 3, v8
    v_add_u32 v8, s63, v8
    v_lshl_add_u32 v9, v7, 2, v3
    v_mul_u32_u24 v9, 1280, v9
    v_lshl_add_u32 v9, v2, 3, v9
    s_mul_i32 s6, s3, 160
    s_add_u32 s6, s6, 81920
    v_add_u32 v9, s6, v9
    s_waitcnt vmcnt(0)
    ds_read_b64_tr_b16 v[48:49], v8 offset:0
    ds_read_b64_tr_b16 v[50:51], v8 offset:256
    ds_read_b64_tr_b16 v[52:53], v8 offset:32
    ds_read_b64_tr_b16 v[54:55], v8 offset:288
    ds_read_b64_tr_b16 v[56:57], v8 offset:2048
    ds_read_b64_tr_b16 v[58:59], v8 offset:2304
    ds_read_b64_tr_b16 v[60:61], v8 offset:2080
    ds_read_b64_tr_b16 v[62:63], v8 offset:2336
    ds_read_b64_tr_b16 v[64:65], v8 offset:4096
    ds_read_b64_tr_b16 v[66:67], v8 offset:4352
    ds_read_b64_tr_b16 v[68:69], v8 offset:4128
    ds_read_b64_tr_b16 v[70:71], v8 offset:4384
    s_waitcnt lgkmcnt(0)
    ds_read_b64_tr_b16 v[72:73], v8 offset:6144
    ds_read_b64_tr_b16 v[74:75], v8 offset:6400
    ds_read_b64_tr_b16 v[76:77], v8 offset:6176
    ds_read_b64_tr_b16 v[78:79], v8 offset:6432
    ds_read_b64_tr_b16 v[80:81], v8 offset:8192
    ds_read_b64_tr_b16 v[82:83], v8 offset:8448
    ds_read_b64_tr_b16 v[84:85], v8 offset:8224
    ds_read_b64_tr_b16 v[86:87], v8 offset:8480
    s_waitcnt lgkmcnt(0)
    v_mfma_f32_16x16x32_bf16 v[88:91], v[48:51], v[24:27], 0
    v_mfma_f32_16x16x32_bf16 v[92:95], v[52:55], v[24:27], 0
    v_mfma_f32_16x16x32_bf16 v[88:91], v[56:59], v[28:31], v[88:91]
    v_mfma_f32_16x16x32_bf16 v[92:95], v[60:63], v[28:31], v[92:95]
    v_mfma_f32_16x16x32_bf16 v[88:91], v[64:67], v[32:35], v[88:91]
    v_mfma_f32_16x16x32_bf16 v[92:95], v[68:71], v[32:35], v[92:95]
    v_mfma_f32_16x16x32_bf16 v[88:91], v[72:75], v[36:39], v[88:91]
    v_mfma_f32_16x16x32_bf16 v[92:95], v[76:79], v[36:39], v[92:95]
    v_mfma_f32_16x16x32_bf16 v[88:91], v[80:83], v[40:43], v[88:91]
    v_mfma_f32_16x16x32_bf16 v[92:95], v[84:87], v[40:43], v[92:95]
    s_lshl_b32 s6, s3, 11
    s_add_u32 s6, s6, 122880
    v_add_u32 v10, s6, v222
    s_nop 7
    ds_write_b128 v10, v[88:91]
    ds_write_b128 v10, v[92:95] offset:1024
    s_waitcnt lgkmcnt(0)
    s_barrier
    v_add_u32 v10, 122880, v222
    ds_read_b128 v[96:99], v10 offset:0
    ds_read_b128 v[100:103], v10 offset:1024
    ds_read_b128 v[104:107], v10 offset:2048
    ds_read_b128 v[108:111], v10 offset:3072
    ds_read_b128 v[112:115], v10 offset:4096
    ds_read_b128 v[116:119], v10 offset:5120
    ds_read_b128 v[120:123], v10 offset:6144
    ds_read_b128 v[124:127], v10 offset:7168
    s_waitcnt lgkmcnt(0)
    ds_read_b128 v[128:131], v10 offset:8192
    ds_read_b128 v[132:135], v10 offset:9216
    ds_read_b128 v[136:139], v10 offset:10240
    ds_read_b128 v[140:143], v10 offset:11264
    ds_read_b128 v[144:147], v10 offset:12288
    ds_read_b128 v[148:151], v10 offset:13312
    ds_read_b128 v[152:155], v10 offset:14336
    ds_read_b128 v[156:159], v10 offset:15360
    ds_read_b64_tr_b16 v[48:49], v9 offset:0
    ds_read_b64_tr_b16 v[50:51], v9 offset:20480
    ds_read_b64_tr_b16 v[52:53], v9 offset:32
    ds_read_b64_tr_b16 v[54:55], v9 offset:20512
    ds_read_b64_tr_b16 v[56:57], v9 offset:64
    ds_read_b64_tr_b16 v[58:59], v9 offset:20544
    s_waitcnt lgkmcnt(6)
    ds_read_b64_tr_b16 v[60:61], v9 offset:96
    ds_read_b64_tr_b16 v[62:63], v9 offset:20576
    ds_read_b64_tr_b16 v[64:65], v9 offset:128
    ds_read_b64_tr_b16 v[66:67], v9 offset:20608
    s_mov_b32 s6, 0xbfb8aa3b
    v_add_f32 v96, v96, v104
    v_add_f32 v2, v112, v120
    v_add_f32 v96, v96, v2
    v_add_f32 v128, v128, v136
    v_add_f32 v2, v144, v152
    v_add_f32 v128, v128, v2
    v_cvt_pk_bf16_f32 v96, v96, v96
    v_lshlrev_b32 v96, 16, v96
    v_cvt_pk_bf16_f32 v128, v128, v128
    v_lshlrev_b32 v128, 16, v128
    v_mul_f32 v2, s6, v96
    v_exp_f32 v2, v2
    s_nop 0
    v_add_f32 v2, 1.0, v2
    v_rcp_f32 v2, v2
    s_nop 0
    v_mul_f32 v96, v96, v2
    v_cvt_pk_bf16_f32 v96, v96, v96
    v_lshlrev_b32 v96, 16, v96
    v_mul_f32 v96, v96, v128
    v_add_f32 v97, v97, v105
    v_add_f32 v2, v113, v121
    v_add_f32 v97, v97, v2
    v_add_f32 v129, v129, v137
    v_add_f32 v2, v145, v153
    v_add_f32 v129, v129, v2
    v_cvt_pk_bf16_f32 v97, v97, v97
    v_lshlrev_b32 v97, 16, v97
    v_cvt_pk_bf16_f32 v129, v129, v129
    v_lshlrev_b32 v129, 16, v129
    v_mul_f32 v2, s6, v97
    v_exp_f32 v2, v2
    s_nop 0
    v_add_f32 v2, 1.0, v2
    v_rcp_f32 v2, v2
    s_nop 0
    v_mul_f32 v97, v97, v2
    v_cvt_pk_bf16_f32 v97, v97, v97
    v_lshlrev_b32 v97, 16, v97
    v_mul_f32 v97, v97, v129
    v_add_f32 v98, v98, v106
    v_add_f32 v2, v114, v122
    v_add_f32 v98, v98, v2
    v_add_f32 v130, v130, v138
    v_add_f32 v2, v146, v154
    v_add_f32 v130, v130, v2
    v_cvt_pk_bf16_f32 v98, v98, v98
    v_lshlrev_b32 v98, 16, v98
    v_cvt_pk_bf16_f32 v130, v130, v130
    v_lshlrev_b32 v130, 16, v130
    v_mul_f32 v2, s6, v98
    v_exp_f32 v2, v2
    s_nop 0
    v_add_f32 v2, 1.0, v2
    v_rcp_f32 v2, v2
    s_nop 0
    v_mul_f32 v98, v98, v2
    v_cvt_pk_bf16_f32 v98, v98, v98
    v_lshlrev_b32 v98, 16, v98
    v_mul_f32 v98, v98, v130
    v_add_f32 v99, v99, v107
    v_add_f32 v2, v115, v123
    v_add_f32 v99, v99, v2
    v_add_f32 v131, v131, v139
    v_add_f32 v2, v147, v155
    v_add_f32 v131, v131, v2
    v_cvt_pk_bf16_f32 v99, v99, v99
    v_lshlrev_b32 v99, 16, v99
    v_cvt_pk_bf16_f32 v131, v131, v131
    v_lshlrev_b32 v131, 16, v131
    v_mul_f32 v2, s6, v99
    v_exp_f32 v2, v2
    s_nop 0
    v_add_f32 v2, 1.0, v2
    v_rcp_f32 v2, v2
    s_nop 0
    v_mul_f32 v99, v99, v2
    v_cvt_pk_bf16_f32 v99, v99, v99
    v_lshlrev_b32 v99, 16, v99
    v_mul_f32 v99, v99, v131
    v_add_f32 v100, v100, v108
    v_add_f32 v2, v116, v124
    v_add_f32 v100, v100, v2
    v_add_f32 v132, v132, v140
    v_add_f32 v2, v148, v156
    v_add_f32 v132, v132, v2
    v_cvt_pk_bf16_f32 v100, v100, v100
    v_lshlrev_b32 v100, 16, v100
    v_cvt_pk_bf16_f32 v132, v132, v132
    v_lshlrev_b32 v132, 16, v132
    v_mul_f32 v2, s6, v100
    v_exp_f32 v2, v2
    s_nop 0
    v_add_f32 v2, 1.0, v2
    v_rcp_f32 v2, v2
    s_nop 0
    v_mul_f32 v100, v100, v2
    v_cvt_pk_bf16_f32 v100, v100, v100
    v_lshlrev_b32 v100, 16, v100
    v_mul_f32 v100, v100, v132
    v_add_f32 v101, v101, v109
    v_add_f32 v2, v117, v125
    v_add_f32 v101, v101, v2
    v_add_f32 v133, v133, v141
    v_add_f32 v2, v149, v157
    v_add_f32 v133, v133, v2
    v_cvt_pk_bf16_f32 v101, v101, v101
    v_lshlrev_b32 v101, 16, v101
    v_cvt_pk_bf16_f32 v133, v133, v133
    v_lshlrev_b32 v133, 16, v133
    v_mul_f32 v2, s6, v101
    v_exp_f32 v2, v2
    s_nop 0
    v_add_f32 v2, 1.0, v2
    v_rcp_f32 v2, v2
    s_nop 0
    v_mul_f32 v101, v101, v2
    v_cvt_pk_bf16_f32 v101, v101, v101
    v_lshlrev_b32 v101, 16, v101
    v_mul_f32 v101, v101, v133
    v_add_f32 v102, v102, v110
    v_add_f32 v2, v118, v126
    v_add_f32 v102, v102, v2
    v_add_f32 v134, v134, v142
    v_add_f32 v2, v150, v158
    v_add_f32 v134, v134, v2
    v_cvt_pk_bf16_f32 v102, v102, v102
    v_lshlrev_b32 v102, 16, v102
    v_cvt_pk_bf16_f32 v134, v134, v134
    v_lshlrev_b32 v134, 16, v134
    v_mul_f32 v2, s6, v102
    v_exp_f32 v2, v2
    s_nop 0
    v_add_f32 v2, 1.0, v2
    v_rcp_f32 v2, v2
    s_nop 0
    v_mul_f32 v102, v102, v2
    v_cvt_pk_bf16_f32 v102, v102, v102
    v_lshlrev_b32 v102, 16, v102
    v_mul_f32 v102, v102, v134
    v_add_f32 v103, v103, v111
    v_add_f32 v2, v119, v127
    v_add_f32 v103, v103, v2
    v_add_f32 v135, v135, v143
    v_add_f32 v2, v151, v159
    v_add_f32 v135, v135, v2
    v_cvt_pk_bf16_f32 v103, v103, v103
    v_lshlrev_b32 v103, 16, v103
    v_cvt_pk_bf16_f32 v135, v135, v135
    v_lshlrev_b32 v135, 16, v135
    v_mul_f32 v2, s6, v103
    v_exp_f32 v2, v2
    s_nop 0
    v_add_f32 v2, 1.0, v2
    v_rcp_f32 v2, v2
    s_nop 0
    v_mul_f32 v103, v103, v2
    v_cvt_pk_bf16_f32 v103, v103, v103
    v_lshlrev_b32 v103, 16, v103
    v_mul_f32 v103, v103, v135
    v_cvt_pk_bf16_f32 v24, v96, v97
    v_cvt_pk_bf16_f32 v25, v98, v99
    v_cvt_pk_bf16_f32 v26, v100, v101
    v_cvt_pk_bf16_f32 v27, v102, v103
    s_waitcnt lgkmcnt(0)
    s_nop 1
    v_mfma_f32_16x16x32_bf16 v[68:71], v[48:51], v[24:27], 0
    v_mfma_f32_16x16x32_bf16 v[72:75], v[52:55], v[24:27], 0
    v_mfma_f32_16x16x32_bf16 v[76:79], v[56:59], v[24:27], 0
    v_mfma_f32_16x16x32_bf16 v[80:83], v[60:63], v[24:27], 0
    v_mfma_f32_16x16x32_bf16 v[84:87], v[64:67], v[24:27], 0
    v_and_b32 v2, 15, v1
    v_mul_u32_u24 v3, 2560, v2
    v_lshl_add_u32 v3, v7, 4, v3
    s_mul_i32 s6, s60, 20480
    s_mul_i32 s7, s3, 320
    s_add_u32 s6, s6, s7
    s_add_u32 s6, s6, 2686976
    v_cmp_gt_u32 vcc, 8, v2
    s_and_saveexec_b64 s[74:75], vcc
    s_nop 7
    buffer_store_dwordx4 v[68:71], v3, s[8:11], s6 offen offset:0
    buffer_store_dwordx4 v[72:75], v3, s[8:11], s6 offen offset:64
    buffer_store_dwordx4 v[76:79], v3, s[8:11], s6 offen offset:128
    buffer_store_dwordx4 v[80:83], v3, s[8:11], s6 offen offset:192
    buffer_store_dwordx4 v[84:87], v3, s[8:11], s6 offen offset:256
L_k2_end:
    s_endpgm
.text
.globl k3_kernel
.p2align 8
.type k3_kernel,@function
k3_kernel:
    s_cmp_ge_u32 s2, 256
    s_cbranch_scc1 L_k3_end
    s_load_dwordx16 s[32:47], s[0:1], 0
    s_load_dwordx8 s[48:55], s[0:1], 64
    s_load_dwordx4 s[56:59], s[0:1], 96
    v_lshrrev_b32 v2, 6, v0
    v_and_b32 v1, 63, v0
    v_readfirstlane_b32 s3, v2
    s_and_b32 s6, s2, 7
    s_lshl_b32 s6, s6, 2
    s_lshr_b32 s7, s2, 3
    s_and_b32 s7, s7, 3
    s_add_u32 s4, s6, s7
    s_lshr_b32 s5, s2, 5
    s_waitcnt lgkmcnt(0)
    s_mov_b32 s8, s58
    s_mov_b32 s9, s59
    s_mov_b32 s10, 0x4000000
    s_mov_b32 s11, 0x20000
    s_mov_b32 s12, s32
    s_mov_b32 s13, s33
    s_mov_b32 s14, 0x280000
    s_mov_b32 s15, 0x20000
    s_mov_b32 s16, s54
    s_mov_b32 s17, s55
    s_mov_b32 s18, 0x280000
    s_mov_b32 s19, 0x20000
    v_lshlrev_b32 v10, 4, v1
    v_add_u32 v11, 131072, v10
    v_add_u32 v12, 262144, v10
    v_add_u32 v13, 393216, v10
    v_add_u32 v14, 4096, v10
    s_lshl_b32 s60, s4, 19
    s_lshl_b32 s6, s3, 14
    s_add_u32 s60, s60, s6
    s_add_u32 s60, s60, 50331648
    s_mul_i32 s61, s3, 655360
    s_mul_i32 s6, s5, 5120
    s_add_u32 s61, s61, s6
    s_add_u32 s61, s61, 4194304
    s_add_u32 s6, s58, 0x3a0000
    s_addc_u32 s7, s59, 0
    s_load_dwordx8 s[84:91], s[6:7], 0
    s_waitcnt lgkmcnt(0)
    s_mov_b32 s63, s84
    s_cmp_eq_u32 s3, 1
    s_cselect_b32 s63, s85, s63
    s_cmp_eq_u32 s3, 2
    s_cselect_b32 s63, s86, s63
    s_cmp_eq_u32 s3, 3
    s_cselect_b32 s63, s87, s63
    s_cmp_eq_u32 s3, 4
    s_cselect_b32 s63, s88, s63
    s_cmp_eq_u32 s3, 5
    s_cselect_b32 s63, s89, s63
    s_cmp_eq_u32 s3, 6
    s_cselect_b32 s63, s90, s63
    s_cmp_eq_u32 s3, 7
    s_cselect_b32 s63, s91, s63
    s_and_b32 s6, s63, 0x7ff
    s_sub_u32 s6, 0x7ff, s6
    s_lshr_b32 s6, s6, 6
    s_cmp_lg_u32 s6, s4
    s_cbranch_scc1 L_k3_noy
    v_mul_u32_u24 v2, 13, v1
    v_lshrrev_b32 v2, 8, v2
    v_mul_u32_u24 v3, 20, v2
    v_sub_u32 v3, v1, v3
    s_mov_b32 s6, 368640
    v_mul_lo_u32 v4, v2, s6
    v_lshl_add_u32 v4, v3, 4, v4
    v_cmp_lt_u32 vcc, 59, v1
    v_mov_b32 v5, 0x4000000
    s_nop 0
    v_cndmask_b32 v4, v4, v5, vcc
    s_mul_i32 s6, s3, 2560
    s_mul_i32 s7, s5, 320
    s_add_u32 s6, s6, s7
    s_add_u32 s6, s6, 2686976
    buffer_load_dwordx4 v[176:179], v4, s[8:11], s6 offen
    s_add_u32 s6, s6, 20480
    buffer_load_dwordx4 v[180:183], v4, s[8:11], s6 offen
    s_add_u32 s6, s6, 20480
    buffer_load_dwordx4 v[184:187], v4, s[8:11], s6 offen
    s_add_u32 s6, s6, 20480
    buffer_load_dwordx4 v[188:191], v4, s[8:11], s6 offen
    s_add_u32 s6, s6, 20480
    buffer_load_dwordx4 v[192:195], v4, s[8:11], s6 offen
    s_add_u32 s6, s6, 20480
    buffer_load_dwordx4 v[196:199], v4, s[8:11], s6 offen
    s_add_u32 s6, s6, 20480
    buffer_load_dwordx4 v[200:203], v4, s[8:11], s6 offen
    s_add_u32 s6, s6, 20480
    buffer_load_dwordx4 v[204:207], v4, s[8:11], s6 offen
    s_add_u32 s6, s6, 20480
    buffer_load_dwordx4 v[208:211], v4, s[8:11], s6 offen
    s_add_u32 s6, s6, 20480
    buffer_load_dwordx4 v[212:215], v4, s[8:11], s6 offen
    s_add_u32 s6, s6, 20480
    buffer_load_dwordx4 v[216:219], v4, s[8:11], s6 offen
    s_add_u32 s6, s6, 20480
    buffer_load_dwordx4 v[220:223], v4, s[8:11], s6 offen
    s_add_u32 s6, s6, 20480
    buffer_load_dwordx4 v[224:227], v4, s[8:11], s6 offen
    s_add_u32 s6, s6, 20480
    buffer_load_dwordx4 v[228:231], v4, s[8:11], s6 offen
    s_add_u32 s6, s6, 20480
    buffer_load_dwordx4 v[232:235], v4, s[8:11], s6 offen
    s_add_u32 s6, s6, 20480
    buffer_load_dwordx4 v[236:239], v4, s[8:11], s6 offen
    s_add_u32 s6, s6, 20480
    buffer_load_dwordx4 v[240:243], v4, s[8:11], s6 offen
    s_add_u32 s6, s6, 20480
    buffer_load_dwordx4 v[244:247], v4, s[8:11], s6 offen
    s_add_u32 s6, s6, 20480
    s_waitcnt vmcnt(0)
    v_add_f32 v176, v176, v180
    v_add_f32 v177, v177, v181
    v_add_f32 v178, v178, v182
    v_add_f32 v179, v179, v183
    v_add_f32 v176, v176, v184
    v_add_f32 v177, v177, v185
    v_add_f32 v178, v178, v186
    v_add_f32 v179, v179, v187
    v_add_f32 v176, v176, v188
    v_add_f32 v177, v177, v189
    v_add_f32 v178, v178, v190
    v_add_f32 v179, v179, v191
    v_add_f32 v176, v176, v192
    v_add_f32 v177, v177, v193
    v_add_f32 v178, v178, v194
    v_add_f32 v179, v179, v195
    v_add_f32 v176, v176, v196
    v_add_f32 v177, v177, v197
    v_add_f32 v178, v178, v198
    v_add_f32 v179, v179, v199
    v_add_f32 v176, v176, v200
    v_add_f32 v177, v177, v201
    v_add_f32 v178, v178, v202
    v_add_f32 v179, v179, v203
    v_add_f32 v176, v176, v204
    v_add_f32 v177, v177, v205
    v_add_f32 v178, v178, v206
    v_add_f32 v179, v179, v207
    v_add_f32 v176, v176, v208
    v_add_f32 v177, v177, v209
    v_add_f32 v178, v178, v210
    v_add_f32 v179, v179, v211
    v_add_f32 v176, v176, v212
    v_add_f32 v177, v177, v213
    v_add_f32 v178, v178, v214
    v_add_f32 v179, v179, v215
    v_add_f32 v176, v176, v216
    v_add_f32 v177, v177, v217
    v_add_f32 v178, v178, v218
    v_add_f32 v179, v179, v219
    v_add_f32 v176, v176, v220
    v_add_f32 v177, v177, v221
    v_add_f32 v178, v178, v222
    v_add_f32 v179, v179, v223
    v_add_f32 v176, v176, v224
    v_add_f32 v177, v177, v225
    v_add_f32 v178, v178, v226
    v_add_f32 v179, v179, v227
    v_add_f32 v176, v176, v228
    v_add_f32 v177, v177, v229
    v_add_f32 v178, v178, v230
    v_add_f32 v179, v179, v231
    v_add_f32 v176, v176, v232
    v_add_f32 v177, v177, v233
    v_add_f32 v178, v178, v234
    v_add_f32 v179, v179, v235
    v_add_f32 v176, v176, v236
    v_add_f32 v177, v177, v237
    v_add_f32 v178, v178, v238
    v_add_f32 v179, v179, v239
    v_add_f32 v176, v176, v240
    v_add_f32 v177, v177, v241
    v_add_f32 v178, v178, v242
    v_add_f32 v179, v179, v243
    v_add_f32 v176, v176, v244
    v_add_f32 v177, v177, v245
    v_add_f32 v178, v178, v246
    v_add_f32 v179, v179, v247
    s_lshl_b32 s6, s3, 10
    s_add_u32 s6, s6, 81920
    v_add_u32 v4, s6, v10
    ds_write_b128 v4, v[176:179]
    s_waitcnt lgkmcnt(0)
L_k3_noy:
    v_and_b32 v2, 15, v1
    v_lshrrev_b32 v3, 4, v1
    s_and_b32 s6, s3, 3
    s_lshl_b32 s7, s4, 2
    s_add_u32 s64, s6, s7
    s_lshl_b32 s6, s64, 4
    v_add_u32 v28, s6, v2
    s_lshr_b32 s6, s3, 2
    s_mul_i32 s7, s5, 5
    s_add_u32 s65, s6, s7
    v_mul_u32_u24 v29, 1280, v28
    v_lshl_add_u32 v29, v3, 3, v29
    s_lshl_b32 s66, s65, 5
    v_lshrrev_b32 v4, 1, v3
    v_lshlrev_b32 v4, 8, v4
    v_lshl_add_u32 v4, v2, 4, v4
    v_and_b32 v5, 1, v3
    v_lshl_add_u32 v4, v5, 3, v4
    s_mul_i32 s6, s64, 20480
    s_lshl_b32 s7, s65, 9
    s_add_u32 s6, s6, s7
    buffer_load_dwordx2 v[16:17], v29, s[12:15], s66 offen offset:0
    buffer_load_dwordx2 v[22:23], v4, s[8:11], s6 offen offset:0
    buffer_load_dwordx2 v[18:19], v29, s[12:15], s66 offen offset:64
    buffer_load_dwordx2 v[24:25], v4, s[8:11], s6 offen offset:1024
    buffer_load_dwordx2 v[20:21], v29, s[12:15], s66 offen offset:128
    buffer_load_dwordx2 v[26:27], v4, s[8:11], s6 offen offset:2048
    buffer_load_dwordx4 v[48:51], v10, s[8:11], s61 offen offset:0
    buffer_load_dwordx4 v[52:55], v10, s[8:11], s61 offen offset:1024
    buffer_load_dwordx4 v[56:59], v10, s[8:11], s61 offen offset:2048
    buffer_load_dwordx4 v[60:63], v10, s[8:11], s61 offen offset:3072
    buffer_load_dwordx4 v[64:67], v14, s[8:11], s61 offen offset:0
    s_add_u32 s61, s61, 40960
    buffer_load_dwordx4 v[32:35], v10, s[8:11], s60 offen offset:0
    buffer_load_dwordx4 v[36:39], v11, s[8:11], s60 offen offset:0
    buffer_load_dwordx4 v[40:43], v12, s[8:11], s60 offen offset:0
    buffer_load_dwordx4 v[44:47], v13, s[8:11], s60 offen offset:0
    buffer_load_dwordx4 v[84:87], v10, s[8:11], s61 offen offset:0
    buffer_load_dwordx4 v[88:91], v10, s[8:11], s61 offen offset:1024
    buffer_load_dwordx4 v[92:95], v10, s[8:11], s61 offen offset:2048
    buffer_load_dwordx4 v[96:99], v10, s[8:11], s61 offen offset:3072
    buffer_load_dwordx4 v[100:103], v14, s[8:11], s61 offen offset:0
    s_add_u32 s61, s61, 40960
    buffer_load_dwordx4 v[68:71], v10, s[8:11], s60 offen offset:1024
    buffer_load_dwordx4 v[72:75], v11, s[8:11], s60 offen offset:1024
    buffer_load_dwordx4 v[76:79], v12, s[8:11], s60 offen offset:1024
    buffer_load_dwordx4 v[80:83], v13, s[8:11], s60 offen offset:1024
    buffer_load_dwordx4 v[120:123], v10, s[8:11], s61 offen offset:0
    buffer_load_dwordx4 v[124:127], v10, s[8:11], s61 offen offset:1024
    buffer_load_dwordx4 v[128:131], v10, s[8:11], s61 offen offset:2048
    buffer_load_dwordx4 v[132:135], v10, s[8:11], s61 offen offset:3072
    buffer_load_dwordx4 v[136:139], v14, s[8:11], s61 offen offset:0
    s_add_u32 s61, s61, 40960
    buffer_load_dwordx4 v[104:107], v10, s[8:11], s60 offen offset:2048
    buffer_load_dwordx4 v[108:111], v11, s[8:11], s60 offen offset:2048
    buffer_load_dwordx4 v[112:115], v12, s[8:11], s60 offen offset:2048
    buffer_load_dwordx4 v[116:119], v13, s[8:11], s60 offen offset:2048
    buffer_load_dwordx4 v[156:159], v10, s[8:11], s61 offen offset:0
    buffer_load_dwordx4 v[160:163], v10, s[8:11], s61 offen offset:1024
    buffer_load_dwordx4 v[164:167], v10, s[8:11], s61 offen offset:2048
    buffer_load_dwordx4 v[168:171], v10, s[8:11], s61 offen offset:3072
    buffer_load_dwordx4 v[172:175], v14, s[8:11], s61 offen offset:0
    s_add_u32 s61, s61, 40960
    buffer_load_dwordx4 v[140:143], v10, s[8:11], s60 offen offset:3072
    buffer_load_dwordx4 v[144:147], v11, s[8:11], s60 offen offset:3072
    buffer_load_dwordx4 v[148:151], v12, s[8:11], s60 offen offset:3072
    buffer_load_dwordx4 v[152:155], v13, s[8:11], s60 offen offset:3072
    v_mov_b32 v176, 0
    v_mov_b32 v177, 0
    v_mov_b32 v178, 0
    v_mov_b32 v179, 0
    v_mov_b32 v180, 0
    v_mov_b32 v181, 0
    v_mov_b32 v182, 0
    v_mov_b32 v183, 0
    v_mov_b32 v184, 0
    v_mov_b32 v185, 0
    v_mov_b32 v186, 0
    v_mov_b32 v187, 0
    v_mov_b32 v188, 0
    v_mov_b32 v189, 0
    v_mov_b32 v190, 0
    v_mov_b32 v191, 0
    v_mov_b32 v192, 0
    v_mov_b32 v193, 0
    v_mov_b32 v194, 0
    v_mov_b32 v195, 0
    v_mov_b32 v196, 0
    v_mov_b32 v197, 0
    v_mov_b32 v198, 0
    v_mov_b32 v199, 0
    v_mov_b32 v200, 0
    v_mov_b32 v201, 0
    v_mov_b32 v202, 0
    v_mov_b32 v203, 0
    v_mov_b32 v204, 0
    v_mov_b32 v205, 0
    v_mov_b32 v206, 0
    v_mov_b32 v207, 0
    v_mov_b32 v208, 0
    v_mov_b32 v209, 0
    v_mov_b32 v210, 0
    v_mov_b32 v211, 0
    v_mov_b32 v212, 0
    v_mov_b32 v213, 0
    v_mov_b32 v214, 0
    v_mov_b32 v215, 0
    v_mov_b32 v216, 0
    v_mov_b32 v217, 0
    v_mov_b32 v218, 0
    v_mov_b32 v219, 0
    v_mov_b32 v220, 0
    v_mov_b32 v221, 0
    v_mov_b32 v222, 0
    v_mov_b32 v223, 0
    v_mov_b32 v224, 0
    v_mov_b32 v225, 0
    v_mov_b32 v226, 0
    v_mov_b32 v227, 0
    v_mov_b32 v228, 0
    v_mov_b32 v229, 0
    v_mov_b32 v230, 0
    v_mov_b32 v231, 0
    v_mov_b32 v232, 0
    v_mov_b32 v233, 0
    v_mov_b32 v234, 0
    v_mov_b32 v235, 0
    v_mov_b32 v236, 0
    v_mov_b32 v237, 0
    v_mov_b32 v238, 0
    v_mov_b32 v239, 0
    v_mov_b32 v240, 0
    v_mov_b32 v241, 0
    v_mov_b32 v242, 0
    v_mov_b32 v243, 0
    v_mov_b32 v244, 0
    v_mov_b32 v245, 0
    v_mov_b32 v246, 0
    v_mov_b32 v247, 0
    v_mov_b32 v248, 0
    v_mov_b32 v249, 0
    v_mov_b32 v250, 0
    v_mov_b32 v251, 0
    v_mov_b32 v252, 0
    v_mov_b32 v253, 0
    v_mov_b32 v254, 0
    v_mov_b32 v255, 0
    s_mov_b32 s62, 0
L_k3_loop:
    s_add_u32 s60, s60, 4096
    s_cmp_ge_u32 s62, 3
    s_cselect_b32 s60, 0x4000000, s60
    s_cselect_b32 s61, 0x4000000, s61
    s_waitcnt vmcnt(27)
    v_mfma_f32_16x16x32_bf16 v[176:179], v[48:51], v[32:35], v[176:179]
    v_mfma_f32_16x16x32_bf16 v[180:183], v[48:51], v[36:39], v[180:183]
    v_mfma_f32_16x16x32_bf16 v[184:187], v[48:51], v[40:43], v[184:187]
    v_mfma_f32_16x16x32_bf16 v[188:191], v[48:51], v[44:47], v[188:191]
    v_mfma_f32_16x16x32_bf16 v[192:195], v[52:55], v[32:35], v[192:195]
    v_mfma_f32_16x16x32_bf16 v[196:199], v[52:55], v[36:39], v[196:199]
    v_mfma_f32_16x16x32_bf16 v[200:203], v[52:55], v[40:43], v[200:203]
    v_mfma_f32_16x16x32_bf16 v[204:207], v[52:55], v[44:47], v[204:207]
    v_mfma_f32_16x16x32_bf16 v[208:211], v[56:59], v[32:35], v[208:211]
    v_mfma_f32_16x16x32_bf16 v[212:215], v[56:59], v[36:39], v[212:215]
    v_mfma_f32_16x16x32_bf16 v[216:219], v[56:59], v[40:43], v[216:219]
    v_mfma_f32_16x16x32_bf16 v[220:223], v[56:59], v[44:47], v[220:223]
    v_mfma_f32_16x16x32_bf16 v[224:227], v[60:63], v[32:35], v[224:227]
    v_mfma_f32_16x16x32_bf16 v[228:231], v[60:63], v[36:39], v[228:231]
    v_mfma_f32_16x16x32_bf16 v[232:235], v[60:63], v[40:43], v[232:235]
    v_mfma_f32_16x16x32_bf16 v[236:239], v[60:63], v[44:47], v[236:239]
    v_mfma_f32_16x16x32_bf16 v[240:243], v[64:67], v[32:35], v[240:243]
    v_mfma_f32_16x16x32_bf16 v[244:247], v[64:67], v[36:39], v[244:247]
    v_mfma_f32_16x16x32_bf16 v[248:251], v[64:67], v[40:43], v[248:251]
    v_mfma_f32_16x16x32_bf16 v[252:255], v[64:67], v[44:47], v[252:255]
    buffer_load_dwordx4 v[48:51], v10, s[8:11], s61 offen offset:0
    buffer_load_dwordx4 v[52:55], v10, s[8:11], s61 offen offset:1024
    buffer_load_dwordx4 v[56:59], v10, s[8:11], s61 offen offset:2048
    buffer_load_dwordx4 v[60:63], v10, s[8:11], s61 offen offset:3072
    buffer_load_dwordx4 v[64:67], v14, s[8:11], s61 offen offset:0
    s_add_u32 s61, s61, 40960
    buffer_load_dwordx4 v[32:35], v10, s[8:11], s60 offen offset:0
    buffer_load_dwordx4 v[36:39], v11, s[8:11], s60 offen offset:0
    buffer_load_dwordx4 v[40:43], v12, s[8:11], s60 offen offset:0
    buffer_load_dwordx4 v[44:47], v13, s[8:11], s60 offen offset:0
    s_waitcnt vmcnt(27)
    v_mfma_f32_16x16x32_bf16 v[176:179], v[84:87], v[68:71], v[176:179]
    v_mfma_f32_16x16x32_bf16 v[180:183], v[84:87], v[72:75], v[180:183]
    v_mfma_f32_16x16x32_bf16 v[184:187], v[84:87], v[76:79], v[184:187]
    v_mfma_f32_16x16x32_bf16 v[188:191], v[84:87], v[80:83], v[188:191]
    v_mfma_f32_16x16x32_bf16 v[192:195], v[88:91], v[68:71], v[192:195]
    v_mfma_f32_16x16x32_bf16 v[196:199], v[88:91], v[72:75], v[196:199]
    v_mfma_f32_16x16x32_bf16 v[200:203], v[88:91], v[76:79], v[200:203]
    v_mfma_f32_16x16x32_bf16 v[204:207], v[88:91], v[80:83], v[204:207]
    v_mfma_f32_16x16x32_bf16 v[208:211], v[92:95], v[68:71], v[208:211]
    v_mfma_f32_16x16x32_bf16 v[212:215], v[92:95], v[72:75], v[212:215]
    v_mfma_f32_16x16x32_bf16 v[216:219], v[92:95], v[76:79], v[216:219]
    v_mfma_f32_16x16x32_bf16 v[220:223], v[92:95], v[80:83], v[220:223]
    v_mfma_f32_16x16x32_bf16 v[224:227], v[96:99], v[68:71], v[224:227]
    v_mfma_f32_16x16x32_bf16 v[228:231], v[96:99], v[72:75], v[228:231]
    v_mfma_f32_16x16x32_bf16 v[232:235], v[96:99], v[76:79], v[232:235]
    v_mfma_f32_16x16x32_bf16 v[236:239], v[96:99], v[80:83], v[236:239]
    v_mfma_f32_16x16x32_bf16 v[240:243], v[100:103], v[68:71], v[240:243]
    v_mfma_f32_16x16x32_bf16 v[244:247], v[100:103], v[72:75], v[244:247]
    v_mfma_f32_16x16x32_bf16 v[248:251], v[100:103], v[76:79], v[248:251]
    v_mfma_f32_16x16x32_bf16 v[252:255], v[100:103], v[80:83], v[252:255]
    buffer_load_dwordx4 v[84:87], v10, s[8:11], s61 offen offset:0
    buffer_load_dwordx4 v[88:91], v10, s[8:11], s61 offen offset:1024
    buffer_load_dwordx4 v[92:95], v10, s[8:11], s61 offen offset:2048
    buffer_load_dwordx4 v[96:99], v10, s[8:11], s61 offen offset:3072
    buffer_load_dwordx4 v[100:103], v14, s[8:11], s61 offen offset:0
    s_add_u32 s61, s61, 40960
    buffer_load_dwordx4 v[68:71], v10, s[8:11], s60 offen offset:1024
    buffer_load_dwordx4 v[72:75], v11, s[8:11], s60 offen offset:1024
    buffer_load_dwordx4 v[76:79], v12, s[8:11], s60 offen offset:1024
    buffer_load_dwordx4 v[80:83], v13, s[8:11], s60 offen offset:1024
    s_waitcnt vmcnt(27)
    v_mfma_f32_16x16x32_bf16 v[176:179], v[120:123], v[104:107], v[176:179]
    v_mfma_f32_16x16x32_bf16 v[180:183], v[120:123], v[108:111], v[180:183]
    v_mfma_f32_16x16x32_bf16 v[184:187], v[120:123], v[112:115], v[184:187]
    v_mfma_f32_16x16x32_bf16 v[188:191], v[120:123], v[116:119], v[188:191]
    v_mfma_f32_16x16x32_bf16 v[192:195], v[124:127], v[104:107], v[192:195]
    v_mfma_f32_16x16x32_bf16 v[196:199], v[124:127], v[108:111], v[196:199]
    v_mfma_f32_16x16x32_bf16 v[200:203], v[124:127], v[112:115], v[200:203]
    v_mfma_f32_16x16x32_bf16 v[204:207], v[124:127], v[116:119], v[204:207]
    v_mfma_f32_16x16x32_bf16 v[208:211], v[128:131], v[104:107], v[208:211]
    v_mfma_f32_16x16x32_bf16 v[212:215], v[128:131], v[108:111], v[212:215]
    v_mfma_f32_16x16x32_bf16 v[216:219], v[128:131], v[112:115], v[216:219]
    v_mfma_f32_16x16x32_bf16 v[220:223], v[128:131], v[116:119], v[220:223]
    v_mfma_f32_16x16x32_bf16 v[224:227], v[132:135], v[104:107], v[224:227]
    v_mfma_f32_16x16x32_bf16 v[228:231], v[132:135], v[108:111], v[228:231]
    v_mfma_f32_16x16x32_bf16 v[232:235], v[132:135], v[112:115], v[232:235]
    v_mfma_f32_16x16x32_bf16 v[236:239], v[132:135], v[116:119], v[236:239]
    v_mfma_f32_16x16x32_bf16 v[240:243], v[136:139], v[104:107], v[240:243]
    v_mfma_f32_16x16x32_bf16 v[244:247], v[136:139], v[108:111], v[244:247]
    v_mfma_f32_16x16x32_bf16 v[248:251], v[136:139], v[112:115], v[248:251]
    v_mfma_f32_16x16x32_bf16 v[252:255], v[136:139], v[116:119], v[252:255]
    buffer_load_dwordx4 v[120:123], v10, s[8:11], s61 offen offset:0
    buffer_load_dwordx4 v[124:127], v10, s[8:11], s61 offen offset:1024
    buffer_load_dwordx4 v[128:131], v10, s[8:11], s61 offen offset:2048
    buffer_load_dwordx4 v[132:135], v10, s[8:11], s61 offen offset:3072
    buffer_load_dwordx4 v[136:139], v14, s[8:11], s61 offen offset:0
    s_add_u32 s61, s61, 40960
    buffer_load_dwordx4 v[104:107], v10, s[8:11], s60 offen offset:2048
    buffer_load_dwordx4 v[108:111], v11, s[8:11], s60 offen offset:2048
    buffer_load_dwordx4 v[112:115], v12, s[8:11], s60 offen offset:2048
    buffer_load_dwordx4 v[116:119], v13, s[8:11], s60 offen offset:2048
    s_waitcnt vmcnt(27)
    v_mfma_f32_16x16x32_bf16 v[176:179], v[156:159], v[140:143], v[176:179]
    v_mfma_f32_16x16x32_bf16 v[180:183], v[156:159], v[144:147], v[180:183]
    v_mfma_f32_16x16x32_bf16 v[184:187], v[156:159], v[148:151], v[184:187]
    v_mfma_f32_16x16x32_bf16 v[188:191], v[156:159], v[152:155], v[188:191]
    v_mfma_f32_16x16x32_bf16 v[192:195], v[160:163], v[140:143], v[192:195]
    v_mfma_f32_16x16x32_bf16 v[196:199], v[160:163], v[144:147], v[196:199]
    v_mfma_f32_16x16x32_bf16 v[200:203], v[160:163], v[148:151], v[200:203]
    v_mfma_f32_16x16x32_bf16 v[204:207], v[160:163], v[152:155], v[204:207]
    v_mfma_f32_16x16x32_bf16 v[208:211], v[164:167], v[140:143], v[208:211]
    v_mfma_f32_16x16x32_bf16 v[212:215], v[164:167], v[144:147], v[212:215]
    v_mfma_f32_16x16x32_bf16 v[216:219], v[164:167], v[148:151], v[216:219]
    v_mfma_f32_16x16x32_bf16 v[220:223], v[164:167], v[152:155], v[220:223]
    v_mfma_f32_16x16x32_bf16 v[224:227], v[168:171], v[140:143], v[224:227]
    v_mfma_f32_16x16x32_bf16 v[228:231], v[168:171], v[144:147], v[228:231]
    v_mfma_f32_16x16x32_bf16 v[232:235], v[168:171], v[148:151], v[232:235]
    v_mfma_f32_16x16x32_bf16 v[236:239], v[168:171], v[152:155], v[236:239]
    v_mfma_f32_16x16x32_bf16 v[240:243], v[172:175], v[140:143], v[240:243]
    v_mfma_f32_16x16x32_bf16 v[244:247], v[172:175], v[144:147], v[244:247]
    v_mfma_f32_16x16x32_bf16 v[248:251], v[172:175], v[148:151], v[248:251]
    v_mfma_f32_16x16x32_bf16 v[252:255], v[172:175], v[152:155], v[252:255]
    buffer_load_dwordx4 v[156:159], v10, s[8:11], s61 offen offset:0
    buffer_load_dwordx4 v[160:163], v10, s[8:11], s61 offen offset:1024
    buffer_load_dwordx4 v[164:167], v10, s[8:11], s61 offen offset:2048
    buffer_load_dwordx4 v[168:171], v10, s[8:11], s61 offen offset:3072
    buffer_load_dwordx4 v[172:175], v14, s[8:11], s61 offen offset:0
    s_add_u32 s61, s61, 40960
    buffer_load_dwordx4 v[140:143], v10, s[8:11], s60 offen offset:3072
    buffer_load_dwordx4 v[144:147], v11, s[8:11], s60 offen offset:3072
    buffer_load_dwordx4 v[148:151], v12, s[8:11], s60 offen offset:3072
    buffer_load_dwordx4 v[152:155], v13, s[8:11], s60 offen offset:3072
    s_add_u32 s62, s62, 1
    s_cmp_lt_u32 s62, 4
    s_cbranch_scc1 L_k3_loop
    s_and_b32 s6, s3, 3
    s_mul_i32 s6, s6, 20480
    v_add_u32 v2, s6, v10
    s_nop 7
    s_cmp_lt_u32 s3, 4
    s_cbranch_scc1 L_k3_r1
    ds_write_b128 v2, v[176:179] offset:0
    ds_write_b128 v2, v[180:183] offset:1024
    ds_write_b128 v2, v[184:187] offset:2048
    ds_write_b128 v2, v[188:191] offset:3072
    ds_write_b128 v2, v[192:195] offset:4096
    ds_write_b128 v2, v[196:199] offset:5120
    ds_write_b128 v2, v[200:203] offset:6144
    ds_write_b128 v2, v[204:207] offset:7168
    ds_write_b128 v2, v[208:211] offset:8192
    ds_write_b128 v2, v[212:215] offset:9216
    ds_write_b128 v2, v[216:219] offset:10240
    ds_write_b128 v2, v[220:223] offset:11264
    ds_write_b128 v2, v[224:227] offset:12288
    ds_write_b128 v2, v[228:231] offset:13312
    ds_write_b128 v2, v[232:235] offset:14336
    ds_write_b128 v2, v[236:239] offset:15360
    ds_write_b128 v2, v[240:243] offset:16384
    ds_write_b128 v2, v[244:247] offset:17408
    ds_write_b128 v2, v[248:251] offset:18432
    ds_write_b128 v2, v[252:255] offset:19456
    s_waitcnt lgkmcnt(0)
    s_barrier
    s_branch L_k3_r2
L_k3_r1:
    s_waitcnt vmcnt(0)
    s_barrier
    ds_read_b128 v[32:35], v2 offset:0
    ds_read_b128 v[36:39], v2 offset:1024
    ds_read_b128 v[40:43], v2 offset:2048
    ds_read_b128 v[44:47], v2 offset:3072
    ds_read_b128 v[48:51], v2 offset:4096
    ds_read_b128 v[52:55], v2 offset:5120
    ds_read_b128 v[56:59], v2 offset:6144
    ds_read_b128 v[60:63], v2 offset:7168
    ds_read_b128 v[64:67], v2 offset:8192
    ds_read_b128 v[68:71], v2 offset:9216
    ds_read_b128 v[72:75], v2 offset:10240
    ds_read_b128 v[76:79], v2 offset:11264
    s_waitcnt lgkmcnt(11)
    v_add_f32 v176, v176, v32
    v_add_f32 v177, v177, v33
    v_add_f32 v178, v178, v34
    v_add_f32 v179, v179, v35
    s_waitcnt lgkmcnt(10)
    v_add_f32 v180, v180, v36
    v_add_f32 v181, v181, v37
    v_add_f32 v182, v182, v38
    v_add_f32 v183, v183, v39
    s_waitcnt lgkmcnt(9)
    v_add_f32 v184, v184, v40
    v_add_f32 v185, v185, v41
    v_add_f32 v186, v186, v42
    v_add_f32 v187, v187, v43
    s_waitcnt lgkmcnt(8)
    v_add_f32 v188, v188, v44
    v_add_f32 v189, v189, v45
    v_add_f32 v190, v190, v46
    v_add_f32 v191, v191, v47
    ds_read_b128 v[80:83], v2 offset:12288
    ds_read_b128 v[84:87], v2 offset:13312
    ds_read_b128 v[88:91], v2 offset:14336
    ds_read_b128 v[92:95], v2 offset:15360
    ds_read_b128 v[96:99], v2 offset:16384
    ds_read_b128 v[100:103], v2 offset:17408
    ds_read_b128 v[104:107], v2 offset:18432
    ds_read_b128 v[108:111], v2 offset:19456
    s_waitcnt lgkmcnt(15)
    v_add_f32 v192, v192, v48
    v_add_f32 v193, v193, v49
    v_add_f32 v194, v194, v50
    v_add_f32 v195, v195, v51
    s_waitcnt lgkmcnt(14)
    v_add_f32 v196, v196, v52
    v_add_f32 v197, v197, v53
    v_add_f32 v198, v198, v54
    v_add_f32 v199, v199, v55
    s_waitcnt lgkmcnt(13)
    v_add_f32 v200, v200, v56
    v_add_f32 v201, v201, v57
    v_add_f32 v202, v202, v58
    v_add_f32 v203, v203, v59
    s_waitcnt lgkmcnt(12)
    v_add_f32 v204, v204, v60
    v_add_f32 v205, v205, v61
    v_add_f32 v206, v206, v62
    v_add_f32 v207, v207, v63
    s_waitcnt lgkmcnt(11)
    v_add_f32 v208, v208, v64
    v_add_f32 v209, v209, v65
    v_add_f32 v210, v210, v66
    v_add_f32 v211, v211, v67
    s_waitcnt lgkmcnt(10)
    v_add_f32 v212, v212, v68
    v_add_f32 v213, v213, v69
    v_add_f32 v214, v214, v70
    v_add_f32 v215, v215, v71
    s_waitcnt lgkmcnt(9)
    v_add_f32 v216, v216, v72
    v_add_f32 v217, v217, v73
    v_add_f32 v218, v218, v74
    v_add_f32 v219, v219, v75
    s_waitcnt lgkmcnt(8)
    v_add_f32 v220, v220, v76
    v_add_f32 v221, v221, v77
    v_add_f32 v222, v222, v78
    v_add_f32 v223, v223, v79
    s_waitcnt lgkmcnt(7)
    v_add_f32 v224, v224, v80
    v_add_f32 v225, v225, v81
    v_add_f32 v226, v226, v82
    v_add_f32 v227, v227, v83
    s_waitcnt lgkmcnt(6)
    v_add_f32 v228, v228, v84
    v_add_f32 v229, v229, v85
    v_add_f32 v230, v230, v86
    v_add_f32 v231, v231, v87
    s_waitcnt lgkmcnt(5)
    v_add_f32 v232, v232, v88
    v_add_f32 v233, v233, v89
    v_add_f32 v234, v234, v90
    v_add_f32 v235, v235, v91
    s_waitcnt lgkmcnt(4)
    v_add_f32 v236, v236, v92
    v_add_f32 v237, v237, v93
    v_add_f32 v238, v238, v94
    v_add_f32 v239, v239, v95
    s_waitcnt lgkmcnt(3)
    v_add_f32 v240, v240, v96
    v_add_f32 v241, v241, v97
    v_add_f32 v242, v242, v98
    v_add_f32 v243, v243, v99
    s_waitcnt lgkmcnt(2)
    v_add_f32 v244, v244, v100
    v_add_f32 v245, v245, v101
    v_add_f32 v246, v246, v102
    v_add_f32 v247, v247, v103
    s_waitcnt lgkmcnt(1)
    v_add_f32 v248, v248, v104
    v_add_f32 v249, v249, v105
    v_add_f32 v250, v250, v106
    v_add_f32 v251, v251, v107
    s_waitcnt lgkmcnt(0)
    v_add_f32 v252, v252, v108
    v_add_f32 v253, v253, v109
    v_add_f32 v254, v254, v110
    v_add_f32 v255, v255, v111
    ds_write_b128 v2, v[176:179] offset:0
    ds_write_b128 v2, v[180:183] offset:1024
    ds_write_b128 v2, v[184:187] offset:2048
    ds_write_b128 v2, v[188:191] offset:3072
    ds_write_b128 v2, v[192:195] offset:4096
    ds_write_b128 v2, v[196:199] offset:5120
    ds_write_b128 v2, v[200:203] offset:6144
    ds_write_b128 v2, v[204:207] offset:7168
    ds_write_b128 v2, v[208:211] offset:8192
    ds_write_b128 v2, v[212:215] offset:9216
    ds_write_b128 v2, v[216:219] offset:10240
    ds_write_b128 v2, v[220:223] offset:11264
    ds_write_b128 v2, v[224:227] offset:12288
    ds_write_b128 v2, v[228:231] offset:13312
    ds_write_b128 v2, v[232:235] offset:14336
    ds_write_b128 v2, v[236:239] offset:15360
    ds_write_b128 v2, v[240:243] offset:16384
    ds_write_b128 v2, v[244:247] offset:17408
    ds_write_b128 v2, v[248:251] offset:18432
    ds_write_b128 v2, v[252:255] offset:19456
    s_waitcnt lgkmcnt(0)
L_k3_r2:
    s_waitcnt vmcnt(0)
    s_barrier
    s_lshl_b32 s6, s3, 10
    v_add_u32 v2, s6, v10
    v_sub_u32 v3, 0x7ff, v28
    v_mov_b32 v30, -1
    v_mov_b32 v31, 0
    s_and_b32 s6, s84, 0x7ff
    v_cmp_eq_u32 vcc, s6, v3
    v_mov_b32 v4, 0
    v_mov_b32 v5, s84
    v_cndmask_b32 v30, v30, v4, vcc
    v_cndmask_b32 v31, v31, v5, vcc
    s_and_b32 s6, s85, 0x7ff
    v_cmp_eq_u32 vcc, s6, v3
    v_mov_b32 v4, 1
    v_mov_b32 v5, s85
    v_cndmask_b32 v30, v30, v4, vcc
    v_cndmask_b32 v31, v31, v5, vcc
    s_and_b32 s6, s86, 0x7ff
    v_cmp_eq_u32 vcc, s6, v3
    v_mov_b32 v4, 2
    v_mov_b32 v5, s86
    v_cndmask_b32 v30, v30, v4, vcc
    v_cndmask_b32 v31, v31, v5, vcc
    s_and_b32 s6, s87, 0x7ff
    v_cmp_eq_u32 vcc, s6, v3
    v_mov_b32 v4, 3
    v_mov_b32 v5, s87
    v_cndmask_b32 v30, v30, v4, vcc
    v_cndmask_b32 v31, v31, v5, vcc
    s_and_b32 s6, s88, 0x7ff
    v_cmp_eq_u32 vcc, s6, v3
    v_mov_b32 v4, 4
    v_mov_b32 v5, s88
    v_cndmask_b32 v30, v30, v4, vcc
    v_cndmask_b32 v31, v31, v5, vcc
    s_and_b32 s6, s89, 0x7ff
    v_cmp_eq_u32 vcc, s6, v3
    v_mov_b32 v4, 5
    v_mov_b32 v5, s89
    v_cndmask_b32 v30, v30, v4, vcc
    v_cndmask_b32 v31, v31, v5, vcc
    s_and_b32 s6, s90, 0x7ff
    v_cmp_eq_u32 vcc, s6, v3
    v_mov_b32 v4, 6
    v_mov_b32 v5, s90
    v_cndmask_b32 v30, v30, v4, vcc
    v_cndmask_b32 v31, v31, v5, vcc
    s_and_b32 s6, s91, 0x7ff
    v_cmp_eq_u32 vcc, s6, v3
    v_mov_b32 v4, 7
    v_mov_b32 v5, s91
    v_cndmask_b32 v30, v30, v4, vcc
    v_cndmask_b32 v31, v31, v5, vcc
    v_cmp_ne_u32 s[74:75], -1, v30
    v_lshrrev_b32 v31, 11, v31
    v_bfe_i32 v4, v31, 15, 1
    v_not_b32 v4, v4
    v_and_b32 v4, 0x7fff, v4
    v_or_b32 v4, 0x8000, v4
    v_xor_b32 v31, v31, v4
    v_lshlrev_b32 v31, 16, v31
    v_mul_f32 v31, 0xbfb8aa3b, v31
    v_exp_f32 v31, v31
    s_nop 0
    v_add_f32 v31, 1.0, v31
    v_rcp_f32 v31, v31
    s_nop 0
    v_cvt_pk_bf16_f32 v31, v31, v31
    v_lshlrev_b32 v31, 16, v31
    v_and_b32 v30, 7, v30
    v_lshlrev_b32 v30, 10, v30
    v_lshrrev_b32 v4, 4, v1
    v_lshl_add_u32 v30, v4, 4, v30
    s_lshr_b32 s6, s3, 2
    s_lshl_b32 s6, s6, 6
    s_add_u32 s6, s6, 81920
    v_add_u32 v30, s6, v30
    ds_read_b128 v[32:35], v2 offset:0
    ds_read_b128 v[36:39], v2 offset:20480
    ds_read_b128 v[40:43], v2 offset:40960
    ds_read_b128 v[44:47], v2 offset:61440
    ds_read_b128 v[48:51], v30 offset:0
    ds_read_b128 v[52:55], v30 offset:320
    ds_read_b128 v[56:59], v30 offset:640
    s_waitcnt lgkmcnt(0)
    v_add_f32 v32, v32, v36
    v_add_f32 v4, v40, v44
    v_add_f32 v32, v32, v4
    v_cvt_pk_bf16_f32 v32, v32, v32
    v_lshlrev_b32 v32, 16, v32
    v_lshlrev_b32 v4, 16, v16
    v_lshlrev_b32 v5, 16, v22
    v_add_f32 v32, v32, v4
    v_cvt_pk_bf16_f32 v32, v32, v32
    v_lshlrev_b32 v32, 16, v32
    v_add_f32 v48, v48, v52
    v_add_f32 v48, v48, v56
    v_cvt_pk_bf16_f32 v48, v48, v48
    v_lshlrev_b32 v48, 16, v48
    v_mul_f32 v48, v48, v31
    v_cvt_pk_bf16_f32 v48, v48, v48
    v_lshlrev_b32 v48, 16, v48
    v_add_f32 v48, v48, v5
    v_cvt_pk_bf16_f32 v48, v48, v48
    v_lshlrev_b32 v48, 16, v48
    v_cndmask_b32 v5, v5, v48, s[74:75]
    v_add_f32 v32, v32, v5
    v_add_f32 v33, v33, v37
    v_add_f32 v4, v41, v45
    v_add_f32 v33, v33, v4
    v_cvt_pk_bf16_f32 v33, v33, v33
    v_lshlrev_b32 v33, 16, v33
    v_and_b32 v4, 0xffff0000, v16
    v_and_b32 v5, 0xffff0000, v22
    v_add_f32 v33, v33, v4
    v_cvt_pk_bf16_f32 v33, v33, v33
    v_lshlrev_b32 v33, 16, v33
    v_add_f32 v49, v49, v53
    v_add_f32 v49, v49, v57
    v_cvt_pk_bf16_f32 v49, v49, v49
    v_lshlrev_b32 v49, 16, v49
    v_mul_f32 v49, v49, v31
    v_cvt_pk_bf16_f32 v49, v49, v49
    v_lshlrev_b32 v49, 16, v49
    v_add_f32 v49, v49, v5
    v_cvt_pk_bf16_f32 v49, v49, v49
    v_lshlrev_b32 v49, 16, v49
    v_cndmask_b32 v5, v5, v49, s[74:75]
    v_add_f32 v33, v33, v5
    v_add_f32 v34, v34, v38
    v_add_f32 v4, v42, v46
    v_add_f32 v34, v34, v4
    v_cvt_pk_bf16_f32 v34, v34, v34
    v_lshlrev_b32 v34, 16, v34
    v_lshlrev_b32 v4, 16, v17
    v_lshlrev_b32 v5, 16, v23
    v_add_f32 v34, v34, v4
    v_cvt_pk_bf16_f32 v34, v34, v34
    v_lshlrev_b32 v34, 16, v34
    v_add_f32 v50, v50, v54
    v_add_f32 v50, v50, v58
    v_cvt_pk_bf16_f32 v50, v50, v50
    v_lshlrev_b32 v50, 16, v50
    v_mul_f32 v50, v50, v31
    v_cvt_pk_bf16_f32 v50, v50, v50
    v_lshlrev_b32 v50, 16, v50
    v_add_f32 v50, v50, v5
    v_cvt_pk_bf16_f32 v50, v50, v50
    v_lshlrev_b32 v50, 16, v50
    v_cndmask_b32 v5, v5, v50, s[74:75]
    v_add_f32 v34, v34, v5
    v_add_f32 v35, v35, v39
    v_add_f32 v4, v43, v47
    v_add_f32 v35, v35, v4
    v_cvt_pk_bf16_f32 v35, v35, v35
    v_lshlrev_b32 v35, 16, v35
    v_and_b32 v4, 0xffff0000, v17
    v_and_b32 v5, 0xffff0000, v23
    v_add_f32 v35, v35, v4
    v_cvt_pk_bf16_f32 v35, v35, v35
    v_lshlrev_b32 v35, 16, v35
    v_add_f32 v51, v51, v55
    v_add_f32 v51, v51, v59
    v_cvt_pk_bf16_f32 v51, v51, v51
    v_lshlrev_b32 v51, 16, v51
    v_mul_f32 v51, v51, v31
    v_cvt_pk_bf16_f32 v51, v51, v51
    v_lshlrev_b32 v51, 16, v51
    v_add_f32 v51, v51, v5
    v_cvt_pk_bf16_f32 v51, v51, v51
    v_lshlrev_b32 v51, 16, v51
    v_cndmask_b32 v5, v5, v51, s[74:75]
    v_add_f32 v35, v35, v5
    v_cvt_pk_bf16_f32 v6, v32, v33
    v_cvt_pk_bf16_f32 v7, v34, v35
    buffer_store_dwordx2 v[6:7], v29, s[16:19], s66 offen offset:0
    s_nop 1
    ds_read_b128 v[32:35], v2 offset:8192
    ds_read_b128 v[36:39], v2 offset:28672
    ds_read_b128 v[40:43], v2 offset:49152
    v_add_u32 v4, 61440, v2
    ds_read_b128 v[44:47], v4 offset:8192
    ds_read_b128 v[48:51], v30 offset:128
    ds_read_b128 v[52:55], v30 offset:448
    ds_read_b128 v[56:59], v30 offset:768
    s_waitcnt lgkmcnt(0)
    v_add_f32 v32, v32, v36
    v_add_f32 v4, v40, v44
    v_add_f32 v32, v32, v4
    v_cvt_pk_bf16_f32 v32, v32, v32
    v_lshlrev_b32 v32, 16, v32
    v_lshlrev_b32 v4, 16, v18
    v_lshlrev_b32 v5, 16, v24
    v_add_f32 v32, v32, v4
    v_cvt_pk_bf16_f32 v32, v32, v32
    v_lshlrev_b32 v32, 16, v32
    v_add_f32 v48, v48, v52
    v_add_f32 v48, v48, v56
    v_cvt_pk_bf16_f32 v48, v48, v48
    v_lshlrev_b32 v48, 16, v48
    v_mul_f32 v48, v48, v31
    v_cvt_pk_bf16_f32 v48, v48, v48
    v_lshlrev_b32 v48, 16, v48
    v_add_f32 v48, v48, v5
    v_cvt_pk_bf16_f32 v48, v48, v48
    v_lshlrev_b32 v48, 16, v48
    v_cndmask_b32 v5, v5, v48, s[74:75]
    v_add_f32 v32, v32, v5
    v_add_f32 v33, v33, v37
    v_add_f32 v4, v41, v45
    v_add_f32 v33, v33, v4
    v_cvt_pk_bf16_f32 v33, v33, v33
    v_lshlrev_b32 v33, 16, v33
    v_and_b32 v4, 0xffff0000, v18
    v_and_b32 v5, 0xffff0000, v24
    v_add_f32 v33, v33, v4
    v_cvt_pk_bf16_f32 v33, v33, v33
    v_lshlrev_b32 v33, 16, v33
    v_add_f32 v49, v49, v53
    v_add_f32 v49, v49, v57
    v_cvt_pk_bf16_f32 v49, v49, v49
    v_lshlrev_b32 v49, 16, v49
    v_mul_f32 v49, v49, v31
    v_cvt_pk_bf16_f32 v49, v49, v49
    v_lshlrev_b32 v49, 16, v49
    v_add_f32 v49, v49, v5
    v_cvt_pk_bf16_f32 v49, v49, v49
    v_lshlrev_b32 v49, 16, v49
    v_cndmask_b32 v5, v5, v49, s[74:75]
    v_add_f32 v33, v33, v5
    v_add_f32 v34, v34, v38
    v_add_f32 v4, v42, v46
    v_add_f32 v34, v34, v4
    v_cvt_pk_bf16_f32 v34, v34, v34
    v_lshlrev_b32 v34, 16, v34
    v_lshlrev_b32 v4, 16, v19
    v_lshlrev_b32 v5, 16, v25
    v_add_f32 v34, v34, v4
    v_cvt_pk_bf16_f32 v34, v34, v34
    v_lshlrev_b32 v34, 16, v34
    v_add_f32 v50, v50, v54
    v_add_f32 v50, v50, v58
    v_cvt_pk_bf16_f32 v50, v50, v50
    v_lshlrev_b32 v50, 16, v50
    v_mul_f32 v50, v50, v31
    v_cvt_pk_bf16_f32 v50, v50, v50
    v_lshlrev_b32 v50, 16, v50
    v_add_f32 v50, v50, v5
    v_cvt_pk_bf16_f32 v50, v50, v50
    v_lshlrev_b32 v50, 16, v50
    v_cndmask_b32 v5, v5, v50, s[74:75]
    v_add_f32 v34, v34, v5
    v_add_f32 v35, v35, v39
    v_add_f32 v4, v43, v47
    v_add_f32 v35, v35, v4
    v_cvt_pk_bf16_f32 v35, v35, v35
    v_lshlrev_b32 v35, 16, v35
    v_and_b32 v4, 0xffff0000, v19
    v_and_b32 v5, 0xffff0000, v25
    v_add_f32 v35, v35, v4
    v_cvt_pk_bf16_f32 v35, v35, v35
    v_lshlrev_b32 v35, 16, v35
    v_add_f32 v51, v51, v55
    v_add_f32 v51, v51, v59
    v_cvt_pk_bf16_f32 v51, v51, v51
    v_lshlrev_b32 v51, 16, v51
    v_mul_f32 v51, v51, v31
    v_cvt_pk_bf16_f32 v51, v51, v51
    v_lshlrev_b32 v51, 16, v51
    v_add_f32 v51, v51, v5
    v_cvt_pk_bf16_f32 v51, v51, v51
    v_lshlrev_b32 v51, 16, v51
    v_cndmask_b32 v5, v5, v51, s[74:75]
    v_add_f32 v35, v35, v5
    v_cvt_pk_bf16_f32 v6, v32, v33
    v_cvt_pk_bf16_f32 v7, v34, v35
    buffer_store_dwordx2 v[6:7], v29, s[16:19], s66 offen offset:64
    s_nop 1
    s_cmp_ge_u32 s3, 4
    s_cbranch_scc1 L_k3_end
    ds_read_b128 v[32:35], v2 offset:16384
    ds_read_b128 v[36:39], v2 offset:36864
    ds_read_b128 v[40:43], v2 offset:57344
    v_add_u32 v4, 61440, v2
    ds_read_b128 v[44:47], v4 offset:16384
    ds_read_b128 v[48:51], v30 offset:256
    ds_read_b128 v[52:55], v30 offset:576
    ds_read_b128 v[56:59], v30 offset:896
    s_waitcnt lgkmcnt(0)
    v_add_f32 v32, v32, v36
    v_add_f32 v4, v40, v44
    v_add_f32 v32, v32, v4
    v_cvt_pk_bf16_f32 v32, v32, v32
    v_lshlrev_b32 v32, 16, v32
    v_lshlrev_b32 v4, 16, v20
    v_lshlrev_b32 v5, 16, v26
    v_add_f32 v32, v32, v4
    v_cvt_pk_bf16_f32 v32, v32, v32
    v_lshlrev_b32 v32, 16, v32
    v_add_f32 v48, v48, v52
    v_add_f32 v48, v48, v56
    v_cvt_pk_bf16_f32 v48, v48, v48
    v_lshlrev_b32 v48, 16, v48
    v_mul_f32 v48, v48, v31
    v_cvt_pk_bf16_f32 v48, v48, v48
    v_lshlrev_b32 v48, 16, v48
    v_add_f32 v48, v48, v5
    v_cvt_pk_bf16_f32 v48, v48, v48
    v_lshlrev_b32 v48, 16, v48
    v_cndmask_b32 v5, v5, v48, s[74:75]
    v_add_f32 v32, v32, v5
    v_add_f32 v33, v33, v37
    v_add_f32 v4, v41, v45
    v_add_f32 v33, v33, v4
    v_cvt_pk_bf16_f32 v33, v33, v33
    v_lshlrev_b32 v33, 16, v33
    v_and_b32 v4, 0xffff0000, v20
    v_and_b32 v5, 0xffff0000, v26
    v_add_f32 v33, v33, v4
    v_cvt_pk_bf16_f32 v33, v33, v33
    v_lshlrev_b32 v33, 16, v33
    v_add_f32 v49, v49, v53
    v_add_f32 v49, v49, v57
    v_cvt_pk_bf16_f32 v49, v49, v49
    v_lshlrev_b32 v49, 16, v49
    v_mul_f32 v49, v49, v31
    v_cvt_pk_bf16_f32 v49, v49, v49
    v_lshlrev_b32 v49, 16, v49
    v_add_f32 v49, v49, v5
    v_cvt_pk_bf16_f32 v49, v49, v49
    v_lshlrev_b32 v49, 16, v49
    v_cndmask_b32 v5, v5, v49, s[74:75]
    v_add_f32 v33, v33, v5
    v_add_f32 v34, v34, v38
    v_add_f32 v4, v42, v46
    v_add_f32 v34, v34, v4
    v_cvt_pk_bf16_f32 v34, v34, v34
    v_lshlrev_b32 v34, 16, v34
    v_lshlrev_b32 v4, 16, v21
    v_lshlrev_b32 v5, 16, v27
    v_add_f32 v34, v34, v4
    v_cvt_pk_bf16_f32 v34, v34, v34
    v_lshlrev_b32 v34, 16, v34
    v_add_f32 v50, v50, v54
    v_add_f32 v50, v50, v58
    v_cvt_pk_bf16_f32 v50, v50, v50
    v_lshlrev_b32 v50, 16, v50
    v_mul_f32 v50, v50, v31
    v_cvt_pk_bf16_f32 v50, v50, v50
    v_lshlrev_b32 v50, 16, v50
    v_add_f32 v50, v50, v5
    v_cvt_pk_bf16_f32 v50, v50, v50
    v_lshlrev_b32 v50, 16, v50
    v_cndmask_b32 v5, v5, v50, s[74:75]
    v_add_f32 v34, v34, v5
    v_add_f32 v35, v35, v39
    v_add_f32 v4, v43, v47
    v_add_f32 v35, v35, v4
    v_cvt_pk_bf16_f32 v35, v35, v35
    v_lshlrev_b32 v35, 16, v35
    v_and_b32 v4, 0xffff0000, v21
    v_and_b32 v5, 0xffff0000, v27
    v_add_f32 v35, v35, v4
    v_cvt_pk_bf16_f32 v35, v35, v35
    v_lshlrev_b32 v35, 16, v35
    v_add_f32 v51, v51, v55
    v_add_f32 v51, v51, v59
    v_cvt_pk_bf16_f32 v51, v51, v51
    v_lshlrev_b32 v51, 16, v51
    v_mul_f32 v51, v51, v31
    v_cvt_pk_bf16_f32 v51, v51, v51
    v_lshlrev_b32 v51, 16, v51
    v_add_f32 v51, v51, v5
    v_cvt_pk_bf16_f32 v51, v51, v51
    v_lshlrev_b32 v51, 16, v51
    v_cndmask_b32 v5, v5, v51, s[74:75]
    v_add_f32 v35, v35, v5
    v_cvt_pk_bf16_f32 v6, v32, v33
    v_cvt_pk_bf16_f32 v7, v34, v35
    buffer_store_dwordx2 v[6:7], v29, s[16:19], s66 offen offset:128
    s_nop 1
L_k3_end:
    s_endpgm
.section .rodata,"a"
.p2align 6
.amdhsa_kernel k1_kernel
  .amdhsa_next_free_vgpr 256
  .amdhsa_next_free_sgpr 102
  .amdhsa_accum_offset 256
  .amdhsa_group_segment_fixed_size 0
  .amdhsa_kernarg_size 112
  .amdhsa_user_sgpr_count 2
  .amdhsa_user_sgpr_kernarg_segment_ptr 1
  .amdhsa_system_sgpr_workgroup_id_x 1
  .amdhsa_float_denorm_mode_32 3
.end_amdhsa_kernel
.p2align 6
.amdhsa_kernel k2_kernel
  .amdhsa_next_free_vgpr 256
  .amdhsa_next_free_sgpr 102
  .amdhsa_accum_offset 256
  .amdhsa_group_segment_fixed_size 0
  .amdhsa_kernarg_size 112
  .amdhsa_user_sgpr_count 2
  .amdhsa_user_sgpr_kernarg_segment_ptr 1
  .amdhsa_system_sgpr_workgroup_id_x 1
  .amdhsa_float_denorm_mode_32 3
.end_amdhsa_kernel
.p2align 6
.amdhsa_kernel k3_kernel
  .amdhsa_next_free_vgpr 256
  .amdhsa_next_free_sgpr 102
  .amdhsa_accum_offset 256
  .amdhsa_group_segment_fixed_size 0
  .amdhsa_kernarg_size 112
  .amdhsa_user_sgpr_count 2
  .amdhsa_user_sgpr_kernarg_segment_ptr 1
  .amdhsa_system_sgpr_workgroup_id_x 1
  .amdhsa_float_denorm_mode_32 3
.end_amdhsa_kernel
```

```asm
; @launch grid=(256,1,1) block=(512,1,1) lds=163840
.amdgcn_target "amdgcn-amd-amdhsa--gfx950"
.text
.globl parallel_sum__compressed_kv_cla__moe_arch_mod__prompt_kernel
.p2align 8
.type parallel_sum__compressed_kv_cla__moe_arch_mod__prompt_kernel,@function
parallel_sum__compressed_kv_cla__moe_arch_mod__prompt_kernel:
    s_cmp_ge_u32 s2, 256
    s_cbranch_scc1 L_exit
    s_load_dwordx16 s[32:47], s[0:1], 0
    s_load_dwordx8 s[48:55], s[0:1], 64
    s_load_dwordx4 s[56:59], s[0:1], 96
    v_lshrrev_b32 v2, 6, v0
    v_and_b32 v1, 63, v0
    v_readfirstlane_b32 s3, v2
    s_getpc_b64 s[80:81]
L_pc:
    s_lshr_b32 s6, s2, 3
    s_and_b32 s6, s6, 15
    s_lshl_b32 s6, s6, 12
    s_cmp_lt_u32 s3, 2
    s_cselect_b32 s6, 0, s6
    v_lshl_add_u32 v3, v0, 6, s6
    v_min_u32 v3, L_exit-L_pc, v3
    s_cmp_ge_u32 s3, 3
    s_cbranch_scc1 L_noct
    global_load_dword v11, v3, s[80:81]
L_noct:
    v_lshrrev_b32 v62, 5, v0
    v_and_b32 v62, 7, v62
    v_and_b32 v2, 31, v0
    v_lshlrev_b32 v2, 3, v2
    v_mul_u32_u24 v63, 1280, v62
    v_add_u32 v63, v63, v2
    s_mul_i32 s6, s2, 10240
    v_add_u32 v10, s6, v63
    s_cmp_lt_u32 s3, 4
    s_cbranch_scc1 L_st_k0
    s_waitcnt lgkmcnt(0)
    global_load_dwordx2 v[16:17], v10, s[32:33] offset:0
    global_load_dwordx2 v[18:19], v10, s[32:33] offset:256
    global_load_dwordx2 v[20:21], v10, s[32:33] offset:512
    global_load_dwordx2 v[22:23], v10, s[32:33] offset:768
    global_load_dwordx2 v[24:25], v10, s[32:33] offset:1024
    global_load_dwordx2 v[26:27], v2, s[46:47] offset:0
    global_load_dwordx2 v[28:29], v2, s[46:47] offset:256
    global_load_dwordx2 v[30:31], v2, s[46:47] offset:512
    global_load_dwordx2 v[32:33], v2, s[46:47] offset:768
    global_load_dwordx2 v[34:35], v2, s[46:47] offset:1024
L_st_k0:
    s_and_b32 s6, s2, 7
    s_lshl_b32 s6, s6, 2
    s_lshr_b32 s7, s2, 3
    s_and_b32 s7, s7, 3
    s_add_u32 s4, s6, s7
    s_lshr_b32 s5, s2, 5
    s_and_b32 s76, s3, 3
    v_lshrrev_b32 v2, 3, v1
    v_and_b32 v3, 7, v1
    v_lshrrev_b32 v4, 4, v1
    s_lshl_b32 s6, s76, 6
    v_xor_b32 v5, v3, v4
    v_lshlrev_b32 v5, 4, v5
    v_add_u32 v6, s6, v2
    v_lshl_add_u32 v40, v6, 10, v5
    v_xor_b32 v5, 64, v40
    v_add_u32 v41, 7168, v5
    v_add_u32 v42, 14336, v40
    v_add_u32 v43, 14336, v41
    v_and_b32 v6, 15, v1
    s_lshl_b32 s6, s76, 4
    v_add_u32 v7, s6, v4
    v_lshlrev_b32 v5, 1, v4
    v_xor_b32 v5, v6, v5
    v_lshlrev_b32 v5, 4, v5
    v_lshl_add_u32 v44, v7, 13, v5
    v_add_u32 v45, 31744, v44
    v_xor_b32 v5, 0x80, v44
    v_add_u32 v46, 63488, v5
    v_add_u32 v47, 31744, v46
    s_lshl_b32 s62, s5, 18
    s_lshl_b32 s63, s4, 8
    s_lshl_b32 s64, s76, 13
    s_lshl_b32 s73, s76, 12
    s_add_u32 s73, s73, 32768
    s_waitcnt lgkmcnt(0)
    s_mov_b32 s12, s34
    s_mov_b32 s13, s35
    s_mov_b32 s14, 0x200000
    s_mov_b32 s15, 0x20000
    s_mov_b32 s16, s38
    s_mov_b32 s17, s39
    s_mov_b32 s18, 0x400000
    s_mov_b32 s19, 0x20000
    s_mov_b32 s20, s40
    s_mov_b32 s21, s41
    s_mov_b32 s22, 0x400000
    s_mov_b32 s23, 0x20000
    s_cmp_ge_u32 s3, 4
    s_cbranch_scc1 L_st_v0
    s_mov_b32 m0, s64
    s_add_u32 s72, s62, 32768
    buffer_load_dwordx4 v40, s[12:15], s62 offen offset:0 lds
    buffer_load_dwordx4 v41, s[12:15], s62 offen offset:1024 lds
    buffer_load_dwordx4 v42, s[12:15], s62 offen offset:2048 lds
    buffer_load_dwordx4 v43, s[12:15], s62 offen offset:3072 lds
    s_add_u32 m0, s64, 4096
    s_add_u32 s62, s62, 128
    s_bitset0_b32 s62, 10
    buffer_load_dwordx4 v40, s[12:15], s72 offen offset:0 lds
    buffer_load_dwordx4 v41, s[12:15], s72 offen offset:1024 lds
    buffer_load_dwordx4 v42, s[12:15], s72 offen offset:2048 lds
    buffer_load_dwordx4 v43, s[12:15], s72 offen offset:3072 lds
    s_mov_b32 m0, s73
    s_xor_b32 s64, s64, 0x10000
    buffer_load_dwordx4 v44, s[16:19], s63 offen offset:0 lds
    buffer_load_dwordx4 v45, s[16:19], s63 offen offset:1024 lds
    buffer_load_dwordx4 v46, s[16:19], s63 offen offset:2048 lds
    buffer_load_dwordx4 v47, s[16:19], s63 offen offset:3072 lds
    s_add_u32 m0, s73, 16384
    s_xor_b32 s73, s73, 0x10000
    buffer_load_dwordx4 v44, s[20:23], s63 offen offset:0 lds
    buffer_load_dwordx4 v45, s[20:23], s63 offen offset:1024 lds
    buffer_load_dwordx4 v46, s[20:23], s63 offen offset:2048 lds
    buffer_load_dwordx4 v47, s[20:23], s63 offen offset:3072 lds
    s_add_u32 s63, s63, 524288
    s_bitset0_b32 s63, 22
    s_setprio 1
    s_branch L_st_j0
L_st_v0:
    s_cmp_ge_u32 s76, 2
    s_cbranch_scc1 L_tch_1a
    s_and_b32 s6, s4, 3
    s_lshl_b32 s6, s6, 16
    s_lshl_b32 s7, s5, 18
    s_add_u32 s6, s6, s7
    s_lshl_b32 s7, s76, 7
    s_add_u32 s6, s6, s7
    s_add_u32 s6, s6, 128
    v_lshrrev_b32 v6, 1, v1
    v_lshlrev_b32 v6, 10, v6
    v_and_b32 v7, 1, v1
    v_lshl_add_u32 v6, v7, 6, v6
    buffer_load_dword v11, v6, s[12:15], s6 offen
    s_add_u32 s6, s6, 32768
    buffer_load_dword v11, v6, s[12:15], s6 offen
    s_branch L_tch_1c
L_tch_1a:
    v_lshrrev_b32 v6, 5, v1
    v_lshlrev_b32 v6, 6, v6
    v_bfe_u32 v7, v1, 2, 3
    v_add_u32 v6, v6, v7
    v_lshlrev_b32 v6, 13, v6
    v_and_b32 v7, 3, v1
    v_lshl_add_u32 v6, v7, 6, v6
    s_lshl_b32 s6, s4, 8
    s_lshl_b32 s7, s5, 16
    s_add_u32 s6, s6, s7
    s_add_u32 s6, s6, 524288
    s_cmp_lg_u32 s76, 2
    s_cbranch_scc1 L_tch_1b
    buffer_load_dword v11, v6, s[16:19], s6 offen
    s_branch L_tch_1c
L_tch_1b:
    buffer_load_dword v11, v6, s[20:23], s6 offen
L_tch_1c:
L_st_j0:
    s_mov_b32 s8, s58
    s_mov_b32 s9, s59
    s_mov_b32 s10, 0x4000000
    s_mov_b32 s11, 0x20000
    s_mov_b32 s24, s36
    s_mov_b32 s25, s37
    s_mov_b32 s26, 0x500000
    s_mov_b32 s27, 0x20000
    v_lshlrev_b32 v13, 4, v1
    s_lshl_b32 s6, s5, 2
    s_add_u32 s7, s6, s3
    s_sub_u32 s6, 56, s6
    s_add_u32 s6, s6, s3
    s_cmp_lt_u32 s3, 4
    s_cselect_b32 s60, s7, s6
    s_add_u32 s6, s5, 7
    s_and_b32 s6, s6, 7
    s_lshl_b32 s6, s6, 5
    s_add_u32 s61, s6, s4
    v_and_b32 v2, 15, v1
    v_lshrrev_b32 v3, 4, v1
    s_and_b32 s6, s3, 1
    s_lshl_b32 s6, s6, 7
    v_add_u32 v4, s6, v2
    v_lshlrev_b32 v4, 7, v4
    v_lshrrev_b32 v5, 1, v2
    v_add_u32 v6, 0, v3
    v_xor_b32 v6, v6, v5
    v_lshl_add_u32 v48, v6, 4, v4
    v_add_u32 v6, 4, v3
    v_xor_b32 v6, v6, v5
    v_lshl_add_u32 v49, v6, 4, v4
    v_lshrrev_b32 v4, 2, v2
    v_lshl_add_u32 v5, v3, 3, v4
    v_lshlrev_b32 v5, 8, v5
    v_and_b32 v6, 1, v2
    v_lshl_add_u32 v5, v6, 3, v5
    v_and_b32 v6, 1, v3
    v_lshl_or_b32 v4, v6, 2, v4
    v_lshlrev_b32 v4, 1, v4
    v_bfe_u32 v6, v2, 1, 1
    v_add_u32 v8, 131072, v5
    v_add_u32 v7, 0, v6
    v_xor_b32 v7, v7, v4
    v_lshl_add_u32 v54, v7, 4, v8
    v_add_u32 v7, 2, v6
    v_xor_b32 v7, v7, v4
    v_lshl_add_u32 v55, v7, 4, v8
    v_add_u32 v7, 4, v6
    v_xor_b32 v7, v7, v4
    v_lshl_add_u32 v56, v7, 4, v8
    v_add_u32 v7, 6, v6
    v_xor_b32 v7, v7, v4
    v_lshl_add_u32 v57, v7, 4, v8
    v_add_u32 v7, 8, v6
    v_xor_b32 v7, v7, v4
    v_lshl_add_u32 v58, v7, 4, v8
    v_add_u32 v7, 10, v6
    v_xor_b32 v7, v7, v4
    v_lshl_add_u32 v59, v7, 4, v8
    v_add_u32 v7, 12, v6
    v_xor_b32 v7, v7, v4
    v_lshl_add_u32 v60, v7, 4, v8
    v_add_u32 v7, 14, v6
    v_xor_b32 v7, v7, v4
    v_lshl_add_u32 v61, v7, 4, v8
    s_lshr_b32 s6, s3, 2
    s_lshl_b32 s6, s6, 14
    s_add_u32 s6, s6, 32768
    v_add_u32 v5, s6, v5
    s_lshr_b32 s7, s3, 1
    s_and_b32 s7, s7, 1
    s_lshl_b32 s7, s7, 3
    s_add_u32 s6, s7, 0
    v_add_u32 v7, s6, v6
    v_xor_b32 v7, v7, v4
    v_lshl_add_u32 v50, v7, 4, v5
    s_add_u32 s6, s7, 2
    v_add_u32 v7, s6, v6
    v_xor_b32 v7, v7, v4
    v_lshl_add_u32 v51, v7, 4, v5
    s_add_u32 s6, s7, 4
    v_add_u32 v7, s6, v6
    v_xor_b32 v7, v7, v4
    v_lshl_add_u32 v52, v7, 4, v5
    s_add_u32 s6, s7, 6
    v_add_u32 v7, s6, v6
    v_xor_b32 v7, v7, v4
    v_lshl_add_u32 v53, v7, 4, v5
    v_mov_b64 v[128:129], 0
    v_mov_b64 v[130:131], 0
    v_mov_b64 v[132:133], 0
    v_mov_b64 v[134:135], 0
    v_mov_b64 v[136:137], 0
    v_mov_b64 v[138:139], 0
    v_mov_b64 v[140:141], 0
    v_mov_b64 v[142:143], 0
    v_mov_b64 v[144:145], 0
    v_mov_b64 v[146:147], 0
    v_mov_b64 v[148:149], 0
    v_mov_b64 v[150:151], 0
    v_mov_b64 v[152:153], 0
    v_mov_b64 v[154:155], 0
    v_mov_b64 v[156:157], 0
    v_mov_b64 v[158:159], 0
    v_mov_b64 v[160:161], 0
    v_mov_b64 v[162:163], 0
    v_mov_b64 v[164:165], 0
    v_mov_b64 v[166:167], 0
    v_mov_b64 v[168:169], 0
    v_mov_b64 v[170:171], 0
    v_mov_b64 v[172:173], 0
    v_mov_b64 v[174:175], 0
    v_mov_b64 v[176:177], 0
    v_mov_b64 v[178:179], 0
    v_mov_b64 v[180:181], 0
    v_mov_b64 v[182:183], 0
    v_mov_b64 v[184:185], 0
    v_mov_b64 v[186:187], 0
    v_mov_b64 v[188:189], 0
    v_mov_b64 v[190:191], 0
    v_mov_b64 v[192:193], 0
    v_mov_b64 v[194:195], 0
    v_mov_b64 v[196:197], 0
    v_mov_b64 v[198:199], 0
    v_mov_b64 v[200:201], 0
    v_mov_b64 v[202:203], 0
    v_mov_b64 v[204:205], 0
    v_mov_b64 v[206:207], 0
    v_mov_b64 v[208:209], 0
    v_mov_b64 v[210:211], 0
    v_mov_b64 v[212:213], 0
    v_mov_b64 v[214:215], 0
    v_mov_b64 v[216:217], 0
    v_mov_b64 v[218:219], 0
    v_mov_b64 v[220:221], 0
    v_mov_b64 v[222:223], 0
    v_mov_b64 v[224:225], 0
    v_mov_b64 v[226:227], 0
    v_mov_b64 v[228:229], 0
    v_mov_b64 v[230:231], 0
    v_mov_b64 v[232:233], 0
    v_mov_b64 v[234:235], 0
    v_mov_b64 v[236:237], 0
    v_mov_b64 v[238:239], 0
    v_mov_b64 v[240:241], 0
    v_mov_b64 v[242:243], 0
    v_mov_b64 v[244:245], 0
    v_mov_b64 v[246:247], 0
    v_mov_b64 v[248:249], 0
    v_mov_b64 v[250:251], 0
    v_mov_b64 v[252:253], 0
    v_mov_b64 v[254:255], 0
    v_add_u32 v12, 20480, v13
    s_mul_i32 s70, s60, 40960
    s_cmp_ge_u32 s3, 4
    s_cbranch_scc1 L_st_v1
    s_mov_b32 m0, s64
    s_add_u32 s72, s62, 32768
    buffer_load_dwordx4 v40, s[12:15], s62 offen offset:0 lds
    buffer_load_dwordx4 v41, s[12:15], s62 offen offset:1024 lds
    buffer_load_dwordx4 v42, s[12:15], s62 offen offset:2048 lds
    buffer_load_dwordx4 v43, s[12:15], s62 offen offset:3072 lds
    s_add_u32 m0, s64, 4096
    s_add_u32 s62, s62, 128
    s_bitset0_b32 s62, 10
    buffer_load_dwordx4 v40, s[12:15], s72 offen offset:0 lds
    buffer_load_dwordx4 v41, s[12:15], s72 offen offset:1024 lds
    buffer_load_dwordx4 v42, s[12:15], s72 offen offset:2048 lds
    buffer_load_dwordx4 v43, s[12:15], s72 offen offset:3072 lds
    s_mov_b32 m0, s73
    s_xor_b32 s64, s64, 0x10000
    buffer_load_dwordx4 v44, s[16:19], s63 offen offset:0 lds
    buffer_load_dwordx4 v45, s[16:19], s63 offen offset:1024 lds
    buffer_load_dwordx4 v46, s[16:19], s63 offen offset:2048 lds
    buffer_load_dwordx4 v47, s[16:19], s63 offen offset:3072 lds
    s_add_u32 m0, s73, 16384
    s_xor_b32 s73, s73, 0x10000
    buffer_load_dwordx4 v44, s[20:23], s63 offen offset:0 lds
    buffer_load_dwordx4 v45, s[20:23], s63 offen offset:1024 lds
    buffer_load_dwordx4 v46, s[20:23], s63 offen offset:2048 lds
    buffer_load_dwordx4 v47, s[20:23], s63 offen offset:3072 lds
    s_add_u32 s63, s63, 524288
    s_bitset0_b32 s63, 22
    s_waitcnt vmcnt(16)
    s_branch L_st_j1
L_st_v1:
    s_waitcnt vmcnt(1)
    v_lshlrev_b32 v64, 16, v16
    v_and_b32 v65, 0xffff0000, v16
    v_lshlrev_b32 v66, 16, v17
    v_and_b32 v67, 0xffff0000, v17
    v_lshlrev_b32 v68, 16, v18
    v_and_b32 v69, 0xffff0000, v18
    v_lshlrev_b32 v70, 16, v19
    v_and_b32 v71, 0xffff0000, v19
    v_lshlrev_b32 v72, 16, v20
    v_and_b32 v73, 0xffff0000, v20
    v_lshlrev_b32 v74, 16, v21
    v_and_b32 v75, 0xffff0000, v21
    v_lshlrev_b32 v76, 16, v22
    v_and_b32 v77, 0xffff0000, v22
    v_lshlrev_b32 v78, 16, v23
    v_and_b32 v79, 0xffff0000, v23
    v_lshlrev_b32 v80, 16, v24
    v_and_b32 v81, 0xffff0000, v24
    v_lshlrev_b32 v82, 16, v25
    v_and_b32 v83, 0xffff0000, v25
    v_pk_add_f32 v[2:3], v[64:65], v[66:67]
    v_pk_add_f32 v[2:3], v[2:3], v[68:69]
    v_pk_add_f32 v[2:3], v[2:3], v[70:71]
    v_pk_add_f32 v[2:3], v[2:3], v[72:73]
    v_pk_add_f32 v[2:3], v[2:3], v[74:75]
    v_pk_add_f32 v[2:3], v[2:3], v[76:77]
    v_pk_add_f32 v[2:3], v[2:3], v[78:79]
    v_pk_add_f32 v[2:3], v[2:3], v[80:81]
    v_pk_add_f32 v[2:3], v[2:3], v[82:83]
    v_add_f32 v2, v2, v3
    s_nop 1
    v_add_f32_dpp v2, v2, v2 quad_perm:[1,0,3,2] row_mask:0xf bank_mask:0xf
    s_nop 1
    v_add_f32_dpp v2, v2, v2 quad_perm:[2,3,0,1] row_mask:0xf bank_mask:0xf
    s_nop 1
    v_add_f32_dpp v2, v2, v2 row_half_mirror row_mask:0xf bank_mask:0xf
    s_nop 1
    v_add_f32_dpp v2, v2, v2 row_mirror row_mask:0xf bank_mask:0xf
    v_mov_b32 v8, v2
    s_nop 1
    v_permlane16_swap_b32 v2, v8
    s_nop 1
    v_add_f32 v2, v2, v8
    s_mov_b32 s7, 0x3acccccd
    v_mul_f32 v2, s7, v2
    v_mov_b64 v[4:5], 0
    v_pk_add_f32 v[6:7], v[64:65], v[2:3] op_sel_hi:[1,0] neg_lo:[0,1] neg_hi:[0,1]
    v_pk_fma_f32 v[4:5], v[6:7], v[6:7], v[4:5]
    v_pk_add_f32 v[6:7], v[66:67], v[2:3] op_sel_hi:[1,0] neg_lo:[0,1] neg_hi:[0,1]
    v_pk_fma_f32 v[4:5], v[6:7], v[6:7], v[4:5]
    v_pk_add_f32 v[6:7], v[68:69], v[2:3] op_sel_hi:[1,0] neg_lo:[0,1] neg_hi:[0,1]
    v_pk_fma_f32 v[4:5], v[6:7], v[6:7], v[4:5]
    v_pk_add_f32 v[6:7], v[70:71], v[2:3] op_sel_hi:[1,0] neg_lo:[0,1] neg_hi:[0,1]
    v_pk_fma_f32 v[4:5], v[6:7], v[6:7], v[4:5]
    v_pk_add_f32 v[6:7], v[72:73], v[2:3] op_sel_hi:[1,0] neg_lo:[0,1] neg_hi:[0,1]
    v_pk_fma_f32 v[4:5], v[6:7], v[6:7], v[4:5]
    v_pk_add_f32 v[6:7], v[74:75], v[2:3] op_sel_hi:[1,0] neg_lo:[0,1] neg_hi:[0,1]
    v_pk_fma_f32 v[4:5], v[6:7], v[6:7], v[4:5]
    v_pk_add_f32 v[6:7], v[76:77], v[2:3] op_sel_hi:[1,0] neg_lo:[0,1] neg_hi:[0,1]
    v_pk_fma_f32 v[4:5], v[6:7], v[6:7], v[4:5]
    v_pk_add_f32 v[6:7], v[78:79], v[2:3] op_sel_hi:[1,0] neg_lo:[0,1] neg_hi:[0,1]
    v_pk_fma_f32 v[4:5], v[6:7], v[6:7], v[4:5]
    v_pk_add_f32 v[6:7], v[80:81], v[2:3] op_sel_hi:[1,0] neg_lo:[0,1] neg_hi:[0,1]
    v_pk_fma_f32 v[4:5], v[6:7], v[6:7], v[4:5]
    v_pk_add_f32 v[6:7], v[82:83], v[2:3] op_sel_hi:[1,0] neg_lo:[0,1] neg_hi:[0,1]
    v_pk_fma_f32 v[4:5], v[6:7], v[6:7], v[4:5]
    v_add_f32 v4, v4, v5
    s_nop 1
    v_add_f32_dpp v4, v4, v4 quad_perm:[1,0,3,2] row_mask:0xf bank_mask:0xf
    s_nop 1
    v_add_f32_dpp v4, v4, v4 quad_perm:[2,3,0,1] row_mask:0xf bank_mask:0xf
    s_nop 1
    v_add_f32_dpp v4, v4, v4 row_half_mirror row_mask:0xf bank_mask:0xf
    s_nop 1
    v_add_f32_dpp v4, v4, v4 row_mirror row_mask:0xf bank_mask:0xf
    v_mov_b32 v8, v4
    s_nop 1
    v_permlane16_swap_b32 v4, v8
    s_nop 1
    v_add_f32 v4, v4, v8
    v_mul_f32 v4, s7, v4
    v_cvt_pk_bf16_f32 v2, v2, v2
    v_lshlrev_b32 v2, 16, v2
    v_cvt_pk_bf16_f32 v4, v4, v4
    v_lshlrev_b32 v4, 16, v4
    v_add_f32 v4, 0x3727c5ac, v4
    v_cvt_pk_bf16_f32 v4, v4, v4
    v_lshlrev_b32 v4, 16, v4
    v_sqrt_f32 v4, v4
    s_nop 0
    v_cvt_pk_bf16_f32 v4, v4, v4
    v_lshlrev_b32 v4, 16, v4
    v_rcp_f32 v6, v4
    s_nop 0
    v_fma_f32 v5, -v4, v6, 1.0
    v_fmac_f32 v6, v5, v6
    v_mov_b32 v9, 0
    v_pk_add_f32 v[64:65], v[64:65], v[2:3] op_sel_hi:[1,0] neg_lo:[0,1] neg_hi:[0,1]
    v_cvt_pk_bf16_f32 v5, v64, v65
    v_lshlrev_b32 v64, 16, v5
    v_and_b32 v65, 0xffff0000, v5
    v_pk_mul_f32 v[64:65], v[64:65], v[6:7] op_sel_hi:[1,0]
    v_cvt_pk_bf16_f32 v16, v64, v65
    v_pk_add_f32 v[66:67], v[66:67], v[2:3] op_sel_hi:[1,0] neg_lo:[0,1] neg_hi:[0,1]
    v_cvt_pk_bf16_f32 v5, v66, v67
    v_lshlrev_b32 v66, 16, v5
    v_and_b32 v67, 0xffff0000, v5
    v_pk_mul_f32 v[66:67], v[66:67], v[6:7] op_sel_hi:[1,0]
    v_cvt_pk_bf16_f32 v17, v66, v67
    v_pk_add_f32 v[68:69], v[68:69], v[2:3] op_sel_hi:[1,0] neg_lo:[0,1] neg_hi:[0,1]
    v_cvt_pk_bf16_f32 v5, v68, v69
    v_lshlrev_b32 v68, 16, v5
    v_and_b32 v69, 0xffff0000, v5
    v_pk_mul_f32 v[68:69], v[68:69], v[6:7] op_sel_hi:[1,0]
    v_cvt_pk_bf16_f32 v18, v68, v69
    v_pk_add_f32 v[70:71], v[70:71], v[2:3] op_sel_hi:[1,0] neg_lo:[0,1] neg_hi:[0,1]
    v_cvt_pk_bf16_f32 v5, v70, v71
    v_lshlrev_b32 v70, 16, v5
    v_and_b32 v71, 0xffff0000, v5
    v_pk_mul_f32 v[70:71], v[70:71], v[6:7] op_sel_hi:[1,0]
    v_cvt_pk_bf16_f32 v19, v70, v71
    v_pk_add_f32 v[72:73], v[72:73], v[2:3] op_sel_hi:[1,0] neg_lo:[0,1] neg_hi:[0,1]
    v_cvt_pk_bf16_f32 v5, v72, v73
    v_lshlrev_b32 v72, 16, v5
    v_and_b32 v73, 0xffff0000, v5
    v_pk_mul_f32 v[72:73], v[72:73], v[6:7] op_sel_hi:[1,0]
    v_cvt_pk_bf16_f32 v20, v72, v73
    v_pk_add_f32 v[74:75], v[74:75], v[2:3] op_sel_hi:[1,0] neg_lo:[0,1] neg_hi:[0,1]
    v_cvt_pk_bf16_f32 v5, v74, v75
    v_lshlrev_b32 v74, 16, v5
    v_and_b32 v75, 0xffff0000, v5
    v_pk_mul_f32 v[74:75], v[74:75], v[6:7] op_sel_hi:[1,0]
    v_cvt_pk_bf16_f32 v21, v74, v75
    v_pk_add_f32 v[76:77], v[76:77], v[2:3] op_sel_hi:[1,0] neg_lo:[0,1] neg_hi:[0,1]
    v_cvt_pk_bf16_f32 v5, v76, v77
    v_lshlrev_b32 v76, 16, v5
    v_and_b32 v77, 0xffff0000, v5
    v_pk_mul_f32 v[76:77], v[76:77], v[6:7] op_sel_hi:[1,0]
    v_cvt_pk_bf16_f32 v22, v76, v77
    v_pk_add_f32 v[78:79], v[78:79], v[2:3] op_sel_hi:[1,0] neg_lo:[0,1] neg_hi:[0,1]
    v_cvt_pk_bf16_f32 v5, v78, v79
    v_lshlrev_b32 v78, 16, v5
    v_and_b32 v79, 0xffff0000, v5
    v_pk_mul_f32 v[78:79], v[78:79], v[6:7] op_sel_hi:[1,0]
    v_cvt_pk_bf16_f32 v23, v78, v79
    v_pk_add_f32 v[80:81], v[80:81], v[2:3] op_sel_hi:[1,0] neg_lo:[0,1] neg_hi:[0,1]
    v_cvt_pk_bf16_f32 v5, v80, v81
    v_lshlrev_b32 v80, 16, v5
    v_and_b32 v81, 0xffff0000, v5
    v_pk_mul_f32 v[80:81], v[80:81], v[6:7] op_sel_hi:[1,0]
    v_cvt_pk_bf16_f32 v24, v80, v81
    v_pk_add_f32 v[82:83], v[82:83], v[2:3] op_sel_hi:[1,0] neg_lo:[0,1] neg_hi:[0,1]
    v_cvt_pk_bf16_f32 v5, v82, v83
    v_lshlrev_b32 v82, 16, v5
    v_and_b32 v83, 0xffff0000, v5
    v_pk_mul_f32 v[82:83], v[82:83], v[6:7] op_sel_hi:[1,0]
    v_cvt_pk_bf16_f32 v25, v82, v83
    v_add_u32 v10, 131072, v63
    ds_write_b64 v10, v[16:17] offset:0
    ds_write_b64 v10, v[18:19] offset:256
    ds_write_b64 v10, v[20:21] offset:512
    ds_write_b64 v10, v[22:23] offset:768
    ds_write_b64 v10, v[24:25] offset:1024
    s_waitcnt lgkmcnt(0)
L_st_j1:
    s_barrier
    s_cmp_ge_u32 s3, 4
    s_cbranch_scc1 L_kv_v
    ds_read_b128 v[64:67], v48 offset:0
    ds_read_b128 v[68:71], v48 offset:2048
    ds_read_b64_tr_b16 v[96:97], v50 offset:0
    ds_read_b64_tr_b16 v[98:99], v50 offset:1024
    ds_read_b64_tr_b16 v[100:101], v51 offset:0
    ds_read_b64_tr_b16 v[102:103], v51 offset:1024
    ds_read_b128 v[72:75], v48 offset:4096
    ds_read_b64_tr_b16 v[104:105], v52 offset:0
    ds_read_b64_tr_b16 v[106:107], v52 offset:1024
    ds_read_b64_tr_b16 v[108:109], v53 offset:0
    ds_read_b64_tr_b16 v[110:111], v53 offset:1024
    ds_read_b128 v[76:79], v48 offset:6144
    ds_read_b128 v[80:83], v48 offset:8192
    ds_read_b128 v[84:87], v48 offset:10240
    ds_read_b128 v[88:91], v48 offset:12288
    ds_read_b128 v[92:95], v48 offset:14336
    v_mov_b32 v3, 0x4000000
    v_mov_b32 v2, 0
    s_lshl_b32 s6, s4, 3
    s_add_u32 s6, s6, s5
    s_lshl_b32 s6, s6, 5
    s_add_u32 s6, s6, s3
    s_lshl_b32 s6, s6, 2
    s_add_u32 s6, s6, 3866624
    v_writelane_b32 v3, s6, 0
    s_lshl_b32 s6, s60, 5
    s_add_u32 s6, s6, s4
    s_lshl_b32 s6, s6, 7
    s_add_u32 s6, s6, 3932160
    v_writelane_b32 v3, s6, 1
    s_lshl_b32 s6, s61, 3
    s_add_u32 s6, s6, s3
    s_lshl_b32 s6, s6, 2
    s_add_u32 s6, s6, 3825664
    v_writelane_b32 v3, s6, 2
    s_lshl_b32 s6, s3, 2
    s_add_u32 s6, s6, 3801088
    s_cmp_eq_u32 s2, 0
    s_cselect_b32 s6, s6, 0x4000000
    v_writelane_b32 v3, s6, 3
    buffer_store_dword v2, v3, s[8:11], 0 offen sc1
    s_mov_b32 s65, 0
    s_lshl_b32 s6, s4, 20
    s_lshl_b32 s7, s5, 16
    s_add_u32 s6, s6, s7
    s_and_b32 s7, s3, 1
    s_lshl_b32 s7, s7, 15
    s_add_u32 s6, s6, s7
    s_add_u32 s67, s6, 16777216
    s_and_b32 s6, s4, 3
    s_add_u32 s6, s6, s5
    s_sub_u32 s7, s6, 5
    s_cselect_b32 s6, s6, s7
    s_sub_u32 s7, s6, 5
    s_cselect_b32 s6, s6, s7
    s_lshl_b32 s71, s6, 20
    s_lshl_b32 s7, s4, 8
    s_add_u32 s71, s71, s7
    s_lshl_b32 s7, s6, 12
    s_add_u32 s84, s70, s7
    s_add_u32 s6, s6, 1
    s_cmp_eq_u32 s6, 5
    s_cselect_b32 s6, 0, s6
    s_lshl_b32 s7, s6, 12
    s_add_u32 s85, s70, s7
    s_add_u32 s6, s6, 1
    s_cmp_eq_u32 s6, 5
    s_cselect_b32 s6, 0, s6
    s_lshl_b32 s7, s6, 12
    s_add_u32 s86, s70, s7
    s_add_u32 s6, s6, 1
    s_cmp_eq_u32 s6, 5
    s_cselect_b32 s6, 0, s6
    s_lshl_b32 s7, s6, 12
    s_add_u32 s87, s70, s7
    s_add_u32 s6, s6, 1
    s_cmp_eq_u32 s6, 5
    s_cselect_b32 s6, 0, s6
    s_lshl_b32 s7, s6, 12
    s_add_u32 s88, s70, s7
    s_lshr_b32 s7, s3, 1
    s_and_b32 s7, s7, 1
    s_lshl_b32 s7, s7, 11
    s_add_u32 s67, s67, s7
    s_movk_i32 s68, 3072
    s_movk_i32 s69, 3072
    s_add_u32 s71, s71, 1048576
    s_sub_u32 s75, s71, 5242880
    s_cselect_b32 s71, s71, s75
    s_lshl_b32 s74, s76, 12
.p2align 4
L_kloopA:
    s_waitcnt lgkmcnt(12)
    v_mfma_f32_16x16x32_bf16 v[128:131], v[96:99], v[64:67], v[128:131]
    ds_read_b64_tr_b16 v[112:113], v50 offset:8192
    s_waitcnt lgkmcnt(11)
    v_mfma_f32_16x16x32_bf16 v[132:135], v[100:103], v[64:67], v[132:135]
    ds_read_b64_tr_b16 v[114:115], v50 offset:9216
    s_waitcnt lgkmcnt(9)
    v_mfma_f32_16x16x32_bf16 v[136:139], v[104:107], v[64:67], v[136:139]
    ds_read_b64_tr_b16 v[116:117], v51 offset:8192
    s_waitcnt lgkmcnt(8)
    v_mfma_f32_16x16x32_bf16 v[140:143], v[108:111], v[64:67], v[140:143]
    ds_read_b64_tr_b16 v[118:119], v51 offset:9216
    ds_read_b128 v[64:67], v49 offset:0
    v_mfma_f32_16x16x32_bf16 v[144:147], v[96:99], v[68:71], v[144:147]
    ds_read_b64_tr_b16 v[120:121], v52 offset:8192
    v_mfma_f32_16x16x32_bf16 v[148:151], v[100:103], v[68:71], v[148:151]
    ds_read_b64_tr_b16 v[122:123], v52 offset:9216
    v_mfma_f32_16x16x32_bf16 v[152:155], v[104:107], v[68:71], v[152:155]
    ds_read_b64_tr_b16 v[124:125], v53 offset:8192
    v_mfma_f32_16x16x32_bf16 v[156:159], v[108:111], v[68:71], v[156:159]
    ds_read_b64_tr_b16 v[126:127], v53 offset:9216
    ds_read_b128 v[68:71], v49 offset:2048
    v_mfma_f32_16x16x32_bf16 v[160:163], v[96:99], v[72:75], v[160:163]
    v_mfma_f32_16x16x32_bf16 v[164:167], v[100:103], v[72:75], v[164:167]
    v_mfma_f32_16x16x32_bf16 v[168:171], v[104:107], v[72:75], v[168:171]
    v_mfma_f32_16x16x32_bf16 v[172:175], v[108:111], v[72:75], v[172:175]
    ds_read_b128 v[72:75], v49 offset:4096
    s_waitcnt lgkmcnt(15)
    v_mfma_f32_16x16x32_bf16 v[176:179], v[96:99], v[76:79], v[176:179]
    v_mfma_f32_16x16x32_bf16 v[180:183], v[100:103], v[76:79], v[180:183]
    v_mfma_f32_16x16x32_bf16 v[184:187], v[104:107], v[76:79], v[184:187]
    v_mfma_f32_16x16x32_bf16 v[188:191], v[108:111], v[76:79], v[188:191]
    ds_read_b128 v[76:79], v49 offset:6144
    s_waitcnt lgkmcnt(15)
    v_mfma_f32_16x16x32_bf16 v[192:195], v[96:99], v[80:83], v[192:195]
    v_mfma_f32_16x16x32_bf16 v[196:199], v[100:103], v[80:83], v[196:199]
    v_mfma_f32_16x16x32_bf16 v[200:203], v[104:107], v[80:83], v[200:203]
    v_mfma_f32_16x16x32_bf16 v[204:207], v[108:111], v[80:83], v[204:207]
    ds_read_b128 v[80:83], v49 offset:8192
    s_waitcnt lgkmcnt(15)
    v_mfma_f32_16x16x32_bf16 v[208:211], v[96:99], v[84:87], v[208:211]
    v_mfma_f32_16x16x32_bf16 v[212:215], v[100:103], v[84:87], v[212:215]
    v_mfma_f32_16x16x32_bf16 v[216:219], v[104:107], v[84:87], v[216:219]
    v_mfma_f32_16x16x32_bf16 v[220:223], v[108:111], v[84:87], v[220:223]
    ds_read_b128 v[84:87], v49 offset:10240
    s_waitcnt lgkmcnt(15)
    v_mfma_f32_16x16x32_bf16 v[224:227], v[96:99], v[88:91], v[224:227]
    v_mfma_f32_16x16x32_bf16 v[228:231], v[100:103], v[88:91], v[228:231]
    v_mfma_f32_16x16x32_bf16 v[232:235], v[104:107], v[88:91], v[232:235]
    v_mfma_f32_16x16x32_bf16 v[236:239], v[108:111], v[88:91], v[236:239]
    ds_read_b128 v[88:91], v49 offset:12288
    s_waitcnt lgkmcnt(15)
    v_mfma_f32_16x16x32_bf16 v[240:243], v[96:99], v[92:95], v[240:243]
    v_mfma_f32_16x16x32_bf16 v[244:247], v[100:103], v[92:95], v[244:247]
    v_mfma_f32_16x16x32_bf16 v[248:251], v[104:107], v[92:95], v[248:251]
    v_mfma_f32_16x16x32_bf16 v[252:255], v[108:111], v[92:95], v[252:255]
    ds_read_b128 v[92:95], v49 offset:14336
    s_waitcnt lgkmcnt(11)
    v_mfma_f32_16x16x32_bf16 v[128:131], v[112:115], v[64:67], v[128:131]
    v_mfma_f32_16x16x32_bf16 v[132:135], v[116:119], v[64:67], v[132:135]
    s_waitcnt lgkmcnt(9)
    v_mfma_f32_16x16x32_bf16 v[136:139], v[120:123], v[64:67], v[136:139]
    s_waitcnt lgkmcnt(7)
    v_mfma_f32_16x16x32_bf16 v[140:143], v[124:127], v[64:67], v[140:143]
    s_waitcnt lgkmcnt(6)
    v_mfma_f32_16x16x32_bf16 v[144:147], v[112:115], v[68:71], v[144:147]
    v_mfma_f32_16x16x32_bf16 v[148:151], v[116:119], v[68:71], v[148:151]
    v_mfma_f32_16x16x32_bf16 v[152:155], v[120:123], v[68:71], v[152:155]
    v_mfma_f32_16x16x32_bf16 v[156:159], v[124:127], v[68:71], v[156:159]
    v_xor_b32 v48, 0x10000, v48
    v_xor_b32 v49, 0x10000, v49
    v_xor_b32 v50, 0x10000, v50
    v_xor_b32 v51, 0x10000, v51
    v_xor_b32 v52, 0x10000, v52
    v_xor_b32 v53, 0x10000, v53
    s_waitcnt vmcnt(0) lgkmcnt(0)
    s_barrier
    ds_read_b128 v[64:67], v48 offset:0
    ds_read_b128 v[68:71], v48 offset:2048
    v_mfma_f32_16x16x32_bf16 v[160:163], v[112:115], v[72:75], v[160:163]
    ds_read_b64_tr_b16 v[96:97], v50 offset:0
    s_mov_b32 m0, s64
    s_add_u32 s72, s62, 32768
    v_mfma_f32_16x16x32_bf16 v[164:167], v[116:119], v[72:75], v[164:167]
    ds_read_b64_tr_b16 v[98:99], v50 offset:1024
    buffer_load_dwordx4 v40, s[12:15], s62 offen offset:0 lds
    v_mfma_f32_16x16x32_bf16 v[168:171], v[120:123], v[72:75], v[168:171]
    ds_read_b64_tr_b16 v[100:101], v51 offset:0
    buffer_load_dwordx4 v41, s[12:15], s62 offen offset:1024 lds
    v_mfma_f32_16x16x32_bf16 v[172:175], v[124:127], v[72:75], v[172:175]
    ds_read_b64_tr_b16 v[102:103], v51 offset:1024
    buffer_load_dwordx4 v42, s[12:15], s62 offen offset:2048 lds
    ds_read_b128 v[72:75], v48 offset:4096
    v_mfma_f32_16x16x32_bf16 v[176:179], v[112:115], v[76:79], v[176:179]
    ds_read_b64_tr_b16 v[104:105], v52 offset:0
    buffer_load_dwordx4 v43, s[12:15], s62 offen offset:3072 lds
    v_mfma_f32_16x16x32_bf16 v[180:183], v[116:119], v[76:79], v[180:183]
    ds_read_b64_tr_b16 v[106:107], v52 offset:1024
    s_add_u32 m0, s64, 4096
    s_add_u32 s62, s62, 128
    s_bitset0_b32 s62, 10
    v_mfma_f32_16x16x32_bf16 v[184:187], v[120:123], v[76:79], v[184:187]
    ds_read_b64_tr_b16 v[108:109], v53 offset:0
    buffer_load_dwordx4 v40, s[12:15], s72 offen offset:0 lds
    v_mfma_f32_16x16x32_bf16 v[188:191], v[124:127], v[76:79], v[188:191]
    ds_read_b64_tr_b16 v[110:111], v53 offset:1024
    buffer_load_dwordx4 v41, s[12:15], s72 offen offset:1024 lds
    ds_read_b128 v[76:79], v48 offset:6144
    v_mfma_f32_16x16x32_bf16 v[192:195], v[112:115], v[80:83], v[192:195]
    buffer_load_dwordx4 v42, s[12:15], s72 offen offset:2048 lds
    v_mfma_f32_16x16x32_bf16 v[196:199], v[116:119], v[80:83], v[196:199]
    buffer_load_dwordx4 v43, s[12:15], s72 offen offset:3072 lds
    v_mfma_f32_16x16x32_bf16 v[200:203], v[120:123], v[80:83], v[200:203]
    s_mov_b32 m0, s73
    s_xor_b32 s64, s64, 0x10000
    v_mfma_f32_16x16x32_bf16 v[204:207], v[124:127], v[80:83], v[204:207]
    buffer_load_dwordx4 v44, s[16:19], s63 offen offset:0 lds
    ds_read_b128 v[80:83], v48 offset:8192
    v_mfma_f32_16x16x32_bf16 v[208:211], v[112:115], v[84:87], v[208:211]
    buffer_load_dwordx4 v45, s[16:19], s63 offen offset:1024 lds
    v_mfma_f32_16x16x32_bf16 v[212:215], v[116:119], v[84:87], v[212:215]
    buffer_load_dwordx4 v46, s[16:19], s63 offen offset:2048 lds
    v_mfma_f32_16x16x32_bf16 v[216:219], v[120:123], v[84:87], v[216:219]
    buffer_load_dwordx4 v47, s[16:19], s63 offen offset:3072 lds
    v_mfma_f32_16x16x32_bf16 v[220:223], v[124:127], v[84:87], v[220:223]
    s_add_u32 m0, s73, 16384
    s_xor_b32 s73, s73, 0x10000
    ds_read_b128 v[84:87], v48 offset:10240
    v_mfma_f32_16x16x32_bf16 v[224:227], v[112:115], v[88:91], v[224:227]
    buffer_load_dwordx4 v44, s[20:23], s63 offen offset:0 lds
    v_mfma_f32_16x16x32_bf16 v[228:231], v[116:119], v[88:91], v[228:231]
    buffer_load_dwordx4 v45, s[20:23], s63 offen offset:1024 lds
    v_mfma_f32_16x16x32_bf16 v[232:235], v[120:123], v[88:91], v[232:235]
    buffer_load_dwordx4 v46, s[20:23], s63 offen offset:2048 lds
    v_mfma_f32_16x16x32_bf16 v[236:239], v[124:127], v[88:91], v[236:239]
    buffer_load_dwordx4 v47, s[20:23], s63 offen offset:3072 lds
    ds_read_b128 v[88:91], v48 offset:12288
    v_mfma_f32_16x16x32_bf16 v[240:243], v[112:115], v[92:95], v[240:243]
    s_add_u32 s63, s63, 524288
    s_bitset0_b32 s63, 22
    v_mfma_f32_16x16x32_bf16 v[244:247], v[116:119], v[92:95], v[244:247]
    v_mfma_f32_16x16x32_bf16 v[248:251], v[120:123], v[92:95], v[248:251]
    v_mfma_f32_16x16x32_bf16 v[252:255], v[124:127], v[92:95], v[252:255]
    ds_read_b128 v[92:95], v48 offset:14336
    s_add_u32 s65, s65, 1
    s_cmp_lt_u32 s65, 6
    s_cbranch_scc1 L_kloopA
    buffer_load_dwordx4 v[16:19], v13, s[8:11], s84 offen offset:0 sc1
    buffer_load_dwordx4 v[20:23], v12, s[8:11], s84 offen offset:0 sc1
    buffer_load_dwordx4 v[24:27], v13, s[8:11], s84 offen offset:1024 sc1
    buffer_load_dwordx4 v[28:31], v12, s[8:11], s84 offen offset:1024 sc1
    buffer_load_dwordx4 v[32:35], v13, s[8:11], s84 offen offset:2048 sc1
    buffer_load_dwordx4 v[36:39], v12, s[8:11], s84 offen offset:2048 sc1
.p2align 4
L_kloopB:
    s_waitcnt lgkmcnt(12)
    v_mfma_f32_16x16x32_bf16 v[128:131], v[96:99], v[64:67], v[128:131]
    ds_read_b64_tr_b16 v[112:113], v50 offset:8192
    s_waitcnt lgkmcnt(11)
    v_mfma_f32_16x16x32_bf16 v[132:135], v[100:103], v[64:67], v[132:135]
    ds_read_b64_tr_b16 v[114:115], v50 offset:9216
    s_waitcnt lgkmcnt(9)
    v_mfma_f32_16x16x32_bf16 v[136:139], v[104:107], v[64:67], v[136:139]
    ds_read_b64_tr_b16 v[116:117], v51 offset:8192
    s_waitcnt lgkmcnt(8)
    v_mfma_f32_16x16x32_bf16 v[140:143], v[108:111], v[64:67], v[140:143]
    ds_read_b64_tr_b16 v[118:119], v51 offset:9216
    ds_read_b128 v[64:67], v49 offset:0
    v_mfma_f32_16x16x32_bf16 v[144:147], v[96:99], v[68:71], v[144:147]
    ds_read_b64_tr_b16 v[120:121], v52 offset:8192
    v_mfma_f32_16x16x32_bf16 v[148:151], v[100:103], v[68:71], v[148:151]
    ds_read_b64_tr_b16 v[122:123], v52 offset:9216
    v_mfma_f32_16x16x32_bf16 v[152:155], v[104:107], v[68:71], v[152:155]
    ds_read_b64_tr_b16 v[124:125], v53 offset:8192
    v_mfma_f32_16x16x32_bf16 v[156:159], v[108:111], v[68:71], v[156:159]
    ds_read_b64_tr_b16 v[126:127], v53 offset:9216
    ds_read_b128 v[68:71], v49 offset:2048
    v_mfma_f32_16x16x32_bf16 v[160:163], v[96:99], v[72:75], v[160:163]
    v_mfma_f32_16x16x32_bf16 v[164:167], v[100:103], v[72:75], v[164:167]
    v_mfma_f32_16x16x32_bf16 v[168:171], v[104:107], v[72:75], v[168:171]
    v_mfma_f32_16x16x32_bf16 v[172:175], v[108:111], v[72:75], v[172:175]
    ds_read_b128 v[72:75], v49 offset:4096
    s_waitcnt lgkmcnt(15)
    v_mfma_f32_16x16x32_bf16 v[176:179], v[96:99], v[76:79], v[176:179]
    v_mfma_f32_16x16x32_bf16 v[180:183], v[100:103], v[76:79], v[180:183]
    v_mfma_f32_16x16x32_bf16 v[184:187], v[104:107], v[76:79], v[184:187]
    v_mfma_f32_16x16x32_bf16 v[188:191], v[108:111], v[76:79], v[188:191]
    ds_read_b128 v[76:79], v49 offset:6144
    s_waitcnt lgkmcnt(15)
    v_mfma_f32_16x16x32_bf16 v[192:195], v[96:99], v[80:83], v[192:195]
    v_mfma_f32_16x16x32_bf16 v[196:199], v[100:103], v[80:83], v[196:199]
    v_mfma_f32_16x16x32_bf16 v[200:203], v[104:107], v[80:83], v[200:203]
    v_mfma_f32_16x16x32_bf16 v[204:207], v[108:111], v[80:83], v[204:207]
    ds_read_b128 v[80:83], v49 offset:8192
    s_waitcnt lgkmcnt(15)
    v_mfma_f32_16x16x32_bf16 v[208:211], v[96:99], v[84:87], v[208:211]
    v_mfma_f32_16x16x32_bf16 v[212:215], v[100:103], v[84:87], v[212:215]
    v_mfma_f32_16x16x32_bf16 v[216:219], v[104:107], v[84:87], v[216:219]
    v_mfma_f32_16x16x32_bf16 v[220:223], v[108:111], v[84:87], v[220:223]
    ds_read_b128 v[84:87], v49 offset:10240
    s_waitcnt lgkmcnt(15)
    v_mfma_f32_16x16x32_bf16 v[224:227], v[96:99], v[88:91], v[224:227]
    v_mfma_f32_16x16x32_bf16 v[228:231], v[100:103], v[88:91], v[228:231]
    v_mfma_f32_16x16x32_bf16 v[232:235], v[104:107], v[88:91], v[232:235]
    v_mfma_f32_16x16x32_bf16 v[236:239], v[108:111], v[88:91], v[236:239]
    ds_read_b128 v[88:91], v49 offset:12288
    s_waitcnt lgkmcnt(15)
    v_mfma_f32_16x16x32_bf16 v[240:243], v[96:99], v[92:95], v[240:243]
    v_mfma_f32_16x16x32_bf16 v[244:247], v[100:103], v[92:95], v[244:247]
    v_mfma_f32_16x16x32_bf16 v[248:251], v[104:107], v[92:95], v[248:251]
    v_mfma_f32_16x16x32_bf16 v[252:255], v[108:111], v[92:95], v[252:255]
    ds_read_b128 v[92:95], v49 offset:14336
    s_waitcnt lgkmcnt(11)
    v_mfma_f32_16x16x32_bf16 v[128:131], v[112:115], v[64:67], v[128:131]
    v_mfma_f32_16x16x32_bf16 v[132:135], v[116:119], v[64:67], v[132:135]
    s_waitcnt lgkmcnt(9)
    v_mfma_f32_16x16x32_bf16 v[136:139], v[120:123], v[64:67], v[136:139]
    s_waitcnt lgkmcnt(7)
    v_mfma_f32_16x16x32_bf16 v[140:143], v[124:127], v[64:67], v[140:143]
    s_waitcnt lgkmcnt(6)
    v_mfma_f32_16x16x32_bf16 v[144:147], v[112:115], v[68:71], v[144:147]
    v_mfma_f32_16x16x32_bf16 v[148:151], v[116:119], v[68:71], v[148:151]
    v_mfma_f32_16x16x32_bf16 v[152:155], v[120:123], v[68:71], v[152:155]
    v_mfma_f32_16x16x32_bf16 v[156:159], v[124:127], v[68:71], v[156:159]
    v_xor_b32 v48, 0x10000, v48
    v_xor_b32 v49, 0x10000, v49
    v_xor_b32 v50, 0x10000, v50
    v_xor_b32 v51, 0x10000, v51
    v_xor_b32 v52, 0x10000, v52
    v_xor_b32 v53, 0x10000, v53
    s_waitcnt vmcnt(0) lgkmcnt(0)
    s_barrier
    ds_read_b128 v[64:67], v48 offset:0
    ds_read_b128 v[68:71], v48 offset:2048
    v_mfma_f32_16x16x32_bf16 v[160:163], v[112:115], v[72:75], v[160:163]
    ds_read_b64_tr_b16 v[96:97], v50 offset:0
    s_mov_b32 m0, s74
    s_add_u32 s74, s74, 16384
    v_mfma_f32_16x16x32_bf16 v[164:167], v[116:119], v[72:75], v[164:167]
    ds_read_b64_tr_b16 v[98:99], v50 offset:1024
    buffer_load_dwordx4 v44, s[24:27], s71 offen offset:0 lds
    v_mfma_f32_16x16x32_bf16 v[168:171], v[120:123], v[72:75], v[168:171]
    ds_read_b64_tr_b16 v[100:101], v51 offset:0
    buffer_load_dwordx4 v45, s[24:27], s71 offen offset:1024 lds
    v_mfma_f32_16x16x32_bf16 v[172:175], v[124:127], v[72:75], v[172:175]
    ds_read_b64_tr_b16 v[102:103], v51 offset:1024
    buffer_load_dwordx4 v46, s[24:27], s71 offen offset:2048 lds
    ds_read_b128 v[72:75], v48 offset:4096
    v_mfma_f32_16x16x32_bf16 v[176:179], v[112:115], v[76:79], v[176:179]
    ds_read_b64_tr_b16 v[104:105], v52 offset:0
    buffer_load_dwordx4 v47, s[24:27], s71 offen offset:3072 lds
    v_mfma_f32_16x16x32_bf16 v[180:183], v[116:119], v[76:79], v[180:183]
    ds_read_b64_tr_b16 v[106:107], v52 offset:1024
    s_add_u32 s71, s71, 524288
    s_sub_u32 s75, s71, 5242880
    s_cselect_b32 s71, s71, s75
    v_mfma_f32_16x16x32_bf16 v[184:187], v[120:123], v[76:79], v[184:187]
    ds_read_b64_tr_b16 v[108:109], v53 offset:0
    s_mov_b32 m0, s74
    s_add_u32 s74, s74, 16384
    v_mfma_f32_16x16x32_bf16 v[188:191], v[124:127], v[76:79], v[188:191]
    ds_read_b64_tr_b16 v[110:111], v53 offset:1024
    buffer_load_dwordx4 v44, s[24:27], s71 offen offset:0 lds
    ds_read_b128 v[76:79], v48 offset:6144
    v_mfma_f32_16x16x32_bf16 v[192:195], v[112:115], v[80:83], v[192:195]
    buffer_load_dwordx4 v45, s[24:27], s71 offen offset:1024 lds
    v_mfma_f32_16x16x32_bf16 v[196:199], v[116:119], v[80:83], v[196:199]
    buffer_load_dwordx4 v46, s[24:27], s71 offen offset:2048 lds
    v_mfma_f32_16x16x32_bf16 v[200:203], v[120:123], v[80:83], v[200:203]
    buffer_load_dwordx4 v47, s[24:27], s71 offen offset:3072 lds
    v_mfma_f32_16x16x32_bf16 v[204:207], v[124:127], v[80:83], v[204:207]
    s_add_u32 s71, s71, 524288
    s_sub_u32 s75, s71, 5242880
    s_cselect_b32 s71, s71, s75
    ds_read_b128 v[80:83], v48 offset:8192
    v_mfma_f32_16x16x32_bf16 v[208:211], v[112:115], v[84:87], v[208:211]
    s_mov_b32 m0, s74
    s_add_u32 s74, s74, 16384
    v_mfma_f32_16x16x32_bf16 v[212:215], v[116:119], v[84:87], v[212:215]
    buffer_load_dwordx4 v44, s[24:27], s71 offen offset:0 lds
    v_mfma_f32_16x16x32_bf16 v[216:219], v[120:123], v[84:87], v[216:219]
    buffer_load_dwordx4 v45, s[24:27], s71 offen offset:1024 lds
    v_mfma_f32_16x16x32_bf16 v[220:223], v[124:127], v[84:87], v[220:223]
    buffer_load_dwordx4 v46, s[24:27], s71 offen offset:2048 lds
    ds_read_b128 v[84:87], v48 offset:10240
    v_mfma_f32_16x16x32_bf16 v[224:227], v[112:115], v[88:91], v[224:227]
    buffer_load_dwordx4 v47, s[24:27], s71 offen offset:3072 lds
    v_mfma_f32_16x16x32_bf16 v[228:231], v[116:119], v[88:91], v[228:231]
    s_add_u32 s71, s71, 524288
    s_sub_u32 s75, s71, 5242880
    s_cselect_b32 s71, s71, s75
    v_mfma_f32_16x16x32_bf16 v[232:235], v[120:123], v[88:91], v[232:235]
    s_mov_b32 m0, s74
    s_add_u32 s74, s74, 16384
    v_mfma_f32_16x16x32_bf16 v[236:239], v[124:127], v[88:91], v[236:239]
    buffer_load_dwordx4 v44, s[24:27], s71 offen offset:0 lds
    ds_read_b128 v[88:91], v48 offset:12288
    v_mfma_f32_16x16x32_bf16 v[240:243], v[112:115], v[92:95], v[240:243]
    buffer_load_dwordx4 v45, s[24:27], s71 offen offset:1024 lds
    v_mfma_f32_16x16x32_bf16 v[244:247], v[116:119], v[92:95], v[244:247]
    buffer_load_dwordx4 v46, s[24:27], s71 offen offset:2048 lds
    v_mfma_f32_16x16x32_bf16 v[248:251], v[120:123], v[92:95], v[248:251]
    buffer_load_dwordx4 v47, s[24:27], s71 offen offset:3072 lds
    v_mfma_f32_16x16x32_bf16 v[252:255], v[124:127], v[92:95], v[252:255]
    s_add_u32 s71, s71, 524288
    s_sub_u32 s75, s71, 5242880
    s_cselect_b32 s71, s71, s75
    ds_read_b128 v[92:95], v48 offset:14336
    s_add_u32 s65, s65, 1
    s_cmp_lt_u32 s65, 8
    s_cbranch_scc1 L_kloopB
    s_waitcnt lgkmcnt(0)
    s_nop 7
    v_cvt_pk_bf16_f32 v128, v128, v129
    v_cvt_pk_bf16_f32 v129, v130, v131
    v_cvt_pk_bf16_f32 v130, v132, v133
    v_cvt_pk_bf16_f32 v131, v134, v135
    v_cvt_pk_bf16_f32 v132, v136, v137
    v_cvt_pk_bf16_f32 v133, v138, v139
    v_cvt_pk_bf16_f32 v134, v140, v141
    v_cvt_pk_bf16_f32 v135, v142, v143
    v_cvt_pk_bf16_f32 v136, v144, v145
    v_cvt_pk_bf16_f32 v137, v146, v147
    v_cvt_pk_bf16_f32 v138, v148, v149
    v_cvt_pk_bf16_f32 v139, v150, v151
    v_cvt_pk_bf16_f32 v140, v152, v153
    v_cvt_pk_bf16_f32 v141, v154, v155
    v_cvt_pk_bf16_f32 v142, v156, v157
    v_cvt_pk_bf16_f32 v143, v158, v159
    v_cvt_pk_bf16_f32 v144, v160, v161
    v_cvt_pk_bf16_f32 v145, v162, v163
    v_cvt_pk_bf16_f32 v146, v164, v165
    v_cvt_pk_bf16_f32 v147, v166, v167
    v_cvt_pk_bf16_f32 v148, v168, v169
    v_cvt_pk_bf16_f32 v149, v170, v171
    v_cvt_pk_bf16_f32 v150, v172, v173
    v_cvt_pk_bf16_f32 v151, v174, v175
    v_cvt_pk_bf16_f32 v152, v176, v177
    v_cvt_pk_bf16_f32 v153, v178, v179
    v_cvt_pk_bf16_f32 v154, v180, v181
    v_cvt_pk_bf16_f32 v155, v182, v183
    v_cvt_pk_bf16_f32 v156, v184, v185
    v_cvt_pk_bf16_f32 v157, v186, v187
    v_cvt_pk_bf16_f32 v158, v188, v189
    v_cvt_pk_bf16_f32 v159, v190, v191
    v_cvt_pk_bf16_f32 v160, v192, v193
    v_cvt_pk_bf16_f32 v161, v194, v195
    v_cvt_pk_bf16_f32 v162, v196, v197
    v_cvt_pk_bf16_f32 v163, v198, v199
    v_cvt_pk_bf16_f32 v164, v200, v201
    v_cvt_pk_bf16_f32 v165, v202, v203
    v_cvt_pk_bf16_f32 v166, v204, v205
    v_cvt_pk_bf16_f32 v167, v206, v207
    v_cvt_pk_bf16_f32 v168, v208, v209
    v_cvt_pk_bf16_f32 v169, v210, v211
    v_cvt_pk_bf16_f32 v170, v212, v213
    v_cvt_pk_bf16_f32 v171, v214, v215
    v_cvt_pk_bf16_f32 v172, v216, v217
    v_cvt_pk_bf16_f32 v173, v218, v219
    v_cvt_pk_bf16_f32 v174, v220, v221
    v_cvt_pk_bf16_f32 v175, v222, v223
    v_cvt_pk_bf16_f32 v176, v224, v225
    v_cvt_pk_bf16_f32 v177, v226, v227
    v_cvt_pk_bf16_f32 v178, v228, v229
    v_cvt_pk_bf16_f32 v179, v230, v231
    v_cvt_pk_bf16_f32 v180, v232, v233
    v_cvt_pk_bf16_f32 v181, v234, v235
    v_cvt_pk_bf16_f32 v182, v236, v237
    v_cvt_pk_bf16_f32 v183, v238, v239
    v_cvt_pk_bf16_f32 v184, v240, v241
    v_cvt_pk_bf16_f32 v185, v242, v243
    v_cvt_pk_bf16_f32 v186, v244, v245
    v_cvt_pk_bf16_f32 v187, v246, v247
    v_cvt_pk_bf16_f32 v188, v248, v249
    v_cvt_pk_bf16_f32 v189, v250, v251
    v_cvt_pk_bf16_f32 v190, v252, v253
    v_cvt_pk_bf16_f32 v191, v254, v255
    s_branch L_q
L_hook:
    s_cmp_eq_u32 s65, 1
    s_cbranch_scc1 L_hook1
    s_cmp_eq_u32 s65, 2
    s_cbranch_scc1 L_hook2
    s_cmp_eq_u32 s65, 3
    s_cbranch_scc1 L_hook3
    s_cmp_eq_u32 s65, 4
    s_cbranch_scc1 L_hook4
    s_cmp_eq_u32 s65, 5
    s_cbranch_scc1 L_hook5
    s_cmp_eq_u32 s65, 6
    s_cbranch_scc1 L_hook6
    s_cmp_lg_u32 s65, 7
    s_cbranch_scc1 L_hook_back
    buffer_load_dwordx4 v[16:19], v13, s[8:11], s84 offen offset:0 sc1
    buffer_load_dwordx4 v[20:23], v12, s[8:11], s84 offen offset:0 sc1
    buffer_load_dwordx4 v[24:27], v13, s[8:11], s84 offen offset:1024 sc1
    buffer_load_dwordx4 v[28:31], v12, s[8:11], s84 offen offset:1024 sc1
    buffer_load_dwordx4 v[32:35], v13, s[8:11], s84 offen offset:2048 sc1
    buffer_load_dwordx4 v[36:39], v12, s[8:11], s84 offen offset:2048 sc1
    s_branch L_hook_back
L_hook1:
    s_cmp_lg_u32 s3, 4
    s_cbranch_scc1 L_hook1b
    s_mov_b32 s28, s56
    s_mov_b32 s29, s57
    s_mov_b32 s30, 0x100
    s_mov_b32 s31, 0x20000
    v_mov_b32 v2, 1
    v_lshlrev_b32 v3, 8, v1
    buffer_atomic_add v2, v3, s[28:31], 0 offen offset:0 sc1
L_hook1b:
    s_cmp_ge_u32 s76, 2
    s_cbranch_scc1 L_tch_2a
    s_and_b32 s6, s4, 3
    s_lshl_b32 s6, s6, 16
    s_lshl_b32 s7, s5, 18
    s_add_u32 s6, s6, s7
    s_lshl_b32 s7, s76, 7
    s_add_u32 s6, s6, s7
    s_add_u32 s6, s6, 640
    v_lshrrev_b32 v6, 1, v1
    v_lshlrev_b32 v6, 10, v6
    v_and_b32 v7, 1, v1
    v_lshl_add_u32 v6, v7, 6, v6
    buffer_load_dword v11, v6, s[12:15], s6 offen
    s_add_u32 s6, s6, 32768
    buffer_load_dword v11, v6, s[12:15], s6 offen
    s_branch L_tch_2c
L_tch_2a:
    v_lshrrev_b32 v6, 5, v1
    v_lshlrev_b32 v6, 6, v6
    v_bfe_u32 v7, v1, 2, 3
    v_add_u32 v6, v6, v7
    v_lshlrev_b32 v6, 13, v6
    v_and_b32 v7, 3, v1
    v_lshl_add_u32 v6, v7, 6, v6
    s_lshl_b32 s6, s4, 8
    s_lshl_b32 s7, s5, 16
    s_add_u32 s6, s6, s7
    s_add_u32 s6, s6, 2621440
    s_cmp_lg_u32 s76, 2
    s_cbranch_scc1 L_tch_2b
    buffer_load_dword v11, v6, s[16:19], s6 offen
    s_branch L_tch_2c
L_tch_2b:
    buffer_load_dword v11, v6, s[20:23], s6 offen
L_tch_2c:
    s_branch L_hook_back
L_hook2:
    s_cmp_ge_u32 s76, 2
    s_cbranch_scc1 L_tch_3a
    s_and_b32 s6, s4, 3
    s_lshl_b32 s6, s6, 16
    s_lshl_b32 s7, s5, 18
    s_add_u32 s6, s6, s7
    s_lshl_b32 s7, s76, 7
    s_add_u32 s6, s6, s7
    s_add_u32 s6, s6, 768
    v_lshrrev_b32 v6, 1, v1
    v_lshlrev_b32 v6, 10, v6
    v_and_b32 v7, 1, v1
    v_lshl_add_u32 v6, v7, 6, v6
    buffer_load_dword v11, v6, s[12:15], s6 offen
    s_add_u32 s6, s6, 32768
    buffer_load_dword v11, v6, s[12:15], s6 offen
    s_branch L_tch_3c
L_tch_3a:
    v_lshrrev_b32 v6, 5, v1
    v_lshlrev_b32 v6, 6, v6
    v_bfe_u32 v7, v1, 2, 3
    v_add_u32 v6, v6, v7
    v_lshlrev_b32 v6, 13, v6
    v_and_b32 v7, 3, v1
    v_lshl_add_u32 v6, v7, 6, v6
    s_lshl_b32 s6, s4, 8
    s_lshl_b32 s7, s5, 16
    s_add_u32 s6, s6, s7
    s_add_u32 s6, s6, 3145728
    s_cmp_lg_u32 s76, 2
    s_cbranch_scc1 L_tch_3b
    buffer_load_dword v11, v6, s[16:19], s6 offen
    s_branch L_tch_3c
L_tch_3b:
    buffer_load_dword v11, v6, s[20:23], s6 offen
L_tch_3c:
    s_mov_b32 s28, s42
    s_mov_b32 s29, s43
    s_mov_b32 s30, 0x500000
    s_mov_b32 s31, 0x20000
    s_lshr_b32 s73, s2, 1
    s_mul_i32 s73, s73, 40960
    s_and_b32 s6, s2, 1
    s_mul_i32 s6, s6, 640
    s_add_u32 s73, s73, s6
    s_movk_i32 s7, 1639
    s_mul_i32 s74, s76, 5120
    s_add_u32 s74, s74, 141312
    s_mul_i32 s6, s76, 320
    v_add_u32 v9, s6, v1
    v_add_u32 v2, 0, v9
    v_mul_lo_u32 v3, v2, s7
    v_lshrrev_b32 v3, 16, v3
    v_mul_u32_u24 v4, 40, v3
    v_sub_u32 v4, v2, v4
    v_mul_u32_u24 v3, 1280, v3
    v_lshl_add_u32 v3, v4, 4, v3
    s_add_u32 m0, s74, 0
    s_nop 0
    buffer_load_dwordx4 v3, s[28:31], s73 offen lds
    v_add_u32 v2, 64, v9
    v_mul_lo_u32 v3, v2, s7
    v_lshrrev_b32 v3, 16, v3
    v_mul_u32_u24 v4, 40, v3
    v_sub_u32 v4, v2, v4
    v_mul_u32_u24 v3, 1280, v3
    v_lshl_add_u32 v3, v4, 4, v3
    s_add_u32 m0, s74, 1024
    s_nop 0
    buffer_load_dwordx4 v3, s[28:31], s73 offen lds
    v_add_u32 v2, 128, v9
    v_mul_lo_u32 v3, v2, s7
    v_lshrrev_b32 v3, 16, v3
    v_mul_u32_u24 v4, 40, v3
    v_sub_u32 v4, v2, v4
    v_mul_u32_u24 v3, 1280, v3
    v_lshl_add_u32 v3, v4, 4, v3
    s_add_u32 m0, s74, 2048
    s_nop 0
    buffer_load_dwordx4 v3, s[28:31], s73 offen lds
    v_add_u32 v2, 192, v9
    v_mul_lo_u32 v3, v2, s7
    v_lshrrev_b32 v3, 16, v3
    v_mul_u32_u24 v4, 40, v3
    v_sub_u32 v4, v2, v4
    v_mul_u32_u24 v3, 1280, v3
    v_lshl_add_u32 v3, v4, 4, v3
    s_add_u32 m0, s74, 3072
    s_nop 0
    buffer_load_dwordx4 v3, s[28:31], s73 offen lds
    v_add_u32 v2, 256, v9
    v_mul_lo_u32 v3, v2, s7
    v_lshrrev_b32 v3, 16, v3
    v_mul_u32_u24 v4, 40, v3
    v_sub_u32 v4, v2, v4
    v_mul_u32_u24 v3, 1280, v3
    v_lshl_add_u32 v3, v4, 4, v3
    s_add_u32 m0, s74, 4096
    s_nop 0
    buffer_load_dwordx4 v3, s[28:31], s73 offen lds
L_hook3:
    s_branch L_hook_back
L_hook4:
    v_and_b32 v2, 15, v1
    v_lshrrev_b32 v3, 4, v1
    v_lshrrev_b32 v4, 2, v2
    v_lshl_add_u32 v4, v3, 2, v4
    v_mul_u32_u24 v4, 640, v4
    v_and_b32 v2, 3, v2
    v_lshl_add_u32 v4, v2, 3, v4
    s_mul_i32 s6, s76, 160
    s_add_u32 s6, s6, 141312
    v_add_u32 v4, s6, v4
    s_mul_i32 s6, s2, 20480
    s_mul_i32 s7, s76, 5120
    s_add_u32 s6, s6, s7
    s_add_u32 s6, s6, 4194304
    s_add_u32 s7, s6, 4096
    ds_read_b64_tr_b16 v[16:17], v4 offset:0
    ds_read_b64_tr_b16 v[18:19], v4 offset:10240
    ds_read_b64_tr_b16 v[20:21], v4 offset:32
    ds_read_b64_tr_b16 v[22:23], v4 offset:10272
    ds_read_b64_tr_b16 v[24:25], v4 offset:64
    ds_read_b64_tr_b16 v[26:27], v4 offset:10304
    ds_read_b64_tr_b16 v[28:29], v4 offset:96
    ds_read_b64_tr_b16 v[30:31], v4 offset:10336
    ds_read_b64_tr_b16 v[32:33], v4 offset:128
    ds_read_b64_tr_b16 v[34:35], v4 offset:10368
    s_waitcnt lgkmcnt(0)
    buffer_store_dwordx4 v[16:19], v13, s[8:11], s6 offen offset:0 sc1
    buffer_store_dwordx4 v[20:23], v13, s[8:11], s6 offen offset:1024 sc1
    buffer_store_dwordx4 v[24:27], v13, s[8:11], s6 offen offset:2048 sc1
    buffer_store_dwordx4 v[28:31], v13, s[8:11], s6 offen offset:3072 sc1
    buffer_store_dwordx4 v[32:35], v13, s[8:11], s7 offen offset:0 sc1
    s_mov_b32 s28, s56
    s_mov_b32 s29, s57
    s_mov_b32 s30, 0x100
    s_mov_b32 s31, 0x20000
    v_mov_b32 v3, 0
    buffer_load_dword v62, v3, s[28:31], 0 offen sc1
    s_branch L_hook_back
L_hook5:
    s_waitcnt vmcnt(0)
    v_cmp_gt_u32 vcc, 0x100, v62
    s_cbranch_vccz L_hook5b
    s_mov_b32 s28, s56
    s_mov_b32 s29, s57
    s_mov_b32 s30, 0x100
    s_mov_b32 s31, 0x20000
    v_mov_b32 v3, 0
    s_mov_b32 s79, 262144
L_poll_4:
    buffer_load_dword v2, v3, s[28:31], 0 offen offset:0 sc1
    s_waitcnt vmcnt(0)
    v_cmp_gt_u32 vcc, 0x100, v2
    s_cbranch_vccz L_polldone_5
    s_sleep 2
    s_sub_u32 s79, s79, 1
    s_cmp_lg_u32 s79, 0
    s_cbranch_scc1 L_poll_4
L_polldone_5:
L_hook5b:
    s_lshl_b32 s74, s76, 12
    s_add_u32 s74, s74, 131072
    s_mov_b32 m0, s74
    s_add_u32 s74, s74, 16384
    buffer_load_dwordx4 v44, s[24:27], s71 offen offset:0 lds
    buffer_load_dwordx4 v45, s[24:27], s71 offen offset:1024 lds
    buffer_load_dwordx4 v46, s[24:27], s71 offen offset:2048 lds
    buffer_load_dwordx4 v47, s[24:27], s71 offen offset:3072 lds
    s_add_u32 s71, s71, 524288
    s_sub_u32 s75, s71, 5242880
    s_cselect_b32 s71, s71, s75
    s_mov_b32 m0, s74
    s_add_u32 s74, s74, 16384
    buffer_load_dwordx4 v44, s[24:27], s71 offen offset:0 lds
    buffer_load_dwordx4 v45, s[24:27], s71 offen offset:1024 lds
    buffer_load_dwordx4 v46, s[24:27], s71 offen offset:2048 lds
    buffer_load_dwordx4 v47, s[24:27], s71 offen offset:3072 lds
    s_add_u32 s71, s71, 524288
    s_sub_u32 s75, s71, 5242880
    s_cselect_b32 s71, s71, s75
    s_branch L_hook_back
L_hook6:
    s_cmp_lg_u32 s3, 4
    s_cbranch_scc1 L_hook_back
    s_mov_b32 s28, s56
    s_mov_b32 s29, s57
    s_mov_b32 s30, 0x100
    s_mov_b32 s31, 0x20000
    v_mov_b32 v2, 1
    v_lshlrev_b32 v3, 8, v1
    buffer_atomic_add v2, v3, s[28:31], 0 offen offset:128 sc1
    s_branch L_hook_back
L_kv_v:
    s_lshr_b32 s6, s2, 1
    s_mul_i32 s6, s6, 20480
    s_and_b32 s7, s2, 1
    s_lshl_b32 s7, s7, 7
    s_add_u32 s6, s6, s7
    v_add_u32 v2, -256, v0
    v_lshrrev_b32 v3, 3, v2
    v_and_b32 v4, 7, v2
    v_mul_u32_u24 v5, 1280, v4
    v_lshl_add_u32 v5, v3, 4, v5
    v_add_u32 v5, 131072, v5
    ds_read_b128 v[64:67], v5
    v_lshlrev_b32 v5, 8, v3
    v_lshl_add_u32 v76, v4, 4, v5
    v_add_u32 v2, 0, v0
    v_lshrrev_b32 v3, 3, v2
    v_and_b32 v4, 7, v2
    v_mul_u32_u24 v5, 1280, v4
    v_lshl_add_u32 v5, v3, 4, v5
    v_add_u32 v5, 131072, v5
    ds_read_b128 v[68:71], v5
    v_lshlrev_b32 v5, 8, v3
    v_lshl_add_u32 v77, v4, 4, v5
    v_add_u32 v2, 256, v0
    v_lshrrev_b32 v3, 3, v2
    v_and_b32 v4, 7, v2
    v_mul_u32_u24 v5, 1280, v4
    v_lshl_add_u32 v5, v3, 4, v5
    v_add_u32 v5, 131072, v5
    ds_read_b128 v[72:75], v5
    v_lshlrev_b32 v5, 8, v3
    v_lshl_add_u32 v78, v4, 4, v5
    s_waitcnt lgkmcnt(0)
    buffer_store_dwordx4 v[64:67], v76, s[8:11], s6 offen sc1
    buffer_store_dwordx4 v[68:71], v77, s[8:11], s6 offen sc1
    s_cmp_ge_u32 s3, 6
    s_cbranch_scc1 L_lns
    buffer_store_dwordx4 v[72:75], v78, s[8:11], s6 offen sc1
L_lns:
    ds_read_b128 v[64:67], v48 offset:0
    ds_read_b128 v[68:71], v48 offset:2048
    ds_read_b64_tr_b16 v[96:97], v50 offset:0
    ds_read_b64_tr_b16 v[98:99], v50 offset:1024
    ds_read_b64_tr_b16 v[100:101], v51 offset:0
    ds_read_b64_tr_b16 v[102:103], v51 offset:1024
    ds_read_b128 v[72:75], v48 offset:4096
    ds_read_b64_tr_b16 v[104:105], v52 offset:0
    ds_read_b64_tr_b16 v[106:107], v52 offset:1024
    ds_read_b64_tr_b16 v[108:109], v53 offset:0
    ds_read_b64_tr_b16 v[110:111], v53 offset:1024
    ds_read_b128 v[76:79], v48 offset:6144
    ds_read_b128 v[80:83], v48 offset:8192
    ds_read_b128 v[84:87], v48 offset:10240
    ds_read_b128 v[88:91], v48 offset:12288
    ds_read_b128 v[92:95], v48 offset:14336
    s_mul_i32 s6, s2, 10240
    s_add_u32 s6, s6, 12582912
    buffer_store_dwordx2 v[16:17], v63, s[8:11], s6 offen offset:0 sc1
    buffer_store_dwordx2 v[18:19], v63, s[8:11], s6 offen offset:256 sc1
    buffer_store_dwordx2 v[20:21], v63, s[8:11], s6 offen offset:512 sc1
    buffer_store_dwordx2 v[22:23], v63, s[8:11], s6 offen offset:768 sc1
    buffer_store_dwordx2 v[24:25], v63, s[8:11], s6 offen offset:1024 sc1
    v_mov_b32 v2, 0
    v_lshlrev_b32 v4, 16, v16
    v_lshlrev_b32 v5, 16, v26
    v_fmac_f32 v2, v4, v5
    v_and_b32 v4, 0xffff0000, v16
    v_and_b32 v5, 0xffff0000, v26
    v_fmac_f32 v2, v4, v5
    v_lshlrev_b32 v4, 16, v17
    v_lshlrev_b32 v5, 16, v27
    v_fmac_f32 v2, v4, v5
    v_and_b32 v4, 0xffff0000, v17
    v_and_b32 v5, 0xffff0000, v27
    v_fmac_f32 v2, v4, v5
    v_lshlrev_b32 v4, 16, v18
    v_lshlrev_b32 v5, 16, v28
    v_fmac_f32 v2, v4, v5
    v_and_b32 v4, 0xffff0000, v18
    v_and_b32 v5, 0xffff0000, v28
    v_fmac_f32 v2, v4, v5
    v_lshlrev_b32 v4, 16, v19
    v_lshlrev_b32 v5, 16, v29
    v_fmac_f32 v2, v4, v5
    v_and_b32 v4, 0xffff0000, v19
    v_and_b32 v5, 0xffff0000, v29
    v_fmac_f32 v2, v4, v5
    v_lshlrev_b32 v4, 16, v20
    v_lshlrev_b32 v5, 16, v30
    v_fmac_f32 v2, v4, v5
    v_and_b32 v4, 0xffff0000, v20
    v_and_b32 v5, 0xffff0000, v30
    v_fmac_f32 v2, v4, v5
    v_lshlrev_b32 v4, 16, v21
    v_lshlrev_b32 v5, 16, v31
    v_fmac_f32 v2, v4, v5
    v_and_b32 v4, 0xffff0000, v21
    v_and_b32 v5, 0xffff0000, v31
    v_fmac_f32 v2, v4, v5
    v_lshlrev_b32 v4, 16, v22
    v_lshlrev_b32 v5, 16, v32
    v_fmac_f32 v2, v4, v5
    v_and_b32 v4, 0xffff0000, v22
    v_and_b32 v5, 0xffff0000, v32
    v_fmac_f32 v2, v4, v5
    v_lshlrev_b32 v4, 16, v23
    v_lshlrev_b32 v5, 16, v33
    v_fmac_f32 v2, v4, v5
    v_and_b32 v4, 0xffff0000, v23
    v_and_b32 v5, 0xffff0000, v33
    v_fmac_f32 v2, v4, v5
    v_lshlrev_b32 v4, 16, v24
    v_lshlrev_b32 v5, 16, v34
    v_fmac_f32 v2, v4, v5
    v_and_b32 v4, 0xffff0000, v24
    v_and_b32 v5, 0xffff0000, v34
    v_fmac_f32 v2, v4, v5
    v_lshlrev_b32 v4, 16, v25
    v_lshlrev_b32 v5, 16, v35
    v_fmac_f32 v2, v4, v5
    v_and_b32 v4, 0xffff0000, v25
    v_and_b32 v5, 0xffff0000, v35
    v_fmac_f32 v2, v4, v5
    s_nop 1
    v_add_f32_dpp v2, v2, v2 quad_perm:[1,0,3,2] row_mask:0xf bank_mask:0xf
    s_nop 1
    v_add_f32_dpp v2, v2, v2 quad_perm:[2,3,0,1] row_mask:0xf bank_mask:0xf
    s_nop 1
    v_add_f32_dpp v2, v2, v2 row_half_mirror row_mask:0xf bank_mask:0xf
    s_nop 1
    v_add_f32_dpp v2, v2, v2 row_mirror row_mask:0xf bank_mask:0xf
    v_mov_b32 v8, v2
    s_nop 1
    v_permlane16_swap_b32 v2, v8
    s_nop 1
    v_add_f32 v2, v2, v8
    v_cvt_pk_bf16_f32 v2, v2, v2
    v_and_b32 v2, 0xffff, v2
    v_bfe_i32 v3, v2, 15, 1
    v_and_b32 v3, 0x7fff, v3
    v_or_b32 v3, 0x8000, v3
    v_xor_b32 v2, v2, v3
    s_lshl_b32 s7, s2, 3
    s_sub_u32 s6, 2047, s7
    v_sub_u32 v3, s6, v62
    v_lshl_or_b32 v2, v2, 11, v3
    s_lshl_b32 s6, s2, 5
    s_add_u32 s6, s6, 2621440
    v_lshlrev_b32 v3, 2, v62
    buffer_store_dword v2, v3, s[8:11], s6 offen sc1
    v_mov_b32 v3, 0x4000000
    v_mov_b32 v2, 0
    s_lshl_b32 s6, s4, 3
    s_add_u32 s6, s6, s5
    s_lshl_b32 s6, s6, 5
    s_add_u32 s6, s6, s3
    s_lshl_b32 s6, s6, 2
    s_add_u32 s6, s6, 3866624
    v_writelane_b32 v3, s6, 0
    s_lshl_b32 s6, s60, 5
    s_add_u32 s6, s6, s4
    s_lshl_b32 s6, s6, 7
    s_add_u32 s6, s6, 3932160
    v_writelane_b32 v3, s6, 1
    s_lshl_b32 s6, s61, 3
    s_add_u32 s6, s6, s3
    s_lshl_b32 s6, s6, 2
    s_add_u32 s6, s6, 3825664
    v_writelane_b32 v3, s6, 2
    s_lshl_b32 s6, s3, 2
    s_add_u32 s6, s6, 3801088
    s_cmp_eq_u32 s2, 0
    s_cselect_b32 s6, s6, 0x4000000
    v_writelane_b32 v3, s6, 3
    buffer_store_dword v2, v3, s[8:11], 0 offen sc1
    s_cmp_ge_u32 s76, 2
    s_cbranch_scc1 L_tch_6a
    s_and_b32 s6, s4, 3
    s_lshl_b32 s6, s6, 16
    s_lshl_b32 s7, s5, 18
    s_add_u32 s6, s6, s7
    s_lshl_b32 s7, s76, 7
    s_add_u32 s6, s6, s7
    s_add_u32 s6, s6, 384
    v_lshrrev_b32 v6, 1, v1
    v_lshlrev_b32 v6, 10, v6
    v_and_b32 v7, 1, v1
    v_lshl_add_u32 v6, v7, 6, v6
    buffer_load_dword v11, v6, s[12:15], s6 offen
    s_add_u32 s6, s6, 32768
    buffer_load_dword v11, v6, s[12:15], s6 offen
    s_branch L_tch_6c
L_tch_6a:
    v_lshrrev_b32 v6, 5, v1
    v_lshlrev_b32 v6, 6, v6
    v_bfe_u32 v7, v1, 2, 3
    v_add_u32 v6, v6, v7
    v_lshlrev_b32 v6, 13, v6
    v_and_b32 v7, 3, v1
    v_lshl_add_u32 v6, v7, 6, v6
    s_lshl_b32 s6, s4, 8
    s_lshl_b32 s7, s5, 16
    s_add_u32 s6, s6, s7
    s_add_u32 s6, s6, 1572864
    s_cmp_lg_u32 s76, 2
    s_cbranch_scc1 L_tch_6b
    buffer_load_dword v11, v6, s[16:19], s6 offen
    s_branch L_tch_6c
L_tch_6b:
    buffer_load_dword v11, v6, s[20:23], s6 offen
L_tch_6c:
    s_mov_b32 s65, 0
    s_lshl_b32 s6, s4, 20
    s_lshl_b32 s7, s5, 16
    s_add_u32 s6, s6, s7
    s_and_b32 s7, s3, 1
    s_lshl_b32 s7, s7, 15
    s_add_u32 s6, s6, s7
    s_add_u32 s67, s6, 16777216
    s_and_b32 s6, s4, 3
    s_add_u32 s6, s6, s5
    s_sub_u32 s7, s6, 5
    s_cselect_b32 s6, s6, s7
    s_sub_u32 s7, s6, 5
    s_cselect_b32 s6, s6, s7
    s_lshl_b32 s71, s6, 20
    s_lshl_b32 s7, s4, 8
    s_add_u32 s71, s71, s7
    s_lshl_b32 s7, s6, 12
    s_add_u32 s84, s70, s7
    s_add_u32 s6, s6, 1
    s_cmp_eq_u32 s6, 5
    s_cselect_b32 s6, 0, s6
    s_lshl_b32 s7, s6, 12
    s_add_u32 s85, s70, s7
    s_add_u32 s6, s6, 1
    s_cmp_eq_u32 s6, 5
    s_cselect_b32 s6, 0, s6
    s_lshl_b32 s7, s6, 12
    s_add_u32 s86, s70, s7
    s_add_u32 s6, s6, 1
    s_cmp_eq_u32 s6, 5
    s_cselect_b32 s6, 0, s6
    s_lshl_b32 s7, s6, 12
    s_add_u32 s87, s70, s7
    s_add_u32 s6, s6, 1
    s_cmp_eq_u32 s6, 5
    s_cselect_b32 s6, 0, s6
    s_lshl_b32 s7, s6, 12
    s_add_u32 s88, s70, s7
    s_lshr_b32 s7, s3, 1
    s_and_b32 s7, s7, 1
    s_lshl_b32 s7, s7, 12
    s_add_u32 s67, s67, s7
    s_add_u32 s67, s67, 0x80000
    s_movk_i32 s68, 1024
    s_movk_i32 s69, 5120
.p2align 4
L_vloop:
    s_branch L_hook
L_hook_back:
    s_waitcnt lgkmcnt(12)
    v_mfma_f32_16x16x32_bf16 v[128:131], v[64:67], v[96:99], v[128:131]
    ds_read_b64_tr_b16 v[112:113], v50 offset:8192
    s_waitcnt lgkmcnt(11)
    v_mfma_f32_16x16x32_bf16 v[132:135], v[64:67], v[100:103], v[132:135]
    ds_read_b64_tr_b16 v[114:115], v50 offset:9216
    s_waitcnt lgkmcnt(9)
    v_mfma_f32_16x16x32_bf16 v[136:139], v[64:67], v[104:107], v[136:139]
    ds_read_b64_tr_b16 v[116:117], v51 offset:8192
    s_waitcnt lgkmcnt(8)
    v_mfma_f32_16x16x32_bf16 v[140:143], v[64:67], v[108:111], v[140:143]
    ds_read_b64_tr_b16 v[118:119], v51 offset:9216
    ds_read_b128 v[64:67], v49 offset:0
    v_mfma_f32_16x16x32_bf16 v[144:147], v[68:71], v[96:99], v[144:147]
    ds_read_b64_tr_b16 v[120:121], v52 offset:8192
    v_mfma_f32_16x16x32_bf16 v[148:151], v[68:71], v[100:103], v[148:151]
    ds_read_b64_tr_b16 v[122:123], v52 offset:9216
    v_mfma_f32_16x16x32_bf16 v[152:155], v[68:71], v[104:107], v[152:155]
    ds_read_b64_tr_b16 v[124:125], v53 offset:8192
    v_mfma_f32_16x16x32_bf16 v[156:159], v[68:71], v[108:111], v[156:159]
    ds_read_b64_tr_b16 v[126:127], v53 offset:9216
    ds_read_b128 v[68:71], v49 offset:2048
    v_mfma_f32_16x16x32_bf16 v[160:163], v[72:75], v[96:99], v[160:163]
    v_mfma_f32_16x16x32_bf16 v[164:167], v[72:75], v[100:103], v[164:167]
    v_mfma_f32_16x16x32_bf16 v[168:171], v[72:75], v[104:107], v[168:171]
    v_mfma_f32_16x16x32_bf16 v[172:175], v[72:75], v[108:111], v[172:175]
    ds_read_b128 v[72:75], v49 offset:4096
    s_waitcnt lgkmcnt(15)
    v_mfma_f32_16x16x32_bf16 v[176:179], v[76:79], v[96:99], v[176:179]
    v_mfma_f32_16x16x32_bf16 v[180:183], v[76:79], v[100:103], v[180:183]
    v_mfma_f32_16x16x32_bf16 v[184:187], v[76:79], v[104:107], v[184:187]
    v_mfma_f32_16x16x32_bf16 v[188:191], v[76:79], v[108:111], v[188:191]
    ds_read_b128 v[76:79], v49 offset:6144
    s_waitcnt lgkmcnt(15)
    v_mfma_f32_16x16x32_bf16 v[192:195], v[80:83], v[96:99], v[192:195]
    v_mfma_f32_16x16x32_bf16 v[196:199], v[80:83], v[100:103], v[196:199]
    v_mfma_f32_16x16x32_bf16 v[200:203], v[80:83], v[104:107], v[200:203]
    v_mfma_f32_16x16x32_bf16 v[204:207], v[80:83], v[108:111], v[204:207]
    ds_read_b128 v[80:83], v49 offset:8192
    s_waitcnt lgkmcnt(15)
    v_mfma_f32_16x16x32_bf16 v[208:211], v[84:87], v[96:99], v[208:211]
    v_mfma_f32_16x16x32_bf16 v[212:215], v[84:87], v[100:103], v[212:215]
    v_mfma_f32_16x16x32_bf16 v[216:219], v[84:87], v[104:107], v[216:219]
    v_mfma_f32_16x16x32_bf16 v[220:223], v[84:87], v[108:111], v[220:223]
    ds_read_b128 v[84:87], v49 offset:10240
    s_waitcnt lgkmcnt(15)
    v_mfma_f32_16x16x32_bf16 v[224:227], v[88:91], v[96:99], v[224:227]
    v_mfma_f32_16x16x32_bf16 v[228:231], v[88:91], v[100:103], v[228:231]
    v_mfma_f32_16x16x32_bf16 v[232:235], v[88:91], v[104:107], v[232:235]
    v_mfma_f32_16x16x32_bf16 v[236:239], v[88:91], v[108:111], v[236:239]
    ds_read_b128 v[88:91], v49 offset:12288
    s_waitcnt lgkmcnt(15)
    v_mfma_f32_16x16x32_bf16 v[240:243], v[92:95], v[96:99], v[240:243]
    v_mfma_f32_16x16x32_bf16 v[244:247], v[92:95], v[100:103], v[244:247]
    v_mfma_f32_16x16x32_bf16 v[248:251], v[92:95], v[104:107], v[248:251]
    v_mfma_f32_16x16x32_bf16 v[252:255], v[92:95], v[108:111], v[252:255]
    ds_read_b128 v[92:95], v49 offset:14336
    s_waitcnt lgkmcnt(11)
    v_mfma_f32_16x16x32_bf16 v[128:131], v[64:67], v[112:115], v[128:131]
    v_mfma_f32_16x16x32_bf16 v[132:135], v[64:67], v[116:119], v[132:135]
    s_waitcnt lgkmcnt(9)
    v_mfma_f32_16x16x32_bf16 v[136:139], v[64:67], v[120:123], v[136:139]
    s_waitcnt lgkmcnt(7)
    v_mfma_f32_16x16x32_bf16 v[140:143], v[64:67], v[124:127], v[140:143]
    s_waitcnt lgkmcnt(6)
    v_mfma_f32_16x16x32_bf16 v[144:147], v[68:71], v[112:115], v[144:147]
    v_mfma_f32_16x16x32_bf16 v[148:151], v[68:71], v[116:119], v[148:151]
    v_mfma_f32_16x16x32_bf16 v[152:155], v[68:71], v[120:123], v[152:155]
    v_mfma_f32_16x16x32_bf16 v[156:159], v[68:71], v[124:127], v[156:159]
    v_xor_b32 v48, 0x10000, v48
    v_xor_b32 v49, 0x10000, v49
    v_xor_b32 v50, 0x10000, v50
    v_xor_b32 v51, 0x10000, v51
    v_xor_b32 v52, 0x10000, v52
    v_xor_b32 v53, 0x10000, v53
    s_bitcmp1_b32 0x89, s65
    s_cbranch_scc0 L_vnow
    s_waitcnt vmcnt(1)
    s_cmp_eq_u32 s65, 0
    s_cbranch_scc1 L_vnow
    s_waitcnt vmcnt(0)
L_vnow:
    s_waitcnt lgkmcnt(0)
    s_barrier
    ds_read_b128 v[64:67], v48 offset:0
    ds_read_b128 v[68:71], v48 offset:2048
    v_mfma_f32_16x16x32_bf16 v[160:163], v[72:75], v[112:115], v[160:163]
    ds_read_b64_tr_b16 v[96:97], v50 offset:0
    v_mfma_f32_16x16x32_bf16 v[164:167], v[72:75], v[116:119], v[164:167]
    ds_read_b64_tr_b16 v[98:99], v50 offset:1024
    v_mfma_f32_16x16x32_bf16 v[168:171], v[72:75], v[120:123], v[168:171]
    ds_read_b64_tr_b16 v[100:101], v51 offset:0
    v_mfma_f32_16x16x32_bf16 v[172:175], v[72:75], v[124:127], v[172:175]
    ds_read_b64_tr_b16 v[102:103], v51 offset:1024
    ds_read_b128 v[72:75], v48 offset:4096
    v_mfma_f32_16x16x32_bf16 v[176:179], v[76:79], v[112:115], v[176:179]
    ds_read_b64_tr_b16 v[104:105], v52 offset:0
    v_mfma_f32_16x16x32_bf16 v[180:183], v[76:79], v[116:119], v[180:183]
    ds_read_b64_tr_b16 v[106:107], v52 offset:1024
    v_mfma_f32_16x16x32_bf16 v[184:187], v[76:79], v[120:123], v[184:187]
    ds_read_b64_tr_b16 v[108:109], v53 offset:0
    v_mfma_f32_16x16x32_bf16 v[188:191], v[76:79], v[124:127], v[188:191]
    ds_read_b64_tr_b16 v[110:111], v53 offset:1024
    ds_read_b128 v[76:79], v48 offset:6144
    v_mfma_f32_16x16x32_bf16 v[192:195], v[80:83], v[112:115], v[192:195]
    v_mfma_f32_16x16x32_bf16 v[196:199], v[80:83], v[116:119], v[196:199]
    v_mfma_f32_16x16x32_bf16 v[200:203], v[80:83], v[120:123], v[200:203]
    v_mfma_f32_16x16x32_bf16 v[204:207], v[80:83], v[124:127], v[204:207]
    ds_read_b128 v[80:83], v48 offset:8192
    v_mfma_f32_16x16x32_bf16 v[208:211], v[84:87], v[112:115], v[208:211]
    v_mfma_f32_16x16x32_bf16 v[212:215], v[84:87], v[116:119], v[212:215]
    v_mfma_f32_16x16x32_bf16 v[216:219], v[84:87], v[120:123], v[216:219]
    v_mfma_f32_16x16x32_bf16 v[220:223], v[84:87], v[124:127], v[220:223]
    ds_read_b128 v[84:87], v48 offset:10240
    v_mfma_f32_16x16x32_bf16 v[224:227], v[88:91], v[112:115], v[224:227]
    v_mfma_f32_16x16x32_bf16 v[228:231], v[88:91], v[116:119], v[228:231]
    v_mfma_f32_16x16x32_bf16 v[232:235], v[88:91], v[120:123], v[232:235]
    v_mfma_f32_16x16x32_bf16 v[236:239], v[88:91], v[124:127], v[236:239]
    ds_read_b128 v[88:91], v48 offset:12288
    v_mfma_f32_16x16x32_bf16 v[240:243], v[92:95], v[112:115], v[240:243]
    v_mfma_f32_16x16x32_bf16 v[244:247], v[92:95], v[116:119], v[244:247]
    v_mfma_f32_16x16x32_bf16 v[248:251], v[92:95], v[120:123], v[248:251]
    v_mfma_f32_16x16x32_bf16 v[252:255], v[92:95], v[124:127], v[252:255]
    ds_read_b128 v[92:95], v48 offset:14336
    s_add_u32 s65, s65, 1
    s_cmp_lt_u32 s65, 8
    s_cbranch_scc1 L_vloop
    s_waitcnt lgkmcnt(0)
    s_nop 7
    v_cvt_pk_bf16_f32 v128, v128, v129
    v_cvt_pk_bf16_f32 v129, v130, v131
    v_cvt_pk_bf16_f32 v130, v144, v145
    v_cvt_pk_bf16_f32 v131, v146, v147
    v_cvt_pk_bf16_f32 v132, v132, v133
    v_cvt_pk_bf16_f32 v133, v134, v135
    v_cvt_pk_bf16_f32 v134, v148, v149
    v_cvt_pk_bf16_f32 v135, v150, v151
    v_cvt_pk_bf16_f32 v136, v136, v137
    v_cvt_pk_bf16_f32 v137, v138, v139
    v_cvt_pk_bf16_f32 v138, v152, v153
    v_cvt_pk_bf16_f32 v139, v154, v155
    v_cvt_pk_bf16_f32 v140, v140, v141
    v_cvt_pk_bf16_f32 v141, v142, v143
    v_cvt_pk_bf16_f32 v142, v156, v157
    v_cvt_pk_bf16_f32 v143, v158, v159
    v_cvt_pk_bf16_f32 v144, v160, v161
    v_cvt_pk_bf16_f32 v145, v162, v163
    v_cvt_pk_bf16_f32 v146, v176, v177
    v_cvt_pk_bf16_f32 v147, v178, v179
    v_cvt_pk_bf16_f32 v148, v164, v165
    v_cvt_pk_bf16_f32 v149, v166, v167
    v_cvt_pk_bf16_f32 v150, v180, v181
    v_cvt_pk_bf16_f32 v151, v182, v183
    v_cvt_pk_bf16_f32 v152, v168, v169
    v_cvt_pk_bf16_f32 v153, v170, v171
    v_cvt_pk_bf16_f32 v154, v184, v185
    v_cvt_pk_bf16_f32 v155, v186, v187
    v_cvt_pk_bf16_f32 v156, v172, v173
    v_cvt_pk_bf16_f32 v157, v174, v175
    v_cvt_pk_bf16_f32 v158, v188, v189
    v_cvt_pk_bf16_f32 v159, v190, v191
    v_cvt_pk_bf16_f32 v160, v192, v193
    v_cvt_pk_bf16_f32 v161, v194, v195
    v_cvt_pk_bf16_f32 v162, v208, v209
    v_cvt_pk_bf16_f32 v163, v210, v211
    v_cvt_pk_bf16_f32 v164, v196, v197
    v_cvt_pk_bf16_f32 v165, v198, v199
    v_cvt_pk_bf16_f32 v166, v212, v213
    v_cvt_pk_bf16_f32 v167, v214, v215
    v_cvt_pk_bf16_f32 v168, v200, v201
    v_cvt_pk_bf16_f32 v169, v202, v203
    v_cvt_pk_bf16_f32 v170, v216, v217
    v_cvt_pk_bf16_f32 v171, v218, v219
    v_cvt_pk_bf16_f32 v172, v204, v205
    v_cvt_pk_bf16_f32 v173, v206, v207
    v_cvt_pk_bf16_f32 v174, v220, v221
    v_cvt_pk_bf16_f32 v175, v222, v223
    v_cvt_pk_bf16_f32 v176, v224, v225
    v_cvt_pk_bf16_f32 v177, v226, v227
    v_cvt_pk_bf16_f32 v178, v240, v241
    v_cvt_pk_bf16_f32 v179, v242, v243
    v_cvt_pk_bf16_f32 v180, v228, v229
    v_cvt_pk_bf16_f32 v181, v230, v231
    v_cvt_pk_bf16_f32 v182, v244, v245
    v_cvt_pk_bf16_f32 v183, v246, v247
    v_cvt_pk_bf16_f32 v184, v232, v233
    v_cvt_pk_bf16_f32 v185, v234, v235
    v_cvt_pk_bf16_f32 v186, v248, v249
    v_cvt_pk_bf16_f32 v187, v250, v251
    v_cvt_pk_bf16_f32 v188, v236, v237
    v_cvt_pk_bf16_f32 v189, v238, v239
    v_cvt_pk_bf16_f32 v190, v252, v253
    v_cvt_pk_bf16_f32 v191, v254, v255
L_q:
    s_mov_b32 s28, s56
    s_mov_b32 s29, s57
    s_mov_b32 s30, 0x100
    s_mov_b32 s31, 0x20000
    s_lshl_b32 s6, s76, 13
    v_add_u32 v49, s6, v13
    s_lshl_b32 s6, s76, 12
    v_add_u32 v50, s6, v13
    s_lshl_b32 s77, s4, 20
    s_add_u32 s77, s77, 16777216
    s_mov_b32 s78, 0
    s_mov_b32 s90, 0
    s_cmp_lt_u32 s3, 4
    s_cselect_b32 s89, 1, 0
    s_cmp_ge_u32 s5, 2
    s_cbranch_scc1 L_q_late
    ds_read_b64_tr_b16 v[96:97], v54 offset:0
    ds_read_b64_tr_b16 v[98:99], v54 offset:1024
    ds_read_b64_tr_b16 v[100:101], v55 offset:0
    ds_read_b64_tr_b16 v[102:103], v55 offset:1024
    ds_read_b64_tr_b16 v[104:105], v56 offset:0
    ds_read_b64_tr_b16 v[106:107], v56 offset:1024
    ds_read_b64_tr_b16 v[108:109], v57 offset:0
    ds_read_b64_tr_b16 v[110:111], v57 offset:1024
    ds_read_b64_tr_b16 v[112:113], v58 offset:0
    ds_read_b64_tr_b16 v[114:115], v58 offset:1024
    ds_read_b64_tr_b16 v[116:117], v59 offset:0
    ds_read_b64_tr_b16 v[118:119], v59 offset:1024
    ds_read_b64_tr_b16 v[120:121], v60 offset:0
    ds_read_b64_tr_b16 v[122:123], v60 offset:1024
    ds_read_b64_tr_b16 v[124:125], v61 offset:0
    ds_read_b64_tr_b16 v[126:127], v61 offset:1024
    buffer_load_dwordx4 v[64:67], v13, s[8:11], s84 offen offset:3072 sc1
    buffer_load_dwordx4 v[68:71], v12, s[8:11], s84 offen offset:3072 sc1
    buffer_load_dwordx4 v[72:75], v13, s[8:11], s85 offen offset:0 sc1
    buffer_load_dwordx4 v[76:79], v12, s[8:11], s85 offen offset:0 sc1
    buffer_load_dwordx4 v[80:83], v13, s[8:11], s85 offen offset:1024 sc1
    buffer_load_dwordx4 v[84:87], v12, s[8:11], s85 offen offset:1024 sc1
    buffer_load_dwordx4 v[88:91], v13, s[8:11], s85 offen offset:2048 sc1
    buffer_load_dwordx4 v[92:95], v12, s[8:11], s85 offen offset:2048 sc1
    s_waitcnt lgkmcnt(14)
    v_mfma_f32_16x16x32_bf16 v[192:195], v[96:99], v[16:19], 0
    v_mfma_f32_16x16x32_bf16 v[196:199], v[96:99], v[20:23], 0
    ds_read_b64_tr_b16 v[96:97], v54 offset:8192
    s_waitcnt lgkmcnt(13)
    v_mfma_f32_16x16x32_bf16 v[200:203], v[100:103], v[16:19], 0
    ds_read_b64_tr_b16 v[98:99], v54 offset:9216
    buffer_store_dwordx4 v[128:131], v13, s[8:11], s67 offen sc1
    s_add_u32 s67, s67, 1024
    v_mfma_f32_16x16x32_bf16 v[204:207], v[100:103], v[20:23], 0
    ds_read_b64_tr_b16 v[100:101], v55 offset:8192
    s_waitcnt lgkmcnt(13)
    v_mfma_f32_16x16x32_bf16 v[208:211], v[104:107], v[16:19], 0
    ds_read_b64_tr_b16 v[102:103], v55 offset:9216
    v_mfma_f32_16x16x32_bf16 v[212:215], v[104:107], v[20:23], 0
    ds_read_b64_tr_b16 v[104:105], v56 offset:8192
    s_waitcnt lgkmcnt(13)
    v_mfma_f32_16x16x32_bf16 v[216:219], v[108:111], v[16:19], 0
    ds_read_b64_tr_b16 v[106:107], v56 offset:9216
    buffer_store_dwordx4 v[132:135], v13, s[8:11], s67 offen sc1
    s_add_u32 s67, s67, s68
    v_mfma_f32_16x16x32_bf16 v[220:223], v[108:111], v[20:23], 0
    ds_read_b64_tr_b16 v[108:109], v57 offset:8192
    s_waitcnt lgkmcnt(13)
    v_mfma_f32_16x16x32_bf16 v[224:227], v[112:115], v[16:19], 0
    ds_read_b64_tr_b16 v[110:111], v57 offset:9216
    v_mfma_f32_16x16x32_bf16 v[228:231], v[112:115], v[20:23], 0
    ds_read_b64_tr_b16 v[112:113], v58 offset:8192
    s_waitcnt lgkmcnt(13)
    v_mfma_f32_16x16x32_bf16 v[232:235], v[116:119], v[16:19], 0
    ds_read_b64_tr_b16 v[114:115], v58 offset:9216
    buffer_store_dwordx4 v[136:139], v13, s[8:11], s67 offen sc1
    s_add_u32 s67, s67, 1024
    v_mfma_f32_16x16x32_bf16 v[236:239], v[116:119], v[20:23], 0
    ds_read_b64_tr_b16 v[116:117], v59 offset:8192
    s_waitcnt lgkmcnt(13)
    v_mfma_f32_16x16x32_bf16 v[240:243], v[120:123], v[16:19], 0
    ds_read_b64_tr_b16 v[118:119], v59 offset:9216
    v_mfma_f32_16x16x32_bf16 v[244:247], v[120:123], v[20:23], 0
    ds_read_b64_tr_b16 v[120:121], v60 offset:8192
    s_waitcnt lgkmcnt(13)
    v_mfma_f32_16x16x32_bf16 v[248:251], v[124:127], v[16:19], 0
    ds_read_b64_tr_b16 v[122:123], v60 offset:9216
    buffer_store_dwordx4 v[140:143], v13, s[8:11], s67 offen sc1
    s_add_u32 s67, s67, s69
    v_mfma_f32_16x16x32_bf16 v[252:255], v[124:127], v[20:23], 0
    ds_read_b64_tr_b16 v[124:125], v61 offset:8192
    ds_read_b64_tr_b16 v[126:127], v61 offset:9216
    buffer_load_dwordx4 v[16:19], v13, s[8:11], s85 offen offset:3072 sc1
    buffer_load_dwordx4 v[20:23], v12, s[8:11], s85 offen offset:3072 sc1
    s_waitcnt lgkmcnt(14)
    v_mfma_f32_16x16x32_bf16 v[192:195], v[96:99], v[24:27], v[192:195]
    v_mfma_f32_16x16x32_bf16 v[196:199], v[96:99], v[28:31], v[196:199]
    ds_read_b64_tr_b16 v[96:97], v54 offset:16384
    s_waitcnt lgkmcnt(13)
    v_mfma_f32_16x16x32_bf16 v[200:203], v[100:103], v[24:27], v[200:203]
    ds_read_b64_tr_b16 v[98:99], v54 offset:17408
    buffer_store_dwordx4 v[144:147], v13, s[8:11], s67 offen sc1
    s_add_u32 s67, s67, 1024
    v_mfma_f32_16x16x32_bf16 v[204:207], v[100:103], v[28:31], v[204:207]
    ds_read_b64_tr_b16 v[100:101], v55 offset:16384
    s_waitcnt lgkmcnt(13)
    v_mfma_f32_16x16x32_bf16 v[208:211], v[104:107], v[24:27], v[208:211]
    ds_read_b64_tr_b16 v[102:103], v55 offset:17408
    v_mfma_f32_16x16x32_bf16 v[212:215], v[104:107], v[28:31], v[212:215]
    ds_read_b64_tr_b16 v[104:105], v56 offset:16384
    s_waitcnt lgkmcnt(13)
    v_mfma_f32_16x16x32_bf16 v[216:219], v[108:111], v[24:27], v[216:219]
    ds_read_b64_tr_b16 v[106:107], v56 offset:17408
    buffer_store_dwordx4 v[148:151], v13, s[8:11], s67 offen sc1
    s_add_u32 s67, s67, s68
    v_mfma_f32_16x16x32_bf16 v[220:223], v[108:111], v[28:31], v[220:223]
    ds_read_b64_tr_b16 v[108:109], v57 offset:16384
    s_waitcnt lgkmcnt(13)
    v_mfma_f32_16x16x32_bf16 v[224:227], v[112:115], v[24:27], v[224:227]
    ds_read_b64_tr_b16 v[110:111], v57 offset:17408
    v_mfma_f32_16x16x32_bf16 v[228:231], v[112:115], v[28:31], v[228:231]
    ds_read_b64_tr_b16 v[112:113], v58 offset:16384
    s_waitcnt lgkmcnt(13)
    v_mfma_f32_16x16x32_bf16 v[232:235], v[116:119], v[24:27], v[232:235]
    ds_read_b64_tr_b16 v[114:115], v58 offset:17408
    buffer_store_dwordx4 v[152:155], v13, s[8:11], s67 offen sc1
    s_add_u32 s67, s67, 1024
    v_mfma_f32_16x16x32_bf16 v[236:239], v[116:119], v[28:31], v[236:239]
    ds_read_b64_tr_b16 v[116:117], v59 offset:16384
    s_waitcnt lgkmcnt(13)
    v_mfma_f32_16x16x32_bf16 v[240:243], v[120:123], v[24:27], v[240:243]
    ds_read_b64_tr_b16 v[118:119], v59 offset:17408
    v_mfma_f32_16x16x32_bf16 v[244:247], v[120:123], v[28:31], v[244:247]
    ds_read_b64_tr_b16 v[120:121], v60 offset:16384
    s_waitcnt lgkmcnt(13)
    v_mfma_f32_16x16x32_bf16 v[248:251], v[124:127], v[24:27], v[248:251]
    ds_read_b64_tr_b16 v[122:123], v60 offset:17408
    buffer_store_dwordx4 v[156:159], v13, s[8:11], s67 offen sc1
    s_add_u32 s67, s67, s69
    v_mfma_f32_16x16x32_bf16 v[252:255], v[124:127], v[28:31], v[252:255]
    ds_read_b64_tr_b16 v[124:125], v61 offset:16384
    ds_read_b64_tr_b16 v[126:127], v61 offset:17408
    buffer_load_dwordx4 v[24:27], v13, s[8:11], s86 offen offset:0 sc1
    buffer_load_dwordx4 v[28:31], v12, s[8:11], s86 offen offset:0 sc1
    s_waitcnt lgkmcnt(14)
    v_mfma_f32_16x16x32_bf16 v[192:195], v[96:99], v[32:35], v[192:195]
    v_mfma_f32_16x16x32_bf16 v[196:199], v[96:99], v[36:39], v[196:199]
    ds_read_b64_tr_b16 v[96:97], v54 offset:24576
    s_waitcnt lgkmcnt(13)
    v_mfma_f32_16x16x32_bf16 v[200:203], v[100:103], v[32:35], v[200:203]
    ds_read_b64_tr_b16 v[98:99], v54 offset:25600
    buffer_store_dwordx4 v[160:163], v13, s[8:11], s67 offen sc1
    s_add_u32 s67, s67, 1024
    v_mfma_f32_16x16x32_bf16 v[204:207], v[100:103], v[36:39], v[204:207]
    ds_read_b64_tr_b16 v[100:101], v55 offset:24576
    s_waitcnt lgkmcnt(13)
    v_mfma_f32_16x16x32_bf16 v[208:211], v[104:107], v[32:35], v[208:211]
    ds_read_b64_tr_b16 v[102:103], v55 offset:25600
    v_mfma_f32_16x16x32_bf16 v[212:215], v[104:107], v[36:39], v[212:215]
    ds_read_b64_tr_b16 v[104:105], v56 offset:24576
    s_waitcnt lgkmcnt(13)
    v_mfma_f32_16x16x32_bf16 v[216:219], v[108:111], v[32:35], v[216:219]
    ds_read_b64_tr_b16 v[106:107], v56 offset:25600
    buffer_store_dwordx4 v[164:167], v13, s[8:11], s67 offen sc1
    s_add_u32 s67, s67, s68
    v_mfma_f32_16x16x32_bf16 v[220:223], v[108:111], v[36:39], v[220:223]
    ds_read_b64_tr_b16 v[108:109], v57 offset:24576
    s_waitcnt lgkmcnt(13)
    v_mfma_f32_16x16x32_bf16 v[224:227], v[112:115], v[32:35], v[224:227]
    ds_read_b64_tr_b16 v[110:111], v57 offset:25600
    v_mfma_f32_16x16x32_bf16 v[228:231], v[112:115], v[36:39], v[228:231]
    ds_read_b64_tr_b16 v[112:113], v58 offset:24576
    s_waitcnt lgkmcnt(13)
    v_mfma_f32_16x16x32_bf16 v[232:235], v[116:119], v[32:35], v[232:235]
    ds_read_b64_tr_b16 v[114:115], v58 offset:25600
    buffer_store_dwordx4 v[168:171], v13, s[8:11], s67 offen sc1
    s_add_u32 s67, s67, 1024
    v_mfma_f32_16x16x32_bf16 v[236:239], v[116:119], v[36:39], v[236:239]
    ds_read_b64_tr_b16 v[116:117], v59 offset:24576
    s_waitcnt lgkmcnt(13)
    v_mfma_f32_16x16x32_bf16 v[240:243], v[120:123], v[32:35], v[240:243]
    ds_read_b64_tr_b16 v[118:119], v59 offset:25600
    v_mfma_f32_16x16x32_bf16 v[244:247], v[120:123], v[36:39], v[244:247]
    ds_read_b64_tr_b16 v[120:121], v60 offset:24576
    s_waitcnt lgkmcnt(13)
    v_mfma_f32_16x16x32_bf16 v[248:251], v[124:127], v[32:35], v[248:251]
    ds_read_b64_tr_b16 v[122:123], v60 offset:25600
    buffer_store_dwordx4 v[172:175], v13, s[8:11], s67 offen sc1
    s_add_u32 s67, s67, s69
    v_mfma_f32_16x16x32_bf16 v[252:255], v[124:127], v[36:39], v[252:255]
    ds_read_b64_tr_b16 v[124:125], v61 offset:24576
    ds_read_b64_tr_b16 v[126:127], v61 offset:25600
    buffer_load_dwordx4 v[32:35], v13, s[8:11], s86 offen offset:1024 sc1
    buffer_load_dwordx4 v[36:39], v12, s[8:11], s86 offen offset:1024 sc1
    s_waitcnt vmcnt(24)
    s_waitcnt lgkmcnt(14)
    v_mfma_f32_16x16x32_bf16 v[192:195], v[96:99], v[64:67], v[192:195]
    v_add_u32 v54, 0xfffe0000, v54
    v_mfma_f32_16x16x32_bf16 v[196:199], v[96:99], v[68:71], v[196:199]
    ds_read_b64_tr_b16 v[96:97], v54 offset:0
    s_waitcnt lgkmcnt(13)
    v_mfma_f32_16x16x32_bf16 v[200:203], v[100:103], v[64:67], v[200:203]
    ds_read_b64_tr_b16 v[98:99], v54 offset:1024
    v_add_u32 v55, 0xfffe0000, v55
    buffer_store_dwordx4 v[176:179], v13, s[8:11], s67 offen sc1
    s_add_u32 s67, s67, 1024
    v_mfma_f32_16x16x32_bf16 v[204:207], v[100:103], v[68:71], v[204:207]
    ds_read_b64_tr_b16 v[100:101], v55 offset:0
    s_waitcnt lgkmcnt(13)
    v_mfma_f32_16x16x32_bf16 v[208:211], v[104:107], v[64:67], v[208:211]
    ds_read_b64_tr_b16 v[102:103], v55 offset:1024
    v_add_u32 v56, 0xfffe0000, v56
    v_mfma_f32_16x16x32_bf16 v[212:215], v[104:107], v[68:71], v[212:215]
    ds_read_b64_tr_b16 v[104:105], v56 offset:0
    s_waitcnt lgkmcnt(13)
    v_mfma_f32_16x16x32_bf16 v[216:219], v[108:111], v[64:67], v[216:219]
    ds_read_b64_tr_b16 v[106:107], v56 offset:1024
    v_add_u32 v57, 0xfffe0000, v57
    buffer_store_dwordx4 v[180:183], v13, s[8:11], s67 offen sc1
    s_add_u32 s67, s67, s68
    v_mfma_f32_16x16x32_bf16 v[220:223], v[108:111], v[68:71], v[220:223]
    ds_read_b64_tr_b16 v[108:109], v57 offset:0
    s_waitcnt lgkmcnt(13)
    v_mfma_f32_16x16x32_bf16 v[224:227], v[112:115], v[64:67], v[224:227]
    ds_read_b64_tr_b16 v[110:111], v57 offset:1024
    v_add_u32 v58, 0xfffe0000, v58
    v_mfma_f32_16x16x32_bf16 v[228:231], v[112:115], v[68:71], v[228:231]
    ds_read_b64_tr_b16 v[112:113], v58 offset:0
    s_waitcnt lgkmcnt(13)
    v_mfma_f32_16x16x32_bf16 v[232:235], v[116:119], v[64:67], v[232:235]
    ds_read_b64_tr_b16 v[114:115], v58 offset:1024
    v_add_u32 v59, 0xfffe0000, v59
    buffer_store_dwordx4 v[184:187], v13, s[8:11], s67 offen sc1
    s_add_u32 s67, s67, 1024
    v_mfma_f32_16x16x32_bf16 v[236:239], v[116:119], v[68:71], v[236:239]
    ds_read_b64_tr_b16 v[116:117], v59 offset:0
    s_waitcnt lgkmcnt(13)
    v_mfma_f32_16x16x32_bf16 v[240:243], v[120:123], v[64:67], v[240:243]
    ds_read_b64_tr_b16 v[118:119], v59 offset:1024
    v_add_u32 v60, 0xfffe0000, v60
    v_mfma_f32_16x16x32_bf16 v[244:247], v[120:123], v[68:71], v[244:247]
    ds_read_b64_tr_b16 v[120:121], v60 offset:0
    s_waitcnt lgkmcnt(13)
    v_mfma_f32_16x16x32_bf16 v[248:251], v[124:127], v[64:67], v[248:251]
    ds_read_b64_tr_b16 v[122:123], v60 offset:1024
    v_add_u32 v61, 0xfffe0000, v61
    buffer_store_dwordx4 v[188:191], v13, s[8:11], s67 offen sc1
    s_add_u32 s67, s67, s69
    v_mfma_f32_16x16x32_bf16 v[252:255], v[124:127], v[68:71], v[252:255]
    ds_read_b64_tr_b16 v[124:125], v61 offset:0
    ds_read_b64_tr_b16 v[126:127], v61 offset:1024
    buffer_load_dwordx4 v[64:67], v13, s[8:11], s86 offen offset:2048 sc1
    buffer_load_dwordx4 v[68:71], v12, s[8:11], s86 offen offset:2048 sc1
    s_barrier
    s_waitcnt vmcnt(28)
    s_waitcnt lgkmcnt(14)
    v_mfma_f32_16x16x32_bf16 v[192:195], v[96:99], v[72:75], v[192:195]
    v_mfma_f32_16x16x32_bf16 v[196:199], v[96:99], v[76:79], v[196:199]
    ds_read_b64_tr_b16 v[96:97], v54 offset:8192
    s_waitcnt lgkmcnt(13)
    v_mfma_f32_16x16x32_bf16 v[200:203], v[100:103], v[72:75], v[200:203]
    ds_read_b64_tr_b16 v[98:99], v54 offset:9216
    v_mfma_f32_16x16x32_bf16 v[204:207], v[100:103], v[76:79], v[204:207]
    ds_read_b64_tr_b16 v[100:101], v55 offset:8192
    s_waitcnt lgkmcnt(13)
    v_mfma_f32_16x16x32_bf16 v[208:211], v[104:107], v[72:75], v[208:211]
    ds_read_b64_tr_b16 v[102:103], v55 offset:9216
    v_mfma_f32_16x16x32_bf16 v[212:215], v[104:107], v[76:79], v[212:215]
    ds_read_b64_tr_b16 v[104:105], v56 offset:8192
    s_waitcnt lgkmcnt(13)
    v_mfma_f32_16x16x32_bf16 v[216:219], v[108:111], v[72:75], v[216:219]
    ds_read_b64_tr_b16 v[106:107], v56 offset:9216
    v_mfma_f32_16x16x32_bf16 v[220:223], v[108:111], v[76:79], v[220:223]
    ds_read_b64_tr_b16 v[108:109], v57 offset:8192
    s_waitcnt lgkmcnt(13)
    v_mfma_f32_16x16x32_bf16 v[224:227], v[112:115], v[72:75], v[224:227]
    ds_read_b64_tr_b16 v[110:111], v57 offset:9216
    v_mfma_f32_16x16x32_bf16 v[228:231], v[112:115], v[76:79], v[228:231]
    ds_read_b64_tr_b16 v[112:113], v58 offset:8192
    s_waitcnt lgkmcnt(13)
    v_mfma_f32_16x16x32_bf16 v[232:235], v[116:119], v[72:75], v[232:235]
    ds_read_b64_tr_b16 v[114:115], v58 offset:9216
    v_mfma_f32_16x16x32_bf16 v[236:239], v[116:119], v[76:79], v[236:239]
    ds_read_b64_tr_b16 v[116:117], v59 offset:8192
    s_waitcnt lgkmcnt(13)
    v_mfma_f32_16x16x32_bf16 v[240:243], v[120:123], v[72:75], v[240:243]
    ds_read_b64_tr_b16 v[118:119], v59 offset:9216
    v_mfma_f32_16x16x32_bf16 v[244:247], v[120:123], v[76:79], v[244:247]
    ds_read_b64_tr_b16 v[120:121], v60 offset:8192
    s_waitcnt lgkmcnt(13)
    v_mfma_f32_16x16x32_bf16 v[248:251], v[124:127], v[72:75], v[248:251]
    ds_read_b64_tr_b16 v[122:123], v60 offset:9216
    v_mfma_f32_16x16x32_bf16 v[252:255], v[124:127], v[76:79], v[252:255]
    ds_read_b64_tr_b16 v[124:125], v61 offset:8192
    ds_read_b64_tr_b16 v[126:127], v61 offset:9216
    buffer_load_dwordx4 v[72:75], v13, s[8:11], s86 offen offset:3072 sc1
    buffer_load_dwordx4 v[76:79], v12, s[8:11], s86 offen offset:3072 sc1
    s_waitcnt vmcnt(28)
    s_waitcnt lgkmcnt(14)
    v_mfma_f32_16x16x32_bf16 v[192:195], v[96:99], v[80:83], v[192:195]
    v_mfma_f32_16x16x32_bf16 v[196:199], v[96:99], v[84:87], v[196:199]
    ds_read_b64_tr_b16 v[96:97], v54 offset:16384
    s_waitcnt lgkmcnt(13)
    v_mfma_f32_16x16x32_bf16 v[200:203], v[100:103], v[80:83], v[200:203]
    ds_read_b64_tr_b16 v[98:99], v54 offset:17408
    v_mfma_f32_16x16x32_bf16 v[204:207], v[100:103], v[84:87], v[204:207]
    ds_read_b64_tr_b16 v[100:101], v55 offset:16384
    s_waitcnt lgkmcnt(13)
    v_mfma_f32_16x16x32_bf16 v[208:211], v[104:107], v[80:83], v[208:211]
    ds_read_b64_tr_b16 v[102:103], v55 offset:17408
    v_mfma_f32_16x16x32_bf16 v[212:215], v[104:107], v[84:87], v[212:215]
    ds_read_b64_tr_b16 v[104:105], v56 offset:16384
    s_waitcnt lgkmcnt(13)
    v_mfma_f32_16x16x32_bf16 v[216:219], v[108:111], v[80:83], v[216:219]
    ds_read_b64_tr_b16 v[106:107], v56 offset:17408
    v_mfma_f32_16x16x32_bf16 v[220:223], v[108:111], v[84:87], v[220:223]
    ds_read_b64_tr_b16 v[108:109], v57 offset:16384
    s_waitcnt lgkmcnt(13)
    v_mfma_f32_16x16x32_bf16 v[224:227], v[112:115], v[80:83], v[224:227]
    ds_read_b64_tr_b16 v[110:111], v57 offset:17408
    v_mfma_f32_16x16x32_bf16 v[228:231], v[112:115], v[84:87], v[228:231]
    ds_read_b64_tr_b16 v[112:113], v58 offset:16384
    s_waitcnt lgkmcnt(13)
    v_mfma_f32_16x16x32_bf16 v[232:235], v[116:119], v[80:83], v[232:235]
    ds_read_b64_tr_b16 v[114:115], v58 offset:17408
    v_mfma_f32_16x16x32_bf16 v[236:239], v[116:119], v[84:87], v[236:239]
    ds_read_b64_tr_b16 v[116:117], v59 offset:16384
    s_waitcnt lgkmcnt(13)
    v_mfma_f32_16x16x32_bf16 v[240:243], v[120:123], v[80:83], v[240:243]
    ds_read_b64_tr_b16 v[118:119], v59 offset:17408
    v_mfma_f32_16x16x32_bf16 v[244:247], v[120:123], v[84:87], v[244:247]
    ds_read_b64_tr_b16 v[120:121], v60 offset:16384
    s_waitcnt lgkmcnt(13)
    v_mfma_f32_16x16x32_bf16 v[248:251], v[124:127], v[80:83], v[248:251]
    ds_read_b64_tr_b16 v[122:123], v60 offset:17408
    v_mfma_f32_16x16x32_bf16 v[252:255], v[124:127], v[84:87], v[252:255]
    ds_read_b64_tr_b16 v[124:125], v61 offset:16384
    ds_read_b64_tr_b16 v[126:127], v61 offset:17408
    buffer_load_dwordx4 v[80:83], v13, s[8:11], s87 offen offset:0 sc1
    buffer_load_dwordx4 v[84:87], v12, s[8:11], s87 offen offset:0 sc1
    s_waitcnt vmcnt(6)
    s_lshl_b32 s6, s4, 3
    s_add_u32 s6, s6, s5
    s_lshl_b32 s6, s6, 5
    s_add_u32 s6, s6, s3
    s_lshl_b32 s6, s6, 2
    s_add_u32 s6, s6, 3866624
    v_mov_b32 v2, 1
    v_mov_b32 v3, 0x4000000
    v_writelane_b32 v3, s6, 0
    buffer_store_dword v2, v3, s[8:11], 0 offen sc1
    s_waitcnt lgkmcnt(14)
    v_mfma_f32_16x16x32_bf16 v[192:195], v[96:99], v[88:91], v[192:195]
    v_mfma_f32_16x16x32_bf16 v[196:199], v[96:99], v[92:95], v[196:199]
    ds_read_b64_tr_b16 v[96:97], v54 offset:24576
    s_waitcnt lgkmcnt(13)
    v_mfma_f32_16x16x32_bf16 v[200:203], v[100:103], v[88:91], v[200:203]
    ds_read_b64_tr_b16 v[98:99], v54 offset:25600
    v_mfma_f32_16x16x32_bf16 v[204:207], v[100:103], v[92:95], v[204:207]
    ds_read_b64_tr_b16 v[100:101], v55 offset:24576
    s_waitcnt lgkmcnt(13)
    v_mfma_f32_16x16x32_bf16 v[208:211], v[104:107], v[88:91], v[208:211]
    ds_read_b64_tr_b16 v[102:103], v55 offset:25600
    v_mfma_f32_16x16x32_bf16 v[212:215], v[104:107], v[92:95], v[212:215]
    ds_read_b64_tr_b16 v[104:105], v56 offset:24576
    s_waitcnt lgkmcnt(13)
    v_mfma_f32_16x16x32_bf16 v[216:219], v[108:111], v[88:91], v[216:219]
    ds_read_b64_tr_b16 v[106:107], v56 offset:25600
    v_mfma_f32_16x16x32_bf16 v[220:223], v[108:111], v[92:95], v[220:223]
    ds_read_b64_tr_b16 v[108:109], v57 offset:24576
    s_waitcnt lgkmcnt(13)
    v_mfma_f32_16x16x32_bf16 v[224:227], v[112:115], v[88:91], v[224:227]
    ds_read_b64_tr_b16 v[110:111], v57 offset:25600
    v_mfma_f32_16x16x32_bf16 v[228:231], v[112:115], v[92:95], v[228:231]
    ds_read_b64_tr_b16 v[112:113], v58 offset:24576
    s_waitcnt lgkmcnt(13)
    v_mfma_f32_16x16x32_bf16 v[232:235], v[116:119], v[88:91], v[232:235]
    ds_read_b64_tr_b16 v[114:115], v58 offset:25600
    v_mfma_f32_16x16x32_bf16 v[236:239], v[116:119], v[92:95], v[236:239]
    ds_read_b64_tr_b16 v[116:117], v59 offset:24576
    s_waitcnt lgkmcnt(13)
    v_mfma_f32_16x16x32_bf16 v[240:243], v[120:123], v[88:91], v[240:243]
    ds_read_b64_tr_b16 v[118:119], v59 offset:25600
    v_mfma_f32_16x16x32_bf16 v[244:247], v[120:123], v[92:95], v[244:247]
    ds_read_b64_tr_b16 v[120:121], v60 offset:24576
    s_waitcnt lgkmcnt(13)
    v_mfma_f32_16x16x32_bf16 v[248:251], v[124:127], v[88:91], v[248:251]
    ds_read_b64_tr_b16 v[122:123], v60 offset:25600
    v_mfma_f32_16x16x32_bf16 v[252:255], v[124:127], v[92:95], v[252:255]
    ds_read_b64_tr_b16 v[124:125], v61 offset:24576
    ds_read_b64_tr_b16 v[126:127], v61 offset:25600
    buffer_load_dwordx4 v[88:91], v13, s[8:11], s87 offen offset:1024 sc1
    buffer_load_dwordx4 v[92:95], v12, s[8:11], s87 offen offset:1024 sc1
    s_waitcnt lgkmcnt(14)
    v_mfma_f32_16x16x32_bf16 v[192:195], v[96:99], v[16:19], v[192:195]
    v_mfma_f32_16x16x32_bf16 v[196:199], v[96:99], v[20:23], v[196:199]
    ds_read_b64_tr_b16 v[96:97], v54 offset:32768
    s_waitcnt lgkmcnt(13)
    v_mfma_f32_16x16x32_bf16 v[200:203], v[100:103], v[16:19], v[200:203]
    ds_read_b64_tr_b16 v[98:99], v54 offset:33792
    v_mfma_f32_16x16x32_bf16 v[204:207], v[100:103], v[20:23], v[204:207]
    ds_read_b64_tr_b16 v[100:101], v55 offset:32768
    s_waitcnt lgkmcnt(13)
    v_mfma_f32_16x16x32_bf16 v[208:211], v[104:107], v[16:19], v[208:211]
    ds_read_b64_tr_b16 v[102:103], v55 offset:33792
    v_mfma_f32_16x16x32_bf16 v[212:215], v[104:107], v[20:23], v[212:215]
    ds_read_b64_tr_b16 v[104:105], v56 offset:32768
    s_waitcnt lgkmcnt(13)
    v_mfma_f32_16x16x32_bf16 v[216:219], v[108:111], v[16:19], v[216:219]
    ds_read_b64_tr_b16 v[106:107], v56 offset:33792
    v_mfma_f32_16x16x32_bf16 v[220:223], v[108:111], v[20:23], v[220:223]
    ds_read_b64_tr_b16 v[108:109], v57 offset:32768
    s_waitcnt lgkmcnt(13)
    v_mfma_f32_16x16x32_bf16 v[224:227], v[112:115], v[16:19], v[224:227]
    ds_read_b64_tr_b16 v[110:111], v57 offset:33792
    v_mfma_f32_16x16x32_bf16 v[228:231], v[112:115], v[20:23], v[228:231]
    ds_read_b64_tr_b16 v[112:113], v58 offset:32768
    s_waitcnt lgkmcnt(13)
    v_mfma_f32_16x16x32_bf16 v[232:235], v[116:119], v[16:19], v[232:235]
    ds_read_b64_tr_b16 v[114:115], v58 offset:33792
    v_mfma_f32_16x16x32_bf16 v[236:239], v[116:119], v[20:23], v[236:239]
    ds_read_b64_tr_b16 v[116:117], v59 offset:32768
    s_waitcnt lgkmcnt(13)
    v_mfma_f32_16x16x32_bf16 v[240:243], v[120:123], v[16:19], v[240:243]
    ds_read_b64_tr_b16 v[118:119], v59 offset:33792
    v_mfma_f32_16x16x32_bf16 v[244:247], v[120:123], v[20:23], v[244:247]
    ds_read_b64_tr_b16 v[120:121], v60 offset:32768
    s_waitcnt lgkmcnt(13)
    v_mfma_f32_16x16x32_bf16 v[248:251], v[124:127], v[16:19], v[248:251]
    ds_read_b64_tr_b16 v[122:123], v60 offset:33792
    v_mfma_f32_16x16x32_bf16 v[252:255], v[124:127], v[20:23], v[252:255]
    ds_read_b64_tr_b16 v[124:125], v61 offset:32768
    ds_read_b64_tr_b16 v[126:127], v61 offset:33792
    buffer_load_dwordx4 v[16:19], v13, s[8:11], s87 offen offset:2048 sc1
    buffer_load_dwordx4 v[20:23], v12, s[8:11], s87 offen offset:2048 sc1
    s_waitcnt lgkmcnt(14)
    v_mfma_f32_16x16x32_bf16 v[192:195], v[96:99], v[24:27], v[192:195]
    v_mfma_f32_16x16x32_bf16 v[196:199], v[96:99], v[28:31], v[196:199]
    ds_read_b64_tr_b16 v[96:97], v54 offset:40960
    s_waitcnt lgkmcnt(13)
    v_mfma_f32_16x16x32_bf16 v[200:203], v[100:103], v[24:27], v[200:203]
    ds_read_b64_tr_b16 v[98:99], v54 offset:41984
    v_mfma_f32_16x16x32_bf16 v[204:207], v[100:103], v[28:31], v[204:207]
    ds_read_b64_tr_b16 v[100:101], v55 offset:40960
    s_waitcnt lgkmcnt(13)
    v_mfma_f32_16x16x32_bf16 v[208:211], v[104:107], v[24:27], v[208:211]
    ds_read_b64_tr_b16 v[102:103], v55 offset:41984
    v_mfma_f32_16x16x32_bf16 v[212:215], v[104:107], v[28:31], v[212:215]
    ds_read_b64_tr_b16 v[104:105], v56 offset:40960
    s_waitcnt lgkmcnt(13)
    v_mfma_f32_16x16x32_bf16 v[216:219], v[108:111], v[24:27], v[216:219]
    ds_read_b64_tr_b16 v[106:107], v56 offset:41984
    v_mfma_f32_16x16x32_bf16 v[220:223], v[108:111], v[28:31], v[220:223]
    ds_read_b64_tr_b16 v[108:109], v57 offset:40960
    s_waitcnt lgkmcnt(13)
    v_mfma_f32_16x16x32_bf16 v[224:227], v[112:115], v[24:27], v[224:227]
    ds_read_b64_tr_b16 v[110:111], v57 offset:41984
    v_mfma_f32_16x16x32_bf16 v[228:231], v[112:115], v[28:31], v[228:231]
    ds_read_b64_tr_b16 v[112:113], v58 offset:40960
    s_waitcnt lgkmcnt(13)
    v_mfma_f32_16x16x32_bf16 v[232:235], v[116:119], v[24:27], v[232:235]
    ds_read_b64_tr_b16 v[114:115], v58 offset:41984
    v_mfma_f32_16x16x32_bf16 v[236:239], v[116:119], v[28:31], v[236:239]
    ds_read_b64_tr_b16 v[116:117], v59 offset:40960
    s_waitcnt lgkmcnt(13)
    v_mfma_f32_16x16x32_bf16 v[240:243], v[120:123], v[24:27], v[240:243]
    ds_read_b64_tr_b16 v[118:119], v59 offset:41984
    v_mfma_f32_16x16x32_bf16 v[244:247], v[120:123], v[28:31], v[244:247]
    ds_read_b64_tr_b16 v[120:121], v60 offset:40960
    s_waitcnt lgkmcnt(13)
    v_mfma_f32_16x16x32_bf16 v[248:251], v[124:127], v[24:27], v[248:251]
    ds_read_b64_tr_b16 v[122:123], v60 offset:41984
    v_mfma_f32_16x16x32_bf16 v[252:255], v[124:127], v[28:31], v[252:255]
    ds_read_b64_tr_b16 v[124:125], v61 offset:40960
    ds_read_b64_tr_b16 v[126:127], v61 offset:41984
    buffer_load_dwordx4 v[24:27], v13, s[8:11], s87 offen offset:3072 sc1
    buffer_load_dwordx4 v[28:31], v12, s[8:11], s87 offen offset:3072 sc1
    s_waitcnt lgkmcnt(14)
    v_mfma_f32_16x16x32_bf16 v[192:195], v[96:99], v[32:35], v[192:195]
    v_mfma_f32_16x16x32_bf16 v[196:199], v[96:99], v[36:39], v[196:199]
    ds_read_b64_tr_b16 v[96:97], v54 offset:49152
    s_waitcnt lgkmcnt(13)
    v_mfma_f32_16x16x32_bf16 v[200:203], v[100:103], v[32:35], v[200:203]
    ds_read_b64_tr_b16 v[98:99], v54 offset:50176
    v_mfma_f32_16x16x32_bf16 v[204:207], v[100:103], v[36:39], v[204:207]
    ds_read_b64_tr_b16 v[100:101], v55 offset:49152
    s_waitcnt lgkmcnt(13)
    v_mfma_f32_16x16x32_bf16 v[208:211], v[104:107], v[32:35], v[208:211]
    ds_read_b64_tr_b16 v[102:103], v55 offset:50176
    v_mfma_f32_16x16x32_bf16 v[212:215], v[104:107], v[36:39], v[212:215]
    ds_read_b64_tr_b16 v[104:105], v56 offset:49152
    s_waitcnt lgkmcnt(13)
    v_mfma_f32_16x16x32_bf16 v[216:219], v[108:111], v[32:35], v[216:219]
    ds_read_b64_tr_b16 v[106:107], v56 offset:50176
    v_mfma_f32_16x16x32_bf16 v[220:223], v[108:111], v[36:39], v[220:223]
    ds_read_b64_tr_b16 v[108:109], v57 offset:49152
    s_waitcnt lgkmcnt(13)
    v_mfma_f32_16x16x32_bf16 v[224:227], v[112:115], v[32:35], v[224:227]
    ds_read_b64_tr_b16 v[110:111], v57 offset:50176
    v_mfma_f32_16x16x32_bf16 v[228:231], v[112:115], v[36:39], v[228:231]
    ds_read_b64_tr_b16 v[112:113], v58 offset:49152
    s_waitcnt lgkmcnt(13)
    v_mfma_f32_16x16x32_bf16 v[232:235], v[116:119], v[32:35], v[232:235]
    ds_read_b64_tr_b16 v[114:115], v58 offset:50176
    v_mfma_f32_16x16x32_bf16 v[236:239], v[116:119], v[36:39], v[236:239]
    ds_read_b64_tr_b16 v[116:117], v59 offset:49152
    s_waitcnt lgkmcnt(13)
    v_mfma_f32_16x16x32_bf16 v[240:243], v[120:123], v[32:35], v[240:243]
    ds_read_b64_tr_b16 v[118:119], v59 offset:50176
    v_mfma_f32_16x16x32_bf16 v[244:247], v[120:123], v[36:39], v[244:247]
    ds_read_b64_tr_b16 v[120:121], v60 offset:49152
    s_waitcnt lgkmcnt(13)
    v_mfma_f32_16x16x32_bf16 v[248:251], v[124:127], v[32:35], v[248:251]
    ds_read_b64_tr_b16 v[122:123], v60 offset:50176
    v_mfma_f32_16x16x32_bf16 v[252:255], v[124:127], v[36:39], v[252:255]
    ds_read_b64_tr_b16 v[124:125], v61 offset:49152
    ds_read_b64_tr_b16 v[126:127], v61 offset:50176
    buffer_load_dwordx4 v[32:35], v13, s[8:11], s88 offen offset:0 sc1
    buffer_load_dwordx4 v[36:39], v12, s[8:11], s88 offen offset:0 sc1
    s_waitcnt vmcnt(13)
    s_waitcnt lgkmcnt(14)
    v_mfma_f32_16x16x32_bf16 v[192:195], v[96:99], v[64:67], v[192:195]
    v_mfma_f32_16x16x32_bf16 v[196:199], v[96:99], v[68:71], v[196:199]
    ds_read_b64_tr_b16 v[96:97], v54 offset:57344
    s_waitcnt lgkmcnt(13)
    v_mfma_f32_16x16x32_bf16 v[200:203], v[100:103], v[64:67], v[200:203]
    ds_read_b64_tr_b16 v[98:99], v54 offset:58368
    v_mfma_f32_16x16x32_bf16 v[204:207], v[100:103], v[68:71], v[204:207]
    ds_read_b64_tr_b16 v[100:101], v55 offset:57344
    s_waitcnt lgkmcnt(13)
    v_mfma_f32_16x16x32_bf16 v[208:211], v[104:107], v[64:67], v[208:211]
    ds_read_b64_tr_b16 v[102:103], v55 offset:58368
    v_mfma_f32_16x16x32_bf16 v[212:215], v[104:107], v[68:71], v[212:215]
    ds_read_b64_tr_b16 v[104:105], v56 offset:57344
    s_waitcnt lgkmcnt(13)
    v_mfma_f32_16x16x32_bf16 v[216:219], v[108:111], v[64:67], v[216:219]
    ds_read_b64_tr_b16 v[106:107], v56 offset:58368
    v_mfma_f32_16x16x32_bf16 v[220:223], v[108:111], v[68:71], v[220:223]
    ds_read_b64_tr_b16 v[108:109], v57 offset:57344
    s_waitcnt lgkmcnt(13)
    v_mfma_f32_16x16x32_bf16 v[224:227], v[112:115], v[64:67], v[224:227]
    ds_read_b64_tr_b16 v[110:111], v57 offset:58368
    v_mfma_f32_16x16x32_bf16 v[228:231], v[112:115], v[68:71], v[228:231]
    ds_read_b64_tr_b16 v[112:113], v58 offset:57344
    s_waitcnt lgkmcnt(13)
    v_mfma_f32_16x16x32_bf16 v[232:235], v[116:119], v[64:67], v[232:235]
    ds_read_b64_tr_b16 v[114:115], v58 offset:58368
    v_mfma_f32_16x16x32_bf16 v[236:239], v[116:119], v[68:71], v[236:239]
    ds_read_b64_tr_b16 v[116:117], v59 offset:57344
    s_waitcnt lgkmcnt(13)
    v_mfma_f32_16x16x32_bf16 v[240:243], v[120:123], v[64:67], v[240:243]
    ds_read_b64_tr_b16 v[118:119], v59 offset:58368
    v_mfma_f32_16x16x32_bf16 v[244:247], v[120:123], v[68:71], v[244:247]
    ds_read_b64_tr_b16 v[120:121], v60 offset:57344
    s_waitcnt lgkmcnt(13)
    v_mfma_f32_16x16x32_bf16 v[248:251], v[124:127], v[64:67], v[248:251]
    ds_read_b64_tr_b16 v[122:123], v60 offset:58368
    v_mfma_f32_16x16x32_bf16 v[252:255], v[124:127], v[68:71], v[252:255]
    ds_read_b64_tr_b16 v[124:125], v61 offset:57344
    ds_read_b64_tr_b16 v[126:127], v61 offset:58368
    buffer_load_dwordx4 v[64:67], v13, s[8:11], s88 offen offset:1024 sc1
    buffer_load_dwordx4 v[68:71], v12, s[8:11], s88 offen offset:1024 sc1
    s_waitcnt vmcnt(13)
    s_waitcnt lgkmcnt(14)
    v_mfma_f32_16x16x32_bf16 v[192:195], v[96:99], v[72:75], v[192:195]
    v_add_u32 v54, 0x10000, v54
    v_mfma_f32_16x16x32_bf16 v[196:199], v[96:99], v[76:79], v[196:199]
    s_waitcnt lgkmcnt(12)
    v_mfma_f32_16x16x32_bf16 v[200:203], v[100:103], v[72:75], v[200:203]
    v_add_u32 v55, 0x10000, v55
    v_mfma_f32_16x16x32_bf16 v[204:207], v[100:103], v[76:79], v[204:207]
    s_waitcnt lgkmcnt(0)
    s_barrier
    ds_read_b64_tr_b16 v[96:97], v54 offset:0
    ds_read_b64_tr_b16 v[98:99], v54 offset:1024
    ds_read_b64_tr_b16 v[100:101], v55 offset:0
    v_mfma_f32_16x16x32_bf16 v[208:211], v[104:107], v[72:75], v[208:211]
    ds_read_b64_tr_b16 v[102:103], v55 offset:1024
    v_add_u32 v56, 0x10000, v56
    v_mfma_f32_16x16x32_bf16 v[212:215], v[104:107], v[76:79], v[212:215]
    ds_read_b64_tr_b16 v[104:105], v56 offset:0
    v_mfma_f32_16x16x32_bf16 v[216:219], v[108:111], v[72:75], v[216:219]
    ds_read_b64_tr_b16 v[106:107], v56 offset:1024
    v_add_u32 v57, 0x10000, v57
    v_mfma_f32_16x16x32_bf16 v[220:223], v[108:111], v[76:79], v[220:223]
    ds_read_b64_tr_b16 v[108:109], v57 offset:0
    v_mfma_f32_16x16x32_bf16 v[224:227], v[112:115], v[72:75], v[224:227]
    ds_read_b64_tr_b16 v[110:111], v57 offset:1024
    v_add_u32 v58, 0x10000, v58
    v_mfma_f32_16x16x32_bf16 v[228:231], v[112:115], v[76:79], v[228:231]
    ds_read_b64_tr_b16 v[112:113], v58 offset:0
    v_mfma_f32_16x16x32_bf16 v[232:235], v[116:119], v[72:75], v[232:235]
    ds_read_b64_tr_b16 v[114:115], v58 offset:1024
    v_add_u32 v59, 0x10000, v59
    v_mfma_f32_16x16x32_bf16 v[236:239], v[116:119], v[76:79], v[236:239]
    ds_read_b64_tr_b16 v[116:117], v59 offset:0
    v_mfma_f32_16x16x32_bf16 v[240:243], v[120:123], v[72:75], v[240:243]
    ds_read_b64_tr_b16 v[118:119], v59 offset:1024
    v_add_u32 v60, 0x10000, v60
    v_mfma_f32_16x16x32_bf16 v[244:247], v[120:123], v[76:79], v[244:247]
    ds_read_b64_tr_b16 v[120:121], v60 offset:0
    v_mfma_f32_16x16x32_bf16 v[248:251], v[124:127], v[72:75], v[248:251]
    ds_read_b64_tr_b16 v[122:123], v60 offset:1024
    v_add_u32 v61, 0x10000, v61
    v_mfma_f32_16x16x32_bf16 v[252:255], v[124:127], v[76:79], v[252:255]
    ds_read_b64_tr_b16 v[124:125], v61 offset:0
    ds_read_b64_tr_b16 v[126:127], v61 offset:1024
    buffer_load_dwordx4 v[72:75], v13, s[8:11], s88 offen offset:2048 sc1
    buffer_load_dwordx4 v[76:79], v12, s[8:11], s88 offen offset:2048 sc1
    s_waitcnt vmcnt(13)
    s_waitcnt lgkmcnt(14)
    v_mfma_f32_16x16x32_bf16 v[192:195], v[96:99], v[80:83], v[192:195]
    v_mfma_f32_16x16x32_bf16 v[196:199], v[96:99], v[84:87], v[196:199]
    ds_read_b64_tr_b16 v[96:97], v54 offset:8192
    s_waitcnt lgkmcnt(13)
    v_mfma_f32_16x16x32_bf16 v[200:203], v[100:103], v[80:83], v[200:203]
    ds_read_b64_tr_b16 v[98:99], v54 offset:9216
    v_mfma_f32_16x16x32_bf16 v[204:207], v[100:103], v[84:87], v[204:207]
    ds_read_b64_tr_b16 v[100:101], v55 offset:8192
    s_waitcnt lgkmcnt(13)
    v_mfma_f32_16x16x32_bf16 v[208:211], v[104:107], v[80:83], v[208:211]
    ds_read_b64_tr_b16 v[102:103], v55 offset:9216
    v_mfma_f32_16x16x32_bf16 v[212:215], v[104:107], v[84:87], v[212:215]
    ds_read_b64_tr_b16 v[104:105], v56 offset:8192
    s_waitcnt lgkmcnt(13)
    v_mfma_f32_16x16x32_bf16 v[216:219], v[108:111], v[80:83], v[216:219]
    ds_read_b64_tr_b16 v[106:107], v56 offset:9216
    v_mfma_f32_16x16x32_bf16 v[220:223], v[108:111], v[84:87], v[220:223]
    ds_read_b64_tr_b16 v[108:109], v57 offset:8192
    s_waitcnt lgkmcnt(13)
    v_mfma_f32_16x16x32_bf16 v[224:227], v[112:115], v[80:83], v[224:227]
    ds_read_b64_tr_b16 v[110:111], v57 offset:9216
    v_mfma_f32_16x16x32_bf16 v[228:231], v[112:115], v[84:87], v[228:231]
    ds_read_b64_tr_b16 v[112:113], v58 offset:8192
    s_waitcnt lgkmcnt(13)
    v_mfma_f32_16x16x32_bf16 v[232:235], v[116:119], v[80:83], v[232:235]
    ds_read_b64_tr_b16 v[114:115], v58 offset:9216
    v_mfma_f32_16x16x32_bf16 v[236:239], v[116:119], v[84:87], v[236:239]
    ds_read_b64_tr_b16 v[116:117], v59 offset:8192
    s_waitcnt lgkmcnt(13)
    v_mfma_f32_16x16x32_bf16 v[240:243], v[120:123], v[80:83], v[240:243]
    ds_read_b64_tr_b16 v[118:119], v59 offset:9216
    v_mfma_f32_16x16x32_bf16 v[244:247], v[120:123], v[84:87], v[244:247]
    ds_read_b64_tr_b16 v[120:121], v60 offset:8192
    s_waitcnt lgkmcnt(13)
    v_mfma_f32_16x16x32_bf16 v[248:251], v[124:127], v[80:83], v[248:251]
    ds_read_b64_tr_b16 v[122:123], v60 offset:9216
    v_mfma_f32_16x16x32_bf16 v[252:255], v[124:127], v[84:87], v[252:255]
    ds_read_b64_tr_b16 v[124:125], v61 offset:8192
    ds_read_b64_tr_b16 v[126:127], v61 offset:9216
    buffer_load_dwordx4 v[80:83], v13, s[8:11], s88 offen offset:3072 sc1
    buffer_load_dwordx4 v[84:87], v12, s[8:11], s88 offen offset:3072 sc1
    s_waitcnt vmcnt(12)
    s_waitcnt lgkmcnt(14)
    v_mfma_f32_16x16x32_bf16 v[192:195], v[96:99], v[88:91], v[192:195]
    v_mfma_f32_16x16x32_bf16 v[196:199], v[96:99], v[92:95], v[196:199]
    ds_read_b64_tr_b16 v[96:97], v54 offset:16384
    s_waitcnt lgkmcnt(13)
    v_mfma_f32_16x16x32_bf16 v[200:203], v[100:103], v[88:91], v[200:203]
    ds_read_b64_tr_b16 v[98:99], v54 offset:17408
    v_mfma_f32_16x16x32_bf16 v[204:207], v[100:103], v[92:95], v[204:207]
    ds_read_b64_tr_b16 v[100:101], v55 offset:16384
    s_waitcnt lgkmcnt(13)
    v_mfma_f32_16x16x32_bf16 v[208:211], v[104:107], v[88:91], v[208:211]
    ds_read_b64_tr_b16 v[102:103], v55 offset:17408
    v_mfma_f32_16x16x32_bf16 v[212:215], v[104:107], v[92:95], v[212:215]
    ds_read_b64_tr_b16 v[104:105], v56 offset:16384
    s_waitcnt lgkmcnt(13)
    v_mfma_f32_16x16x32_bf16 v[216:219], v[108:111], v[88:91], v[216:219]
    ds_read_b64_tr_b16 v[106:107], v56 offset:17408
    v_mfma_f32_16x16x32_bf16 v[220:223], v[108:111], v[92:95], v[220:223]
    ds_read_b64_tr_b16 v[108:109], v57 offset:16384
    s_waitcnt lgkmcnt(13)
    v_mfma_f32_16x16x32_bf16 v[224:227], v[112:115], v[88:91], v[224:227]
    ds_read_b64_tr_b16 v[110:111], v57 offset:17408
    v_mfma_f32_16x16x32_bf16 v[228:231], v[112:115], v[92:95], v[228:231]
    ds_read_b64_tr_b16 v[112:113], v58 offset:16384
    s_waitcnt lgkmcnt(13)
    v_mfma_f32_16x16x32_bf16 v[232:235], v[116:119], v[88:91], v[232:235]
    ds_read_b64_tr_b16 v[114:115], v58 offset:17408
    v_mfma_f32_16x16x32_bf16 v[236:239], v[116:119], v[92:95], v[236:239]
    ds_read_b64_tr_b16 v[116:117], v59 offset:16384
    s_waitcnt lgkmcnt(13)
    v_mfma_f32_16x16x32_bf16 v[240:243], v[120:123], v[88:91], v[240:243]
    ds_read_b64_tr_b16 v[118:119], v59 offset:17408
    v_mfma_f32_16x16x32_bf16 v[244:247], v[120:123], v[92:95], v[244:247]
    ds_read_b64_tr_b16 v[120:121], v60 offset:16384
    s_waitcnt lgkmcnt(13)
    v_mfma_f32_16x16x32_bf16 v[248:251], v[124:127], v[88:91], v[248:251]
    ds_read_b64_tr_b16 v[122:123], v60 offset:17408
    v_mfma_f32_16x16x32_bf16 v[252:255], v[124:127], v[92:95], v[252:255]
    ds_read_b64_tr_b16 v[124:125], v61 offset:16384
    ds_read_b64_tr_b16 v[126:127], v61 offset:17408
    s_waitcnt vmcnt(10)
    s_waitcnt lgkmcnt(14)
    v_mfma_f32_16x16x32_bf16 v[192:195], v[96:99], v[16:19], v[192:195]
    v_mfma_f32_16x16x32_bf16 v[196:199], v[96:99], v[20:23], v[196:199]
    ds_read_b64_tr_b16 v[96:97], v54 offset:24576
    s_waitcnt lgkmcnt(13)
    v_mfma_f32_16x16x32_bf16 v[200:203], v[100:103], v[16:19], v[200:203]
    ds_read_b64_tr_b16 v[98:99], v54 offset:25600
    v_mfma_f32_16x16x32_bf16 v[204:207], v[100:103], v[20:23], v[204:207]
    ds_read_b64_tr_b16 v[100:101], v55 offset:24576
    s_waitcnt lgkmcnt(13)
    v_mfma_f32_16x16x32_bf16 v[208:211], v[104:107], v[16:19], v[208:211]
    ds_read_b64_tr_b16 v[102:103], v55 offset:25600
    v_mfma_f32_16x16x32_bf16 v[212:215], v[104:107], v[20:23], v[212:215]
    ds_read_b64_tr_b16 v[104:105], v56 offset:24576
    s_waitcnt lgkmcnt(13)
    v_mfma_f32_16x16x32_bf16 v[216:219], v[108:111], v[16:19], v[216:219]
    ds_read_b64_tr_b16 v[106:107], v56 offset:25600
    v_mfma_f32_16x16x32_bf16 v[220:223], v[108:111], v[20:23], v[220:223]
    ds_read_b64_tr_b16 v[108:109], v57 offset:24576
    s_waitcnt lgkmcnt(13)
    v_mfma_f32_16x16x32_bf16 v[224:227], v[112:115], v[16:19], v[224:227]
    ds_read_b64_tr_b16 v[110:111], v57 offset:25600
    v_mfma_f32_16x16x32_bf16 v[228:231], v[112:115], v[20:23], v[228:231]
    ds_read_b64_tr_b16 v[112:113], v58 offset:24576
    s_waitcnt lgkmcnt(13)
    v_mfma_f32_16x16x32_bf16 v[232:235], v[116:119], v[16:19], v[232:235]
    ds_read_b64_tr_b16 v[114:115], v58 offset:25600
    v_mfma_f32_16x16x32_bf16 v[236:239], v[116:119], v[20:23], v[236:239]
    ds_read_b64_tr_b16 v[116:117], v59 offset:24576
    s_waitcnt lgkmcnt(13)
    v_mfma_f32_16x16x32_bf16 v[240:243], v[120:123], v[16:19], v[240:243]
    ds_read_b64_tr_b16 v[118:119], v59 offset:25600
    v_mfma_f32_16x16x32_bf16 v[244:247], v[120:123], v[20:23], v[244:247]
    ds_read_b64_tr_b16 v[120:121], v60 offset:24576
    s_waitcnt lgkmcnt(13)
    v_mfma_f32_16x16x32_bf16 v[248:251], v[124:127], v[16:19], v[248:251]
    ds_read_b64_tr_b16 v[122:123], v60 offset:25600
    v_mfma_f32_16x16x32_bf16 v[252:255], v[124:127], v[20:23], v[252:255]
    ds_read_b64_tr_b16 v[124:125], v61 offset:24576
    ds_read_b64_tr_b16 v[126:127], v61 offset:25600
    s_waitcnt vmcnt(8)
    s_waitcnt lgkmcnt(14)
    v_mfma_f32_16x16x32_bf16 v[192:195], v[96:99], v[24:27], v[192:195]
    v_mfma_f32_16x16x32_bf16 v[196:199], v[96:99], v[28:31], v[196:199]
    ds_read_b64_tr_b16 v[96:97], v54 offset:32768
    s_waitcnt lgkmcnt(13)
    v_mfma_f32_16x16x32_bf16 v[200:203], v[100:103], v[24:27], v[200:203]
    ds_read_b64_tr_b16 v[98:99], v54 offset:33792
    v_mfma_f32_16x16x32_bf16 v[204:207], v[100:103], v[28:31], v[204:207]
    ds_read_b64_tr_b16 v[100:101], v55 offset:32768
    s_waitcnt lgkmcnt(13)
    v_mfma_f32_16x16x32_bf16 v[208:211], v[104:107], v[24:27], v[208:211]
    ds_read_b64_tr_b16 v[102:103], v55 offset:33792
    v_mfma_f32_16x16x32_bf16 v[212:215], v[104:107], v[28:31], v[212:215]
    ds_read_b64_tr_b16 v[104:105], v56 offset:32768
    s_waitcnt lgkmcnt(13)
    v_mfma_f32_16x16x32_bf16 v[216:219], v[108:111], v[24:27], v[216:219]
    ds_read_b64_tr_b16 v[106:107], v56 offset:33792
    v_mfma_f32_16x16x32_bf16 v[220:223], v[108:111], v[28:31], v[220:223]
    ds_read_b64_tr_b16 v[108:109], v57 offset:32768
    s_waitcnt lgkmcnt(13)
    v_mfma_f32_16x16x32_bf16 v[224:227], v[112:115], v[24:27], v[224:227]
    ds_read_b64_tr_b16 v[110:111], v57 offset:33792
    v_mfma_f32_16x16x32_bf16 v[228:231], v[112:115], v[28:31], v[228:231]
    ds_read_b64_tr_b16 v[112:113], v58 offset:32768
    s_waitcnt lgkmcnt(13)
    v_mfma_f32_16x16x32_bf16 v[232:235], v[116:119], v[24:27], v[232:235]
    ds_read_b64_tr_b16 v[114:115], v58 offset:33792
    v_mfma_f32_16x16x32_bf16 v[236:239], v[116:119], v[28:31], v[236:239]
    ds_read_b64_tr_b16 v[116:117], v59 offset:32768
    s_waitcnt lgkmcnt(13)
    v_mfma_f32_16x16x32_bf16 v[240:243], v[120:123], v[24:27], v[240:243]
    ds_read_b64_tr_b16 v[118:119], v59 offset:33792
    v_mfma_f32_16x16x32_bf16 v[244:247], v[120:123], v[28:31], v[244:247]
    ds_read_b64_tr_b16 v[120:121], v60 offset:32768
    s_waitcnt lgkmcnt(13)
    v_mfma_f32_16x16x32_bf16 v[248:251], v[124:127], v[24:27], v[248:251]
    ds_read_b64_tr_b16 v[122:123], v60 offset:33792
    v_mfma_f32_16x16x32_bf16 v[252:255], v[124:127], v[28:31], v[252:255]
    ds_read_b64_tr_b16 v[124:125], v61 offset:32768
    ds_read_b64_tr_b16 v[126:127], v61 offset:33792
    s_waitcnt vmcnt(0)
    s_cmp_ge_u32 s3, 4
    s_cbranch_scc1 L_q_nolde
    s_cmp_ge_u32 s90, 8
    s_cbranch_scc1 L_kvpd_8
    s_lshl_b32 s7, s4, 10
    s_add_u32 s7, s7, 3866624
    v_lshrrev_b32 v2, 3, v1
    v_and_b32 v3, 7, v1
    v_lshlrev_b32 v3, 2, v3
    v_lshl_add_u32 v3, v2, 7, v3
    s_mov_b32 s79, 262144
L_kvp_7:
    buffer_load_dword v2, v3, s[8:11], s7 offen sc1
    s_waitcnt vmcnt(0)
    v_cmp_ne_u32 vcc, 1, v2
    s_nop 3
    s_ff1_i32_b64 s90, vcc
    s_cmp_ge_u32 s90, 8
    s_cbranch_scc1 L_kvpd_8
    s_sleep 2
    s_sub_u32 s79, s79, 1
    s_cmp_lg_u32 s79, 0
    s_cbranch_scc1 L_kvp_7
L_kvpd_8:
    s_lshl_b32 s6, s76, 13
    s_add_u32 s6, s6, s78
    s_add_u32 m0, s6, 0
    s_add_u32 s7, s77, 0
    buffer_load_dwordx4 v49, s[8:11], s7 offen offset:0 sc1 lds
    buffer_load_dwordx4 v49, s[8:11], s7 offen offset:1024 sc1 lds
    buffer_load_dwordx4 v49, s[8:11], s7 offen offset:2048 sc1 lds
    buffer_load_dwordx4 v49, s[8:11], s7 offen offset:3072 sc1 lds
    s_lshl_b32 s6, s76, 13
    s_add_u32 s6, s6, s78
    s_add_u32 m0, s6, 4096
    s_add_u32 s7, s77, 4096
    buffer_load_dwordx4 v49, s[8:11], s7 offen offset:0 sc1 lds
    buffer_load_dwordx4 v49, s[8:11], s7 offen offset:1024 sc1 lds
    buffer_load_dwordx4 v49, s[8:11], s7 offen offset:2048 sc1 lds
    buffer_load_dwordx4 v49, s[8:11], s7 offen offset:3072 sc1 lds
    s_lshl_b32 s6, s76, 12
    s_add_u32 s6, s6, s78
    s_add_u32 m0, s6, 49152
    s_add_u32 s7, s77, 524288
    buffer_load_dwordx4 v50, s[8:11], s7 offen offset:0 sc1 lds
    buffer_load_dwordx4 v50, s[8:11], s7 offen offset:1024 sc1 lds
    buffer_load_dwordx4 v50, s[8:11], s7 offen offset:2048 sc1 lds
    buffer_load_dwordx4 v50, s[8:11], s7 offen offset:3072 sc1 lds
    s_branch L_q_je
L_q_nolde:
    v_mov_b32 v3, 0
    buffer_load_dword v63, v3, s[28:31], 0 offen offset:128 sc1
L_q_je:
    s_waitcnt lgkmcnt(14)
    v_mfma_f32_16x16x32_bf16 v[192:195], v[96:99], v[32:35], v[192:195]
    v_mfma_f32_16x16x32_bf16 v[196:199], v[96:99], v[36:39], v[196:199]
    ds_read_b64_tr_b16 v[96:97], v54 offset:40960
    s_waitcnt lgkmcnt(13)
    v_mfma_f32_16x16x32_bf16 v[200:203], v[100:103], v[32:35], v[200:203]
    ds_read_b64_tr_b16 v[98:99], v54 offset:41984
    v_mfma_f32_16x16x32_bf16 v[204:207], v[100:103], v[36:39], v[204:207]
    ds_read_b64_tr_b16 v[100:101], v55 offset:40960
    s_waitcnt lgkmcnt(13)
    v_mfma_f32_16x16x32_bf16 v[208:211], v[104:107], v[32:35], v[208:211]
    ds_read_b64_tr_b16 v[102:103], v55 offset:41984
    v_mfma_f32_16x16x32_bf16 v[212:215], v[104:107], v[36:39], v[212:215]
    ds_read_b64_tr_b16 v[104:105], v56 offset:40960
    s_waitcnt lgkmcnt(13)
    v_mfma_f32_16x16x32_bf16 v[216:219], v[108:111], v[32:35], v[216:219]
    ds_read_b64_tr_b16 v[106:107], v56 offset:41984
    v_mfma_f32_16x16x32_bf16 v[220:223], v[108:111], v[36:39], v[220:223]
    ds_read_b64_tr_b16 v[108:109], v57 offset:40960
    s_waitcnt lgkmcnt(13)
    v_mfma_f32_16x16x32_bf16 v[224:227], v[112:115], v[32:35], v[224:227]
    ds_read_b64_tr_b16 v[110:111], v57 offset:41984
    v_mfma_f32_16x16x32_bf16 v[228:231], v[112:115], v[36:39], v[228:231]
    ds_read_b64_tr_b16 v[112:113], v58 offset:40960
    s_waitcnt lgkmcnt(13)
    v_mfma_f32_16x16x32_bf16 v[232:235], v[116:119], v[32:35], v[232:235]
    ds_read_b64_tr_b16 v[114:115], v58 offset:41984
    v_mfma_f32_16x16x32_bf16 v[236:239], v[116:119], v[36:39], v[236:239]
    ds_read_b64_tr_b16 v[116:117], v59 offset:40960
    s_waitcnt lgkmcnt(13)
    v_mfma_f32_16x16x32_bf16 v[240:243], v[120:123], v[32:35], v[240:243]
    ds_read_b64_tr_b16 v[118:119], v59 offset:41984
    v_mfma_f32_16x16x32_bf16 v[244:247], v[120:123], v[36:39], v[244:247]
    ds_read_b64_tr_b16 v[120:121], v60 offset:40960
    s_waitcnt lgkmcnt(13)
    v_mfma_f32_16x16x32_bf16 v[248:251], v[124:127], v[32:35], v[248:251]
    ds_read_b64_tr_b16 v[122:123], v60 offset:41984
    v_mfma_f32_16x16x32_bf16 v[252:255], v[124:127], v[36:39], v[252:255]
    ds_read_b64_tr_b16 v[124:125], v61 offset:40960
    ds_read_b64_tr_b16 v[126:127], v61 offset:41984
    s_waitcnt lgkmcnt(14)
    v_mfma_f32_16x16x32_bf16 v[192:195], v[96:99], v[64:67], v[192:195]
    v_mfma_f32_16x16x32_bf16 v[196:199], v[96:99], v[68:71], v[196:199]
    ds_read_b64_tr_b16 v[96:97], v54 offset:49152
    s_waitcnt lgkmcnt(13)
    v_mfma_f32_16x16x32_bf16 v[200:203], v[100:103], v[64:67], v[200:203]
    ds_read_b64_tr_b16 v[98:99], v54 offset:50176
    v_mfma_f32_16x16x32_bf16 v[204:207], v[100:103], v[68:71], v[204:207]
    ds_read_b64_tr_b16 v[100:101], v55 offset:49152
    s_waitcnt lgkmcnt(13)
    v_mfma_f32_16x16x32_bf16 v[208:211], v[104:107], v[64:67], v[208:211]
    ds_read_b64_tr_b16 v[102:103], v55 offset:50176
    v_mfma_f32_16x16x32_bf16 v[212:215], v[104:107], v[68:71], v[212:215]
    ds_read_b64_tr_b16 v[104:105], v56 offset:49152
    s_waitcnt lgkmcnt(13)
    v_mfma_f32_16x16x32_bf16 v[216:219], v[108:111], v[64:67], v[216:219]
    ds_read_b64_tr_b16 v[106:107], v56 offset:50176
    v_mfma_f32_16x16x32_bf16 v[220:223], v[108:111], v[68:71], v[220:223]
    ds_read_b64_tr_b16 v[108:109], v57 offset:49152
    s_waitcnt lgkmcnt(13)
    v_mfma_f32_16x16x32_bf16 v[224:227], v[112:115], v[64:67], v[224:227]
    ds_read_b64_tr_b16 v[110:111], v57 offset:50176
    v_mfma_f32_16x16x32_bf16 v[228:231], v[112:115], v[68:71], v[228:231]
    ds_read_b64_tr_b16 v[112:113], v58 offset:49152
    s_waitcnt lgkmcnt(13)
    v_mfma_f32_16x16x32_bf16 v[232:235], v[116:119], v[64:67], v[232:235]
    ds_read_b64_tr_b16 v[114:115], v58 offset:50176
    v_mfma_f32_16x16x32_bf16 v[236:239], v[116:119], v[68:71], v[236:239]
    ds_read_b64_tr_b16 v[116:117], v59 offset:49152
    s_waitcnt lgkmcnt(13)
    v_mfma_f32_16x16x32_bf16 v[240:243], v[120:123], v[64:67], v[240:243]
    ds_read_b64_tr_b16 v[118:119], v59 offset:50176
    v_mfma_f32_16x16x32_bf16 v[244:247], v[120:123], v[68:71], v[244:247]
    ds_read_b64_tr_b16 v[120:121], v60 offset:49152
    s_waitcnt lgkmcnt(13)
    v_mfma_f32_16x16x32_bf16 v[248:251], v[124:127], v[64:67], v[248:251]
    ds_read_b64_tr_b16 v[122:123], v60 offset:50176
    v_mfma_f32_16x16x32_bf16 v[252:255], v[124:127], v[68:71], v[252:255]
    ds_read_b64_tr_b16 v[124:125], v61 offset:49152
    ds_read_b64_tr_b16 v[126:127], v61 offset:50176
    s_waitcnt lgkmcnt(14)
    v_mfma_f32_16x16x32_bf16 v[192:195], v[96:99], v[72:75], v[192:195]
    v_mfma_f32_16x16x32_bf16 v[196:199], v[96:99], v[76:79], v[196:199]
    ds_read_b64_tr_b16 v[96:97], v54 offset:57344
    s_waitcnt lgkmcnt(13)
    v_mfma_f32_16x16x32_bf16 v[200:203], v[100:103], v[72:75], v[200:203]
    ds_read_b64_tr_b16 v[98:99], v54 offset:58368
    v_mfma_f32_16x16x32_bf16 v[204:207], v[100:103], v[76:79], v[204:207]
    ds_read_b64_tr_b16 v[100:101], v55 offset:57344
    s_waitcnt lgkmcnt(13)
    v_mfma_f32_16x16x32_bf16 v[208:211], v[104:107], v[72:75], v[208:211]
    ds_read_b64_tr_b16 v[102:103], v55 offset:58368
    v_mfma_f32_16x16x32_bf16 v[212:215], v[104:107], v[76:79], v[212:215]
    ds_read_b64_tr_b16 v[104:105], v56 offset:57344
    s_waitcnt lgkmcnt(13)
    v_mfma_f32_16x16x32_bf16 v[216:219], v[108:111], v[72:75], v[216:219]
    ds_read_b64_tr_b16 v[106:107], v56 offset:58368
    v_mfma_f32_16x16x32_bf16 v[220:223], v[108:111], v[76:79], v[220:223]
    ds_read_b64_tr_b16 v[108:109], v57 offset:57344
    s_waitcnt lgkmcnt(13)
    v_mfma_f32_16x16x32_bf16 v[224:227], v[112:115], v[72:75], v[224:227]
    ds_read_b64_tr_b16 v[110:111], v57 offset:58368
    v_mfma_f32_16x16x32_bf16 v[228:231], v[112:115], v[76:79], v[228:231]
    ds_read_b64_tr_b16 v[112:113], v58 offset:57344
    s_waitcnt lgkmcnt(13)
    v_mfma_f32_16x16x32_bf16 v[232:235], v[116:119], v[72:75], v[232:235]
    ds_read_b64_tr_b16 v[114:115], v58 offset:58368
    v_mfma_f32_16x16x32_bf16 v[236:239], v[116:119], v[76:79], v[236:239]
    ds_read_b64_tr_b16 v[116:117], v59 offset:57344
    s_waitcnt lgkmcnt(13)
    v_mfma_f32_16x16x32_bf16 v[240:243], v[120:123], v[72:75], v[240:243]
    ds_read_b64_tr_b16 v[118:119], v59 offset:58368
    v_mfma_f32_16x16x32_bf16 v[244:247], v[120:123], v[76:79], v[244:247]
    ds_read_b64_tr_b16 v[120:121], v60 offset:57344
    s_waitcnt lgkmcnt(13)
    v_mfma_f32_16x16x32_bf16 v[248:251], v[124:127], v[72:75], v[248:251]
    ds_read_b64_tr_b16 v[122:123], v60 offset:58368
    v_mfma_f32_16x16x32_bf16 v[252:255], v[124:127], v[76:79], v[252:255]
    ds_read_b64_tr_b16 v[124:125], v61 offset:57344
    ds_read_b64_tr_b16 v[126:127], v61 offset:58368
    s_waitcnt lgkmcnt(14)
    v_mfma_f32_16x16x32_bf16 v[192:195], v[96:99], v[80:83], v[192:195]
    v_mfma_f32_16x16x32_bf16 v[196:199], v[96:99], v[84:87], v[196:199]
    s_waitcnt lgkmcnt(12)
    v_mfma_f32_16x16x32_bf16 v[200:203], v[100:103], v[80:83], v[200:203]
    v_mfma_f32_16x16x32_bf16 v[204:207], v[100:103], v[84:87], v[204:207]
    s_waitcnt lgkmcnt(10)
    v_mfma_f32_16x16x32_bf16 v[208:211], v[104:107], v[80:83], v[208:211]
    v_mfma_f32_16x16x32_bf16 v[212:215], v[104:107], v[84:87], v[212:215]
    s_waitcnt lgkmcnt(8)
    v_mfma_f32_16x16x32_bf16 v[216:219], v[108:111], v[80:83], v[216:219]
    v_mfma_f32_16x16x32_bf16 v[220:223], v[108:111], v[84:87], v[220:223]
    s_waitcnt lgkmcnt(6)
    v_mfma_f32_16x16x32_bf16 v[224:227], v[112:115], v[80:83], v[224:227]
    v_mfma_f32_16x16x32_bf16 v[228:231], v[112:115], v[84:87], v[228:231]
    s_waitcnt lgkmcnt(4)
    v_mfma_f32_16x16x32_bf16 v[232:235], v[116:119], v[80:83], v[232:235]
    v_mfma_f32_16x16x32_bf16 v[236:239], v[116:119], v[84:87], v[236:239]
    s_waitcnt lgkmcnt(2)
    v_mfma_f32_16x16x32_bf16 v[240:243], v[120:123], v[80:83], v[240:243]
    v_mfma_f32_16x16x32_bf16 v[244:247], v[120:123], v[84:87], v[244:247]
    s_waitcnt lgkmcnt(0)
    v_mfma_f32_16x16x32_bf16 v[248:251], v[124:127], v[80:83], v[248:251]
    v_mfma_f32_16x16x32_bf16 v[252:255], v[124:127], v[84:87], v[252:255]
    s_branch L_q_end
L_q_late:
    s_or_b32 s89, s89, 2
    ds_read_b64_tr_b16 v[96:97], v54 offset:0
    ds_read_b64_tr_b16 v[98:99], v54 offset:1024
    ds_read_b64_tr_b16 v[100:101], v55 offset:0
    ds_read_b64_tr_b16 v[102:103], v55 offset:1024
    ds_read_b64_tr_b16 v[104:105], v56 offset:0
    ds_read_b64_tr_b16 v[106:107], v56 offset:1024
    ds_read_b64_tr_b16 v[108:109], v57 offset:0
    ds_read_b64_tr_b16 v[110:111], v57 offset:1024
    ds_read_b64_tr_b16 v[112:113], v58 offset:0
    ds_read_b64_tr_b16 v[114:115], v58 offset:1024
    ds_read_b64_tr_b16 v[116:117], v59 offset:0
    ds_read_b64_tr_b16 v[118:119], v59 offset:1024
    ds_read_b64_tr_b16 v[120:121], v60 offset:0
    ds_read_b64_tr_b16 v[122:123], v60 offset:1024
    ds_read_b64_tr_b16 v[124:125], v61 offset:0
    ds_read_b64_tr_b16 v[126:127], v61 offset:1024
    buffer_load_dwordx4 v[64:67], v13, s[8:11], s84 offen offset:3072 sc1
    buffer_load_dwordx4 v[68:71], v12, s[8:11], s84 offen offset:3072 sc1
    buffer_load_dwordx4 v[72:75], v13, s[8:11], s85 offen offset:0 sc1
    buffer_load_dwordx4 v[76:79], v12, s[8:11], s85 offen offset:0 sc1
    buffer_load_dwordx4 v[80:83], v13, s[8:11], s85 offen offset:1024 sc1
    buffer_load_dwordx4 v[84:87], v12, s[8:11], s85 offen offset:1024 sc1
    buffer_load_dwordx4 v[88:91], v13, s[8:11], s85 offen offset:2048 sc1
    buffer_load_dwordx4 v[92:95], v12, s[8:11], s85 offen offset:2048 sc1
    s_waitcnt lgkmcnt(14)
    v_mfma_f32_16x16x32_bf16 v[192:195], v[96:99], v[16:19], 0
    v_mfma_f32_16x16x32_bf16 v[196:199], v[96:99], v[20:23], 0
    ds_read_b64_tr_b16 v[96:97], v54 offset:8192
    s_waitcnt lgkmcnt(13)
    v_mfma_f32_16x16x32_bf16 v[200:203], v[100:103], v[16:19], 0
    ds_read_b64_tr_b16 v[98:99], v54 offset:9216
    v_mfma_f32_16x16x32_bf16 v[204:207], v[100:103], v[20:23], 0
    ds_read_b64_tr_b16 v[100:101], v55 offset:8192
    s_waitcnt lgkmcnt(13)
    v_mfma_f32_16x16x32_bf16 v[208:211], v[104:107], v[16:19], 0
    ds_read_b64_tr_b16 v[102:103], v55 offset:9216
    v_mfma_f32_16x16x32_bf16 v[212:215], v[104:107], v[20:23], 0
    ds_read_b64_tr_b16 v[104:105], v56 offset:8192
    s_waitcnt lgkmcnt(13)
    v_mfma_f32_16x16x32_bf16 v[216:219], v[108:111], v[16:19], 0
    ds_read_b64_tr_b16 v[106:107], v56 offset:9216
    v_mfma_f32_16x16x32_bf16 v[220:223], v[108:111], v[20:23], 0
    ds_read_b64_tr_b16 v[108:109], v57 offset:8192
    s_waitcnt lgkmcnt(13)
    v_mfma_f32_16x16x32_bf16 v[224:227], v[112:115], v[16:19], 0
    ds_read_b64_tr_b16 v[110:111], v57 offset:9216
    v_mfma_f32_16x16x32_bf16 v[228:231], v[112:115], v[20:23], 0
    ds_read_b64_tr_b16 v[112:113], v58 offset:8192
    s_waitcnt lgkmcnt(13)
    v_mfma_f32_16x16x32_bf16 v[232:235], v[116:119], v[16:19], 0
    ds_read_b64_tr_b16 v[114:115], v58 offset:9216
    v_mfma_f32_16x16x32_bf16 v[236:239], v[116:119], v[20:23], 0
    ds_read_b64_tr_b16 v[116:117], v59 offset:8192
    s_waitcnt lgkmcnt(13)
    v_mfma_f32_16x16x32_bf16 v[240:243], v[120:123], v[16:19], 0
    ds_read_b64_tr_b16 v[118:119], v59 offset:9216
    v_mfma_f32_16x16x32_bf16 v[244:247], v[120:123], v[20:23], 0
    ds_read_b64_tr_b16 v[120:121], v60 offset:8192
    s_waitcnt lgkmcnt(13)
    v_mfma_f32_16x16x32_bf16 v[248:251], v[124:127], v[16:19], 0
    ds_read_b64_tr_b16 v[122:123], v60 offset:9216
    v_mfma_f32_16x16x32_bf16 v[252:255], v[124:127], v[20:23], 0
    ds_read_b64_tr_b16 v[124:125], v61 offset:8192
    ds_read_b64_tr_b16 v[126:127], v61 offset:9216
    buffer_load_dwordx4 v[16:19], v13, s[8:11], s85 offen offset:3072 sc1
    buffer_load_dwordx4 v[20:23], v12, s[8:11], s85 offen offset:3072 sc1
    s_waitcnt lgkmcnt(14)
    v_mfma_f32_16x16x32_bf16 v[192:195], v[96:99], v[24:27], v[192:195]
    v_mfma_f32_16x16x32_bf16 v[196:199], v[96:99], v[28:31], v[196:199]
    ds_read_b64_tr_b16 v[96:97], v54 offset:16384
    s_waitcnt lgkmcnt(13)
    v_mfma_f32_16x16x32_bf16 v[200:203], v[100:103], v[24:27], v[200:203]
    ds_read_b64_tr_b16 v[98:99], v54 offset:17408
    v_mfma_f32_16x16x32_bf16 v[204:207], v[100:103], v[28:31], v[204:207]
    ds_read_b64_tr_b16 v[100:101], v55 offset:16384
    s_waitcnt lgkmcnt(13)
    v_mfma_f32_16x16x32_bf16 v[208:211], v[104:107], v[24:27], v[208:211]
    ds_read_b64_tr_b16 v[102:103], v55 offset:17408
    v_mfma_f32_16x16x32_bf16 v[212:215], v[104:107], v[28:31], v[212:215]
    ds_read_b64_tr_b16 v[104:105], v56 offset:16384
    s_waitcnt lgkmcnt(13)
    v_mfma_f32_16x16x32_bf16 v[216:219], v[108:111], v[24:27], v[216:219]
    ds_read_b64_tr_b16 v[106:107], v56 offset:17408
    v_mfma_f32_16x16x32_bf16 v[220:223], v[108:111], v[28:31], v[220:223]
    ds_read_b64_tr_b16 v[108:109], v57 offset:16384
    s_waitcnt lgkmcnt(13)
    v_mfma_f32_16x16x32_bf16 v[224:227], v[112:115], v[24:27], v[224:227]
    ds_read_b64_tr_b16 v[110:111], v57 offset:17408
    v_mfma_f32_16x16x32_bf16 v[228:231], v[112:115], v[28:31], v[228:231]
    ds_read_b64_tr_b16 v[112:113], v58 offset:16384
    s_waitcnt lgkmcnt(13)
    v_mfma_f32_16x16x32_bf16 v[232:235], v[116:119], v[24:27], v[232:235]
    ds_read_b64_tr_b16 v[114:115], v58 offset:17408
    v_mfma_f32_16x16x32_bf16 v[236:239], v[116:119], v[28:31], v[236:239]
    ds_read_b64_tr_b16 v[116:117], v59 offset:16384
    s_waitcnt lgkmcnt(13)
    v_mfma_f32_16x16x32_bf16 v[240:243], v[120:123], v[24:27], v[240:243]
    ds_read_b64_tr_b16 v[118:119], v59 offset:17408
    v_mfma_f32_16x16x32_bf16 v[244:247], v[120:123], v[28:31], v[244:247]
    ds_read_b64_tr_b16 v[120:121], v60 offset:16384
    s_waitcnt lgkmcnt(13)
    v_mfma_f32_16x16x32_bf16 v[248:251], v[124:127], v[24:27], v[248:251]
    ds_read_b64_tr_b16 v[122:123], v60 offset:17408
    v_mfma_f32_16x16x32_bf16 v[252:255], v[124:127], v[28:31], v[252:255]
    ds_read_b64_tr_b16 v[124:125], v61 offset:16384
    ds_read_b64_tr_b16 v[126:127], v61 offset:17408
    buffer_load_dwordx4 v[24:27], v13, s[8:11], s86 offen offset:0 sc1
    buffer_load_dwordx4 v[28:31], v12, s[8:11], s86 offen offset:0 sc1
    s_waitcnt lgkmcnt(14)
    v_mfma_f32_16x16x32_bf16 v[192:195], v[96:99], v[32:35], v[192:195]
    v_mfma_f32_16x16x32_bf16 v[196:199], v[96:99], v[36:39], v[196:199]
    ds_read_b64_tr_b16 v[96:97], v54 offset:24576
    s_waitcnt lgkmcnt(13)
    v_mfma_f32_16x16x32_bf16 v[200:203], v[100:103], v[32:35], v[200:203]
    ds_read_b64_tr_b16 v[98:99], v54 offset:25600
    v_mfma_f32_16x16x32_bf16 v[204:207], v[100:103], v[36:39], v[204:207]
    ds_read_b64_tr_b16 v[100:101], v55 offset:24576
    s_waitcnt lgkmcnt(13)
    v_mfma_f32_16x16x32_bf16 v[208:211], v[104:107], v[32:35], v[208:211]
    ds_read_b64_tr_b16 v[102:103], v55 offset:25600
    v_mfma_f32_16x16x32_bf16 v[212:215], v[104:107], v[36:39], v[212:215]
    ds_read_b64_tr_b16 v[104:105], v56 offset:24576
    s_waitcnt lgkmcnt(13)
    v_mfma_f32_16x16x32_bf16 v[216:219], v[108:111], v[32:35], v[216:219]
    ds_read_b64_tr_b16 v[106:107], v56 offset:25600
    v_mfma_f32_16x16x32_bf16 v[220:223], v[108:111], v[36:39], v[220:223]
    ds_read_b64_tr_b16 v[108:109], v57 offset:24576
    s_waitcnt lgkmcnt(13)
    v_mfma_f32_16x16x32_bf16 v[224:227], v[112:115], v[32:35], v[224:227]
    ds_read_b64_tr_b16 v[110:111], v57 offset:25600
    v_mfma_f32_16x16x32_bf16 v[228:231], v[112:115], v[36:39], v[228:231]
    ds_read_b64_tr_b16 v[112:113], v58 offset:24576
    s_waitcnt lgkmcnt(13)
    v_mfma_f32_16x16x32_bf16 v[232:235], v[116:119], v[32:35], v[232:235]
    ds_read_b64_tr_b16 v[114:115], v58 offset:25600
    v_mfma_f32_16x16x32_bf16 v[236:239], v[116:119], v[36:39], v[236:239]
    ds_read_b64_tr_b16 v[116:117], v59 offset:24576
    s_waitcnt lgkmcnt(13)
    v_mfma_f32_16x16x32_bf16 v[240:243], v[120:123], v[32:35], v[240:243]
    ds_read_b64_tr_b16 v[118:119], v59 offset:25600
    v_mfma_f32_16x16x32_bf16 v[244:247], v[120:123], v[36:39], v[244:247]
    ds_read_b64_tr_b16 v[120:121], v60 offset:24576
    s_waitcnt lgkmcnt(13)
    v_mfma_f32_16x16x32_bf16 v[248:251], v[124:127], v[32:35], v[248:251]
    ds_read_b64_tr_b16 v[122:123], v60 offset:25600
    v_mfma_f32_16x16x32_bf16 v[252:255], v[124:127], v[36:39], v[252:255]
    ds_read_b64_tr_b16 v[124:125], v61 offset:24576
    ds_read_b64_tr_b16 v[126:127], v61 offset:25600
    buffer_load_dwordx4 v[32:35], v13, s[8:11], s86 offen offset:1024 sc1
    buffer_load_dwordx4 v[36:39], v12, s[8:11], s86 offen offset:1024 sc1
    s_waitcnt vmcnt(12)
    s_waitcnt lgkmcnt(14)
    v_mfma_f32_16x16x32_bf16 v[192:195], v[96:99], v[64:67], v[192:195]
    v_add_u32 v54, 0xfffe0000, v54
    v_mfma_f32_16x16x32_bf16 v[196:199], v[96:99], v[68:71], v[196:199]
    ds_read_b64_tr_b16 v[96:97], v54 offset:0
    s_waitcnt lgkmcnt(13)
    v_mfma_f32_16x16x32_bf16 v[200:203], v[100:103], v[64:67], v[200:203]
    ds_read_b64_tr_b16 v[98:99], v54 offset:1024
    v_add_u32 v55, 0xfffe0000, v55
    v_mfma_f32_16x16x32_bf16 v[204:207], v[100:103], v[68:71], v[204:207]
    ds_read_b64_tr_b16 v[100:101], v55 offset:0
    s_waitcnt lgkmcnt(13)
    v_mfma_f32_16x16x32_bf16 v[208:211], v[104:107], v[64:67], v[208:211]
    ds_read_b64_tr_b16 v[102:103], v55 offset:1024
    v_add_u32 v56, 0xfffe0000, v56
    v_mfma_f32_16x16x32_bf16 v[212:215], v[104:107], v[68:71], v[212:215]
    ds_read_b64_tr_b16 v[104:105], v56 offset:0
    s_waitcnt lgkmcnt(13)
    v_mfma_f32_16x16x32_bf16 v[216:219], v[108:111], v[64:67], v[216:219]
    ds_read_b64_tr_b16 v[106:107], v56 offset:1024
    v_add_u32 v57, 0xfffe0000, v57
    v_mfma_f32_16x16x32_bf16 v[220:223], v[108:111], v[68:71], v[220:223]
    ds_read_b64_tr_b16 v[108:109], v57 offset:0
    s_waitcnt lgkmcnt(13)
    v_mfma_f32_16x16x32_bf16 v[224:227], v[112:115], v[64:67], v[224:227]
    ds_read_b64_tr_b16 v[110:111], v57 offset:1024
    v_add_u32 v58, 0xfffe0000, v58
    v_mfma_f32_16x16x32_bf16 v[228:231], v[112:115], v[68:71], v[228:231]
    ds_read_b64_tr_b16 v[112:113], v58 offset:0
    s_waitcnt lgkmcnt(13)
    v_mfma_f32_16x16x32_bf16 v[232:235], v[116:119], v[64:67], v[232:235]
    ds_read_b64_tr_b16 v[114:115], v58 offset:1024
    v_add_u32 v59, 0xfffe0000, v59
    v_mfma_f32_16x16x32_bf16 v[236:239], v[116:119], v[68:71], v[236:239]
    ds_read_b64_tr_b16 v[116:117], v59 offset:0
    s_waitcnt lgkmcnt(13)
    v_mfma_f32_16x16x32_bf16 v[240:243], v[120:123], v[64:67], v[240:243]
    ds_read_b64_tr_b16 v[118:119], v59 offset:1024
    v_add_u32 v60, 0xfffe0000, v60
    v_mfma_f32_16x16x32_bf16 v[244:247], v[120:123], v[68:71], v[244:247]
    ds_read_b64_tr_b16 v[120:121], v60 offset:0
    s_waitcnt lgkmcnt(13)
    v_mfma_f32_16x16x32_bf16 v[248:251], v[124:127], v[64:67], v[248:251]
    ds_read_b64_tr_b16 v[122:123], v60 offset:1024
    v_add_u32 v61, 0xfffe0000, v61
    v_mfma_f32_16x16x32_bf16 v[252:255], v[124:127], v[68:71], v[252:255]
    ds_read_b64_tr_b16 v[124:125], v61 offset:0
    ds_read_b64_tr_b16 v[126:127], v61 offset:1024
    buffer_load_dwordx4 v[64:67], v13, s[8:11], s86 offen offset:2048 sc1
    buffer_load_dwordx4 v[68:71], v12, s[8:11], s86 offen offset:2048 sc1
    s_waitcnt vmcnt(12)
    s_waitcnt lgkmcnt(14)
    v_mfma_f32_16x16x32_bf16 v[192:195], v[96:99], v[72:75], v[192:195]
    v_mfma_f32_16x16x32_bf16 v[196:199], v[96:99], v[76:79], v[196:199]
    ds_read_b64_tr_b16 v[96:97], v54 offset:8192
    s_waitcnt lgkmcnt(13)
    v_mfma_f32_16x16x32_bf16 v[200:203], v[100:103], v[72:75], v[200:203]
    ds_read_b64_tr_b16 v[98:99], v54 offset:9216
    v_mfma_f32_16x16x32_bf16 v[204:207], v[100:103], v[76:79], v[204:207]
    ds_read_b64_tr_b16 v[100:101], v55 offset:8192
    s_waitcnt lgkmcnt(13)
    v_mfma_f32_16x16x32_bf16 v[208:211], v[104:107], v[72:75], v[208:211]
    ds_read_b64_tr_b16 v[102:103], v55 offset:9216
    v_mfma_f32_16x16x32_bf16 v[212:215], v[104:107], v[76:79], v[212:215]
    ds_read_b64_tr_b16 v[104:105], v56 offset:8192
    s_waitcnt lgkmcnt(13)
    v_mfma_f32_16x16x32_bf16 v[216:219], v[108:111], v[72:75], v[216:219]
    ds_read_b64_tr_b16 v[106:107], v56 offset:9216
    v_mfma_f32_16x16x32_bf16 v[220:223], v[108:111], v[76:79], v[220:223]
    ds_read_b64_tr_b16 v[108:109], v57 offset:8192
    s_waitcnt lgkmcnt(13)
    v_mfma_f32_16x16x32_bf16 v[224:227], v[112:115], v[72:75], v[224:227]
    ds_read_b64_tr_b16 v[110:111], v57 offset:9216
    v_mfma_f32_16x16x32_bf16 v[228:231], v[112:115], v[76:79], v[228:231]
    ds_read_b64_tr_b16 v[112:113], v58 offset:8192
    s_waitcnt lgkmcnt(13)
    v_mfma_f32_16x16x32_bf16 v[232:235], v[116:119], v[72:75], v[232:235]
    ds_read_b64_tr_b16 v[114:115], v58 offset:9216
    v_mfma_f32_16x16x32_bf16 v[236:239], v[116:119], v[76:79], v[236:239]
    ds_read_b64_tr_b16 v[116:117], v59 offset:8192
    s_waitcnt lgkmcnt(13)
    v_mfma_f32_16x16x32_bf16 v[240:243], v[120:123], v[72:75], v[240:243]
    ds_read_b64_tr_b16 v[118:119], v59 offset:9216
    v_mfma_f32_16x16x32_bf16 v[244:247], v[120:123], v[76:79], v[244:247]
    ds_read_b64_tr_b16 v[120:121], v60 offset:8192
    s_waitcnt lgkmcnt(13)
    v_mfma_f32_16x16x32_bf16 v[248:251], v[124:127], v[72:75], v[248:251]
    ds_read_b64_tr_b16 v[122:123], v60 offset:9216
    v_mfma_f32_16x16x32_bf16 v[252:255], v[124:127], v[76:79], v[252:255]
    ds_read_b64_tr_b16 v[124:125], v61 offset:8192
    ds_read_b64_tr_b16 v[126:127], v61 offset:9216
    buffer_load_dwordx4 v[72:75], v13, s[8:11], s86 offen offset:3072 sc1
    buffer_load_dwordx4 v[76:79], v12, s[8:11], s86 offen offset:3072 sc1
    s_waitcnt vmcnt(12)
    s_waitcnt lgkmcnt(14)
    v_mfma_f32_16x16x32_bf16 v[192:195], v[96:99], v[80:83], v[192:195]
    v_mfma_f32_16x16x32_bf16 v[196:199], v[96:99], v[84:87], v[196:199]
    ds_read_b64_tr_b16 v[96:97], v54 offset:16384
    s_waitcnt lgkmcnt(13)
    v_mfma_f32_16x16x32_bf16 v[200:203], v[100:103], v[80:83], v[200:203]
    ds_read_b64_tr_b16 v[98:99], v54 offset:17408
    v_mfma_f32_16x16x32_bf16 v[204:207], v[100:103], v[84:87], v[204:207]
    ds_read_b64_tr_b16 v[100:101], v55 offset:16384
    s_waitcnt lgkmcnt(13)
    v_mfma_f32_16x16x32_bf16 v[208:211], v[104:107], v[80:83], v[208:211]
    ds_read_b64_tr_b16 v[102:103], v55 offset:17408
    v_mfma_f32_16x16x32_bf16 v[212:215], v[104:107], v[84:87], v[212:215]
    ds_read_b64_tr_b16 v[104:105], v56 offset:16384
    s_waitcnt lgkmcnt(13)
    v_mfma_f32_16x16x32_bf16 v[216:219], v[108:111], v[80:83], v[216:219]
    ds_read_b64_tr_b16 v[106:107], v56 offset:17408
    v_mfma_f32_16x16x32_bf16 v[220:223], v[108:111], v[84:87], v[220:223]
    ds_read_b64_tr_b16 v[108:109], v57 offset:16384
    s_waitcnt lgkmcnt(13)
    v_mfma_f32_16x16x32_bf16 v[224:227], v[112:115], v[80:83], v[224:227]
    ds_read_b64_tr_b16 v[110:111], v57 offset:17408
    v_mfma_f32_16x16x32_bf16 v[228:231], v[112:115], v[84:87], v[228:231]
    ds_read_b64_tr_b16 v[112:113], v58 offset:16384
    s_waitcnt lgkmcnt(13)
    v_mfma_f32_16x16x32_bf16 v[232:235], v[116:119], v[80:83], v[232:235]
    ds_read_b64_tr_b16 v[114:115], v58 offset:17408
    v_mfma_f32_16x16x32_bf16 v[236:239], v[116:119], v[84:87], v[236:239]
    ds_read_b64_tr_b16 v[116:117], v59 offset:16384
    s_waitcnt lgkmcnt(13)
    v_mfma_f32_16x16x32_bf16 v[240:243], v[120:123], v[80:83], v[240:243]
    ds_read_b64_tr_b16 v[118:119], v59 offset:17408
    v_mfma_f32_16x16x32_bf16 v[244:247], v[120:123], v[84:87], v[244:247]
    ds_read_b64_tr_b16 v[120:121], v60 offset:16384
    s_waitcnt lgkmcnt(13)
    v_mfma_f32_16x16x32_bf16 v[248:251], v[124:127], v[80:83], v[248:251]
    ds_read_b64_tr_b16 v[122:123], v60 offset:17408
    v_mfma_f32_16x16x32_bf16 v[252:255], v[124:127], v[84:87], v[252:255]
    ds_read_b64_tr_b16 v[124:125], v61 offset:16384
    ds_read_b64_tr_b16 v[126:127], v61 offset:17408
    buffer_load_dwordx4 v[80:83], v13, s[8:11], s87 offen offset:0 sc1
    buffer_load_dwordx4 v[84:87], v12, s[8:11], s87 offen offset:0 sc1
    s_waitcnt vmcnt(12)
    s_waitcnt lgkmcnt(14)
    v_mfma_f32_16x16x32_bf16 v[192:195], v[96:99], v[88:91], v[192:195]
    v_mfma_f32_16x16x32_bf16 v[196:199], v[96:99], v[92:95], v[196:199]
    ds_read_b64_tr_b16 v[96:97], v54 offset:24576
    s_waitcnt lgkmcnt(13)
    v_mfma_f32_16x16x32_bf16 v[200:203], v[100:103], v[88:91], v[200:203]
    ds_read_b64_tr_b16 v[98:99], v54 offset:25600
    v_mfma_f32_16x16x32_bf16 v[204:207], v[100:103], v[92:95], v[204:207]
    ds_read_b64_tr_b16 v[100:101], v55 offset:24576
    s_waitcnt lgkmcnt(13)
    v_mfma_f32_16x16x32_bf16 v[208:211], v[104:107], v[88:91], v[208:211]
    ds_read_b64_tr_b16 v[102:103], v55 offset:25600
    v_mfma_f32_16x16x32_bf16 v[212:215], v[104:107], v[92:95], v[212:215]
    ds_read_b64_tr_b16 v[104:105], v56 offset:24576
    s_waitcnt lgkmcnt(13)
    v_mfma_f32_16x16x32_bf16 v[216:219], v[108:111], v[88:91], v[216:219]
    ds_read_b64_tr_b16 v[106:107], v56 offset:25600
    buffer_store_dwordx4 v[128:131], v13, s[8:11], s67 offen sc1
    s_add_u32 s67, s67, 1024
    v_mfma_f32_16x16x32_bf16 v[220:223], v[108:111], v[92:95], v[220:223]
    ds_read_b64_tr_b16 v[108:109], v57 offset:24576
    s_waitcnt lgkmcnt(13)
    v_mfma_f32_16x16x32_bf16 v[224:227], v[112:115], v[88:91], v[224:227]
    ds_read_b64_tr_b16 v[110:111], v57 offset:25600
    v_mfma_f32_16x16x32_bf16 v[228:231], v[112:115], v[92:95], v[228:231]
    ds_read_b64_tr_b16 v[112:113], v58 offset:24576
    s_waitcnt lgkmcnt(13)
    v_mfma_f32_16x16x32_bf16 v[232:235], v[116:119], v[88:91], v[232:235]
    ds_read_b64_tr_b16 v[114:115], v58 offset:25600
    v_mfma_f32_16x16x32_bf16 v[236:239], v[116:119], v[92:95], v[236:239]
    ds_read_b64_tr_b16 v[116:117], v59 offset:24576
    s_waitcnt lgkmcnt(13)
    v_mfma_f32_16x16x32_bf16 v[240:243], v[120:123], v[88:91], v[240:243]
    ds_read_b64_tr_b16 v[118:119], v59 offset:25600
    v_mfma_f32_16x16x32_bf16 v[244:247], v[120:123], v[92:95], v[244:247]
    ds_read_b64_tr_b16 v[120:121], v60 offset:24576
    s_waitcnt lgkmcnt(13)
    v_mfma_f32_16x16x32_bf16 v[248:251], v[124:127], v[88:91], v[248:251]
    ds_read_b64_tr_b16 v[122:123], v60 offset:25600
    v_mfma_f32_16x16x32_bf16 v[252:255], v[124:127], v[92:95], v[252:255]
    ds_read_b64_tr_b16 v[124:125], v61 offset:24576
    ds_read_b64_tr_b16 v[126:127], v61 offset:25600
    buffer_load_dwordx4 v[88:91], v13, s[8:11], s87 offen offset:1024 sc1
    buffer_load_dwordx4 v[92:95], v12, s[8:11], s87 offen offset:1024 sc1
    s_waitcnt vmcnt(13)
    s_waitcnt lgkmcnt(14)
    v_mfma_f32_16x16x32_bf16 v[192:195], v[96:99], v[16:19], v[192:195]
    v_mfma_f32_16x16x32_bf16 v[196:199], v[96:99], v[20:23], v[196:199]
    ds_read_b64_tr_b16 v[96:97], v54 offset:32768
    s_waitcnt lgkmcnt(13)
    v_mfma_f32_16x16x32_bf16 v[200:203], v[100:103], v[16:19], v[200:203]
    ds_read_b64_tr_b16 v[98:99], v54 offset:33792
    v_mfma_f32_16x16x32_bf16 v[204:207], v[100:103], v[20:23], v[204:207]
    ds_read_b64_tr_b16 v[100:101], v55 offset:32768
    s_waitcnt lgkmcnt(13)
    v_mfma_f32_16x16x32_bf16 v[208:211], v[104:107], v[16:19], v[208:211]
    ds_read_b64_tr_b16 v[102:103], v55 offset:33792
    v_mfma_f32_16x16x32_bf16 v[212:215], v[104:107], v[20:23], v[212:215]
    ds_read_b64_tr_b16 v[104:105], v56 offset:32768
    s_waitcnt lgkmcnt(13)
    v_mfma_f32_16x16x32_bf16 v[216:219], v[108:111], v[16:19], v[216:219]
    ds_read_b64_tr_b16 v[106:107], v56 offset:33792
    v_mfma_f32_16x16x32_bf16 v[220:223], v[108:111], v[20:23], v[220:223]
    ds_read_b64_tr_b16 v[108:109], v57 offset:32768
    s_waitcnt lgkmcnt(13)
    v_mfma_f32_16x16x32_bf16 v[224:227], v[112:115], v[16:19], v[224:227]
    ds_read_b64_tr_b16 v[110:111], v57 offset:33792
    v_mfma_f32_16x16x32_bf16 v[228:231], v[112:115], v[20:23], v[228:231]
    ds_read_b64_tr_b16 v[112:113], v58 offset:32768
    s_waitcnt lgkmcnt(13)
    v_mfma_f32_16x16x32_bf16 v[232:235], v[116:119], v[16:19], v[232:235]
    ds_read_b64_tr_b16 v[114:115], v58 offset:33792
    v_mfma_f32_16x16x32_bf16 v[236:239], v[116:119], v[20:23], v[236:239]
    ds_read_b64_tr_b16 v[116:117], v59 offset:32768
    s_waitcnt lgkmcnt(13)
    v_mfma_f32_16x16x32_bf16 v[240:243], v[120:123], v[16:19], v[240:243]
    ds_read_b64_tr_b16 v[118:119], v59 offset:33792
    v_mfma_f32_16x16x32_bf16 v[244:247], v[120:123], v[20:23], v[244:247]
    ds_read_b64_tr_b16 v[120:121], v60 offset:32768
    s_waitcnt lgkmcnt(13)
    v_mfma_f32_16x16x32_bf16 v[248:251], v[124:127], v[16:19], v[248:251]
    ds_read_b64_tr_b16 v[122:123], v60 offset:33792
    v_mfma_f32_16x16x32_bf16 v[252:255], v[124:127], v[20:23], v[252:255]
    ds_read_b64_tr_b16 v[124:125], v61 offset:32768
    ds_read_b64_tr_b16 v[126:127], v61 offset:33792
    buffer_load_dwordx4 v[16:19], v13, s[8:11], s87 offen offset:2048 sc1
    buffer_load_dwordx4 v[20:23], v12, s[8:11], s87 offen offset:2048 sc1
    s_waitcnt vmcnt(13)
    s_waitcnt lgkmcnt(14)
    v_mfma_f32_16x16x32_bf16 v[192:195], v[96:99], v[24:27], v[192:195]
    v_mfma_f32_16x16x32_bf16 v[196:199], v[96:99], v[28:31], v[196:199]
    ds_read_b64_tr_b16 v[96:97], v54 offset:40960
    s_waitcnt lgkmcnt(13)
    v_mfma_f32_16x16x32_bf16 v[200:203], v[100:103], v[24:27], v[200:203]
    ds_read_b64_tr_b16 v[98:99], v54 offset:41984
    v_mfma_f32_16x16x32_bf16 v[204:207], v[100:103], v[28:31], v[204:207]
    ds_read_b64_tr_b16 v[100:101], v55 offset:40960
    s_waitcnt lgkmcnt(13)
    v_mfma_f32_16x16x32_bf16 v[208:211], v[104:107], v[24:27], v[208:211]
    ds_read_b64_tr_b16 v[102:103], v55 offset:41984
    v_mfma_f32_16x16x32_bf16 v[212:215], v[104:107], v[28:31], v[212:215]
    ds_read_b64_tr_b16 v[104:105], v56 offset:40960
    s_waitcnt lgkmcnt(13)
    v_mfma_f32_16x16x32_bf16 v[216:219], v[108:111], v[24:27], v[216:219]
    ds_read_b64_tr_b16 v[106:107], v56 offset:41984
    buffer_store_dwordx4 v[132:135], v13, s[8:11], s67 offen sc1
    s_add_u32 s67, s67, s68
    v_mfma_f32_16x16x32_bf16 v[220:223], v[108:111], v[28:31], v[220:223]
    ds_read_b64_tr_b16 v[108:109], v57 offset:40960
    s_waitcnt lgkmcnt(13)
    v_mfma_f32_16x16x32_bf16 v[224:227], v[112:115], v[24:27], v[224:227]
    ds_read_b64_tr_b16 v[110:111], v57 offset:41984
    v_mfma_f32_16x16x32_bf16 v[228:231], v[112:115], v[28:31], v[228:231]
    ds_read_b64_tr_b16 v[112:113], v58 offset:40960
    s_waitcnt lgkmcnt(13)
    v_mfma_f32_16x16x32_bf16 v[232:235], v[116:119], v[24:27], v[232:235]
    ds_read_b64_tr_b16 v[114:115], v58 offset:41984
    v_mfma_f32_16x16x32_bf16 v[236:239], v[116:119], v[28:31], v[236:239]
    ds_read_b64_tr_b16 v[116:117], v59 offset:40960
    s_waitcnt lgkmcnt(13)
    v_mfma_f32_16x16x32_bf16 v[240:243], v[120:123], v[24:27], v[240:243]
    ds_read_b64_tr_b16 v[118:119], v59 offset:41984
    v_mfma_f32_16x16x32_bf16 v[244:247], v[120:123], v[28:31], v[244:247]
    ds_read_b64_tr_b16 v[120:121], v60 offset:40960
    s_waitcnt lgkmcnt(13)
    v_mfma_f32_16x16x32_bf16 v[248:251], v[124:127], v[24:27], v[248:251]
    ds_read_b64_tr_b16 v[122:123], v60 offset:41984
    v_mfma_f32_16x16x32_bf16 v[252:255], v[124:127], v[28:31], v[252:255]
    ds_read_b64_tr_b16 v[124:125], v61 offset:40960
    ds_read_b64_tr_b16 v[126:127], v61 offset:41984
    buffer_load_dwordx4 v[24:27], v13, s[8:11], s87 offen offset:3072 sc1
    buffer_load_dwordx4 v[28:31], v12, s[8:11], s87 offen offset:3072 sc1
    s_waitcnt vmcnt(14)
    s_waitcnt lgkmcnt(14)
    v_mfma_f32_16x16x32_bf16 v[192:195], v[96:99], v[32:35], v[192:195]
    v_mfma_f32_16x16x32_bf16 v[196:199], v[96:99], v[36:39], v[196:199]
    ds_read_b64_tr_b16 v[96:97], v54 offset:49152
    s_waitcnt lgkmcnt(13)
    v_mfma_f32_16x16x32_bf16 v[200:203], v[100:103], v[32:35], v[200:203]
    ds_read_b64_tr_b16 v[98:99], v54 offset:50176
    v_mfma_f32_16x16x32_bf16 v[204:207], v[100:103], v[36:39], v[204:207]
    ds_read_b64_tr_b16 v[100:101], v55 offset:49152
    s_waitcnt lgkmcnt(13)
    v_mfma_f32_16x16x32_bf16 v[208:211], v[104:107], v[32:35], v[208:211]
    ds_read_b64_tr_b16 v[102:103], v55 offset:50176
    v_mfma_f32_16x16x32_bf16 v[212:215], v[104:107], v[36:39], v[212:215]
    ds_read_b64_tr_b16 v[104:105], v56 offset:49152
    s_waitcnt lgkmcnt(13)
    v_mfma_f32_16x16x32_bf16 v[216:219], v[108:111], v[32:35], v[216:219]
    ds_read_b64_tr_b16 v[106:107], v56 offset:50176
    v_mfma_f32_16x16x32_bf16 v[220:223], v[108:111], v[36:39], v[220:223]
    ds_read_b64_tr_b16 v[108:109], v57 offset:49152
    s_waitcnt lgkmcnt(13)
    v_mfma_f32_16x16x32_bf16 v[224:227], v[112:115], v[32:35], v[224:227]
    ds_read_b64_tr_b16 v[110:111], v57 offset:50176
    v_mfma_f32_16x16x32_bf16 v[228:231], v[112:115], v[36:39], v[228:231]
    ds_read_b64_tr_b16 v[112:113], v58 offset:49152
    s_waitcnt lgkmcnt(13)
    v_mfma_f32_16x16x32_bf16 v[232:235], v[116:119], v[32:35], v[232:235]
    ds_read_b64_tr_b16 v[114:115], v58 offset:50176
    v_mfma_f32_16x16x32_bf16 v[236:239], v[116:119], v[36:39], v[236:239]
    ds_read_b64_tr_b16 v[116:117], v59 offset:49152
    s_waitcnt lgkmcnt(13)
    v_mfma_f32_16x16x32_bf16 v[240:243], v[120:123], v[32:35], v[240:243]
    ds_read_b64_tr_b16 v[118:119], v59 offset:50176
    v_mfma_f32_16x16x32_bf16 v[244:247], v[120:123], v[36:39], v[244:247]
    ds_read_b64_tr_b16 v[120:121], v60 offset:49152
    s_waitcnt lgkmcnt(13)
    v_mfma_f32_16x16x32_bf16 v[248:251], v[124:127], v[32:35], v[248:251]
    ds_read_b64_tr_b16 v[122:123], v60 offset:50176
    v_mfma_f32_16x16x32_bf16 v[252:255], v[124:127], v[36:39], v[252:255]
    ds_read_b64_tr_b16 v[124:125], v61 offset:49152
    ds_read_b64_tr_b16 v[126:127], v61 offset:50176
    buffer_load_dwordx4 v[32:35], v13, s[8:11], s88 offen offset:0 sc1
    buffer_load_dwordx4 v[36:39], v12, s[8:11], s88 offen offset:0 sc1
    s_waitcnt vmcnt(14)
    s_waitcnt lgkmcnt(14)
    v_mfma_f32_16x16x32_bf16 v[192:195], v[96:99], v[64:67], v[192:195]
    v_mfma_f32_16x16x32_bf16 v[196:199], v[96:99], v[68:71], v[196:199]
    ds_read_b64_tr_b16 v[96:97], v54 offset:57344
    s_waitcnt lgkmcnt(13)
    v_mfma_f32_16x16x32_bf16 v[200:203], v[100:103], v[64:67], v[200:203]
    ds_read_b64_tr_b16 v[98:99], v54 offset:58368
    v_mfma_f32_16x16x32_bf16 v[204:207], v[100:103], v[68:71], v[204:207]
    ds_read_b64_tr_b16 v[100:101], v55 offset:57344
    s_waitcnt lgkmcnt(13)
    v_mfma_f32_16x16x32_bf16 v[208:211], v[104:107], v[64:67], v[208:211]
    ds_read_b64_tr_b16 v[102:103], v55 offset:58368
    v_mfma_f32_16x16x32_bf16 v[212:215], v[104:107], v[68:71], v[212:215]
    ds_read_b64_tr_b16 v[104:105], v56 offset:57344
    s_waitcnt lgkmcnt(13)
    v_mfma_f32_16x16x32_bf16 v[216:219], v[108:111], v[64:67], v[216:219]
    ds_read_b64_tr_b16 v[106:107], v56 offset:58368
    buffer_store_dwordx4 v[136:139], v13, s[8:11], s67 offen sc1
    s_add_u32 s67, s67, 1024
    v_mfma_f32_16x16x32_bf16 v[220:223], v[108:111], v[68:71], v[220:223]
    ds_read_b64_tr_b16 v[108:109], v57 offset:57344
    s_waitcnt lgkmcnt(13)
    v_mfma_f32_16x16x32_bf16 v[224:227], v[112:115], v[64:67], v[224:227]
    ds_read_b64_tr_b16 v[110:111], v57 offset:58368
    v_mfma_f32_16x16x32_bf16 v[228:231], v[112:115], v[68:71], v[228:231]
    ds_read_b64_tr_b16 v[112:113], v58 offset:57344
    s_waitcnt lgkmcnt(13)
    v_mfma_f32_16x16x32_bf16 v[232:235], v[116:119], v[64:67], v[232:235]
    ds_read_b64_tr_b16 v[114:115], v58 offset:58368
    v_mfma_f32_16x16x32_bf16 v[236:239], v[116:119], v[68:71], v[236:239]
    ds_read_b64_tr_b16 v[116:117], v59 offset:57344
    s_waitcnt lgkmcnt(13)
    v_mfma_f32_16x16x32_bf16 v[240:243], v[120:123], v[64:67], v[240:243]
    ds_read_b64_tr_b16 v[118:119], v59 offset:58368
    v_mfma_f32_16x16x32_bf16 v[244:247], v[120:123], v[68:71], v[244:247]
    ds_read_b64_tr_b16 v[120:121], v60 offset:57344
    s_waitcnt lgkmcnt(13)
    v_mfma_f32_16x16x32_bf16 v[248:251], v[124:127], v[64:67], v[248:251]
    ds_read_b64_tr_b16 v[122:123], v60 offset:58368
    v_mfma_f32_16x16x32_bf16 v[252:255], v[124:127], v[68:71], v[252:255]
    ds_read_b64_tr_b16 v[124:125], v61 offset:57344
    ds_read_b64_tr_b16 v[126:127], v61 offset:58368
    buffer_load_dwordx4 v[64:67], v13, s[8:11], s88 offen offset:1024 sc1
    buffer_load_dwordx4 v[68:71], v12, s[8:11], s88 offen offset:1024 sc1
    s_waitcnt vmcnt(15)
    s_waitcnt lgkmcnt(14)
    v_mfma_f32_16x16x32_bf16 v[192:195], v[96:99], v[72:75], v[192:195]
    v_add_u32 v54, 0x10000, v54
    v_mfma_f32_16x16x32_bf16 v[196:199], v[96:99], v[76:79], v[196:199]
    s_waitcnt lgkmcnt(12)
    v_mfma_f32_16x16x32_bf16 v[200:203], v[100:103], v[72:75], v[200:203]
    v_add_u32 v55, 0x10000, v55
    v_mfma_f32_16x16x32_bf16 v[204:207], v[100:103], v[76:79], v[204:207]
    s_waitcnt lgkmcnt(0)
    s_barrier
    ds_read_b64_tr_b16 v[96:97], v54 offset:0
    ds_read_b64_tr_b16 v[98:99], v54 offset:1024
    ds_read_b64_tr_b16 v[100:101], v55 offset:0
    v_mfma_f32_16x16x32_bf16 v[208:211], v[104:107], v[72:75], v[208:211]
    ds_read_b64_tr_b16 v[102:103], v55 offset:1024
    v_add_u32 v56, 0x10000, v56
    v_mfma_f32_16x16x32_bf16 v[212:215], v[104:107], v[76:79], v[212:215]
    ds_read_b64_tr_b16 v[104:105], v56 offset:0
    v_mfma_f32_16x16x32_bf16 v[216:219], v[108:111], v[72:75], v[216:219]
    ds_read_b64_tr_b16 v[106:107], v56 offset:1024
    v_add_u32 v57, 0x10000, v57
    v_mfma_f32_16x16x32_bf16 v[220:223], v[108:111], v[76:79], v[220:223]
    ds_read_b64_tr_b16 v[108:109], v57 offset:0
    v_mfma_f32_16x16x32_bf16 v[224:227], v[112:115], v[72:75], v[224:227]
    ds_read_b64_tr_b16 v[110:111], v57 offset:1024
    v_add_u32 v58, 0x10000, v58
    v_mfma_f32_16x16x32_bf16 v[228:231], v[112:115], v[76:79], v[228:231]
    ds_read_b64_tr_b16 v[112:113], v58 offset:0
    v_mfma_f32_16x16x32_bf16 v[232:235], v[116:119], v[72:75], v[232:235]
    ds_read_b64_tr_b16 v[114:115], v58 offset:1024
    v_add_u32 v59, 0x10000, v59
    v_mfma_f32_16x16x32_bf16 v[236:239], v[116:119], v[76:79], v[236:239]
    ds_read_b64_tr_b16 v[116:117], v59 offset:0
    v_mfma_f32_16x16x32_bf16 v[240:243], v[120:123], v[72:75], v[240:243]
    ds_read_b64_tr_b16 v[118:119], v59 offset:1024
    v_add_u32 v60, 0x10000, v60
    v_mfma_f32_16x16x32_bf16 v[244:247], v[120:123], v[76:79], v[244:247]
    ds_read_b64_tr_b16 v[120:121], v60 offset:0
    v_mfma_f32_16x16x32_bf16 v[248:251], v[124:127], v[72:75], v[248:251]
    ds_read_b64_tr_b16 v[122:123], v60 offset:1024
    v_add_u32 v61, 0x10000, v61
    v_mfma_f32_16x16x32_bf16 v[252:255], v[124:127], v[76:79], v[252:255]
    ds_read_b64_tr_b16 v[124:125], v61 offset:0
    ds_read_b64_tr_b16 v[126:127], v61 offset:1024
    buffer_load_dwordx4 v[72:75], v13, s[8:11], s88 offen offset:2048 sc1
    buffer_load_dwordx4 v[76:79], v12, s[8:11], s88 offen offset:2048 sc1
    s_waitcnt vmcnt(15)
    s_waitcnt lgkmcnt(14)
    v_mfma_f32_16x16x32_bf16 v[192:195], v[96:99], v[80:83], v[192:195]
    v_mfma_f32_16x16x32_bf16 v[196:199], v[96:99], v[84:87], v[196:199]
    ds_read_b64_tr_b16 v[96:97], v54 offset:8192
    s_waitcnt lgkmcnt(13)
    v_mfma_f32_16x16x32_bf16 v[200:203], v[100:103], v[80:83], v[200:203]
    ds_read_b64_tr_b16 v[98:99], v54 offset:9216
    v_mfma_f32_16x16x32_bf16 v[204:207], v[100:103], v[84:87], v[204:207]
    ds_read_b64_tr_b16 v[100:101], v55 offset:8192
    s_waitcnt lgkmcnt(13)
    v_mfma_f32_16x16x32_bf16 v[208:211], v[104:107], v[80:83], v[208:211]
    ds_read_b64_tr_b16 v[102:103], v55 offset:9216
    v_mfma_f32_16x16x32_bf16 v[212:215], v[104:107], v[84:87], v[212:215]
    ds_read_b64_tr_b16 v[104:105], v56 offset:8192
    s_waitcnt lgkmcnt(13)
    v_mfma_f32_16x16x32_bf16 v[216:219], v[108:111], v[80:83], v[216:219]
    ds_read_b64_tr_b16 v[106:107], v56 offset:9216
    buffer_store_dwordx4 v[140:143], v13, s[8:11], s67 offen sc1
    s_add_u32 s67, s67, s69
    v_mfma_f32_16x16x32_bf16 v[220:223], v[108:111], v[84:87], v[220:223]
    ds_read_b64_tr_b16 v[108:109], v57 offset:8192
    s_waitcnt lgkmcnt(13)
    v_mfma_f32_16x16x32_bf16 v[224:227], v[112:115], v[80:83], v[224:227]
    ds_read_b64_tr_b16 v[110:111], v57 offset:9216
    v_mfma_f32_16x16x32_bf16 v[228:231], v[112:115], v[84:87], v[228:231]
    ds_read_b64_tr_b16 v[112:113], v58 offset:8192
    s_waitcnt lgkmcnt(13)
    v_mfma_f32_16x16x32_bf16 v[232:235], v[116:119], v[80:83], v[232:235]
    ds_read_b64_tr_b16 v[114:115], v58 offset:9216
    v_mfma_f32_16x16x32_bf16 v[236:239], v[116:119], v[84:87], v[236:239]
    ds_read_b64_tr_b16 v[116:117], v59 offset:8192
    s_waitcnt lgkmcnt(13)
    v_mfma_f32_16x16x32_bf16 v[240:243], v[120:123], v[80:83], v[240:243]
    ds_read_b64_tr_b16 v[118:119], v59 offset:9216
    v_mfma_f32_16x16x32_bf16 v[244:247], v[120:123], v[84:87], v[244:247]
    ds_read_b64_tr_b16 v[120:121], v60 offset:8192
    s_waitcnt lgkmcnt(13)
    v_mfma_f32_16x16x32_bf16 v[248:251], v[124:127], v[80:83], v[248:251]
    ds_read_b64_tr_b16 v[122:123], v60 offset:9216
    v_mfma_f32_16x16x32_bf16 v[252:255], v[124:127], v[84:87], v[252:255]
    ds_read_b64_tr_b16 v[124:125], v61 offset:8192
    ds_read_b64_tr_b16 v[126:127], v61 offset:9216
    buffer_load_dwordx4 v[80:83], v13, s[8:11], s88 offen offset:3072 sc1
    buffer_load_dwordx4 v[84:87], v12, s[8:11], s88 offen offset:3072 sc1
    s_waitcnt vmcnt(15)
    s_waitcnt lgkmcnt(14)
    v_mfma_f32_16x16x32_bf16 v[192:195], v[96:99], v[88:91], v[192:195]
    v_mfma_f32_16x16x32_bf16 v[196:199], v[96:99], v[92:95], v[196:199]
    ds_read_b64_tr_b16 v[96:97], v54 offset:16384
    s_waitcnt lgkmcnt(13)
    v_mfma_f32_16x16x32_bf16 v[200:203], v[100:103], v[88:91], v[200:203]
    ds_read_b64_tr_b16 v[98:99], v54 offset:17408
    v_mfma_f32_16x16x32_bf16 v[204:207], v[100:103], v[92:95], v[204:207]
    ds_read_b64_tr_b16 v[100:101], v55 offset:16384
    s_waitcnt lgkmcnt(13)
    v_mfma_f32_16x16x32_bf16 v[208:211], v[104:107], v[88:91], v[208:211]
    ds_read_b64_tr_b16 v[102:103], v55 offset:17408
    v_mfma_f32_16x16x32_bf16 v[212:215], v[104:107], v[92:95], v[212:215]
    ds_read_b64_tr_b16 v[104:105], v56 offset:16384
    s_waitcnt lgkmcnt(13)
    v_mfma_f32_16x16x32_bf16 v[216:219], v[108:111], v[88:91], v[216:219]
    ds_read_b64_tr_b16 v[106:107], v56 offset:17408
    v_mfma_f32_16x16x32_bf16 v[220:223], v[108:111], v[92:95], v[220:223]
    ds_read_b64_tr_b16 v[108:109], v57 offset:16384
    s_waitcnt lgkmcnt(13)
    v_mfma_f32_16x16x32_bf16 v[224:227], v[112:115], v[88:91], v[224:227]
    ds_read_b64_tr_b16 v[110:111], v57 offset:17408
    v_mfma_f32_16x16x32_bf16 v[228:231], v[112:115], v[92:95], v[228:231]
    ds_read_b64_tr_b16 v[112:113], v58 offset:16384
    s_waitcnt lgkmcnt(13)
    v_mfma_f32_16x16x32_bf16 v[232:235], v[116:119], v[88:91], v[232:235]
    ds_read_b64_tr_b16 v[114:115], v58 offset:17408
    v_mfma_f32_16x16x32_bf16 v[236:239], v[116:119], v[92:95], v[236:239]
    ds_read_b64_tr_b16 v[116:117], v59 offset:16384
    s_waitcnt lgkmcnt(13)
    v_mfma_f32_16x16x32_bf16 v[240:243], v[120:123], v[88:91], v[240:243]
    ds_read_b64_tr_b16 v[118:119], v59 offset:17408
    v_mfma_f32_16x16x32_bf16 v[244:247], v[120:123], v[92:95], v[244:247]
    ds_read_b64_tr_b16 v[120:121], v60 offset:16384
    s_waitcnt lgkmcnt(13)
    v_mfma_f32_16x16x32_bf16 v[248:251], v[124:127], v[88:91], v[248:251]
    ds_read_b64_tr_b16 v[122:123], v60 offset:17408
    v_mfma_f32_16x16x32_bf16 v[252:255], v[124:127], v[92:95], v[252:255]
    ds_read_b64_tr_b16 v[124:125], v61 offset:16384
    ds_read_b64_tr_b16 v[126:127], v61 offset:17408
    s_waitcnt vmcnt(13)
    s_waitcnt lgkmcnt(14)
    v_mfma_f32_16x16x32_bf16 v[192:195], v[96:99], v[16:19], v[192:195]
    v_mfma_f32_16x16x32_bf16 v[196:199], v[96:99], v[20:23], v[196:199]
    ds_read_b64_tr_b16 v[96:97], v54 offset:24576
    s_waitcnt lgkmcnt(13)
    v_mfma_f32_16x16x32_bf16 v[200:203], v[100:103], v[16:19], v[200:203]
    ds_read_b64_tr_b16 v[98:99], v54 offset:25600
    v_mfma_f32_16x16x32_bf16 v[204:207], v[100:103], v[20:23], v[204:207]
    ds_read_b64_tr_b16 v[100:101], v55 offset:24576
    s_waitcnt lgkmcnt(13)
    v_mfma_f32_16x16x32_bf16 v[208:211], v[104:107], v[16:19], v[208:211]
    ds_read_b64_tr_b16 v[102:103], v55 offset:25600
    v_mfma_f32_16x16x32_bf16 v[212:215], v[104:107], v[20:23], v[212:215]
    ds_read_b64_tr_b16 v[104:105], v56 offset:24576
    s_waitcnt lgkmcnt(13)
    v_mfma_f32_16x16x32_bf16 v[216:219], v[108:111], v[16:19], v[216:219]
    ds_read_b64_tr_b16 v[106:107], v56 offset:25600
    buffer_store_dwordx4 v[144:147], v13, s[8:11], s67 offen sc1
    s_add_u32 s67, s67, 1024
    v_mfma_f32_16x16x32_bf16 v[220:223], v[108:111], v[20:23], v[220:223]
    ds_read_b64_tr_b16 v[108:109], v57 offset:24576
    s_waitcnt lgkmcnt(13)
    v_mfma_f32_16x16x32_bf16 v[224:227], v[112:115], v[16:19], v[224:227]
    ds_read_b64_tr_b16 v[110:111], v57 offset:25600
    v_mfma_f32_16x16x32_bf16 v[228:231], v[112:115], v[20:23], v[228:231]
    ds_read_b64_tr_b16 v[112:113], v58 offset:24576
    s_waitcnt lgkmcnt(13)
    v_mfma_f32_16x16x32_bf16 v[232:235], v[116:119], v[16:19], v[232:235]
    ds_read_b64_tr_b16 v[114:115], v58 offset:25600
    v_mfma_f32_16x16x32_bf16 v[236:239], v[116:119], v[20:23], v[236:239]
    ds_read_b64_tr_b16 v[116:117], v59 offset:24576
    s_waitcnt lgkmcnt(13)
    v_mfma_f32_16x16x32_bf16 v[240:243], v[120:123], v[16:19], v[240:243]
    ds_read_b64_tr_b16 v[118:119], v59 offset:25600
    v_mfma_f32_16x16x32_bf16 v[244:247], v[120:123], v[20:23], v[244:247]
    ds_read_b64_tr_b16 v[120:121], v60 offset:24576
    s_waitcnt lgkmcnt(13)
    v_mfma_f32_16x16x32_bf16 v[248:251], v[124:127], v[16:19], v[248:251]
    ds_read_b64_tr_b16 v[122:123], v60 offset:25600
    v_mfma_f32_16x16x32_bf16 v[252:255], v[124:127], v[20:23], v[252:255]
    ds_read_b64_tr_b16 v[124:125], v61 offset:24576
    ds_read_b64_tr_b16 v[126:127], v61 offset:25600
    s_waitcnt vmcnt(11)
    s_waitcnt lgkmcnt(14)
    v_mfma_f32_16x16x32_bf16 v[192:195], v[96:99], v[24:27], v[192:195]
    v_mfma_f32_16x16x32_bf16 v[196:199], v[96:99], v[28:31], v[196:199]
    ds_read_b64_tr_b16 v[96:97], v54 offset:32768
    s_waitcnt lgkmcnt(13)
    v_mfma_f32_16x16x32_bf16 v[200:203], v[100:103], v[24:27], v[200:203]
    ds_read_b64_tr_b16 v[98:99], v54 offset:33792
    v_mfma_f32_16x16x32_bf16 v[204:207], v[100:103], v[28:31], v[204:207]
    ds_read_b64_tr_b16 v[100:101], v55 offset:32768
    s_waitcnt lgkmcnt(13)
    v_mfma_f32_16x16x32_bf16 v[208:211], v[104:107], v[24:27], v[208:211]
    ds_read_b64_tr_b16 v[102:103], v55 offset:33792
    v_mfma_f32_16x16x32_bf16 v[212:215], v[104:107], v[28:31], v[212:215]
    ds_read_b64_tr_b16 v[104:105], v56 offset:32768
    s_waitcnt lgkmcnt(13)
    v_mfma_f32_16x16x32_bf16 v[216:219], v[108:111], v[24:27], v[216:219]
    ds_read_b64_tr_b16 v[106:107], v56 offset:33792
    v_mfma_f32_16x16x32_bf16 v[220:223], v[108:111], v[28:31], v[220:223]
    ds_read_b64_tr_b16 v[108:109], v57 offset:32768
    s_waitcnt lgkmcnt(13)
    v_mfma_f32_16x16x32_bf16 v[224:227], v[112:115], v[24:27], v[224:227]
    ds_read_b64_tr_b16 v[110:111], v57 offset:33792
    v_mfma_f32_16x16x32_bf16 v[228:231], v[112:115], v[28:31], v[228:231]
    ds_read_b64_tr_b16 v[112:113], v58 offset:32768
    s_waitcnt lgkmcnt(13)
    v_mfma_f32_16x16x32_bf16 v[232:235], v[116:119], v[24:27], v[232:235]
    ds_read_b64_tr_b16 v[114:115], v58 offset:33792
    v_mfma_f32_16x16x32_bf16 v[236:239], v[116:119], v[28:31], v[236:239]
    ds_read_b64_tr_b16 v[116:117], v59 offset:32768
    s_waitcnt lgkmcnt(13)
    v_mfma_f32_16x16x32_bf16 v[240:243], v[120:123], v[24:27], v[240:243]
    ds_read_b64_tr_b16 v[118:119], v59 offset:33792
    v_mfma_f32_16x16x32_bf16 v[244:247], v[120:123], v[28:31], v[244:247]
    ds_read_b64_tr_b16 v[120:121], v60 offset:32768
    s_waitcnt lgkmcnt(13)
    v_mfma_f32_16x16x32_bf16 v[248:251], v[124:127], v[24:27], v[248:251]
    ds_read_b64_tr_b16 v[122:123], v60 offset:33792
    v_mfma_f32_16x16x32_bf16 v[252:255], v[124:127], v[28:31], v[252:255]
    ds_read_b64_tr_b16 v[124:125], v61 offset:32768
    ds_read_b64_tr_b16 v[126:127], v61 offset:33792
    s_waitcnt vmcnt(1)
    s_cmp_ge_u32 s3, 4
    s_cbranch_scc1 L_q_noldl
    s_cmp_ge_u32 s90, 8
    s_cbranch_scc1 L_kvpd_10
    s_lshl_b32 s7, s4, 10
    s_add_u32 s7, s7, 3866624
    v_lshrrev_b32 v2, 3, v1
    v_and_b32 v3, 7, v1
    v_lshlrev_b32 v3, 2, v3
    v_lshl_add_u32 v3, v2, 7, v3
    s_mov_b32 s79, 262144
L_kvp_9:
    buffer_load_dword v2, v3, s[8:11], s7 offen sc1
    s_waitcnt vmcnt(0)
    v_cmp_ne_u32 vcc, 1, v2
    s_nop 3
    s_ff1_i32_b64 s90, vcc
    s_cmp_ge_u32 s90, 8
    s_cbranch_scc1 L_kvpd_10
    s_sleep 2
    s_sub_u32 s79, s79, 1
    s_cmp_lg_u32 s79, 0
    s_cbranch_scc1 L_kvp_9
L_kvpd_10:
    s_lshl_b32 s6, s76, 13
    s_add_u32 s6, s6, s78
    s_add_u32 m0, s6, 0
    s_add_u32 s7, s77, 0
    buffer_load_dwordx4 v49, s[8:11], s7 offen offset:0 sc1 lds
    buffer_load_dwordx4 v49, s[8:11], s7 offen offset:1024 sc1 lds
    buffer_load_dwordx4 v49, s[8:11], s7 offen offset:2048 sc1 lds
    buffer_load_dwordx4 v49, s[8:11], s7 offen offset:3072 sc1 lds
    s_lshl_b32 s6, s76, 13
    s_add_u32 s6, s6, s78
    s_add_u32 m0, s6, 4096
    s_add_u32 s7, s77, 4096
    buffer_load_dwordx4 v49, s[8:11], s7 offen offset:0 sc1 lds
    buffer_load_dwordx4 v49, s[8:11], s7 offen offset:1024 sc1 lds
    buffer_load_dwordx4 v49, s[8:11], s7 offen offset:2048 sc1 lds
    buffer_load_dwordx4 v49, s[8:11], s7 offen offset:3072 sc1 lds
    s_lshl_b32 s6, s76, 12
    s_add_u32 s6, s6, s78
    s_add_u32 m0, s6, 49152
    s_add_u32 s7, s77, 524288
    buffer_load_dwordx4 v50, s[8:11], s7 offen offset:0 sc1 lds
    buffer_load_dwordx4 v50, s[8:11], s7 offen offset:1024 sc1 lds
    buffer_load_dwordx4 v50, s[8:11], s7 offen offset:2048 sc1 lds
    buffer_load_dwordx4 v50, s[8:11], s7 offen offset:3072 sc1 lds
    s_branch L_q_jl
L_q_noldl:
    v_mov_b32 v3, 0
    buffer_load_dword v63, v3, s[28:31], 0 offen offset:128 sc1
L_q_jl:
    s_waitcnt lgkmcnt(14)
    v_mfma_f32_16x16x32_bf16 v[192:195], v[96:99], v[32:35], v[192:195]
    v_mfma_f32_16x16x32_bf16 v[196:199], v[96:99], v[36:39], v[196:199]
    ds_read_b64_tr_b16 v[96:97], v54 offset:40960
    s_waitcnt lgkmcnt(13)
    v_mfma_f32_16x16x32_bf16 v[200:203], v[100:103], v[32:35], v[200:203]
    ds_read_b64_tr_b16 v[98:99], v54 offset:41984
    v_mfma_f32_16x16x32_bf16 v[204:207], v[100:103], v[36:39], v[204:207]
    ds_read_b64_tr_b16 v[100:101], v55 offset:40960
    s_waitcnt lgkmcnt(13)
    v_mfma_f32_16x16x32_bf16 v[208:211], v[104:107], v[32:35], v[208:211]
    ds_read_b64_tr_b16 v[102:103], v55 offset:41984
    v_mfma_f32_16x16x32_bf16 v[212:215], v[104:107], v[36:39], v[212:215]
    ds_read_b64_tr_b16 v[104:105], v56 offset:40960
    s_waitcnt lgkmcnt(13)
    v_mfma_f32_16x16x32_bf16 v[216:219], v[108:111], v[32:35], v[216:219]
    ds_read_b64_tr_b16 v[106:107], v56 offset:41984
    buffer_store_dwordx4 v[148:151], v13, s[8:11], s67 offen sc1
    s_add_u32 s67, s67, s68
    v_mfma_f32_16x16x32_bf16 v[220:223], v[108:111], v[36:39], v[220:223]
    ds_read_b64_tr_b16 v[108:109], v57 offset:40960
    s_waitcnt lgkmcnt(13)
    v_mfma_f32_16x16x32_bf16 v[224:227], v[112:115], v[32:35], v[224:227]
    ds_read_b64_tr_b16 v[110:111], v57 offset:41984
    v_mfma_f32_16x16x32_bf16 v[228:231], v[112:115], v[36:39], v[228:231]
    ds_read_b64_tr_b16 v[112:113], v58 offset:40960
    s_waitcnt lgkmcnt(13)
    v_mfma_f32_16x16x32_bf16 v[232:235], v[116:119], v[32:35], v[232:235]
    ds_read_b64_tr_b16 v[114:115], v58 offset:41984
    v_mfma_f32_16x16x32_bf16 v[236:239], v[116:119], v[36:39], v[236:239]
    ds_read_b64_tr_b16 v[116:117], v59 offset:40960
    s_waitcnt lgkmcnt(13)
    v_mfma_f32_16x16x32_bf16 v[240:243], v[120:123], v[32:35], v[240:243]
    ds_read_b64_tr_b16 v[118:119], v59 offset:41984
    v_mfma_f32_16x16x32_bf16 v[244:247], v[120:123], v[36:39], v[244:247]
    ds_read_b64_tr_b16 v[120:121], v60 offset:40960
    s_waitcnt lgkmcnt(13)
    v_mfma_f32_16x16x32_bf16 v[248:251], v[124:127], v[32:35], v[248:251]
    ds_read_b64_tr_b16 v[122:123], v60 offset:41984
    v_mfma_f32_16x16x32_bf16 v[252:255], v[124:127], v[36:39], v[252:255]
    ds_read_b64_tr_b16 v[124:125], v61 offset:40960
    ds_read_b64_tr_b16 v[126:127], v61 offset:41984
    s_waitcnt lgkmcnt(14)
    v_mfma_f32_16x16x32_bf16 v[192:195], v[96:99], v[64:67], v[192:195]
    v_mfma_f32_16x16x32_bf16 v[196:199], v[96:99], v[68:71], v[196:199]
    ds_read_b64_tr_b16 v[96:97], v54 offset:49152
    s_waitcnt lgkmcnt(13)
    v_mfma_f32_16x16x32_bf16 v[200:203], v[100:103], v[64:67], v[200:203]
    ds_read_b64_tr_b16 v[98:99], v54 offset:50176
    v_mfma_f32_16x16x32_bf16 v[204:207], v[100:103], v[68:71], v[204:207]
    ds_read_b64_tr_b16 v[100:101], v55 offset:49152
    s_waitcnt lgkmcnt(13)
    v_mfma_f32_16x16x32_bf16 v[208:211], v[104:107], v[64:67], v[208:211]
    ds_read_b64_tr_b16 v[102:103], v55 offset:50176
    v_mfma_f32_16x16x32_bf16 v[212:215], v[104:107], v[68:71], v[212:215]
    ds_read_b64_tr_b16 v[104:105], v56 offset:49152
    s_waitcnt lgkmcnt(13)
    v_mfma_f32_16x16x32_bf16 v[216:219], v[108:111], v[64:67], v[216:219]
    ds_read_b64_tr_b16 v[106:107], v56 offset:50176
    buffer_store_dwordx4 v[152:155], v13, s[8:11], s67 offen sc1
    s_add_u32 s67, s67, 1024
    v_mfma_f32_16x16x32_bf16 v[220:223], v[108:111], v[68:71], v[220:223]
    ds_read_b64_tr_b16 v[108:109], v57 offset:49152
    s_waitcnt lgkmcnt(13)
    v_mfma_f32_16x16x32_bf16 v[224:227], v[112:115], v[64:67], v[224:227]
    ds_read_b64_tr_b16 v[110:111], v57 offset:50176
    v_mfma_f32_16x16x32_bf16 v[228:231], v[112:115], v[68:71], v[228:231]
    ds_read_b64_tr_b16 v[112:113], v58 offset:49152
    s_waitcnt lgkmcnt(13)
    v_mfma_f32_16x16x32_bf16 v[232:235], v[116:119], v[64:67], v[232:235]
    ds_read_b64_tr_b16 v[114:115], v58 offset:50176
    v_mfma_f32_16x16x32_bf16 v[236:239], v[116:119], v[68:71], v[236:239]
    ds_read_b64_tr_b16 v[116:117], v59 offset:49152
    s_waitcnt lgkmcnt(13)
    v_mfma_f32_16x16x32_bf16 v[240:243], v[120:123], v[64:67], v[240:243]
    ds_read_b64_tr_b16 v[118:119], v59 offset:50176
    v_mfma_f32_16x16x32_bf16 v[244:247], v[120:123], v[68:71], v[244:247]
    ds_read_b64_tr_b16 v[120:121], v60 offset:49152
    s_waitcnt lgkmcnt(13)
    v_mfma_f32_16x16x32_bf16 v[248:251], v[124:127], v[64:67], v[248:251]
    ds_read_b64_tr_b16 v[122:123], v60 offset:50176
    v_mfma_f32_16x16x32_bf16 v[252:255], v[124:127], v[68:71], v[252:255]
    ds_read_b64_tr_b16 v[124:125], v61 offset:49152
    ds_read_b64_tr_b16 v[126:127], v61 offset:50176
    s_waitcnt lgkmcnt(14)
    v_mfma_f32_16x16x32_bf16 v[192:195], v[96:99], v[72:75], v[192:195]
    v_mfma_f32_16x16x32_bf16 v[196:199], v[96:99], v[76:79], v[196:199]
    ds_read_b64_tr_b16 v[96:97], v54 offset:57344
    s_waitcnt lgkmcnt(13)
    v_mfma_f32_16x16x32_bf16 v[200:203], v[100:103], v[72:75], v[200:203]
    ds_read_b64_tr_b16 v[98:99], v54 offset:58368
    v_mfma_f32_16x16x32_bf16 v[204:207], v[100:103], v[76:79], v[204:207]
    ds_read_b64_tr_b16 v[100:101], v55 offset:57344
    s_waitcnt lgkmcnt(13)
    v_mfma_f32_16x16x32_bf16 v[208:211], v[104:107], v[72:75], v[208:211]
    ds_read_b64_tr_b16 v[102:103], v55 offset:58368
    v_mfma_f32_16x16x32_bf16 v[212:215], v[104:107], v[76:79], v[212:215]
    ds_read_b64_tr_b16 v[104:105], v56 offset:57344
    s_waitcnt lgkmcnt(13)
    v_mfma_f32_16x16x32_bf16 v[216:219], v[108:111], v[72:75], v[216:219]
    ds_read_b64_tr_b16 v[106:107], v56 offset:58368
    buffer_store_dwordx4 v[156:159], v13, s[8:11], s67 offen sc1
    s_add_u32 s67, s67, s69
    v_mfma_f32_16x16x32_bf16 v[220:223], v[108:111], v[76:79], v[220:223]
    ds_read_b64_tr_b16 v[108:109], v57 offset:57344
    s_waitcnt lgkmcnt(13)
    v_mfma_f32_16x16x32_bf16 v[224:227], v[112:115], v[72:75], v[224:227]
    ds_read_b64_tr_b16 v[110:111], v57 offset:58368
    v_mfma_f32_16x16x32_bf16 v[228:231], v[112:115], v[76:79], v[228:231]
    ds_read_b64_tr_b16 v[112:113], v58 offset:57344
    s_waitcnt lgkmcnt(13)
    v_mfma_f32_16x16x32_bf16 v[232:235], v[116:119], v[72:75], v[232:235]
    ds_read_b64_tr_b16 v[114:115], v58 offset:58368
    v_mfma_f32_16x16x32_bf16 v[236:239], v[116:119], v[76:79], v[236:239]
    ds_read_b64_tr_b16 v[116:117], v59 offset:57344
    s_waitcnt lgkmcnt(13)
    v_mfma_f32_16x16x32_bf16 v[240:243], v[120:123], v[72:75], v[240:243]
    ds_read_b64_tr_b16 v[118:119], v59 offset:58368
    v_mfma_f32_16x16x32_bf16 v[244:247], v[120:123], v[76:79], v[244:247]
    ds_read_b64_tr_b16 v[120:121], v60 offset:57344
    s_waitcnt lgkmcnt(13)
    v_mfma_f32_16x16x32_bf16 v[248:251], v[124:127], v[72:75], v[248:251]
    ds_read_b64_tr_b16 v[122:123], v60 offset:58368
    v_mfma_f32_16x16x32_bf16 v[252:255], v[124:127], v[76:79], v[252:255]
    ds_read_b64_tr_b16 v[124:125], v61 offset:57344
    ds_read_b64_tr_b16 v[126:127], v61 offset:58368
    s_waitcnt lgkmcnt(14)
    v_mfma_f32_16x16x32_bf16 v[192:195], v[96:99], v[80:83], v[192:195]
    v_mfma_f32_16x16x32_bf16 v[196:199], v[96:99], v[84:87], v[196:199]
    s_waitcnt lgkmcnt(12)
    v_mfma_f32_16x16x32_bf16 v[200:203], v[100:103], v[80:83], v[200:203]
    v_mfma_f32_16x16x32_bf16 v[204:207], v[100:103], v[84:87], v[204:207]
    s_waitcnt lgkmcnt(10)
    v_mfma_f32_16x16x32_bf16 v[208:211], v[104:107], v[80:83], v[208:211]
    v_mfma_f32_16x16x32_bf16 v[212:215], v[104:107], v[84:87], v[212:215]
    s_waitcnt lgkmcnt(8)
    v_mfma_f32_16x16x32_bf16 v[216:219], v[108:111], v[80:83], v[216:219]
    v_mfma_f32_16x16x32_bf16 v[220:223], v[108:111], v[84:87], v[220:223]
    s_waitcnt lgkmcnt(6)
    v_mfma_f32_16x16x32_bf16 v[224:227], v[112:115], v[80:83], v[224:227]
    v_mfma_f32_16x16x32_bf16 v[228:231], v[112:115], v[84:87], v[228:231]
    s_waitcnt lgkmcnt(4)
    v_mfma_f32_16x16x32_bf16 v[232:235], v[116:119], v[80:83], v[232:235]
    v_mfma_f32_16x16x32_bf16 v[236:239], v[116:119], v[84:87], v[236:239]
    s_waitcnt lgkmcnt(2)
    v_mfma_f32_16x16x32_bf16 v[240:243], v[120:123], v[80:83], v[240:243]
    v_mfma_f32_16x16x32_bf16 v[244:247], v[120:123], v[84:87], v[244:247]
    s_waitcnt lgkmcnt(0)
    v_mfma_f32_16x16x32_bf16 v[248:251], v[124:127], v[80:83], v[248:251]
    v_mfma_f32_16x16x32_bf16 v[252:255], v[124:127], v[84:87], v[252:255]
L_q_end:
    s_mov_b32 s6, 0x3e0293ee
    s_nop 7
    s_cmp_lt_u32 s5, 2
    s_cbranch_scc1 L_qs0
    buffer_store_dwordx4 v[160:163], v13, s[8:11], s67 offen sc1
    s_add_u32 s67, s67, 1024
    buffer_store_dwordx4 v[164:167], v13, s[8:11], s67 offen sc1
    s_add_u32 s67, s67, s68
L_qs0:
    v_mul_f32 v192, s6, v192
    v_mul_f32 v193, s6, v193
    v_mul_f32 v194, s6, v194
    v_mul_f32 v195, s6, v195
    v_cvt_pk_bf16_f32 v16, v192, v193
    v_cvt_pk_bf16_f32 v17, v194, v195
    v_mul_f32 v200, s6, v200
    v_mul_f32 v201, s6, v201
    v_mul_f32 v202, s6, v202
    v_mul_f32 v203, s6, v203
    v_cvt_pk_bf16_f32 v18, v200, v201
    v_cvt_pk_bf16_f32 v19, v202, v203
    v_mul_f32 v208, s6, v208
    v_mul_f32 v209, s6, v209
    v_mul_f32 v210, s6, v210
    v_mul_f32 v211, s6, v211
    v_cvt_pk_bf16_f32 v20, v208, v209
    v_cvt_pk_bf16_f32 v21, v210, v211
    v_mul_f32 v216, s6, v216
    v_mul_f32 v217, s6, v217
    v_mul_f32 v218, s6, v218
    v_mul_f32 v219, s6, v219
    v_cvt_pk_bf16_f32 v22, v216, v217
    v_cvt_pk_bf16_f32 v23, v218, v219
    v_mul_f32 v224, s6, v224
    v_mul_f32 v225, s6, v225
    v_mul_f32 v226, s6, v226
    v_mul_f32 v227, s6, v227
    v_cvt_pk_bf16_f32 v24, v224, v225
    v_cvt_pk_bf16_f32 v25, v226, v227
    v_mul_f32 v232, s6, v232
    v_mul_f32 v233, s6, v233
    v_mul_f32 v234, s6, v234
    v_mul_f32 v235, s6, v235
    v_cvt_pk_bf16_f32 v26, v232, v233
    v_cvt_pk_bf16_f32 v27, v234, v235
    v_mul_f32 v240, s6, v240
    v_mul_f32 v241, s6, v241
    v_mul_f32 v242, s6, v242
    v_mul_f32 v243, s6, v243
    v_cvt_pk_bf16_f32 v28, v240, v241
    v_cvt_pk_bf16_f32 v29, v242, v243
    v_mul_f32 v248, s6, v248
    v_mul_f32 v249, s6, v249
    v_mul_f32 v250, s6, v250
    v_mul_f32 v251, s6, v251
    v_cvt_pk_bf16_f32 v30, v248, v249
    v_cvt_pk_bf16_f32 v31, v250, v251
    s_cmp_lt_u32 s5, 2
    s_cbranch_scc1 L_qs1
    buffer_store_dwordx4 v[168:171], v13, s[8:11], s67 offen sc1
    s_add_u32 s67, s67, 1024
    buffer_store_dwordx4 v[172:175], v13, s[8:11], s67 offen sc1
    s_add_u32 s67, s67, s69
L_qs1:
    v_mul_f32 v196, s6, v196
    v_mul_f32 v197, s6, v197
    v_mul_f32 v198, s6, v198
    v_mul_f32 v199, s6, v199
    v_cvt_pk_bf16_f32 v32, v196, v197
    v_cvt_pk_bf16_f32 v33, v198, v199
    v_mul_f32 v204, s6, v204
    v_mul_f32 v205, s6, v205
    v_mul_f32 v206, s6, v206
    v_mul_f32 v207, s6, v207
    v_cvt_pk_bf16_f32 v34, v204, v205
    v_cvt_pk_bf16_f32 v35, v206, v207
    v_mul_f32 v212, s6, v212
    v_mul_f32 v213, s6, v213
    v_mul_f32 v214, s6, v214
    v_mul_f32 v215, s6, v215
    v_cvt_pk_bf16_f32 v36, v212, v213
    v_cvt_pk_bf16_f32 v37, v214, v215
    v_mul_f32 v220, s6, v220
    v_mul_f32 v221, s6, v221
    v_mul_f32 v222, s6, v222
    v_mul_f32 v223, s6, v223
    v_cvt_pk_bf16_f32 v38, v220, v221
    v_cvt_pk_bf16_f32 v39, v222, v223
    v_mul_f32 v228, s6, v228
    v_mul_f32 v229, s6, v229
    v_mul_f32 v230, s6, v230
    v_mul_f32 v231, s6, v231
    v_cvt_pk_bf16_f32 v40, v228, v229
    v_cvt_pk_bf16_f32 v41, v230, v231
    v_mul_f32 v236, s6, v236
    v_mul_f32 v237, s6, v237
    v_mul_f32 v238, s6, v238
    v_mul_f32 v239, s6, v239
    v_cvt_pk_bf16_f32 v42, v236, v237
    v_cvt_pk_bf16_f32 v43, v238, v239
    v_mul_f32 v244, s6, v244
    v_mul_f32 v245, s6, v245
    v_mul_f32 v246, s6, v246
    v_mul_f32 v247, s6, v247
    v_cvt_pk_bf16_f32 v44, v244, v245
    v_cvt_pk_bf16_f32 v45, v246, v247
    v_mul_f32 v252, s6, v252
    v_mul_f32 v253, s6, v253
    v_mul_f32 v254, s6, v254
    v_mul_f32 v255, s6, v255
    v_cvt_pk_bf16_f32 v46, v252, v253
    v_cvt_pk_bf16_f32 v47, v254, v255
    v_mov_b64 v[192:193], 0
    v_mov_b64 v[194:195], 0
    v_mov_b64 v[196:197], 0
    v_mov_b64 v[198:199], 0
    v_mov_b64 v[200:201], 0
    v_mov_b64 v[202:203], 0
    v_mov_b64 v[204:205], 0
    v_mov_b64 v[206:207], 0
    v_mov_b64 v[208:209], 0
    v_mov_b64 v[210:211], 0
    v_mov_b64 v[212:213], 0
    v_mov_b64 v[214:215], 0
    v_mov_b64 v[216:217], 0
    v_mov_b64 v[218:219], 0
    v_mov_b64 v[220:221], 0
    v_mov_b64 v[222:223], 0
    v_mov_b64 v[224:225], 0
    v_mov_b64 v[226:227], 0
    v_mov_b64 v[228:229], 0
    v_mov_b64 v[230:231], 0
    v_mov_b64 v[232:233], 0
    v_mov_b64 v[234:235], 0
    v_mov_b64 v[236:237], 0
    v_mov_b64 v[238:239], 0
    v_mov_b64 v[240:241], 0
    v_mov_b64 v[242:243], 0
    v_mov_b64 v[244:245], 0
    v_mov_b64 v[246:247], 0
    v_mov_b64 v[248:249], 0
    v_mov_b64 v[250:251], 0
    v_mov_b64 v[252:253], 0
    v_mov_b64 v[254:255], 0
    v_mov_b64 v[144:145], 0
    v_mov_b64 v[146:147], 0
    v_mov_b64 v[148:149], 0
    v_mov_b64 v[150:151], 0
    v_mov_b64 v[152:153], 0
    v_mov_b64 v[154:155], 0
    v_mov_b64 v[156:157], 0
    v_mov_b64 v[158:159], 0
    v_mov_b64 v[52:53], 0
    v_mov_b64 v[54:55], 0
    v_mov_b64 v[56:57], 0
    v_mov_b32 v48, v13
    s_waitcnt vmcnt(7)
    s_cmp_ge_u32 s5, 2
    s_cbranch_scc1 L_q_w
    s_waitcnt vmcnt(0)
L_q_w:
    s_cmp_lt_u32 s3, 4
    s_cbranch_scc1 L_q_c
    v_cmp_gt_u32 vcc, 0x100, v63
    s_cbranch_vccz L_q_c
    s_mov_b32 s28, s56
    s_mov_b32 s29, s57
    s_mov_b32 s30, 0x100
    s_mov_b32 s31, 0x20000
    v_mov_b32 v3, 0
    s_mov_b32 s79, 262144
L_poll_11:
    buffer_load_dword v2, v3, s[28:31], 0 offen offset:128 sc1
    s_waitcnt vmcnt(0)
    v_cmp_gt_u32 vcc, 0x100, v2
    s_cbranch_vccz L_polldone_12
    s_sleep 2
    s_sub_u32 s79, s79, 1
    s_cmp_lg_u32 s79, 0
    s_cbranch_scc1 L_poll_11
L_polldone_12:
L_q_c:
    s_mov_b32 s72, 0x4b800000
    s_mov_b32 s65, s72
    s_sub_u32 s63, 15, s5
    s_mov_b32 s62, -1
    s_waitcnt lgkmcnt(0)
    s_barrier
    s_cmp_lg_u32 s89, 0
    s_cbranch_scc1 L_ldback_13_c
L_ldback_13:
    s_add_i32 s62, s62, 1
    ds_read_b128 v[96:99], v48 offset:0
    ds_read_b128 v[100:103], v48 offset:1024
    ds_read_b128 v[104:107], v48 offset:2048
    ds_read_b128 v[108:111], v48 offset:3072
    ds_read_b128 v[112:115], v48 offset:4096
    ds_read_b128 v[116:119], v48 offset:5120
    ds_read_b128 v[120:123], v48 offset:6144
    ds_read_b128 v[124:127], v48 offset:7168
    s_cmp_lg_u32 s60, 0
    s_cbranch_scc1 L_nm0
    s_call_b64 s[82:83], L_mask
L_nm0:
    s_waitcnt lgkmcnt(7)
    v_mfma_f32_16x16x32_bf16 v[64:67], v[96:99], v[16:19], v[144:147]
    v_mfma_f32_16x16x32_bf16 v[68:71], v[96:99], v[32:35], v[148:151]
    ds_read_b128 v[96:99], v48 offset:8192
    s_waitcnt lgkmcnt(7)
    v_mfma_f32_16x16x32_bf16 v[64:67], v[100:103], v[20:23], v[64:67]
    v_mfma_f32_16x16x32_bf16 v[68:71], v[100:103], v[36:39], v[68:71]
    ds_read_b128 v[100:103], v48 offset:9216
    s_waitcnt lgkmcnt(7)
    v_mfma_f32_16x16x32_bf16 v[64:67], v[104:107], v[24:27], v[64:67]
    v_mfma_f32_16x16x32_bf16 v[68:71], v[104:107], v[40:43], v[68:71]
    ds_read_b128 v[104:107], v48 offset:10240
    s_waitcnt lgkmcnt(7)
    v_mfma_f32_16x16x32_bf16 v[64:67], v[108:111], v[28:31], v[64:67]
    v_mfma_f32_16x16x32_bf16 v[68:71], v[108:111], v[44:47], v[68:71]
    ds_read_b128 v[108:111], v48 offset:11264
    s_waitcnt lgkmcnt(7)
    v_mfma_f32_16x16x32_bf16 v[72:75], v[112:115], v[16:19], v[152:155]
    v_mfma_f32_16x16x32_bf16 v[76:79], v[112:115], v[32:35], v[156:159]
    ds_read_b128 v[112:115], v48 offset:12288
    s_waitcnt lgkmcnt(7)
    v_mfma_f32_16x16x32_bf16 v[72:75], v[116:119], v[20:23], v[72:75]
    v_mfma_f32_16x16x32_bf16 v[76:79], v[116:119], v[36:39], v[76:79]
    ds_read_b128 v[116:119], v48 offset:13312
    s_waitcnt lgkmcnt(7)
    v_mfma_f32_16x16x32_bf16 v[72:75], v[120:123], v[24:27], v[72:75]
    v_mfma_f32_16x16x32_bf16 v[76:79], v[120:123], v[40:43], v[76:79]
    ds_read_b128 v[120:123], v48 offset:14336
    s_waitcnt lgkmcnt(7)
    v_mfma_f32_16x16x32_bf16 v[72:75], v[124:127], v[28:31], v[72:75]
    v_mfma_f32_16x16x32_bf16 v[76:79], v[124:127], v[44:47], v[76:79]
    ds_read_b128 v[124:127], v48 offset:15360
    s_nop 7
    v_max3_f32 v58, v64, v65, v66
    v_max3_f32 v58, v58, v67, v72
    v_max3_f32 v58, v58, v73, v74
    v_max_f32 v58, v58, v75
    v_mov_b32 v60, v58
    s_nop 1
    v_permlane16_swap_b32 v58, v60
    s_nop 1
    v_max_f32 v58, v58, v60
    v_mov_b32 v60, v58
    s_nop 1
    v_permlane32_swap_b32 v58, v60
    s_nop 1
    v_max_f32 v58, v58, v60
    v_sub_f32 v64, v64, v58
    v_sub_f32 v144, 0, v58
    v_sub_f32 v65, v65, v58
    v_sub_f32 v145, 0, v58
    v_sub_f32 v66, v66, v58
    v_sub_f32 v146, 0, v58
    v_sub_f32 v67, v67, v58
    v_sub_f32 v147, 0, v58
    v_sub_f32 v72, v72, v58
    v_sub_f32 v152, 0, v58
    v_sub_f32 v73, v73, v58
    v_sub_f32 v153, 0, v58
    v_sub_f32 v74, v74, v58
    v_sub_f32 v154, 0, v58
    v_sub_f32 v75, v75, v58
    v_sub_f32 v155, 0, v58
    v_max3_f32 v59, v68, v69, v70
    v_max3_f32 v59, v59, v71, v76
    v_max3_f32 v59, v59, v77, v78
    v_max_f32 v59, v59, v79
    v_mov_b32 v60, v59
    s_nop 1
    v_permlane16_swap_b32 v59, v60
    s_nop 1
    v_max_f32 v59, v59, v60
    v_mov_b32 v60, v59
    s_nop 1
    v_permlane32_swap_b32 v59, v60
    s_nop 1
    v_max_f32 v59, v59, v60
    v_sub_f32 v68, v68, v59
    v_sub_f32 v148, 0, v59
    v_sub_f32 v69, v69, v59
    v_sub_f32 v149, 0, v59
    v_sub_f32 v70, v70, v59
    v_sub_f32 v150, 0, v59
    v_sub_f32 v71, v71, v59
    v_sub_f32 v151, 0, v59
    v_sub_f32 v76, v76, v59
    v_sub_f32 v156, 0, v59
    v_sub_f32 v77, v77, v59
    v_sub_f32 v157, 0, v59
    v_sub_f32 v78, v78, v59
    v_sub_f32 v158, 0, v59
    v_sub_f32 v79, v79, v59
    v_sub_f32 v159, 0, v59
    s_cmp_lg_u32 s60, 1
    s_cbranch_scc1 L_nm1
    s_call_b64 s[82:83], L_mask
L_nm1:
    v_exp_f32 v58, v64
    v_exp_f32 v59, v65
    s_nop 0
    v_add_f32 v52, v58, v59
    v_cvt_pk_bf16_f32 v128, v58, v59
    s_waitcnt lgkmcnt(7)
    v_mfma_f32_16x16x32_bf16 v[80:83], v[96:99], v[16:19], v[144:147]
    s_waitcnt lgkmcnt(6)
    v_exp_f32 v60, v66
    v_exp_f32 v61, v67
    v_mfma_f32_16x16x32_bf16 v[84:87], v[96:99], v[32:35], v[148:151]
    ds_read_b128 v[96:99], v48 offset:49152
    v_add_f32 v52, v60, v52
    v_add_f32 v52, v61, v52
    v_cvt_pk_bf16_f32 v129, v60, v61
    v_add_f32 v56, v54, v56
    v_mfma_f32_16x16x32_bf16 v[80:83], v[100:103], v[20:23], v[80:83]
    s_waitcnt lgkmcnt(6)
    v_exp_f32 v58, v68
    v_exp_f32 v59, v69
    v_mfma_f32_16x16x32_bf16 v[84:87], v[100:103], v[36:39], v[84:87]
    ds_read_b128 v[100:103], v48 offset:50176
    v_add_f32 v53, v58, v59
    v_cvt_pk_bf16_f32 v132, v58, v59
    v_mfma_f32_16x16x32_bf16 v[80:83], v[104:107], v[24:27], v[80:83]
    s_waitcnt lgkmcnt(6)
    v_exp_f32 v60, v70
    v_exp_f32 v61, v71
    v_mfma_f32_16x16x32_bf16 v[84:87], v[104:107], v[40:43], v[84:87]
    ds_read_b128 v[104:107], v48 offset:51200
    v_add_f32 v53, v60, v53
    v_add_f32 v53, v61, v53
    v_cvt_pk_bf16_f32 v133, v60, v61
    v_add_f32 v57, v55, v57
    v_mfma_f32_16x16x32_bf16 v[80:83], v[108:111], v[28:31], v[80:83]
    s_waitcnt lgkmcnt(6)
    v_exp_f32 v58, v72
    v_exp_f32 v59, v73
    v_mfma_f32_16x16x32_bf16 v[84:87], v[108:111], v[44:47], v[84:87]
    ds_read_b128 v[108:111], v48 offset:52224
    v_add_f32 v52, v58, v52
    v_add_f32 v52, v59, v52
    v_cvt_pk_bf16_f32 v130, v58, v59
    v_mfma_f32_16x16x32_bf16 v[88:91], v[112:115], v[16:19], v[152:155]
    s_waitcnt lgkmcnt(6)
    v_exp_f32 v60, v74
    v_exp_f32 v61, v75
    v_mfma_f32_16x16x32_bf16 v[92:95], v[112:115], v[32:35], v[156:159]
    ds_read_b128 v[112:115], v48 offset:53248
    v_add_f32 v52, v60, v52
    v_add_f32 v52, v61, v52
    v_cvt_pk_bf16_f32 v131, v60, v61
    v_mfma_f32_16x16x32_bf16 v[88:91], v[116:119], v[20:23], v[88:91]
    s_waitcnt lgkmcnt(6)
    v_exp_f32 v58, v76
    v_exp_f32 v59, v77
    v_mfma_f32_16x16x32_bf16 v[92:95], v[116:119], v[36:39], v[92:95]
    ds_read_b128 v[116:119], v48 offset:54272
    v_add_f32 v53, v58, v53
    v_add_f32 v53, v59, v53
    v_cvt_pk_bf16_f32 v134, v58, v59
    v_mfma_f32_16x16x32_bf16 v[88:91], v[120:123], v[24:27], v[88:91]
    s_waitcnt lgkmcnt(6)
    v_exp_f32 v60, v78
    v_exp_f32 v61, v79
    v_mfma_f32_16x16x32_bf16 v[92:95], v[120:123], v[40:43], v[92:95]
    ds_read_b128 v[120:123], v48 offset:55296
    v_add_f32 v53, v60, v53
    v_add_f32 v53, v61, v53
    v_cvt_pk_bf16_f32 v135, v60, v61
    v_mfma_f32_16x16x32_bf16 v[88:91], v[124:127], v[28:31], v[88:91]
    v_mfma_f32_16x16x32_bf16 v[92:95], v[124:127], v[44:47], v[92:95]
    ds_read_b128 v[124:127], v48 offset:56320
    v_add_f32 v62, v52, v53
    v_cmp_nge_f32 vcc, s65, v62
    s_cbranch_vccnz L_back_14_h
L_back_14:
    s_nop 7
    v_exp_f32 v58, v80
    v_exp_f32 v59, v81
    s_nop 0
    v_add_f32 v54, v58, v59
    v_cvt_pk_bf16_f32 v136, v58, v59
    s_cmp_lt_u32 s5, 2
    s_cbranch_scc1 L_qs2
    buffer_store_dwordx4 v[176:179], v13, s[8:11], s67 offen sc1
    s_add_u32 s67, s67, 1024
    buffer_store_dwordx4 v[180:183], v13, s[8:11], s67 offen sc1
    s_add_u32 s67, s67, s68
    buffer_store_dwordx4 v[184:187], v13, s[8:11], s67 offen sc1
    s_add_u32 s67, s67, 1024
    buffer_store_dwordx4 v[188:191], v13, s[8:11], s67 offen sc1
    s_add_u32 s67, s67, s69
L_qs2:
    s_sub_i32 s64, s60, 2
    s_cmp_eq_u32 s60, 0
    s_cbranch_scc1 L_pv2
    s_cmp_eq_u32 s60, 1
    s_cbranch_scc1 L_tail2
    s_cmp_lg_u32 s60, 2
    s_cbranch_scc1 L_st2
    s_call_b64 s[82:83], L_mask
    s_branch L_st2
.p2align 6
L_st0:
    s_waitcnt lgkmcnt(7)
    v_mfma_f32_16x16x32_bf16 v[192:195], v[96:99], v[128:131], v[192:195]
    s_waitcnt lgkmcnt(6)
    v_exp_f32 v60, v82
    v_mfma_f32_16x16x32_bf16 v[196:199], v[96:99], v[132:135], v[196:199]
    ds_read_b128 v[96:99], v48 offset:0
    v_add_f32 v54, v60, v54
    v_add_f32 v56, v52, v56
    v_mfma_f32_16x16x32_bf16 v[200:203], v[100:103], v[128:131], v[200:203]
    s_waitcnt lgkmcnt(6)
    v_exp_f32 v61, v83
    v_mfma_f32_16x16x32_bf16 v[204:207], v[100:103], v[132:135], v[204:207]
    ds_read_b128 v[100:103], v48 offset:1024
    v_add_f32 v54, v61, v54
    v_cvt_pk_bf16_f32 v137, v60, v61
    v_mfma_f32_16x16x32_bf16 v[208:211], v[104:107], v[128:131], v[208:211]
    s_waitcnt lgkmcnt(6)
    v_exp_f32 v58, v84
    v_mfma_f32_16x16x32_bf16 v[212:215], v[104:107], v[132:135], v[212:215]
    ds_read_b128 v[104:107], v48 offset:2048
    v_add_f32 v57, v53, v57
    v_mfma_f32_16x16x32_bf16 v[216:219], v[108:111], v[128:131], v[216:219]
    s_waitcnt lgkmcnt(6)
    v_exp_f32 v59, v85
    v_mfma_f32_16x16x32_bf16 v[220:223], v[108:111], v[132:135], v[220:223]
    s_sub_i32 s64, s64, 1
    ds_read_b128 v[108:111], v48 offset:3072
    v_add_f32 v55, v58, v59
    v_cvt_pk_bf16_f32 v140, v58, v59
    v_mfma_f32_16x16x32_bf16 v[224:227], v[112:115], v[128:131], v[224:227]
    s_waitcnt lgkmcnt(6)
    v_exp_f32 v60, v86
    v_mfma_f32_16x16x32_bf16 v[228:231], v[112:115], v[132:135], v[228:231]
    ds_read_b128 v[112:115], v48 offset:4096
    v_add_f32 v55, v60, v55
    v_mfma_f32_16x16x32_bf16 v[232:235], v[116:119], v[128:131], v[232:235]
    s_waitcnt lgkmcnt(6)
    v_exp_f32 v61, v87
    v_mfma_f32_16x16x32_bf16 v[236:239], v[116:119], v[132:135], v[236:239]
    s_cmp_gt_i32 s64, 0
    ds_read_b128 v[116:119], v48 offset:5120
    v_add_f32 v55, v61, v55
    v_cvt_pk_bf16_f32 v141, v60, v61
    v_mfma_f32_16x16x32_bf16 v[240:243], v[120:123], v[128:131], v[240:243]
    s_waitcnt lgkmcnt(6)
    v_exp_f32 v58, v88
    v_mfma_f32_16x16x32_bf16 v[244:247], v[120:123], v[132:135], v[244:247]
    ds_read_b128 v[120:123], v48 offset:6144
    v_add_f32 v54, v58, v54
    v_mfma_f32_16x16x32_bf16 v[248:251], v[124:127], v[128:131], v[248:251]
    s_waitcnt lgkmcnt(6)
    v_exp_f32 v59, v89
    v_mfma_f32_16x16x32_bf16 v[252:255], v[124:127], v[132:135], v[252:255]
    s_cselect_b32 s65, s72, -1.0
    ds_read_b128 v[124:127], v48 offset:7168
    v_add_f32 v54, v59, v54
    v_cvt_pk_bf16_f32 v138, v58, v59
    v_mfma_f32_16x16x32_bf16 v[64:67], v[96:99], v[16:19], v[144:147]
    s_waitcnt lgkmcnt(6)
    v_exp_f32 v60, v90
    v_mfma_f32_16x16x32_bf16 v[68:71], v[96:99], v[32:35], v[148:151]
    ds_read_b128 v[96:99], v48 offset:40960
    v_add_f32 v54, v60, v54
    v_mfma_f32_16x16x32_bf16 v[64:67], v[100:103], v[20:23], v[64:67]
    s_waitcnt lgkmcnt(6)
    v_exp_f32 v61, v91
    v_mfma_f32_16x16x32_bf16 v[68:71], v[100:103], v[36:39], v[68:71]
    ds_read_b128 v[100:103], v48 offset:41984
    v_add_f32 v54, v61, v54
    v_cvt_pk_bf16_f32 v139, v60, v61
    v_mfma_f32_16x16x32_bf16 v[64:67], v[104:107], v[24:27], v[64:67]
    s_waitcnt lgkmcnt(6)
    v_exp_f32 v58, v92
    v_mfma_f32_16x16x32_bf16 v[68:71], v[104:107], v[40:43], v[68:71]
    ds_read_b128 v[104:107], v48 offset:43008
    v_add_f32 v55, v58, v55
    v_mfma_f32_16x16x32_bf16 v[64:67], v[108:111], v[28:31], v[64:67]
    s_waitcnt lgkmcnt(6)
    v_exp_f32 v59, v93
    v_mfma_f32_16x16x32_bf16 v[68:71], v[108:111], v[44:47], v[68:71]
    ds_read_b128 v[108:111], v48 offset:44032
    v_add_f32 v55, v59, v55
    v_cvt_pk_bf16_f32 v142, v58, v59
    v_mfma_f32_16x16x32_bf16 v[72:75], v[112:115], v[16:19], v[152:155]
    s_waitcnt lgkmcnt(6)
    v_exp_f32 v60, v94
    v_mfma_f32_16x16x32_bf16 v[76:79], v[112:115], v[32:35], v[156:159]
    ds_read_b128 v[112:115], v48 offset:45056
    v_add_f32 v55, v60, v55
    v_mfma_f32_16x16x32_bf16 v[72:75], v[116:119], v[20:23], v[72:75]
    s_waitcnt lgkmcnt(6)
    v_exp_f32 v61, v95
    v_mfma_f32_16x16x32_bf16 v[76:79], v[116:119], v[36:39], v[76:79]
    ds_read_b128 v[116:119], v48 offset:46080
    v_add_f32 v55, v61, v55
    v_cvt_pk_bf16_f32 v143, v60, v61
    v_mfma_f32_16x16x32_bf16 v[72:75], v[120:123], v[24:27], v[72:75]
    s_waitcnt lgkmcnt(6)
    v_exp_f32 v58, v64
    v_mfma_f32_16x16x32_bf16 v[76:79], v[120:123], v[40:43], v[76:79]
    ds_read_b128 v[120:123], v48 offset:47104
    v_add_f32 v62, v54, v55
    v_cmp_nge_f32 vcc, s65, v62
    v_mfma_f32_16x16x32_bf16 v[72:75], v[124:127], v[28:31], v[72:75]
    v_exp_f32 v59, v65
    v_mfma_f32_16x16x32_bf16 v[76:79], v[124:127], v[44:47], v[76:79]
    ds_read_b128 v[124:127], v48 offset:48128
    v_add_f32 v52, v58, v59
    v_cvt_pk_bf16_f32 v128, v58, v59
    s_cbranch_vccnz L_back_15_h
L_back_15:
    s_waitcnt lgkmcnt(7)
    v_mfma_f32_16x16x32_bf16 v[192:195], v[96:99], v[136:139], v[192:195]
    s_waitcnt lgkmcnt(6)
    v_exp_f32 v60, v66
    v_mfma_f32_16x16x32_bf16 v[196:199], v[96:99], v[140:143], v[196:199]
    ds_read_b128 v[96:99], v48 offset:8192
    v_add_f32 v52, v60, v52
    v_add_f32 v56, v54, v56
    v_mfma_f32_16x16x32_bf16 v[200:203], v[100:103], v[136:139], v[200:203]
    s_waitcnt lgkmcnt(6)
    v_exp_f32 v61, v67
    v_mfma_f32_16x16x32_bf16 v[204:207], v[100:103], v[140:143], v[204:207]
    ds_read_b128 v[100:103], v48 offset:9216
    v_add_f32 v52, v61, v52
    v_cvt_pk_bf16_f32 v129, v60, v61
    v_mfma_f32_16x16x32_bf16 v[208:211], v[104:107], v[136:139], v[208:211]
    s_waitcnt lgkmcnt(6)
    v_exp_f32 v58, v68
    v_mfma_f32_16x16x32_bf16 v[212:215], v[104:107], v[140:143], v[212:215]
    ds_read_b128 v[104:107], v48 offset:10240
    v_add_f32 v57, v55, v57
    v_mfma_f32_16x16x32_bf16 v[216:219], v[108:111], v[136:139], v[216:219]
    s_waitcnt lgkmcnt(6)
    v_exp_f32 v59, v69
    v_mfma_f32_16x16x32_bf16 v[220:223], v[108:111], v[140:143], v[220:223]
    s_sub_i32 s64, s64, 1
    ds_read_b128 v[108:111], v48 offset:11264
    v_add_f32 v53, v58, v59
    v_cvt_pk_bf16_f32 v132, v58, v59
    v_mfma_f32_16x16x32_bf16 v[224:227], v[112:115], v[136:139], v[224:227]
    s_waitcnt lgkmcnt(6)
    v_exp_f32 v60, v70
    v_mfma_f32_16x16x32_bf16 v[228:231], v[112:115], v[140:143], v[228:231]
    ds_read_b128 v[112:115], v48 offset:12288
    v_add_f32 v53, v60, v53
    v_mfma_f32_16x16x32_bf16 v[232:235], v[116:119], v[136:139], v[232:235]
    s_waitcnt lgkmcnt(6)
    v_exp_f32 v61, v71
    v_mfma_f32_16x16x32_bf16 v[236:239], v[116:119], v[140:143], v[236:239]
    s_cmp_gt_i32 s64, 0
    ds_read_b128 v[116:119], v48 offset:13312
    v_add_f32 v53, v61, v53
    v_cvt_pk_bf16_f32 v133, v60, v61
    v_mfma_f32_16x16x32_bf16 v[240:243], v[120:123], v[136:139], v[240:243]
    s_waitcnt lgkmcnt(6)
    v_exp_f32 v58, v72
    v_mfma_f32_16x16x32_bf16 v[244:247], v[120:123], v[140:143], v[244:247]
    ds_read_b128 v[120:123], v48 offset:14336
    v_add_f32 v52, v58, v52
    v_mfma_f32_16x16x32_bf16 v[248:251], v[124:127], v[136:139], v[248:251]
    s_waitcnt lgkmcnt(6)
    v_exp_f32 v59, v73
    v_mfma_f32_16x16x32_bf16 v[252:255], v[124:127], v[140:143], v[252:255]
    s_cselect_b32 s65, s72, -1.0
    ds_read_b128 v[124:127], v48 offset:15360
    v_add_f32 v52, v59, v52
    v_cvt_pk_bf16_f32 v130, v58, v59
    v_mfma_f32_16x16x32_bf16 v[80:83], v[96:99], v[16:19], v[144:147]
    s_waitcnt lgkmcnt(6)
    v_exp_f32 v60, v74
    v_mfma_f32_16x16x32_bf16 v[84:87], v[96:99], v[32:35], v[148:151]
    ds_read_b128 v[96:99], v48 offset:49152
    v_add_f32 v52, v60, v52
    v_mfma_f32_16x16x32_bf16 v[80:83], v[100:103], v[20:23], v[80:83]
    s_waitcnt lgkmcnt(6)
    v_exp_f32 v61, v75
    v_mfma_f32_16x16x32_bf16 v[84:87], v[100:103], v[36:39], v[84:87]
    ds_read_b128 v[100:103], v48 offset:50176
    v_add_f32 v52, v61, v52
    v_cvt_pk_bf16_f32 v131, v60, v61
    v_mfma_f32_16x16x32_bf16 v[80:83], v[104:107], v[24:27], v[80:83]
    s_waitcnt lgkmcnt(6)
    v_exp_f32 v58, v76
    v_mfma_f32_16x16x32_bf16 v[84:87], v[104:107], v[40:43], v[84:87]
    ds_read_b128 v[104:107], v48 offset:51200
    v_add_f32 v53, v58, v53
    v_mfma_f32_16x16x32_bf16 v[80:83], v[108:111], v[28:31], v[80:83]
    s_waitcnt lgkmcnt(6)
    v_exp_f32 v59, v77
    v_mfma_f32_16x16x32_bf16 v[84:87], v[108:111], v[44:47], v[84:87]
    ds_read_b128 v[108:111], v48 offset:52224
    v_add_f32 v53, v59, v53
    v_cvt_pk_bf16_f32 v134, v58, v59
    v_mfma_f32_16x16x32_bf16 v[88:91], v[112:115], v[16:19], v[152:155]
    s_waitcnt lgkmcnt(6)
    v_exp_f32 v60, v78
    v_mfma_f32_16x16x32_bf16 v[92:95], v[112:115], v[32:35], v[156:159]
    ds_read_b128 v[112:115], v48 offset:53248
    v_add_f32 v53, v60, v53
    v_mfma_f32_16x16x32_bf16 v[88:91], v[116:119], v[20:23], v[88:91]
    s_waitcnt lgkmcnt(6)
    v_exp_f32 v61, v79
    v_mfma_f32_16x16x32_bf16 v[92:95], v[116:119], v[36:39], v[92:95]
    ds_read_b128 v[116:119], v48 offset:54272
    v_add_f32 v53, v61, v53
    v_cvt_pk_bf16_f32 v135, v60, v61
    v_mfma_f32_16x16x32_bf16 v[88:91], v[120:123], v[24:27], v[88:91]
    s_waitcnt lgkmcnt(6)
    v_exp_f32 v58, v80
    v_mfma_f32_16x16x32_bf16 v[92:95], v[120:123], v[40:43], v[92:95]
    ds_read_b128 v[120:123], v48 offset:55296
    v_add_f32 v62, v52, v53
    v_cmp_nge_f32 vcc, s65, v62
    v_mfma_f32_16x16x32_bf16 v[88:91], v[124:127], v[28:31], v[88:91]
    v_exp_f32 v59, v81
    v_mfma_f32_16x16x32_bf16 v[92:95], v[124:127], v[44:47], v[92:95]
    ds_read_b128 v[124:127], v48 offset:56320
    v_add_f32 v54, v58, v59
    v_cvt_pk_bf16_f32 v136, v58, v59
    s_cbranch_vccnz L_back_16_h
L_back_16:
L_st2:
    s_waitcnt lgkmcnt(7)
    v_mfma_f32_16x16x32_bf16 v[192:195], v[96:99], v[128:131], v[192:195]
    s_waitcnt lgkmcnt(6)
    v_exp_f32 v60, v82
    v_mfma_f32_16x16x32_bf16 v[196:199], v[96:99], v[132:135], v[196:199]
    ds_read_b128 v[96:99], v48 offset:16384
    v_add_f32 v54, v60, v54
    v_add_f32 v56, v52, v56
    v_mfma_f32_16x16x32_bf16 v[200:203], v[100:103], v[128:131], v[200:203]
    s_waitcnt lgkmcnt(6)
    v_exp_f32 v61, v83
    v_mfma_f32_16x16x32_bf16 v[204:207], v[100:103], v[132:135], v[204:207]
    ds_read_b128 v[100:103], v48 offset:17408
    v_add_f32 v54, v61, v54
    v_cvt_pk_bf16_f32 v137, v60, v61
    v_mfma_f32_16x16x32_bf16 v[208:211], v[104:107], v[128:131], v[208:211]
    s_waitcnt lgkmcnt(6)
    v_exp_f32 v58, v84
    v_mfma_f32_16x16x32_bf16 v[212:215], v[104:107], v[132:135], v[212:215]
    ds_read_b128 v[104:107], v48 offset:18432
    v_add_f32 v57, v53, v57
    v_mfma_f32_16x16x32_bf16 v[216:219], v[108:111], v[128:131], v[216:219]
    s_waitcnt lgkmcnt(6)
    v_exp_f32 v59, v85
    v_mfma_f32_16x16x32_bf16 v[220:223], v[108:111], v[132:135], v[220:223]
    s_sub_i32 s64, s64, 1
    ds_read_b128 v[108:111], v48 offset:19456
    v_add_f32 v55, v58, v59
    v_cvt_pk_bf16_f32 v140, v58, v59
    v_mfma_f32_16x16x32_bf16 v[224:227], v[112:115], v[128:131], v[224:227]
    s_waitcnt lgkmcnt(6)
    v_exp_f32 v60, v86
    v_mfma_f32_16x16x32_bf16 v[228:231], v[112:115], v[132:135], v[228:231]
    ds_read_b128 v[112:115], v48 offset:20480
    v_add_f32 v55, v60, v55
    v_mfma_f32_16x16x32_bf16 v[232:235], v[116:119], v[128:131], v[232:235]
    s_waitcnt lgkmcnt(6)
    v_exp_f32 v61, v87
    v_mfma_f32_16x16x32_bf16 v[236:239], v[116:119], v[132:135], v[236:239]
    s_cmp_gt_i32 s64, 0
    ds_read_b128 v[116:119], v48 offset:21504
    v_add_f32 v55, v61, v55
    v_cvt_pk_bf16_f32 v141, v60, v61
    v_mfma_f32_16x16x32_bf16 v[240:243], v[120:123], v[128:131], v[240:243]
    s_waitcnt lgkmcnt(6)
    v_exp_f32 v58, v88
    v_mfma_f32_16x16x32_bf16 v[244:247], v[120:123], v[132:135], v[244:247]
    ds_read_b128 v[120:123], v48 offset:22528
    v_add_f32 v54, v58, v54
    v_mfma_f32_16x16x32_bf16 v[248:251], v[124:127], v[128:131], v[248:251]
    s_waitcnt lgkmcnt(6)
    v_exp_f32 v59, v89
    v_mfma_f32_16x16x32_bf16 v[252:255], v[124:127], v[132:135], v[252:255]
    s_cselect_b32 s65, s72, -1.0
    ds_read_b128 v[124:127], v48 offset:23552
    v_add_f32 v54, v59, v54
    v_cvt_pk_bf16_f32 v138, v58, v59
    v_mfma_f32_16x16x32_bf16 v[64:67], v[96:99], v[16:19], v[144:147]
    s_waitcnt lgkmcnt(6)
    v_exp_f32 v60, v90
    v_mfma_f32_16x16x32_bf16 v[68:71], v[96:99], v[32:35], v[148:151]
    ds_read_b128 v[96:99], v48 offset:57344
    v_add_f32 v54, v60, v54
    v_mfma_f32_16x16x32_bf16 v[64:67], v[100:103], v[20:23], v[64:67]
    s_waitcnt lgkmcnt(6)
    v_exp_f32 v61, v91
    v_mfma_f32_16x16x32_bf16 v[68:71], v[100:103], v[36:39], v[68:71]
    ds_read_b128 v[100:103], v48 offset:58368
    v_add_f32 v54, v61, v54
    v_cvt_pk_bf16_f32 v139, v60, v61
    v_mfma_f32_16x16x32_bf16 v[64:67], v[104:107], v[24:27], v[64:67]
    s_waitcnt lgkmcnt(6)
    v_exp_f32 v58, v92
    v_mfma_f32_16x16x32_bf16 v[68:71], v[104:107], v[40:43], v[68:71]
    ds_read_b128 v[104:107], v48 offset:59392
    v_add_f32 v55, v58, v55
    v_mfma_f32_16x16x32_bf16 v[64:67], v[108:111], v[28:31], v[64:67]
    s_waitcnt lgkmcnt(6)
    v_exp_f32 v59, v93
    v_mfma_f32_16x16x32_bf16 v[68:71], v[108:111], v[44:47], v[68:71]
    ds_read_b128 v[108:111], v48 offset:60416
    v_add_f32 v55, v59, v55
    v_cvt_pk_bf16_f32 v142, v58, v59
    v_mfma_f32_16x16x32_bf16 v[72:75], v[112:115], v[16:19], v[152:155]
    s_waitcnt lgkmcnt(6)
    v_exp_f32 v60, v94
    v_mfma_f32_16x16x32_bf16 v[76:79], v[112:115], v[32:35], v[156:159]
    ds_read_b128 v[112:115], v48 offset:61440
    v_add_f32 v55, v60, v55
    v_mfma_f32_16x16x32_bf16 v[72:75], v[116:119], v[20:23], v[72:75]
    s_waitcnt lgkmcnt(6)
    v_exp_f32 v61, v95
    v_mfma_f32_16x16x32_bf16 v[76:79], v[116:119], v[36:39], v[76:79]
    ds_read_b128 v[116:119], v48 offset:62464
    v_add_f32 v55, v61, v55
    v_cvt_pk_bf16_f32 v143, v60, v61
    v_mfma_f32_16x16x32_bf16 v[72:75], v[120:123], v[24:27], v[72:75]
    s_waitcnt lgkmcnt(6)
    v_exp_f32 v58, v64
    v_mfma_f32_16x16x32_bf16 v[76:79], v[120:123], v[40:43], v[76:79]
    ds_read_b128 v[120:123], v48 offset:63488
    v_add_f32 v62, v54, v55
    v_cmp_nge_f32 vcc, s65, v62
    v_mfma_f32_16x16x32_bf16 v[72:75], v[124:127], v[28:31], v[72:75]
    v_exp_f32 v59, v65
    v_mfma_f32_16x16x32_bf16 v[76:79], v[124:127], v[44:47], v[76:79]
    ds_read_b128 v[124:127], v48 offset:64512
    v_add_f32 v52, v58, v59
    v_cvt_pk_bf16_f32 v128, v58, v59
    s_cbranch_vccnz L_back_17_h
L_back_17:
    s_waitcnt lgkmcnt(7)
    v_mfma_f32_16x16x32_bf16 v[192:195], v[96:99], v[136:139], v[192:195]
    s_waitcnt lgkmcnt(6)
    v_exp_f32 v60, v66
    v_mfma_f32_16x16x32_bf16 v[196:199], v[96:99], v[140:143], v[196:199]
    ds_read_b128 v[96:99], v48 offset:24576
    v_add_f32 v52, v60, v52
    v_add_f32 v56, v54, v56
    v_mfma_f32_16x16x32_bf16 v[200:203], v[100:103], v[136:139], v[200:203]
    s_waitcnt lgkmcnt(6)
    v_exp_f32 v61, v67
    v_mfma_f32_16x16x32_bf16 v[204:207], v[100:103], v[140:143], v[204:207]
    ds_read_b128 v[100:103], v48 offset:25600
    v_add_f32 v52, v61, v52
    v_cvt_pk_bf16_f32 v129, v60, v61
    v_mfma_f32_16x16x32_bf16 v[208:211], v[104:107], v[136:139], v[208:211]
    s_waitcnt lgkmcnt(6)
    v_exp_f32 v58, v68
    v_mfma_f32_16x16x32_bf16 v[212:215], v[104:107], v[140:143], v[212:215]
    ds_read_b128 v[104:107], v48 offset:26624
    v_add_f32 v57, v55, v57
    v_mfma_f32_16x16x32_bf16 v[216:219], v[108:111], v[136:139], v[216:219]
    s_waitcnt lgkmcnt(6)
    v_exp_f32 v59, v69
    v_mfma_f32_16x16x32_bf16 v[220:223], v[108:111], v[140:143], v[220:223]
    s_sub_i32 s64, s64, 1
    ds_read_b128 v[108:111], v48 offset:27648
    v_add_f32 v53, v58, v59
    v_cvt_pk_bf16_f32 v132, v58, v59
    v_mfma_f32_16x16x32_bf16 v[224:227], v[112:115], v[136:139], v[224:227]
    s_waitcnt lgkmcnt(6)
    v_exp_f32 v60, v70
    v_mfma_f32_16x16x32_bf16 v[228:231], v[112:115], v[140:143], v[228:231]
    ds_read_b128 v[112:115], v48 offset:28672
    v_add_f32 v53, v60, v53
    v_mfma_f32_16x16x32_bf16 v[232:235], v[116:119], v[136:139], v[232:235]
    s_waitcnt lgkmcnt(6)
    v_exp_f32 v61, v71
    v_mfma_f32_16x16x32_bf16 v[236:239], v[116:119], v[140:143], v[236:239]
    s_cmp_gt_i32 s64, 0
    ds_read_b128 v[116:119], v48 offset:29696
    v_add_f32 v53, v61, v53
    v_cvt_pk_bf16_f32 v133, v60, v61
    v_mfma_f32_16x16x32_bf16 v[240:243], v[120:123], v[136:139], v[240:243]
    s_waitcnt lgkmcnt(6)
    v_exp_f32 v58, v72
    v_mfma_f32_16x16x32_bf16 v[244:247], v[120:123], v[140:143], v[244:247]
    ds_read_b128 v[120:123], v48 offset:30720
    v_add_f32 v52, v58, v52
    v_mfma_f32_16x16x32_bf16 v[248:251], v[124:127], v[136:139], v[248:251]
    s_waitcnt lgkmcnt(6)
    v_exp_f32 v59, v73
    v_mfma_f32_16x16x32_bf16 v[252:255], v[124:127], v[140:143], v[252:255]
    s_cselect_b32 s65, s72, -1.0
    ds_read_b128 v[124:127], v48 offset:31744
    v_add_f32 v52, v59, v52
    v_cvt_pk_bf16_f32 v130, v58, v59
    v_mfma_f32_16x16x32_bf16 v[80:83], v[96:99], v[16:19], v[144:147]
    s_waitcnt lgkmcnt(6)
    v_exp_f32 v60, v74
    v_mfma_f32_16x16x32_bf16 v[84:87], v[96:99], v[32:35], v[148:151]
    v_add_f32 v52, v60, v52
    v_mfma_f32_16x16x32_bf16 v[80:83], v[100:103], v[20:23], v[80:83]
    s_waitcnt lgkmcnt(5)
    v_exp_f32 v61, v75
    v_xor_b32 v48, 0x10000, v48
    v_mfma_f32_16x16x32_bf16 v[84:87], v[100:103], v[36:39], v[84:87]
    s_waitcnt vmcnt(0) lgkmcnt(0)
    s_barrier
    s_cmp_lg_u32 s89, 0
    s_cbranch_scc1 L_ldback_18_c
L_ldback_18:
    s_add_i32 s62, s62, 1
    ds_read_b128 v[96:99], v48 offset:32768
    ds_read_b128 v[100:103], v48 offset:33792
    v_add_f32 v52, v61, v52
    v_cvt_pk_bf16_f32 v131, v60, v61
    v_mfma_f32_16x16x32_bf16 v[80:83], v[104:107], v[24:27], v[80:83]
    v_exp_f32 v58, v76
    v_mfma_f32_16x16x32_bf16 v[84:87], v[104:107], v[40:43], v[84:87]
    ds_read_b128 v[104:107], v48 offset:34816
    v_add_f32 v53, v58, v53
    v_mfma_f32_16x16x32_bf16 v[80:83], v[108:111], v[28:31], v[80:83]
    v_exp_f32 v59, v77
    v_mfma_f32_16x16x32_bf16 v[84:87], v[108:111], v[44:47], v[84:87]
    ds_read_b128 v[108:111], v48 offset:35840
    v_add_f32 v53, v59, v53
    v_cvt_pk_bf16_f32 v134, v58, v59
    v_mfma_f32_16x16x32_bf16 v[88:91], v[112:115], v[16:19], v[152:155]
    v_exp_f32 v60, v78
    v_mfma_f32_16x16x32_bf16 v[92:95], v[112:115], v[32:35], v[156:159]
    ds_read_b128 v[112:115], v48 offset:36864
    v_add_f32 v53, v60, v53
    v_mfma_f32_16x16x32_bf16 v[88:91], v[116:119], v[20:23], v[88:91]
    v_exp_f32 v61, v79
    v_mfma_f32_16x16x32_bf16 v[92:95], v[116:119], v[36:39], v[92:95]
    ds_read_b128 v[116:119], v48 offset:37888
    v_add_f32 v53, v61, v53
    v_cvt_pk_bf16_f32 v135, v60, v61
    v_mfma_f32_16x16x32_bf16 v[88:91], v[120:123], v[24:27], v[88:91]
    v_exp_f32 v58, v80
    v_mfma_f32_16x16x32_bf16 v[92:95], v[120:123], v[40:43], v[92:95]
    ds_read_b128 v[120:123], v48 offset:38912
    v_add_f32 v62, v52, v53
    v_cmp_nge_f32 vcc, s65, v62
    v_mfma_f32_16x16x32_bf16 v[88:91], v[124:127], v[28:31], v[88:91]
    v_exp_f32 v59, v81
    v_mfma_f32_16x16x32_bf16 v[92:95], v[124:127], v[44:47], v[92:95]
    ds_read_b128 v[124:127], v48 offset:39936
    v_add_f32 v54, v58, v59
    v_cvt_pk_bf16_f32 v136, v58, v59
    s_cbranch_vccnz L_back_19_h
L_back_19:
    s_branch L_st0
L_tail0:
    s_mov_b32 s65, s72
    s_waitcnt lgkmcnt(7)
    v_mfma_f32_16x16x32_bf16 v[192:195], v[96:99], v[128:131], v[192:195]
    s_waitcnt lgkmcnt(6)
    v_exp_f32 v60, v82
    v_exp_f32 v61, v83
    v_mfma_f32_16x16x32_bf16 v[196:199], v[96:99], v[132:135], v[196:199]
    ds_read_b128 v[96:99], v48 offset:40960
    v_add_f32 v54, v60, v54
    v_add_f32 v54, v61, v54
    v_cvt_pk_bf16_f32 v137, v60, v61
    v_add_f32 v56, v52, v56
    v_mfma_f32_16x16x32_bf16 v[200:203], v[100:103], v[128:131], v[200:203]
    s_waitcnt lgkmcnt(6)
    v_exp_f32 v58, v84
    v_exp_f32 v59, v85
    v_mfma_f32_16x16x32_bf16 v[204:207], v[100:103], v[132:135], v[204:207]
    ds_read_b128 v[100:103], v48 offset:41984
    v_add_f32 v55, v58, v59
    v_cvt_pk_bf16_f32 v140, v58, v59
    v_mfma_f32_16x16x32_bf16 v[208:211], v[104:107], v[128:131], v[208:211]
    s_waitcnt lgkmcnt(6)
    v_exp_f32 v60, v86
    v_exp_f32 v61, v87
    v_mfma_f32_16x16x32_bf16 v[212:215], v[104:107], v[132:135], v[212:215]
    ds_read_b128 v[104:107], v48 offset:43008
    v_add_f32 v55, v60, v55
    v_add_f32 v55, v61, v55
    v_cvt_pk_bf16_f32 v141, v60, v61
    v_add_f32 v57, v53, v57
    v_mfma_f32_16x16x32_bf16 v[216:219], v[108:111], v[128:131], v[216:219]
    s_waitcnt lgkmcnt(6)
    v_exp_f32 v58, v88
    v_exp_f32 v59, v89
    v_mfma_f32_16x16x32_bf16 v[220:223], v[108:111], v[132:135], v[220:223]
    ds_read_b128 v[108:111], v48 offset:44032
    v_add_f32 v54, v58, v54
    v_add_f32 v54, v59, v54
    v_cvt_pk_bf16_f32 v138, v58, v59
    v_mfma_f32_16x16x32_bf16 v[224:227], v[112:115], v[128:131], v[224:227]
    s_waitcnt lgkmcnt(6)
    v_exp_f32 v60, v90
    v_exp_f32 v61, v91
    v_mfma_f32_16x16x32_bf16 v[228:231], v[112:115], v[132:135], v[228:231]
    ds_read_b128 v[112:115], v48 offset:45056
    v_add_f32 v54, v60, v54
    v_add_f32 v54, v61, v54
    v_cvt_pk_bf16_f32 v139, v60, v61
    v_mfma_f32_16x16x32_bf16 v[232:235], v[116:119], v[128:131], v[232:235]
    s_waitcnt lgkmcnt(6)
    v_exp_f32 v58, v92
    v_exp_f32 v59, v93
    v_mfma_f32_16x16x32_bf16 v[236:239], v[116:119], v[132:135], v[236:239]
    ds_read_b128 v[116:119], v48 offset:46080
    v_add_f32 v55, v58, v55
    v_add_f32 v55, v59, v55
    v_cvt_pk_bf16_f32 v142, v58, v59
    v_mfma_f32_16x16x32_bf16 v[240:243], v[120:123], v[128:131], v[240:243]
    s_waitcnt lgkmcnt(6)
    v_exp_f32 v60, v94
    v_exp_f32 v61, v95
    v_mfma_f32_16x16x32_bf16 v[244:247], v[120:123], v[132:135], v[244:247]
    ds_read_b128 v[120:123], v48 offset:47104
    v_add_f32 v55, v60, v55
    v_add_f32 v55, v61, v55
    v_cvt_pk_bf16_f32 v143, v60, v61
    v_mfma_f32_16x16x32_bf16 v[248:251], v[124:127], v[128:131], v[248:251]
    v_mfma_f32_16x16x32_bf16 v[252:255], v[124:127], v[132:135], v[252:255]
    ds_read_b128 v[124:127], v48 offset:48128
    v_add_f32 v62, v54, v55
    v_cmp_nge_f32 vcc, s65, v62
    s_cbranch_vccnz L_back_20_h
L_back_20:
L_pv1:
    s_waitcnt lgkmcnt(7)
    v_mfma_f32_16x16x32_bf16 v[192:195], v[96:99], v[136:139], v[192:195]
    s_waitcnt lgkmcnt(6)
    v_mfma_f32_16x16x32_bf16 v[196:199], v[96:99], v[140:143], v[196:199]
    v_add_f32 v56, v54, v56
    v_mfma_f32_16x16x32_bf16 v[200:203], v[100:103], v[136:139], v[200:203]
    s_waitcnt lgkmcnt(5)
    v_mfma_f32_16x16x32_bf16 v[204:207], v[100:103], v[140:143], v[204:207]
    v_mfma_f32_16x16x32_bf16 v[208:211], v[104:107], v[136:139], v[208:211]
    s_waitcnt lgkmcnt(4)
    v_mfma_f32_16x16x32_bf16 v[212:215], v[104:107], v[140:143], v[212:215]
    v_add_f32 v57, v55, v57
    v_mfma_f32_16x16x32_bf16 v[216:219], v[108:111], v[136:139], v[216:219]
    s_waitcnt lgkmcnt(3)
    v_mfma_f32_16x16x32_bf16 v[220:223], v[108:111], v[140:143], v[220:223]
    v_mfma_f32_16x16x32_bf16 v[224:227], v[112:115], v[136:139], v[224:227]
    s_waitcnt lgkmcnt(2)
    v_mfma_f32_16x16x32_bf16 v[228:231], v[112:115], v[140:143], v[228:231]
    v_mfma_f32_16x16x32_bf16 v[232:235], v[116:119], v[136:139], v[232:235]
    s_waitcnt lgkmcnt(1)
    v_mfma_f32_16x16x32_bf16 v[236:239], v[116:119], v[140:143], v[236:239]
    v_mfma_f32_16x16x32_bf16 v[240:243], v[120:123], v[136:139], v[240:243]
    s_waitcnt lgkmcnt(0)
    v_mfma_f32_16x16x32_bf16 v[244:247], v[120:123], v[140:143], v[244:247]
    v_mfma_f32_16x16x32_bf16 v[248:251], v[124:127], v[136:139], v[248:251]
    v_mfma_f32_16x16x32_bf16 v[252:255], v[124:127], v[140:143], v[252:255]
    s_branch L_fin
L_tail1:
    s_mov_b32 s65, s72
    s_waitcnt lgkmcnt(7)
    v_mfma_f32_16x16x32_bf16 v[192:195], v[96:99], v[136:139], v[192:195]
    s_waitcnt lgkmcnt(6)
    v_exp_f32 v60, v66
    v_exp_f32 v61, v67
    v_mfma_f32_16x16x32_bf16 v[196:199], v[96:99], v[140:143], v[196:199]
    ds_read_b128 v[96:99], v48 offset:49152
    v_add_f32 v52, v60, v52
    v_add_f32 v52, v61, v52
    v_cvt_pk_bf16_f32 v129, v60, v61
    v_add_f32 v56, v54, v56
    v_mfma_f32_16x16x32_bf16 v[200:203], v[100:103], v[136:139], v[200:203]
    s_waitcnt lgkmcnt(6)
    v_exp_f32 v58, v68
    v_exp_f32 v59, v69
    v_mfma_f32_16x16x32_bf16 v[204:207], v[100:103], v[140:143], v[204:207]
    ds_read_b128 v[100:103], v48 offset:50176
    v_add_f32 v53, v58, v59
    v_cvt_pk_bf16_f32 v132, v58, v59
    v_mfma_f32_16x16x32_bf16 v[208:211], v[104:107], v[136:139], v[208:211]
    s_waitcnt lgkmcnt(6)
    v_exp_f32 v60, v70
    v_exp_f32 v61, v71
    v_mfma_f32_16x16x32_bf16 v[212:215], v[104:107], v[140:143], v[212:215]
    ds_read_b128 v[104:107], v48 offset:51200
    v_add_f32 v53, v60, v53
    v_add_f32 v53, v61, v53
    v_cvt_pk_bf16_f32 v133, v60, v61
    v_add_f32 v57, v55, v57
    v_mfma_f32_16x16x32_bf16 v[216:219], v[108:111], v[136:139], v[216:219]
    s_waitcnt lgkmcnt(6)
    v_exp_f32 v58, v72
    v_exp_f32 v59, v73
    v_mfma_f32_16x16x32_bf16 v[220:223], v[108:111], v[140:143], v[220:223]
    ds_read_b128 v[108:111], v48 offset:52224
    v_add_f32 v52, v58, v52
    v_add_f32 v52, v59, v52
    v_cvt_pk_bf16_f32 v130, v58, v59
    v_mfma_f32_16x16x32_bf16 v[224:227], v[112:115], v[136:139], v[224:227]
    s_waitcnt lgkmcnt(6)
    v_exp_f32 v60, v74
    v_exp_f32 v61, v75
    v_mfma_f32_16x16x32_bf16 v[228:231], v[112:115], v[140:143], v[228:231]
    ds_read_b128 v[112:115], v48 offset:53248
    v_add_f32 v52, v60, v52
    v_add_f32 v52, v61, v52
    v_cvt_pk_bf16_f32 v131, v60, v61
    v_mfma_f32_16x16x32_bf16 v[232:235], v[116:119], v[136:139], v[232:235]
    s_waitcnt lgkmcnt(6)
    v_exp_f32 v58, v76
    v_exp_f32 v59, v77
    v_mfma_f32_16x16x32_bf16 v[236:239], v[116:119], v[140:143], v[236:239]
    ds_read_b128 v[116:119], v48 offset:54272
    v_add_f32 v53, v58, v53
    v_add_f32 v53, v59, v53
    v_cvt_pk_bf16_f32 v134, v58, v59
    v_mfma_f32_16x16x32_bf16 v[240:243], v[120:123], v[136:139], v[240:243]
    s_waitcnt lgkmcnt(6)
    v_exp_f32 v60, v78
    v_exp_f32 v61, v79
    v_mfma_f32_16x16x32_bf16 v[244:247], v[120:123], v[140:143], v[244:247]
    ds_read_b128 v[120:123], v48 offset:55296
    v_add_f32 v53, v60, v53
    v_add_f32 v53, v61, v53
    v_cvt_pk_bf16_f32 v135, v60, v61
    v_mfma_f32_16x16x32_bf16 v[248:251], v[124:127], v[136:139], v[248:251]
    v_mfma_f32_16x16x32_bf16 v[252:255], v[124:127], v[140:143], v[252:255]
    ds_read_b128 v[124:127], v48 offset:56320
    v_add_f32 v62, v52, v53
    v_cmp_nge_f32 vcc, s65, v62
    s_cbranch_vccnz L_back_21_h
L_back_21:
L_pv2:
    s_waitcnt lgkmcnt(7)
    v_mfma_f32_16x16x32_bf16 v[192:195], v[96:99], v[128:131], v[192:195]
    s_waitcnt lgkmcnt(6)
    v_mfma_f32_16x16x32_bf16 v[196:199], v[96:99], v[132:135], v[196:199]
    v_add_f32 v56, v52, v56
    v_mfma_f32_16x16x32_bf16 v[200:203], v[100:103], v[128:131], v[200:203]
    s_waitcnt lgkmcnt(5)
    v_mfma_f32_16x16x32_bf16 v[204:207], v[100:103], v[132:135], v[204:207]
    v_mfma_f32_16x16x32_bf16 v[208:211], v[104:107], v[128:131], v[208:211]
    s_waitcnt lgkmcnt(4)
    v_mfma_f32_16x16x32_bf16 v[212:215], v[104:107], v[132:135], v[212:215]
    v_add_f32 v57, v53, v57
    v_mfma_f32_16x16x32_bf16 v[216:219], v[108:111], v[128:131], v[216:219]
    s_waitcnt lgkmcnt(3)
    v_mfma_f32_16x16x32_bf16 v[220:223], v[108:111], v[132:135], v[220:223]
    v_mfma_f32_16x16x32_bf16 v[224:227], v[112:115], v[128:131], v[224:227]
    s_waitcnt lgkmcnt(2)
    v_mfma_f32_16x16x32_bf16 v[228:231], v[112:115], v[132:135], v[228:231]
    v_mfma_f32_16x16x32_bf16 v[232:235], v[116:119], v[128:131], v[232:235]
    s_waitcnt lgkmcnt(1)
    v_mfma_f32_16x16x32_bf16 v[236:239], v[116:119], v[132:135], v[236:239]
    v_mfma_f32_16x16x32_bf16 v[240:243], v[120:123], v[128:131], v[240:243]
    s_waitcnt lgkmcnt(0)
    v_mfma_f32_16x16x32_bf16 v[244:247], v[120:123], v[132:135], v[244:247]
    v_mfma_f32_16x16x32_bf16 v[248:251], v[124:127], v[128:131], v[248:251]
    v_mfma_f32_16x16x32_bf16 v[252:255], v[124:127], v[132:135], v[252:255]
    s_branch L_fin
L_tail2:
    s_mov_b32 s65, s72
    s_waitcnt lgkmcnt(7)
    v_mfma_f32_16x16x32_bf16 v[192:195], v[96:99], v[128:131], v[192:195]
    s_waitcnt lgkmcnt(6)
    v_exp_f32 v60, v82
    v_exp_f32 v61, v83
    v_mfma_f32_16x16x32_bf16 v[196:199], v[96:99], v[132:135], v[196:199]
    ds_read_b128 v[96:99], v48 offset:57344
    v_add_f32 v54, v60, v54
    v_add_f32 v54, v61, v54
    v_cvt_pk_bf16_f32 v137, v60, v61
    v_add_f32 v56, v52, v56
    v_mfma_f32_16x16x32_bf16 v[200:203], v[100:103], v[128:131], v[200:203]
    s_waitcnt lgkmcnt(6)
    v_exp_f32 v58, v84
    v_exp_f32 v59, v85
    v_mfma_f32_16x16x32_bf16 v[204:207], v[100:103], v[132:135], v[204:207]
    ds_read_b128 v[100:103], v48 offset:58368
    v_add_f32 v55, v58, v59
    v_cvt_pk_bf16_f32 v140, v58, v59
    v_mfma_f32_16x16x32_bf16 v[208:211], v[104:107], v[128:131], v[208:211]
    s_waitcnt lgkmcnt(6)
    v_exp_f32 v60, v86
    v_exp_f32 v61, v87
    v_mfma_f32_16x16x32_bf16 v[212:215], v[104:107], v[132:135], v[212:215]
    ds_read_b128 v[104:107], v48 offset:59392
    v_add_f32 v55, v60, v55
    v_add_f32 v55, v61, v55
    v_cvt_pk_bf16_f32 v141, v60, v61
    v_add_f32 v57, v53, v57
    v_mfma_f32_16x16x32_bf16 v[216:219], v[108:111], v[128:131], v[216:219]
    s_waitcnt lgkmcnt(6)
    v_exp_f32 v58, v88
    v_exp_f32 v59, v89
    v_mfma_f32_16x16x32_bf16 v[220:223], v[108:111], v[132:135], v[220:223]
    ds_read_b128 v[108:111], v48 offset:60416
    v_add_f32 v54, v58, v54
    v_add_f32 v54, v59, v54
    v_cvt_pk_bf16_f32 v138, v58, v59
    v_mfma_f32_16x16x32_bf16 v[224:227], v[112:115], v[128:131], v[224:227]
    s_waitcnt lgkmcnt(6)
    v_exp_f32 v60, v90
    v_exp_f32 v61, v91
    v_mfma_f32_16x16x32_bf16 v[228:231], v[112:115], v[132:135], v[228:231]
    ds_read_b128 v[112:115], v48 offset:61440
    v_add_f32 v54, v60, v54
    v_add_f32 v54, v61, v54
    v_cvt_pk_bf16_f32 v139, v60, v61
    v_mfma_f32_16x16x32_bf16 v[232:235], v[116:119], v[128:131], v[232:235]
    s_waitcnt lgkmcnt(6)
    v_exp_f32 v58, v92
    v_exp_f32 v59, v93
    v_mfma_f32_16x16x32_bf16 v[236:239], v[116:119], v[132:135], v[236:239]
    ds_read_b128 v[116:119], v48 offset:62464
    v_add_f32 v55, v58, v55
    v_add_f32 v55, v59, v55
    v_cvt_pk_bf16_f32 v142, v58, v59
    v_mfma_f32_16x16x32_bf16 v[240:243], v[120:123], v[128:131], v[240:243]
    s_waitcnt lgkmcnt(6)
    v_exp_f32 v60, v94
    v_exp_f32 v61, v95
    v_mfma_f32_16x16x32_bf16 v[244:247], v[120:123], v[132:135], v[244:247]
    ds_read_b128 v[120:123], v48 offset:63488
    v_add_f32 v55, v60, v55
    v_add_f32 v55, v61, v55
    v_cvt_pk_bf16_f32 v143, v60, v61
    v_mfma_f32_16x16x32_bf16 v[248:251], v[124:127], v[128:131], v[248:251]
    v_mfma_f32_16x16x32_bf16 v[252:255], v[124:127], v[132:135], v[252:255]
    ds_read_b128 v[124:127], v48 offset:64512
    v_add_f32 v62, v54, v55
    v_cmp_nge_f32 vcc, s65, v62
    s_cbranch_vccnz L_back_22_h
L_back_22:
L_pv3:
    s_waitcnt lgkmcnt(7)
    v_mfma_f32_16x16x32_bf16 v[192:195], v[96:99], v[136:139], v[192:195]
    s_waitcnt lgkmcnt(6)
    v_mfma_f32_16x16x32_bf16 v[196:199], v[96:99], v[140:143], v[196:199]
    v_add_f32 v56, v54, v56
    v_mfma_f32_16x16x32_bf16 v[200:203], v[100:103], v[136:139], v[200:203]
    s_waitcnt lgkmcnt(5)
    v_xor_b32 v48, 0x10000, v48
    v_mfma_f32_16x16x32_bf16 v[204:207], v[100:103], v[140:143], v[204:207]
    s_waitcnt vmcnt(0) lgkmcnt(0)
    s_barrier
    s_cmp_lg_u32 s89, 0
    s_cbranch_scc1 L_ldback_23_c
L_ldback_23:
    s_add_i32 s62, s62, 1
    v_mfma_f32_16x16x32_bf16 v[208:211], v[104:107], v[136:139], v[208:211]
    v_mfma_f32_16x16x32_bf16 v[212:215], v[104:107], v[140:143], v[212:215]
    v_add_f32 v57, v55, v57
    v_mfma_f32_16x16x32_bf16 v[216:219], v[108:111], v[136:139], v[216:219]
    v_mfma_f32_16x16x32_bf16 v[220:223], v[108:111], v[140:143], v[220:223]
    v_mfma_f32_16x16x32_bf16 v[224:227], v[112:115], v[136:139], v[224:227]
    v_mfma_f32_16x16x32_bf16 v[228:231], v[112:115], v[140:143], v[228:231]
    v_mfma_f32_16x16x32_bf16 v[232:235], v[116:119], v[136:139], v[232:235]
    v_mfma_f32_16x16x32_bf16 v[236:239], v[116:119], v[140:143], v[236:239]
    v_mfma_f32_16x16x32_bf16 v[240:243], v[120:123], v[136:139], v[240:243]
    v_mfma_f32_16x16x32_bf16 v[244:247], v[120:123], v[140:143], v[244:247]
    v_mfma_f32_16x16x32_bf16 v[248:251], v[124:127], v[136:139], v[248:251]
    v_mfma_f32_16x16x32_bf16 v[252:255], v[124:127], v[140:143], v[252:255]
    s_branch L_fin
L_tail3:
    s_mov_b32 s65, s72
    s_waitcnt lgkmcnt(7)
    v_mfma_f32_16x16x32_bf16 v[192:195], v[96:99], v[136:139], v[192:195]
    s_waitcnt lgkmcnt(6)
    v_exp_f32 v60, v66
    v_exp_f32 v61, v67
    v_mfma_f32_16x16x32_bf16 v[196:199], v[96:99], v[140:143], v[196:199]
    v_add_f32 v52, v60, v52
    v_add_f32 v52, v61, v52
    v_cvt_pk_bf16_f32 v129, v60, v61
    v_add_f32 v56, v54, v56
    v_mfma_f32_16x16x32_bf16 v[200:203], v[100:103], v[136:139], v[200:203]
    s_waitcnt lgkmcnt(5)
    v_exp_f32 v58, v68
    v_exp_f32 v59, v69
    v_xor_b32 v48, 0x10000, v48
    v_mfma_f32_16x16x32_bf16 v[204:207], v[100:103], v[140:143], v[204:207]
    s_waitcnt vmcnt(0) lgkmcnt(0)
    s_barrier
    s_cmp_lg_u32 s89, 0
    s_cbranch_scc1 L_ldback_24_c
L_ldback_24:
    s_add_i32 s62, s62, 1
    ds_read_b128 v[96:99], v48 offset:32768
    ds_read_b128 v[100:103], v48 offset:33792
    v_add_f32 v53, v58, v59
    v_cvt_pk_bf16_f32 v132, v58, v59
    v_mfma_f32_16x16x32_bf16 v[208:211], v[104:107], v[136:139], v[208:211]
    v_exp_f32 v60, v70
    v_exp_f32 v61, v71
    v_mfma_f32_16x16x32_bf16 v[212:215], v[104:107], v[140:143], v[212:215]
    ds_read_b128 v[104:107], v48 offset:34816
    v_add_f32 v53, v60, v53
    v_add_f32 v53, v61, v53
    v_cvt_pk_bf16_f32 v133, v60, v61
    v_add_f32 v57, v55, v57
    v_mfma_f32_16x16x32_bf16 v[216:219], v[108:111], v[136:139], v[216:219]
    v_exp_f32 v58, v72
    v_exp_f32 v59, v73
    v_mfma_f32_16x16x32_bf16 v[220:223], v[108:111], v[140:143], v[220:223]
    ds_read_b128 v[108:111], v48 offset:35840
    v_add_f32 v52, v58, v52
    v_add_f32 v52, v59, v52
    v_cvt_pk_bf16_f32 v130, v58, v59
    v_mfma_f32_16x16x32_bf16 v[224:227], v[112:115], v[136:139], v[224:227]
    v_exp_f32 v60, v74
    v_exp_f32 v61, v75
    v_mfma_f32_16x16x32_bf16 v[228:231], v[112:115], v[140:143], v[228:231]
    ds_read_b128 v[112:115], v48 offset:36864
    v_add_f32 v52, v60, v52
    v_add_f32 v52, v61, v52
    v_cvt_pk_bf16_f32 v131, v60, v61
    v_mfma_f32_16x16x32_bf16 v[232:235], v[116:119], v[136:139], v[232:235]
    v_exp_f32 v58, v76
    v_exp_f32 v59, v77
    v_mfma_f32_16x16x32_bf16 v[236:239], v[116:119], v[140:143], v[236:239]
    ds_read_b128 v[116:119], v48 offset:37888
    v_add_f32 v53, v58, v53
    v_add_f32 v53, v59, v53
    v_cvt_pk_bf16_f32 v134, v58, v59
    v_mfma_f32_16x16x32_bf16 v[240:243], v[120:123], v[136:139], v[240:243]
    v_exp_f32 v60, v78
    v_exp_f32 v61, v79
    v_mfma_f32_16x16x32_bf16 v[244:247], v[120:123], v[140:143], v[244:247]
    ds_read_b128 v[120:123], v48 offset:38912
    v_add_f32 v53, v60, v53
    v_add_f32 v53, v61, v53
    v_cvt_pk_bf16_f32 v135, v60, v61
    v_mfma_f32_16x16x32_bf16 v[248:251], v[124:127], v[136:139], v[248:251]
    v_mfma_f32_16x16x32_bf16 v[252:255], v[124:127], v[140:143], v[252:255]
    ds_read_b128 v[124:127], v48 offset:39936
    v_add_f32 v62, v52, v53
    v_cmp_nge_f32 vcc, s65, v62
    s_cbranch_vccnz L_back_25_h
L_back_25:
L_pv0:
    s_waitcnt lgkmcnt(7)
    v_mfma_f32_16x16x32_bf16 v[192:195], v[96:99], v[128:131], v[192:195]
    s_waitcnt lgkmcnt(6)
    v_mfma_f32_16x16x32_bf16 v[196:199], v[96:99], v[132:135], v[196:199]
    v_add_f32 v56, v52, v56
    v_mfma_f32_16x16x32_bf16 v[200:203], v[100:103], v[128:131], v[200:203]
    s_waitcnt lgkmcnt(5)
    v_mfma_f32_16x16x32_bf16 v[204:207], v[100:103], v[132:135], v[204:207]
    v_mfma_f32_16x16x32_bf16 v[208:211], v[104:107], v[128:131], v[208:211]
    s_waitcnt lgkmcnt(4)
    v_mfma_f32_16x16x32_bf16 v[212:215], v[104:107], v[132:135], v[212:215]
    v_add_f32 v57, v53, v57
    v_mfma_f32_16x16x32_bf16 v[216:219], v[108:111], v[128:131], v[216:219]
    s_waitcnt lgkmcnt(3)
    v_mfma_f32_16x16x32_bf16 v[220:223], v[108:111], v[132:135], v[220:223]
    v_mfma_f32_16x16x32_bf16 v[224:227], v[112:115], v[128:131], v[224:227]
    s_waitcnt lgkmcnt(2)
    v_mfma_f32_16x16x32_bf16 v[228:231], v[112:115], v[132:135], v[228:231]
    v_mfma_f32_16x16x32_bf16 v[232:235], v[116:119], v[128:131], v[232:235]
    s_waitcnt lgkmcnt(1)
    v_mfma_f32_16x16x32_bf16 v[236:239], v[116:119], v[132:135], v[236:239]
    v_mfma_f32_16x16x32_bf16 v[240:243], v[120:123], v[128:131], v[240:243]
    s_waitcnt lgkmcnt(0)
    v_mfma_f32_16x16x32_bf16 v[244:247], v[120:123], v[132:135], v[244:247]
    v_mfma_f32_16x16x32_bf16 v[248:251], v[124:127], v[128:131], v[248:251]
    v_mfma_f32_16x16x32_bf16 v[252:255], v[124:127], v[132:135], v[252:255]
L_fin:
    v_mov_b32 v58, v56
    s_nop 1
    v_permlane16_swap_b32 v56, v58
    s_nop 1
    v_add_f32 v56, v56, v58
    v_mov_b32 v58, v56
    s_nop 1
    v_permlane32_swap_b32 v56, v58
    s_nop 1
    v_add_f32 v56, v56, v58
    v_rcp_f32 v56, v56
    v_mov_b32 v58, v57
    s_nop 1
    v_permlane16_swap_b32 v57, v58
    s_nop 1
    v_add_f32 v57, v57, v58
    v_mov_b32 v58, v57
    s_nop 1
    v_permlane32_swap_b32 v57, v58
    s_nop 1
    v_add_f32 v57, v57, v58
    v_rcp_f32 v57, v57
    s_lshl_b32 s6, s60, 18
    s_lshl_b32 s7, s4, 12
    s_add_u32 s6, s6, s7
    s_add_u32 s6, s6, 50331648
    s_nop 4
    v_mul_f32 v192, v56, v192
    v_mul_f32 v193, v56, v193
    v_mul_f32 v194, v56, v194
    v_mul_f32 v195, v56, v195
    v_cvt_pk_bf16_f32 v16, v192, v193
    v_cvt_pk_bf16_f32 v17, v194, v195
    v_mul_f32 v200, v56, v200
    v_mul_f32 v201, v56, v201
    v_mul_f32 v202, v56, v202
    v_mul_f32 v203, v56, v203
    v_cvt_pk_bf16_f32 v18, v200, v201
    v_cvt_pk_bf16_f32 v19, v202, v203
    buffer_store_dwordx4 v[16:19], v13, s[8:11], s6 offen offset:0 sc1
    v_mul_f32 v208, v56, v208
    v_mul_f32 v209, v56, v209
    v_mul_f32 v210, v56, v210
    v_mul_f32 v211, v56, v211
    v_cvt_pk_bf16_f32 v20, v208, v209
    v_cvt_pk_bf16_f32 v21, v210, v211
    v_mul_f32 v216, v56, v216
    v_mul_f32 v217, v56, v217
    v_mul_f32 v218, v56, v218
    v_mul_f32 v219, v56, v219
    v_cvt_pk_bf16_f32 v22, v216, v217
    v_cvt_pk_bf16_f32 v23, v218, v219
    buffer_store_dwordx4 v[20:23], v13, s[8:11], s6 offen offset:1024 sc1
    v_mul_f32 v224, v56, v224
    v_mul_f32 v225, v56, v225
    v_mul_f32 v226, v56, v226
    v_mul_f32 v227, v56, v227
    v_cvt_pk_bf16_f32 v24, v224, v225
    v_cvt_pk_bf16_f32 v25, v226, v227
    v_mul_f32 v232, v56, v232
    v_mul_f32 v233, v56, v233
    v_mul_f32 v234, v56, v234
    v_mul_f32 v235, v56, v235
    v_cvt_pk_bf16_f32 v26, v232, v233
    v_cvt_pk_bf16_f32 v27, v234, v235
    buffer_store_dwordx4 v[24:27], v13, s[8:11], s6 offen offset:2048 sc1
    v_mul_f32 v240, v56, v240
    v_mul_f32 v241, v56, v241
    v_mul_f32 v242, v56, v242
    v_mul_f32 v243, v56, v243
    v_cvt_pk_bf16_f32 v28, v240, v241
    v_cvt_pk_bf16_f32 v29, v242, v243
    v_mul_f32 v248, v56, v248
    v_mul_f32 v249, v56, v249
    v_mul_f32 v250, v56, v250
    v_mul_f32 v251, v56, v251
    v_cvt_pk_bf16_f32 v30, v248, v249
    v_cvt_pk_bf16_f32 v31, v250, v251
    buffer_store_dwordx4 v[28:31], v13, s[8:11], s6 offen offset:3072 sc1
    s_add_u32 s6, s6, 0x20000
    v_mul_f32 v196, v57, v196
    v_mul_f32 v197, v57, v197
    v_mul_f32 v198, v57, v198
    v_mul_f32 v199, v57, v199
    v_cvt_pk_bf16_f32 v32, v196, v197
    v_cvt_pk_bf16_f32 v33, v198, v199
    v_mul_f32 v204, v57, v204
    v_mul_f32 v205, v57, v205
    v_mul_f32 v206, v57, v206
    v_mul_f32 v207, v57, v207
    v_cvt_pk_bf16_f32 v34, v204, v205
    v_cvt_pk_bf16_f32 v35, v206, v207
    buffer_store_dwordx4 v[32:35], v13, s[8:11], s6 offen offset:0 sc1
    v_mul_f32 v212, v57, v212
    v_mul_f32 v213, v57, v213
    v_mul_f32 v214, v57, v214
    v_mul_f32 v215, v57, v215
    v_cvt_pk_bf16_f32 v36, v212, v213
    v_cvt_pk_bf16_f32 v37, v214, v215
    v_mul_f32 v220, v57, v220
    v_mul_f32 v221, v57, v221
    v_mul_f32 v222, v57, v222
    v_mul_f32 v223, v57, v223
    v_cvt_pk_bf16_f32 v38, v220, v221
    v_cvt_pk_bf16_f32 v39, v222, v223
    buffer_store_dwordx4 v[36:39], v13, s[8:11], s6 offen offset:1024 sc1
    v_mul_f32 v228, v57, v228
    v_mul_f32 v229, v57, v229
    v_mul_f32 v230, v57, v230
    v_mul_f32 v231, v57, v231
    v_cvt_pk_bf16_f32 v40, v228, v229
    v_cvt_pk_bf16_f32 v41, v230, v231
    v_mul_f32 v236, v57, v236
    v_mul_f32 v237, v57, v237
    v_mul_f32 v238, v57, v238
    v_mul_f32 v239, v57, v239
    v_cvt_pk_bf16_f32 v42, v236, v237
    v_cvt_pk_bf16_f32 v43, v238, v239
    buffer_store_dwordx4 v[40:43], v13, s[8:11], s6 offen offset:2048 sc1
    v_mul_f32 v244, v57, v244
    v_mul_f32 v245, v57, v245
    v_mul_f32 v246, v57, v246
    v_mul_f32 v247, v57, v247
    v_cvt_pk_bf16_f32 v44, v244, v245
    v_cvt_pk_bf16_f32 v45, v246, v247
    v_mul_f32 v252, v57, v252
    v_mul_f32 v253, v57, v253
    v_mul_f32 v254, v57, v254
    v_mul_f32 v255, v57, v255
    v_cvt_pk_bf16_f32 v46, v252, v253
    v_cvt_pk_bf16_f32 v47, v254, v255
    buffer_store_dwordx4 v[44:47], v13, s[8:11], s6 offen offset:3072 sc1
    s_cmp_gt_i32 s62, s63
    s_cbranch_scc1 L_e0
    s_waitcnt vmcnt(8)
    s_barrier
    s_waitcnt vmcnt(0)
    s_lshl_b32 s6, s60, 5
    s_add_u32 s6, s6, s4
    s_lshl_b32 s6, s6, 7
    s_add_u32 s6, s6, 3932160
    v_mov_b32 v2, 1
    v_mov_b32 v3, 0x4000000
    v_writelane_b32 v3, s6, 0
    buffer_store_dword v2, v3, s[8:11], 0 offen sc1
    s_cmp_lg_u32 s89, 0
    s_cbranch_scc1 L_ldback_26_c
L_ldback_26:
    s_add_i32 s62, s62, 1
    s_branch L_e1
L_e0:
    s_waitcnt vmcnt(0)
    s_lshl_b32 s6, s60, 5
    s_add_u32 s6, s6, s4
    s_lshl_b32 s6, s6, 7
    s_add_u32 s6, s6, 3932160
    v_mov_b32 v2, 1
    v_mov_b32 v3, 0x4000000
    v_writelane_b32 v3, s6, 0
    buffer_store_dword v2, v3, s[8:11], 0 offen sc1
L_e1:
L_idle:
    s_sub_i32 s6, s63, 3
    s_cmp_gt_i32 s62, s6
    s_cbranch_scc1 L_pre
    s_waitcnt vmcnt(0) lgkmcnt(0)
    s_barrier
    s_cmp_lg_u32 s89, 0
    s_cbranch_scc1 L_ldback_27_c
L_ldback_27:
    s_add_i32 s62, s62, 1
    s_cmp_lt_u32 s61, 54
    s_cbranch_scc1 L_moe
    s_cmp_lg_u32 s2, 0
    s_cbranch_scc1 L_idle
    s_cmp_eq_u32 s62, 3
    s_cbranch_scc1 L_top1
    s_cmp_eq_u32 s62, 4
    s_cbranch_scc1 L_top2
    s_branch L_idle
L_pre:
    s_cmp_lt_u32 s3, 4
    s_cbranch_scc1 L_pre1
    s_barrier
L_pre1:
    v_and_b32 v3, 7, v1
    v_lshlrev_b32 v3, 2, v3
    s_mov_b32 s72, 0x3a0000
    buffer_load_dword v51, v3, s[8:11], s72 offen sc1
    v_and_b32 v3, 3, v1
    v_bfe_u32 v2, v1, 2, 1
    v_lshl_add_u32 v3, v2, 5, v3
    v_lshlrev_b32 v3, 7, v3
    s_lshl_b32 s72, s4, 13
    s_lshl_b32 s6, s3, 9
    s_add_u32 s72, s72, s6
    s_add_u32 s72, s72, 3932160
    buffer_load_dword v53, v3, s[8:11], s72 offen sc1
    s_lshl_b32 s66, s5, 1
    v_add_u32 v52, 4096, v13
    s_mul_i32 s69, s3, 655360
    s_mul_i32 s7, s5, 5120
    s_add_u32 s69, s69, s7
    s_add_u32 s69, s69, 4194304
    s_add_u32 s75, s66, 0
    s_and_b32 s75, s75, 15
    s_mul_i32 s75, s75, 40960
    s_add_u32 s75, s75, s69
    buffer_load_dwordx4 v[56:59], v13, s[8:11], s75 offen offset:0 sc1
    buffer_load_dwordx4 v[60:63], v13, s[8:11], s75 offen offset:1024 sc1
    buffer_load_dwordx4 v[64:67], v13, s[8:11], s75 offen offset:2048 sc1
    buffer_load_dwordx4 v[68:71], v13, s[8:11], s75 offen offset:3072 sc1
    buffer_load_dwordx4 v[72:75], v52, s[8:11], s75 offen offset:0 sc1
    s_add_u32 s75, s66, 1
    s_and_b32 s75, s75, 15
    s_mul_i32 s75, s75, 40960
    s_add_u32 s75, s75, s69
    buffer_load_dwordx4 v[76:79], v13, s[8:11], s75 offen offset:0 sc1
    buffer_load_dwordx4 v[80:83], v13, s[8:11], s75 offen offset:1024 sc1
    buffer_load_dwordx4 v[84:87], v13, s[8:11], s75 offen offset:2048 sc1
    buffer_load_dwordx4 v[88:91], v13, s[8:11], s75 offen offset:3072 sc1
    buffer_load_dwordx4 v[92:95], v52, s[8:11], s75 offen offset:0 sc1
    s_cmp_gt_i32 s62, s63
    s_cbranch_scc1 L_e2
    s_waitcnt vmcnt(12)
    s_barrier
    s_cmp_lg_u32 s89, 0
    s_cbranch_scc1 L_ldback_28_c
L_ldback_28:
    s_add_i32 s62, s62, 1
L_e2:
    s_add_u32 s75, s66, 2
    s_and_b32 s75, s75, 15
    s_mul_i32 s75, s75, 40960
    s_add_u32 s75, s75, s69
    buffer_load_dwordx4 v[96:99], v13, s[8:11], s75 offen offset:0 sc1
    buffer_load_dwordx4 v[100:103], v13, s[8:11], s75 offen offset:1024 sc1
    buffer_load_dwordx4 v[104:107], v13, s[8:11], s75 offen offset:2048 sc1
    buffer_load_dwordx4 v[108:111], v13, s[8:11], s75 offen offset:3072 sc1
    buffer_load_dwordx4 v[112:115], v52, s[8:11], s75 offen offset:0 sc1
    s_add_u32 s75, s66, 3
    s_and_b32 s75, s75, 15
    s_mul_i32 s75, s75, 40960
    s_add_u32 s75, s75, s69
    buffer_load_dwordx4 v[116:119], v13, s[8:11], s75 offen offset:0 sc1
    buffer_load_dwordx4 v[120:123], v13, s[8:11], s75 offen offset:1024 sc1
    buffer_load_dwordx4 v[124:127], v13, s[8:11], s75 offen offset:2048 sc1
    buffer_load_dwordx4 v[128:131], v13, s[8:11], s75 offen offset:3072 sc1
    buffer_load_dwordx4 v[132:135], v52, s[8:11], s75 offen offset:0 sc1
    s_cmp_gt_i32 s62, s63
    s_cbranch_scc1 L_e3
    s_waitcnt vmcnt(10)
    s_barrier
    s_cmp_lg_u32 s89, 0
    s_cbranch_scc1 L_ldback_29_c
L_ldback_29:
    s_add_i32 s62, s62, 1
L_e3:
    s_add_u32 s75, s66, 4
    s_and_b32 s75, s75, 15
    s_mul_i32 s75, s75, 40960
    s_add_u32 s75, s75, s69
    buffer_load_dwordx4 v[136:139], v13, s[8:11], s75 offen offset:0 sc1
    buffer_load_dwordx4 v[140:143], v13, s[8:11], s75 offen offset:1024 sc1
    buffer_load_dwordx4 v[144:147], v13, s[8:11], s75 offen offset:2048 sc1
    buffer_load_dwordx4 v[148:151], v13, s[8:11], s75 offen offset:3072 sc1
    buffer_load_dwordx4 v[152:155], v52, s[8:11], s75 offen offset:0 sc1
    s_add_u32 s75, s66, 5
    s_and_b32 s75, s75, 15
    s_mul_i32 s75, s75, 40960
    s_add_u32 s75, s75, s69
    buffer_load_dwordx4 v[156:159], v13, s[8:11], s75 offen offset:0 sc1
    buffer_load_dwordx4 v[160:163], v13, s[8:11], s75 offen offset:1024 sc1
    buffer_load_dwordx4 v[164:167], v13, s[8:11], s75 offen offset:2048 sc1
    buffer_load_dwordx4 v[168:171], v13, s[8:11], s75 offen offset:3072 sc1
    buffer_load_dwordx4 v[172:175], v52, s[8:11], s75 offen offset:0 sc1
    s_cmp_gt_i32 s62, s63
    s_cbranch_scc1 L_e4
    s_waitcnt vmcnt(10)
    s_barrier
    s_cmp_lg_u32 s89, 0
    s_cbranch_scc1 L_ldback_30_c
L_ldback_30:
    s_add_i32 s62, s62, 1
L_e4:
    s_cmp_ge_u32 s3, 4
    s_cbranch_scc1 L_adone
    s_waitcnt vmcnt(30)
    v_cmp_le_i32 vcc, 0, v51
    s_cbranch_vccz L_idx_oka
    v_and_b32 v3, 7, v1
    v_lshlrev_b32 v3, 2, v3
    s_mov_b32 s72, 0x3a0000
    s_mov_b32 s79, 262144
L_poll_31:
    buffer_load_dword v51, v3, s[8:11], s72 offen sc1
    s_waitcnt vmcnt(0)
    v_cmp_le_i32 vcc, 0, v51
    s_cbranch_vccz L_polldone_32
    s_sleep 2
    s_sub_u32 s79, s79, 1
    s_cmp_lg_u32 s79, 0
    s_cbranch_scc1 L_poll_31
L_polldone_32:
L_idx_oka:
    s_mov_b32 s84, s3
L_yl:
    s_mov_b32 m0, s84
    s_nop 3
    v_readlane_b32 s85, v51, m0
    s_nop 3
    s_and_b32 s86, s85, 0x7ff
    s_sub_u32 s86, 0x7ff, s86
    s_lshr_b32 s6, s86, 6
    s_cmp_lg_u32 s6, s4
    s_cbranch_scc1 L_yn
    v_min_u32 v3, 53, v1
    v_lshlrev_b32 v3, 5, v3
    s_mov_b32 s72, 0x3a6000
    s_mov_b32 s79, 262144
L_poll_33:
    buffer_load_dwordx4 v[176:179], v3, s[8:11], s72 offen sc1
    s_waitcnt vmcnt(0)
    v_and_b32 v176, v176, v177
    v_and_b32 v176, v176, v178
    v_and_b32 v176, v176, v179
    v_cmp_ne_u32 vcc, 1, v176
    s_cbranch_vccz L_polldone_34
    s_sleep 2
    s_sub_u32 s79, s79, 1
    s_cmp_lg_u32 s79, 0
    s_cbranch_scc1 L_poll_33
L_polldone_34:
    v_mul_u32_u24 v2, 13, v1
    v_lshrrev_b32 v2, 8, v2
    v_mul_u32_u24 v3, 20, v2
    v_sub_u32 v4, v1, v3
    s_mov_b32 s6, 368640
    v_mul_lo_u32 v2, v2, s6
    v_lshl_add_u32 v2, v4, 4, v2
    v_cmp_lt_u32 vcc, 59, v1
    v_mov_b32 v3, 0x4000000
    s_nop 0
    v_cndmask_b32 v2, v2, v3, vcc
    s_mul_i32 s6, s84, 2560
    s_mul_i32 s7, s5, 320
    s_add_u32 s6, s6, s7
    s_add_u32 s6, s6, 2686976
    buffer_load_dwordx4 v[176:179], v2, s[8:11], s6 offen sc1
    s_add_u32 s6, s6, 20480
    buffer_load_dwordx4 v[180:183], v2, s[8:11], s6 offen sc1
    s_add_u32 s6, s6, 20480
    buffer_load_dwordx4 v[184:187], v2, s[8:11], s6 offen sc1
    s_add_u32 s6, s6, 20480
    buffer_load_dwordx4 v[188:191], v2, s[8:11], s6 offen sc1
    s_add_u32 s6, s6, 20480
    buffer_load_dwordx4 v[192:195], v2, s[8:11], s6 offen sc1
    s_add_u32 s6, s6, 20480
    buffer_load_dwordx4 v[196:199], v2, s[8:11], s6 offen sc1
    s_add_u32 s6, s6, 20480
    buffer_load_dwordx4 v[200:203], v2, s[8:11], s6 offen sc1
    s_add_u32 s6, s6, 20480
    buffer_load_dwordx4 v[204:207], v2, s[8:11], s6 offen sc1
    s_add_u32 s6, s6, 20480
    buffer_load_dwordx4 v[208:211], v2, s[8:11], s6 offen sc1
    s_add_u32 s6, s6, 20480
    buffer_load_dwordx4 v[212:215], v2, s[8:11], s6 offen sc1
    s_add_u32 s6, s6, 20480
    buffer_load_dwordx4 v[216:219], v2, s[8:11], s6 offen sc1
    s_add_u32 s6, s6, 20480
    buffer_load_dwordx4 v[220:223], v2, s[8:11], s6 offen sc1
    s_add_u32 s6, s6, 20480
    buffer_load_dwordx4 v[224:227], v2, s[8:11], s6 offen sc1
    s_add_u32 s6, s6, 20480
    buffer_load_dwordx4 v[228:231], v2, s[8:11], s6 offen sc1
    s_add_u32 s6, s6, 20480
    buffer_load_dwordx4 v[232:235], v2, s[8:11], s6 offen sc1
    s_add_u32 s6, s6, 20480
    buffer_load_dwordx4 v[236:239], v2, s[8:11], s6 offen sc1
    s_add_u32 s6, s6, 20480
    buffer_load_dwordx4 v[240:243], v2, s[8:11], s6 offen sc1
    s_add_u32 s6, s6, 20480
    buffer_load_dwordx4 v[244:247], v2, s[8:11], s6 offen sc1
    s_add_u32 s6, s6, 20480
    s_lshr_b32 s6, s86, 4
    s_mul_i32 s6, s6, 20480
    s_and_b32 s7, s86, 15
    s_lshl_b32 s7, s7, 4
    s_add_u32 s6, s6, s7
    s_mul_i32 s7, s5, 2560
    s_add_u32 s6, s6, s7
    v_lshrrev_b32 v5, 1, v4
    v_lshlrev_b32 v5, 8, v5
    v_and_b32 v6, 1, v4
    v_lshl_add_u32 v5, v6, 3, v5
    buffer_load_dwordx2 v[248:249], v5, s[8:11], s6 offen sc1
    s_bfe_u32 s6, s85, 0x10000b
    s_xor_b32 s7, s6, 0xffff
    s_bitcmp1_b32 s6, 15
    s_bitset0_b32 s6, 15
    s_cselect_b32 s6, s6, s7
    s_lshl_b32 s6, s6, 16
    v_mov_b32 v5, s6
    v_mul_f32 v5, 0xbfb8aa3b, v5
    v_exp_f32 v5, v5
    s_nop 0
    v_add_f32 v5, 1.0, v5
    v_rcp_f32 v5, v5
    s_nop 0
    v_cvt_pk_bf16_f32 v5, v5, v5
    v_lshlrev_b32 v5, 16, v5
    v_lshlrev_b32 v6, 2, v1
    s_waitcnt vmcnt(0)
    v_pk_add_f32 v[176:177], v[176:177], v[180:181]
    v_pk_add_f32 v[178:179], v[178:179], v[182:183]
    v_pk_add_f32 v[176:177], v[176:177], v[184:185]
    v_pk_add_f32 v[178:179], v[178:179], v[186:187]
    v_pk_add_f32 v[176:177], v[176:177], v[188:189]
    v_pk_add_f32 v[178:179], v[178:179], v[190:191]
    v_pk_add_f32 v[176:177], v[176:177], v[192:193]
    v_pk_add_f32 v[178:179], v[178:179], v[194:195]
    v_pk_add_f32 v[176:177], v[176:177], v[196:197]
    v_pk_add_f32 v[178:179], v[178:179], v[198:199]
    v_pk_add_f32 v[176:177], v[176:177], v[200:201]
    v_pk_add_f32 v[178:179], v[178:179], v[202:203]
    v_pk_add_f32 v[176:177], v[176:177], v[204:205]
    v_pk_add_f32 v[178:179], v[178:179], v[206:207]
    v_pk_add_f32 v[176:177], v[176:177], v[208:209]
    v_pk_add_f32 v[178:179], v[178:179], v[210:211]
    v_pk_add_f32 v[176:177], v[176:177], v[212:213]
    v_pk_add_f32 v[178:179], v[178:179], v[214:215]
    v_pk_add_f32 v[176:177], v[176:177], v[216:217]
    v_pk_add_f32 v[178:179], v[178:179], v[218:219]
    v_pk_add_f32 v[176:177], v[176:177], v[220:221]
    v_pk_add_f32 v[178:179], v[178:179], v[222:223]
    v_pk_add_f32 v[176:177], v[176:177], v[224:225]
    v_pk_add_f32 v[178:179], v[178:179], v[226:227]
    v_pk_add_f32 v[176:177], v[176:177], v[228:229]
    v_pk_add_f32 v[178:179], v[178:179], v[230:231]
    v_pk_add_f32 v[176:177], v[176:177], v[232:233]
    v_pk_add_f32 v[178:179], v[178:179], v[234:235]
    v_pk_add_f32 v[176:177], v[176:177], v[236:237]
    v_pk_add_f32 v[178:179], v[178:179], v[238:239]
    v_pk_add_f32 v[176:177], v[176:177], v[240:241]
    v_pk_add_f32 v[178:179], v[178:179], v[242:243]
    v_pk_add_f32 v[176:177], v[176:177], v[244:245]
    v_pk_add_f32 v[178:179], v[178:179], v[246:247]
    ds_bpermute_b32 v180, v6, v176 offset:80
    ds_bpermute_b32 v181, v6, v177 offset:80
    ds_bpermute_b32 v182, v6, v178 offset:80
    ds_bpermute_b32 v183, v6, v179 offset:80
    ds_bpermute_b32 v184, v6, v176 offset:160
    ds_bpermute_b32 v185, v6, v177 offset:160
    ds_bpermute_b32 v186, v6, v178 offset:160
    ds_bpermute_b32 v187, v6, v179 offset:160
    s_waitcnt lgkmcnt(0)
    v_add_f32 v176, v176, v180
    v_add_f32 v176, v176, v184
    v_cvt_pk_bf16_f32 v176, v176, v176
    v_lshlrev_b32 v176, 16, v176
    v_mul_f32 v176, v176, v5
    v_cvt_pk_bf16_f32 v176, v176, v176
    v_lshlrev_b32 v176, 16, v176
    v_lshlrev_b32 v7, 16, v248
    v_add_f32 v176, v176, v7
    v_add_f32 v177, v177, v181
    v_add_f32 v177, v177, v185
    v_cvt_pk_bf16_f32 v177, v177, v177
    v_lshlrev_b32 v177, 16, v177
    v_mul_f32 v177, v177, v5
    v_cvt_pk_bf16_f32 v177, v177, v177
    v_lshlrev_b32 v177, 16, v177
    v_and_b32 v7, 0xffff0000, v248
    v_add_f32 v177, v177, v7
    v_add_f32 v178, v178, v182
    v_add_f32 v178, v178, v186
    v_cvt_pk_bf16_f32 v178, v178, v178
    v_lshlrev_b32 v178, 16, v178
    v_mul_f32 v178, v178, v5
    v_cvt_pk_bf16_f32 v178, v178, v178
    v_lshlrev_b32 v178, 16, v178
    v_lshlrev_b32 v7, 16, v249
    v_add_f32 v178, v178, v7
    v_add_f32 v179, v179, v183
    v_add_f32 v179, v179, v187
    v_cvt_pk_bf16_f32 v179, v179, v179
    v_lshlrev_b32 v179, 16, v179
    v_mul_f32 v179, v179, v5
    v_cvt_pk_bf16_f32 v179, v179, v179
    v_lshlrev_b32 v179, 16, v179
    v_and_b32 v7, 0xffff0000, v249
    v_add_f32 v179, v179, v7
    v_cvt_pk_bf16_f32 v180, v176, v177
    v_cvt_pk_bf16_f32 v181, v178, v179
    v_lshlrev_b32 v2, 3, v1
    v_cmp_lt_u32 vcc, 19, v1
    s_mul_i32 s6, s84, 1280
    s_mul_i32 s7, s5, 160
    v_cndmask_b32 v2, v2, v3, vcc
    s_add_u32 s6, s6, s7
    s_add_u32 s6, s6, 3837952
    buffer_store_dwordx2 v[180:181], v2, s[8:11], s6 offen sc1
    s_waitcnt vmcnt(0)
L_yn:
    s_add_u32 s84, s84, 4
    s_cmp_lt_u32 s84, 8
    s_cbranch_scc1 L_yl
    s_barrier
    s_branch L_adone
L_moe:
    s_cmp_lg_u32 s62, 5
    s_cbranch_scc1 L_idle
    s_mov_b32 s12, s48
    s_mov_b32 s13, s49
    s_mov_b32 s14, 0x21c000
    s_mov_b32 s15, 0x20000
    s_cmp_ge_u32 s3, 2
    s_cselect_b32 s12, s50, s12
    s_cselect_b32 s13, s51, s13
    s_mov_b32 s16, s52
    s_mov_b32 s17, s53
    s_mov_b32 s18, 0x21c000
    s_mov_b32 s19, 0x20000
    v_lshrrev_b32 v3, 2, v1
    v_mul_u32_u24 v3, 3456, v3
    v_and_b32 v4, 3, v1
    v_lshl_add_u32 v16, v4, 4, v3
    v_lshrrev_b32 v3, 3, v1
    v_mul_u32_u24 v3, 1280, v3
    v_and_b32 v4, 7, v1
    v_lshl_add_u32 v18, v4, 4, v3
    s_and_b32 s7, s3, 1
    s_mul_i32 s84, s7, 1105920
    s_lshl_b32 s6, s61, 6
    s_add_u32 s84, s84, s6
    s_lshl_b32 s85, s3, 13
    s_add_u32 s85, s85, 131072
    s_mul_i32 s86, s61, 40960
    s_lshl_b32 s6, s3, 7
    s_add_u32 s86, s86, s6
    s_add_u32 m0, s85, 0
    s_nop 0
    buffer_load_dwordx4 v16, s[12:15], s84 offen lds
    s_add_u32 s84, s84, 55296
    s_add_u32 m0, s85, 1024
    s_nop 0
    buffer_load_dwordx4 v16, s[12:15], s84 offen lds
    s_add_u32 s84, s84, 55296
    s_add_u32 m0, s85, 2048
    s_nop 0
    buffer_load_dwordx4 v16, s[12:15], s84 offen lds
    s_add_u32 s84, s84, 55296
    s_add_u32 m0, s85, 3072
    s_nop 0
    buffer_load_dwordx4 v16, s[12:15], s84 offen lds
    s_add_u32 s84, s84, 55296
    s_add_u32 m0, s85, 4096
    s_nop 0
    buffer_load_dwordx4 v16, s[12:15], s84 offen lds
    s_add_u32 s84, s84, 55296
    s_add_u32 m0, s85, 5120
    s_nop 0
    buffer_load_dwordx4 v16, s[12:15], s84 offen lds
    s_add_u32 s84, s84, 55296
    s_add_u32 m0, s85, 6144
    s_nop 0
    buffer_load_dwordx4 v16, s[12:15], s84 offen lds
    s_add_u32 s84, s84, 55296
    s_add_u32 m0, s85, 7168
    s_nop 0
    buffer_load_dwordx4 v16, s[12:15], s84 offen lds
    s_add_u32 s84, s84, 55296
    v_and_b32 v3, 7, v1
    v_lshlrev_b32 v3, 2, v3
    s_mov_b32 s72, 0x3a0000
    buffer_load_dword v51, v3, s[8:11], s72 offen sc1
    v_lshrrev_b32 v7, 4, v1
    v_and_b32 v2, 15, v1
    v_lshrrev_b32 v3, 2, v2
    v_lshl_add_u32 v8, v7, 3, v3
    v_lshlrev_b32 v8, 6, v8
    v_and_b32 v4, 3, v2
    v_lshl_add_u32 v8, v4, 3, v8
    v_add_u32 v17, s85, v8
    v_lshl_add_u32 v8, v7, 2, v3
    v_lshlrev_b32 v8, 7, v8
    v_lshl_add_u32 v8, v4, 3, v8
    s_add_u32 s6, s85, 4096
    v_add_u32 v19, s6, v8
    v_mul_u32_u24 v3, 2560, v2
    v_lshl_add_u32 v3, v7, 4, v3
    v_mov_b32 v4, 0x4000000
    v_cmp_gt_u32 vcc, 8, v2
    s_mul_i32 s87, s61, 20480
    s_lshl_b32 s7, s3, 8
    s_add_u32 s87, s87, s7
    s_add_u32 s87, s87, 2686976
    v_cndmask_b32 v20, v4, v3, vcc
    s_waitcnt vmcnt(0) lgkmcnt(0)
    s_barrier
    s_cmp_lg_u32 s89, 0
    s_cbranch_scc1 L_ldback_35_c
L_ldback_35:
    s_add_i32 s62, s62, 1
    ds_read_b64_tr_b16 v[104:105], v17 offset:0
    ds_read_b64_tr_b16 v[106:107], v17 offset:256
    ds_read_b64_tr_b16 v[108:109], v17 offset:32
    ds_read_b64_tr_b16 v[110:111], v17 offset:288
    ds_read_b64_tr_b16 v[112:113], v17 offset:2048
    ds_read_b64_tr_b16 v[114:115], v17 offset:2304
    ds_read_b64_tr_b16 v[116:117], v17 offset:2080
    ds_read_b64_tr_b16 v[118:119], v17 offset:2336
    s_waitcnt lgkmcnt(0)
    ds_read_b64_tr_b16 v[120:121], v17 offset:4096
    ds_read_b64_tr_b16 v[122:123], v17 offset:4352
    ds_read_b64_tr_b16 v[124:125], v17 offset:4128
    ds_read_b64_tr_b16 v[126:127], v17 offset:4384
    ds_read_b64_tr_b16 v[128:129], v17 offset:6144
    ds_read_b64_tr_b16 v[130:131], v17 offset:6400
    ds_read_b64_tr_b16 v[132:133], v17 offset:6176
    ds_read_b64_tr_b16 v[134:135], v17 offset:6432
    v_cmp_le_i32 vcc, 0, v51
    s_cbranch_vccz L_idx_okm
    v_and_b32 v3, 7, v1
    v_lshlrev_b32 v3, 2, v3
    s_mov_b32 s72, 0x3a0000
    s_mov_b32 s79, 262144
L_poll_36:
    buffer_load_dword v51, v3, s[8:11], s72 offen sc1
    s_waitcnt vmcnt(0)
    v_cmp_le_i32 vcc, 0, v51
    s_cbranch_vccz L_polldone_37
    s_sleep 2
    s_sub_u32 s79, s79, 1
    s_cmp_lg_u32 s79, 0
    s_cbranch_scc1 L_poll_36
L_polldone_37:
L_idx_okm:
    s_waitcnt lgkmcnt(0)
    s_add_u32 m0, s85, 0
    s_nop 0
    buffer_load_dwordx4 v16, s[12:15], s84 offen lds
    s_add_u32 s84, s84, 55296
    s_add_u32 m0, s85, 1024
    s_nop 0
    buffer_load_dwordx4 v16, s[12:15], s84 offen lds
    s_add_u32 s84, s84, 55296
    s_add_u32 m0, s85, 2048
    s_nop 0
    buffer_load_dwordx4 v16, s[12:15], s84 offen lds
    s_add_u32 s84, s84, 55296
    s_add_u32 m0, s85, 3072
    s_nop 0
    buffer_load_dwordx4 v16, s[12:15], s84 offen lds
    s_add_u32 s84, s84, 55296
    s_add_u32 m0, s85, 4096
    s_nop 0
    buffer_load_dwordx4 v16, s[12:15], s84 offen lds
    s_add_u32 s84, s84, 55296
    s_add_u32 m0, s85, 5120
    s_nop 0
    buffer_load_dwordx4 v16, s[12:15], s84 offen lds
    s_add_u32 s84, s84, 55296
    s_add_u32 m0, s85, 6144
    s_nop 0
    buffer_load_dwordx4 v16, s[12:15], s84 offen lds
    s_add_u32 s84, s84, 55296
    s_add_u32 m0, s85, 7168
    s_nop 0
    buffer_load_dwordx4 v16, s[12:15], s84 offen lds
    s_add_u32 s84, s84, 55296
    v_and_b32 v4, 0x7ff, v51
    v_sub_u32 v4, 0x7ff, v4
    v_mul_u32_u24 v4, 1280, v4
    v_lshrrev_b32 v7, 4, v1
    v_lshl_add_u32 v4, v7, 4, v4
    s_and_b32 s7, s3, 1
    s_mul_i32 s6, s7, 640
    s_add_u32 s6, s6, 12582912
    v_add_u32 v4, s6, v4
    v_mov_b32 v5, 0x4000000
    v_and_b32 v2, 8, v1
    v_cmp_eq_u32 vcc, 0, v2
    s_nop 1
    v_cndmask_b32 v21, v5, v4, vcc
    buffer_load_dwordx4 v[64:67], v21, s[8:11], 0 offen offset:0 sc1
    buffer_load_dwordx4 v[68:71], v21, s[8:11], 0 offen offset:64 sc1
    buffer_load_dwordx4 v[72:75], v21, s[8:11], 0 offen offset:128 sc1
    buffer_load_dwordx4 v[76:79], v21, s[8:11], 0 offen offset:192 sc1
    buffer_load_dwordx4 v[80:83], v21, s[8:11], 0 offen offset:256 sc1
    s_waitcnt vmcnt(5) lgkmcnt(0)
    s_barrier
    s_cmp_lg_u32 s89, 0
    s_cbranch_scc1 L_ldback_38_c
L_ldback_38:
    s_add_i32 s62, s62, 1
    ds_read_b64_tr_b16 v[136:137], v17 offset:0
    ds_read_b64_tr_b16 v[138:139], v17 offset:256
    ds_read_b64_tr_b16 v[140:141], v17 offset:32
    ds_read_b64_tr_b16 v[142:143], v17 offset:288
    ds_read_b64_tr_b16 v[144:145], v17 offset:2048
    ds_read_b64_tr_b16 v[146:147], v17 offset:2304
    ds_read_b64_tr_b16 v[148:149], v17 offset:2080
    ds_read_b64_tr_b16 v[150:151], v17 offset:2336
    s_waitcnt lgkmcnt(0)
    ds_read_b64_tr_b16 v[152:153], v17 offset:4096
    ds_read_b64_tr_b16 v[154:155], v17 offset:4352
    ds_read_b64_tr_b16 v[156:157], v17 offset:4128
    ds_read_b64_tr_b16 v[158:159], v17 offset:4384
    ds_read_b64_tr_b16 v[160:161], v17 offset:6144
    ds_read_b64_tr_b16 v[162:163], v17 offset:6400
    ds_read_b64_tr_b16 v[164:165], v17 offset:6176
    ds_read_b64_tr_b16 v[166:167], v17 offset:6432
    s_waitcnt lgkmcnt(0)
    s_add_u32 m0, s85, 0
    s_nop 0
    buffer_load_dwordx4 v16, s[12:15], s84 offen lds
    s_add_u32 s84, s84, 55296
    s_add_u32 m0, s85, 1024
    s_nop 0
    buffer_load_dwordx4 v16, s[12:15], s84 offen lds
    s_add_u32 s84, s84, 55296
    s_add_u32 m0, s85, 2048
    s_nop 0
    buffer_load_dwordx4 v16, s[12:15], s84 offen lds
    s_add_u32 s84, s84, 55296
    s_add_u32 m0, s85, 3072
    s_nop 0
    buffer_load_dwordx4 v16, s[12:15], s84 offen lds
    s_add_u32 s84, s84, 55296
    s_add_u32 m0, s85, 4096
    s_add_u32 s6, s86, 0
    buffer_load_dwordx4 v18, s[16:19], s6 offen lds
    s_add_u32 m0, s85, 5120
    s_add_u32 s6, s86, 10240
    buffer_load_dwordx4 v18, s[16:19], s6 offen lds
    s_add_u32 m0, s85, 6144
    s_add_u32 s6, s86, 20480
    buffer_load_dwordx4 v18, s[16:19], s6 offen lds
    s_add_u32 m0, s85, 7168
    s_add_u32 s6, s86, 30720
    buffer_load_dwordx4 v18, s[16:19], s6 offen lds
    s_add_u32 s86, s86, 512
    buffer_load_dwordx4 v[84:87], v21, s[8:11], 0 offen offset:320 sc1
    buffer_load_dwordx4 v[88:91], v21, s[8:11], 0 offen offset:384 sc1
    buffer_load_dwordx4 v[92:95], v21, s[8:11], 0 offen offset:448 sc1
    buffer_load_dwordx4 v[96:99], v21, s[8:11], 0 offen offset:512 sc1
    buffer_load_dwordx4 v[100:103], v21, s[8:11], 0 offen offset:576 sc1
    s_waitcnt vmcnt(0) lgkmcnt(0)
    s_barrier
    s_cmp_lg_u32 s89, 0
    s_cbranch_scc1 L_ldback_39_c
L_ldback_39:
    s_add_i32 s62, s62, 1
    ds_read_b64_tr_b16 v[168:169], v17 offset:0
    ds_read_b64_tr_b16 v[170:171], v17 offset:256
    ds_read_b64_tr_b16 v[172:173], v17 offset:32
    ds_read_b64_tr_b16 v[174:175], v17 offset:288
    ds_read_b64_tr_b16 v[176:177], v17 offset:2048
    ds_read_b64_tr_b16 v[178:179], v17 offset:2304
    ds_read_b64_tr_b16 v[180:181], v17 offset:2080
    ds_read_b64_tr_b16 v[182:183], v17 offset:2336
    s_waitcnt lgkmcnt(0)
    ds_read_b64_tr_b16 v[32:33], v19 offset:0
    ds_read_b64_tr_b16 v[34:35], v19 offset:2048
    ds_read_b64_tr_b16 v[36:37], v19 offset:32
    ds_read_b64_tr_b16 v[38:39], v19 offset:2080
    ds_read_b64_tr_b16 v[40:41], v19 offset:64
    ds_read_b64_tr_b16 v[42:43], v19 offset:2112
    ds_read_b64_tr_b16 v[44:45], v19 offset:96
    ds_read_b64_tr_b16 v[46:47], v19 offset:2144
    s_waitcnt lgkmcnt(0)
    s_add_u32 m0, s85, 4096
    s_add_u32 s6, s86, 0
    buffer_load_dwordx4 v18, s[16:19], s6 offen lds
    s_add_u32 m0, s85, 5120
    s_add_u32 s6, s86, 10240
    buffer_load_dwordx4 v18, s[16:19], s6 offen lds
    s_add_u32 m0, s85, 6144
    s_add_u32 s6, s86, 20480
    buffer_load_dwordx4 v18, s[16:19], s6 offen lds
    s_add_u32 m0, s85, 7168
    s_add_u32 s6, s86, 30720
    buffer_load_dwordx4 v18, s[16:19], s6 offen lds
    s_add_u32 s86, s86, 512
    v_mfma_f32_16x16x32_bf16 v[24:27], v[104:107], v[64:67], 0
    v_mfma_f32_16x16x32_bf16 v[28:31], v[108:111], v[64:67], 0
    v_mfma_f32_16x16x32_bf16 v[24:27], v[112:115], v[68:71], v[24:27]
    v_mfma_f32_16x16x32_bf16 v[28:31], v[116:119], v[68:71], v[28:31]
    v_mfma_f32_16x16x32_bf16 v[24:27], v[120:123], v[72:75], v[24:27]
    v_mfma_f32_16x16x32_bf16 v[28:31], v[124:127], v[72:75], v[28:31]
    v_mfma_f32_16x16x32_bf16 v[24:27], v[128:131], v[76:79], v[24:27]
    v_mfma_f32_16x16x32_bf16 v[28:31], v[132:135], v[76:79], v[28:31]
    v_mfma_f32_16x16x32_bf16 v[24:27], v[136:139], v[80:83], v[24:27]
    v_mfma_f32_16x16x32_bf16 v[28:31], v[140:143], v[80:83], v[28:31]
    v_mfma_f32_16x16x32_bf16 v[24:27], v[144:147], v[84:87], v[24:27]
    v_mfma_f32_16x16x32_bf16 v[28:31], v[148:151], v[84:87], v[28:31]
    v_mfma_f32_16x16x32_bf16 v[24:27], v[152:155], v[88:91], v[24:27]
    v_mfma_f32_16x16x32_bf16 v[28:31], v[156:159], v[88:91], v[28:31]
    v_mfma_f32_16x16x32_bf16 v[24:27], v[160:163], v[92:95], v[24:27]
    v_mfma_f32_16x16x32_bf16 v[28:31], v[164:167], v[92:95], v[28:31]
    v_mfma_f32_16x16x32_bf16 v[24:27], v[168:171], v[96:99], v[24:27]
    v_mfma_f32_16x16x32_bf16 v[28:31], v[172:175], v[96:99], v[28:31]
    v_mfma_f32_16x16x32_bf16 v[24:27], v[176:179], v[100:103], v[24:27]
    v_mfma_f32_16x16x32_bf16 v[28:31], v[180:183], v[100:103], v[28:31]
    v_add_u32 v10, s85, v13
    s_nop 7
    ds_write_b128 v10, v[24:27]
    ds_write_b128 v10, v[28:31] offset:1024
    s_waitcnt vmcnt(0) lgkmcnt(0)
    s_barrier
    s_cmp_lg_u32 s89, 0
    s_cbranch_scc1 L_ldback_40_c
L_ldback_40:
    s_add_i32 s62, s62, 1
    v_add_u32 v10, 131072, v13
    ds_read_b128 v[184:187], v10 offset:0
    ds_read_b128 v[188:191], v10 offset:1024
    ds_read_b128 v[192:195], v10 offset:8192
    ds_read_b128 v[196:199], v10 offset:9216
    ds_read_b128 v[200:203], v10 offset:16384
    ds_read_b128 v[204:207], v10 offset:17408
    ds_read_b128 v[208:211], v10 offset:24576
    ds_read_b128 v[212:215], v10 offset:25600
    s_waitcnt lgkmcnt(0)
    ds_read_b64_tr_b16 v[240:241], v19 offset:0
    ds_read_b64_tr_b16 v[242:243], v19 offset:2048
    ds_read_b64_tr_b16 v[244:245], v19 offset:32
    ds_read_b64_tr_b16 v[246:247], v19 offset:2080
    ds_read_b64_tr_b16 v[248:249], v19 offset:64
    ds_read_b64_tr_b16 v[250:251], v19 offset:2112
    ds_read_b64_tr_b16 v[252:253], v19 offset:96
    ds_read_b64_tr_b16 v[254:255], v19 offset:2144
    s_waitcnt lgkmcnt(0)
    s_cmp_ge_u32 s3, 2
    s_cbranch_scc1 L_moe4b
    s_add_u32 m0, s85, 4096
    s_add_u32 s6, s86, 0
    buffer_load_dwordx4 v18, s[16:19], s6 offen lds
    s_add_u32 m0, s85, 5120
    s_add_u32 s6, s86, 10240
    buffer_load_dwordx4 v18, s[16:19], s6 offen lds
    s_add_u32 m0, s85, 6144
    s_add_u32 s6, s86, 20480
    buffer_load_dwordx4 v18, s[16:19], s6 offen lds
    s_add_u32 m0, s85, 7168
    s_add_u32 s6, s86, 30720
    buffer_load_dwordx4 v18, s[16:19], s6 offen lds
    s_add_u32 s86, s86, 512
L_moe4b:
    s_mov_b32 s6, 0xbfb8aa3b
    v_add_f32 v184, v184, v192
    v_add_f32 v200, v200, v208
    v_cvt_pk_bf16_f32 v184, v184, v184
    v_lshlrev_b32 v184, 16, v184
    v_cvt_pk_bf16_f32 v200, v200, v200
    v_lshlrev_b32 v200, 16, v200
    v_mul_f32 v2, s6, v184
    v_exp_f32 v2, v2
    s_nop 0
    v_add_f32 v2, 1.0, v2
    v_rcp_f32 v2, v2
    s_nop 0
    v_mul_f32 v184, v184, v2
    v_cvt_pk_bf16_f32 v184, v184, v184
    v_lshlrev_b32 v184, 16, v184
    v_mul_f32 v184, v184, v200
    v_add_f32 v185, v185, v193
    v_add_f32 v201, v201, v209
    v_cvt_pk_bf16_f32 v185, v185, v185
    v_lshlrev_b32 v185, 16, v185
    v_cvt_pk_bf16_f32 v201, v201, v201
    v_lshlrev_b32 v201, 16, v201
    v_mul_f32 v2, s6, v185
    v_exp_f32 v2, v2
    s_nop 0
    v_add_f32 v2, 1.0, v2
    v_rcp_f32 v2, v2
    s_nop 0
    v_mul_f32 v185, v185, v2
    v_cvt_pk_bf16_f32 v185, v185, v185
    v_lshlrev_b32 v185, 16, v185
    v_mul_f32 v185, v185, v201
    v_add_f32 v186, v186, v194
    v_add_f32 v202, v202, v210
    v_cvt_pk_bf16_f32 v186, v186, v186
    v_lshlrev_b32 v186, 16, v186
    v_cvt_pk_bf16_f32 v202, v202, v202
    v_lshlrev_b32 v202, 16, v202
    v_mul_f32 v2, s6, v186
    v_exp_f32 v2, v2
    s_nop 0
    v_add_f32 v2, 1.0, v2
    v_rcp_f32 v2, v2
    s_nop 0
    v_mul_f32 v186, v186, v2
    v_cvt_pk_bf16_f32 v186, v186, v186
    v_lshlrev_b32 v186, 16, v186
    v_mul_f32 v186, v186, v202
    v_add_f32 v187, v187, v195
    v_add_f32 v203, v203, v211
    v_cvt_pk_bf16_f32 v187, v187, v187
    v_lshlrev_b32 v187, 16, v187
    v_cvt_pk_bf16_f32 v203, v203, v203
    v_lshlrev_b32 v203, 16, v203
    v_mul_f32 v2, s6, v187
    v_exp_f32 v2, v2
    s_nop 0
    v_add_f32 v2, 1.0, v2
    v_rcp_f32 v2, v2
    s_nop 0
    v_mul_f32 v187, v187, v2
    v_cvt_pk_bf16_f32 v187, v187, v187
    v_lshlrev_b32 v187, 16, v187
    v_mul_f32 v187, v187, v203
    v_add_f32 v188, v188, v196
    v_add_f32 v204, v204, v212
    v_cvt_pk_bf16_f32 v188, v188, v188
    v_lshlrev_b32 v188, 16, v188
    v_cvt_pk_bf16_f32 v204, v204, v204
    v_lshlrev_b32 v204, 16, v204
    v_mul_f32 v2, s6, v188
    v_exp_f32 v2, v2
    s_nop 0
    v_add_f32 v2, 1.0, v2
    v_rcp_f32 v2, v2
    s_nop 0
    v_mul_f32 v188, v188, v2
    v_cvt_pk_bf16_f32 v188, v188, v188
    v_lshlrev_b32 v188, 16, v188
    v_mul_f32 v188, v188, v204
    v_add_f32 v189, v189, v197
    v_add_f32 v205, v205, v213
    v_cvt_pk_bf16_f32 v189, v189, v189
    v_lshlrev_b32 v189, 16, v189
    v_cvt_pk_bf16_f32 v205, v205, v205
    v_lshlrev_b32 v205, 16, v205
    v_mul_f32 v2, s6, v189
    v_exp_f32 v2, v2
    s_nop 0
    v_add_f32 v2, 1.0, v2
    v_rcp_f32 v2, v2
    s_nop 0
    v_mul_f32 v189, v189, v2
    v_cvt_pk_bf16_f32 v189, v189, v189
    v_lshlrev_b32 v189, 16, v189
    v_mul_f32 v189, v189, v205
    v_add_f32 v190, v190, v198
    v_add_f32 v206, v206, v214
    v_cvt_pk_bf16_f32 v190, v190, v190
    v_lshlrev_b32 v190, 16, v190
    v_cvt_pk_bf16_f32 v206, v206, v206
    v_lshlrev_b32 v206, 16, v206
    v_mul_f32 v2, s6, v190
    v_exp_f32 v2, v2
    s_nop 0
    v_add_f32 v2, 1.0, v2
    v_rcp_f32 v2, v2
    s_nop 0
    v_mul_f32 v190, v190, v2
    v_cvt_pk_bf16_f32 v190, v190, v190
    v_lshlrev_b32 v190, 16, v190
    v_mul_f32 v190, v190, v206
    v_add_f32 v191, v191, v199
    v_add_f32 v207, v207, v215
    v_cvt_pk_bf16_f32 v191, v191, v191
    v_lshlrev_b32 v191, 16, v191
    v_cvt_pk_bf16_f32 v207, v207, v207
    v_lshlrev_b32 v207, 16, v207
    v_mul_f32 v2, s6, v191
    v_exp_f32 v2, v2
    s_nop 0
    v_add_f32 v2, 1.0, v2
    v_rcp_f32 v2, v2
    s_nop 0
    v_mul_f32 v191, v191, v2
    v_cvt_pk_bf16_f32 v191, v191, v191
    v_lshlrev_b32 v191, 16, v191
    v_mul_f32 v191, v191, v207
    v_cvt_pk_bf16_f32 v24, v184, v185
    v_cvt_pk_bf16_f32 v25, v186, v187
    v_cvt_pk_bf16_f32 v26, v188, v189
    v_cvt_pk_bf16_f32 v27, v190, v191
    s_nop 1
    v_mfma_f32_16x16x32_bf16 v[216:219], v[32:35], v[24:27], 0
    v_mfma_f32_16x16x32_bf16 v[220:223], v[36:39], v[24:27], 0
    v_mfma_f32_16x16x32_bf16 v[224:227], v[40:43], v[24:27], 0
    v_mfma_f32_16x16x32_bf16 v[228:231], v[44:47], v[24:27], 0
    s_nop 7
    buffer_store_dwordx4 v[216:219], v20, s[8:11], s87 offen offset:0 sc1
    buffer_store_dwordx4 v[220:223], v20, s[8:11], s87 offen offset:64 sc1
    buffer_store_dwordx4 v[224:227], v20, s[8:11], s87 offen offset:128 sc1
    buffer_store_dwordx4 v[228:231], v20, s[8:11], s87 offen offset:192 sc1
    s_nop 1
    s_waitcnt vmcnt(4) lgkmcnt(0)
    s_barrier
    s_cmp_lg_u32 s89, 0
    s_cbranch_scc1 L_ldback_41_c
L_ldback_41:
    s_add_i32 s62, s62, 1
    v_mfma_f32_16x16x32_bf16 v[216:219], v[240:243], v[24:27], 0
    v_mfma_f32_16x16x32_bf16 v[220:223], v[244:247], v[24:27], 0
    v_mfma_f32_16x16x32_bf16 v[224:227], v[248:251], v[24:27], 0
    v_mfma_f32_16x16x32_bf16 v[228:231], v[252:255], v[24:27], 0
    s_nop 7
    buffer_store_dwordx4 v[216:219], v20, s[8:11], s87 offen offset:1024 sc1
    buffer_store_dwordx4 v[220:223], v20, s[8:11], s87 offen offset:1088 sc1
    buffer_store_dwordx4 v[224:227], v20, s[8:11], s87 offen offset:1152 sc1
    buffer_store_dwordx4 v[228:231], v20, s[8:11], s87 offen offset:1216 sc1
    s_nop 1
    s_cmp_ge_u32 s3, 2
    s_cbranch_scc1 L_moe5b
    ds_read_b64_tr_b16 v[32:33], v19 offset:0
    ds_read_b64_tr_b16 v[34:35], v19 offset:2048
    ds_read_b64_tr_b16 v[36:37], v19 offset:32
    ds_read_b64_tr_b16 v[38:39], v19 offset:2080
    ds_read_b64_tr_b16 v[40:41], v19 offset:64
    ds_read_b64_tr_b16 v[42:43], v19 offset:2112
    ds_read_b64_tr_b16 v[44:45], v19 offset:96
    ds_read_b64_tr_b16 v[46:47], v19 offset:2144
    s_waitcnt lgkmcnt(0)
    v_mfma_f32_16x16x32_bf16 v[216:219], v[32:35], v[24:27], 0
    v_mfma_f32_16x16x32_bf16 v[220:223], v[36:39], v[24:27], 0
    v_mfma_f32_16x16x32_bf16 v[224:227], v[40:43], v[24:27], 0
    v_mfma_f32_16x16x32_bf16 v[228:231], v[44:47], v[24:27], 0
    s_nop 7
    buffer_store_dwordx4 v[216:219], v20, s[8:11], s87 offen offset:2048 sc1
    buffer_store_dwordx4 v[220:223], v20, s[8:11], s87 offen offset:2112 sc1
    buffer_store_dwordx4 v[224:227], v20, s[8:11], s87 offen offset:2176 sc1
    buffer_store_dwordx4 v[228:231], v20, s[8:11], s87 offen offset:2240 sc1
    s_nop 1
L_moe5b:
    s_waitcnt vmcnt(4) lgkmcnt(0)
    s_barrier
    s_waitcnt vmcnt(0)
    s_lshl_b32 s6, s61, 3
    s_add_u32 s6, s6, s3
    s_lshl_b32 s6, s6, 2
    s_add_u32 s6, s6, 3825664
    v_mov_b32 v2, 1
    v_mov_b32 v3, 0x4000000
    v_writelane_b32 v3, s6, 0
    buffer_store_dword v2, v3, s[8:11], 0 offen sc1
    s_cmp_lg_u32 s89, 0
    s_cbranch_scc1 L_ldback_42_c
L_ldback_42:
    s_add_i32 s62, s62, 1
    s_branch L_idle
L_top1:
    s_lshl_b32 s6, s3, 11
    s_add_u32 s6, s6, 2621440
    buffer_load_dwordx4 v[16:19], v13, s[8:11], s6 offen sc1
    buffer_load_dwordx4 v[20:23], v13, s[8:11], s6 offen offset:1024 sc1
    s_waitcnt vmcnt(0)
    v_mov_b32 v24, 0
    s_mov_b32 s7, 0
L_top1_l:
    v_max3_u32 v4, v16, v17, v18
    v_max3_u32 v4, v4, v19, v20
    v_max3_u32 v4, v4, v21, v22
    v_max_u32 v4, v4, v23
    s_nop 1
    v_max_u32_dpp v4, v4, v4 quad_perm:[1,0,3,2] row_mask:0xf bank_mask:0xf
    s_nop 1
    v_max_u32_dpp v4, v4, v4 quad_perm:[2,3,0,1] row_mask:0xf bank_mask:0xf
    s_nop 1
    v_max_u32_dpp v4, v4, v4 row_half_mirror row_mask:0xf bank_mask:0xf
    s_nop 1
    v_max_u32_dpp v4, v4, v4 row_mirror row_mask:0xf bank_mask:0xf
    s_nop 1
    v_max_u32_dpp v4, v4, v4 row_bcast:15 row_mask:0xa bank_mask:0xf
    s_nop 1
    v_max_u32_dpp v4, v4, v4 row_bcast:31 row_mask:0xc bank_mask:0xf
    s_nop 1
    v_readlane_b32 s6, v4, 63
    s_mov_b32 m0, s7
    s_nop 3
    v_writelane_b32 v24, s6, m0
    v_cmp_ne_u32 vcc, s6, v16
    s_nop 1
    v_cndmask_b32 v16, 0, v16, vcc
    v_cmp_ne_u32 vcc, s6, v17
    s_nop 1
    v_cndmask_b32 v17, 0, v17, vcc
    v_cmp_ne_u32 vcc, s6, v18
    s_nop 1
    v_cndmask_b32 v18, 0, v18, vcc
    v_cmp_ne_u32 vcc, s6, v19
    s_nop 1
    v_cndmask_b32 v19, 0, v19, vcc
    v_cmp_ne_u32 vcc, s6, v20
    s_nop 1
    v_cndmask_b32 v20, 0, v20, vcc
    v_cmp_ne_u32 vcc, s6, v21
    s_nop 1
    v_cndmask_b32 v21, 0, v21, vcc
    v_cmp_ne_u32 vcc, s6, v22
    s_nop 1
    v_cndmask_b32 v22, 0, v22, vcc
    v_cmp_ne_u32 vcc, s6, v23
    s_nop 1
    v_cndmask_b32 v23, 0, v23, vcc
    s_add_u32 s7, s7, 1
    s_cmp_lt_u32 s7, 8
    s_cbranch_scc1 L_top1_l
    s_lshl_b32 s6, s3, 8
    s_add_u32 s6, s6, 131072
    v_lshl_add_u32 v5, v1, 2, s6
    ds_write_b32 v5, v24
    s_branch L_idle
L_top2:
    s_cmp_lg_u32 s3, 0
    s_cbranch_scc1 L_idle
    v_lshrrev_b32 v5, 3, v1
    v_and_b32 v5, 3, v5
    v_lshlrev_b32 v5, 6, v5
    v_and_b32 v6, 39, v1
    v_add_u32 v5, v5, v6
    v_lshlrev_b32 v5, 2, v5
    v_add_u32 v5, 131072, v5
    ds_read_b32 v16, v5
    s_waitcnt lgkmcnt(0)
    v_mov_b32 v24, 0
    s_mov_b32 s7, 0
L_top2_l:
    v_mov_b32 v4, v16
    s_nop 1
    v_max_u32_dpp v4, v4, v4 quad_perm:[1,0,3,2] row_mask:0xf bank_mask:0xf
    s_nop 1
    v_max_u32_dpp v4, v4, v4 quad_perm:[2,3,0,1] row_mask:0xf bank_mask:0xf
    s_nop 1
    v_max_u32_dpp v4, v4, v4 row_half_mirror row_mask:0xf bank_mask:0xf
    s_nop 1
    v_max_u32_dpp v4, v4, v4 row_mirror row_mask:0xf bank_mask:0xf
    s_nop 1
    v_max_u32_dpp v4, v4, v4 row_bcast:15 row_mask:0xa bank_mask:0xf
    s_nop 1
    v_max_u32_dpp v4, v4, v4 row_bcast:31 row_mask:0xc bank_mask:0xf
    s_nop 1
    v_readlane_b32 s6, v4, 63
    s_mov_b32 m0, s7
    s_nop 3
    v_writelane_b32 v24, s6, m0
    v_cmp_ne_u32 vcc, s6, v16
    s_nop 1
    v_cndmask_b32 v16, 0, v16, vcc
    s_add_u32 s7, s7, 1
    s_cmp_lt_u32 s7, 8
    s_cbranch_scc1 L_top2_l
    v_or_b32 v24, 0x80000000, v24
    v_lshlrev_b32 v5, 2, v1
    v_mov_b32 v6, 0x4000000
    v_cmp_gt_u32 vcc, 8, v1
    s_mov_b32 s6, 0x3a0000
    s_nop 0
    v_cndmask_b32 v5, v6, v5, vcc
    buffer_store_dword v24, v5, s[8:11], s6 offen sc1
    s_branch L_idle
L_ldback_13_c:
    s_call_b64 s[82:83], L_load
    s_branch L_ldback_13
L_back_14_h:
    v_cmp_nge_f32 vcc, s72, v62
    s_cbranch_vccz L_back_14_n
    s_call_b64 s[80:81], L_rare0
L_back_14_n:
    s_branch L_back_14
L_back_15_h:
    v_cmp_nge_f32 vcc, s72, v62
    s_cbranch_vccz L_back_15_n
    s_call_b64 s[80:81], L_rare1
    v_exp_f32 v58, v64
    v_exp_f32 v59, v65
    s_nop 0
    v_add_f32 v52, v58, v59
    v_cvt_pk_bf16_f32 v128, v58, v59
L_back_15_n:
    s_cmp_lt_i32 s64, 0
    s_cbranch_scc1 L_tail1
    s_cmp_gt_i32 s64, 0
    s_cbranch_scc1 L_back_15
    s_call_b64 s[82:83], L_mask
    s_branch L_back_15
L_back_16_h:
    v_cmp_nge_f32 vcc, s72, v62
    s_cbranch_vccz L_back_16_n
    s_call_b64 s[80:81], L_rare0
    v_exp_f32 v58, v80
    v_exp_f32 v59, v81
    s_nop 0
    v_add_f32 v54, v58, v59
    v_cvt_pk_bf16_f32 v136, v58, v59
L_back_16_n:
    s_cmp_lt_i32 s64, 0
    s_cbranch_scc1 L_tail2
    s_cmp_gt_i32 s64, 0
    s_cbranch_scc1 L_back_16
    s_call_b64 s[82:83], L_mask
    s_branch L_back_16
L_back_17_h:
    v_cmp_nge_f32 vcc, s72, v62
    s_cbranch_vccz L_back_17_n
    s_call_b64 s[80:81], L_rare1
    v_exp_f32 v58, v64
    v_exp_f32 v59, v65
    s_nop 0
    v_add_f32 v52, v58, v59
    v_cvt_pk_bf16_f32 v128, v58, v59
L_back_17_n:
    s_cmp_lt_i32 s64, 0
    s_cbranch_scc1 L_tail3
    s_cmp_gt_i32 s64, 0
    s_cbranch_scc1 L_back_17
    s_call_b64 s[82:83], L_mask
    s_branch L_back_17
L_ldback_18_c:
    s_call_b64 s[82:83], L_load
    s_branch L_ldback_18
L_back_19_h:
    v_cmp_nge_f32 vcc, s72, v62
    s_cbranch_vccz L_back_19_n
    s_call_b64 s[80:81], L_rare0
    v_exp_f32 v58, v80
    v_exp_f32 v59, v81
    s_nop 0
    v_add_f32 v54, v58, v59
    v_cvt_pk_bf16_f32 v136, v58, v59
L_back_19_n:
    s_cmp_lt_i32 s64, 0
    s_cbranch_scc1 L_tail0
    s_cmp_gt_i32 s64, 0
    s_cbranch_scc1 L_back_19
    s_call_b64 s[82:83], L_mask
    s_branch L_back_19
L_back_20_h:
    v_cmp_nge_f32 vcc, s72, v62
    s_cbranch_vccz L_back_20_n
    s_call_b64 s[80:81], L_rare1
L_back_20_n:
    s_branch L_back_20
L_back_21_h:
    v_cmp_nge_f32 vcc, s72, v62
    s_cbranch_vccz L_back_21_n
    s_call_b64 s[80:81], L_rare0
L_back_21_n:
    s_branch L_back_21
L_back_22_h:
    v_cmp_nge_f32 vcc, s72, v62
    s_cbranch_vccz L_back_22_n
    s_call_b64 s[80:81], L_rare1
L_back_22_n:
    s_branch L_back_22
L_ldback_23_c:
    s_call_b64 s[82:83], L_load
    s_branch L_ldback_23
L_ldback_24_c:
    s_call_b64 s[82:83], L_load
    s_branch L_ldback_24
L_back_25_h:
    v_cmp_nge_f32 vcc, s72, v62
    s_cbranch_vccz L_back_25_n
    s_call_b64 s[80:81], L_rare0
L_back_25_n:
    s_branch L_back_25
L_ldback_26_c:
    s_call_b64 s[82:83], L_load
    s_branch L_ldback_26
L_ldback_27_c:
    s_call_b64 s[82:83], L_load
    s_branch L_ldback_27
L_ldback_28_c:
    s_call_b64 s[82:83], L_load
    s_branch L_ldback_28
L_ldback_29_c:
    s_call_b64 s[82:83], L_load
    s_branch L_ldback_29
L_ldback_30_c:
    s_call_b64 s[82:83], L_load
    s_branch L_ldback_30
L_ldback_35_c:
    s_call_b64 s[82:83], L_load
    s_branch L_ldback_35
L_ldback_38_c:
    s_call_b64 s[82:83], L_load
    s_branch L_ldback_38
L_ldback_39_c:
    s_call_b64 s[82:83], L_load
    s_branch L_ldback_39
L_ldback_40_c:
    s_call_b64 s[82:83], L_load
    s_branch L_ldback_40
L_ldback_41_c:
    s_call_b64 s[82:83], L_load
    s_branch L_ldback_41
L_ldback_42_c:
    s_call_b64 s[82:83], L_load
    s_branch L_ldback_42
L_load:
    s_bitcmp1_b32 s89, 0
    s_cbranch_scc0 L_load_r
    s_add_u32 s77, s77, 32768
    s_xor_b32 s78, s78, 0x10000
    s_add_i32 s73, s62, 1
    s_cmp_gt_i32 s73, s63
    s_cbranch_scc1 L_load_r
    s_cmp_eq_i32 s73, s63
    s_cbranch_scc1 L_load_v
    s_bitcmp1_b32 s73, 0
    s_cbranch_scc0 L_load_k
    s_lshl_b32 s74, s73, 2
    s_add_u32 s74, s74, 12
    s_cmp_ge_u32 s90, s74
    s_cbranch_scc1 L_kvpd_44
    s_lshl_b32 s7, s4, 10
    s_add_u32 s7, s7, 3866624
    v_lshrrev_b32 v2, 3, v1
    v_and_b32 v3, 7, v1
    v_lshlrev_b32 v3, 2, v3
    v_lshl_add_u32 v3, v2, 7, v3
    s_mov_b32 s79, 262144
L_kvp_43:
    buffer_load_dword v2, v3, s[8:11], s7 offen sc1
    s_waitcnt vmcnt(0)
    v_cmp_ne_u32 vcc, 1, v2
    s_nop 3
    s_ff1_i32_b64 s90, vcc
    s_cmp_ge_u32 s90, s74
    s_cbranch_scc1 L_kvpd_44
    s_sleep 2
    s_sub_u32 s79, s79, 1
    s_cmp_lg_u32 s79, 0
    s_cbranch_scc1 L_kvp_43
L_kvpd_44:
L_load_k:
    s_lshl_b32 s6, s76, 13
    s_add_u32 s6, s6, s78
    s_add_u32 m0, s6, 0
    s_add_u32 s7, s77, 0
    buffer_load_dwordx4 v49, s[8:11], s7 offen offset:0 sc1 lds
    buffer_load_dwordx4 v49, s[8:11], s7 offen offset:1024 sc1 lds
    buffer_load_dwordx4 v49, s[8:11], s7 offen offset:2048 sc1 lds
    buffer_load_dwordx4 v49, s[8:11], s7 offen offset:3072 sc1 lds
    s_lshl_b32 s6, s76, 13
    s_add_u32 s6, s6, s78
    s_add_u32 m0, s6, 4096
    s_add_u32 s7, s77, 4096
    buffer_load_dwordx4 v49, s[8:11], s7 offen offset:0 sc1 lds
    buffer_load_dwordx4 v49, s[8:11], s7 offen offset:1024 sc1 lds
    buffer_load_dwordx4 v49, s[8:11], s7 offen offset:2048 sc1 lds
    buffer_load_dwordx4 v49, s[8:11], s7 offen offset:3072 sc1 lds
    s_lshl_b32 s6, s76, 12
    s_add_u32 s6, s6, s78
    s_add_u32 m0, s6, 49152
    s_add_u32 s7, s77, 524288
    buffer_load_dwordx4 v50, s[8:11], s7 offen offset:0 sc1 lds
    buffer_load_dwordx4 v50, s[8:11], s7 offen offset:1024 sc1 lds
    buffer_load_dwordx4 v50, s[8:11], s7 offen offset:2048 sc1 lds
    buffer_load_dwordx4 v50, s[8:11], s7 offen offset:3072 sc1 lds
L_load_v:
    s_lshl_b32 s6, s76, 12
    s_add_u32 s6, s6, s78
    s_add_u32 m0, s6, 32768
    s_add_u32 s7, s77, 507904
    buffer_load_dwordx4 v50, s[8:11], s7 offen offset:0 sc1 lds
    buffer_load_dwordx4 v50, s[8:11], s7 offen offset:1024 sc1 lds
    buffer_load_dwordx4 v50, s[8:11], s7 offen offset:2048 sc1 lds
    buffer_load_dwordx4 v50, s[8:11], s7 offen offset:3072 sc1 lds
    s_cmp_lt_u32 s5, 4
    s_cbranch_scc1 L_load_r
    s_sub_i32 s79, s73, 2
    s_cmp_lt_u32 s79, 2
    s_cbranch_scc1 L_x3
L_load_r:
    s_bitcmp1_b32 s89, 1
    s_cbranch_scc0 L_load_a
    s_cmp_lt_i32 s62, 0
    s_cbranch_scc1 L_load_a
    s_lshl_b32 s6, s4, 3
    s_add_u32 s6, s6, s5
    s_lshl_b32 s6, s6, 5
    s_add_u32 s6, s6, s3
    s_lshl_b32 s6, s6, 2
    s_add_u32 s6, s6, 3866624
    v_mov_b32 v2, 1
    v_mov_b32 v3, 0x4000000
    v_writelane_b32 v3, s6, 0
    buffer_store_dword v2, v3, s[8:11], 0 offen sc1
    s_and_b32 s89, s89, 1
L_load_a:
    s_setpc_b64 s[82:83]
L_x3:
    s_mov_b32 s12, s48
    s_mov_b32 s13, s49
    s_mov_b32 s14, 0x21c000
    s_mov_b32 s15, 0x20000
    s_cmp_eq_u32 s3, 3
    s_cbranch_scc1 L_load_r
    s_cmp_eq_u32 s3, 1
    s_cselect_b32 s12, s50, s12
    s_cselect_b32 s13, s51, s13
    s_cmp_eq_u32 s3, 2
    s_cselect_b32 s12, s52, s12
    s_cselect_b32 s13, s53, s13
    s_mov_b32 s73, 3456
    s_cmov_b32 s73, 256
    s_mov_b32 s75, 256
    s_cmov_b32 s75, 163840
    s_lshr_b32 s6, s2, 3
    s_sub_u32 s6, s6, 16
    s_mul_i32 s6, s6, 40
    v_lshrrev_b32 v2, 2, v1
    v_add_u32 v2, s6, v2
    v_mul_lo_u32 v2, v2, s73
    v_and_b32 v3, 3, v1
    v_lshl_add_u32 v2, v3, 6, v2
    s_lshl_b32 s6, s79, 3
    s_lshr_b32 s7, s4, 2
    s_add_u32 s6, s6, s7
    s_mul_i32 s6, s6, s75
    v_mov_b32 v3, 0x4000000
    v_cmp_gt_u32 vcc, 32, v1
    s_lshl_b32 s73, s73, 4
    s_nop 0
    v_cndmask_b32 v3, v3, v2, vcc
    buffer_load_dword v11, v2, s[12:15], s6 offen
    s_add_u32 s7, s6, s73
    buffer_load_dword v11, v2, s[12:15], s7 offen
    s_add_u32 s7, s7, s73
    buffer_load_dword v11, v3, s[12:15], s7 offen
    s_setpc_b64 s[82:83]
L_mask:
    v_and_b32 v2, 15, v1
    v_lshrrev_b32 v3, 4, v1
    v_lshlrev_b32 v3, 2, v3
    v_sub_u32 v2, v2, v3
    v_mov_b32 v3, 0xff800000
    v_cmp_gt_i32 vcc, 0, v2
    v_mov_b32 v152, v3
    s_nop 0
    v_cndmask_b32 v144, v144, v3, vcc
    v_cndmask_b32 v156, v156, v3, vcc
    v_cmp_gt_i32 vcc, 1, v2
    v_mov_b32 v153, v3
    s_nop 0
    v_cndmask_b32 v145, v145, v3, vcc
    v_cndmask_b32 v157, v157, v3, vcc
    v_cmp_gt_i32 vcc, 2, v2
    v_mov_b32 v154, v3
    s_nop 0
    v_cndmask_b32 v146, v146, v3, vcc
    v_cndmask_b32 v158, v158, v3, vcc
    v_cmp_gt_i32 vcc, 3, v2
    v_mov_b32 v155, v3
    s_nop 0
    v_cndmask_b32 v147, v147, v3, vcc
    v_cndmask_b32 v159, v159, v3, vcc
    s_nop 1
    s_setpc_b64 s[82:83]
L_rare0:
    s_nop 15
    v_max3_f32 v62, 0, v64, v65
    v_max3_f32 v62, v62, v66, v67
    v_max3_f32 v62, v62, v72, v73
    v_max3_f32 v62, v62, v74, v75
    v_mov_b32 v58, v62
    s_nop 1
    v_permlane16_swap_b32 v62, v58
    s_nop 1
    v_max_f32 v62, v62, v58
    v_mov_b32 v58, v62
    s_nop 1
    v_permlane32_swap_b32 v62, v58
    s_nop 1
    v_max_f32 v62, v62, v58
    v_exp_f32 v58, -v62
    v_sub_f32 v64, v64, v62
    v_sub_f32 v80, v80, v62
    v_sub_f32 v144, v144, v62
    v_sub_f32 v65, v65, v62
    v_sub_f32 v81, v81, v62
    v_sub_f32 v145, v145, v62
    v_sub_f32 v66, v66, v62
    v_sub_f32 v82, v82, v62
    v_sub_f32 v146, v146, v62
    v_sub_f32 v67, v67, v62
    v_sub_f32 v83, v83, v62
    v_sub_f32 v147, v147, v62
    v_sub_f32 v72, v72, v62
    v_sub_f32 v88, v88, v62
    v_sub_f32 v152, v152, v62
    v_sub_f32 v73, v73, v62
    v_sub_f32 v89, v89, v62
    v_sub_f32 v153, v153, v62
    v_sub_f32 v74, v74, v62
    v_sub_f32 v90, v90, v62
    v_sub_f32 v154, v154, v62
    v_sub_f32 v75, v75, v62
    v_sub_f32 v91, v91, v62
    v_sub_f32 v155, v155, v62
    v_mul_f32 v56, v58, v56
    v_mul_f32 v192, v58, v192
    v_mul_f32 v193, v58, v193
    v_mul_f32 v194, v58, v194
    v_mul_f32 v195, v58, v195
    v_mul_f32 v200, v58, v200
    v_mul_f32 v201, v58, v201
    v_mul_f32 v202, v58, v202
    v_mul_f32 v203, v58, v203
    v_mul_f32 v208, v58, v208
    v_mul_f32 v209, v58, v209
    v_mul_f32 v210, v58, v210
    v_mul_f32 v211, v58, v211
    v_mul_f32 v216, v58, v216
    v_mul_f32 v217, v58, v217
    v_mul_f32 v218, v58, v218
    v_mul_f32 v219, v58, v219
    v_mul_f32 v224, v58, v224
    v_mul_f32 v225, v58, v225
    v_mul_f32 v226, v58, v226
    v_mul_f32 v227, v58, v227
    v_mul_f32 v232, v58, v232
    v_mul_f32 v233, v58, v233
    v_mul_f32 v234, v58, v234
    v_mul_f32 v235, v58, v235
    v_mul_f32 v240, v58, v240
    v_mul_f32 v241, v58, v241
    v_mul_f32 v242, v58, v242
    v_mul_f32 v243, v58, v243
    v_mul_f32 v248, v58, v248
    v_mul_f32 v249, v58, v249
    v_mul_f32 v250, v58, v250
    v_mul_f32 v251, v58, v251
    v_max3_f32 v62, 0, v68, v69
    v_max3_f32 v62, v62, v70, v71
    v_max3_f32 v62, v62, v76, v77
    v_max3_f32 v62, v62, v78, v79
    v_mov_b32 v58, v62
    s_nop 1
    v_permlane16_swap_b32 v62, v58
    s_nop 1
    v_max_f32 v62, v62, v58
    v_mov_b32 v58, v62
    s_nop 1
    v_permlane32_swap_b32 v62, v58
    s_nop 1
    v_max_f32 v62, v62, v58
    v_exp_f32 v58, -v62
    v_sub_f32 v68, v68, v62
    v_sub_f32 v84, v84, v62
    v_sub_f32 v148, v148, v62
    v_sub_f32 v69, v69, v62
    v_sub_f32 v85, v85, v62
    v_sub_f32 v149, v149, v62
    v_sub_f32 v70, v70, v62
    v_sub_f32 v86, v86, v62
    v_sub_f32 v150, v150, v62
    v_sub_f32 v71, v71, v62
    v_sub_f32 v87, v87, v62
    v_sub_f32 v151, v151, v62
    v_sub_f32 v76, v76, v62
    v_sub_f32 v92, v92, v62
    v_sub_f32 v156, v156, v62
    v_sub_f32 v77, v77, v62
    v_sub_f32 v93, v93, v62
    v_sub_f32 v157, v157, v62
    v_sub_f32 v78, v78, v62
    v_sub_f32 v94, v94, v62
    v_sub_f32 v158, v158, v62
    v_sub_f32 v79, v79, v62
    v_sub_f32 v95, v95, v62
    v_sub_f32 v159, v159, v62
    v_mul_f32 v57, v58, v57
    v_mul_f32 v196, v58, v196
    v_mul_f32 v197, v58, v197
    v_mul_f32 v198, v58, v198
    v_mul_f32 v199, v58, v199
    v_mul_f32 v204, v58, v204
    v_mul_f32 v205, v58, v205
    v_mul_f32 v206, v58, v206
    v_mul_f32 v207, v58, v207
    v_mul_f32 v212, v58, v212
    v_mul_f32 v213, v58, v213
    v_mul_f32 v214, v58, v214
    v_mul_f32 v215, v58, v215
    v_mul_f32 v220, v58, v220
    v_mul_f32 v221, v58, v221
    v_mul_f32 v222, v58, v222
    v_mul_f32 v223, v58, v223
    v_mul_f32 v228, v58, v228
    v_mul_f32 v229, v58, v229
    v_mul_f32 v230, v58, v230
    v_mul_f32 v231, v58, v231
    v_mul_f32 v236, v58, v236
    v_mul_f32 v237, v58, v237
    v_mul_f32 v238, v58, v238
    v_mul_f32 v239, v58, v239
    v_mul_f32 v244, v58, v244
    v_mul_f32 v245, v58, v245
    v_mul_f32 v246, v58, v246
    v_mul_f32 v247, v58, v247
    v_mul_f32 v252, v58, v252
    v_mul_f32 v253, v58, v253
    v_mul_f32 v254, v58, v254
    v_mul_f32 v255, v58, v255
    v_exp_f32 v58, v64
    s_nop 0
    v_exp_f32 v59, v65
    s_nop 0
    v_add_f32 v52, v58, v59
    v_cvt_pk_bf16_f32 v128, v58, v59
    v_exp_f32 v60, v66
    s_nop 0
    v_add_f32 v52, v60, v52
    v_exp_f32 v61, v67
    s_nop 0
    v_add_f32 v52, v61, v52
    v_cvt_pk_bf16_f32 v129, v60, v61
    v_exp_f32 v58, v68
    s_nop 0
    v_exp_f32 v59, v69
    s_nop 0
    v_add_f32 v53, v58, v59
    v_cvt_pk_bf16_f32 v132, v58, v59
    v_exp_f32 v60, v70
    s_nop 0
    v_add_f32 v53, v60, v53
    v_exp_f32 v61, v71
    s_nop 0
    v_add_f32 v53, v61, v53
    v_cvt_pk_bf16_f32 v133, v60, v61
    v_exp_f32 v58, v72
    s_nop 0
    v_add_f32 v52, v58, v52
    v_exp_f32 v59, v73
    s_nop 0
    v_add_f32 v52, v59, v52
    v_cvt_pk_bf16_f32 v130, v58, v59
    v_exp_f32 v60, v74
    s_nop 0
    v_add_f32 v52, v60, v52
    v_exp_f32 v61, v75
    s_nop 0
    v_add_f32 v52, v61, v52
    v_cvt_pk_bf16_f32 v131, v60, v61
    v_exp_f32 v58, v76
    s_nop 0
    v_add_f32 v53, v58, v53
    v_exp_f32 v59, v77
    s_nop 0
    v_add_f32 v53, v59, v53
    v_cvt_pk_bf16_f32 v134, v58, v59
    v_exp_f32 v60, v78
    s_nop 0
    v_add_f32 v53, v60, v53
    v_exp_f32 v61, v79
    s_nop 0
    v_add_f32 v53, v61, v53
    v_cvt_pk_bf16_f32 v135, v60, v61
    s_nop 1
    s_setpc_b64 s[80:81]
L_rare1:
    s_nop 15
    v_max3_f32 v62, 0, v80, v81
    v_max3_f32 v62, v62, v82, v83
    v_max3_f32 v62, v62, v88, v89
    v_max3_f32 v62, v62, v90, v91
    v_mov_b32 v58, v62
    s_nop 1
    v_permlane16_swap_b32 v62, v58
    s_nop 1
    v_max_f32 v62, v62, v58
    v_mov_b32 v58, v62
    s_nop 1
    v_permlane32_swap_b32 v62, v58
    s_nop 1
    v_max_f32 v62, v62, v58
    v_exp_f32 v58, -v62
    v_sub_f32 v64, v64, v62
    v_sub_f32 v80, v80, v62
    v_sub_f32 v144, v144, v62
    v_sub_f32 v65, v65, v62
    v_sub_f32 v81, v81, v62
    v_sub_f32 v145, v145, v62
    v_sub_f32 v66, v66, v62
    v_sub_f32 v82, v82, v62
    v_sub_f32 v146, v146, v62
    v_sub_f32 v67, v67, v62
    v_sub_f32 v83, v83, v62
    v_sub_f32 v147, v147, v62
    v_sub_f32 v72, v72, v62
    v_sub_f32 v88, v88, v62
    v_sub_f32 v152, v152, v62
    v_sub_f32 v73, v73, v62
    v_sub_f32 v89, v89, v62
    v_sub_f32 v153, v153, v62
    v_sub_f32 v74, v74, v62
    v_sub_f32 v90, v90, v62
    v_sub_f32 v154, v154, v62
    v_sub_f32 v75, v75, v62
    v_sub_f32 v91, v91, v62
    v_sub_f32 v155, v155, v62
    v_mul_f32 v56, v58, v56
    v_mul_f32 v192, v58, v192
    v_mul_f32 v193, v58, v193
    v_mul_f32 v194, v58, v194
    v_mul_f32 v195, v58, v195
    v_mul_f32 v200, v58, v200
    v_mul_f32 v201, v58, v201
    v_mul_f32 v202, v58, v202
    v_mul_f32 v203, v58, v203
    v_mul_f32 v208, v58, v208
    v_mul_f32 v209, v58, v209
    v_mul_f32 v210, v58, v210
    v_mul_f32 v211, v58, v211
    v_mul_f32 v216, v58, v216
    v_mul_f32 v217, v58, v217
    v_mul_f32 v218, v58, v218
    v_mul_f32 v219, v58, v219
    v_mul_f32 v224, v58, v224
    v_mul_f32 v225, v58, v225
    v_mul_f32 v226, v58, v226
    v_mul_f32 v227, v58, v227
    v_mul_f32 v232, v58, v232
    v_mul_f32 v233, v58, v233
    v_mul_f32 v234, v58, v234
    v_mul_f32 v235, v58, v235
    v_mul_f32 v240, v58, v240
    v_mul_f32 v241, v58, v241
    v_mul_f32 v242, v58, v242
    v_mul_f32 v243, v58, v243
    v_mul_f32 v248, v58, v248
    v_mul_f32 v249, v58, v249
    v_mul_f32 v250, v58, v250
    v_mul_f32 v251, v58, v251
    v_max3_f32 v62, 0, v84, v85
    v_max3_f32 v62, v62, v86, v87
    v_max3_f32 v62, v62, v92, v93
    v_max3_f32 v62, v62, v94, v95
    v_mov_b32 v58, v62
    s_nop 1
    v_permlane16_swap_b32 v62, v58
    s_nop 1
    v_max_f32 v62, v62, v58
    v_mov_b32 v58, v62
    s_nop 1
    v_permlane32_swap_b32 v62, v58
    s_nop 1
    v_max_f32 v62, v62, v58
    v_exp_f32 v58, -v62
    v_sub_f32 v68, v68, v62
    v_sub_f32 v84, v84, v62
    v_sub_f32 v148, v148, v62
    v_sub_f32 v69, v69, v62
    v_sub_f32 v85, v85, v62
    v_sub_f32 v149, v149, v62
    v_sub_f32 v70, v70, v62
    v_sub_f32 v86, v86, v62
    v_sub_f32 v150, v150, v62
    v_sub_f32 v71, v71, v62
    v_sub_f32 v87, v87, v62
    v_sub_f32 v151, v151, v62
    v_sub_f32 v76, v76, v62
    v_sub_f32 v92, v92, v62
    v_sub_f32 v156, v156, v62
    v_sub_f32 v77, v77, v62
    v_sub_f32 v93, v93, v62
    v_sub_f32 v157, v157, v62
    v_sub_f32 v78, v78, v62
    v_sub_f32 v94, v94, v62
    v_sub_f32 v158, v158, v62
    v_sub_f32 v79, v79, v62
    v_sub_f32 v95, v95, v62
    v_sub_f32 v159, v159, v62
    v_mul_f32 v57, v58, v57
    v_mul_f32 v196, v58, v196
    v_mul_f32 v197, v58, v197
    v_mul_f32 v198, v58, v198
    v_mul_f32 v199, v58, v199
    v_mul_f32 v204, v58, v204
    v_mul_f32 v205, v58, v205
    v_mul_f32 v206, v58, v206
    v_mul_f32 v207, v58, v207
    v_mul_f32 v212, v58, v212
    v_mul_f32 v213, v58, v213
    v_mul_f32 v214, v58, v214
    v_mul_f32 v215, v58, v215
    v_mul_f32 v220, v58, v220
    v_mul_f32 v221, v58, v221
    v_mul_f32 v222, v58, v222
    v_mul_f32 v223, v58, v223
    v_mul_f32 v228, v58, v228
    v_mul_f32 v229, v58, v229
    v_mul_f32 v230, v58, v230
    v_mul_f32 v231, v58, v231
    v_mul_f32 v236, v58, v236
    v_mul_f32 v237, v58, v237
    v_mul_f32 v238, v58, v238
    v_mul_f32 v239, v58, v239
    v_mul_f32 v244, v58, v244
    v_mul_f32 v245, v58, v245
    v_mul_f32 v246, v58, v246
    v_mul_f32 v247, v58, v247
    v_mul_f32 v252, v58, v252
    v_mul_f32 v253, v58, v253
    v_mul_f32 v254, v58, v254
    v_mul_f32 v255, v58, v255
    v_exp_f32 v58, v80
    s_nop 0
    v_exp_f32 v59, v81
    s_nop 0
    v_add_f32 v54, v58, v59
    v_cvt_pk_bf16_f32 v136, v58, v59
    v_exp_f32 v60, v82
    s_nop 0
    v_add_f32 v54, v60, v54
    v_exp_f32 v61, v83
    s_nop 0
    v_add_f32 v54, v61, v54
    v_cvt_pk_bf16_f32 v137, v60, v61
    v_exp_f32 v58, v84
    s_nop 0
    v_exp_f32 v59, v85
    s_nop 0
    v_add_f32 v55, v58, v59
    v_cvt_pk_bf16_f32 v140, v58, v59
    v_exp_f32 v60, v86
    s_nop 0
    v_add_f32 v55, v60, v55
    v_exp_f32 v61, v87
    s_nop 0
    v_add_f32 v55, v61, v55
    v_cvt_pk_bf16_f32 v141, v60, v61
    v_exp_f32 v58, v88
    s_nop 0
    v_add_f32 v54, v58, v54
    v_exp_f32 v59, v89
    s_nop 0
    v_add_f32 v54, v59, v54
    v_cvt_pk_bf16_f32 v138, v58, v59
    v_exp_f32 v60, v90
    s_nop 0
    v_add_f32 v54, v60, v54
    v_exp_f32 v61, v91
    s_nop 0
    v_add_f32 v54, v61, v54
    v_cvt_pk_bf16_f32 v139, v60, v61
    v_exp_f32 v58, v92
    s_nop 0
    v_add_f32 v55, v58, v55
    v_exp_f32 v59, v93
    s_nop 0
    v_add_f32 v55, v59, v55
    v_cvt_pk_bf16_f32 v142, v58, v59
    v_exp_f32 v60, v94
    s_nop 0
    v_add_f32 v55, v60, v55
    v_exp_f32 v61, v95
    s_nop 0
    v_add_f32 v55, v61, v55
    v_cvt_pk_bf16_f32 v143, v60, v61
    s_nop 1
    s_setpc_b64 s[80:81]
L_adone:
    s_setprio 0
    s_waitcnt vmcnt(30)
    v_cmp_le_i32 vcc, 0, v51
    s_cbranch_vccz L_idx_okb
    v_and_b32 v3, 7, v1
    v_lshlrev_b32 v3, 2, v3
    s_mov_b32 s72, 0x3a0000
    s_mov_b32 s79, 262144
L_poll_45:
    buffer_load_dword v51, v3, s[8:11], s72 offen sc1
    s_waitcnt vmcnt(0)
    v_cmp_le_i32 vcc, 0, v51
    s_cbranch_vccz L_polldone_46
    s_sleep 2
    s_sub_u32 s79, s79, 1
    s_cmp_lg_u32 s79, 0
    s_cbranch_scc1 L_poll_45
L_polldone_46:
L_idx_okb:
    s_lshl_b32 s68, s4, 19
    s_lshl_b32 s6, s3, 14
    s_add_u32 s68, s68, s6
    s_add_u32 s68, s68, 50331648
    v_add_u32 v4, 0, v13
    v_add_u32 v5, 131072, v13
    v_add_u32 v6, 262144, v13
    v_add_u32 v7, 393216, v13
    v_mov_b64 v[176:177], 0
    v_mov_b64 v[178:179], 0
    v_mov_b64 v[180:181], 0
    v_mov_b64 v[182:183], 0
    v_mov_b64 v[184:185], 0
    v_mov_b64 v[186:187], 0
    v_mov_b64 v[188:189], 0
    v_mov_b64 v[190:191], 0
    v_mov_b64 v[192:193], 0
    v_mov_b64 v[194:195], 0
    v_mov_b64 v[196:197], 0
    v_mov_b64 v[198:199], 0
    v_mov_b64 v[200:201], 0
    v_mov_b64 v[202:203], 0
    v_mov_b64 v[204:205], 0
    v_mov_b64 v[206:207], 0
    v_mov_b64 v[208:209], 0
    v_mov_b64 v[210:211], 0
    v_mov_b64 v[212:213], 0
    v_mov_b64 v[214:215], 0
    v_mov_b64 v[216:217], 0
    v_mov_b64 v[218:219], 0
    v_mov_b64 v[220:221], 0
    v_mov_b64 v[222:223], 0
    v_mov_b64 v[224:225], 0
    v_mov_b64 v[226:227], 0
    v_mov_b64 v[228:229], 0
    v_mov_b64 v[230:231], 0
    v_mov_b64 v[232:233], 0
    v_mov_b64 v[234:235], 0
    v_mov_b64 v[236:237], 0
    v_mov_b64 v[238:239], 0
    v_mov_b64 v[240:241], 0
    v_mov_b64 v[242:243], 0
    v_mov_b64 v[244:245], 0
    v_mov_b64 v[246:247], 0
    v_mov_b64 v[248:249], 0
    v_mov_b64 v[250:251], 0
    v_mov_b64 v[252:253], 0
    v_mov_b64 v[254:255], 0
    v_cmp_ne_u32 vcc, 1, v53
    s_cbranch_vccz L_ctx_ok
    v_and_b32 v3, 3, v1
    v_bfe_u32 v2, v1, 2, 1
    v_lshl_add_u32 v3, v2, 5, v3
    v_lshlrev_b32 v3, 7, v3
    s_lshl_b32 s72, s4, 13
    s_lshl_b32 s6, s3, 9
    s_add_u32 s72, s72, s6
    s_add_u32 s72, s72, 3932160
    s_mov_b32 s79, 262144
L_poll_47:
    buffer_load_dword v2, v3, s[8:11], s72 offen sc1
    s_waitcnt vmcnt(0)
    v_cmp_ne_u32 vcc, 1, v2
    s_cbranch_vccz L_polldone_48
    s_sleep 2
    s_sub_u32 s79, s79, 1
    s_cmp_lg_u32 s79, 0
    s_cbranch_scc1 L_poll_47
L_polldone_48:
L_ctx_ok:
    s_add_u32 s75, s66, 0
    s_and_b32 s75, s75, 15
    s_lshl_b32 s75, s75, 10
    s_add_u32 s75, s75, s68
    buffer_load_dwordx4 v[16:19], v4, s[8:11], s75 offen sc1
    buffer_load_dwordx4 v[20:23], v5, s[8:11], s75 offen sc1
    buffer_load_dwordx4 v[24:27], v6, s[8:11], s75 offen sc1
    buffer_load_dwordx4 v[28:31], v7, s[8:11], s75 offen sc1
    s_add_u32 s75, s66, 1
    s_and_b32 s75, s75, 15
    s_lshl_b32 s75, s75, 10
    s_add_u32 s75, s75, s68
    buffer_load_dwordx4 v[32:35], v4, s[8:11], s75 offen sc1
    buffer_load_dwordx4 v[36:39], v5, s[8:11], s75 offen sc1
    buffer_load_dwordx4 v[40:43], v6, s[8:11], s75 offen sc1
    buffer_load_dwordx4 v[44:47], v7, s[8:11], s75 offen sc1
    s_waitcnt vmcnt(4)
    v_mfma_f32_16x16x32_bf16 v[176:179], v[56:59], v[16:19], v[176:179]
    v_mfma_f32_16x16x32_bf16 v[180:183], v[56:59], v[20:23], v[180:183]
    v_mfma_f32_16x16x32_bf16 v[184:187], v[56:59], v[24:27], v[184:187]
    v_mfma_f32_16x16x32_bf16 v[188:191], v[56:59], v[28:31], v[188:191]
    v_mfma_f32_16x16x32_bf16 v[192:195], v[60:63], v[16:19], v[192:195]
    v_mfma_f32_16x16x32_bf16 v[196:199], v[60:63], v[20:23], v[196:199]
    v_mfma_f32_16x16x32_bf16 v[200:203], v[60:63], v[24:27], v[200:203]
    v_mfma_f32_16x16x32_bf16 v[204:207], v[60:63], v[28:31], v[204:207]
    v_mfma_f32_16x16x32_bf16 v[208:211], v[64:67], v[16:19], v[208:211]
    v_mfma_f32_16x16x32_bf16 v[212:215], v[64:67], v[20:23], v[212:215]
    v_mfma_f32_16x16x32_bf16 v[216:219], v[64:67], v[24:27], v[216:219]
    v_mfma_f32_16x16x32_bf16 v[220:223], v[64:67], v[28:31], v[220:223]
    v_mfma_f32_16x16x32_bf16 v[224:227], v[68:71], v[16:19], v[224:227]
    v_mfma_f32_16x16x32_bf16 v[228:231], v[68:71], v[20:23], v[228:231]
    v_mfma_f32_16x16x32_bf16 v[232:235], v[68:71], v[24:27], v[232:235]
    v_mfma_f32_16x16x32_bf16 v[236:239], v[68:71], v[28:31], v[236:239]
    v_mfma_f32_16x16x32_bf16 v[240:243], v[72:75], v[16:19], v[240:243]
    v_mfma_f32_16x16x32_bf16 v[244:247], v[72:75], v[20:23], v[244:247]
    v_mfma_f32_16x16x32_bf16 v[248:251], v[72:75], v[24:27], v[248:251]
    v_mfma_f32_16x16x32_bf16 v[252:255], v[72:75], v[28:31], v[252:255]
    s_add_u32 s75, s66, 2
    s_and_b32 s75, s75, 15
    s_lshl_b32 s75, s75, 10
    s_add_u32 s75, s75, s68
    buffer_load_dwordx4 v[16:19], v4, s[8:11], s75 offen sc1
    buffer_load_dwordx4 v[20:23], v5, s[8:11], s75 offen sc1
    buffer_load_dwordx4 v[24:27], v6, s[8:11], s75 offen sc1
    buffer_load_dwordx4 v[28:31], v7, s[8:11], s75 offen sc1
    s_add_u32 s75, s66, 3
    s_and_b32 s75, s75, 15
    s_lshl_b32 s75, s75, 10
    s_add_u32 s75, s75, s68
    buffer_load_dwordx4 v[56:59], v4, s[8:11], s75 offen sc1
    buffer_load_dwordx4 v[60:63], v5, s[8:11], s75 offen sc1
    buffer_load_dwordx4 v[64:67], v6, s[8:11], s75 offen sc1
    buffer_load_dwordx4 v[68:71], v7, s[8:11], s75 offen sc1
    s_waitcnt vmcnt(8)
    v_mfma_f32_16x16x32_bf16 v[176:179], v[76:79], v[32:35], v[176:179]
    v_mfma_f32_16x16x32_bf16 v[180:183], v[76:79], v[36:39], v[180:183]
    v_mfma_f32_16x16x32_bf16 v[184:187], v[76:79], v[40:43], v[184:187]
    v_mfma_f32_16x16x32_bf16 v[188:191], v[76:79], v[44:47], v[188:191]
    v_mfma_f32_16x16x32_bf16 v[192:195], v[80:83], v[32:35], v[192:195]
    v_mfma_f32_16x16x32_bf16 v[196:199], v[80:83], v[36:39], v[196:199]
    v_mfma_f32_16x16x32_bf16 v[200:203], v[80:83], v[40:43], v[200:203]
    v_mfma_f32_16x16x32_bf16 v[204:207], v[80:83], v[44:47], v[204:207]
    v_mfma_f32_16x16x32_bf16 v[208:211], v[84:87], v[32:35], v[208:211]
    v_mfma_f32_16x16x32_bf16 v[212:215], v[84:87], v[36:39], v[212:215]
    v_mfma_f32_16x16x32_bf16 v[216:219], v[84:87], v[40:43], v[216:219]
    v_mfma_f32_16x16x32_bf16 v[220:223], v[84:87], v[44:47], v[220:223]
    v_mfma_f32_16x16x32_bf16 v[224:227], v[88:91], v[32:35], v[224:227]
    v_mfma_f32_16x16x32_bf16 v[228:231], v[88:91], v[36:39], v[228:231]
    v_mfma_f32_16x16x32_bf16 v[232:235], v[88:91], v[40:43], v[232:235]
    v_mfma_f32_16x16x32_bf16 v[236:239], v[88:91], v[44:47], v[236:239]
    v_mfma_f32_16x16x32_bf16 v[240:243], v[92:95], v[32:35], v[240:243]
    v_mfma_f32_16x16x32_bf16 v[244:247], v[92:95], v[36:39], v[244:247]
    v_mfma_f32_16x16x32_bf16 v[248:251], v[92:95], v[40:43], v[248:251]
    v_mfma_f32_16x16x32_bf16 v[252:255], v[92:95], v[44:47], v[252:255]
    s_add_u32 s75, s66, 4
    s_and_b32 s75, s75, 15
    s_lshl_b32 s75, s75, 10
    s_add_u32 s75, s75, s68
    buffer_load_dwordx4 v[72:75], v4, s[8:11], s75 offen sc1
    buffer_load_dwordx4 v[32:35], v5, s[8:11], s75 offen sc1
    buffer_load_dwordx4 v[36:39], v6, s[8:11], s75 offen sc1
    buffer_load_dwordx4 v[40:43], v7, s[8:11], s75 offen sc1
    s_add_u32 s75, s66, 5
    s_and_b32 s75, s75, 15
    s_lshl_b32 s75, s75, 10
    s_add_u32 s75, s75, s68
    buffer_load_dwordx4 v[44:47], v4, s[8:11], s75 offen sc1
    buffer_load_dwordx4 v[76:79], v5, s[8:11], s75 offen sc1
    buffer_load_dwordx4 v[80:83], v6, s[8:11], s75 offen sc1
    buffer_load_dwordx4 v[84:87], v7, s[8:11], s75 offen sc1
    s_waitcnt vmcnt(12)
    v_mfma_f32_16x16x32_bf16 v[176:179], v[96:99], v[16:19], v[176:179]
    v_mfma_f32_16x16x32_bf16 v[180:183], v[96:99], v[20:23], v[180:183]
    v_mfma_f32_16x16x32_bf16 v[184:187], v[96:99], v[24:27], v[184:187]
    v_mfma_f32_16x16x32_bf16 v[188:191], v[96:99], v[28:31], v[188:191]
    v_mfma_f32_16x16x32_bf16 v[192:195], v[100:103], v[16:19], v[192:195]
    v_mfma_f32_16x16x32_bf16 v[196:199], v[100:103], v[20:23], v[196:199]
    v_mfma_f32_16x16x32_bf16 v[200:203], v[100:103], v[24:27], v[200:203]
    v_mfma_f32_16x16x32_bf16 v[204:207], v[100:103], v[28:31], v[204:207]
    v_mfma_f32_16x16x32_bf16 v[208:211], v[104:107], v[16:19], v[208:211]
    v_mfma_f32_16x16x32_bf16 v[212:215], v[104:107], v[20:23], v[212:215]
    v_mfma_f32_16x16x32_bf16 v[216:219], v[104:107], v[24:27], v[216:219]
    v_mfma_f32_16x16x32_bf16 v[220:223], v[104:107], v[28:31], v[220:223]
    v_mfma_f32_16x16x32_bf16 v[224:227], v[108:111], v[16:19], v[224:227]
    v_mfma_f32_16x16x32_bf16 v[228:231], v[108:111], v[20:23], v[228:231]
    v_mfma_f32_16x16x32_bf16 v[232:235], v[108:111], v[24:27], v[232:235]
    v_mfma_f32_16x16x32_bf16 v[236:239], v[108:111], v[28:31], v[236:239]
    v_mfma_f32_16x16x32_bf16 v[240:243], v[112:115], v[16:19], v[240:243]
    v_mfma_f32_16x16x32_bf16 v[244:247], v[112:115], v[20:23], v[244:247]
    v_mfma_f32_16x16x32_bf16 v[248:251], v[112:115], v[24:27], v[248:251]
    v_mfma_f32_16x16x32_bf16 v[252:255], v[112:115], v[28:31], v[252:255]
    s_add_u32 s75, s66, 6
    s_and_b32 s75, s75, 15
    s_mul_i32 s75, s75, 40960
    s_add_u32 s75, s75, s69
    buffer_load_dwordx4 v[88:91], v13, s[8:11], s75 offen offset:0 sc1
    buffer_load_dwordx4 v[92:95], v13, s[8:11], s75 offen offset:1024 sc1
    buffer_load_dwordx4 v[16:19], v13, s[8:11], s75 offen offset:2048 sc1
    buffer_load_dwordx4 v[20:23], v13, s[8:11], s75 offen offset:3072 sc1
    buffer_load_dwordx4 v[24:27], v52, s[8:11], s75 offen offset:0 sc1
    s_add_u32 s75, s66, 6
    s_and_b32 s75, s75, 15
    s_lshl_b32 s75, s75, 10
    s_add_u32 s75, s75, s68
    buffer_load_dwordx4 v[28:31], v4, s[8:11], s75 offen sc1
    buffer_load_dwordx4 v[96:99], v5, s[8:11], s75 offen sc1
    buffer_load_dwordx4 v[100:103], v6, s[8:11], s75 offen sc1
    buffer_load_dwordx4 v[104:107], v7, s[8:11], s75 offen sc1
    s_waitcnt vmcnt(17)
    v_mfma_f32_16x16x32_bf16 v[176:179], v[116:119], v[56:59], v[176:179]
    v_mfma_f32_16x16x32_bf16 v[180:183], v[116:119], v[60:63], v[180:183]
    v_mfma_f32_16x16x32_bf16 v[184:187], v[116:119], v[64:67], v[184:187]
    v_mfma_f32_16x16x32_bf16 v[188:191], v[116:119], v[68:71], v[188:191]
    v_mfma_f32_16x16x32_bf16 v[192:195], v[120:123], v[56:59], v[192:195]
    v_mfma_f32_16x16x32_bf16 v[196:199], v[120:123], v[60:63], v[196:199]
    v_mfma_f32_16x16x32_bf16 v[200:203], v[120:123], v[64:67], v[200:203]
    v_mfma_f32_16x16x32_bf16 v[204:207], v[120:123], v[68:71], v[204:207]
    v_mfma_f32_16x16x32_bf16 v[208:211], v[124:127], v[56:59], v[208:211]
    v_mfma_f32_16x16x32_bf16 v[212:215], v[124:127], v[60:63], v[212:215]
    v_mfma_f32_16x16x32_bf16 v[216:219], v[124:127], v[64:67], v[216:219]
    v_mfma_f32_16x16x32_bf16 v[220:223], v[124:127], v[68:71], v[220:223]
    v_mfma_f32_16x16x32_bf16 v[224:227], v[128:131], v[56:59], v[224:227]
    v_mfma_f32_16x16x32_bf16 v[228:231], v[128:131], v[60:63], v[228:231]
    v_mfma_f32_16x16x32_bf16 v[232:235], v[128:131], v[64:67], v[232:235]
    v_mfma_f32_16x16x32_bf16 v[236:239], v[128:131], v[68:71], v[236:239]
    v_mfma_f32_16x16x32_bf16 v[240:243], v[132:135], v[56:59], v[240:243]
    v_mfma_f32_16x16x32_bf16 v[244:247], v[132:135], v[60:63], v[244:247]
    v_mfma_f32_16x16x32_bf16 v[248:251], v[132:135], v[64:67], v[248:251]
    v_mfma_f32_16x16x32_bf16 v[252:255], v[132:135], v[68:71], v[252:255]
    s_add_u32 s75, s66, 7
    s_and_b32 s75, s75, 15
    s_mul_i32 s75, s75, 40960
    s_add_u32 s75, s75, s69
    buffer_load_dwordx4 v[108:111], v13, s[8:11], s75 offen offset:0 sc1
    buffer_load_dwordx4 v[112:115], v13, s[8:11], s75 offen offset:1024 sc1
    buffer_load_dwordx4 v[56:59], v13, s[8:11], s75 offen offset:2048 sc1
    buffer_load_dwordx4 v[60:63], v13, s[8:11], s75 offen offset:3072 sc1
    buffer_load_dwordx4 v[64:67], v52, s[8:11], s75 offen offset:0 sc1
    s_add_u32 s75, s66, 7
    s_and_b32 s75, s75, 15
    s_lshl_b32 s75, s75, 10
    s_add_u32 s75, s75, s68
    buffer_load_dwordx4 v[68:71], v4, s[8:11], s75 offen sc1
    buffer_load_dwordx4 v[116:119], v5, s[8:11], s75 offen sc1
    buffer_load_dwordx4 v[120:123], v6, s[8:11], s75 offen sc1
    buffer_load_dwordx4 v[124:127], v7, s[8:11], s75 offen sc1
    s_waitcnt vmcnt(22)
    v_mfma_f32_16x16x32_bf16 v[176:179], v[136:139], v[72:75], v[176:179]
    v_mfma_f32_16x16x32_bf16 v[180:183], v[136:139], v[32:35], v[180:183]
    v_mfma_f32_16x16x32_bf16 v[184:187], v[136:139], v[36:39], v[184:187]
    v_mfma_f32_16x16x32_bf16 v[188:191], v[136:139], v[40:43], v[188:191]
    v_mfma_f32_16x16x32_bf16 v[192:195], v[140:143], v[72:75], v[192:195]
    v_mfma_f32_16x16x32_bf16 v[196:199], v[140:143], v[32:35], v[196:199]
    v_mfma_f32_16x16x32_bf16 v[200:203], v[140:143], v[36:39], v[200:203]
    v_mfma_f32_16x16x32_bf16 v[204:207], v[140:143], v[40:43], v[204:207]
    v_mfma_f32_16x16x32_bf16 v[208:211], v[144:147], v[72:75], v[208:211]
    v_mfma_f32_16x16x32_bf16 v[212:215], v[144:147], v[32:35], v[212:215]
    v_mfma_f32_16x16x32_bf16 v[216:219], v[144:147], v[36:39], v[216:219]
    v_mfma_f32_16x16x32_bf16 v[220:223], v[144:147], v[40:43], v[220:223]
    v_mfma_f32_16x16x32_bf16 v[224:227], v[148:151], v[72:75], v[224:227]
    v_mfma_f32_16x16x32_bf16 v[228:231], v[148:151], v[32:35], v[228:231]
    v_mfma_f32_16x16x32_bf16 v[232:235], v[148:151], v[36:39], v[232:235]
    v_mfma_f32_16x16x32_bf16 v[236:239], v[148:151], v[40:43], v[236:239]
    v_mfma_f32_16x16x32_bf16 v[240:243], v[152:155], v[72:75], v[240:243]
    v_mfma_f32_16x16x32_bf16 v[244:247], v[152:155], v[32:35], v[244:247]
    v_mfma_f32_16x16x32_bf16 v[248:251], v[152:155], v[36:39], v[248:251]
    v_mfma_f32_16x16x32_bf16 v[252:255], v[152:155], v[40:43], v[252:255]
    s_add_u32 s75, s66, 8
    s_and_b32 s75, s75, 15
    s_mul_i32 s75, s75, 40960
    s_add_u32 s75, s75, s69
    buffer_load_dwordx4 v[128:131], v13, s[8:11], s75 offen offset:0 sc1
    buffer_load_dwordx4 v[132:135], v13, s[8:11], s75 offen offset:1024 sc1
    buffer_load_dwordx4 v[72:75], v13, s[8:11], s75 offen offset:2048 sc1
    buffer_load_dwordx4 v[32:35], v13, s[8:11], s75 offen offset:3072 sc1
    buffer_load_dwordx4 v[36:39], v52, s[8:11], s75 offen offset:0 sc1
    s_add_u32 s75, s66, 8
    s_and_b32 s75, s75, 15
    s_lshl_b32 s75, s75, 10
    s_add_u32 s75, s75, s68
    buffer_load_dwordx4 v[40:43], v4, s[8:11], s75 offen sc1
    buffer_load_dwordx4 v[136:139], v5, s[8:11], s75 offen sc1
    buffer_load_dwordx4 v[140:143], v6, s[8:11], s75 offen sc1
    buffer_load_dwordx4 v[144:147], v7, s[8:11], s75 offen sc1
    s_waitcnt vmcnt(27)
    v_mfma_f32_16x16x32_bf16 v[176:179], v[156:159], v[44:47], v[176:179]
    v_mfma_f32_16x16x32_bf16 v[180:183], v[156:159], v[76:79], v[180:183]
    v_mfma_f32_16x16x32_bf16 v[184:187], v[156:159], v[80:83], v[184:187]
    v_mfma_f32_16x16x32_bf16 v[188:191], v[156:159], v[84:87], v[188:191]
    v_mfma_f32_16x16x32_bf16 v[192:195], v[160:163], v[44:47], v[192:195]
    v_mfma_f32_16x16x32_bf16 v[196:199], v[160:163], v[76:79], v[196:199]
    v_mfma_f32_16x16x32_bf16 v[200:203], v[160:163], v[80:83], v[200:203]
    v_mfma_f32_16x16x32_bf16 v[204:207], v[160:163], v[84:87], v[204:207]
    v_mfma_f32_16x16x32_bf16 v[208:211], v[164:167], v[44:47], v[208:211]
    v_mfma_f32_16x16x32_bf16 v[212:215], v[164:167], v[76:79], v[212:215]
    v_mfma_f32_16x16x32_bf16 v[216:219], v[164:167], v[80:83], v[216:219]
    v_mfma_f32_16x16x32_bf16 v[220:223], v[164:167], v[84:87], v[220:223]
    v_mfma_f32_16x16x32_bf16 v[224:227], v[168:171], v[44:47], v[224:227]
    v_mfma_f32_16x16x32_bf16 v[228:231], v[168:171], v[76:79], v[228:231]
    v_mfma_f32_16x16x32_bf16 v[232:235], v[168:171], v[80:83], v[232:235]
    v_mfma_f32_16x16x32_bf16 v[236:239], v[168:171], v[84:87], v[236:239]
    v_mfma_f32_16x16x32_bf16 v[240:243], v[172:175], v[44:47], v[240:243]
    v_mfma_f32_16x16x32_bf16 v[244:247], v[172:175], v[76:79], v[244:247]
    v_mfma_f32_16x16x32_bf16 v[248:251], v[172:175], v[80:83], v[248:251]
    v_mfma_f32_16x16x32_bf16 v[252:255], v[172:175], v[84:87], v[252:255]
    s_add_u32 s75, s66, 9
    s_and_b32 s75, s75, 15
    s_mul_i32 s75, s75, 40960
    s_add_u32 s75, s75, s69
    buffer_load_dwordx4 v[148:151], v13, s[8:11], s75 offen offset:0 sc1
    buffer_load_dwordx4 v[152:155], v13, s[8:11], s75 offen offset:1024 sc1
    buffer_load_dwordx4 v[44:47], v13, s[8:11], s75 offen offset:2048 sc1
    buffer_load_dwordx4 v[76:79], v13, s[8:11], s75 offen offset:3072 sc1
    buffer_load_dwordx4 v[80:83], v52, s[8:11], s75 offen offset:0 sc1
    s_add_u32 s75, s66, 9
    s_and_b32 s75, s75, 15
    s_lshl_b32 s75, s75, 10
    s_add_u32 s75, s75, s68
    buffer_load_dwordx4 v[84:87], v4, s[8:11], s75 offen sc1
    buffer_load_dwordx4 v[156:159], v5, s[8:11], s75 offen sc1
    buffer_load_dwordx4 v[160:163], v6, s[8:11], s75 offen sc1
    buffer_load_dwordx4 v[164:167], v7, s[8:11], s75 offen sc1
    s_waitcnt vmcnt(27)
    v_mfma_f32_16x16x32_bf16 v[176:179], v[88:91], v[28:31], v[176:179]
    v_mfma_f32_16x16x32_bf16 v[180:183], v[88:91], v[96:99], v[180:183]
    v_mfma_f32_16x16x32_bf16 v[184:187], v[88:91], v[100:103], v[184:187]
    v_mfma_f32_16x16x32_bf16 v[188:191], v[88:91], v[104:107], v[188:191]
    v_mfma_f32_16x16x32_bf16 v[192:195], v[92:95], v[28:31], v[192:195]
    v_mfma_f32_16x16x32_bf16 v[196:199], v[92:95], v[96:99], v[196:199]
    v_mfma_f32_16x16x32_bf16 v[200:203], v[92:95], v[100:103], v[200:203]
    v_mfma_f32_16x16x32_bf16 v[204:207], v[92:95], v[104:107], v[204:207]
    v_mfma_f32_16x16x32_bf16 v[208:211], v[16:19], v[28:31], v[208:211]
    v_mfma_f32_16x16x32_bf16 v[212:215], v[16:19], v[96:99], v[212:215]
    v_mfma_f32_16x16x32_bf16 v[216:219], v[16:19], v[100:103], v[216:219]
    v_mfma_f32_16x16x32_bf16 v[220:223], v[16:19], v[104:107], v[220:223]
    v_mfma_f32_16x16x32_bf16 v[224:227], v[20:23], v[28:31], v[224:227]
    v_mfma_f32_16x16x32_bf16 v[228:231], v[20:23], v[96:99], v[228:231]
    v_mfma_f32_16x16x32_bf16 v[232:235], v[20:23], v[100:103], v[232:235]
    v_mfma_f32_16x16x32_bf16 v[236:239], v[20:23], v[104:107], v[236:239]
    v_mfma_f32_16x16x32_bf16 v[240:243], v[24:27], v[28:31], v[240:243]
    v_mfma_f32_16x16x32_bf16 v[244:247], v[24:27], v[96:99], v[244:247]
    v_mfma_f32_16x16x32_bf16 v[248:251], v[24:27], v[100:103], v[248:251]
    v_mfma_f32_16x16x32_bf16 v[252:255], v[24:27], v[104:107], v[252:255]
    s_add_u32 s75, s66, 10
    s_and_b32 s75, s75, 15
    s_mul_i32 s75, s75, 40960
    s_add_u32 s75, s75, s69
    buffer_load_dwordx4 v[168:171], v13, s[8:11], s75 offen offset:0 sc1
    buffer_load_dwordx4 v[172:175], v13, s[8:11], s75 offen offset:1024 sc1
    buffer_load_dwordx4 v[28:31], v13, s[8:11], s75 offen offset:2048 sc1
    buffer_load_dwordx4 v[96:99], v13, s[8:11], s75 offen offset:3072 sc1
    buffer_load_dwordx4 v[100:103], v52, s[8:11], s75 offen offset:0 sc1
    s_add_u32 s75, s66, 10
    s_and_b32 s75, s75, 15
    s_lshl_b32 s75, s75, 10
    s_add_u32 s75, s75, s68
    buffer_load_dwordx4 v[104:107], v4, s[8:11], s75 offen sc1
    buffer_load_dwordx4 v[88:91], v5, s[8:11], s75 offen sc1
    buffer_load_dwordx4 v[92:95], v6, s[8:11], s75 offen sc1
    buffer_load_dwordx4 v[16:19], v7, s[8:11], s75 offen sc1
    s_waitcnt vmcnt(27)
    v_mfma_f32_16x16x32_bf16 v[176:179], v[108:111], v[68:71], v[176:179]
    v_mfma_f32_16x16x32_bf16 v[180:183], v[108:111], v[116:119], v[180:183]
    v_mfma_f32_16x16x32_bf16 v[184:187], v[108:111], v[120:123], v[184:187]
    v_mfma_f32_16x16x32_bf16 v[188:191], v[108:111], v[124:127], v[188:191]
    v_mfma_f32_16x16x32_bf16 v[192:195], v[112:115], v[68:71], v[192:195]
    v_mfma_f32_16x16x32_bf16 v[196:199], v[112:115], v[116:119], v[196:199]
    v_mfma_f32_16x16x32_bf16 v[200:203], v[112:115], v[120:123], v[200:203]
    v_mfma_f32_16x16x32_bf16 v[204:207], v[112:115], v[124:127], v[204:207]
    v_mfma_f32_16x16x32_bf16 v[208:211], v[56:59], v[68:71], v[208:211]
    v_mfma_f32_16x16x32_bf16 v[212:215], v[56:59], v[116:119], v[212:215]
    v_mfma_f32_16x16x32_bf16 v[216:219], v[56:59], v[120:123], v[216:219]
    v_mfma_f32_16x16x32_bf16 v[220:223], v[56:59], v[124:127], v[220:223]
    v_mfma_f32_16x16x32_bf16 v[224:227], v[60:63], v[68:71], v[224:227]
    v_mfma_f32_16x16x32_bf16 v[228:231], v[60:63], v[116:119], v[228:231]
    v_mfma_f32_16x16x32_bf16 v[232:235], v[60:63], v[120:123], v[232:235]
    v_mfma_f32_16x16x32_bf16 v[236:239], v[60:63], v[124:127], v[236:239]
    v_mfma_f32_16x16x32_bf16 v[240:243], v[64:67], v[68:71], v[240:243]
    v_mfma_f32_16x16x32_bf16 v[244:247], v[64:67], v[116:119], v[244:247]
    v_mfma_f32_16x16x32_bf16 v[248:251], v[64:67], v[120:123], v[248:251]
    v_mfma_f32_16x16x32_bf16 v[252:255], v[64:67], v[124:127], v[252:255]
    s_add_u32 s75, s66, 11
    s_and_b32 s75, s75, 15
    s_mul_i32 s75, s75, 40960
    s_add_u32 s75, s75, s69
    buffer_load_dwordx4 v[20:23], v13, s[8:11], s75 offen offset:0 sc1
    buffer_load_dwordx4 v[24:27], v13, s[8:11], s75 offen offset:1024 sc1
    buffer_load_dwordx4 v[68:71], v13, s[8:11], s75 offen offset:2048 sc1
    buffer_load_dwordx4 v[116:119], v13, s[8:11], s75 offen offset:3072 sc1
    buffer_load_dwordx4 v[120:123], v52, s[8:11], s75 offen offset:0 sc1
    s_add_u32 s75, s66, 11
    s_and_b32 s75, s75, 15
    s_lshl_b32 s75, s75, 10
    s_add_u32 s75, s75, s68
    buffer_load_dwordx4 v[124:127], v4, s[8:11], s75 offen sc1
    buffer_load_dwordx4 v[108:111], v5, s[8:11], s75 offen sc1
    buffer_load_dwordx4 v[112:115], v6, s[8:11], s75 offen sc1
    buffer_load_dwordx4 v[56:59], v7, s[8:11], s75 offen sc1
    s_waitcnt vmcnt(27)
    v_mfma_f32_16x16x32_bf16 v[176:179], v[128:131], v[40:43], v[176:179]
    v_mfma_f32_16x16x32_bf16 v[180:183], v[128:131], v[136:139], v[180:183]
    v_mfma_f32_16x16x32_bf16 v[184:187], v[128:131], v[140:143], v[184:187]
    v_mfma_f32_16x16x32_bf16 v[188:191], v[128:131], v[144:147], v[188:191]
    v_mfma_f32_16x16x32_bf16 v[192:195], v[132:135], v[40:43], v[192:195]
    v_mfma_f32_16x16x32_bf16 v[196:199], v[132:135], v[136:139], v[196:199]
    v_mfma_f32_16x16x32_bf16 v[200:203], v[132:135], v[140:143], v[200:203]
    v_mfma_f32_16x16x32_bf16 v[204:207], v[132:135], v[144:147], v[204:207]
    v_mfma_f32_16x16x32_bf16 v[208:211], v[72:75], v[40:43], v[208:211]
    v_mfma_f32_16x16x32_bf16 v[212:215], v[72:75], v[136:139], v[212:215]
    v_mfma_f32_16x16x32_bf16 v[216:219], v[72:75], v[140:143], v[216:219]
    v_mfma_f32_16x16x32_bf16 v[220:223], v[72:75], v[144:147], v[220:223]
    v_mfma_f32_16x16x32_bf16 v[224:227], v[32:35], v[40:43], v[224:227]
    v_mfma_f32_16x16x32_bf16 v[228:231], v[32:35], v[136:139], v[228:231]
    v_mfma_f32_16x16x32_bf16 v[232:235], v[32:35], v[140:143], v[232:235]
    v_mfma_f32_16x16x32_bf16 v[236:239], v[32:35], v[144:147], v[236:239]
    v_mfma_f32_16x16x32_bf16 v[240:243], v[36:39], v[40:43], v[240:243]
    v_mfma_f32_16x16x32_bf16 v[244:247], v[36:39], v[136:139], v[244:247]
    v_mfma_f32_16x16x32_bf16 v[248:251], v[36:39], v[140:143], v[248:251]
    v_mfma_f32_16x16x32_bf16 v[252:255], v[36:39], v[144:147], v[252:255]
    s_add_u32 s75, s66, 12
    s_and_b32 s75, s75, 15
    s_mul_i32 s75, s75, 40960
    s_add_u32 s75, s75, s69
    buffer_load_dwordx4 v[60:63], v13, s[8:11], s75 offen offset:0 sc1
    buffer_load_dwordx4 v[64:67], v13, s[8:11], s75 offen offset:1024 sc1
    buffer_load_dwordx4 v[40:43], v13, s[8:11], s75 offen offset:2048 sc1
    buffer_load_dwordx4 v[136:139], v13, s[8:11], s75 offen offset:3072 sc1
    buffer_load_dwordx4 v[140:143], v52, s[8:11], s75 offen offset:0 sc1
    s_add_u32 s75, s66, 12
    s_and_b32 s75, s75, 15
    s_lshl_b32 s75, s75, 10
    s_add_u32 s75, s75, s68
    buffer_load_dwordx4 v[144:147], v4, s[8:11], s75 offen sc1
    buffer_load_dwordx4 v[128:131], v5, s[8:11], s75 offen sc1
    buffer_load_dwordx4 v[132:135], v6, s[8:11], s75 offen sc1
    buffer_load_dwordx4 v[72:75], v7, s[8:11], s75 offen sc1
    s_waitcnt vmcnt(27)
    v_mfma_f32_16x16x32_bf16 v[176:179], v[148:151], v[84:87], v[176:179]
    v_mfma_f32_16x16x32_bf16 v[180:183], v[148:151], v[156:159], v[180:183]
    v_mfma_f32_16x16x32_bf16 v[184:187], v[148:151], v[160:163], v[184:187]
    v_mfma_f32_16x16x32_bf16 v[188:191], v[148:151], v[164:167], v[188:191]
    v_mfma_f32_16x16x32_bf16 v[192:195], v[152:155], v[84:87], v[192:195]
    v_mfma_f32_16x16x32_bf16 v[196:199], v[152:155], v[156:159], v[196:199]
    v_mfma_f32_16x16x32_bf16 v[200:203], v[152:155], v[160:163], v[200:203]
    v_mfma_f32_16x16x32_bf16 v[204:207], v[152:155], v[164:167], v[204:207]
    v_mfma_f32_16x16x32_bf16 v[208:211], v[44:47], v[84:87], v[208:211]
    v_mfma_f32_16x16x32_bf16 v[212:215], v[44:47], v[156:159], v[212:215]
    v_mfma_f32_16x16x32_bf16 v[216:219], v[44:47], v[160:163], v[216:219]
    v_mfma_f32_16x16x32_bf16 v[220:223], v[44:47], v[164:167], v[220:223]
    v_mfma_f32_16x16x32_bf16 v[224:227], v[76:79], v[84:87], v[224:227]
    v_mfma_f32_16x16x32_bf16 v[228:231], v[76:79], v[156:159], v[228:231]
    v_mfma_f32_16x16x32_bf16 v[232:235], v[76:79], v[160:163], v[232:235]
    v_mfma_f32_16x16x32_bf16 v[236:239], v[76:79], v[164:167], v[236:239]
    v_mfma_f32_16x16x32_bf16 v[240:243], v[80:83], v[84:87], v[240:243]
    v_mfma_f32_16x16x32_bf16 v[244:247], v[80:83], v[156:159], v[244:247]
    v_mfma_f32_16x16x32_bf16 v[248:251], v[80:83], v[160:163], v[248:251]
    v_mfma_f32_16x16x32_bf16 v[252:255], v[80:83], v[164:167], v[252:255]
    s_add_u32 s75, s66, 13
    s_and_b32 s75, s75, 15
    s_mul_i32 s75, s75, 40960
    s_add_u32 s75, s75, s69
    buffer_load_dwordx4 v[32:35], v13, s[8:11], s75 offen offset:0 sc1
    buffer_load_dwordx4 v[36:39], v13, s[8:11], s75 offen offset:1024 sc1
    buffer_load_dwordx4 v[84:87], v13, s[8:11], s75 offen offset:2048 sc1
    buffer_load_dwordx4 v[156:159], v13, s[8:11], s75 offen offset:3072 sc1
    buffer_load_dwordx4 v[160:163], v52, s[8:11], s75 offen offset:0 sc1
    s_add_u32 s75, s66, 13
    s_and_b32 s75, s75, 15
    s_lshl_b32 s75, s75, 10
    s_add_u32 s75, s75, s68
    buffer_load_dwordx4 v[164:167], v4, s[8:11], s75 offen sc1
    buffer_load_dwordx4 v[148:151], v5, s[8:11], s75 offen sc1
    buffer_load_dwordx4 v[152:155], v6, s[8:11], s75 offen sc1
    buffer_load_dwordx4 v[44:47], v7, s[8:11], s75 offen sc1
    s_waitcnt vmcnt(27)
    v_mfma_f32_16x16x32_bf16 v[176:179], v[168:171], v[104:107], v[176:179]
    v_mfma_f32_16x16x32_bf16 v[180:183], v[168:171], v[88:91], v[180:183]
    v_mfma_f32_16x16x32_bf16 v[184:187], v[168:171], v[92:95], v[184:187]
    v_mfma_f32_16x16x32_bf16 v[188:191], v[168:171], v[16:19], v[188:191]
    v_mfma_f32_16x16x32_bf16 v[192:195], v[172:175], v[104:107], v[192:195]
    v_mfma_f32_16x16x32_bf16 v[196:199], v[172:175], v[88:91], v[196:199]
    v_mfma_f32_16x16x32_bf16 v[200:203], v[172:175], v[92:95], v[200:203]
    v_mfma_f32_16x16x32_bf16 v[204:207], v[172:175], v[16:19], v[204:207]
    v_mfma_f32_16x16x32_bf16 v[208:211], v[28:31], v[104:107], v[208:211]
    v_mfma_f32_16x16x32_bf16 v[212:215], v[28:31], v[88:91], v[212:215]
    v_mfma_f32_16x16x32_bf16 v[216:219], v[28:31], v[92:95], v[216:219]
    v_mfma_f32_16x16x32_bf16 v[220:223], v[28:31], v[16:19], v[220:223]
    v_mfma_f32_16x16x32_bf16 v[224:227], v[96:99], v[104:107], v[224:227]
    v_mfma_f32_16x16x32_bf16 v[228:231], v[96:99], v[88:91], v[228:231]
    v_mfma_f32_16x16x32_bf16 v[232:235], v[96:99], v[92:95], v[232:235]
    v_mfma_f32_16x16x32_bf16 v[236:239], v[96:99], v[16:19], v[236:239]
    v_mfma_f32_16x16x32_bf16 v[240:243], v[100:103], v[104:107], v[240:243]
    v_mfma_f32_16x16x32_bf16 v[244:247], v[100:103], v[88:91], v[244:247]
    v_mfma_f32_16x16x32_bf16 v[248:251], v[100:103], v[92:95], v[248:251]
    v_mfma_f32_16x16x32_bf16 v[252:255], v[100:103], v[16:19], v[252:255]
    s_add_u32 s75, s66, 14
    s_and_b32 s75, s75, 15
    s_mul_i32 s75, s75, 40960
    s_add_u32 s75, s75, s69
    buffer_load_dwordx4 v[76:79], v13, s[8:11], s75 offen offset:0 sc1
    buffer_load_dwordx4 v[80:83], v13, s[8:11], s75 offen offset:1024 sc1
    buffer_load_dwordx4 v[104:107], v13, s[8:11], s75 offen offset:2048 sc1
    buffer_load_dwordx4 v[88:91], v13, s[8:11], s75 offen offset:3072 sc1
    buffer_load_dwordx4 v[92:95], v52, s[8:11], s75 offen offset:0 sc1
    s_add_u32 s75, s66, 14
    s_and_b32 s75, s75, 15
    s_lshl_b32 s75, s75, 10
    s_add_u32 s75, s75, s68
    buffer_load_dwordx4 v[16:19], v4, s[8:11], s75 offen sc1
    buffer_load_dwordx4 v[168:171], v5, s[8:11], s75 offen sc1
    buffer_load_dwordx4 v[172:175], v6, s[8:11], s75 offen sc1
    buffer_load_dwordx4 v[28:31], v7, s[8:11], s75 offen sc1
    s_waitcnt vmcnt(27)
    v_mfma_f32_16x16x32_bf16 v[176:179], v[20:23], v[124:127], v[176:179]
    v_mfma_f32_16x16x32_bf16 v[180:183], v[20:23], v[108:111], v[180:183]
    v_mfma_f32_16x16x32_bf16 v[184:187], v[20:23], v[112:115], v[184:187]
    v_mfma_f32_16x16x32_bf16 v[188:191], v[20:23], v[56:59], v[188:191]
    v_mfma_f32_16x16x32_bf16 v[192:195], v[24:27], v[124:127], v[192:195]
    v_mfma_f32_16x16x32_bf16 v[196:199], v[24:27], v[108:111], v[196:199]
    v_mfma_f32_16x16x32_bf16 v[200:203], v[24:27], v[112:115], v[200:203]
    v_mfma_f32_16x16x32_bf16 v[204:207], v[24:27], v[56:59], v[204:207]
    v_mfma_f32_16x16x32_bf16 v[208:211], v[68:71], v[124:127], v[208:211]
    v_mfma_f32_16x16x32_bf16 v[212:215], v[68:71], v[108:111], v[212:215]
    v_mfma_f32_16x16x32_bf16 v[216:219], v[68:71], v[112:115], v[216:219]
    v_mfma_f32_16x16x32_bf16 v[220:223], v[68:71], v[56:59], v[220:223]
    v_mfma_f32_16x16x32_bf16 v[224:227], v[116:119], v[124:127], v[224:227]
    v_mfma_f32_16x16x32_bf16 v[228:231], v[116:119], v[108:111], v[228:231]
    v_mfma_f32_16x16x32_bf16 v[232:235], v[116:119], v[112:115], v[232:235]
    v_mfma_f32_16x16x32_bf16 v[236:239], v[116:119], v[56:59], v[236:239]
    v_mfma_f32_16x16x32_bf16 v[240:243], v[120:123], v[124:127], v[240:243]
    v_mfma_f32_16x16x32_bf16 v[244:247], v[120:123], v[108:111], v[244:247]
    v_mfma_f32_16x16x32_bf16 v[248:251], v[120:123], v[112:115], v[248:251]
    v_mfma_f32_16x16x32_bf16 v[252:255], v[120:123], v[56:59], v[252:255]
    s_add_u32 s75, s66, 15
    s_and_b32 s75, s75, 15
    s_mul_i32 s75, s75, 40960
    s_add_u32 s75, s75, s69
    buffer_load_dwordx4 v[96:99], v13, s[8:11], s75 offen offset:0 sc1
    buffer_load_dwordx4 v[100:103], v13, s[8:11], s75 offen offset:1024 sc1
    buffer_load_dwordx4 v[124:127], v13, s[8:11], s75 offen offset:2048 sc1
    buffer_load_dwordx4 v[108:111], v13, s[8:11], s75 offen offset:3072 sc1
    buffer_load_dwordx4 v[112:115], v52, s[8:11], s75 offen offset:0 sc1
    s_add_u32 s75, s66, 15
    s_and_b32 s75, s75, 15
    s_lshl_b32 s75, s75, 10
    s_add_u32 s75, s75, s68
    buffer_load_dwordx4 v[56:59], v4, s[8:11], s75 offen sc1
    buffer_load_dwordx4 v[20:23], v5, s[8:11], s75 offen sc1
    buffer_load_dwordx4 v[24:27], v6, s[8:11], s75 offen sc1
    buffer_load_dwordx4 v[68:71], v7, s[8:11], s75 offen sc1
    s_waitcnt vmcnt(27)
    v_mfma_f32_16x16x32_bf16 v[176:179], v[60:63], v[144:147], v[176:179]
    v_mfma_f32_16x16x32_bf16 v[180:183], v[60:63], v[128:131], v[180:183]
    v_mfma_f32_16x16x32_bf16 v[184:187], v[60:63], v[132:135], v[184:187]
    v_mfma_f32_16x16x32_bf16 v[188:191], v[60:63], v[72:75], v[188:191]
    v_mfma_f32_16x16x32_bf16 v[192:195], v[64:67], v[144:147], v[192:195]
    v_mfma_f32_16x16x32_bf16 v[196:199], v[64:67], v[128:131], v[196:199]
    v_mfma_f32_16x16x32_bf16 v[200:203], v[64:67], v[132:135], v[200:203]
    v_mfma_f32_16x16x32_bf16 v[204:207], v[64:67], v[72:75], v[204:207]
    v_mfma_f32_16x16x32_bf16 v[208:211], v[40:43], v[144:147], v[208:211]
    v_mfma_f32_16x16x32_bf16 v[212:215], v[40:43], v[128:131], v[212:215]
    v_mfma_f32_16x16x32_bf16 v[216:219], v[40:43], v[132:135], v[216:219]
    v_mfma_f32_16x16x32_bf16 v[220:223], v[40:43], v[72:75], v[220:223]
    v_mfma_f32_16x16x32_bf16 v[224:227], v[136:139], v[144:147], v[224:227]
    v_mfma_f32_16x16x32_bf16 v[228:231], v[136:139], v[128:131], v[228:231]
    v_mfma_f32_16x16x32_bf16 v[232:235], v[136:139], v[132:135], v[232:235]
    v_mfma_f32_16x16x32_bf16 v[236:239], v[136:139], v[72:75], v[236:239]
    v_mfma_f32_16x16x32_bf16 v[240:243], v[140:143], v[144:147], v[240:243]
    v_mfma_f32_16x16x32_bf16 v[244:247], v[140:143], v[128:131], v[244:247]
    v_mfma_f32_16x16x32_bf16 v[248:251], v[140:143], v[132:135], v[248:251]
    v_mfma_f32_16x16x32_bf16 v[252:255], v[140:143], v[72:75], v[252:255]
    s_mov_b32 s12, s32
    s_mov_b32 s13, s33
    s_mov_b32 s14, 0x280000
    s_mov_b32 s15, 0x20000
    v_and_b32 v2, 0x7ff, v51
    s_nop 0
    v_readlane_b32 s84, v2, 0
    v_readlane_b32 s85, v2, 1
    v_readlane_b32 s86, v2, 2
    v_readlane_b32 s87, v2, 3
    v_readlane_b32 s88, v2, 4
    v_readlane_b32 s89, v2, 5
    v_readlane_b32 s90, v2, 6
    v_readlane_b32 s91, v2, 7
    s_movk_i32 s7, 6554
    s_mul_i32 s70, s4, 81920
    s_mul_i32 s6, s5, 160
    s_add_u32 s70, s70, s6
    s_mul_i32 s71, s4, 81920
    s_mul_i32 s6, s5, 2560
    s_add_u32 s71, s71, s6
    v_lshrrev_b32 v2, 4, v0
    v_add_u32 v2, 0, v2
    v_mul_lo_u32 v8, v2, s7
    v_lshrrev_b32 v8, 16, v8
    v_mul_u32_u24 v3, 10, v8
    v_sub_u32 v9, v2, v3
    v_and_b32 v3, 15, v1
    v_lshl_add_u32 v8, v8, 4, v3
    v_mul_u32_u24 v2, 1280, v8
    v_lshl_add_u32 v53, v9, 4, v2
    v_lshrrev_b32 v2, 4, v8
    v_mul_u32_u24 v2, 20480, v2
    v_and_b32 v3, 15, v8
    v_lshl_add_u32 v2, v3, 4, v2
    v_lshl_add_u32 v2, v9, 8, v2
    v_add_u32 v2, s71, v2
    s_lshl_b32 s6, s4, 6
    s_sub_u32 s6, 0x7ff, s6
    v_sub_u32 v3, s6, v8
    s_mul_i32 s6, s5, 160
    s_add_u32 s6, s6, 3837952
    v_lshl_add_u32 v11, v9, 4, s6
    v_cmp_eq_u32 vcc, s84, v3
    s_nop 1
    v_cndmask_b32 v2, v2, v11, vcc
    v_add_u32 v11, 1280, v11
    v_cmp_eq_u32 vcc, s85, v3
    s_nop 1
    v_cndmask_b32 v2, v2, v11, vcc
    v_add_u32 v11, 1280, v11
    v_cmp_eq_u32 vcc, s86, v3
    s_nop 1
    v_cndmask_b32 v2, v2, v11, vcc
    v_add_u32 v11, 1280, v11
    v_cmp_eq_u32 vcc, s87, v3
    s_nop 1
    v_cndmask_b32 v2, v2, v11, vcc
    v_add_u32 v11, 1280, v11
    v_cmp_eq_u32 vcc, s88, v3
    s_nop 1
    v_cndmask_b32 v2, v2, v11, vcc
    v_add_u32 v11, 1280, v11
    v_cmp_eq_u32 vcc, s89, v3
    s_nop 1
    v_cndmask_b32 v2, v2, v11, vcc
    v_add_u32 v11, 1280, v11
    v_cmp_eq_u32 vcc, s90, v3
    s_nop 1
    v_cndmask_b32 v2, v2, v11, vcc
    v_add_u32 v11, 1280, v11
    v_cmp_eq_u32 vcc, s91, v3
    s_nop 1
    v_cndmask_b32 v2, v2, v11, vcc
    buffer_load_dwordx4 v[116:119], v53, s[12:15], s70 offen
    buffer_load_dwordx4 v[120:123], v2, s[8:11], 0 offen sc1
    v_lshrrev_b32 v2, 4, v0
    v_add_u32 v2, 32, v2
    v_mul_lo_u32 v10, v2, s7
    v_lshrrev_b32 v10, 16, v10
    v_mul_u32_u24 v3, 10, v10
    v_sub_u32 v55, v2, v3
    v_and_b32 v3, 15, v1
    v_lshl_add_u32 v10, v10, 4, v3
    v_mul_u32_u24 v2, 1280, v10
    v_lshl_add_u32 v54, v55, 4, v2
    v_lshrrev_b32 v2, 4, v10
    v_mul_u32_u24 v2, 20480, v2
    v_and_b32 v3, 15, v10
    v_lshl_add_u32 v2, v3, 4, v2
    v_lshl_add_u32 v2, v55, 8, v2
    v_add_u32 v2, s71, v2
    s_lshl_b32 s6, s4, 6
    s_sub_u32 s6, 0x7ff, s6
    v_sub_u32 v3, s6, v10
    s_mul_i32 s6, s5, 160
    s_add_u32 s6, s6, 3837952
    v_lshl_add_u32 v11, v55, 4, s6
    v_cmp_eq_u32 vcc, s84, v3
    s_nop 1
    v_cndmask_b32 v2, v2, v11, vcc
    v_add_u32 v11, 1280, v11
    v_cmp_eq_u32 vcc, s85, v3
    s_nop 1
    v_cndmask_b32 v2, v2, v11, vcc
    v_add_u32 v11, 1280, v11
    v_cmp_eq_u32 vcc, s86, v3
    s_nop 1
    v_cndmask_b32 v2, v2, v11, vcc
    v_add_u32 v11, 1280, v11
    v_cmp_eq_u32 vcc, s87, v3
    s_nop 1
    v_cndmask_b32 v2, v2, v11, vcc
    v_add_u32 v11, 1280, v11
    v_cmp_eq_u32 vcc, s88, v3
    s_nop 1
    v_cndmask_b32 v2, v2, v11, vcc
    v_add_u32 v11, 1280, v11
    v_cmp_eq_u32 vcc, s89, v3
    s_nop 1
    v_cndmask_b32 v2, v2, v11, vcc
    v_add_u32 v11, 1280, v11
    v_cmp_eq_u32 vcc, s90, v3
    s_nop 1
    v_cndmask_b32 v2, v2, v11, vcc
    v_add_u32 v11, 1280, v11
    v_cmp_eq_u32 vcc, s91, v3
    s_nop 1
    v_cndmask_b32 v2, v2, v11, vcc
    s_cmp_ge_u32 s3, 2
    s_cbranch_scc1 L_itskip_50
    buffer_load_dwordx4 v[144:147], v54, s[12:15], s70 offen
    buffer_load_dwordx4 v[128:131], v2, s[8:11], 0 offen sc1
L_itskip_50:
    s_waitcnt vmcnt(18)
    v_mfma_f32_16x16x32_bf16 v[176:179], v[32:35], v[164:167], v[176:179]
    v_mfma_f32_16x16x32_bf16 v[180:183], v[32:35], v[148:151], v[180:183]
    v_mfma_f32_16x16x32_bf16 v[184:187], v[32:35], v[152:155], v[184:187]
    v_mfma_f32_16x16x32_bf16 v[188:191], v[32:35], v[44:47], v[188:191]
    v_mfma_f32_16x16x32_bf16 v[192:195], v[36:39], v[164:167], v[192:195]
    v_mfma_f32_16x16x32_bf16 v[196:199], v[36:39], v[148:151], v[196:199]
    v_mfma_f32_16x16x32_bf16 v[200:203], v[36:39], v[152:155], v[200:203]
    v_mfma_f32_16x16x32_bf16 v[204:207], v[36:39], v[44:47], v[204:207]
    v_mfma_f32_16x16x32_bf16 v[208:211], v[84:87], v[164:167], v[208:211]
    v_mfma_f32_16x16x32_bf16 v[212:215], v[84:87], v[148:151], v[212:215]
    v_mfma_f32_16x16x32_bf16 v[216:219], v[84:87], v[152:155], v[216:219]
    v_mfma_f32_16x16x32_bf16 v[220:223], v[84:87], v[44:47], v[220:223]
    v_mfma_f32_16x16x32_bf16 v[224:227], v[156:159], v[164:167], v[224:227]
    v_mfma_f32_16x16x32_bf16 v[228:231], v[156:159], v[148:151], v[228:231]
    v_mfma_f32_16x16x32_bf16 v[232:235], v[156:159], v[152:155], v[232:235]
    v_mfma_f32_16x16x32_bf16 v[236:239], v[156:159], v[44:47], v[236:239]
    v_mfma_f32_16x16x32_bf16 v[240:243], v[160:163], v[164:167], v[240:243]
    v_mfma_f32_16x16x32_bf16 v[244:247], v[160:163], v[148:151], v[244:247]
    v_mfma_f32_16x16x32_bf16 v[248:251], v[160:163], v[152:155], v[248:251]
    v_mfma_f32_16x16x32_bf16 v[252:255], v[160:163], v[44:47], v[252:255]
    s_waitcnt vmcnt(9)
    v_mfma_f32_16x16x32_bf16 v[176:179], v[76:79], v[16:19], v[176:179]
    v_mfma_f32_16x16x32_bf16 v[180:183], v[76:79], v[168:171], v[180:183]
    v_mfma_f32_16x16x32_bf16 v[184:187], v[76:79], v[172:175], v[184:187]
    v_mfma_f32_16x16x32_bf16 v[188:191], v[76:79], v[28:31], v[188:191]
    v_mfma_f32_16x16x32_bf16 v[192:195], v[80:83], v[16:19], v[192:195]
    v_mfma_f32_16x16x32_bf16 v[196:199], v[80:83], v[168:171], v[196:199]
    v_mfma_f32_16x16x32_bf16 v[200:203], v[80:83], v[172:175], v[200:203]
    v_mfma_f32_16x16x32_bf16 v[204:207], v[80:83], v[28:31], v[204:207]
    v_mfma_f32_16x16x32_bf16 v[208:211], v[104:107], v[16:19], v[208:211]
    v_mfma_f32_16x16x32_bf16 v[212:215], v[104:107], v[168:171], v[212:215]
    v_mfma_f32_16x16x32_bf16 v[216:219], v[104:107], v[172:175], v[216:219]
    v_mfma_f32_16x16x32_bf16 v[220:223], v[104:107], v[28:31], v[220:223]
    v_mfma_f32_16x16x32_bf16 v[224:227], v[88:91], v[16:19], v[224:227]
    v_mfma_f32_16x16x32_bf16 v[228:231], v[88:91], v[168:171], v[228:231]
    v_mfma_f32_16x16x32_bf16 v[232:235], v[88:91], v[172:175], v[232:235]
    v_mfma_f32_16x16x32_bf16 v[236:239], v[88:91], v[28:31], v[236:239]
    v_mfma_f32_16x16x32_bf16 v[240:243], v[92:95], v[16:19], v[240:243]
    v_mfma_f32_16x16x32_bf16 v[244:247], v[92:95], v[168:171], v[244:247]
    v_mfma_f32_16x16x32_bf16 v[248:251], v[92:95], v[172:175], v[248:251]
    v_mfma_f32_16x16x32_bf16 v[252:255], v[92:95], v[28:31], v[252:255]
    s_waitcnt vmcnt(0)
    v_mfma_f32_16x16x32_bf16 v[176:179], v[96:99], v[56:59], v[176:179]
    v_mfma_f32_16x16x32_bf16 v[180:183], v[96:99], v[20:23], v[180:183]
    v_mfma_f32_16x16x32_bf16 v[184:187], v[96:99], v[24:27], v[184:187]
    v_mfma_f32_16x16x32_bf16 v[188:191], v[96:99], v[68:71], v[188:191]
    v_mfma_f32_16x16x32_bf16 v[192:195], v[100:103], v[56:59], v[192:195]
    v_mfma_f32_16x16x32_bf16 v[196:199], v[100:103], v[20:23], v[196:199]
    v_mfma_f32_16x16x32_bf16 v[200:203], v[100:103], v[24:27], v[200:203]
    v_mfma_f32_16x16x32_bf16 v[204:207], v[100:103], v[68:71], v[204:207]
    v_mfma_f32_16x16x32_bf16 v[208:211], v[124:127], v[56:59], v[208:211]
    v_mfma_f32_16x16x32_bf16 v[212:215], v[124:127], v[20:23], v[212:215]
    v_mfma_f32_16x16x32_bf16 v[216:219], v[124:127], v[24:27], v[216:219]
    v_mfma_f32_16x16x32_bf16 v[220:223], v[124:127], v[68:71], v[220:223]
    v_mfma_f32_16x16x32_bf16 v[224:227], v[108:111], v[56:59], v[224:227]
    v_mfma_f32_16x16x32_bf16 v[228:231], v[108:111], v[20:23], v[228:231]
    v_mfma_f32_16x16x32_bf16 v[232:235], v[108:111], v[24:27], v[232:235]
    v_mfma_f32_16x16x32_bf16 v[236:239], v[108:111], v[68:71], v[236:239]
    v_mfma_f32_16x16x32_bf16 v[240:243], v[112:115], v[56:59], v[240:243]
    v_mfma_f32_16x16x32_bf16 v[244:247], v[112:115], v[20:23], v[244:247]
    v_mfma_f32_16x16x32_bf16 v[248:251], v[112:115], v[24:27], v[248:251]
    v_mfma_f32_16x16x32_bf16 v[252:255], v[112:115], v[68:71], v[252:255]
    s_mul_i32 s6, s3, 20480
    v_add_u32 v2, s6, v13
    s_nop 7
    ds_write_b128 v2, v[176:179] offset:0
    ds_write_b128 v2, v[180:183] offset:1024
    ds_write_b128 v2, v[184:187] offset:2048
    ds_write_b128 v2, v[188:191] offset:3072
    ds_write_b128 v2, v[192:195] offset:4096
    ds_write_b128 v2, v[196:199] offset:5120
    ds_write_b128 v2, v[200:203] offset:6144
    ds_write_b128 v2, v[204:207] offset:7168
    ds_write_b128 v2, v[208:211] offset:8192
    ds_write_b128 v2, v[212:215] offset:9216
    ds_write_b128 v2, v[216:219] offset:10240
    ds_write_b128 v2, v[220:223] offset:11264
    ds_write_b128 v2, v[224:227] offset:12288
    ds_write_b128 v2, v[228:231] offset:13312
    ds_write_b128 v2, v[232:235] offset:14336
    ds_write_b128 v2, v[236:239] offset:15360
    ds_write_b128 v2, v[240:243] offset:16384
    ds_write_b128 v2, v[244:247] offset:17408
    ds_write_b128 v2, v[248:251] offset:18432
    ds_write_b128 v2, v[252:255] offset:19456
    s_mov_b32 s16, s54
    s_mov_b32 s17, s55
    s_mov_b32 s18, 0x280000
    s_mov_b32 s19, 0x20000
    s_waitcnt vmcnt(0) lgkmcnt(0)
    s_barrier
    v_lshrrev_b32 v2, 1, v9
    v_lshlrev_b32 v2, 12, v2
    v_lshrrev_b32 v3, 4, v8
    v_lshl_add_u32 v2, v3, 10, v2
    v_and_b32 v3, 15, v8
    v_lshl_add_u32 v2, v3, 4, v2
    v_and_b32 v3, 1, v9
    v_lshl_add_u32 v2, v3, 9, v2
    v_add_u32 v3, 61440, v2
    v_add_u32 v4, 122880, v2
    ds_read_b128 v[176:179], v2 offset:0
    ds_read_b128 v[180:183], v2 offset:256
    ds_read_b128 v[184:187], v2 offset:20480
    ds_read_b128 v[188:191], v2 offset:20736
    ds_read_b128 v[192:195], v2 offset:40960
    ds_read_b128 v[196:199], v2 offset:41216
    ds_read_b128 v[200:203], v3 offset:0
    ds_read_b128 v[204:207], v3 offset:256
    ds_read_b128 v[208:211], v3 offset:20480
    ds_read_b128 v[212:215], v3 offset:20736
    ds_read_b128 v[216:219], v3 offset:40960
    ds_read_b128 v[220:223], v3 offset:41216
    ds_read_b128 v[224:227], v4 offset:0
    ds_read_b128 v[228:231], v4 offset:256
    ds_read_b128 v[232:235], v4 offset:20480
    ds_read_b128 v[236:239], v4 offset:20736
    s_waitcnt lgkmcnt(12)
    v_add_f32 v176, v176, v184
    v_add_f32 v177, v177, v185
    v_add_f32 v178, v178, v186
    v_add_f32 v179, v179, v187
    v_add_f32 v180, v180, v188
    v_add_f32 v181, v181, v189
    v_add_f32 v182, v182, v190
    v_add_f32 v183, v183, v191
    s_waitcnt lgkmcnt(10)
    v_add_f32 v176, v176, v192
    v_add_f32 v177, v177, v193
    v_add_f32 v178, v178, v194
    v_add_f32 v179, v179, v195
    v_add_f32 v180, v180, v196
    v_add_f32 v181, v181, v197
    v_add_f32 v182, v182, v198
    v_add_f32 v183, v183, v199
    s_waitcnt lgkmcnt(8)
    v_add_f32 v176, v176, v200
    v_add_f32 v177, v177, v201
    v_add_f32 v178, v178, v202
    v_add_f32 v179, v179, v203
    v_add_f32 v180, v180, v204
    v_add_f32 v181, v181, v205
    v_add_f32 v182, v182, v206
    v_add_f32 v183, v183, v207
    s_waitcnt lgkmcnt(6)
    v_add_f32 v176, v176, v208
    v_add_f32 v177, v177, v209
    v_add_f32 v178, v178, v210
    v_add_f32 v179, v179, v211
    v_add_f32 v180, v180, v212
    v_add_f32 v181, v181, v213
    v_add_f32 v182, v182, v214
    v_add_f32 v183, v183, v215
    s_waitcnt lgkmcnt(4)
    v_add_f32 v176, v176, v216
    v_add_f32 v177, v177, v217
    v_add_f32 v178, v178, v218
    v_add_f32 v179, v179, v219
    v_add_f32 v180, v180, v220
    v_add_f32 v181, v181, v221
    v_add_f32 v182, v182, v222
    v_add_f32 v183, v183, v223
    s_waitcnt lgkmcnt(2)
    v_add_f32 v176, v176, v224
    v_add_f32 v177, v177, v225
    v_add_f32 v178, v178, v226
    v_add_f32 v179, v179, v227
    v_add_f32 v180, v180, v228
    v_add_f32 v181, v181, v229
    v_add_f32 v182, v182, v230
    v_add_f32 v183, v183, v231
    s_waitcnt lgkmcnt(0)
    v_add_f32 v176, v176, v232
    v_add_f32 v177, v177, v233
    v_add_f32 v178, v178, v234
    v_add_f32 v179, v179, v235
    v_add_f32 v180, v180, v236
    v_add_f32 v181, v181, v237
    v_add_f32 v182, v182, v238
    v_add_f32 v183, v183, v239
    v_cvt_pk_bf16_f32 v176, v176, v176
    v_lshlrev_b32 v176, 16, v176
    v_lshlrev_b32 v5, 16, v116
    v_lshlrev_b32 v6, 16, v120
    v_add_f32 v176, v176, v5
    v_cvt_pk_bf16_f32 v176, v176, v176
    v_lshlrev_b32 v176, 16, v176
    v_add_f32 v176, v176, v6
    v_cvt_pk_bf16_f32 v177, v177, v177
    v_lshlrev_b32 v177, 16, v177
    v_and_b32 v5, 0xffff0000, v116
    v_and_b32 v6, 0xffff0000, v120
    v_add_f32 v177, v177, v5
    v_cvt_pk_bf16_f32 v177, v177, v177
    v_lshlrev_b32 v177, 16, v177
    v_add_f32 v177, v177, v6
    v_cvt_pk_bf16_f32 v178, v178, v178
    v_lshlrev_b32 v178, 16, v178
    v_lshlrev_b32 v5, 16, v117
    v_lshlrev_b32 v6, 16, v121
    v_add_f32 v178, v178, v5
    v_cvt_pk_bf16_f32 v178, v178, v178
    v_lshlrev_b32 v178, 16, v178
    v_add_f32 v178, v178, v6
    v_cvt_pk_bf16_f32 v179, v179, v179
    v_lshlrev_b32 v179, 16, v179
    v_and_b32 v5, 0xffff0000, v117
    v_and_b32 v6, 0xffff0000, v121
    v_add_f32 v179, v179, v5
    v_cvt_pk_bf16_f32 v179, v179, v179
    v_lshlrev_b32 v179, 16, v179
    v_add_f32 v179, v179, v6
    v_cvt_pk_bf16_f32 v180, v180, v180
    v_lshlrev_b32 v180, 16, v180
    v_lshlrev_b32 v5, 16, v118
    v_lshlrev_b32 v6, 16, v122
    v_add_f32 v180, v180, v5
    v_cvt_pk_bf16_f32 v180, v180, v180
    v_lshlrev_b32 v180, 16, v180
    v_add_f32 v180, v180, v6
    v_cvt_pk_bf16_f32 v181, v181, v181
    v_lshlrev_b32 v181, 16, v181
    v_and_b32 v5, 0xffff0000, v118
    v_and_b32 v6, 0xffff0000, v122
    v_add_f32 v181, v181, v5
    v_cvt_pk_bf16_f32 v181, v181, v181
    v_lshlrev_b32 v181, 16, v181
    v_add_f32 v181, v181, v6
    v_cvt_pk_bf16_f32 v182, v182, v182
    v_lshlrev_b32 v182, 16, v182
    v_lshlrev_b32 v5, 16, v119
    v_lshlrev_b32 v6, 16, v123
    v_add_f32 v182, v182, v5
    v_cvt_pk_bf16_f32 v182, v182, v182
    v_lshlrev_b32 v182, 16, v182
    v_add_f32 v182, v182, v6
    v_cvt_pk_bf16_f32 v183, v183, v183
    v_lshlrev_b32 v183, 16, v183
    v_and_b32 v5, 0xffff0000, v119
    v_and_b32 v6, 0xffff0000, v123
    v_add_f32 v183, v183, v5
    v_cvt_pk_bf16_f32 v183, v183, v183
    v_lshlrev_b32 v183, 16, v183
    v_add_f32 v183, v183, v6
    v_cvt_pk_bf16_f32 v240, v176, v177
    v_cvt_pk_bf16_f32 v241, v178, v179
    v_cvt_pk_bf16_f32 v242, v180, v181
    v_cvt_pk_bf16_f32 v243, v182, v183
    buffer_store_dwordx4 v[240:243], v53, s[16:19], s70 offen
    s_cmp_ge_u32 s3, 2
    s_cbranch_scc1 L_end
    v_lshrrev_b32 v2, 1, v55
    v_lshlrev_b32 v2, 12, v2
    v_lshrrev_b32 v3, 4, v10
    v_lshl_add_u32 v2, v3, 10, v2
    v_and_b32 v3, 15, v10
    v_lshl_add_u32 v2, v3, 4, v2
    v_and_b32 v3, 1, v55
    v_lshl_add_u32 v2, v3, 9, v2
    v_add_u32 v3, 61440, v2
    v_add_u32 v4, 122880, v2
    ds_read_b128 v[176:179], v2 offset:0
    ds_read_b128 v[180:183], v2 offset:256
    ds_read_b128 v[184:187], v2 offset:20480
    ds_read_b128 v[188:191], v2 offset:20736
    ds_read_b128 v[192:195], v2 offset:40960
    ds_read_b128 v[196:199], v2 offset:41216
    ds_read_b128 v[200:203], v3 offset:0
    ds_read_b128 v[204:207], v3 offset:256
    ds_read_b128 v[208:211], v3 offset:20480
    ds_read_b128 v[212:215], v3 offset:20736
    ds_read_b128 v[216:219], v3 offset:40960
    ds_read_b128 v[220:223], v3 offset:41216
    ds_read_b128 v[224:227], v4 offset:0
    ds_read_b128 v[228:231], v4 offset:256
    ds_read_b128 v[232:235], v4 offset:20480
    ds_read_b128 v[236:239], v4 offset:20736
    s_waitcnt lgkmcnt(12)
    v_add_f32 v176, v176, v184
    v_add_f32 v177, v177, v185
    v_add_f32 v178, v178, v186
    v_add_f32 v179, v179, v187
    v_add_f32 v180, v180, v188
    v_add_f32 v181, v181, v189
    v_add_f32 v182, v182, v190
    v_add_f32 v183, v183, v191
    s_waitcnt lgkmcnt(10)
    v_add_f32 v176, v176, v192
    v_add_f32 v177, v177, v193
    v_add_f32 v178, v178, v194
    v_add_f32 v179, v179, v195
    v_add_f32 v180, v180, v196
    v_add_f32 v181, v181, v197
    v_add_f32 v182, v182, v198
    v_add_f32 v183, v183, v199
    s_waitcnt lgkmcnt(8)
    v_add_f32 v176, v176, v200
    v_add_f32 v177, v177, v201
    v_add_f32 v178, v178, v202
    v_add_f32 v179, v179, v203
    v_add_f32 v180, v180, v204
    v_add_f32 v181, v181, v205
    v_add_f32 v182, v182, v206
    v_add_f32 v183, v183, v207
    s_waitcnt lgkmcnt(6)
    v_add_f32 v176, v176, v208
    v_add_f32 v177, v177, v209
    v_add_f32 v178, v178, v210
    v_add_f32 v179, v179, v211
    v_add_f32 v180, v180, v212
    v_add_f32 v181, v181, v213
    v_add_f32 v182, v182, v214
    v_add_f32 v183, v183, v215
    s_waitcnt lgkmcnt(4)
    v_add_f32 v176, v176, v216
    v_add_f32 v177, v177, v217
    v_add_f32 v178, v178, v218
    v_add_f32 v179, v179, v219
    v_add_f32 v180, v180, v220
    v_add_f32 v181, v181, v221
    v_add_f32 v182, v182, v222
    v_add_f32 v183, v183, v223
    s_waitcnt lgkmcnt(2)
    v_add_f32 v176, v176, v224
    v_add_f32 v177, v177, v225
    v_add_f32 v178, v178, v226
    v_add_f32 v179, v179, v227
    v_add_f32 v180, v180, v228
    v_add_f32 v181, v181, v229
    v_add_f32 v182, v182, v230
    v_add_f32 v183, v183, v231
    s_waitcnt lgkmcnt(0)
    v_add_f32 v176, v176, v232
    v_add_f32 v177, v177, v233
    v_add_f32 v178, v178, v234
    v_add_f32 v179, v179, v235
    v_add_f32 v180, v180, v236
    v_add_f32 v181, v181, v237
    v_add_f32 v182, v182, v238
    v_add_f32 v183, v183, v239
    v_cvt_pk_bf16_f32 v176, v176, v176
    v_lshlrev_b32 v176, 16, v176
    v_lshlrev_b32 v5, 16, v144
    v_lshlrev_b32 v6, 16, v128
    v_add_f32 v176, v176, v5
    v_cvt_pk_bf16_f32 v176, v176, v176
    v_lshlrev_b32 v176, 16, v176
    v_add_f32 v176, v176, v6
    v_cvt_pk_bf16_f32 v177, v177, v177
    v_lshlrev_b32 v177, 16, v177
    v_and_b32 v5, 0xffff0000, v144
    v_and_b32 v6, 0xffff0000, v128
    v_add_f32 v177, v177, v5
    v_cvt_pk_bf16_f32 v177, v177, v177
    v_lshlrev_b32 v177, 16, v177
    v_add_f32 v177, v177, v6
    v_cvt_pk_bf16_f32 v178, v178, v178
    v_lshlrev_b32 v178, 16, v178
    v_lshlrev_b32 v5, 16, v145
    v_lshlrev_b32 v6, 16, v129
    v_add_f32 v178, v178, v5
    v_cvt_pk_bf16_f32 v178, v178, v178
    v_lshlrev_b32 v178, 16, v178
    v_add_f32 v178, v178, v6
    v_cvt_pk_bf16_f32 v179, v179, v179
    v_lshlrev_b32 v179, 16, v179
    v_and_b32 v5, 0xffff0000, v145
    v_and_b32 v6, 0xffff0000, v129
    v_add_f32 v179, v179, v5
    v_cvt_pk_bf16_f32 v179, v179, v179
    v_lshlrev_b32 v179, 16, v179
    v_add_f32 v179, v179, v6
    v_cvt_pk_bf16_f32 v180, v180, v180
    v_lshlrev_b32 v180, 16, v180
    v_lshlrev_b32 v5, 16, v146
    v_lshlrev_b32 v6, 16, v130
    v_add_f32 v180, v180, v5
    v_cvt_pk_bf16_f32 v180, v180, v180
    v_lshlrev_b32 v180, 16, v180
    v_add_f32 v180, v180, v6
    v_cvt_pk_bf16_f32 v181, v181, v181
    v_lshlrev_b32 v181, 16, v181
    v_and_b32 v5, 0xffff0000, v146
    v_and_b32 v6, 0xffff0000, v130
    v_add_f32 v181, v181, v5
    v_cvt_pk_bf16_f32 v181, v181, v181
    v_lshlrev_b32 v181, 16, v181
    v_add_f32 v181, v181, v6
    v_cvt_pk_bf16_f32 v182, v182, v182
    v_lshlrev_b32 v182, 16, v182
    v_lshlrev_b32 v5, 16, v147
    v_lshlrev_b32 v6, 16, v131
    v_add_f32 v182, v182, v5
    v_cvt_pk_bf16_f32 v182, v182, v182
    v_lshlrev_b32 v182, 16, v182
    v_add_f32 v182, v182, v6
    v_cvt_pk_bf16_f32 v183, v183, v183
    v_lshlrev_b32 v183, 16, v183
    v_and_b32 v5, 0xffff0000, v147
    v_and_b32 v6, 0xffff0000, v131
    v_add_f32 v183, v183, v5
    v_cvt_pk_bf16_f32 v183, v183, v183
    v_lshlrev_b32 v183, 16, v183
    v_add_f32 v183, v183, v6
    v_cvt_pk_bf16_f32 v244, v176, v177
    v_cvt_pk_bf16_f32 v245, v178, v179
    v_cvt_pk_bf16_f32 v246, v180, v181
    v_cvt_pk_bf16_f32 v247, v182, v183
    buffer_store_dwordx4 v[244:247], v54, s[16:19], s70 offen
L_end:
L_exit:
    s_endpgm
.section .rodata,"a"
.p2align 6
.amdhsa_kernel parallel_sum__compressed_kv_cla__moe_arch_mod__prompt_kernel
  .amdhsa_next_free_vgpr 256
  .amdhsa_next_free_sgpr 102
  .amdhsa_accum_offset 256
  .amdhsa_group_segment_fixed_size 0
  .amdhsa_kernarg_size 112
  .amdhsa_user_sgpr_count 2
  .amdhsa_user_sgpr_kernarg_segment_ptr 1
  .amdhsa_system_sgpr_workgroup_id_x 1
  .amdhsa_float_denorm_mode_32 3
.end_amdhsa_kernel
```

```asm
; @launch grid=(256,1,1) block=(512,1,1) lds=163840
.amdgcn_target "amdgcn-amd-amdhsa--gfx950"
.text
.globl parallel_sum__compressed_kv_cla__moe_arch_mod__prompt_kernel
.p2align 8
.type parallel_sum__compressed_kv_cla__moe_arch_mod__prompt_kernel,@function
parallel_sum__compressed_kv_cla__moe_arch_mod__prompt_kernel:
    s_cmp_ge_u32 s2, 256
    s_cbranch_scc1 L_exit
    s_load_dwordx16 s[32:47], s[0:1], 0
    s_load_dwordx8 s[48:55], s[0:1], 64
    s_load_dwordx4 s[56:59], s[0:1], 96
    v_lshrrev_b32 v2, 6, v0
    v_and_b32 v1, 63, v0
    v_readfirstlane_b32 s3, v2
    s_getpc_b64 s[80:81]
L_pc:
    s_lshr_b32 s6, s2, 3
    s_and_b32 s6, s6, 15
    s_lshl_b32 s6, s6, 12
    s_cmp_lt_u32 s3, 2
    s_cselect_b32 s6, 0, s6
    v_lshl_add_u32 v3, v0, 6, s6
    v_min_u32 v3, L_exit-L_pc, v3
    s_cmp_ge_u32 s3, 3
    s_cbranch_scc1 L_noct
    global_load_dword v11, v3, s[80:81]
L_noct:
    v_lshrrev_b32 v62, 5, v0
    v_and_b32 v62, 7, v62
    v_and_b32 v2, 31, v0
    v_lshlrev_b32 v2, 3, v2
    v_mul_u32_u24 v63, 1280, v62
    v_add_u32 v63, v63, v2
    s_mul_i32 s6, s2, 10240
    v_add_u32 v10, s6, v63
    s_cmp_lt_u32 s3, 4
    s_cbranch_scc1 L_st_k0
    s_waitcnt lgkmcnt(0)
    global_load_dwordx2 v[16:17], v10, s[32:33] offset:0
    global_load_dwordx2 v[18:19], v10, s[32:33] offset:256
    global_load_dwordx2 v[20:21], v10, s[32:33] offset:512
    global_load_dwordx2 v[22:23], v10, s[32:33] offset:768
    global_load_dwordx2 v[24:25], v10, s[32:33] offset:1024
    global_load_dwordx2 v[26:27], v2, s[46:47] offset:0
    global_load_dwordx2 v[28:29], v2, s[46:47] offset:256
    global_load_dwordx2 v[30:31], v2, s[46:47] offset:512
    global_load_dwordx2 v[32:33], v2, s[46:47] offset:768
    global_load_dwordx2 v[34:35], v2, s[46:47] offset:1024
L_st_k0:
    s_and_b32 s6, s2, 7
    s_lshl_b32 s6, s6, 2
    s_lshr_b32 s7, s2, 3
    s_and_b32 s7, s7, 3
    s_add_u32 s4, s6, s7
    s_lshr_b32 s5, s2, 5
    s_and_b32 s76, s3, 3
    v_lshrrev_b32 v2, 3, v1
    v_and_b32 v3, 7, v1
    v_lshrrev_b32 v4, 4, v1
    v_xor_b32 v5, v3, v4
    v_lshlrev_b32 v5, 4, v5
    v_lshl_add_u32 v40, v2, 10, v5
    v_xor_b32 v5, 64, v40
    v_add_u32 v41, 7168, v5
    v_add_u32 v42, 14336, v40
    v_add_u32 v43, 14336, v41
    v_and_b32 v6, 15, v1
    s_lshl_b32 s6, s76, 4
    v_add_u32 v7, s6, v4
    v_lshlrev_b32 v5, 1, v4
    v_xor_b32 v5, v6, v5
    v_lshlrev_b32 v5, 4, v5
    v_lshl_add_u32 v44, v7, 13, v5
    v_add_u32 v45, 31744, v44
    v_xor_b32 v5, 0x80, v44
    v_add_u32 v46, 63488, v5
    v_add_u32 v47, 31744, v46
    s_and_b32 s6, s76, 1
    s_lshl_b32 s6, s6, 20
    s_lshr_b32 s7, s76, 1
    s_lshl_b32 s7, s7, 18
    s_add_u32 s6, s6, s7
    s_lshl_b32 s62, s5, 15
    s_add_u32 s62, s62, s6
    s_lshl_b32 s63, s4, 8
    s_lshl_b32 s64, s76, 13
    s_lshl_b32 s73, s76, 12
    s_add_u32 s73, s73, 32768
    s_waitcnt lgkmcnt(0)
    s_mov_b32 s12, s34
    s_mov_b32 s13, s35
    s_mov_b32 s14, 0x200000
    s_mov_b32 s15, 0x20000
    s_mov_b32 s16, s38
    s_mov_b32 s17, s39
    s_mov_b32 s18, 0x400000
    s_mov_b32 s19, 0x20000
    s_mov_b32 s20, s40
    s_mov_b32 s21, s41
    s_mov_b32 s22, 0x400000
    s_mov_b32 s23, 0x20000
    s_cmp_ge_u32 s3, 4
    s_cbranch_scc1 L_st_v0
    s_mov_b32 m0, s64
    s_add_u32 s72, s62, 524288
    buffer_load_dwordx4 v40, s[12:15], s62 offen offset:0 lds
    buffer_load_dwordx4 v41, s[12:15], s62 offen offset:1024 lds
    buffer_load_dwordx4 v42, s[12:15], s62 offen offset:2048 lds
    buffer_load_dwordx4 v43, s[12:15], s62 offen offset:3072 lds
    s_add_u32 m0, s64, 4096
    s_add_u32 s62, s62, 128
    s_bitset0_b32 s62, 10
    buffer_load_dwordx4 v40, s[12:15], s72 offen offset:0 lds
    buffer_load_dwordx4 v41, s[12:15], s72 offen offset:1024 lds
    buffer_load_dwordx4 v42, s[12:15], s72 offen offset:2048 lds
    buffer_load_dwordx4 v43, s[12:15], s72 offen offset:3072 lds
    s_mov_b32 m0, s73
    s_xor_b32 s64, s64, 0x10000
    buffer_load_dwordx4 v44, s[16:19], s63 offen offset:0 lds
    buffer_load_dwordx4 v45, s[16:19], s63 offen offset:1024 lds
    buffer_load_dwordx4 v46, s[16:19], s63 offen offset:2048 lds
    buffer_load_dwordx4 v47, s[16:19], s63 offen offset:3072 lds
    s_add_u32 m0, s73, 16384
    s_xor_b32 s73, s73, 0x10000
    buffer_load_dwordx4 v44, s[20:23], s63 offen offset:0 lds
    buffer_load_dwordx4 v45, s[20:23], s63 offen offset:1024 lds
    buffer_load_dwordx4 v46, s[20:23], s63 offen offset:2048 lds
    buffer_load_dwordx4 v47, s[20:23], s63 offen offset:3072 lds
    s_add_u32 s63, s63, 524288
    s_bitset0_b32 s63, 22
    s_setprio 1
L_st_v0:
    s_mov_b32 s8, s58
    s_mov_b32 s9, s59
    s_mov_b32 s10, 0x5000000
    s_mov_b32 s11, 0x20000
    s_mov_b32 s24, s36
    s_mov_b32 s25, s37
    s_mov_b32 s26, 0x500000
    s_mov_b32 s27, 0x20000
    v_lshlrev_b32 v13, 4, v1
    s_lshl_b32 s6, s5, 2
    s_add_u32 s7, s6, s3
    s_sub_u32 s6, 56, s6
    s_add_u32 s6, s6, s3
    s_cmp_lt_u32 s3, 4
    s_cselect_b32 s60, s7, s6
    s_xor_b32 s6, s5, 1
    s_lshl_b32 s6, s6, 5
    s_add_u32 s61, s6, s4
    v_and_b32 v2, 15, v1
    v_lshrrev_b32 v3, 4, v1
    s_and_b32 s6, s3, 1
    s_lshl_b32 s6, s6, 7
    v_add_u32 v4, s6, v2
    v_lshlrev_b32 v4, 7, v4
    v_lshrrev_b32 v5, 1, v2
    v_add_u32 v6, 0, v3
    v_xor_b32 v6, v6, v5
    v_lshl_add_u32 v48, v6, 4, v4
    v_add_u32 v6, 4, v3
    v_xor_b32 v6, v6, v5
    v_lshl_add_u32 v49, v6, 4, v4
    v_lshrrev_b32 v4, 2, v2
    v_lshl_add_u32 v5, v3, 3, v4
    v_lshlrev_b32 v5, 8, v5
    v_and_b32 v6, 1, v2
    v_lshl_add_u32 v5, v6, 3, v5
    v_and_b32 v6, 1, v3
    v_lshl_or_b32 v4, v6, 2, v4
    v_lshlrev_b32 v4, 1, v4
    v_bfe_u32 v6, v2, 1, 1
    v_add_u32 v8, 131072, v5
    v_add_u32 v7, 0, v6
    v_xor_b32 v7, v7, v4
    v_lshl_add_u32 v54, v7, 4, v8
    v_add_u32 v7, 2, v6
    v_xor_b32 v7, v7, v4
    v_lshl_add_u32 v55, v7, 4, v8
    v_add_u32 v7, 4, v6
    v_xor_b32 v7, v7, v4
    v_lshl_add_u32 v56, v7, 4, v8
    v_add_u32 v7, 6, v6
    v_xor_b32 v7, v7, v4
    v_lshl_add_u32 v57, v7, 4, v8
    v_add_u32 v7, 8, v6
    v_xor_b32 v7, v7, v4
    v_lshl_add_u32 v58, v7, 4, v8
    v_add_u32 v7, 10, v6
    v_xor_b32 v7, v7, v4
    v_lshl_add_u32 v59, v7, 4, v8
    v_add_u32 v7, 12, v6
    v_xor_b32 v7, v7, v4
    v_lshl_add_u32 v60, v7, 4, v8
    v_add_u32 v7, 14, v6
    v_xor_b32 v7, v7, v4
    v_lshl_add_u32 v61, v7, 4, v8
    s_lshr_b32 s6, s3, 2
    s_lshl_b32 s6, s6, 14
    s_add_u32 s6, s6, 32768
    v_add_u32 v5, s6, v5
    s_lshr_b32 s7, s3, 1
    s_and_b32 s7, s7, 1
    s_lshl_b32 s7, s7, 3
    s_add_u32 s6, s7, 0
    v_add_u32 v7, s6, v6
    v_xor_b32 v7, v7, v4
    v_lshl_add_u32 v50, v7, 4, v5
    s_add_u32 s6, s7, 2
    v_add_u32 v7, s6, v6
    v_xor_b32 v7, v7, v4
    v_lshl_add_u32 v51, v7, 4, v5
    s_add_u32 s6, s7, 4
    v_add_u32 v7, s6, v6
    v_xor_b32 v7, v7, v4
    v_lshl_add_u32 v52, v7, 4, v5
    s_add_u32 s6, s7, 6
    v_add_u32 v7, s6, v6
    v_xor_b32 v7, v7, v4
    v_lshl_add_u32 v53, v7, 4, v5
    v_mov_b64 v[128:129], 0
    v_mov_b64 v[130:131], 0
    v_mov_b64 v[132:133], 0
    v_mov_b64 v[134:135], 0
    v_mov_b64 v[136:137], 0
    v_mov_b64 v[138:139], 0
    v_mov_b64 v[140:141], 0
    v_mov_b64 v[142:143], 0
    v_mov_b64 v[144:145], 0
    v_mov_b64 v[146:147], 0
    v_mov_b64 v[148:149], 0
    v_mov_b64 v[150:151], 0
    v_mov_b64 v[152:153], 0
    v_mov_b64 v[154:155], 0
    v_mov_b64 v[156:157], 0
    v_mov_b64 v[158:159], 0
    v_mov_b64 v[160:161], 0
    v_mov_b64 v[162:163], 0
    v_mov_b64 v[164:165], 0
    v_mov_b64 v[166:167], 0
    v_mov_b64 v[168:169], 0
    v_mov_b64 v[170:171], 0
    v_mov_b64 v[172:173], 0
    v_mov_b64 v[174:175], 0
    v_mov_b64 v[176:177], 0
    v_mov_b64 v[178:179], 0
    v_mov_b64 v[180:181], 0
    v_mov_b64 v[182:183], 0
    v_mov_b64 v[184:185], 0
    v_mov_b64 v[186:187], 0
    v_mov_b64 v[188:189], 0
    v_mov_b64 v[190:191], 0
    v_mov_b64 v[192:193], 0
    v_mov_b64 v[194:195], 0
    v_mov_b64 v[196:197], 0
    v_mov_b64 v[198:199], 0
    v_mov_b64 v[200:201], 0
    v_mov_b64 v[202:203], 0
    v_mov_b64 v[204:205], 0
    v_mov_b64 v[206:207], 0
    v_mov_b64 v[208:209], 0
    v_mov_b64 v[210:211], 0
    v_mov_b64 v[212:213], 0
    v_mov_b64 v[214:215], 0
    v_mov_b64 v[216:217], 0
    v_mov_b64 v[218:219], 0
    v_mov_b64 v[220:221], 0
    v_mov_b64 v[222:223], 0
    v_mov_b64 v[224:225], 0
    v_mov_b64 v[226:227], 0
    v_mov_b64 v[228:229], 0
    v_mov_b64 v[230:231], 0
    v_mov_b64 v[232:233], 0
    v_mov_b64 v[234:235], 0
    v_mov_b64 v[236:237], 0
    v_mov_b64 v[238:239], 0
    v_mov_b64 v[240:241], 0
    v_mov_b64 v[242:243], 0
    v_mov_b64 v[244:245], 0
    v_mov_b64 v[246:247], 0
    v_mov_b64 v[248:249], 0
    v_mov_b64 v[250:251], 0
    v_mov_b64 v[252:253], 0
    v_mov_b64 v[254:255], 0
    v_add_u32 v12, 20480, v13
    s_mul_i32 s70, s60, 40960
    s_mov_b32 s65, 0
    s_lshl_b32 s6, s4, 20
    s_lshl_b32 s7, s5, 13
    s_add_u32 s6, s6, s7
    s_and_b32 s7, s3, 1
    s_lshl_b32 s7, s7, 16
    s_add_u32 s6, s6, s7
    s_add_u32 s67, s6, 16777216
    s_and_b32 s6, s4, 3
    s_add_u32 s6, s6, s5
    s_sub_u32 s7, s6, 5
    s_cselect_b32 s6, s6, s7
    s_sub_u32 s7, s6, 5
    s_cselect_b32 s6, s6, s7
    s_lshl_b32 s71, s6, 20
    s_lshl_b32 s7, s4, 8
    s_add_u32 s71, s71, s7
    s_lshl_b32 s7, s6, 12
    s_add_u32 s84, s70, s7
    s_add_u32 s6, s6, 1
    s_cmp_eq_u32 s6, 5
    s_cselect_b32 s6, 0, s6
    s_lshl_b32 s7, s6, 12
    s_add_u32 s85, s70, s7
    s_add_u32 s6, s6, 1
    s_cmp_eq_u32 s6, 5
    s_cselect_b32 s6, 0, s6
    s_lshl_b32 s7, s6, 12
    s_add_u32 s86, s70, s7
    s_add_u32 s6, s6, 1
    s_cmp_eq_u32 s6, 5
    s_cselect_b32 s6, 0, s6
    s_lshl_b32 s7, s6, 12
    s_add_u32 s87, s70, s7
    s_add_u32 s6, s6, 1
    s_cmp_eq_u32 s6, 5
    s_cselect_b32 s6, 0, s6
    s_lshl_b32 s7, s6, 12
    s_add_u32 s88, s70, s7
    s_lshr_b32 s7, s3, 1
    s_and_b32 s7, s7, 1
    s_cmp_ge_u32 s3, 4
    s_cbranch_scc1 L_c_v
    s_lshl_b32 s7, s7, 11
    s_add_u32 s67, s67, s7
    s_movk_i32 s68, 3072
    s_mov_b32 s69, 125952
    s_add_u32 s71, s71, 1048576
    s_sub_u32 s75, s71, 5242880
    s_cselect_b32 s71, s71, s75
    s_lshl_b32 s74, s76, 12
    s_branch L_c_j
L_c_v:
    s_lshl_b32 s7, s7, 12
    s_add_u32 s67, s67, s7
    s_add_u32 s67, s67, 0x80000
    s_movk_i32 s68, 1024
    s_mov_b32 s69, 128000
L_c_j:
    s_cmp_ge_u32 s3, 4
    s_cbranch_scc1 L_st_v1
    s_mov_b32 m0, s64
    s_add_u32 s72, s62, 524288
    buffer_load_dwordx4 v40, s[12:15], s62 offen offset:0 lds
    buffer_load_dwordx4 v41, s[12:15], s62 offen offset:1024 lds
    buffer_load_dwordx4 v42, s[12:15], s62 offen offset:2048 lds
    buffer_load_dwordx4 v43, s[12:15], s62 offen offset:3072 lds
    s_add_u32 m0, s64, 4096
    s_add_u32 s62, s62, 128
    s_bitset0_b32 s62, 10
    buffer_load_dwordx4 v40, s[12:15], s72 offen offset:0 lds
    buffer_load_dwordx4 v41, s[12:15], s72 offen offset:1024 lds
    buffer_load_dwordx4 v42, s[12:15], s72 offen offset:2048 lds
    buffer_load_dwordx4 v43, s[12:15], s72 offen offset:3072 lds
    s_waitcnt vmcnt(8)
    s_branch L_st_j1
L_st_v1:
    s_waitcnt vmcnt(0)
    v_lshlrev_b32 v64, 16, v16
    v_and_b32 v65, 0xffff0000, v16
    v_lshlrev_b32 v66, 16, v17
    v_and_b32 v67, 0xffff0000, v17
    v_lshlrev_b32 v68, 16, v18
    v_and_b32 v69, 0xffff0000, v18
    v_lshlrev_b32 v70, 16, v19
    v_and_b32 v71, 0xffff0000, v19
    v_lshlrev_b32 v72, 16, v20
    v_and_b32 v73, 0xffff0000, v20
    v_lshlrev_b32 v74, 16, v21
    v_and_b32 v75, 0xffff0000, v21
    v_lshlrev_b32 v76, 16, v22
    v_and_b32 v77, 0xffff0000, v22
    v_lshlrev_b32 v78, 16, v23
    v_and_b32 v79, 0xffff0000, v23
    v_lshlrev_b32 v80, 16, v24
    v_and_b32 v81, 0xffff0000, v24
    v_lshlrev_b32 v82, 16, v25
    v_and_b32 v83, 0xffff0000, v25
    v_pk_add_f32 v[2:3], v[64:65], v[66:67]
    v_pk_add_f32 v[2:3], v[2:3], v[68:69]
    v_pk_add_f32 v[2:3], v[2:3], v[70:71]
    v_pk_add_f32 v[2:3], v[2:3], v[72:73]
    v_pk_add_f32 v[2:3], v[2:3], v[74:75]
    v_pk_add_f32 v[2:3], v[2:3], v[76:77]
    v_pk_add_f32 v[2:3], v[2:3], v[78:79]
    v_pk_add_f32 v[2:3], v[2:3], v[80:81]
    v_pk_add_f32 v[2:3], v[2:3], v[82:83]
    v_add_f32 v2, v2, v3
    s_nop 1
    v_add_f32_dpp v2, v2, v2 quad_perm:[1,0,3,2] row_mask:0xf bank_mask:0xf
    s_nop 1
    v_add_f32_dpp v2, v2, v2 quad_perm:[2,3,0,1] row_mask:0xf bank_mask:0xf
    s_nop 1
    v_add_f32_dpp v2, v2, v2 row_half_mirror row_mask:0xf bank_mask:0xf
    s_nop 1
    v_add_f32_dpp v2, v2, v2 row_mirror row_mask:0xf bank_mask:0xf
    v_mov_b32 v8, v2
    s_nop 1
    v_permlane16_swap_b32 v2, v8
    s_nop 1
    v_add_f32 v2, v2, v8
    s_mov_b32 s7, 0x3acccccd
    v_mul_f32 v2, s7, v2
    v_mov_b64 v[4:5], 0
    v_pk_add_f32 v[6:7], v[64:65], v[2:3] op_sel_hi:[1,0] neg_lo:[0,1] neg_hi:[0,1]
    v_pk_fma_f32 v[4:5], v[6:7], v[6:7], v[4:5]
    v_pk_add_f32 v[6:7], v[66:67], v[2:3] op_sel_hi:[1,0] neg_lo:[0,1] neg_hi:[0,1]
    v_pk_fma_f32 v[4:5], v[6:7], v[6:7], v[4:5]
    v_pk_add_f32 v[6:7], v[68:69], v[2:3] op_sel_hi:[1,0] neg_lo:[0,1] neg_hi:[0,1]
    v_pk_fma_f32 v[4:5], v[6:7], v[6:7], v[4:5]
    v_pk_add_f32 v[6:7], v[70:71], v[2:3] op_sel_hi:[1,0] neg_lo:[0,1] neg_hi:[0,1]
    v_pk_fma_f32 v[4:5], v[6:7], v[6:7], v[4:5]
    v_pk_add_f32 v[6:7], v[72:73], v[2:3] op_sel_hi:[1,0] neg_lo:[0,1] neg_hi:[0,1]
    v_pk_fma_f32 v[4:5], v[6:7], v[6:7], v[4:5]
    v_pk_add_f32 v[6:7], v[74:75], v[2:3] op_sel_hi:[1,0] neg_lo:[0,1] neg_hi:[0,1]
    v_pk_fma_f32 v[4:5], v[6:7], v[6:7], v[4:5]
    v_pk_add_f32 v[6:7], v[76:77], v[2:3] op_sel_hi:[1,0] neg_lo:[0,1] neg_hi:[0,1]
    v_pk_fma_f32 v[4:5], v[6:7], v[6:7], v[4:5]
    v_pk_add_f32 v[6:7], v[78:79], v[2:3] op_sel_hi:[1,0] neg_lo:[0,1] neg_hi:[0,1]
    v_pk_fma_f32 v[4:5], v[6:7], v[6:7], v[4:5]
    v_pk_add_f32 v[6:7], v[80:81], v[2:3] op_sel_hi:[1,0] neg_lo:[0,1] neg_hi:[0,1]
    v_pk_fma_f32 v[4:5], v[6:7], v[6:7], v[4:5]
    v_pk_add_f32 v[6:7], v[82:83], v[2:3] op_sel_hi:[1,0] neg_lo:[0,1] neg_hi:[0,1]
    v_pk_fma_f32 v[4:5], v[6:7], v[6:7], v[4:5]
    v_add_f32 v4, v4, v5
    s_nop 1
    v_add_f32_dpp v4, v4, v4 quad_perm:[1,0,3,2] row_mask:0xf bank_mask:0xf
    s_nop 1
    v_add_f32_dpp v4, v4, v4 quad_perm:[2,3,0,1] row_mask:0xf bank_mask:0xf
    s_nop 1
    v_add_f32_dpp v4, v4, v4 row_half_mirror row_mask:0xf bank_mask:0xf
    s_nop 1
    v_add_f32_dpp v4, v4, v4 row_mirror row_mask:0xf bank_mask:0xf
    v_mov_b32 v8, v4
    s_nop 1
    v_permlane16_swap_b32 v4, v8
    s_nop 1
    v_add_f32 v4, v4, v8
    v_mul_f32 v4, s7, v4
    v_cvt_pk_bf16_f32 v2, v2, v2
    v_lshlrev_b32 v2, 16, v2
    v_cvt_pk_bf16_f32 v4, v4, v4
    v_lshlrev_b32 v4, 16, v4
    v_add_f32 v4, 0x3727c5ac, v4
    v_cvt_pk_bf16_f32 v4, v4, v4
    v_lshlrev_b32 v4, 16, v4
    v_sqrt_f32 v4, v4
    s_nop 0
    v_cvt_pk_bf16_f32 v4, v4, v4
    v_lshlrev_b32 v4, 16, v4
    v_rcp_f32 v6, v4
    s_nop 0
    v_fma_f32 v5, -v4, v6, 1.0
    v_fmac_f32 v6, v5, v6
    v_mov_b32 v9, 0
    v_pk_add_f32 v[64:65], v[64:65], v[2:3] op_sel_hi:[1,0] neg_lo:[0,1] neg_hi:[0,1]
    v_cvt_pk_bf16_f32 v5, v64, v65
    v_lshlrev_b32 v64, 16, v5
    v_and_b32 v65, 0xffff0000, v5
    v_pk_mul_f32 v[64:65], v[64:65], v[6:7] op_sel_hi:[1,0]
    v_cvt_pk_bf16_f32 v16, v64, v65
    v_pk_add_f32 v[66:67], v[66:67], v[2:3] op_sel_hi:[1,0] neg_lo:[0,1] neg_hi:[0,1]
    v_cvt_pk_bf16_f32 v5, v66, v67
    v_lshlrev_b32 v66, 16, v5
    v_and_b32 v67, 0xffff0000, v5
    v_pk_mul_f32 v[66:67], v[66:67], v[6:7] op_sel_hi:[1,0]
    v_cvt_pk_bf16_f32 v17, v66, v67
    v_pk_add_f32 v[68:69], v[68:69], v[2:3] op_sel_hi:[1,0] neg_lo:[0,1] neg_hi:[0,1]
    v_cvt_pk_bf16_f32 v5, v68, v69
    v_lshlrev_b32 v68, 16, v5
    v_and_b32 v69, 0xffff0000, v5
    v_pk_mul_f32 v[68:69], v[68:69], v[6:7] op_sel_hi:[1,0]
    v_cvt_pk_bf16_f32 v18, v68, v69
    v_pk_add_f32 v[70:71], v[70:71], v[2:3] op_sel_hi:[1,0] neg_lo:[0,1] neg_hi:[0,1]
    v_cvt_pk_bf16_f32 v5, v70, v71
    v_lshlrev_b32 v70, 16, v5
    v_and_b32 v71, 0xffff0000, v5
    v_pk_mul_f32 v[70:71], v[70:71], v[6:7] op_sel_hi:[1,0]
    v_cvt_pk_bf16_f32 v19, v70, v71
    v_pk_add_f32 v[72:73], v[72:73], v[2:3] op_sel_hi:[1,0] neg_lo:[0,1] neg_hi:[0,1]
    v_cvt_pk_bf16_f32 v5, v72, v73
    v_lshlrev_b32 v72, 16, v5
    v_and_b32 v73, 0xffff0000, v5
    v_pk_mul_f32 v[72:73], v[72:73], v[6:7] op_sel_hi:[1,0]
    v_cvt_pk_bf16_f32 v20, v72, v73
    v_pk_add_f32 v[74:75], v[74:75], v[2:3] op_sel_hi:[1,0] neg_lo:[0,1] neg_hi:[0,1]
    v_cvt_pk_bf16_f32 v5, v74, v75
    v_lshlrev_b32 v74, 16, v5
    v_and_b32 v75, 0xffff0000, v5
    v_pk_mul_f32 v[74:75], v[74:75], v[6:7] op_sel_hi:[1,0]
    v_cvt_pk_bf16_f32 v21, v74, v75
    v_pk_add_f32 v[76:77], v[76:77], v[2:3] op_sel_hi:[1,0] neg_lo:[0,1] neg_hi:[0,1]
    v_cvt_pk_bf16_f32 v5, v76, v77
    v_lshlrev_b32 v76, 16, v5
    v_and_b32 v77, 0xffff0000, v5
    v_pk_mul_f32 v[76:77], v[76:77], v[6:7] op_sel_hi:[1,0]
    v_cvt_pk_bf16_f32 v22, v76, v77
    v_pk_add_f32 v[78:79], v[78:79], v[2:3] op_sel_hi:[1,0] neg_lo:[0,1] neg_hi:[0,1]
    v_cvt_pk_bf16_f32 v5, v78, v79
    v_lshlrev_b32 v78, 16, v5
    v_and_b32 v79, 0xffff0000, v5
    v_pk_mul_f32 v[78:79], v[78:79], v[6:7] op_sel_hi:[1,0]
    v_cvt_pk_bf16_f32 v23, v78, v79
    v_pk_add_f32 v[80:81], v[80:81], v[2:3] op_sel_hi:[1,0] neg_lo:[0,1] neg_hi:[0,1]
    v_cvt_pk_bf16_f32 v5, v80, v81
    v_lshlrev_b32 v80, 16, v5
    v_and_b32 v81, 0xffff0000, v5
    v_pk_mul_f32 v[80:81], v[80:81], v[6:7] op_sel_hi:[1,0]
    v_cvt_pk_bf16_f32 v24, v80, v81
    v_pk_add_f32 v[82:83], v[82:83], v[2:3] op_sel_hi:[1,0] neg_lo:[0,1] neg_hi:[0,1]
    v_cvt_pk_bf16_f32 v5, v82, v83
    v_lshlrev_b32 v82, 16, v5
    v_and_b32 v83, 0xffff0000, v5
    v_pk_mul_f32 v[82:83], v[82:83], v[6:7] op_sel_hi:[1,0]
    v_cvt_pk_bf16_f32 v25, v82, v83
    v_add_u32 v10, 131072, v63
    ds_write_b64 v10, v[16:17] offset:0
    ds_write_b64 v10, v[18:19] offset:256
    ds_write_b64 v10, v[20:21] offset:512
    ds_write_b64 v10, v[22:23] offset:768
    ds_write_b64 v10, v[24:25] offset:1024
    s_waitcnt lgkmcnt(0)
    v_mov_b32 v2, 0
    v_lshlrev_b32 v4, 16, v16
    v_lshlrev_b32 v5, 16, v26
    v_fmac_f32 v2, v4, v5
    v_and_b32 v4, 0xffff0000, v16
    v_and_b32 v5, 0xffff0000, v26
    v_fmac_f32 v2, v4, v5
    v_lshlrev_b32 v4, 16, v17
    v_lshlrev_b32 v5, 16, v27
    v_fmac_f32 v2, v4, v5
    v_and_b32 v4, 0xffff0000, v17
    v_and_b32 v5, 0xffff0000, v27
    v_fmac_f32 v2, v4, v5
    v_lshlrev_b32 v4, 16, v18
    v_lshlrev_b32 v5, 16, v28
    v_fmac_f32 v2, v4, v5
    v_and_b32 v4, 0xffff0000, v18
    v_and_b32 v5, 0xffff0000, v28
    v_fmac_f32 v2, v4, v5
    v_lshlrev_b32 v4, 16, v19
    v_lshlrev_b32 v5, 16, v29
    v_fmac_f32 v2, v4, v5
    v_and_b32 v4, 0xffff0000, v19
    v_and_b32 v5, 0xffff0000, v29
    v_fmac_f32 v2, v4, v5
    v_lshlrev_b32 v4, 16, v20
    v_lshlrev_b32 v5, 16, v30
    v_fmac_f32 v2, v4, v5
    v_and_b32 v4, 0xffff0000, v20
    v_and_b32 v5, 0xffff0000, v30
    v_fmac_f32 v2, v4, v5
    v_lshlrev_b32 v4, 16, v21
    v_lshlrev_b32 v5, 16, v31
    v_fmac_f32 v2, v4, v5
    v_and_b32 v4, 0xffff0000, v21
    v_and_b32 v5, 0xffff0000, v31
    v_fmac_f32 v2, v4, v5
    v_lshlrev_b32 v4, 16, v22
    v_lshlrev_b32 v5, 16, v32
    v_fmac_f32 v2, v4, v5
    v_and_b32 v4, 0xffff0000, v22
    v_and_b32 v5, 0xffff0000, v32
    v_fmac_f32 v2, v4, v5
    v_lshlrev_b32 v4, 16, v23
    v_lshlrev_b32 v5, 16, v33
    v_fmac_f32 v2, v4, v5
    v_and_b32 v4, 0xffff0000, v23
    v_and_b32 v5, 0xffff0000, v33
    v_fmac_f32 v2, v4, v5
    v_lshlrev_b32 v4, 16, v24
    v_lshlrev_b32 v5, 16, v34
    v_fmac_f32 v2, v4, v5
    v_and_b32 v4, 0xffff0000, v24
    v_and_b32 v5, 0xffff0000, v34
    v_fmac_f32 v2, v4, v5
    v_lshlrev_b32 v4, 16, v25
    v_lshlrev_b32 v5, 16, v35
    v_fmac_f32 v2, v4, v5
    v_and_b32 v4, 0xffff0000, v25
    v_and_b32 v5, 0xffff0000, v35
    v_fmac_f32 v2, v4, v5
    s_nop 1
    v_add_f32_dpp v2, v2, v2 quad_perm:[1,0,3,2] row_mask:0xf bank_mask:0xf
    s_nop 1
    v_add_f32_dpp v2, v2, v2 quad_perm:[2,3,0,1] row_mask:0xf bank_mask:0xf
    s_nop 1
    v_add_f32_dpp v2, v2, v2 row_half_mirror row_mask:0xf bank_mask:0xf
    s_nop 1
    v_add_f32_dpp v2, v2, v2 row_mirror row_mask:0xf bank_mask:0xf
    v_mov_b32 v8, v2
    s_nop 1
    v_permlane16_swap_b32 v2, v8
    s_nop 1
    v_add_f32 v2, v2, v8
    v_cvt_pk_bf16_f32 v2, v2, v2
    v_and_b32 v2, 0xffff, v2
    v_bfe_i32 v3, v2, 15, 1
    v_and_b32 v3, 0x7fff, v3
    v_or_b32 v3, 0x8000, v3
    v_xor_b32 v2, v2, v3
    s_lshl_b32 s7, s2, 3
    s_sub_u32 s6, 2047, s7
    v_sub_u32 v3, s6, v62
    v_lshl_or_b32 v63, v2, 11, v3
L_st_j1:
    s_barrier
    s_cmp_ge_u32 s3, 4
    s_cbranch_scc1 L_kv_v
    ds_read_b128 v[64:67], v48 offset:0
    ds_read_b128 v[68:71], v48 offset:2048
    ds_read_b64_tr_b16 v[96:97], v50 offset:0
    ds_read_b64_tr_b16 v[98:99], v50 offset:1024
    ds_read_b64_tr_b16 v[100:101], v51 offset:0
    ds_read_b64_tr_b16 v[102:103], v51 offset:1024
    ds_read_b128 v[72:75], v48 offset:4096
    ds_read_b64_tr_b16 v[104:105], v52 offset:0
    ds_read_b64_tr_b16 v[106:107], v52 offset:1024
    ds_read_b64_tr_b16 v[108:109], v53 offset:0
    ds_read_b64_tr_b16 v[110:111], v53 offset:1024
    ds_read_b128 v[76:79], v48 offset:6144
    ds_read_b128 v[80:83], v48 offset:8192
    ds_read_b128 v[84:87], v48 offset:10240
    ds_read_b128 v[88:91], v48 offset:12288
    ds_read_b128 v[92:95], v48 offset:14336
    s_mov_b32 m0, s73
    s_xor_b32 s64, s64, 0x10000
    buffer_load_dwordx4 v44, s[16:19], s63 offen offset:0 lds
    buffer_load_dwordx4 v45, s[16:19], s63 offen offset:1024 lds
    buffer_load_dwordx4 v46, s[16:19], s63 offen offset:2048 lds
    buffer_load_dwordx4 v47, s[16:19], s63 offen offset:3072 lds
    s_add_u32 m0, s73, 16384
    s_xor_b32 s73, s73, 0x10000
    buffer_load_dwordx4 v44, s[20:23], s63 offen offset:0 lds
    buffer_load_dwordx4 v45, s[20:23], s63 offen offset:1024 lds
    buffer_load_dwordx4 v46, s[20:23], s63 offen offset:2048 lds
    buffer_load_dwordx4 v47, s[20:23], s63 offen offset:3072 lds
    s_add_u32 s63, s63, 524288
    s_bitset0_b32 s63, 22
    v_mov_b32 v3, 0x5000000
    v_mov_b32 v2, 0
    s_lshl_b32 s6, s4, 3
    s_add_u32 s6, s6, s5
    s_lshl_b32 s6, s6, 5
    s_add_u32 s6, s6, s3
    s_lshl_b32 s6, s6, 2
    s_add_u32 s6, s6, 3866624
    v_writelane_b32 v3, s6, 0
    s_lshl_b32 s6, s60, 5
    s_add_u32 s6, s6, s4
    s_lshl_b32 s6, s6, 7
    s_add_u32 s6, s6, 3932160
    v_writelane_b32 v3, s6, 1
    s_lshl_b32 s6, s61, 3
    s_add_u32 s6, s6, s3
    s_lshl_b32 s6, s6, 2
    s_add_u32 s6, s6, 3825664
    v_writelane_b32 v3, s6, 2
    s_lshl_b32 s6, s3, 2
    s_add_u32 s6, s6, 3801088
    s_cmp_eq_u32 s2, 31
    s_cselect_b32 s6, s6, 0x5000000
    v_writelane_b32 v3, s6, 3
    s_and_b32 s6, s4, 7
    s_lshl_b32 s7, s5, 3
    s_add_u32 s6, s6, s7
    s_lshr_b32 s7, s4, 3
    s_add_u32 s7, s7, 0
    s_add_u32 s7, s7, 1
    s_and_b32 s7, s7, 3
    s_lshl_b32 s6, s6, 2
    s_add_u32 s6, s6, s7
    s_mul_i32 s6, s6, 3
    s_add_u32 s6, s6, 0
    s_lshl_b32 s6, s6, 5
    s_add_u32 s6, s6, s3
    s_lshl_b32 s6, s6, 2
    s_add_u32 s6, s6, 15728640
    v_writelane_b32 v3, s6, 4
    s_and_b32 s6, s4, 7
    s_lshl_b32 s7, s5, 3
    s_add_u32 s6, s6, s7
    s_lshr_b32 s7, s4, 3
    s_add_u32 s7, s7, 1
    s_add_u32 s7, s7, 1
    s_and_b32 s7, s7, 3
    s_lshl_b32 s6, s6, 2
    s_add_u32 s6, s6, s7
    s_mul_i32 s6, s6, 3
    s_add_u32 s6, s6, 1
    s_lshl_b32 s6, s6, 5
    s_add_u32 s6, s6, s3
    s_lshl_b32 s6, s6, 2
    s_add_u32 s6, s6, 15728640
    v_writelane_b32 v3, s6, 5
    s_and_b32 s6, s4, 7
    s_lshl_b32 s7, s5, 3
    s_add_u32 s6, s6, s7
    s_lshr_b32 s7, s4, 3
    s_add_u32 s7, s7, 2
    s_add_u32 s7, s7, 1
    s_and_b32 s7, s7, 3
    s_lshl_b32 s6, s6, 2
    s_add_u32 s6, s6, s7
    s_mul_i32 s6, s6, 3
    s_add_u32 s6, s6, 2
    s_lshl_b32 s6, s6, 5
    s_add_u32 s6, s6, s3
    s_lshl_b32 s6, s6, 2
    s_add_u32 s6, s6, 15728640
    v_writelane_b32 v3, s6, 6
    s_xor_b32 s6, s5, 1
    s_lshl_b32 s6, s6, 5
    s_add_u32 s6, s6, s4
    s_lshl_b32 s6, s6, 7
    s_add_u32 s6, s6, 3899392
    s_cmp_eq_u32 s3, 0
    s_cselect_b32 s6, s6, 0x5000000
    v_writelane_b32 v3, s6, 7
    buffer_store_dword v2, v3, s[8:11], 0 offen sc1
.p2align 4
L_kloopA:
    s_waitcnt lgkmcnt(12)
    v_mfma_f32_16x16x32_bf16 v[128:131], v[96:99], v[64:67], v[128:131]
    ds_read_b64_tr_b16 v[112:113], v50 offset:8192
    s_waitcnt lgkmcnt(11)
    v_mfma_f32_16x16x32_bf16 v[132:135], v[100:103], v[64:67], v[132:135]
    ds_read_b64_tr_b16 v[114:115], v50 offset:9216
    s_waitcnt lgkmcnt(9)
    v_mfma_f32_16x16x32_bf16 v[136:139], v[104:107], v[64:67], v[136:139]
    ds_read_b64_tr_b16 v[116:117], v51 offset:8192
    s_waitcnt lgkmcnt(8)
    v_mfma_f32_16x16x32_bf16 v[140:143], v[108:111], v[64:67], v[140:143]
    ds_read_b64_tr_b16 v[118:119], v51 offset:9216
    ds_read_b128 v[64:67], v49 offset:0
    v_mfma_f32_16x16x32_bf16 v[144:147], v[96:99], v[68:71], v[144:147]
    ds_read_b64_tr_b16 v[120:121], v52 offset:8192
    v_mfma_f32_16x16x32_bf16 v[148:151], v[100:103], v[68:71], v[148:151]
    ds_read_b64_tr_b16 v[122:123], v52 offset:9216
    v_mfma_f32_16x16x32_bf16 v[152:155], v[104:107], v[68:71], v[152:155]
    ds_read_b64_tr_b16 v[124:125], v53 offset:8192
    v_mfma_f32_16x16x32_bf16 v[156:159], v[108:111], v[68:71], v[156:159]
    ds_read_b64_tr_b16 v[126:127], v53 offset:9216
    ds_read_b128 v[68:71], v49 offset:2048
    v_mfma_f32_16x16x32_bf16 v[160:163], v[96:99], v[72:75], v[160:163]
    v_mfma_f32_16x16x32_bf16 v[164:167], v[100:103], v[72:75], v[164:167]
    v_mfma_f32_16x16x32_bf16 v[168:171], v[104:107], v[72:75], v[168:171]
    v_mfma_f32_16x16x32_bf16 v[172:175], v[108:111], v[72:75], v[172:175]
    ds_read_b128 v[72:75], v49 offset:4096
    s_waitcnt lgkmcnt(15)
    v_mfma_f32_16x16x32_bf16 v[176:179], v[96:99], v[76:79], v[176:179]
    v_mfma_f32_16x16x32_bf16 v[180:183], v[100:103], v[76:79], v[180:183]
    v_mfma_f32_16x16x32_bf16 v[184:187], v[104:107], v[76:79], v[184:187]
    v_mfma_f32_16x16x32_bf16 v[188:191], v[108:111], v[76:79], v[188:191]
    ds_read_b128 v[76:79], v49 offset:6144
    s_waitcnt lgkmcnt(15)
    v_mfma_f32_16x16x32_bf16 v[192:195], v[96:99], v[80:83], v[192:195]
    v_mfma_f32_16x16x32_bf16 v[196:199], v[100:103], v[80:83], v[196:199]
    v_mfma_f32_16x16x32_bf16 v[200:203], v[104:107], v[80:83], v[200:203]
    v_mfma_f32_16x16x32_bf16 v[204:207], v[108:111], v[80:83], v[204:207]
    ds_read_b128 v[80:83], v49 offset:8192
    s_waitcnt lgkmcnt(15)
    v_mfma_f32_16x16x32_bf16 v[208:211], v[96:99], v[84:87], v[208:211]
    v_mfma_f32_16x16x32_bf16 v[212:215], v[100:103], v[84:87], v[212:215]
    v_mfma_f32_16x16x32_bf16 v[216:219], v[104:107], v[84:87], v[216:219]
    v_mfma_f32_16x16x32_bf16 v[220:223], v[108:111], v[84:87], v[220:223]
    ds_read_b128 v[84:87], v49 offset:10240
    s_waitcnt lgkmcnt(15)
    v_mfma_f32_16x16x32_bf16 v[224:227], v[96:99], v[88:91], v[224:227]
    v_mfma_f32_16x16x32_bf16 v[228:231], v[100:103], v[88:91], v[228:231]
    v_mfma_f32_16x16x32_bf16 v[232:235], v[104:107], v[88:91], v[232:235]
    v_mfma_f32_16x16x32_bf16 v[236:239], v[108:111], v[88:91], v[236:239]
    ds_read_b128 v[88:91], v49 offset:12288
    s_waitcnt lgkmcnt(15)
    v_mfma_f32_16x16x32_bf16 v[240:243], v[96:99], v[92:95], v[240:243]
    v_mfma_f32_16x16x32_bf16 v[244:247], v[100:103], v[92:95], v[244:247]
    v_mfma_f32_16x16x32_bf16 v[248:251], v[104:107], v[92:95], v[248:251]
    v_mfma_f32_16x16x32_bf16 v[252:255], v[108:111], v[92:95], v[252:255]
    ds_read_b128 v[92:95], v49 offset:14336
    s_waitcnt lgkmcnt(11)
    v_mfma_f32_16x16x32_bf16 v[128:131], v[112:115], v[64:67], v[128:131]
    v_mfma_f32_16x16x32_bf16 v[132:135], v[116:119], v[64:67], v[132:135]
    s_waitcnt lgkmcnt(9)
    v_mfma_f32_16x16x32_bf16 v[136:139], v[120:123], v[64:67], v[136:139]
    s_waitcnt lgkmcnt(7)
    v_mfma_f32_16x16x32_bf16 v[140:143], v[124:127], v[64:67], v[140:143]
    s_waitcnt lgkmcnt(6)
    v_mfma_f32_16x16x32_bf16 v[144:147], v[112:115], v[68:71], v[144:147]
    v_mfma_f32_16x16x32_bf16 v[148:151], v[116:119], v[68:71], v[148:151]
    v_mfma_f32_16x16x32_bf16 v[152:155], v[120:123], v[68:71], v[152:155]
    v_mfma_f32_16x16x32_bf16 v[156:159], v[124:127], v[68:71], v[156:159]
    v_xor_b32 v48, 0x10000, v48
    v_xor_b32 v49, 0x10000, v49
    v_xor_b32 v50, 0x10000, v50
    v_xor_b32 v51, 0x10000, v51
    v_xor_b32 v52, 0x10000, v52
    v_xor_b32 v53, 0x10000, v53
    s_waitcnt vmcnt(0) lgkmcnt(0)
    s_barrier
    ds_read_b128 v[64:67], v48 offset:0
    ds_read_b128 v[68:71], v48 offset:2048
    v_mfma_f32_16x16x32_bf16 v[160:163], v[112:115], v[72:75], v[160:163]
    ds_read_b64_tr_b16 v[96:97], v50 offset:0
    s_mov_b32 m0, s64
    s_add_u32 s72, s62, 524288
    v_mfma_f32_16x16x32_bf16 v[164:167], v[116:119], v[72:75], v[164:167]
    ds_read_b64_tr_b16 v[98:99], v50 offset:1024
    buffer_load_dwordx4 v40, s[12:15], s62 offen offset:0 lds
    v_mfma_f32_16x16x32_bf16 v[168:171], v[120:123], v[72:75], v[168:171]
    ds_read_b64_tr_b16 v[100:101], v51 offset:0
    buffer_load_dwordx4 v41, s[12:15], s62 offen offset:1024 lds
    v_mfma_f32_16x16x32_bf16 v[172:175], v[124:127], v[72:75], v[172:175]
    ds_read_b64_tr_b16 v[102:103], v51 offset:1024
    buffer_load_dwordx4 v42, s[12:15], s62 offen offset:2048 lds
    ds_read_b128 v[72:75], v48 offset:4096
    v_mfma_f32_16x16x32_bf16 v[176:179], v[112:115], v[76:79], v[176:179]
    ds_read_b64_tr_b16 v[104:105], v52 offset:0
    buffer_load_dwordx4 v43, s[12:15], s62 offen offset:3072 lds
    v_mfma_f32_16x16x32_bf16 v[180:183], v[116:119], v[76:79], v[180:183]
    ds_read_b64_tr_b16 v[106:107], v52 offset:1024
    s_add_u32 m0, s64, 4096
    s_add_u32 s62, s62, 128
    s_bitset0_b32 s62, 10
    v_mfma_f32_16x16x32_bf16 v[184:187], v[120:123], v[76:79], v[184:187]
    ds_read_b64_tr_b16 v[108:109], v53 offset:0
    buffer_load_dwordx4 v40, s[12:15], s72 offen offset:0 lds
    v_mfma_f32_16x16x32_bf16 v[188:191], v[124:127], v[76:79], v[188:191]
    ds_read_b64_tr_b16 v[110:111], v53 offset:1024
    buffer_load_dwordx4 v41, s[12:15], s72 offen offset:1024 lds
    ds_read_b128 v[76:79], v48 offset:6144
    v_mfma_f32_16x16x32_bf16 v[192:195], v[112:115], v[80:83], v[192:195]
    buffer_load_dwordx4 v42, s[12:15], s72 offen offset:2048 lds
    v_mfma_f32_16x16x32_bf16 v[196:199], v[116:119], v[80:83], v[196:199]
    buffer_load_dwordx4 v43, s[12:15], s72 offen offset:3072 lds
    v_mfma_f32_16x16x32_bf16 v[200:203], v[120:123], v[80:83], v[200:203]
    s_mov_b32 m0, s73
    s_xor_b32 s64, s64, 0x10000
    v_mfma_f32_16x16x32_bf16 v[204:207], v[124:127], v[80:83], v[204:207]
    buffer_load_dwordx4 v44, s[16:19], s63 offen offset:0 lds
    ds_read_b128 v[80:83], v48 offset:8192
    v_mfma_f32_16x16x32_bf16 v[208:211], v[112:115], v[84:87], v[208:211]
    buffer_load_dwordx4 v45, s[16:19], s63 offen offset:1024 lds
    v_mfma_f32_16x16x32_bf16 v[212:215], v[116:119], v[84:87], v[212:215]
    buffer_load_dwordx4 v46, s[16:19], s63 offen offset:2048 lds
    v_mfma_f32_16x16x32_bf16 v[216:219], v[120:123], v[84:87], v[216:219]
    buffer_load_dwordx4 v47, s[16:19], s63 offen offset:3072 lds
    v_mfma_f32_16x16x32_bf16 v[220:223], v[124:127], v[84:87], v[220:223]
    s_add_u32 m0, s73, 16384
    s_xor_b32 s73, s73, 0x10000
    ds_read_b128 v[84:87], v48 offset:10240
    v_mfma_f32_16x16x32_bf16 v[224:227], v[112:115], v[88:91], v[224:227]
    buffer_load_dwordx4 v44, s[20:23], s63 offen offset:0 lds
    v_mfma_f32_16x16x32_bf16 v[228:231], v[116:119], v[88:91], v[228:231]
    buffer_load_dwordx4 v45, s[20:23], s63 offen offset:1024 lds
    v_mfma_f32_16x16x32_bf16 v[232:235], v[120:123], v[88:91], v[232:235]
    buffer_load_dwordx4 v46, s[20:23], s63 offen offset:2048 lds
    v_mfma_f32_16x16x32_bf16 v[236:239], v[124:127], v[88:91], v[236:239]
    buffer_load_dwordx4 v47, s[20:23], s63 offen offset:3072 lds
    ds_read_b128 v[88:91], v48 offset:12288
    v_mfma_f32_16x16x32_bf16 v[240:243], v[112:115], v[92:95], v[240:243]
    s_add_u32 s63, s63, 524288
    s_bitset0_b32 s63, 22
    v_mfma_f32_16x16x32_bf16 v[244:247], v[116:119], v[92:95], v[244:247]
    v_mfma_f32_16x16x32_bf16 v[248:251], v[120:123], v[92:95], v[248:251]
    v_mfma_f32_16x16x32_bf16 v[252:255], v[124:127], v[92:95], v[252:255]
    ds_read_b128 v[92:95], v48 offset:14336
    s_add_u32 s65, s65, 1
    s_cmp_lt_u32 s65, 6
    s_cbranch_scc1 L_kloopA
.p2align 4
L_kloopB:
    s_branch L_khook
L_khook_back:
    s_waitcnt lgkmcnt(12)
    v_mfma_f32_16x16x32_bf16 v[128:131], v[96:99], v[64:67], v[128:131]
    ds_read_b64_tr_b16 v[112:113], v50 offset:8192
    s_waitcnt lgkmcnt(11)
    v_mfma_f32_16x16x32_bf16 v[132:135], v[100:103], v[64:67], v[132:135]
    ds_read_b64_tr_b16 v[114:115], v50 offset:9216
    s_waitcnt lgkmcnt(9)
    v_mfma_f32_16x16x32_bf16 v[136:139], v[104:107], v[64:67], v[136:139]
    ds_read_b64_tr_b16 v[116:117], v51 offset:8192
    s_waitcnt lgkmcnt(8)
    v_mfma_f32_16x16x32_bf16 v[140:143], v[108:111], v[64:67], v[140:143]
    ds_read_b64_tr_b16 v[118:119], v51 offset:9216
    ds_read_b128 v[64:67], v49 offset:0
    v_mfma_f32_16x16x32_bf16 v[144:147], v[96:99], v[68:71], v[144:147]
    ds_read_b64_tr_b16 v[120:121], v52 offset:8192
    v_mfma_f32_16x16x32_bf16 v[148:151], v[100:103], v[68:71], v[148:151]
    ds_read_b64_tr_b16 v[122:123], v52 offset:9216
    v_mfma_f32_16x16x32_bf16 v[152:155], v[104:107], v[68:71], v[152:155]
    ds_read_b64_tr_b16 v[124:125], v53 offset:8192
    v_mfma_f32_16x16x32_bf16 v[156:159], v[108:111], v[68:71], v[156:159]
    ds_read_b64_tr_b16 v[126:127], v53 offset:9216
    ds_read_b128 v[68:71], v49 offset:2048
    v_mfma_f32_16x16x32_bf16 v[160:163], v[96:99], v[72:75], v[160:163]
    v_mfma_f32_16x16x32_bf16 v[164:167], v[100:103], v[72:75], v[164:167]
    v_mfma_f32_16x16x32_bf16 v[168:171], v[104:107], v[72:75], v[168:171]
    v_mfma_f32_16x16x32_bf16 v[172:175], v[108:111], v[72:75], v[172:175]
    ds_read_b128 v[72:75], v49 offset:4096
    s_waitcnt lgkmcnt(15)
    v_mfma_f32_16x16x32_bf16 v[176:179], v[96:99], v[76:79], v[176:179]
    v_mfma_f32_16x16x32_bf16 v[180:183], v[100:103], v[76:79], v[180:183]
    v_mfma_f32_16x16x32_bf16 v[184:187], v[104:107], v[76:79], v[184:187]
    v_mfma_f32_16x16x32_bf16 v[188:191], v[108:111], v[76:79], v[188:191]
    ds_read_b128 v[76:79], v49 offset:6144
    s_waitcnt lgkmcnt(15)
    v_mfma_f32_16x16x32_bf16 v[192:195], v[96:99], v[80:83], v[192:195]
    v_mfma_f32_16x16x32_bf16 v[196:199], v[100:103], v[80:83], v[196:199]
    v_mfma_f32_16x16x32_bf16 v[200:203], v[104:107], v[80:83], v[200:203]
    v_mfma_f32_16x16x32_bf16 v[204:207], v[108:111], v[80:83], v[204:207]
    ds_read_b128 v[80:83], v49 offset:8192
    s_waitcnt lgkmcnt(15)
    v_mfma_f32_16x16x32_bf16 v[208:211], v[96:99], v[84:87], v[208:211]
    v_mfma_f32_16x16x32_bf16 v[212:215], v[100:103], v[84:87], v[212:215]
    v_mfma_f32_16x16x32_bf16 v[216:219], v[104:107], v[84:87], v[216:219]
    v_mfma_f32_16x16x32_bf16 v[220:223], v[108:111], v[84:87], v[220:223]
    ds_read_b128 v[84:87], v49 offset:10240
    s_waitcnt lgkmcnt(15)
    v_mfma_f32_16x16x32_bf16 v[224:227], v[96:99], v[88:91], v[224:227]
    v_mfma_f32_16x16x32_bf16 v[228:231], v[100:103], v[88:91], v[228:231]
    v_mfma_f32_16x16x32_bf16 v[232:235], v[104:107], v[88:91], v[232:235]
    v_mfma_f32_16x16x32_bf16 v[236:239], v[108:111], v[88:91], v[236:239]
    ds_read_b128 v[88:91], v49 offset:12288
    s_waitcnt lgkmcnt(15)
    v_mfma_f32_16x16x32_bf16 v[240:243], v[96:99], v[92:95], v[240:243]
    v_mfma_f32_16x16x32_bf16 v[244:247], v[100:103], v[92:95], v[244:247]
    v_mfma_f32_16x16x32_bf16 v[248:251], v[104:107], v[92:95], v[248:251]
    v_mfma_f32_16x16x32_bf16 v[252:255], v[108:111], v[92:95], v[252:255]
    ds_read_b128 v[92:95], v49 offset:14336
    s_waitcnt lgkmcnt(11)
    v_mfma_f32_16x16x32_bf16 v[128:131], v[112:115], v[64:67], v[128:131]
    v_mfma_f32_16x16x32_bf16 v[132:135], v[116:119], v[64:67], v[132:135]
    s_waitcnt lgkmcnt(9)
    v_mfma_f32_16x16x32_bf16 v[136:139], v[120:123], v[64:67], v[136:139]
    s_waitcnt lgkmcnt(7)
    v_mfma_f32_16x16x32_bf16 v[140:143], v[124:127], v[64:67], v[140:143]
    s_waitcnt lgkmcnt(6)
    v_mfma_f32_16x16x32_bf16 v[144:147], v[112:115], v[68:71], v[144:147]
    v_mfma_f32_16x16x32_bf16 v[148:151], v[116:119], v[68:71], v[148:151]
    v_mfma_f32_16x16x32_bf16 v[152:155], v[120:123], v[68:71], v[152:155]
    v_mfma_f32_16x16x32_bf16 v[156:159], v[124:127], v[68:71], v[156:159]
    v_xor_b32 v48, 0x10000, v48
    v_xor_b32 v49, 0x10000, v49
    v_xor_b32 v50, 0x10000, v50
    v_xor_b32 v51, 0x10000, v51
    v_xor_b32 v52, 0x10000, v52
    v_xor_b32 v53, 0x10000, v53
    s_waitcnt vmcnt(0) lgkmcnt(0)
    s_barrier
    ds_read_b128 v[64:67], v48 offset:0
    ds_read_b128 v[68:71], v48 offset:2048
    v_mfma_f32_16x16x32_bf16 v[160:163], v[112:115], v[72:75], v[160:163]
    ds_read_b64_tr_b16 v[96:97], v50 offset:0
    s_mov_b32 m0, s74
    s_add_u32 s74, s74, 16384
    v_mfma_f32_16x16x32_bf16 v[164:167], v[116:119], v[72:75], v[164:167]
    ds_read_b64_tr_b16 v[98:99], v50 offset:1024
    buffer_load_dwordx4 v44, s[24:27], s71 offen offset:0 lds
    v_mfma_f32_16x16x32_bf16 v[168:171], v[120:123], v[72:75], v[168:171]
    ds_read_b64_tr_b16 v[100:101], v51 offset:0
    buffer_load_dwordx4 v45, s[24:27], s71 offen offset:1024 lds
    v_mfma_f32_16x16x32_bf16 v[172:175], v[124:127], v[72:75], v[172:175]
    ds_read_b64_tr_b16 v[102:103], v51 offset:1024
    buffer_load_dwordx4 v46, s[24:27], s71 offen offset:2048 lds
    ds_read_b128 v[72:75], v48 offset:4096
    v_mfma_f32_16x16x32_bf16 v[176:179], v[112:115], v[76:79], v[176:179]
    ds_read_b64_tr_b16 v[104:105], v52 offset:0
    buffer_load_dwordx4 v47, s[24:27], s71 offen offset:3072 lds
    v_mfma_f32_16x16x32_bf16 v[180:183], v[116:119], v[76:79], v[180:183]
    ds_read_b64_tr_b16 v[106:107], v52 offset:1024
    s_add_u32 s71, s71, 524288
    s_sub_u32 s75, s71, 5242880
    s_cselect_b32 s71, s71, s75
    v_mfma_f32_16x16x32_bf16 v[184:187], v[120:123], v[76:79], v[184:187]
    ds_read_b64_tr_b16 v[108:109], v53 offset:0
    s_mov_b32 m0, s74
    s_add_u32 s74, s74, 16384
    v_mfma_f32_16x16x32_bf16 v[188:191], v[124:127], v[76:79], v[188:191]
    ds_read_b64_tr_b16 v[110:111], v53 offset:1024
    buffer_load_dwordx4 v44, s[24:27], s71 offen offset:0 lds
    ds_read_b128 v[76:79], v48 offset:6144
    v_mfma_f32_16x16x32_bf16 v[192:195], v[112:115], v[80:83], v[192:195]
    buffer_load_dwordx4 v45, s[24:27], s71 offen offset:1024 lds
    v_mfma_f32_16x16x32_bf16 v[196:199], v[116:119], v[80:83], v[196:199]
    buffer_load_dwordx4 v46, s[24:27], s71 offen offset:2048 lds
    v_mfma_f32_16x16x32_bf16 v[200:203], v[120:123], v[80:83], v[200:203]
    buffer_load_dwordx4 v47, s[24:27], s71 offen offset:3072 lds
    v_mfma_f32_16x16x32_bf16 v[204:207], v[124:127], v[80:83], v[204:207]
    s_add_u32 s71, s71, 524288
    s_sub_u32 s75, s71, 5242880
    s_cselect_b32 s71, s71, s75
    ds_read_b128 v[80:83], v48 offset:8192
    v_mfma_f32_16x16x32_bf16 v[208:211], v[112:115], v[84:87], v[208:211]
    s_mov_b32 m0, s74
    s_add_u32 s74, s74, 16384
    v_mfma_f32_16x16x32_bf16 v[212:215], v[116:119], v[84:87], v[212:215]
    buffer_load_dwordx4 v44, s[24:27], s71 offen offset:0 lds
    v_mfma_f32_16x16x32_bf16 v[216:219], v[120:123], v[84:87], v[216:219]
    buffer_load_dwordx4 v45, s[24:27], s71 offen offset:1024 lds
    v_mfma_f32_16x16x32_bf16 v[220:223], v[124:127], v[84:87], v[220:223]
    buffer_load_dwordx4 v46, s[24:27], s71 offen offset:2048 lds
    ds_read_b128 v[84:87], v48 offset:10240
    v_mfma_f32_16x16x32_bf16 v[224:227], v[112:115], v[88:91], v[224:227]
    buffer_load_dwordx4 v47, s[24:27], s71 offen offset:3072 lds
    v_mfma_f32_16x16x32_bf16 v[228:231], v[116:119], v[88:91], v[228:231]
    s_add_u32 s71, s71, 524288
    s_sub_u32 s75, s71, 5242880
    s_cselect_b32 s71, s71, s75
    v_mfma_f32_16x16x32_bf16 v[232:235], v[120:123], v[88:91], v[232:235]
    s_mov_b32 m0, s74
    s_add_u32 s74, s74, 16384
    v_mfma_f32_16x16x32_bf16 v[236:239], v[124:127], v[88:91], v[236:239]
    buffer_load_dwordx4 v44, s[24:27], s71 offen offset:0 lds
    ds_read_b128 v[88:91], v48 offset:12288
    v_mfma_f32_16x16x32_bf16 v[240:243], v[112:115], v[92:95], v[240:243]
    buffer_load_dwordx4 v45, s[24:27], s71 offen offset:1024 lds
    v_mfma_f32_16x16x32_bf16 v[244:247], v[116:119], v[92:95], v[244:247]
    buffer_load_dwordx4 v46, s[24:27], s71 offen offset:2048 lds
    v_mfma_f32_16x16x32_bf16 v[248:251], v[120:123], v[92:95], v[248:251]
    buffer_load_dwordx4 v47, s[24:27], s71 offen offset:3072 lds
    v_mfma_f32_16x16x32_bf16 v[252:255], v[124:127], v[92:95], v[252:255]
    s_add_u32 s71, s71, 524288
    s_sub_u32 s75, s71, 5242880
    s_cselect_b32 s71, s71, s75
    ds_read_b128 v[92:95], v48 offset:14336
    s_add_u32 s65, s65, 1
    s_cmp_lt_u32 s65, 8
    s_cbranch_scc1 L_kloopB
    s_waitcnt lgkmcnt(0)
    s_nop 7
    v_cvt_pk_bf16_f32 v128, v128, v129
    v_cvt_pk_bf16_f32 v129, v130, v131
    v_cvt_pk_bf16_f32 v130, v132, v133
    v_cvt_pk_bf16_f32 v131, v134, v135
    v_cvt_pk_bf16_f32 v132, v136, v137
    v_cvt_pk_bf16_f32 v133, v138, v139
    v_cvt_pk_bf16_f32 v134, v140, v141
    v_cvt_pk_bf16_f32 v135, v142, v143
    v_cvt_pk_bf16_f32 v136, v144, v145
    v_cvt_pk_bf16_f32 v137, v146, v147
    v_cvt_pk_bf16_f32 v138, v148, v149
    v_cvt_pk_bf16_f32 v139, v150, v151
    v_cvt_pk_bf16_f32 v140, v152, v153
    v_cvt_pk_bf16_f32 v141, v154, v155
    v_cvt_pk_bf16_f32 v142, v156, v157
    v_cvt_pk_bf16_f32 v143, v158, v159
    v_cvt_pk_bf16_f32 v144, v160, v161
    v_cvt_pk_bf16_f32 v145, v162, v163
    v_cvt_pk_bf16_f32 v146, v164, v165
    v_cvt_pk_bf16_f32 v147, v166, v167
    v_cvt_pk_bf16_f32 v148, v168, v169
    v_cvt_pk_bf16_f32 v149, v170, v171
    v_cvt_pk_bf16_f32 v150, v172, v173
    v_cvt_pk_bf16_f32 v151, v174, v175
    v_cvt_pk_bf16_f32 v152, v176, v177
    v_cvt_pk_bf16_f32 v153, v178, v179
    v_cvt_pk_bf16_f32 v154, v180, v181
    v_cvt_pk_bf16_f32 v155, v182, v183
    v_cvt_pk_bf16_f32 v156, v184, v185
    v_cvt_pk_bf16_f32 v157, v186, v187
    v_cvt_pk_bf16_f32 v158, v188, v189
    v_cvt_pk_bf16_f32 v159, v190, v191
    v_cvt_pk_bf16_f32 v160, v192, v193
    v_cvt_pk_bf16_f32 v161, v194, v195
    v_cvt_pk_bf16_f32 v162, v196, v197
    v_cvt_pk_bf16_f32 v163, v198, v199
    v_cvt_pk_bf16_f32 v164, v200, v201
    v_cvt_pk_bf16_f32 v165, v202, v203
    v_cvt_pk_bf16_f32 v166, v204, v205
    v_cvt_pk_bf16_f32 v167, v206, v207
    v_cvt_pk_bf16_f32 v168, v208, v209
    v_cvt_pk_bf16_f32 v169, v210, v211
    v_cvt_pk_bf16_f32 v170, v212, v213
    v_cvt_pk_bf16_f32 v171, v214, v215
    v_cvt_pk_bf16_f32 v172, v216, v217
    v_cvt_pk_bf16_f32 v173, v218, v219
    v_cvt_pk_bf16_f32 v174, v220, v221
    v_cvt_pk_bf16_f32 v175, v222, v223
    v_cvt_pk_bf16_f32 v176, v224, v225
    v_cvt_pk_bf16_f32 v177, v226, v227
    v_cvt_pk_bf16_f32 v178, v228, v229
    v_cvt_pk_bf16_f32 v179, v230, v231
    v_cvt_pk_bf16_f32 v180, v232, v233
    v_cvt_pk_bf16_f32 v181, v234, v235
    v_cvt_pk_bf16_f32 v182, v236, v237
    v_cvt_pk_bf16_f32 v183, v238, v239
    v_cvt_pk_bf16_f32 v184, v240, v241
    v_cvt_pk_bf16_f32 v185, v242, v243
    v_cvt_pk_bf16_f32 v186, v244, v245
    v_cvt_pk_bf16_f32 v187, v246, v247
    v_cvt_pk_bf16_f32 v188, v248, v249
    v_cvt_pk_bf16_f32 v189, v250, v251
    v_cvt_pk_bf16_f32 v190, v252, v253
    v_cvt_pk_bf16_f32 v191, v254, v255
    s_branch L_q
L_hook:
    s_cmp_eq_u32 s65, 1
    s_cbranch_scc1 L_hook1
    s_cmp_eq_u32 s65, 2
    s_cbranch_scc1 L_hook2
    s_cmp_eq_u32 s65, 4
    s_cbranch_scc1 L_hook4
    s_cmp_eq_u32 s65, 5
    s_cbranch_scc1 L_hook5
    s_cmp_eq_u32 s65, 6
    s_cbranch_scc1 L_hook6
    s_cmp_lg_u32 s65, 7
    s_cbranch_scc1 L_hook_back
    buffer_load_dwordx4 v[16:19], v13, s[8:11], s84 offen offset:0 sc1
    buffer_load_dwordx4 v[20:23], v12, s[8:11], s84 offen offset:0 sc1
    buffer_load_dwordx4 v[24:27], v13, s[8:11], s84 offen offset:1024 sc1
    buffer_load_dwordx4 v[28:31], v12, s[8:11], s84 offen offset:1024 sc1
    buffer_load_dwordx4 v[32:35], v13, s[8:11], s84 offen offset:2048 sc1
    buffer_load_dwordx4 v[36:39], v12, s[8:11], s84 offen offset:2048 sc1
    s_branch L_hook_back
L_hook1:
    s_lshr_b32 s72, s2, 1
    s_mul_i32 s72, s72, 20480
    s_and_b32 s7, s2, 1
    s_lshl_b32 s7, s7, 7
    s_add_u32 s72, s72, s7
    s_mul_i32 s73, s2, 10240
    s_add_u32 s73, s73, 12578816
    v_lshlrev_b32 v9, 4, v0
    v_add_u32 v10, 126976, v9
    v_add_u32 v2, -256, v0
    v_lshrrev_b32 v3, 3, v2
    v_and_b32 v4, 7, v2
    v_mul_u32_u24 v5, 1280, v4
    v_lshl_add_u32 v5, v3, 4, v5
    v_add_u32 v5, 131072, v5
    ds_read_b128 v[16:19], v5
    ds_read_b128 v[20:23], v10 offset:0
    v_lshlrev_b32 v5, 8, v3
    v_lshl_add_u32 v6, v4, 4, v5
    v_add_u32 v2, 0, v0
    v_lshrrev_b32 v3, 3, v2
    v_and_b32 v4, 7, v2
    v_mul_u32_u24 v5, 1280, v4
    v_lshl_add_u32 v5, v3, 4, v5
    v_add_u32 v5, 131072, v5
    ds_read_b128 v[24:27], v5
    ds_read_b128 v[28:31], v10 offset:4096
    v_lshlrev_b32 v5, 8, v3
    v_lshl_add_u32 v7, v4, 4, v5
    v_add_u32 v2, 256, v0
    v_lshrrev_b32 v3, 3, v2
    v_and_b32 v4, 7, v2
    v_mul_u32_u24 v5, 1280, v4
    v_lshl_add_u32 v5, v3, 4, v5
    v_add_u32 v5, 131072, v5
    ds_read_b128 v[32:35], v5
    ds_read_b128 v[36:39], v10 offset:8192
    v_lshlrev_b32 v5, 8, v3
    v_lshl_add_u32 v8, v4, 4, v5
    v_mov_b32 v3, 0x5000000
    v_mov_b32 v2, 0
    s_lshl_b32 s6, s4, 3
    s_add_u32 s6, s6, s5
    s_lshl_b32 s6, s6, 5
    s_add_u32 s6, s6, s3
    s_lshl_b32 s6, s6, 2
    s_add_u32 s6, s6, 3866624
    v_writelane_b32 v3, s6, 0
    s_lshl_b32 s6, s60, 5
    s_add_u32 s6, s6, s4
    s_lshl_b32 s6, s6, 7
    s_add_u32 s6, s6, 3932160
    v_writelane_b32 v3, s6, 1
    s_lshl_b32 s6, s61, 3
    s_add_u32 s6, s6, s3
    s_lshl_b32 s6, s6, 2
    s_add_u32 s6, s6, 3825664
    v_writelane_b32 v3, s6, 2
    s_lshl_b32 s6, s3, 2
    s_add_u32 s6, s6, 3801088
    s_cmp_eq_u32 s2, 31
    s_cselect_b32 s6, s6, 0x5000000
    v_writelane_b32 v3, s6, 3
    s_and_b32 s6, s4, 7
    s_lshl_b32 s7, s5, 3
    s_add_u32 s6, s6, s7
    s_lshr_b32 s7, s4, 3
    s_add_u32 s7, s7, 0
    s_add_u32 s7, s7, 1
    s_and_b32 s7, s7, 3
    s_lshl_b32 s6, s6, 2
    s_add_u32 s6, s6, s7
    s_mul_i32 s6, s6, 3
    s_add_u32 s6, s6, 0
    s_lshl_b32 s6, s6, 5
    s_add_u32 s6, s6, s3
    s_lshl_b32 s6, s6, 2
    s_add_u32 s6, s6, 15728640
    v_writelane_b32 v3, s6, 4
    s_and_b32 s6, s4, 7
    s_lshl_b32 s7, s5, 3
    s_add_u32 s6, s6, s7
    s_lshr_b32 s7, s4, 3
    s_add_u32 s7, s7, 1
    s_add_u32 s7, s7, 1
    s_and_b32 s7, s7, 3
    s_lshl_b32 s6, s6, 2
    s_add_u32 s6, s6, s7
    s_mul_i32 s6, s6, 3
    s_add_u32 s6, s6, 1
    s_lshl_b32 s6, s6, 5
    s_add_u32 s6, s6, s3
    s_lshl_b32 s6, s6, 2
    s_add_u32 s6, s6, 15728640
    v_writelane_b32 v3, s6, 5
    s_and_b32 s6, s4, 7
    s_lshl_b32 s7, s5, 3
    s_add_u32 s6, s6, s7
    s_lshr_b32 s7, s4, 3
    s_add_u32 s7, s7, 2
    s_add_u32 s7, s7, 1
    s_and_b32 s7, s7, 3
    s_lshl_b32 s6, s6, 2
    s_add_u32 s6, s6, s7
    s_mul_i32 s6, s6, 3
    s_add_u32 s6, s6, 2
    s_lshl_b32 s6, s6, 5
    s_add_u32 s6, s6, s3
    s_lshl_b32 s6, s6, 2
    s_add_u32 s6, s6, 15728640
    v_writelane_b32 v3, s6, 6
    v_cmp_lt_u32 vcc, 7, v1
    s_lshl_b32 s6, s2, 5
    s_lshl_b32 s7, s76, 3
    s_add_u32 s6, s6, s7
    v_cndmask_b32 v2, v2, v63, vcc
    s_add_u32 s6, s6, 2621440
    v_writelane_b32 v3, s6, 31
    s_add_u32 s6, s6, 4
    v_writelane_b32 v3, s6, 63
    buffer_store_dword v2, v3, s[8:11], 0 offen sc1
    s_waitcnt lgkmcnt(0)
    buffer_store_dwordx4 v[16:19], v6, s[8:11], s72 offen sc1
    buffer_store_dwordx4 v[20:23], v9, s[8:11], s73 offen sc1
    s_add_u32 s73, s73, 4096
    buffer_store_dwordx4 v[24:27], v7, s[8:11], s72 offen sc1
    buffer_store_dwordx4 v[28:31], v9, s[8:11], s73 offen sc1
    s_add_u32 s73, s73, 4096
    s_cmp_ge_u32 s3, 6
    s_cbranch_scc1 L_lns
    buffer_store_dwordx4 v[32:35], v8, s[8:11], s72 offen sc1
    buffer_store_dwordx4 v[36:39], v9, s[8:11], s73 offen sc1
    s_add_u32 s73, s73, 4096
L_lns:
    s_cmp_ge_u32 s76, 2
    s_cbranch_scc1 L_tch_1a
    s_and_b32 s6, s4, 3
    s_lshl_b32 s6, s6, 19
    s_lshl_b32 s7, s5, 15
    s_add_u32 s6, s6, s7
    s_lshl_b32 s7, s76, 7
    s_add_u32 s6, s6, s7
    s_add_u32 s6, s6, 512
    v_lshrrev_b32 v6, 1, v1
    v_lshlrev_b32 v6, 10, v6
    v_and_b32 v7, 1, v1
    v_lshl_add_u32 v6, v7, 6, v6
    buffer_load_dword v11, v6, s[12:15], s6 offen
    s_add_u32 s6, s6, 262144
    buffer_load_dword v11, v6, s[12:15], s6 offen
    s_branch L_tch_1c
L_tch_1a:
    v_lshrrev_b32 v6, 5, v1
    v_lshlrev_b32 v6, 6, v6
    v_bfe_u32 v7, v1, 2, 3
    v_add_u32 v6, v6, v7
    v_lshlrev_b32 v6, 13, v6
    v_and_b32 v7, 3, v1
    v_lshl_add_u32 v6, v7, 6, v6
    s_lshl_b32 s6, s4, 8
    s_lshl_b32 s7, s5, 16
    s_add_u32 s6, s6, s7
    s_add_u32 s6, s6, 2097152
    s_cmp_lg_u32 s76, 2
    s_cbranch_scc1 L_tch_1b
    buffer_load_dword v11, v6, s[16:19], s6 offen
    s_branch L_tch_1c
L_tch_1b:
    buffer_load_dword v11, v6, s[20:23], s6 offen
L_tch_1c:
    s_branch L_hook_back
L_hook2:
    s_cmp_ge_u32 s76, 2
    s_cbranch_scc1 L_tch_2a
    s_and_b32 s6, s4, 3
    s_lshl_b32 s6, s6, 19
    s_lshl_b32 s7, s5, 15
    s_add_u32 s6, s6, s7
    s_lshl_b32 s7, s76, 7
    s_add_u32 s6, s6, s7
    s_add_u32 s6, s6, 768
    v_lshrrev_b32 v6, 1, v1
    v_lshlrev_b32 v6, 10, v6
    v_and_b32 v7, 1, v1
    v_lshl_add_u32 v6, v7, 6, v6
    buffer_load_dword v11, v6, s[12:15], s6 offen
    s_add_u32 s6, s6, 262144
    buffer_load_dword v11, v6, s[12:15], s6 offen
    s_branch L_tch_2c
L_tch_2a:
    v_lshrrev_b32 v6, 5, v1
    v_lshlrev_b32 v6, 6, v6
    v_bfe_u32 v7, v1, 2, 3
    v_add_u32 v6, v6, v7
    v_lshlrev_b32 v6, 13, v6
    v_and_b32 v7, 3, v1
    v_lshl_add_u32 v6, v7, 6, v6
    s_lshl_b32 s6, s4, 8
    s_lshl_b32 s7, s5, 16
    s_add_u32 s6, s6, s7
    s_add_u32 s6, s6, 3145728
    s_cmp_lg_u32 s76, 2
    s_cbranch_scc1 L_tch_2b
    buffer_load_dword v11, v6, s[16:19], s6 offen
    s_branch L_tch_2c
L_tch_2b:
    buffer_load_dword v11, v6, s[20:23], s6 offen
L_tch_2c:
    s_mov_b32 s28, s42
    s_mov_b32 s29, s43
    s_mov_b32 s30, 0x500000
    s_mov_b32 s31, 0x20000
    s_lshr_b32 s73, s2, 1
    s_mul_i32 s73, s73, 40960
    s_and_b32 s6, s2, 1
    s_mul_i32 s6, s6, 640
    s_add_u32 s73, s73, s6
    s_movk_i32 s7, 1639
    s_mul_i32 s74, s76, 5120
    s_add_u32 s74, s74, 141312
    s_mul_i32 s6, s76, 320
    v_add_u32 v9, s6, v1
    v_add_u32 v2, 0, v9
    v_mul_lo_u32 v3, v2, s7
    v_lshrrev_b32 v3, 16, v3
    v_mul_u32_u24 v4, 40, v3
    v_sub_u32 v4, v2, v4
    v_mul_u32_u24 v3, 1280, v3
    v_lshl_add_u32 v3, v4, 4, v3
    s_add_u32 m0, s74, 0
    s_nop 0
    buffer_load_dwordx4 v3, s[28:31], s73 offen nt lds
    v_add_u32 v2, 64, v9
    v_mul_lo_u32 v3, v2, s7
    v_lshrrev_b32 v3, 16, v3
    v_mul_u32_u24 v4, 40, v3
    v_sub_u32 v4, v2, v4
    v_mul_u32_u24 v3, 1280, v3
    v_lshl_add_u32 v3, v4, 4, v3
    s_add_u32 m0, s74, 1024
    s_nop 0
    buffer_load_dwordx4 v3, s[28:31], s73 offen nt lds
    v_add_u32 v2, 128, v9
    v_mul_lo_u32 v3, v2, s7
    v_lshrrev_b32 v3, 16, v3
    v_mul_u32_u24 v4, 40, v3
    v_sub_u32 v4, v2, v4
    v_mul_u32_u24 v3, 1280, v3
    v_lshl_add_u32 v3, v4, 4, v3
    s_add_u32 m0, s74, 2048
    s_nop 0
    buffer_load_dwordx4 v3, s[28:31], s73 offen nt lds
    v_add_u32 v2, 192, v9
    v_mul_lo_u32 v3, v2, s7
    v_lshrrev_b32 v3, 16, v3
    v_mul_u32_u24 v4, 40, v3
    v_sub_u32 v4, v2, v4
    v_mul_u32_u24 v3, 1280, v3
    v_lshl_add_u32 v3, v4, 4, v3
    s_add_u32 m0, s74, 3072
    s_nop 0
    buffer_load_dwordx4 v3, s[28:31], s73 offen nt lds
    v_add_u32 v2, 256, v9
    v_mul_lo_u32 v3, v2, s7
    v_lshrrev_b32 v3, 16, v3
    v_mul_u32_u24 v4, 40, v3
    v_sub_u32 v4, v2, v4
    v_mul_u32_u24 v3, 1280, v3
    v_lshl_add_u32 v3, v4, 4, v3
    s_add_u32 m0, s74, 4096
    s_nop 0
    buffer_load_dwordx4 v3, s[28:31], s73 offen nt lds
    s_branch L_hook_back
L_hook4:
    s_cmp_lg_u32 s3, 4
    s_cbranch_scc1 L_hook4b
    s_mov_b32 s28, s56
    s_mov_b32 s29, s57
    s_mov_b32 s30, 0x100
    s_mov_b32 s31, 0x20000
    v_mov_b32 v2, 1
    v_lshlrev_b32 v3, 8, v1
    s_and_b32 s6, s2, 31
    s_lshl_b32 s6, s6, 2
    buffer_atomic_add v2, v3, s[28:31], s6 offen offset:0 sc1
L_hook4b:
    v_and_b32 v2, 15, v1
    v_lshrrev_b32 v3, 4, v1
    v_lshrrev_b32 v4, 2, v2
    v_lshl_add_u32 v4, v3, 2, v4
    v_mul_u32_u24 v4, 640, v4
    v_and_b32 v2, 3, v2
    v_lshl_add_u32 v4, v2, 3, v4
    s_mul_i32 s6, s76, 160
    s_add_u32 s6, s6, 141312
    v_add_u32 v4, s6, v4
    s_mul_i32 s6, s2, 20480
    s_mul_i32 s7, s76, 5120
    s_add_u32 s6, s6, s7
    s_add_u32 s6, s6, 4194304
    s_add_u32 s7, s6, 4096
    ds_read_b64_tr_b16 v[16:17], v4 offset:0
    ds_read_b64_tr_b16 v[18:19], v4 offset:10240
    ds_read_b64_tr_b16 v[20:21], v4 offset:32
    ds_read_b64_tr_b16 v[22:23], v4 offset:10272
    ds_read_b64_tr_b16 v[24:25], v4 offset:64
    ds_read_b64_tr_b16 v[26:27], v4 offset:10304
    ds_read_b64_tr_b16 v[28:29], v4 offset:96
    ds_read_b64_tr_b16 v[30:31], v4 offset:10336
    ds_read_b64_tr_b16 v[32:33], v4 offset:128
    ds_read_b64_tr_b16 v[34:35], v4 offset:10368
    s_waitcnt lgkmcnt(0)
    buffer_store_dwordx4 v[16:19], v13, s[8:11], s6 offen offset:0 sc1
    buffer_store_dwordx4 v[20:23], v13, s[8:11], s6 offen offset:1024 sc1
    buffer_store_dwordx4 v[24:27], v13, s[8:11], s6 offen offset:2048 sc1
    buffer_store_dwordx4 v[28:31], v13, s[8:11], s6 offen offset:3072 sc1
    buffer_store_dwordx4 v[32:35], v13, s[8:11], s7 offen offset:0 sc1
    s_branch L_hook_back
L_hook5:
    s_lshl_b32 s74, s76, 12
    s_add_u32 s74, s74, 131072
    s_mov_b32 m0, s74
    s_add_u32 s74, s74, 16384
    buffer_load_dwordx4 v44, s[24:27], s71 offen offset:0 lds
    buffer_load_dwordx4 v45, s[24:27], s71 offen offset:1024 lds
    buffer_load_dwordx4 v46, s[24:27], s71 offen offset:2048 lds
    buffer_load_dwordx4 v47, s[24:27], s71 offen offset:3072 lds
    s_add_u32 s71, s71, 524288
    s_sub_u32 s75, s71, 5242880
    s_cselect_b32 s71, s71, s75
    s_mov_b32 m0, s74
    s_add_u32 s74, s74, 16384
    buffer_load_dwordx4 v44, s[24:27], s71 offen offset:0 lds
    buffer_load_dwordx4 v45, s[24:27], s71 offen offset:1024 lds
    buffer_load_dwordx4 v46, s[24:27], s71 offen offset:2048 lds
    buffer_load_dwordx4 v47, s[24:27], s71 offen offset:3072 lds
    s_add_u32 s71, s71, 524288
    s_sub_u32 s75, s71, 5242880
    s_cselect_b32 s71, s71, s75
    s_branch L_hook_back
L_hook6:
    s_cmp_lg_u32 s3, 5
    s_cbranch_scc1 L_hook6b
    s_mov_b32 s28, s56
    s_mov_b32 s29, s57
    s_mov_b32 s30, 0x100
    s_mov_b32 s31, 0x20000
    v_and_b32 v3, 31, v1
    v_lshlrev_b32 v3, 2, v3
    buffer_load_dword v62, v3, s[28:31], 0 offen offset:0 sc1
L_hook6b:
    s_cmp_lg_u32 s3, 4
    s_cbranch_scc1 L_hook_back
    s_mov_b32 s28, s56
    s_mov_b32 s29, s57
    s_mov_b32 s30, 0x100
    s_mov_b32 s31, 0x20000
    v_mov_b32 v2, 1
    v_lshlrev_b32 v3, 8, v1
    s_and_b32 s6, s2, 31
    s_lshl_b32 s6, s6, 2
    buffer_atomic_add v2, v3, s[28:31], s6 offen offset:128 sc1
    s_branch L_hook_back
L_vpre:
    s_waitcnt vmcnt(8)
    s_cmp_eq_u32 s65, 5
    s_cbranch_scc1 L_vnow
    s_cmp_eq_u32 s65, 6
    s_cbranch_scc1 L_vpre6
    s_waitcnt vmcnt(0)
    s_branch L_vnow
L_vpre6:
    s_cmp_lg_u32 s3, 5
    s_cbranch_scc1 L_vnow
    s_waitcnt vmcnt(0)
    v_cmp_ne_u32 vcc, 8, v62
    s_cbranch_vccz L_cntok_3
    s_mov_b32 s28, s56
    s_mov_b32 s29, s57
    s_mov_b32 s30, 0x100
    s_mov_b32 s31, 0x20000
    v_and_b32 v3, 31, v1
    v_lshlrev_b32 v3, 2, v3
    s_mov_b32 s79, 262144
L_poll_4:
    buffer_load_dword v2, v3, s[28:31], 0 offen offset:0 sc1
    s_waitcnt vmcnt(0)
    v_cmp_ne_u32 vcc, 8, v2
    s_cbranch_vccz L_polldone_5
    s_sleep 8
    s_sub_u32 s79, s79, 1
    s_cmp_lg_u32 s79, 0
    s_cbranch_scc1 L_poll_4
L_polldone_5:
L_cntok_3:
    s_branch L_vnow
L_khook:
    s_cmp_lg_u32 s65, 7
    s_cbranch_scc1 L_khook_back
    buffer_load_dwordx4 v[16:19], v13, s[8:11], s84 offen offset:0 sc1
    buffer_load_dwordx4 v[20:23], v12, s[8:11], s84 offen offset:0 sc1
    buffer_load_dwordx4 v[24:27], v13, s[8:11], s84 offen offset:1024 sc1
    buffer_load_dwordx4 v[28:31], v12, s[8:11], s84 offen offset:1024 sc1
    buffer_load_dwordx4 v[32:35], v13, s[8:11], s84 offen offset:2048 sc1
    buffer_load_dwordx4 v[36:39], v12, s[8:11], s84 offen offset:2048 sc1
    s_branch L_khook_back
L_kv_v:
    ds_read_b128 v[64:67], v48 offset:0
    ds_read_b128 v[68:71], v48 offset:2048
    ds_read_b64_tr_b16 v[96:97], v50 offset:0
    ds_read_b64_tr_b16 v[98:99], v50 offset:1024
    ds_read_b64_tr_b16 v[100:101], v51 offset:0
    ds_read_b64_tr_b16 v[102:103], v51 offset:1024
    ds_read_b128 v[72:75], v48 offset:4096
    ds_read_b64_tr_b16 v[104:105], v52 offset:0
    ds_read_b64_tr_b16 v[106:107], v52 offset:1024
    ds_read_b64_tr_b16 v[108:109], v53 offset:0
    ds_read_b64_tr_b16 v[110:111], v53 offset:1024
    ds_read_b128 v[76:79], v48 offset:6144
    ds_read_b128 v[80:83], v48 offset:8192
    ds_read_b128 v[84:87], v48 offset:10240
    ds_read_b128 v[88:91], v48 offset:12288
    ds_read_b128 v[92:95], v48 offset:14336
    s_cmp_ge_u32 s76, 2
    s_cbranch_scc1 L_tch_6a
    s_and_b32 s6, s4, 3
    s_lshl_b32 s6, s6, 19
    s_lshl_b32 s7, s5, 15
    s_add_u32 s6, s6, s7
    s_lshl_b32 s7, s76, 7
    s_add_u32 s6, s6, s7
    s_add_u32 s6, s6, 256
    v_lshrrev_b32 v6, 1, v1
    v_lshlrev_b32 v6, 10, v6
    v_and_b32 v7, 1, v1
    v_lshl_add_u32 v6, v7, 6, v6
    buffer_load_dword v11, v6, s[12:15], s6 offen
    s_add_u32 s6, s6, 262144
    buffer_load_dword v11, v6, s[12:15], s6 offen
    s_branch L_tch_6c
L_tch_6a:
    v_lshrrev_b32 v6, 5, v1
    v_lshlrev_b32 v6, 6, v6
    v_bfe_u32 v7, v1, 2, 3
    v_add_u32 v6, v6, v7
    v_lshlrev_b32 v6, 13, v6
    v_and_b32 v7, 3, v1
    v_lshl_add_u32 v6, v7, 6, v6
    s_lshl_b32 s6, s4, 8
    s_lshl_b32 s7, s5, 16
    s_add_u32 s6, s6, s7
    s_add_u32 s6, s6, 1048576
    s_cmp_lg_u32 s76, 2
    s_cbranch_scc1 L_tch_6b
    buffer_load_dword v11, v6, s[16:19], s6 offen
    s_branch L_tch_6c
L_tch_6b:
    buffer_load_dword v11, v6, s[20:23], s6 offen
L_tch_6c:
.p2align 4
L_vloop:
    s_branch L_hook
L_hook_back:
    s_waitcnt lgkmcnt(12)
    v_mfma_f32_16x16x32_bf16 v[128:131], v[64:67], v[96:99], v[128:131]
    ds_read_b64_tr_b16 v[112:113], v50 offset:8192
    s_waitcnt lgkmcnt(11)
    v_mfma_f32_16x16x32_bf16 v[132:135], v[64:67], v[100:103], v[132:135]
    ds_read_b64_tr_b16 v[114:115], v50 offset:9216
    s_waitcnt lgkmcnt(9)
    v_mfma_f32_16x16x32_bf16 v[136:139], v[64:67], v[104:107], v[136:139]
    ds_read_b64_tr_b16 v[116:117], v51 offset:8192
    s_waitcnt lgkmcnt(8)
    v_mfma_f32_16x16x32_bf16 v[140:143], v[64:67], v[108:111], v[140:143]
    ds_read_b64_tr_b16 v[118:119], v51 offset:9216
    ds_read_b128 v[64:67], v49 offset:0
    v_mfma_f32_16x16x32_bf16 v[144:147], v[68:71], v[96:99], v[144:147]
    ds_read_b64_tr_b16 v[120:121], v52 offset:8192
    v_mfma_f32_16x16x32_bf16 v[148:151], v[68:71], v[100:103], v[148:151]
    ds_read_b64_tr_b16 v[122:123], v52 offset:9216
    v_mfma_f32_16x16x32_bf16 v[152:155], v[68:71], v[104:107], v[152:155]
    ds_read_b64_tr_b16 v[124:125], v53 offset:8192
    v_mfma_f32_16x16x32_bf16 v[156:159], v[68:71], v[108:111], v[156:159]
    ds_read_b64_tr_b16 v[126:127], v53 offset:9216
    ds_read_b128 v[68:71], v49 offset:2048
    v_mfma_f32_16x16x32_bf16 v[160:163], v[72:75], v[96:99], v[160:163]
    v_mfma_f32_16x16x32_bf16 v[164:167], v[72:75], v[100:103], v[164:167]
    v_mfma_f32_16x16x32_bf16 v[168:171], v[72:75], v[104:107], v[168:171]
    v_mfma_f32_16x16x32_bf16 v[172:175], v[72:75], v[108:111], v[172:175]
    ds_read_b128 v[72:75], v49 offset:4096
    s_waitcnt lgkmcnt(15)
    v_mfma_f32_16x16x32_bf16 v[176:179], v[76:79], v[96:99], v[176:179]
    v_mfma_f32_16x16x32_bf16 v[180:183], v[76:79], v[100:103], v[180:183]
    v_mfma_f32_16x16x32_bf16 v[184:187], v[76:79], v[104:107], v[184:187]
    v_mfma_f32_16x16x32_bf16 v[188:191], v[76:79], v[108:111], v[188:191]
    ds_read_b128 v[76:79], v49 offset:6144
    s_waitcnt lgkmcnt(15)
    v_mfma_f32_16x16x32_bf16 v[192:195], v[80:83], v[96:99], v[192:195]
    v_mfma_f32_16x16x32_bf16 v[196:199], v[80:83], v[100:103], v[196:199]
    v_mfma_f32_16x16x32_bf16 v[200:203], v[80:83], v[104:107], v[200:203]
    v_mfma_f32_16x16x32_bf16 v[204:207], v[80:83], v[108:111], v[204:207]
    ds_read_b128 v[80:83], v49 offset:8192
    s_waitcnt lgkmcnt(15)
    v_mfma_f32_16x16x32_bf16 v[208:211], v[84:87], v[96:99], v[208:211]
    v_mfma_f32_16x16x32_bf16 v[212:215], v[84:87], v[100:103], v[212:215]
    v_mfma_f32_16x16x32_bf16 v[216:219], v[84:87], v[104:107], v[216:219]
    v_mfma_f32_16x16x32_bf16 v[220:223], v[84:87], v[108:111], v[220:223]
    ds_read_b128 v[84:87], v49 offset:10240
    s_waitcnt lgkmcnt(15)
    v_mfma_f32_16x16x32_bf16 v[224:227], v[88:91], v[96:99], v[224:227]
    v_mfma_f32_16x16x32_bf16 v[228:231], v[88:91], v[100:103], v[228:231]
    v_mfma_f32_16x16x32_bf16 v[232:235], v[88:91], v[104:107], v[232:235]
    v_mfma_f32_16x16x32_bf16 v[236:239], v[88:91], v[108:111], v[236:239]
    ds_read_b128 v[88:91], v49 offset:12288
    s_waitcnt lgkmcnt(15)
    v_mfma_f32_16x16x32_bf16 v[240:243], v[92:95], v[96:99], v[240:243]
    v_mfma_f32_16x16x32_bf16 v[244:247], v[92:95], v[100:103], v[244:247]
    v_mfma_f32_16x16x32_bf16 v[248:251], v[92:95], v[104:107], v[248:251]
    v_mfma_f32_16x16x32_bf16 v[252:255], v[92:95], v[108:111], v[252:255]
    ds_read_b128 v[92:95], v49 offset:14336
    s_waitcnt lgkmcnt(11)
    v_mfma_f32_16x16x32_bf16 v[128:131], v[64:67], v[112:115], v[128:131]
    v_mfma_f32_16x16x32_bf16 v[132:135], v[64:67], v[116:119], v[132:135]
    s_waitcnt lgkmcnt(9)
    v_mfma_f32_16x16x32_bf16 v[136:139], v[64:67], v[120:123], v[136:139]
    s_waitcnt lgkmcnt(7)
    v_mfma_f32_16x16x32_bf16 v[140:143], v[64:67], v[124:127], v[140:143]
    s_waitcnt lgkmcnt(6)
    v_mfma_f32_16x16x32_bf16 v[144:147], v[68:71], v[112:115], v[144:147]
    v_mfma_f32_16x16x32_bf16 v[148:151], v[68:71], v[116:119], v[148:151]
    v_mfma_f32_16x16x32_bf16 v[152:155], v[68:71], v[120:123], v[152:155]
    v_mfma_f32_16x16x32_bf16 v[156:159], v[68:71], v[124:127], v[156:159]
    v_xor_b32 v48, 0x10000, v48
    v_xor_b32 v49, 0x10000, v49
    v_xor_b32 v50, 0x10000, v50
    v_xor_b32 v51, 0x10000, v51
    v_xor_b32 v52, 0x10000, v52
    v_xor_b32 v53, 0x10000, v53
    s_bitcmp1_b32 0xe8, s65
    s_cbranch_scc1 L_vpre
L_vnow:
    s_waitcnt lgkmcnt(0)
    s_barrier
    ds_read_b128 v[64:67], v48 offset:0
    ds_read_b128 v[68:71], v48 offset:2048
    v_mfma_f32_16x16x32_bf16 v[160:163], v[72:75], v[112:115], v[160:163]
    ds_read_b64_tr_b16 v[96:97], v50 offset:0
    v_mfma_f32_16x16x32_bf16 v[164:167], v[72:75], v[116:119], v[164:167]
    ds_read_b64_tr_b16 v[98:99], v50 offset:1024
    v_mfma_f32_16x16x32_bf16 v[168:171], v[72:75], v[120:123], v[168:171]
    ds_read_b64_tr_b16 v[100:101], v51 offset:0
    v_mfma_f32_16x16x32_bf16 v[172:175], v[72:75], v[124:127], v[172:175]
    ds_read_b64_tr_b16 v[102:103], v51 offset:1024
    ds_read_b128 v[72:75], v48 offset:4096
    v_mfma_f32_16x16x32_bf16 v[176:179], v[76:79], v[112:115], v[176:179]
    ds_read_b64_tr_b16 v[104:105], v52 offset:0
    v_mfma_f32_16x16x32_bf16 v[180:183], v[76:79], v[116:119], v[180:183]
    ds_read_b64_tr_b16 v[106:107], v52 offset:1024
    v_mfma_f32_16x16x32_bf16 v[184:187], v[76:79], v[120:123], v[184:187]
    ds_read_b64_tr_b16 v[108:109], v53 offset:0
    v_mfma_f32_16x16x32_bf16 v[188:191], v[76:79], v[124:127], v[188:191]
    ds_read_b64_tr_b16 v[110:111], v53 offset:1024
    ds_read_b128 v[76:79], v48 offset:6144
    v_mfma_f32_16x16x32_bf16 v[192:195], v[80:83], v[112:115], v[192:195]
    v_mfma_f32_16x16x32_bf16 v[196:199], v[80:83], v[116:119], v[196:199]
    v_mfma_f32_16x16x32_bf16 v[200:203], v[80:83], v[120:123], v[200:203]
    v_mfma_f32_16x16x32_bf16 v[204:207], v[80:83], v[124:127], v[204:207]
    ds_read_b128 v[80:83], v48 offset:8192
    v_mfma_f32_16x16x32_bf16 v[208:211], v[84:87], v[112:115], v[208:211]
    v_mfma_f32_16x16x32_bf16 v[212:215], v[84:87], v[116:119], v[212:215]
    v_mfma_f32_16x16x32_bf16 v[216:219], v[84:87], v[120:123], v[216:219]
    v_mfma_f32_16x16x32_bf16 v[220:223], v[84:87], v[124:127], v[220:223]
    ds_read_b128 v[84:87], v48 offset:10240
    v_mfma_f32_16x16x32_bf16 v[224:227], v[88:91], v[112:115], v[224:227]
    v_mfma_f32_16x16x32_bf16 v[228:231], v[88:91], v[116:119], v[228:231]
    v_mfma_f32_16x16x32_bf16 v[232:235], v[88:91], v[120:123], v[232:235]
    v_mfma_f32_16x16x32_bf16 v[236:239], v[88:91], v[124:127], v[236:239]
    ds_read_b128 v[88:91], v48 offset:12288
    v_mfma_f32_16x16x32_bf16 v[240:243], v[92:95], v[112:115], v[240:243]
    v_mfma_f32_16x16x32_bf16 v[244:247], v[92:95], v[116:119], v[244:247]
    v_mfma_f32_16x16x32_bf16 v[248:251], v[92:95], v[120:123], v[248:251]
    v_mfma_f32_16x16x32_bf16 v[252:255], v[92:95], v[124:127], v[252:255]
    ds_read_b128 v[92:95], v48 offset:14336
    s_add_u32 s65, s65, 1
    s_cmp_lt_u32 s65, 8
    s_cbranch_scc1 L_vloop
    s_waitcnt lgkmcnt(0)
    s_nop 7
    v_cvt_pk_bf16_f32 v128, v128, v129
    v_cvt_pk_bf16_f32 v129, v130, v131
    v_cvt_pk_bf16_f32 v130, v144, v145
    v_cvt_pk_bf16_f32 v131, v146, v147
    v_cvt_pk_bf16_f32 v132, v132, v133
    v_cvt_pk_bf16_f32 v133, v134, v135
    v_cvt_pk_bf16_f32 v134, v148, v149
    v_cvt_pk_bf16_f32 v135, v150, v151
    v_cvt_pk_bf16_f32 v136, v136, v137
    v_cvt_pk_bf16_f32 v137, v138, v139
    v_cvt_pk_bf16_f32 v138, v152, v153
    v_cvt_pk_bf16_f32 v139, v154, v155
    v_cvt_pk_bf16_f32 v140, v140, v141
    v_cvt_pk_bf16_f32 v141, v142, v143
    v_cvt_pk_bf16_f32 v142, v156, v157
    v_cvt_pk_bf16_f32 v143, v158, v159
    v_cvt_pk_bf16_f32 v144, v160, v161
    v_cvt_pk_bf16_f32 v145, v162, v163
    v_cvt_pk_bf16_f32 v146, v176, v177
    v_cvt_pk_bf16_f32 v147, v178, v179
    v_cvt_pk_bf16_f32 v148, v164, v165
    v_cvt_pk_bf16_f32 v149, v166, v167
    v_cvt_pk_bf16_f32 v150, v180, v181
    v_cvt_pk_bf16_f32 v151, v182, v183
    v_cvt_pk_bf16_f32 v152, v168, v169
    v_cvt_pk_bf16_f32 v153, v170, v171
    v_cvt_pk_bf16_f32 v154, v184, v185
    v_cvt_pk_bf16_f32 v155, v186, v187
    v_cvt_pk_bf16_f32 v156, v172, v173
    v_cvt_pk_bf16_f32 v157, v174, v175
    v_cvt_pk_bf16_f32 v158, v188, v189
    v_cvt_pk_bf16_f32 v159, v190, v191
    v_cvt_pk_bf16_f32 v160, v192, v193
    v_cvt_pk_bf16_f32 v161, v194, v195
    v_cvt_pk_bf16_f32 v162, v208, v209
    v_cvt_pk_bf16_f32 v163, v210, v211
    v_cvt_pk_bf16_f32 v164, v196, v197
    v_cvt_pk_bf16_f32 v165, v198, v199
    v_cvt_pk_bf16_f32 v166, v212, v213
    v_cvt_pk_bf16_f32 v167, v214, v215
    v_cvt_pk_bf16_f32 v168, v200, v201
    v_cvt_pk_bf16_f32 v169, v202, v203
    v_cvt_pk_bf16_f32 v170, v216, v217
    v_cvt_pk_bf16_f32 v171, v218, v219
    v_cvt_pk_bf16_f32 v172, v204, v205
    v_cvt_pk_bf16_f32 v173, v206, v207
    v_cvt_pk_bf16_f32 v174, v220, v221
    v_cvt_pk_bf16_f32 v175, v222, v223
    v_cvt_pk_bf16_f32 v176, v224, v225
    v_cvt_pk_bf16_f32 v177, v226, v227
    v_cvt_pk_bf16_f32 v178, v240, v241
    v_cvt_pk_bf16_f32 v179, v242, v243
    v_cvt_pk_bf16_f32 v180, v228, v229
    v_cvt_pk_bf16_f32 v181, v230, v231
    v_cvt_pk_bf16_f32 v182, v244, v245
    v_cvt_pk_bf16_f32 v183, v246, v247
    v_cvt_pk_bf16_f32 v184, v232, v233
    v_cvt_pk_bf16_f32 v185, v234, v235
    v_cvt_pk_bf16_f32 v186, v248, v249
    v_cvt_pk_bf16_f32 v187, v250, v251
    v_cvt_pk_bf16_f32 v188, v236, v237
    v_cvt_pk_bf16_f32 v189, v238, v239
    v_cvt_pk_bf16_f32 v190, v252, v253
    v_cvt_pk_bf16_f32 v191, v254, v255
L_q:
    s_mov_b32 s28, s56
    s_mov_b32 s29, s57
    s_mov_b32 s30, 0x100
    s_mov_b32 s31, 0x20000
    s_lshl_b32 s6, s76, 13
    v_add_u32 v49, s6, v13
    s_lshl_b32 s6, s76, 12
    v_add_u32 v50, s6, v13
    s_lshl_b32 s77, s4, 20
    s_add_u32 s77, s77, 16777216
    s_mov_b32 s78, 0
    s_mov_b32 s90, 0
    s_cmp_lt_u32 s3, 4
    s_cselect_b32 s89, 3, 2
    ds_read_b64_tr_b16 v[96:97], v54 offset:0
    ds_read_b64_tr_b16 v[98:99], v54 offset:1024
    ds_read_b64_tr_b16 v[100:101], v55 offset:0
    ds_read_b64_tr_b16 v[102:103], v55 offset:1024
    ds_read_b64_tr_b16 v[104:105], v56 offset:0
    ds_read_b64_tr_b16 v[106:107], v56 offset:1024
    ds_read_b64_tr_b16 v[108:109], v57 offset:0
    ds_read_b64_tr_b16 v[110:111], v57 offset:1024
    ds_read_b64_tr_b16 v[112:113], v58 offset:0
    ds_read_b64_tr_b16 v[114:115], v58 offset:1024
    ds_read_b64_tr_b16 v[116:117], v59 offset:0
    ds_read_b64_tr_b16 v[118:119], v59 offset:1024
    ds_read_b64_tr_b16 v[120:121], v60 offset:0
    ds_read_b64_tr_b16 v[122:123], v60 offset:1024
    ds_read_b64_tr_b16 v[124:125], v61 offset:0
    ds_read_b64_tr_b16 v[126:127], v61 offset:1024
    buffer_load_dwordx4 v[64:67], v13, s[8:11], s84 offen offset:3072 sc1
    buffer_load_dwordx4 v[68:71], v12, s[8:11], s84 offen offset:3072 sc1
    buffer_load_dwordx4 v[72:75], v13, s[8:11], s85 offen offset:0 sc1
    buffer_load_dwordx4 v[76:79], v12, s[8:11], s85 offen offset:0 sc1
    buffer_load_dwordx4 v[80:83], v13, s[8:11], s85 offen offset:1024 sc1
    buffer_load_dwordx4 v[84:87], v12, s[8:11], s85 offen offset:1024 sc1
    buffer_load_dwordx4 v[88:91], v13, s[8:11], s85 offen offset:2048 sc1
    buffer_load_dwordx4 v[92:95], v12, s[8:11], s85 offen offset:2048 sc1
    s_waitcnt lgkmcnt(14)
    v_mfma_f32_16x16x32_bf16 v[192:195], v[96:99], v[16:19], 0
    v_mfma_f32_16x16x32_bf16 v[196:199], v[96:99], v[20:23], 0
    ds_read_b64_tr_b16 v[96:97], v54 offset:8192
    s_waitcnt lgkmcnt(13)
    v_mfma_f32_16x16x32_bf16 v[200:203], v[100:103], v[16:19], 0
    ds_read_b64_tr_b16 v[98:99], v54 offset:9216
    v_mfma_f32_16x16x32_bf16 v[204:207], v[100:103], v[20:23], 0
    ds_read_b64_tr_b16 v[100:101], v55 offset:8192
    s_waitcnt lgkmcnt(13)
    v_mfma_f32_16x16x32_bf16 v[208:211], v[104:107], v[16:19], 0
    ds_read_b64_tr_b16 v[102:103], v55 offset:9216
    v_mfma_f32_16x16x32_bf16 v[212:215], v[104:107], v[20:23], 0
    ds_read_b64_tr_b16 v[104:105], v56 offset:8192
    s_waitcnt lgkmcnt(13)
    v_mfma_f32_16x16x32_bf16 v[216:219], v[108:111], v[16:19], 0
    ds_read_b64_tr_b16 v[106:107], v56 offset:9216
    buffer_store_dwordx4 v[128:131], v13, s[8:11], s67 offen sc1
    s_add_u32 s67, s67, 1024
    v_mfma_f32_16x16x32_bf16 v[220:223], v[108:111], v[20:23], 0
    ds_read_b64_tr_b16 v[108:109], v57 offset:8192
    s_waitcnt lgkmcnt(13)
    v_mfma_f32_16x16x32_bf16 v[224:227], v[112:115], v[16:19], 0
    ds_read_b64_tr_b16 v[110:111], v57 offset:9216
    v_mfma_f32_16x16x32_bf16 v[228:231], v[112:115], v[20:23], 0
    ds_read_b64_tr_b16 v[112:113], v58 offset:8192
    s_waitcnt lgkmcnt(13)
    v_mfma_f32_16x16x32_bf16 v[232:235], v[116:119], v[16:19], 0
    ds_read_b64_tr_b16 v[114:115], v58 offset:9216
    v_mfma_f32_16x16x32_bf16 v[236:239], v[116:119], v[20:23], 0
    ds_read_b64_tr_b16 v[116:117], v59 offset:8192
    s_waitcnt lgkmcnt(13)
    v_mfma_f32_16x16x32_bf16 v[240:243], v[120:123], v[16:19], 0
    ds_read_b64_tr_b16 v[118:119], v59 offset:9216
    v_mfma_f32_16x16x32_bf16 v[244:247], v[120:123], v[20:23], 0
    ds_read_b64_tr_b16 v[120:121], v60 offset:8192
    s_waitcnt lgkmcnt(13)
    v_mfma_f32_16x16x32_bf16 v[248:251], v[124:127], v[16:19], 0
    ds_read_b64_tr_b16 v[122:123], v60 offset:9216
    v_mfma_f32_16x16x32_bf16 v[252:255], v[124:127], v[20:23], 0
    ds_read_b64_tr_b16 v[124:125], v61 offset:8192
    ds_read_b64_tr_b16 v[126:127], v61 offset:9216
    buffer_load_dwordx4 v[16:19], v13, s[8:11], s85 offen offset:3072 sc1
    buffer_load_dwordx4 v[20:23], v12, s[8:11], s85 offen offset:3072 sc1
    s_waitcnt lgkmcnt(14)
    v_mfma_f32_16x16x32_bf16 v[192:195], v[96:99], v[24:27], v[192:195]
    v_mfma_f32_16x16x32_bf16 v[196:199], v[96:99], v[28:31], v[196:199]
    ds_read_b64_tr_b16 v[96:97], v54 offset:16384
    s_waitcnt lgkmcnt(13)
    v_mfma_f32_16x16x32_bf16 v[200:203], v[100:103], v[24:27], v[200:203]
    ds_read_b64_tr_b16 v[98:99], v54 offset:17408
    v_mfma_f32_16x16x32_bf16 v[204:207], v[100:103], v[28:31], v[204:207]
    ds_read_b64_tr_b16 v[100:101], v55 offset:16384
    s_waitcnt lgkmcnt(13)
    v_mfma_f32_16x16x32_bf16 v[208:211], v[104:107], v[24:27], v[208:211]
    ds_read_b64_tr_b16 v[102:103], v55 offset:17408
    v_mfma_f32_16x16x32_bf16 v[212:215], v[104:107], v[28:31], v[212:215]
    ds_read_b64_tr_b16 v[104:105], v56 offset:16384
    s_waitcnt lgkmcnt(13)
    v_mfma_f32_16x16x32_bf16 v[216:219], v[108:111], v[24:27], v[216:219]
    ds_read_b64_tr_b16 v[106:107], v56 offset:17408
    buffer_store_dwordx4 v[132:135], v13, s[8:11], s67 offen sc1
    s_add_u32 s67, s67, s68
    v_mfma_f32_16x16x32_bf16 v[220:223], v[108:111], v[28:31], v[220:223]
    ds_read_b64_tr_b16 v[108:109], v57 offset:16384
    s_waitcnt lgkmcnt(13)
    v_mfma_f32_16x16x32_bf16 v[224:227], v[112:115], v[24:27], v[224:227]
    ds_read_b64_tr_b16 v[110:111], v57 offset:17408
    v_mfma_f32_16x16x32_bf16 v[228:231], v[112:115], v[28:31], v[228:231]
    ds_read_b64_tr_b16 v[112:113], v58 offset:16384
    s_waitcnt lgkmcnt(13)
    v_mfma_f32_16x16x32_bf16 v[232:235], v[116:119], v[24:27], v[232:235]
    ds_read_b64_tr_b16 v[114:115], v58 offset:17408
    v_mfma_f32_16x16x32_bf16 v[236:239], v[116:119], v[28:31], v[236:239]
    ds_read_b64_tr_b16 v[116:117], v59 offset:16384
    s_waitcnt lgkmcnt(13)
    v_mfma_f32_16x16x32_bf16 v[240:243], v[120:123], v[24:27], v[240:243]
    ds_read_b64_tr_b16 v[118:119], v59 offset:17408
    v_mfma_f32_16x16x32_bf16 v[244:247], v[120:123], v[28:31], v[244:247]
    ds_read_b64_tr_b16 v[120:121], v60 offset:16384
    s_waitcnt lgkmcnt(13)
    v_mfma_f32_16x16x32_bf16 v[248:251], v[124:127], v[24:27], v[248:251]
    ds_read_b64_tr_b16 v[122:123], v60 offset:17408
    v_mfma_f32_16x16x32_bf16 v[252:255], v[124:127], v[28:31], v[252:255]
    ds_read_b64_tr_b16 v[124:125], v61 offset:16384
    ds_read_b64_tr_b16 v[126:127], v61 offset:17408
    buffer_load_dwordx4 v[24:27], v13, s[8:11], s86 offen offset:0 sc1
    buffer_load_dwordx4 v[28:31], v12, s[8:11], s86 offen offset:0 sc1
    s_waitcnt lgkmcnt(14)
    v_mfma_f32_16x16x32_bf16 v[192:195], v[96:99], v[32:35], v[192:195]
    v_mfma_f32_16x16x32_bf16 v[196:199], v[96:99], v[36:39], v[196:199]
    ds_read_b64_tr_b16 v[96:97], v54 offset:24576
    s_waitcnt lgkmcnt(13)
    v_mfma_f32_16x16x32_bf16 v[200:203], v[100:103], v[32:35], v[200:203]
    ds_read_b64_tr_b16 v[98:99], v54 offset:25600
    v_mfma_f32_16x16x32_bf16 v[204:207], v[100:103], v[36:39], v[204:207]
    ds_read_b64_tr_b16 v[100:101], v55 offset:24576
    s_waitcnt lgkmcnt(13)
    v_mfma_f32_16x16x32_bf16 v[208:211], v[104:107], v[32:35], v[208:211]
    ds_read_b64_tr_b16 v[102:103], v55 offset:25600
    v_mfma_f32_16x16x32_bf16 v[212:215], v[104:107], v[36:39], v[212:215]
    ds_read_b64_tr_b16 v[104:105], v56 offset:24576
    s_waitcnt lgkmcnt(13)
    v_mfma_f32_16x16x32_bf16 v[216:219], v[108:111], v[32:35], v[216:219]
    ds_read_b64_tr_b16 v[106:107], v56 offset:25600
    buffer_store_dwordx4 v[136:139], v13, s[8:11], s67 offen sc1
    s_add_u32 s67, s67, 1024
    v_mfma_f32_16x16x32_bf16 v[220:223], v[108:111], v[36:39], v[220:223]
    ds_read_b64_tr_b16 v[108:109], v57 offset:24576
    s_waitcnt lgkmcnt(13)
    v_mfma_f32_16x16x32_bf16 v[224:227], v[112:115], v[32:35], v[224:227]
    ds_read_b64_tr_b16 v[110:111], v57 offset:25600
    v_mfma_f32_16x16x32_bf16 v[228:231], v[112:115], v[36:39], v[228:231]
    ds_read_b64_tr_b16 v[112:113], v58 offset:24576
    s_waitcnt lgkmcnt(13)
    v_mfma_f32_16x16x32_bf16 v[232:235], v[116:119], v[32:35], v[232:235]
    ds_read_b64_tr_b16 v[114:115], v58 offset:25600
    v_mfma_f32_16x16x32_bf16 v[236:239], v[116:119], v[36:39], v[236:239]
    ds_read_b64_tr_b16 v[116:117], v59 offset:24576
    s_waitcnt lgkmcnt(13)
    v_mfma_f32_16x16x32_bf16 v[240:243], v[120:123], v[32:35], v[240:243]
    ds_read_b64_tr_b16 v[118:119], v59 offset:25600
    v_mfma_f32_16x16x32_bf16 v[244:247], v[120:123], v[36:39], v[244:247]
    ds_read_b64_tr_b16 v[120:121], v60 offset:24576
    s_waitcnt lgkmcnt(13)
    v_mfma_f32_16x16x32_bf16 v[248:251], v[124:127], v[32:35], v[248:251]
    ds_read_b64_tr_b16 v[122:123], v60 offset:25600
    v_mfma_f32_16x16x32_bf16 v[252:255], v[124:127], v[36:39], v[252:255]
    ds_read_b64_tr_b16 v[124:125], v61 offset:24576
    ds_read_b64_tr_b16 v[126:127], v61 offset:25600
    buffer_load_dwordx4 v[32:35], v13, s[8:11], s86 offen offset:1024 sc1
    buffer_load_dwordx4 v[36:39], v12, s[8:11], s86 offen offset:1024 sc1
    s_waitcnt vmcnt(15)
    s_waitcnt lgkmcnt(14)
    v_mfma_f32_16x16x32_bf16 v[192:195], v[96:99], v[64:67], v[192:195]
    v_add_u32 v54, 0xfffe0000, v54
    v_mfma_f32_16x16x32_bf16 v[196:199], v[96:99], v[68:71], v[196:199]
    ds_read_b64_tr_b16 v[96:97], v54 offset:0
    s_waitcnt lgkmcnt(13)
    v_mfma_f32_16x16x32_bf16 v[200:203], v[100:103], v[64:67], v[200:203]
    ds_read_b64_tr_b16 v[98:99], v54 offset:1024
    v_add_u32 v55, 0xfffe0000, v55
    v_mfma_f32_16x16x32_bf16 v[204:207], v[100:103], v[68:71], v[204:207]
    ds_read_b64_tr_b16 v[100:101], v55 offset:0
    s_waitcnt lgkmcnt(13)
    v_mfma_f32_16x16x32_bf16 v[208:211], v[104:107], v[64:67], v[208:211]
    ds_read_b64_tr_b16 v[102:103], v55 offset:1024
    v_add_u32 v56, 0xfffe0000, v56
    v_mfma_f32_16x16x32_bf16 v[212:215], v[104:107], v[68:71], v[212:215]
    ds_read_b64_tr_b16 v[104:105], v56 offset:0
    s_waitcnt lgkmcnt(13)
    v_mfma_f32_16x16x32_bf16 v[216:219], v[108:111], v[64:67], v[216:219]
    ds_read_b64_tr_b16 v[106:107], v56 offset:1024
    v_add_u32 v57, 0xfffe0000, v57
    buffer_store_dwordx4 v[140:143], v13, s[8:11], s67 offen sc1
    s_add_u32 s67, s67, s69
    v_mfma_f32_16x16x32_bf16 v[220:223], v[108:111], v[68:71], v[220:223]
    ds_read_b64_tr_b16 v[108:109], v57 offset:0
    s_waitcnt lgkmcnt(13)
    v_mfma_f32_16x16x32_bf16 v[224:227], v[112:115], v[64:67], v[224:227]
    ds_read_b64_tr_b16 v[110:111], v57 offset:1024
    v_add_u32 v58, 0xfffe0000, v58
    v_mfma_f32_16x16x32_bf16 v[228:231], v[112:115], v[68:71], v[228:231]
    ds_read_b64_tr_b16 v[112:113], v58 offset:0
    s_waitcnt lgkmcnt(13)
    v_mfma_f32_16x16x32_bf16 v[232:235], v[116:119], v[64:67], v[232:235]
    ds_read_b64_tr_b16 v[114:115], v58 offset:1024
    v_add_u32 v59, 0xfffe0000, v59
    v_mfma_f32_16x16x32_bf16 v[236:239], v[116:119], v[68:71], v[236:239]
    ds_read_b64_tr_b16 v[116:117], v59 offset:0
    s_waitcnt lgkmcnt(13)
    v_mfma_f32_16x16x32_bf16 v[240:243], v[120:123], v[64:67], v[240:243]
    ds_read_b64_tr_b16 v[118:119], v59 offset:1024
    v_add_u32 v60, 0xfffe0000, v60
    v_mfma_f32_16x16x32_bf16 v[244:247], v[120:123], v[68:71], v[244:247]
    ds_read_b64_tr_b16 v[120:121], v60 offset:0
    s_waitcnt lgkmcnt(13)
    v_mfma_f32_16x16x32_bf16 v[248:251], v[124:127], v[64:67], v[248:251]
    ds_read_b64_tr_b16 v[122:123], v60 offset:1024
    v_add_u32 v61, 0xfffe0000, v61
    v_mfma_f32_16x16x32_bf16 v[252:255], v[124:127], v[68:71], v[252:255]
    ds_read_b64_tr_b16 v[124:125], v61 offset:0
    ds_read_b64_tr_b16 v[126:127], v61 offset:1024
    buffer_load_dwordx4 v[64:67], v13, s[8:11], s86 offen offset:2048 sc1
    buffer_load_dwordx4 v[68:71], v12, s[8:11], s86 offen offset:2048 sc1
    s_waitcnt vmcnt(16)
    s_waitcnt lgkmcnt(14)
    v_mfma_f32_16x16x32_bf16 v[192:195], v[96:99], v[72:75], v[192:195]
    v_mfma_f32_16x16x32_bf16 v[196:199], v[96:99], v[76:79], v[196:199]
    ds_read_b64_tr_b16 v[96:97], v54 offset:8192
    s_waitcnt lgkmcnt(13)
    v_mfma_f32_16x16x32_bf16 v[200:203], v[100:103], v[72:75], v[200:203]
    ds_read_b64_tr_b16 v[98:99], v54 offset:9216
    v_mfma_f32_16x16x32_bf16 v[204:207], v[100:103], v[76:79], v[204:207]
    ds_read_b64_tr_b16 v[100:101], v55 offset:8192
    s_waitcnt lgkmcnt(13)
    v_mfma_f32_16x16x32_bf16 v[208:211], v[104:107], v[72:75], v[208:211]
    ds_read_b64_tr_b16 v[102:103], v55 offset:9216
    v_mfma_f32_16x16x32_bf16 v[212:215], v[104:107], v[76:79], v[212:215]
    ds_read_b64_tr_b16 v[104:105], v56 offset:8192
    s_waitcnt lgkmcnt(13)
    v_mfma_f32_16x16x32_bf16 v[216:219], v[108:111], v[72:75], v[216:219]
    ds_read_b64_tr_b16 v[106:107], v56 offset:9216
    v_mfma_f32_16x16x32_bf16 v[220:223], v[108:111], v[76:79], v[220:223]
    ds_read_b64_tr_b16 v[108:109], v57 offset:8192
    s_waitcnt lgkmcnt(13)
    v_mfma_f32_16x16x32_bf16 v[224:227], v[112:115], v[72:75], v[224:227]
    ds_read_b64_tr_b16 v[110:111], v57 offset:9216
    v_mfma_f32_16x16x32_bf16 v[228:231], v[112:115], v[76:79], v[228:231]
    ds_read_b64_tr_b16 v[112:113], v58 offset:8192
    s_waitcnt lgkmcnt(13)
    v_mfma_f32_16x16x32_bf16 v[232:235], v[116:119], v[72:75], v[232:235]
    ds_read_b64_tr_b16 v[114:115], v58 offset:9216
    v_mfma_f32_16x16x32_bf16 v[236:239], v[116:119], v[76:79], v[236:239]
    ds_read_b64_tr_b16 v[116:117], v59 offset:8192
    s_waitcnt lgkmcnt(13)
    v_mfma_f32_16x16x32_bf16 v[240:243], v[120:123], v[72:75], v[240:243]
    ds_read_b64_tr_b16 v[118:119], v59 offset:9216
    v_mfma_f32_16x16x32_bf16 v[244:247], v[120:123], v[76:79], v[244:247]
    ds_read_b64_tr_b16 v[120:121], v60 offset:8192
    s_waitcnt lgkmcnt(13)
    v_mfma_f32_16x16x32_bf16 v[248:251], v[124:127], v[72:75], v[248:251]
    ds_read_b64_tr_b16 v[122:123], v60 offset:9216
    v_mfma_f32_16x16x32_bf16 v[252:255], v[124:127], v[76:79], v[252:255]
    ds_read_b64_tr_b16 v[124:125], v61 offset:8192
    ds_read_b64_tr_b16 v[126:127], v61 offset:9216
    buffer_load_dwordx4 v[72:75], v13, s[8:11], s86 offen offset:3072 sc1
    buffer_load_dwordx4 v[76:79], v12, s[8:11], s86 offen offset:3072 sc1
    s_waitcnt vmcnt(16)
    s_waitcnt lgkmcnt(14)
    v_mfma_f32_16x16x32_bf16 v[192:195], v[96:99], v[80:83], v[192:195]
    v_mfma_f32_16x16x32_bf16 v[196:199], v[96:99], v[84:87], v[196:199]
    ds_read_b64_tr_b16 v[96:97], v54 offset:16384
    s_waitcnt lgkmcnt(13)
    v_mfma_f32_16x16x32_bf16 v[200:203], v[100:103], v[80:83], v[200:203]
    ds_read_b64_tr_b16 v[98:99], v54 offset:17408
    v_mfma_f32_16x16x32_bf16 v[204:207], v[100:103], v[84:87], v[204:207]
    ds_read_b64_tr_b16 v[100:101], v55 offset:16384
    s_waitcnt lgkmcnt(13)
    v_mfma_f32_16x16x32_bf16 v[208:211], v[104:107], v[80:83], v[208:211]
    ds_read_b64_tr_b16 v[102:103], v55 offset:17408
    v_mfma_f32_16x16x32_bf16 v[212:215], v[104:107], v[84:87], v[212:215]
    ds_read_b64_tr_b16 v[104:105], v56 offset:16384
    s_waitcnt lgkmcnt(13)
    v_mfma_f32_16x16x32_bf16 v[216:219], v[108:111], v[80:83], v[216:219]
    ds_read_b64_tr_b16 v[106:107], v56 offset:17408
    v_mfma_f32_16x16x32_bf16 v[220:223], v[108:111], v[84:87], v[220:223]
    ds_read_b64_tr_b16 v[108:109], v57 offset:16384
    s_waitcnt lgkmcnt(13)
    v_mfma_f32_16x16x32_bf16 v[224:227], v[112:115], v[80:83], v[224:227]
    ds_read_b64_tr_b16 v[110:111], v57 offset:17408
    v_mfma_f32_16x16x32_bf16 v[228:231], v[112:115], v[84:87], v[228:231]
    ds_read_b64_tr_b16 v[112:113], v58 offset:16384
    s_waitcnt lgkmcnt(13)
    v_mfma_f32_16x16x32_bf16 v[232:235], v[116:119], v[80:83], v[232:235]
    ds_read_b64_tr_b16 v[114:115], v58 offset:17408
    v_mfma_f32_16x16x32_bf16 v[236:239], v[116:119], v[84:87], v[236:239]
    ds_read_b64_tr_b16 v[116:117], v59 offset:16384
    s_waitcnt lgkmcnt(13)
    v_mfma_f32_16x16x32_bf16 v[240:243], v[120:123], v[80:83], v[240:243]
    ds_read_b64_tr_b16 v[118:119], v59 offset:17408
    v_mfma_f32_16x16x32_bf16 v[244:247], v[120:123], v[84:87], v[244:247]
    ds_read_b64_tr_b16 v[120:121], v60 offset:16384
    s_waitcnt lgkmcnt(13)
    v_mfma_f32_16x16x32_bf16 v[248:251], v[124:127], v[80:83], v[248:251]
    ds_read_b64_tr_b16 v[122:123], v60 offset:17408
    v_mfma_f32_16x16x32_bf16 v[252:255], v[124:127], v[84:87], v[252:255]
    ds_read_b64_tr_b16 v[124:125], v61 offset:16384
    ds_read_b64_tr_b16 v[126:127], v61 offset:17408
    buffer_load_dwordx4 v[80:83], v13, s[8:11], s87 offen offset:0 sc1
    buffer_load_dwordx4 v[84:87], v12, s[8:11], s87 offen offset:0 sc1
    s_waitcnt vmcnt(16)
    s_waitcnt lgkmcnt(14)
    v_mfma_f32_16x16x32_bf16 v[192:195], v[96:99], v[88:91], v[192:195]
    v_mfma_f32_16x16x32_bf16 v[196:199], v[96:99], v[92:95], v[196:199]
    ds_read_b64_tr_b16 v[96:97], v54 offset:24576
    s_waitcnt lgkmcnt(13)
    v_mfma_f32_16x16x32_bf16 v[200:203], v[100:103], v[88:91], v[200:203]
    ds_read_b64_tr_b16 v[98:99], v54 offset:25600
    v_mfma_f32_16x16x32_bf16 v[204:207], v[100:103], v[92:95], v[204:207]
    ds_read_b64_tr_b16 v[100:101], v55 offset:24576
    s_waitcnt lgkmcnt(13)
    v_mfma_f32_16x16x32_bf16 v[208:211], v[104:107], v[88:91], v[208:211]
    ds_read_b64_tr_b16 v[102:103], v55 offset:25600
    v_mfma_f32_16x16x32_bf16 v[212:215], v[104:107], v[92:95], v[212:215]
    ds_read_b64_tr_b16 v[104:105], v56 offset:24576
    s_waitcnt lgkmcnt(13)
    v_mfma_f32_16x16x32_bf16 v[216:219], v[108:111], v[88:91], v[216:219]
    ds_read_b64_tr_b16 v[106:107], v56 offset:25600
    v_mfma_f32_16x16x32_bf16 v[220:223], v[108:111], v[92:95], v[220:223]
    ds_read_b64_tr_b16 v[108:109], v57 offset:24576
    s_waitcnt lgkmcnt(13)
    v_mfma_f32_16x16x32_bf16 v[224:227], v[112:115], v[88:91], v[224:227]
    ds_read_b64_tr_b16 v[110:111], v57 offset:25600
    v_mfma_f32_16x16x32_bf16 v[228:231], v[112:115], v[92:95], v[228:231]
    ds_read_b64_tr_b16 v[112:113], v58 offset:24576
    s_waitcnt lgkmcnt(13)
    v_mfma_f32_16x16x32_bf16 v[232:235], v[116:119], v[88:91], v[232:235]
    ds_read_b64_tr_b16 v[114:115], v58 offset:25600
    v_mfma_f32_16x16x32_bf16 v[236:239], v[116:119], v[92:95], v[236:239]
    ds_read_b64_tr_b16 v[116:117], v59 offset:24576
    s_waitcnt lgkmcnt(13)
    v_mfma_f32_16x16x32_bf16 v[240:243], v[120:123], v[88:91], v[240:243]
    ds_read_b64_tr_b16 v[118:119], v59 offset:25600
    v_mfma_f32_16x16x32_bf16 v[244:247], v[120:123], v[92:95], v[244:247]
    ds_read_b64_tr_b16 v[120:121], v60 offset:24576
    s_waitcnt lgkmcnt(13)
    v_mfma_f32_16x16x32_bf16 v[248:251], v[124:127], v[88:91], v[248:251]
    ds_read_b64_tr_b16 v[122:123], v60 offset:25600
    v_mfma_f32_16x16x32_bf16 v[252:255], v[124:127], v[92:95], v[252:255]
    ds_read_b64_tr_b16 v[124:125], v61 offset:24576
    ds_read_b64_tr_b16 v[126:127], v61 offset:25600
    buffer_load_dwordx4 v[88:91], v13, s[8:11], s87 offen offset:1024 sc1
    buffer_load_dwordx4 v[92:95], v12, s[8:11], s87 offen offset:1024 sc1
    s_waitcnt vmcnt(8)
    s_lshl_b32 s6, s4, 3
    s_add_u32 s6, s6, s5
    s_lshl_b32 s6, s6, 5
    s_add_u32 s6, s6, s3
    s_lshl_b32 s6, s6, 2
    s_add_u32 s6, s6, 3866624
    v_mov_b32 v2, 1
    v_mov_b32 v3, 0x5000000
    v_writelane_b32 v3, s6, 0
    buffer_store_dword v2, v3, s[8:11], 0 offen sc1
    s_waitcnt lgkmcnt(14)
    v_mfma_f32_16x16x32_bf16 v[192:195], v[96:99], v[16:19], v[192:195]
    v_mfma_f32_16x16x32_bf16 v[196:199], v[96:99], v[20:23], v[196:199]
    ds_read_b64_tr_b16 v[96:97], v54 offset:32768
    s_waitcnt lgkmcnt(13)
    v_mfma_f32_16x16x32_bf16 v[200:203], v[100:103], v[16:19], v[200:203]
    ds_read_b64_tr_b16 v[98:99], v54 offset:33792
    v_mfma_f32_16x16x32_bf16 v[204:207], v[100:103], v[20:23], v[204:207]
    ds_read_b64_tr_b16 v[100:101], v55 offset:32768
    s_waitcnt lgkmcnt(13)
    v_mfma_f32_16x16x32_bf16 v[208:211], v[104:107], v[16:19], v[208:211]
    ds_read_b64_tr_b16 v[102:103], v55 offset:33792
    v_mfma_f32_16x16x32_bf16 v[212:215], v[104:107], v[20:23], v[212:215]
    ds_read_b64_tr_b16 v[104:105], v56 offset:32768
    s_waitcnt lgkmcnt(13)
    v_mfma_f32_16x16x32_bf16 v[216:219], v[108:111], v[16:19], v[216:219]
    ds_read_b64_tr_b16 v[106:107], v56 offset:33792
    v_mfma_f32_16x16x32_bf16 v[220:223], v[108:111], v[20:23], v[220:223]
    ds_read_b64_tr_b16 v[108:109], v57 offset:32768
    s_waitcnt lgkmcnt(13)
    v_mfma_f32_16x16x32_bf16 v[224:227], v[112:115], v[16:19], v[224:227]
    ds_read_b64_tr_b16 v[110:111], v57 offset:33792
    v_mfma_f32_16x16x32_bf16 v[228:231], v[112:115], v[20:23], v[228:231]
    ds_read_b64_tr_b16 v[112:113], v58 offset:32768
    s_waitcnt lgkmcnt(13)
    v_mfma_f32_16x16x32_bf16 v[232:235], v[116:119], v[16:19], v[232:235]
    ds_read_b64_tr_b16 v[114:115], v58 offset:33792
    v_mfma_f32_16x16x32_bf16 v[236:239], v[116:119], v[20:23], v[236:239]
    ds_read_b64_tr_b16 v[116:117], v59 offset:32768
    s_waitcnt lgkmcnt(13)
    v_mfma_f32_16x16x32_bf16 v[240:243], v[120:123], v[16:19], v[240:243]
    ds_read_b64_tr_b16 v[118:119], v59 offset:33792
    v_mfma_f32_16x16x32_bf16 v[244:247], v[120:123], v[20:23], v[244:247]
    ds_read_b64_tr_b16 v[120:121], v60 offset:32768
    s_waitcnt lgkmcnt(13)
    v_mfma_f32_16x16x32_bf16 v[248:251], v[124:127], v[16:19], v[248:251]
    ds_read_b64_tr_b16 v[122:123], v60 offset:33792
    v_mfma_f32_16x16x32_bf16 v[252:255], v[124:127], v[20:23], v[252:255]
    ds_read_b64_tr_b16 v[124:125], v61 offset:32768
    ds_read_b64_tr_b16 v[126:127], v61 offset:33792
    buffer_load_dwordx4 v[16:19], v13, s[8:11], s87 offen offset:2048 sc1
    buffer_load_dwordx4 v[20:23], v12, s[8:11], s87 offen offset:2048 sc1
    s_waitcnt lgkmcnt(14)
    v_mfma_f32_16x16x32_bf16 v[192:195], v[96:99], v[24:27], v[192:195]
    v_mfma_f32_16x16x32_bf16 v[196:199], v[96:99], v[28:31], v[196:199]
    ds_read_b64_tr_b16 v[96:97], v54 offset:40960
    s_waitcnt lgkmcnt(13)
    v_mfma_f32_16x16x32_bf16 v[200:203], v[100:103], v[24:27], v[200:203]
    ds_read_b64_tr_b16 v[98:99], v54 offset:41984
    v_mfma_f32_16x16x32_bf16 v[204:207], v[100:103], v[28:31], v[204:207]
    ds_read_b64_tr_b16 v[100:101], v55 offset:40960
    s_waitcnt lgkmcnt(13)
    v_mfma_f32_16x16x32_bf16 v[208:211], v[104:107], v[24:27], v[208:211]
    ds_read_b64_tr_b16 v[102:103], v55 offset:41984
    v_mfma_f32_16x16x32_bf16 v[212:215], v[104:107], v[28:31], v[212:215]
    ds_read_b64_tr_b16 v[104:105], v56 offset:40960
    s_waitcnt lgkmcnt(13)
    v_mfma_f32_16x16x32_bf16 v[216:219], v[108:111], v[24:27], v[216:219]
    ds_read_b64_tr_b16 v[106:107], v56 offset:41984
    v_mfma_f32_16x16x32_bf16 v[220:223], v[108:111], v[28:31], v[220:223]
    ds_read_b64_tr_b16 v[108:109], v57 offset:40960
    s_waitcnt lgkmcnt(13)
    v_mfma_f32_16x16x32_bf16 v[224:227], v[112:115], v[24:27], v[224:227]
    ds_read_b64_tr_b16 v[110:111], v57 offset:41984
    v_mfma_f32_16x16x32_bf16 v[228:231], v[112:115], v[28:31], v[228:231]
    ds_read_b64_tr_b16 v[112:113], v58 offset:40960
    s_waitcnt lgkmcnt(13)
    v_mfma_f32_16x16x32_bf16 v[232:235], v[116:119], v[24:27], v[232:235]
    ds_read_b64_tr_b16 v[114:115], v58 offset:41984
    v_mfma_f32_16x16x32_bf16 v[236:239], v[116:119], v[28:31], v[236:239]
    ds_read_b64_tr_b16 v[116:117], v59 offset:40960
    s_waitcnt lgkmcnt(13)
    v_mfma_f32_16x16x32_bf16 v[240:243], v[120:123], v[24:27], v[240:243]
    ds_read_b64_tr_b16 v[118:119], v59 offset:41984
    v_mfma_f32_16x16x32_bf16 v[244:247], v[120:123], v[28:31], v[244:247]
    ds_read_b64_tr_b16 v[120:121], v60 offset:40960
    s_waitcnt lgkmcnt(13)
    v_mfma_f32_16x16x32_bf16 v[248:251], v[124:127], v[24:27], v[248:251]
    ds_read_b64_tr_b16 v[122:123], v60 offset:41984
    v_mfma_f32_16x16x32_bf16 v[252:255], v[124:127], v[28:31], v[252:255]
    ds_read_b64_tr_b16 v[124:125], v61 offset:40960
    ds_read_b64_tr_b16 v[126:127], v61 offset:41984
    buffer_load_dwordx4 v[24:27], v13, s[8:11], s87 offen offset:3072 sc1
    buffer_load_dwordx4 v[28:31], v12, s[8:11], s87 offen offset:3072 sc1
    s_waitcnt lgkmcnt(14)
    v_mfma_f32_16x16x32_bf16 v[192:195], v[96:99], v[32:35], v[192:195]
    v_mfma_f32_16x16x32_bf16 v[196:199], v[96:99], v[36:39], v[196:199]
    ds_read_b64_tr_b16 v[96:97], v54 offset:49152
    s_waitcnt lgkmcnt(13)
    v_mfma_f32_16x16x32_bf16 v[200:203], v[100:103], v[32:35], v[200:203]
    ds_read_b64_tr_b16 v[98:99], v54 offset:50176
    v_mfma_f32_16x16x32_bf16 v[204:207], v[100:103], v[36:39], v[204:207]
    ds_read_b64_tr_b16 v[100:101], v55 offset:49152
    s_waitcnt lgkmcnt(13)
    v_mfma_f32_16x16x32_bf16 v[208:211], v[104:107], v[32:35], v[208:211]
    ds_read_b64_tr_b16 v[102:103], v55 offset:50176
    v_mfma_f32_16x16x32_bf16 v[212:215], v[104:107], v[36:39], v[212:215]
    ds_read_b64_tr_b16 v[104:105], v56 offset:49152
    s_waitcnt lgkmcnt(13)
    v_mfma_f32_16x16x32_bf16 v[216:219], v[108:111], v[32:35], v[216:219]
    ds_read_b64_tr_b16 v[106:107], v56 offset:50176
    v_mfma_f32_16x16x32_bf16 v[220:223], v[108:111], v[36:39], v[220:223]
    ds_read_b64_tr_b16 v[108:109], v57 offset:49152
    s_waitcnt lgkmcnt(13)
    v_mfma_f32_16x16x32_bf16 v[224:227], v[112:115], v[32:35], v[224:227]
    ds_read_b64_tr_b16 v[110:111], v57 offset:50176
    v_mfma_f32_16x16x32_bf16 v[228:231], v[112:115], v[36:39], v[228:231]
    ds_read_b64_tr_b16 v[112:113], v58 offset:49152
    s_waitcnt lgkmcnt(13)
    v_mfma_f32_16x16x32_bf16 v[232:235], v[116:119], v[32:35], v[232:235]
    ds_read_b64_tr_b16 v[114:115], v58 offset:50176
    v_mfma_f32_16x16x32_bf16 v[236:239], v[116:119], v[36:39], v[236:239]
    ds_read_b64_tr_b16 v[116:117], v59 offset:49152
    s_waitcnt lgkmcnt(13)
    v_mfma_f32_16x16x32_bf16 v[240:243], v[120:123], v[32:35], v[240:243]
    ds_read_b64_tr_b16 v[118:119], v59 offset:50176
    v_mfma_f32_16x16x32_bf16 v[244:247], v[120:123], v[36:39], v[244:247]
    ds_read_b64_tr_b16 v[120:121], v60 offset:49152
    s_waitcnt lgkmcnt(13)
    v_mfma_f32_16x16x32_bf16 v[248:251], v[124:127], v[32:35], v[248:251]
    ds_read_b64_tr_b16 v[122:123], v60 offset:50176
    v_mfma_f32_16x16x32_bf16 v[252:255], v[124:127], v[36:39], v[252:255]
    ds_read_b64_tr_b16 v[124:125], v61 offset:49152
    ds_read_b64_tr_b16 v[126:127], v61 offset:50176
    buffer_load_dwordx4 v[32:35], v13, s[8:11], s88 offen offset:0 sc1
    buffer_load_dwordx4 v[36:39], v12, s[8:11], s88 offen offset:0 sc1
    s_waitcnt vmcnt(13)
    s_waitcnt lgkmcnt(14)
    v_mfma_f32_16x16x32_bf16 v[192:195], v[96:99], v[64:67], v[192:195]
    v_mfma_f32_16x16x32_bf16 v[196:199], v[96:99], v[68:71], v[196:199]
    ds_read_b64_tr_b16 v[96:97], v54 offset:57344
    s_waitcnt lgkmcnt(13)
    v_mfma_f32_16x16x32_bf16 v[200:203], v[100:103], v[64:67], v[200:203]
    ds_read_b64_tr_b16 v[98:99], v54 offset:58368
    v_mfma_f32_16x16x32_bf16 v[204:207], v[100:103], v[68:71], v[204:207]
    ds_read_b64_tr_b16 v[100:101], v55 offset:57344
    s_waitcnt lgkmcnt(13)
    v_mfma_f32_16x16x32_bf16 v[208:211], v[104:107], v[64:67], v[208:211]
    ds_read_b64_tr_b16 v[102:103], v55 offset:58368
    v_mfma_f32_16x16x32_bf16 v[212:215], v[104:107], v[68:71], v[212:215]
    ds_read_b64_tr_b16 v[104:105], v56 offset:57344
    s_waitcnt lgkmcnt(13)
    v_mfma_f32_16x16x32_bf16 v[216:219], v[108:111], v[64:67], v[216:219]
    ds_read_b64_tr_b16 v[106:107], v56 offset:58368
    v_mfma_f32_16x16x32_bf16 v[220:223], v[108:111], v[68:71], v[220:223]
    ds_read_b64_tr_b16 v[108:109], v57 offset:57344
    s_waitcnt lgkmcnt(13)
    v_mfma_f32_16x16x32_bf16 v[224:227], v[112:115], v[64:67], v[224:227]
    ds_read_b64_tr_b16 v[110:111], v57 offset:58368
    v_mfma_f32_16x16x32_bf16 v[228:231], v[112:115], v[68:71], v[228:231]
    ds_read_b64_tr_b16 v[112:113], v58 offset:57344
    s_waitcnt lgkmcnt(13)
    v_mfma_f32_16x16x32_bf16 v[232:235], v[116:119], v[64:67], v[232:235]
    ds_read_b64_tr_b16 v[114:115], v58 offset:58368
    v_mfma_f32_16x16x32_bf16 v[236:239], v[116:119], v[68:71], v[236:239]
    ds_read_b64_tr_b16 v[116:117], v59 offset:57344
    s_waitcnt lgkmcnt(13)
    v_mfma_f32_16x16x32_bf16 v[240:243], v[120:123], v[64:67], v[240:243]
    ds_read_b64_tr_b16 v[118:119], v59 offset:58368
    v_mfma_f32_16x16x32_bf16 v[244:247], v[120:123], v[68:71], v[244:247]
    ds_read_b64_tr_b16 v[120:121], v60 offset:57344
    s_waitcnt lgkmcnt(13)
    v_mfma_f32_16x16x32_bf16 v[248:251], v[124:127], v[64:67], v[248:251]
    ds_read_b64_tr_b16 v[122:123], v60 offset:58368
    v_mfma_f32_16x16x32_bf16 v[252:255], v[124:127], v[68:71], v[252:255]
    ds_read_b64_tr_b16 v[124:125], v61 offset:57344
    ds_read_b64_tr_b16 v[126:127], v61 offset:58368
    buffer_load_dwordx4 v[64:67], v13, s[8:11], s88 offen offset:1024 sc1
    buffer_load_dwordx4 v[68:71], v12, s[8:11], s88 offen offset:1024 sc1
    s_waitcnt vmcnt(13)
    s_waitcnt lgkmcnt(14)
    v_mfma_f32_16x16x32_bf16 v[192:195], v[96:99], v[72:75], v[192:195]
    v_add_u32 v54, 0x10000, v54
    v_mfma_f32_16x16x32_bf16 v[196:199], v[96:99], v[76:79], v[196:199]
    s_waitcnt lgkmcnt(12)
    v_mfma_f32_16x16x32_bf16 v[200:203], v[100:103], v[72:75], v[200:203]
    v_add_u32 v55, 0x10000, v55
    v_mfma_f32_16x16x32_bf16 v[204:207], v[100:103], v[76:79], v[204:207]
    s_waitcnt lgkmcnt(0)
    s_barrier
    ds_read_b64_tr_b16 v[96:97], v54 offset:0
    ds_read_b64_tr_b16 v[98:99], v54 offset:1024
    ds_read_b64_tr_b16 v[100:101], v55 offset:0
    v_mfma_f32_16x16x32_bf16 v[208:211], v[104:107], v[72:75], v[208:211]
    ds_read_b64_tr_b16 v[102:103], v55 offset:1024
    v_add_u32 v56, 0x10000, v56
    v_mfma_f32_16x16x32_bf16 v[212:215], v[104:107], v[76:79], v[212:215]
    ds_read_b64_tr_b16 v[104:105], v56 offset:0
    v_mfma_f32_16x16x32_bf16 v[216:219], v[108:111], v[72:75], v[216:219]
    ds_read_b64_tr_b16 v[106:107], v56 offset:1024
    v_add_u32 v57, 0x10000, v57
    v_mfma_f32_16x16x32_bf16 v[220:223], v[108:111], v[76:79], v[220:223]
    ds_read_b64_tr_b16 v[108:109], v57 offset:0
    v_mfma_f32_16x16x32_bf16 v[224:227], v[112:115], v[72:75], v[224:227]
    ds_read_b64_tr_b16 v[110:111], v57 offset:1024
    v_add_u32 v58, 0x10000, v58
    v_mfma_f32_16x16x32_bf16 v[228:231], v[112:115], v[76:79], v[228:231]
    ds_read_b64_tr_b16 v[112:113], v58 offset:0
    v_mfma_f32_16x16x32_bf16 v[232:235], v[116:119], v[72:75], v[232:235]
    ds_read_b64_tr_b16 v[114:115], v58 offset:1024
    v_add_u32 v59, 0x10000, v59
    v_mfma_f32_16x16x32_bf16 v[236:239], v[116:119], v[76:79], v[236:239]
    ds_read_b64_tr_b16 v[116:117], v59 offset:0
    v_mfma_f32_16x16x32_bf16 v[240:243], v[120:123], v[72:75], v[240:243]
    ds_read_b64_tr_b16 v[118:119], v59 offset:1024
    v_add_u32 v60, 0x10000, v60
    v_mfma_f32_16x16x32_bf16 v[244:247], v[120:123], v[76:79], v[244:247]
    ds_read_b64_tr_b16 v[120:121], v60 offset:0
    v_mfma_f32_16x16x32_bf16 v[248:251], v[124:127], v[72:75], v[248:251]
    ds_read_b64_tr_b16 v[122:123], v60 offset:1024
    v_add_u32 v61, 0x10000, v61
    v_mfma_f32_16x16x32_bf16 v[252:255], v[124:127], v[76:79], v[252:255]
    ds_read_b64_tr_b16 v[124:125], v61 offset:0
    ds_read_b64_tr_b16 v[126:127], v61 offset:1024
    buffer_load_dwordx4 v[72:75], v13, s[8:11], s88 offen offset:2048 sc1
    buffer_load_dwordx4 v[76:79], v12, s[8:11], s88 offen offset:2048 sc1
    s_waitcnt vmcnt(13)
    s_waitcnt lgkmcnt(14)
    v_mfma_f32_16x16x32_bf16 v[192:195], v[96:99], v[80:83], v[192:195]
    v_mfma_f32_16x16x32_bf16 v[196:199], v[96:99], v[84:87], v[196:199]
    ds_read_b64_tr_b16 v[96:97], v54 offset:8192
    s_waitcnt lgkmcnt(13)
    v_mfma_f32_16x16x32_bf16 v[200:203], v[100:103], v[80:83], v[200:203]
    ds_read_b64_tr_b16 v[98:99], v54 offset:9216
    v_mfma_f32_16x16x32_bf16 v[204:207], v[100:103], v[84:87], v[204:207]
    ds_read_b64_tr_b16 v[100:101], v55 offset:8192
    s_waitcnt lgkmcnt(13)
    v_mfma_f32_16x16x32_bf16 v[208:211], v[104:107], v[80:83], v[208:211]
    ds_read_b64_tr_b16 v[102:103], v55 offset:9216
    v_mfma_f32_16x16x32_bf16 v[212:215], v[104:107], v[84:87], v[212:215]
    ds_read_b64_tr_b16 v[104:105], v56 offset:8192
    s_waitcnt lgkmcnt(13)
    v_mfma_f32_16x16x32_bf16 v[216:219], v[108:111], v[80:83], v[216:219]
    ds_read_b64_tr_b16 v[106:107], v56 offset:9216
    v_mfma_f32_16x16x32_bf16 v[220:223], v[108:111], v[84:87], v[220:223]
    ds_read_b64_tr_b16 v[108:109], v57 offset:8192
    s_waitcnt lgkmcnt(13)
    v_mfma_f32_16x16x32_bf16 v[224:227], v[112:115], v[80:83], v[224:227]
    ds_read_b64_tr_b16 v[110:111], v57 offset:9216
    v_mfma_f32_16x16x32_bf16 v[228:231], v[112:115], v[84:87], v[228:231]
    ds_read_b64_tr_b16 v[112:113], v58 offset:8192
    s_waitcnt lgkmcnt(13)
    v_mfma_f32_16x16x32_bf16 v[232:235], v[116:119], v[80:83], v[232:235]
    ds_read_b64_tr_b16 v[114:115], v58 offset:9216
    v_mfma_f32_16x16x32_bf16 v[236:239], v[116:119], v[84:87], v[236:239]
    ds_read_b64_tr_b16 v[116:117], v59 offset:8192
    s_waitcnt lgkmcnt(13)
    v_mfma_f32_16x16x32_bf16 v[240:243], v[120:123], v[80:83], v[240:243]
    ds_read_b64_tr_b16 v[118:119], v59 offset:9216
    v_mfma_f32_16x16x32_bf16 v[244:247], v[120:123], v[84:87], v[244:247]
    ds_read_b64_tr_b16 v[120:121], v60 offset:8192
    s_waitcnt lgkmcnt(13)
    v_mfma_f32_16x16x32_bf16 v[248:251], v[124:127], v[80:83], v[248:251]
    ds_read_b64_tr_b16 v[122:123], v60 offset:9216
    v_mfma_f32_16x16x32_bf16 v[252:255], v[124:127], v[84:87], v[252:255]
    ds_read_b64_tr_b16 v[124:125], v61 offset:8192
    ds_read_b64_tr_b16 v[126:127], v61 offset:9216
    buffer_load_dwordx4 v[80:83], v13, s[8:11], s88 offen offset:3072 sc1
    buffer_load_dwordx4 v[84:87], v12, s[8:11], s88 offen offset:3072 sc1
    s_waitcnt vmcnt(13)
    s_waitcnt lgkmcnt(14)
    v_mfma_f32_16x16x32_bf16 v[192:195], v[96:99], v[88:91], v[192:195]
    v_mfma_f32_16x16x32_bf16 v[196:199], v[96:99], v[92:95], v[196:199]
    ds_read_b64_tr_b16 v[96:97], v54 offset:16384
    s_waitcnt lgkmcnt(13)
    v_mfma_f32_16x16x32_bf16 v[200:203], v[100:103], v[88:91], v[200:203]
    ds_read_b64_tr_b16 v[98:99], v54 offset:17408
    v_mfma_f32_16x16x32_bf16 v[204:207], v[100:103], v[92:95], v[204:207]
    ds_read_b64_tr_b16 v[100:101], v55 offset:16384
    s_waitcnt lgkmcnt(13)
    v_mfma_f32_16x16x32_bf16 v[208:211], v[104:107], v[88:91], v[208:211]
    ds_read_b64_tr_b16 v[102:103], v55 offset:17408
    v_mfma_f32_16x16x32_bf16 v[212:215], v[104:107], v[92:95], v[212:215]
    ds_read_b64_tr_b16 v[104:105], v56 offset:16384
    s_waitcnt lgkmcnt(13)
    v_mfma_f32_16x16x32_bf16 v[216:219], v[108:111], v[88:91], v[216:219]
    ds_read_b64_tr_b16 v[106:107], v56 offset:17408
    v_mfma_f32_16x16x32_bf16 v[220:223], v[108:111], v[92:95], v[220:223]
    ds_read_b64_tr_b16 v[108:109], v57 offset:16384
    s_waitcnt lgkmcnt(13)
    v_mfma_f32_16x16x32_bf16 v[224:227], v[112:115], v[88:91], v[224:227]
    ds_read_b64_tr_b16 v[110:111], v57 offset:17408
    v_mfma_f32_16x16x32_bf16 v[228:231], v[112:115], v[92:95], v[228:231]
    ds_read_b64_tr_b16 v[112:113], v58 offset:16384
    s_waitcnt lgkmcnt(13)
    v_mfma_f32_16x16x32_bf16 v[232:235], v[116:119], v[88:91], v[232:235]
    ds_read_b64_tr_b16 v[114:115], v58 offset:17408
    v_mfma_f32_16x16x32_bf16 v[236:239], v[116:119], v[92:95], v[236:239]
    ds_read_b64_tr_b16 v[116:117], v59 offset:16384
    s_waitcnt lgkmcnt(13)
    v_mfma_f32_16x16x32_bf16 v[240:243], v[120:123], v[88:91], v[240:243]
    ds_read_b64_tr_b16 v[118:119], v59 offset:17408
    v_mfma_f32_16x16x32_bf16 v[244:247], v[120:123], v[92:95], v[244:247]
    ds_read_b64_tr_b16 v[120:121], v60 offset:16384
    s_waitcnt lgkmcnt(13)
    v_mfma_f32_16x16x32_bf16 v[248:251], v[124:127], v[88:91], v[248:251]
    ds_read_b64_tr_b16 v[122:123], v60 offset:17408
    v_mfma_f32_16x16x32_bf16 v[252:255], v[124:127], v[92:95], v[252:255]
    ds_read_b64_tr_b16 v[124:125], v61 offset:16384
    ds_read_b64_tr_b16 v[126:127], v61 offset:17408
    s_waitcnt vmcnt(10)
    s_waitcnt lgkmcnt(14)
    v_mfma_f32_16x16x32_bf16 v[192:195], v[96:99], v[16:19], v[192:195]
    v_mfma_f32_16x16x32_bf16 v[196:199], v[96:99], v[20:23], v[196:199]
    ds_read_b64_tr_b16 v[96:97], v54 offset:24576
    s_waitcnt lgkmcnt(13)
    v_mfma_f32_16x16x32_bf16 v[200:203], v[100:103], v[16:19], v[200:203]
    ds_read_b64_tr_b16 v[98:99], v54 offset:25600
    v_mfma_f32_16x16x32_bf16 v[204:207], v[100:103], v[20:23], v[204:207]
    ds_read_b64_tr_b16 v[100:101], v55 offset:24576
    s_waitcnt lgkmcnt(13)
    v_mfma_f32_16x16x32_bf16 v[208:211], v[104:107], v[16:19], v[208:211]
    ds_read_b64_tr_b16 v[102:103], v55 offset:25600
    v_mfma_f32_16x16x32_bf16 v[212:215], v[104:107], v[20:23], v[212:215]
    ds_read_b64_tr_b16 v[104:105], v56 offset:24576
    s_waitcnt lgkmcnt(13)
    v_mfma_f32_16x16x32_bf16 v[216:219], v[108:111], v[16:19], v[216:219]
    ds_read_b64_tr_b16 v[106:107], v56 offset:25600
    v_mfma_f32_16x16x32_bf16 v[220:223], v[108:111], v[20:23], v[220:223]
    ds_read_b64_tr_b16 v[108:109], v57 offset:24576
    s_waitcnt lgkmcnt(13)
    v_mfma_f32_16x16x32_bf16 v[224:227], v[112:115], v[16:19], v[224:227]
    ds_read_b64_tr_b16 v[110:111], v57 offset:25600
    v_mfma_f32_16x16x32_bf16 v[228:231], v[112:115], v[20:23], v[228:231]
    ds_read_b64_tr_b16 v[112:113], v58 offset:24576
    s_waitcnt lgkmcnt(13)
    v_mfma_f32_16x16x32_bf16 v[232:235], v[116:119], v[16:19], v[232:235]
    ds_read_b64_tr_b16 v[114:115], v58 offset:25600
    v_mfma_f32_16x16x32_bf16 v[236:239], v[116:119], v[20:23], v[236:239]
    ds_read_b64_tr_b16 v[116:117], v59 offset:24576
    s_waitcnt lgkmcnt(13)
    v_mfma_f32_16x16x32_bf16 v[240:243], v[120:123], v[16:19], v[240:243]
    ds_read_b64_tr_b16 v[118:119], v59 offset:25600
    v_mfma_f32_16x16x32_bf16 v[244:247], v[120:123], v[20:23], v[244:247]
    ds_read_b64_tr_b16 v[120:121], v60 offset:24576
    s_waitcnt lgkmcnt(13)
    v_mfma_f32_16x16x32_bf16 v[248:251], v[124:127], v[16:19], v[248:251]
    ds_read_b64_tr_b16 v[122:123], v60 offset:25600
    v_mfma_f32_16x16x32_bf16 v[252:255], v[124:127], v[20:23], v[252:255]
    ds_read_b64_tr_b16 v[124:125], v61 offset:24576
    ds_read_b64_tr_b16 v[126:127], v61 offset:25600
    s_waitcnt vmcnt(8)
    s_waitcnt lgkmcnt(14)
    v_mfma_f32_16x16x32_bf16 v[192:195], v[96:99], v[24:27], v[192:195]
    v_mfma_f32_16x16x32_bf16 v[196:199], v[96:99], v[28:31], v[196:199]
    ds_read_b64_tr_b16 v[96:97], v54 offset:32768
    s_waitcnt lgkmcnt(13)
    v_mfma_f32_16x16x32_bf16 v[200:203], v[100:103], v[24:27], v[200:203]
    ds_read_b64_tr_b16 v[98:99], v54 offset:33792
    v_mfma_f32_16x16x32_bf16 v[204:207], v[100:103], v[28:31], v[204:207]
    ds_read_b64_tr_b16 v[100:101], v55 offset:32768
    s_waitcnt lgkmcnt(13)
    v_mfma_f32_16x16x32_bf16 v[208:211], v[104:107], v[24:27], v[208:211]
    ds_read_b64_tr_b16 v[102:103], v55 offset:33792
    v_mfma_f32_16x16x32_bf16 v[212:215], v[104:107], v[28:31], v[212:215]
    ds_read_b64_tr_b16 v[104:105], v56 offset:32768
    s_waitcnt lgkmcnt(13)
    v_mfma_f32_16x16x32_bf16 v[216:219], v[108:111], v[24:27], v[216:219]
    ds_read_b64_tr_b16 v[106:107], v56 offset:33792
    v_mfma_f32_16x16x32_bf16 v[220:223], v[108:111], v[28:31], v[220:223]
    ds_read_b64_tr_b16 v[108:109], v57 offset:32768
    s_waitcnt lgkmcnt(13)
    v_mfma_f32_16x16x32_bf16 v[224:227], v[112:115], v[24:27], v[224:227]
    ds_read_b64_tr_b16 v[110:111], v57 offset:33792
    v_mfma_f32_16x16x32_bf16 v[228:231], v[112:115], v[28:31], v[228:231]
    ds_read_b64_tr_b16 v[112:113], v58 offset:32768
    s_waitcnt lgkmcnt(13)
    v_mfma_f32_16x16x32_bf16 v[232:235], v[116:119], v[24:27], v[232:235]
    ds_read_b64_tr_b16 v[114:115], v58 offset:33792
    v_mfma_f32_16x16x32_bf16 v[236:239], v[116:119], v[28:31], v[236:239]
    ds_read_b64_tr_b16 v[116:117], v59 offset:32768
    s_waitcnt lgkmcnt(13)
    v_mfma_f32_16x16x32_bf16 v[240:243], v[120:123], v[24:27], v[240:243]
    ds_read_b64_tr_b16 v[118:119], v59 offset:33792
    v_mfma_f32_16x16x32_bf16 v[244:247], v[120:123], v[28:31], v[244:247]
    ds_read_b64_tr_b16 v[120:121], v60 offset:32768
    s_waitcnt lgkmcnt(13)
    v_mfma_f32_16x16x32_bf16 v[248:251], v[124:127], v[24:27], v[248:251]
    ds_read_b64_tr_b16 v[122:123], v60 offset:33792
    v_mfma_f32_16x16x32_bf16 v[252:255], v[124:127], v[28:31], v[252:255]
    ds_read_b64_tr_b16 v[124:125], v61 offset:32768
    ds_read_b64_tr_b16 v[126:127], v61 offset:33792
    s_waitcnt vmcnt(0)
    s_cmp_ge_u32 s3, 4
    s_cbranch_scc1 L_q_nold
    s_lshl_b32 s7, s4, 10
    s_add_u32 s7, s7, 3866624
    v_lshrrev_b32 v2, 3, v1
    v_and_b32 v3, 7, v1
    v_lshlrev_b32 v3, 2, v3
    v_lshl_add_u32 v3, v2, 7, v3
    s_mov_b32 s79, 262144
L_poll_7:
    buffer_load_dword v2, v3, s[8:11], s7 offen sc1
    s_waitcnt vmcnt(0)
    v_cmp_gt_u32 vcc, 1, v2
    s_cbranch_vccz L_polldone_8
    s_sleep 2
    s_sub_u32 s79, s79, 1
    s_cmp_lg_u32 s79, 0
    s_cbranch_scc1 L_poll_7
L_polldone_8:
    s_lshl_b32 s6, s76, 13
    s_add_u32 s6, s6, s78
    s_add_u32 m0, s6, 0
    s_add_u32 s7, s77, 0
    buffer_load_dwordx4 v49, s[8:11], s7 offen offset:0 sc1 lds
    buffer_load_dwordx4 v49, s[8:11], s7 offen offset:1024 sc1 lds
    buffer_load_dwordx4 v49, s[8:11], s7 offen offset:2048 sc1 lds
    buffer_load_dwordx4 v49, s[8:11], s7 offen offset:3072 sc1 lds
    s_lshl_b32 s6, s76, 13
    s_add_u32 s6, s6, s78
    s_add_u32 m0, s6, 4096
    s_add_u32 s7, s77, 4096
    buffer_load_dwordx4 v49, s[8:11], s7 offen offset:0 sc1 lds
    buffer_load_dwordx4 v49, s[8:11], s7 offen offset:1024 sc1 lds
    buffer_load_dwordx4 v49, s[8:11], s7 offen offset:2048 sc1 lds
    buffer_load_dwordx4 v49, s[8:11], s7 offen offset:3072 sc1 lds
    s_lshl_b32 s6, s76, 12
    s_add_u32 s6, s6, s78
    s_add_u32 m0, s6, 49152
    s_add_u32 s7, s77, 524288
    buffer_load_dwordx4 v50, s[8:11], s7 offen offset:0 sc1 lds
    buffer_load_dwordx4 v50, s[8:11], s7 offen offset:1024 sc1 lds
    buffer_load_dwordx4 v50, s[8:11], s7 offen offset:2048 sc1 lds
    buffer_load_dwordx4 v50, s[8:11], s7 offen offset:3072 sc1 lds
    s_branch L_q_j
L_q_nold:
    s_cmp_lg_u32 s3, 5
    s_cbranch_scc1 L_q_j
    s_mov_b32 s28, s56
    s_mov_b32 s29, s57
    s_mov_b32 s30, 0x100
    s_mov_b32 s31, 0x20000
    v_and_b32 v3, 31, v1
    v_lshlrev_b32 v3, 2, v3
    buffer_load_dword v63, v3, s[28:31], 0 offen offset:128 sc1
L_q_j:
    s_waitcnt lgkmcnt(14)
    v_mfma_f32_16x16x32_bf16 v[192:195], v[96:99], v[32:35], v[192:195]
    v_mfma_f32_16x16x32_bf16 v[196:199], v[96:99], v[36:39], v[196:199]
    ds_read_b64_tr_b16 v[96:97], v54 offset:40960
    s_waitcnt lgkmcnt(13)
    v_mfma_f32_16x16x32_bf16 v[200:203], v[100:103], v[32:35], v[200:203]
    ds_read_b64_tr_b16 v[98:99], v54 offset:41984
    v_mfma_f32_16x16x32_bf16 v[204:207], v[100:103], v[36:39], v[204:207]
    ds_read_b64_tr_b16 v[100:101], v55 offset:40960
    s_waitcnt lgkmcnt(13)
    v_mfma_f32_16x16x32_bf16 v[208:211], v[104:107], v[32:35], v[208:211]
    ds_read_b64_tr_b16 v[102:103], v55 offset:41984
    v_mfma_f32_16x16x32_bf16 v[212:215], v[104:107], v[36:39], v[212:215]
    ds_read_b64_tr_b16 v[104:105], v56 offset:40960
    s_waitcnt lgkmcnt(13)
    v_mfma_f32_16x16x32_bf16 v[216:219], v[108:111], v[32:35], v[216:219]
    ds_read_b64_tr_b16 v[106:107], v56 offset:41984
    buffer_store_dwordx4 v[144:147], v13, s[8:11], s67 offen sc1
    s_add_u32 s67, s67, 1024
    v_mfma_f32_16x16x32_bf16 v[220:223], v[108:111], v[36:39], v[220:223]
    ds_read_b64_tr_b16 v[108:109], v57 offset:40960
    s_waitcnt lgkmcnt(13)
    v_mfma_f32_16x16x32_bf16 v[224:227], v[112:115], v[32:35], v[224:227]
    ds_read_b64_tr_b16 v[110:111], v57 offset:41984
    v_mfma_f32_16x16x32_bf16 v[228:231], v[112:115], v[36:39], v[228:231]
    ds_read_b64_tr_b16 v[112:113], v58 offset:40960
    s_waitcnt lgkmcnt(13)
    v_mfma_f32_16x16x32_bf16 v[232:235], v[116:119], v[32:35], v[232:235]
    ds_read_b64_tr_b16 v[114:115], v58 offset:41984
    v_mfma_f32_16x16x32_bf16 v[236:239], v[116:119], v[36:39], v[236:239]
    ds_read_b64_tr_b16 v[116:117], v59 offset:40960
    s_waitcnt lgkmcnt(13)
    v_mfma_f32_16x16x32_bf16 v[240:243], v[120:123], v[32:35], v[240:243]
    ds_read_b64_tr_b16 v[118:119], v59 offset:41984
    v_mfma_f32_16x16x32_bf16 v[244:247], v[120:123], v[36:39], v[244:247]
    ds_read_b64_tr_b16 v[120:121], v60 offset:40960
    s_waitcnt lgkmcnt(13)
    v_mfma_f32_16x16x32_bf16 v[248:251], v[124:127], v[32:35], v[248:251]
    ds_read_b64_tr_b16 v[122:123], v60 offset:41984
    v_mfma_f32_16x16x32_bf16 v[252:255], v[124:127], v[36:39], v[252:255]
    ds_read_b64_tr_b16 v[124:125], v61 offset:40960
    ds_read_b64_tr_b16 v[126:127], v61 offset:41984
    s_waitcnt lgkmcnt(14)
    v_mfma_f32_16x16x32_bf16 v[192:195], v[96:99], v[64:67], v[192:195]
    v_mfma_f32_16x16x32_bf16 v[196:199], v[96:99], v[68:71], v[196:199]
    ds_read_b64_tr_b16 v[96:97], v54 offset:49152
    s_waitcnt lgkmcnt(13)
    v_mfma_f32_16x16x32_bf16 v[200:203], v[100:103], v[64:67], v[200:203]
    ds_read_b64_tr_b16 v[98:99], v54 offset:50176
    v_mfma_f32_16x16x32_bf16 v[204:207], v[100:103], v[68:71], v[204:207]
    ds_read_b64_tr_b16 v[100:101], v55 offset:49152
    s_waitcnt lgkmcnt(13)
    v_mfma_f32_16x16x32_bf16 v[208:211], v[104:107], v[64:67], v[208:211]
    ds_read_b64_tr_b16 v[102:103], v55 offset:50176
    v_mfma_f32_16x16x32_bf16 v[212:215], v[104:107], v[68:71], v[212:215]
    ds_read_b64_tr_b16 v[104:105], v56 offset:49152
    s_waitcnt lgkmcnt(13)
    v_mfma_f32_16x16x32_bf16 v[216:219], v[108:111], v[64:67], v[216:219]
    ds_read_b64_tr_b16 v[106:107], v56 offset:50176
    buffer_store_dwordx4 v[148:151], v13, s[8:11], s67 offen sc1
    s_add_u32 s67, s67, s68
    v_mfma_f32_16x16x32_bf16 v[220:223], v[108:111], v[68:71], v[220:223]
    ds_read_b64_tr_b16 v[108:109], v57 offset:49152
    s_waitcnt lgkmcnt(13)
    v_mfma_f32_16x16x32_bf16 v[224:227], v[112:115], v[64:67], v[224:227]
    ds_read_b64_tr_b16 v[110:111], v57 offset:50176
    v_mfma_f32_16x16x32_bf16 v[228:231], v[112:115], v[68:71], v[228:231]
    ds_read_b64_tr_b16 v[112:113], v58 offset:49152
    s_waitcnt lgkmcnt(13)
    v_mfma_f32_16x16x32_bf16 v[232:235], v[116:119], v[64:67], v[232:235]
    ds_read_b64_tr_b16 v[114:115], v58 offset:50176
    v_mfma_f32_16x16x32_bf16 v[236:239], v[116:119], v[68:71], v[236:239]
    ds_read_b64_tr_b16 v[116:117], v59 offset:49152
    s_waitcnt lgkmcnt(13)
    v_mfma_f32_16x16x32_bf16 v[240:243], v[120:123], v[64:67], v[240:243]
    ds_read_b64_tr_b16 v[118:119], v59 offset:50176
    v_mfma_f32_16x16x32_bf16 v[244:247], v[120:123], v[68:71], v[244:247]
    ds_read_b64_tr_b16 v[120:121], v60 offset:49152
    s_waitcnt lgkmcnt(13)
    v_mfma_f32_16x16x32_bf16 v[248:251], v[124:127], v[64:67], v[248:251]
    ds_read_b64_tr_b16 v[122:123], v60 offset:50176
    v_mfma_f32_16x16x32_bf16 v[252:255], v[124:127], v[68:71], v[252:255]
    ds_read_b64_tr_b16 v[124:125], v61 offset:49152
    ds_read_b64_tr_b16 v[126:127], v61 offset:50176
    s_waitcnt lgkmcnt(14)
    v_mfma_f32_16x16x32_bf16 v[192:195], v[96:99], v[72:75], v[192:195]
    v_mfma_f32_16x16x32_bf16 v[196:199], v[96:99], v[76:79], v[196:199]
    ds_read_b64_tr_b16 v[96:97], v54 offset:57344
    s_waitcnt lgkmcnt(13)
    v_mfma_f32_16x16x32_bf16 v[200:203], v[100:103], v[72:75], v[200:203]
    ds_read_b64_tr_b16 v[98:99], v54 offset:58368
    v_mfma_f32_16x16x32_bf16 v[204:207], v[100:103], v[76:79], v[204:207]
    ds_read_b64_tr_b16 v[100:101], v55 offset:57344
    s_waitcnt lgkmcnt(13)
    v_mfma_f32_16x16x32_bf16 v[208:211], v[104:107], v[72:75], v[208:211]
    ds_read_b64_tr_b16 v[102:103], v55 offset:58368
    v_mfma_f32_16x16x32_bf16 v[212:215], v[104:107], v[76:79], v[212:215]
    ds_read_b64_tr_b16 v[104:105], v56 offset:57344
    s_waitcnt lgkmcnt(13)
    v_mfma_f32_16x16x32_bf16 v[216:219], v[108:111], v[72:75], v[216:219]
    ds_read_b64_tr_b16 v[106:107], v56 offset:58368
    buffer_store_dwordx4 v[152:155], v13, s[8:11], s67 offen sc1
    s_add_u32 s67, s67, 1024
    v_mfma_f32_16x16x32_bf16 v[220:223], v[108:111], v[76:79], v[220:223]
    ds_read_b64_tr_b16 v[108:109], v57 offset:57344
    s_waitcnt lgkmcnt(13)
    v_mfma_f32_16x16x32_bf16 v[224:227], v[112:115], v[72:75], v[224:227]
    ds_read_b64_tr_b16 v[110:111], v57 offset:58368
    v_mfma_f32_16x16x32_bf16 v[228:231], v[112:115], v[76:79], v[228:231]
    ds_read_b64_tr_b16 v[112:113], v58 offset:57344
    s_waitcnt lgkmcnt(13)
    v_mfma_f32_16x16x32_bf16 v[232:235], v[116:119], v[72:75], v[232:235]
    ds_read_b64_tr_b16 v[114:115], v58 offset:58368
    v_mfma_f32_16x16x32_bf16 v[236:239], v[116:119], v[76:79], v[236:239]
    ds_read_b64_tr_b16 v[116:117], v59 offset:57344
    s_waitcnt lgkmcnt(13)
    v_mfma_f32_16x16x32_bf16 v[240:243], v[120:123], v[72:75], v[240:243]
    ds_read_b64_tr_b16 v[118:119], v59 offset:58368
    v_mfma_f32_16x16x32_bf16 v[244:247], v[120:123], v[76:79], v[244:247]
    ds_read_b64_tr_b16 v[120:121], v60 offset:57344
    s_waitcnt lgkmcnt(13)
    v_mfma_f32_16x16x32_bf16 v[248:251], v[124:127], v[72:75], v[248:251]
    ds_read_b64_tr_b16 v[122:123], v60 offset:58368
    v_mfma_f32_16x16x32_bf16 v[252:255], v[124:127], v[76:79], v[252:255]
    ds_read_b64_tr_b16 v[124:125], v61 offset:57344
    ds_read_b64_tr_b16 v[126:127], v61 offset:58368
    s_waitcnt lgkmcnt(14)
    v_mfma_f32_16x16x32_bf16 v[192:195], v[96:99], v[80:83], v[192:195]
    v_mfma_f32_16x16x32_bf16 v[196:199], v[96:99], v[84:87], v[196:199]
    s_waitcnt lgkmcnt(12)
    v_mfma_f32_16x16x32_bf16 v[200:203], v[100:103], v[80:83], v[200:203]
    v_mfma_f32_16x16x32_bf16 v[204:207], v[100:103], v[84:87], v[204:207]
    s_waitcnt lgkmcnt(10)
    v_mfma_f32_16x16x32_bf16 v[208:211], v[104:107], v[80:83], v[208:211]
    v_mfma_f32_16x16x32_bf16 v[212:215], v[104:107], v[84:87], v[212:215]
    s_waitcnt lgkmcnt(8)
    v_mfma_f32_16x16x32_bf16 v[216:219], v[108:111], v[80:83], v[216:219]
    buffer_store_dwordx4 v[156:159], v13, s[8:11], s67 offen sc1
    s_add_u32 s67, s67, s69
    v_mfma_f32_16x16x32_bf16 v[220:223], v[108:111], v[84:87], v[220:223]
    s_waitcnt lgkmcnt(6)
    v_mfma_f32_16x16x32_bf16 v[224:227], v[112:115], v[80:83], v[224:227]
    v_mfma_f32_16x16x32_bf16 v[228:231], v[112:115], v[84:87], v[228:231]
    s_waitcnt lgkmcnt(4)
    v_mfma_f32_16x16x32_bf16 v[232:235], v[116:119], v[80:83], v[232:235]
    v_mfma_f32_16x16x32_bf16 v[236:239], v[116:119], v[84:87], v[236:239]
    s_waitcnt lgkmcnt(2)
    v_mfma_f32_16x16x32_bf16 v[240:243], v[120:123], v[80:83], v[240:243]
    v_mfma_f32_16x16x32_bf16 v[244:247], v[120:123], v[84:87], v[244:247]
    s_waitcnt lgkmcnt(0)
    v_mfma_f32_16x16x32_bf16 v[248:251], v[124:127], v[80:83], v[248:251]
    v_mfma_f32_16x16x32_bf16 v[252:255], v[124:127], v[84:87], v[252:255]
    s_mov_b32 s6, 0x3e0293ee
    s_nop 7
    buffer_store_dwordx4 v[160:163], v13, s[8:11], s67 offen sc1
    s_add_u32 s67, s67, 1024
    buffer_store_dwordx4 v[164:167], v13, s[8:11], s67 offen sc1
    s_add_u32 s67, s67, s68
    buffer_store_dwordx4 v[168:171], v13, s[8:11], s67 offen sc1
    s_add_u32 s67, s67, 1024
    buffer_store_dwordx4 v[172:175], v13, s[8:11], s67 offen sc1
    s_add_u32 s67, s67, s69
    v_mul_f32 v192, s6, v192
    v_mul_f32 v193, s6, v193
    v_mul_f32 v194, s6, v194
    v_mul_f32 v195, s6, v195
    v_cvt_pk_bf16_f32 v16, v192, v193
    v_cvt_pk_bf16_f32 v17, v194, v195
    v_mul_f32 v200, s6, v200
    v_mul_f32 v201, s6, v201
    v_mul_f32 v202, s6, v202
    v_mul_f32 v203, s6, v203
    v_cvt_pk_bf16_f32 v18, v200, v201
    v_cvt_pk_bf16_f32 v19, v202, v203
    v_mul_f32 v208, s6, v208
    v_mul_f32 v209, s6, v209
    v_mul_f32 v210, s6, v210
    v_mul_f32 v211, s6, v211
    v_cvt_pk_bf16_f32 v20, v208, v209
    v_cvt_pk_bf16_f32 v21, v210, v211
    v_mul_f32 v216, s6, v216
    v_mul_f32 v217, s6, v217
    v_mul_f32 v218, s6, v218
    v_mul_f32 v219, s6, v219
    v_cvt_pk_bf16_f32 v22, v216, v217
    v_cvt_pk_bf16_f32 v23, v218, v219
    v_mul_f32 v224, s6, v224
    v_mul_f32 v225, s6, v225
    v_mul_f32 v226, s6, v226
    v_mul_f32 v227, s6, v227
    v_cvt_pk_bf16_f32 v24, v224, v225
    v_cvt_pk_bf16_f32 v25, v226, v227
    v_mul_f32 v232, s6, v232
    v_mul_f32 v233, s6, v233
    v_mul_f32 v234, s6, v234
    v_mul_f32 v235, s6, v235
    v_cvt_pk_bf16_f32 v26, v232, v233
    v_cvt_pk_bf16_f32 v27, v234, v235
    v_mul_f32 v240, s6, v240
    v_mul_f32 v241, s6, v241
    v_mul_f32 v242, s6, v242
    v_mul_f32 v243, s6, v243
    v_cvt_pk_bf16_f32 v28, v240, v241
    v_cvt_pk_bf16_f32 v29, v242, v243
    v_mul_f32 v248, s6, v248
    v_mul_f32 v249, s6, v249
    v_mul_f32 v250, s6, v250
    v_mul_f32 v251, s6, v251
    v_cvt_pk_bf16_f32 v30, v248, v249
    v_cvt_pk_bf16_f32 v31, v250, v251
    v_mul_f32 v196, s6, v196
    v_mul_f32 v197, s6, v197
    v_mul_f32 v198, s6, v198
    v_mul_f32 v199, s6, v199
    v_cvt_pk_bf16_f32 v32, v196, v197
    v_cvt_pk_bf16_f32 v33, v198, v199
    v_mul_f32 v204, s6, v204
    v_mul_f32 v205, s6, v205
    v_mul_f32 v206, s6, v206
    v_mul_f32 v207, s6, v207
    v_cvt_pk_bf16_f32 v34, v204, v205
    v_cvt_pk_bf16_f32 v35, v206, v207
    v_mul_f32 v212, s6, v212
    v_mul_f32 v213, s6, v213
    v_mul_f32 v214, s6, v214
    v_mul_f32 v215, s6, v215
    v_cvt_pk_bf16_f32 v36, v212, v213
    v_cvt_pk_bf16_f32 v37, v214, v215
    v_mul_f32 v220, s6, v220
    v_mul_f32 v221, s6, v221
    v_mul_f32 v222, s6, v222
    v_mul_f32 v223, s6, v223
    v_cvt_pk_bf16_f32 v38, v220, v221
    v_cvt_pk_bf16_f32 v39, v222, v223
    v_mul_f32 v228, s6, v228
    v_mul_f32 v229, s6, v229
    v_mul_f32 v230, s6, v230
    v_mul_f32 v231, s6, v231
    v_cvt_pk_bf16_f32 v40, v228, v229
    v_cvt_pk_bf16_f32 v41, v230, v231
    v_mul_f32 v236, s6, v236
    v_mul_f32 v237, s6, v237
    v_mul_f32 v238, s6, v238
    v_mul_f32 v239, s6, v239
    v_cvt_pk_bf16_f32 v42, v236, v237
    v_cvt_pk_bf16_f32 v43, v238, v239
    v_mul_f32 v244, s6, v244
    v_mul_f32 v245, s6, v245
    v_mul_f32 v246, s6, v246
    v_mul_f32 v247, s6, v247
    v_cvt_pk_bf16_f32 v44, v244, v245
    v_cvt_pk_bf16_f32 v45, v246, v247
    v_mul_f32 v252, s6, v252
    v_mul_f32 v253, s6, v253
    v_mul_f32 v254, s6, v254
    v_mul_f32 v255, s6, v255
    v_cvt_pk_bf16_f32 v46, v252, v253
    v_cvt_pk_bf16_f32 v47, v254, v255
    v_mov_b64 v[192:193], 0
    v_mov_b64 v[194:195], 0
    v_mov_b64 v[196:197], 0
    v_mov_b64 v[198:199], 0
    v_mov_b64 v[200:201], 0
    v_mov_b64 v[202:203], 0
    v_mov_b64 v[204:205], 0
    v_mov_b64 v[206:207], 0
    v_mov_b64 v[208:209], 0
    v_mov_b64 v[210:211], 0
    v_mov_b64 v[212:213], 0
    v_mov_b64 v[214:215], 0
    v_mov_b64 v[216:217], 0
    v_mov_b64 v[218:219], 0
    v_mov_b64 v[220:221], 0
    v_mov_b64 v[222:223], 0
    v_mov_b64 v[224:225], 0
    v_mov_b64 v[226:227], 0
    v_mov_b64 v[228:229], 0
    v_mov_b64 v[230:231], 0
    v_mov_b64 v[232:233], 0
    v_mov_b64 v[234:235], 0
    v_mov_b64 v[236:237], 0
    v_mov_b64 v[238:239], 0
    v_mov_b64 v[240:241], 0
    v_mov_b64 v[242:243], 0
    v_mov_b64 v[244:245], 0
    v_mov_b64 v[246:247], 0
    v_mov_b64 v[248:249], 0
    v_mov_b64 v[250:251], 0
    v_mov_b64 v[252:253], 0
    v_mov_b64 v[254:255], 0
    v_mov_b64 v[144:145], 0
    v_mov_b64 v[146:147], 0
    v_mov_b64 v[148:149], 0
    v_mov_b64 v[150:151], 0
    v_mov_b64 v[152:153], 0
    v_mov_b64 v[154:155], 0
    v_mov_b64 v[156:157], 0
    v_mov_b64 v[158:159], 0
    v_mov_b64 v[52:53], 0
    v_mov_b64 v[54:55], 0
    v_mov_b64 v[56:57], 0
    v_mov_b32 v48, v13
    s_waitcnt vmcnt(8)
    s_cmp_lg_u32 s3, 5
    s_cbranch_scc1 L_q_c
    v_cmp_ne_u32 vcc, 8, v63
    s_cbranch_vccz L_cntok_9
    s_mov_b32 s28, s56
    s_mov_b32 s29, s57
    s_mov_b32 s30, 0x100
    s_mov_b32 s31, 0x20000
    v_and_b32 v3, 31, v1
    v_lshlrev_b32 v3, 2, v3
    s_mov_b32 s79, 262144
L_poll_10:
    buffer_load_dword v2, v3, s[28:31], 0 offen offset:128 sc1
    s_waitcnt vmcnt(0)
    v_cmp_ne_u32 vcc, 8, v2
    s_cbranch_vccz L_polldone_11
    s_sleep 8
    s_sub_u32 s79, s79, 1
    s_cmp_lg_u32 s79, 0
    s_cbranch_scc1 L_poll_10
L_polldone_11:
L_cntok_9:
L_q_c:
    s_mov_b32 s72, 0x4b800000
    s_mov_b32 s65, s72
    s_sub_u32 s63, 15, s5
    s_mov_b32 s62, -1
    s_waitcnt lgkmcnt(0)
    s_call_b64 s[82:83], L_pend
    s_barrier
    s_call_b64 s[82:83], L_load
    s_add_i32 s62, s62, 1
    ds_read_b128 v[96:99], v48 offset:0
    ds_read_b128 v[100:103], v48 offset:1024
    ds_read_b128 v[104:107], v48 offset:2048
    ds_read_b128 v[108:111], v48 offset:3072
    ds_read_b128 v[112:115], v48 offset:4096
    ds_read_b128 v[116:119], v48 offset:5120
    ds_read_b128 v[120:123], v48 offset:6144
    ds_read_b128 v[124:127], v48 offset:7168
    s_cmp_lg_u32 s60, 0
    s_cbranch_scc1 L_nm0
    s_call_b64 s[82:83], L_mask
L_nm0:
    s_waitcnt lgkmcnt(7)
    v_mfma_f32_16x16x32_bf16 v[64:67], v[96:99], v[16:19], v[144:147]
    v_mfma_f32_16x16x32_bf16 v[68:71], v[96:99], v[32:35], v[148:151]
    ds_read_b128 v[96:99], v48 offset:8192
    s_waitcnt lgkmcnt(7)
    v_mfma_f32_16x16x32_bf16 v[64:67], v[100:103], v[20:23], v[64:67]
    v_mfma_f32_16x16x32_bf16 v[68:71], v[100:103], v[36:39], v[68:71]
    ds_read_b128 v[100:103], v48 offset:9216
    s_waitcnt lgkmcnt(7)
    v_mfma_f32_16x16x32_bf16 v[64:67], v[104:107], v[24:27], v[64:67]
    v_mfma_f32_16x16x32_bf16 v[68:71], v[104:107], v[40:43], v[68:71]
    ds_read_b128 v[104:107], v48 offset:10240
    s_waitcnt lgkmcnt(7)
    v_mfma_f32_16x16x32_bf16 v[64:67], v[108:111], v[28:31], v[64:67]
    v_mfma_f32_16x16x32_bf16 v[68:71], v[108:111], v[44:47], v[68:71]
    ds_read_b128 v[108:111], v48 offset:11264
    s_waitcnt lgkmcnt(7)
    v_mfma_f32_16x16x32_bf16 v[72:75], v[112:115], v[16:19], v[152:155]
    v_mfma_f32_16x16x32_bf16 v[76:79], v[112:115], v[32:35], v[156:159]
    ds_read_b128 v[112:115], v48 offset:12288
    s_waitcnt lgkmcnt(7)
    v_mfma_f32_16x16x32_bf16 v[72:75], v[116:119], v[20:23], v[72:75]
    v_mfma_f32_16x16x32_bf16 v[76:79], v[116:119], v[36:39], v[76:79]
    ds_read_b128 v[116:119], v48 offset:13312
    s_waitcnt lgkmcnt(7)
    v_mfma_f32_16x16x32_bf16 v[72:75], v[120:123], v[24:27], v[72:75]
    v_mfma_f32_16x16x32_bf16 v[76:79], v[120:123], v[40:43], v[76:79]
    ds_read_b128 v[120:123], v48 offset:14336
    s_waitcnt lgkmcnt(7)
    v_mfma_f32_16x16x32_bf16 v[72:75], v[124:127], v[28:31], v[72:75]
    v_mfma_f32_16x16x32_bf16 v[76:79], v[124:127], v[44:47], v[76:79]
    ds_read_b128 v[124:127], v48 offset:15360
    s_nop 7
    v_max3_f32 v58, v64, v65, v66
    v_max3_f32 v58, v58, v67, v72
    v_max3_f32 v58, v58, v73, v74
    v_max_f32 v58, v58, v75
    v_mov_b32 v60, v58
    s_nop 1
    v_permlane16_swap_b32 v58, v60
    s_nop 1
    v_max_f32 v58, v58, v60
    v_mov_b32 v60, v58
    s_nop 1
    v_permlane32_swap_b32 v58, v60
    s_nop 1
    v_max_f32 v58, v58, v60
    v_sub_f32 v64, v64, v58
    v_sub_f32 v144, 0, v58
    v_sub_f32 v65, v65, v58
    v_sub_f32 v145, 0, v58
    v_sub_f32 v66, v66, v58
    v_sub_f32 v146, 0, v58
    v_sub_f32 v67, v67, v58
    v_sub_f32 v147, 0, v58
    v_sub_f32 v72, v72, v58
    v_sub_f32 v152, 0, v58
    v_sub_f32 v73, v73, v58
    v_sub_f32 v153, 0, v58
    v_sub_f32 v74, v74, v58
    v_sub_f32 v154, 0, v58
    v_sub_f32 v75, v75, v58
    v_sub_f32 v155, 0, v58
    v_max3_f32 v59, v68, v69, v70
    v_max3_f32 v59, v59, v71, v76
    v_max3_f32 v59, v59, v77, v78
    v_max_f32 v59, v59, v79
    v_mov_b32 v60, v59
    s_nop 1
    v_permlane16_swap_b32 v59, v60
    s_nop 1
    v_max_f32 v59, v59, v60
    v_mov_b32 v60, v59
    s_nop 1
    v_permlane32_swap_b32 v59, v60
    s_nop 1
    v_max_f32 v59, v59, v60
    v_sub_f32 v68, v68, v59
    v_sub_f32 v148, 0, v59
    v_sub_f32 v69, v69, v59
    v_sub_f32 v149, 0, v59
    v_sub_f32 v70, v70, v59
    v_sub_f32 v150, 0, v59
    v_sub_f32 v71, v71, v59
    v_sub_f32 v151, 0, v59
    v_sub_f32 v76, v76, v59
    v_sub_f32 v156, 0, v59
    v_sub_f32 v77, v77, v59
    v_sub_f32 v157, 0, v59
    v_sub_f32 v78, v78, v59
    v_sub_f32 v158, 0, v59
    v_sub_f32 v79, v79, v59
    v_sub_f32 v159, 0, v59
    s_cmp_lg_u32 s60, 1
    s_cbranch_scc1 L_nm1
    s_call_b64 s[82:83], L_mask
L_nm1:
    v_exp_f32 v58, v64
    v_exp_f32 v59, v65
    s_nop 0
    v_add_f32 v52, v58, v59
    v_cvt_pk_bf16_f32 v128, v58, v59
    s_waitcnt lgkmcnt(7)
    v_mfma_f32_16x16x32_bf16 v[80:83], v[96:99], v[16:19], v[144:147]
    s_waitcnt lgkmcnt(6)
    v_exp_f32 v60, v66
    v_exp_f32 v61, v67
    v_mfma_f32_16x16x32_bf16 v[84:87], v[96:99], v[32:35], v[148:151]
    ds_read_b128 v[96:99], v48 offset:49152
    v_add_f32 v52, v60, v52
    v_add_f32 v52, v61, v52
    v_cvt_pk_bf16_f32 v129, v60, v61
    v_add_f32 v56, v54, v56
    v_mfma_f32_16x16x32_bf16 v[80:83], v[100:103], v[20:23], v[80:83]
    s_waitcnt lgkmcnt(6)
    v_exp_f32 v58, v68
    v_exp_f32 v59, v69
    v_mfma_f32_16x16x32_bf16 v[84:87], v[100:103], v[36:39], v[84:87]
    ds_read_b128 v[100:103], v48 offset:50176
    v_add_f32 v53, v58, v59
    v_cvt_pk_bf16_f32 v132, v58, v59
    v_mfma_f32_16x16x32_bf16 v[80:83], v[104:107], v[24:27], v[80:83]
    s_waitcnt lgkmcnt(6)
    v_exp_f32 v60, v70
    v_exp_f32 v61, v71
    v_mfma_f32_16x16x32_bf16 v[84:87], v[104:107], v[40:43], v[84:87]
    ds_read_b128 v[104:107], v48 offset:51200
    v_add_f32 v53, v60, v53
    v_add_f32 v53, v61, v53
    v_cvt_pk_bf16_f32 v133, v60, v61
    v_add_f32 v57, v55, v57
    v_mfma_f32_16x16x32_bf16 v[80:83], v[108:111], v[28:31], v[80:83]
    s_waitcnt lgkmcnt(6)
    v_exp_f32 v58, v72
    v_exp_f32 v59, v73
    v_mfma_f32_16x16x32_bf16 v[84:87], v[108:111], v[44:47], v[84:87]
    ds_read_b128 v[108:111], v48 offset:52224
    v_add_f32 v52, v58, v52
    v_add_f32 v52, v59, v52
    v_cvt_pk_bf16_f32 v130, v58, v59
    v_mfma_f32_16x16x32_bf16 v[88:91], v[112:115], v[16:19], v[152:155]
    s_waitcnt lgkmcnt(6)
    v_exp_f32 v60, v74
    v_exp_f32 v61, v75
    v_mfma_f32_16x16x32_bf16 v[92:95], v[112:115], v[32:35], v[156:159]
    ds_read_b128 v[112:115], v48 offset:53248
    v_add_f32 v52, v60, v52
    v_add_f32 v52, v61, v52
    v_cvt_pk_bf16_f32 v131, v60, v61
    v_mfma_f32_16x16x32_bf16 v[88:91], v[116:119], v[20:23], v[88:91]
    s_waitcnt lgkmcnt(6)
    v_exp_f32 v58, v76
    v_exp_f32 v59, v77
    v_mfma_f32_16x16x32_bf16 v[92:95], v[116:119], v[36:39], v[92:95]
    ds_read_b128 v[116:119], v48 offset:54272
    v_add_f32 v53, v58, v53
    v_add_f32 v53, v59, v53
    v_cvt_pk_bf16_f32 v134, v58, v59
    v_mfma_f32_16x16x32_bf16 v[88:91], v[120:123], v[24:27], v[88:91]
    s_waitcnt lgkmcnt(6)
    v_exp_f32 v60, v78
    v_exp_f32 v61, v79
    v_mfma_f32_16x16x32_bf16 v[92:95], v[120:123], v[40:43], v[92:95]
    ds_read_b128 v[120:123], v48 offset:55296
    v_add_f32 v53, v60, v53
    v_add_f32 v53, v61, v53
    v_cvt_pk_bf16_f32 v135, v60, v61
    v_mfma_f32_16x16x32_bf16 v[88:91], v[124:127], v[28:31], v[88:91]
    v_mfma_f32_16x16x32_bf16 v[92:95], v[124:127], v[44:47], v[92:95]
    ds_read_b128 v[124:127], v48 offset:56320
    v_add_f32 v62, v52, v53
    v_cmp_nge_f32 vcc, s65, v62
    s_cbranch_vccnz L_back_13_h
L_back_13:
    s_nop 7
    v_exp_f32 v58, v80
    v_exp_f32 v59, v81
    s_nop 0
    v_add_f32 v54, v58, v59
    v_cvt_pk_bf16_f32 v136, v58, v59
    buffer_store_dwordx4 v[176:179], v13, s[8:11], s67 offen sc1
    s_add_u32 s67, s67, 1024
    buffer_store_dwordx4 v[180:183], v13, s[8:11], s67 offen sc1
    s_add_u32 s67, s67, s68
    buffer_store_dwordx4 v[184:187], v13, s[8:11], s67 offen sc1
    s_add_u32 s67, s67, 1024
    buffer_store_dwordx4 v[188:191], v13, s[8:11], s67 offen sc1
    s_add_u32 s67, s67, s69
    s_sub_i32 s64, s60, 2
    s_cmp_eq_u32 s60, 0
    s_cbranch_scc1 L_pv2
    s_cmp_eq_u32 s60, 1
    s_cbranch_scc1 L_tail2
    s_cmp_lg_u32 s60, 2
    s_cbranch_scc1 L_st2
    s_call_b64 s[82:83], L_mask
    s_branch L_st2
.p2align 6
L_st0:
    s_waitcnt lgkmcnt(7)
    v_mfma_f32_16x16x32_bf16 v[192:195], v[96:99], v[128:131], v[192:195]
    s_waitcnt lgkmcnt(6)
    v_exp_f32 v60, v82
    v_mfma_f32_16x16x32_bf16 v[196:199], v[96:99], v[132:135], v[196:199]
    ds_read_b128 v[96:99], v48 offset:0
    v_add_f32 v54, v60, v54
    v_add_f32 v56, v52, v56
    v_mfma_f32_16x16x32_bf16 v[200:203], v[100:103], v[128:131], v[200:203]
    s_waitcnt lgkmcnt(6)
    v_exp_f32 v61, v83
    v_mfma_f32_16x16x32_bf16 v[204:207], v[100:103], v[132:135], v[204:207]
    ds_read_b128 v[100:103], v48 offset:1024
    v_add_f32 v54, v61, v54
    v_cvt_pk_bf16_f32 v137, v60, v61
    v_mfma_f32_16x16x32_bf16 v[208:211], v[104:107], v[128:131], v[208:211]
    s_waitcnt lgkmcnt(6)
    v_exp_f32 v58, v84
    v_mfma_f32_16x16x32_bf16 v[212:215], v[104:107], v[132:135], v[212:215]
    ds_read_b128 v[104:107], v48 offset:2048
    v_add_f32 v57, v53, v57
    v_mfma_f32_16x16x32_bf16 v[216:219], v[108:111], v[128:131], v[216:219]
    s_waitcnt lgkmcnt(6)
    v_exp_f32 v59, v85
    v_mfma_f32_16x16x32_bf16 v[220:223], v[108:111], v[132:135], v[220:223]
    s_sub_i32 s64, s64, 1
    ds_read_b128 v[108:111], v48 offset:3072
    v_add_f32 v55, v58, v59
    v_cvt_pk_bf16_f32 v140, v58, v59
    v_mfma_f32_16x16x32_bf16 v[224:227], v[112:115], v[128:131], v[224:227]
    s_waitcnt lgkmcnt(6)
    v_exp_f32 v60, v86
    v_mfma_f32_16x16x32_bf16 v[228:231], v[112:115], v[132:135], v[228:231]
    ds_read_b128 v[112:115], v48 offset:4096
    v_add_f32 v55, v60, v55
    v_mfma_f32_16x16x32_bf16 v[232:235], v[116:119], v[128:131], v[232:235]
    s_waitcnt lgkmcnt(6)
    v_exp_f32 v61, v87
    v_mfma_f32_16x16x32_bf16 v[236:239], v[116:119], v[132:135], v[236:239]
    s_cmp_gt_i32 s64, 0
    ds_read_b128 v[116:119], v48 offset:5120
    v_add_f32 v55, v61, v55
    v_cvt_pk_bf16_f32 v141, v60, v61
    v_mfma_f32_16x16x32_bf16 v[240:243], v[120:123], v[128:131], v[240:243]
    s_waitcnt lgkmcnt(6)
    v_exp_f32 v58, v88
    v_mfma_f32_16x16x32_bf16 v[244:247], v[120:123], v[132:135], v[244:247]
    ds_read_b128 v[120:123], v48 offset:6144
    v_add_f32 v54, v58, v54
    v_mfma_f32_16x16x32_bf16 v[248:251], v[124:127], v[128:131], v[248:251]
    s_waitcnt lgkmcnt(6)
    v_exp_f32 v59, v89
    v_mfma_f32_16x16x32_bf16 v[252:255], v[124:127], v[132:135], v[252:255]
    s_cselect_b32 s65, s72, -1.0
    ds_read_b128 v[124:127], v48 offset:7168
    v_add_f32 v54, v59, v54
    v_cvt_pk_bf16_f32 v138, v58, v59
    v_mfma_f32_16x16x32_bf16 v[64:67], v[96:99], v[16:19], v[144:147]
    s_waitcnt lgkmcnt(6)
    v_exp_f32 v60, v90
    v_mfma_f32_16x16x32_bf16 v[68:71], v[96:99], v[32:35], v[148:151]
    ds_read_b128 v[96:99], v48 offset:40960
    v_add_f32 v54, v60, v54
    v_mfma_f32_16x16x32_bf16 v[64:67], v[100:103], v[20:23], v[64:67]
    s_waitcnt lgkmcnt(6)
    v_exp_f32 v61, v91
    v_mfma_f32_16x16x32_bf16 v[68:71], v[100:103], v[36:39], v[68:71]
    ds_read_b128 v[100:103], v48 offset:41984
    v_add_f32 v54, v61, v54
    v_cvt_pk_bf16_f32 v139, v60, v61
    v_mfma_f32_16x16x32_bf16 v[64:67], v[104:107], v[24:27], v[64:67]
    s_waitcnt lgkmcnt(6)
    v_exp_f32 v58, v92
    v_mfma_f32_16x16x32_bf16 v[68:71], v[104:107], v[40:43], v[68:71]
    ds_read_b128 v[104:107], v48 offset:43008
    v_add_f32 v55, v58, v55
    v_mfma_f32_16x16x32_bf16 v[64:67], v[108:111], v[28:31], v[64:67]
    s_waitcnt lgkmcnt(6)
    v_exp_f32 v59, v93
    v_mfma_f32_16x16x32_bf16 v[68:71], v[108:111], v[44:47], v[68:71]
    ds_read_b128 v[108:111], v48 offset:44032
    v_add_f32 v55, v59, v55
    v_cvt_pk_bf16_f32 v142, v58, v59
    v_mfma_f32_16x16x32_bf16 v[72:75], v[112:115], v[16:19], v[152:155]
    s_waitcnt lgkmcnt(6)
    v_exp_f32 v60, v94
    v_mfma_f32_16x16x32_bf16 v[76:79], v[112:115], v[32:35], v[156:159]
    ds_read_b128 v[112:115], v48 offset:45056
    v_add_f32 v55, v60, v55
    v_mfma_f32_16x16x32_bf16 v[72:75], v[116:119], v[20:23], v[72:75]
    s_waitcnt lgkmcnt(6)
    v_exp_f32 v61, v95
    v_mfma_f32_16x16x32_bf16 v[76:79], v[116:119], v[36:39], v[76:79]
    ds_read_b128 v[116:119], v48 offset:46080
    v_add_f32 v55, v61, v55
    v_cvt_pk_bf16_f32 v143, v60, v61
    v_mfma_f32_16x16x32_bf16 v[72:75], v[120:123], v[24:27], v[72:75]
    s_waitcnt lgkmcnt(6)
    v_exp_f32 v58, v64
    v_mfma_f32_16x16x32_bf16 v[76:79], v[120:123], v[40:43], v[76:79]
    ds_read_b128 v[120:123], v48 offset:47104
    v_add_f32 v62, v54, v55
    v_cmp_nge_f32 vcc, s65, v62
    v_mfma_f32_16x16x32_bf16 v[72:75], v[124:127], v[28:31], v[72:75]
    v_exp_f32 v59, v65
    v_mfma_f32_16x16x32_bf16 v[76:79], v[124:127], v[44:47], v[76:79]
    ds_read_b128 v[124:127], v48 offset:48128
    v_add_f32 v52, v58, v59
    v_cvt_pk_bf16_f32 v128, v58, v59
    s_cbranch_vccnz L_back_14_h
L_back_14:
    s_waitcnt lgkmcnt(7)
    v_mfma_f32_16x16x32_bf16 v[192:195], v[96:99], v[136:139], v[192:195]
    s_waitcnt lgkmcnt(6)
    v_exp_f32 v60, v66
    v_mfma_f32_16x16x32_bf16 v[196:199], v[96:99], v[140:143], v[196:199]
    ds_read_b128 v[96:99], v48 offset:8192
    v_add_f32 v52, v60, v52
    v_add_f32 v56, v54, v56
    v_mfma_f32_16x16x32_bf16 v[200:203], v[100:103], v[136:139], v[200:203]
    s_waitcnt lgkmcnt(6)
    v_exp_f32 v61, v67
    v_mfma_f32_16x16x32_bf16 v[204:207], v[100:103], v[140:143], v[204:207]
    ds_read_b128 v[100:103], v48 offset:9216
    v_add_f32 v52, v61, v52
    v_cvt_pk_bf16_f32 v129, v60, v61
    v_mfma_f32_16x16x32_bf16 v[208:211], v[104:107], v[136:139], v[208:211]
    s_waitcnt lgkmcnt(6)
    v_exp_f32 v58, v68
    v_mfma_f32_16x16x32_bf16 v[212:215], v[104:107], v[140:143], v[212:215]
    ds_read_b128 v[104:107], v48 offset:10240
    v_add_f32 v57, v55, v57
    v_mfma_f32_16x16x32_bf16 v[216:219], v[108:111], v[136:139], v[216:219]
    s_waitcnt lgkmcnt(6)
    v_exp_f32 v59, v69
    v_mfma_f32_16x16x32_bf16 v[220:223], v[108:111], v[140:143], v[220:223]
    s_sub_i32 s64, s64, 1
    ds_read_b128 v[108:111], v48 offset:11264
    v_add_f32 v53, v58, v59
    v_cvt_pk_bf16_f32 v132, v58, v59
    v_mfma_f32_16x16x32_bf16 v[224:227], v[112:115], v[136:139], v[224:227]
    s_waitcnt lgkmcnt(6)
    v_exp_f32 v60, v70
    v_mfma_f32_16x16x32_bf16 v[228:231], v[112:115], v[140:143], v[228:231]
    ds_read_b128 v[112:115], v48 offset:12288
    v_add_f32 v53, v60, v53
    v_mfma_f32_16x16x32_bf16 v[232:235], v[116:119], v[136:139], v[232:235]
    s_waitcnt lgkmcnt(6)
    v_exp_f32 v61, v71
    v_mfma_f32_16x16x32_bf16 v[236:239], v[116:119], v[140:143], v[236:239]
    s_cmp_gt_i32 s64, 0
    ds_read_b128 v[116:119], v48 offset:13312
    v_add_f32 v53, v61, v53
    v_cvt_pk_bf16_f32 v133, v60, v61
    v_mfma_f32_16x16x32_bf16 v[240:243], v[120:123], v[136:139], v[240:243]
    s_waitcnt lgkmcnt(6)
    v_exp_f32 v58, v72
    v_mfma_f32_16x16x32_bf16 v[244:247], v[120:123], v[140:143], v[244:247]
    ds_read_b128 v[120:123], v48 offset:14336
    v_add_f32 v52, v58, v52
    v_mfma_f32_16x16x32_bf16 v[248:251], v[124:127], v[136:139], v[248:251]
    s_waitcnt lgkmcnt(6)
    v_exp_f32 v59, v73
    v_mfma_f32_16x16x32_bf16 v[252:255], v[124:127], v[140:143], v[252:255]
    s_cselect_b32 s65, s72, -1.0
    ds_read_b128 v[124:127], v48 offset:15360
    v_add_f32 v52, v59, v52
    v_cvt_pk_bf16_f32 v130, v58, v59
    v_mfma_f32_16x16x32_bf16 v[80:83], v[96:99], v[16:19], v[144:147]
    s_waitcnt lgkmcnt(6)
    v_exp_f32 v60, v74
    v_mfma_f32_16x16x32_bf16 v[84:87], v[96:99], v[32:35], v[148:151]
    ds_read_b128 v[96:99], v48 offset:49152
    v_add_f32 v52, v60, v52
    v_mfma_f32_16x16x32_bf16 v[80:83], v[100:103], v[20:23], v[80:83]
    s_waitcnt lgkmcnt(6)
    v_exp_f32 v61, v75
    v_mfma_f32_16x16x32_bf16 v[84:87], v[100:103], v[36:39], v[84:87]
    ds_read_b128 v[100:103], v48 offset:50176
    v_add_f32 v52, v61, v52
    v_cvt_pk_bf16_f32 v131, v60, v61
    v_mfma_f32_16x16x32_bf16 v[80:83], v[104:107], v[24:27], v[80:83]
    s_waitcnt lgkmcnt(6)
    v_exp_f32 v58, v76
    v_mfma_f32_16x16x32_bf16 v[84:87], v[104:107], v[40:43], v[84:87]
    ds_read_b128 v[104:107], v48 offset:51200
    v_add_f32 v53, v58, v53
    v_mfma_f32_16x16x32_bf16 v[80:83], v[108:111], v[28:31], v[80:83]
    s_waitcnt lgkmcnt(6)
    v_exp_f32 v59, v77
    v_mfma_f32_16x16x32_bf16 v[84:87], v[108:111], v[44:47], v[84:87]
    ds_read_b128 v[108:111], v48 offset:52224
    v_add_f32 v53, v59, v53
    v_cvt_pk_bf16_f32 v134, v58, v59
    v_mfma_f32_16x16x32_bf16 v[88:91], v[112:115], v[16:19], v[152:155]
    s_waitcnt lgkmcnt(6)
    v_exp_f32 v60, v78
    v_mfma_f32_16x16x32_bf16 v[92:95], v[112:115], v[32:35], v[156:159]
    ds_read_b128 v[112:115], v48 offset:53248
    v_add_f32 v53, v60, v53
    v_mfma_f32_16x16x32_bf16 v[88:91], v[116:119], v[20:23], v[88:91]
    s_waitcnt lgkmcnt(6)
    v_exp_f32 v61, v79
    v_mfma_f32_16x16x32_bf16 v[92:95], v[116:119], v[36:39], v[92:95]
    ds_read_b128 v[116:119], v48 offset:54272
    v_add_f32 v53, v61, v53
    v_cvt_pk_bf16_f32 v135, v60, v61
    v_mfma_f32_16x16x32_bf16 v[88:91], v[120:123], v[24:27], v[88:91]
    s_waitcnt lgkmcnt(6)
    v_exp_f32 v58, v80
    v_mfma_f32_16x16x32_bf16 v[92:95], v[120:123], v[40:43], v[92:95]
    ds_read_b128 v[120:123], v48 offset:55296
    v_add_f32 v62, v52, v53
    v_cmp_nge_f32 vcc, s65, v62
    v_mfma_f32_16x16x32_bf16 v[88:91], v[124:127], v[28:31], v[88:91]
    v_exp_f32 v59, v81
    v_mfma_f32_16x16x32_bf16 v[92:95], v[124:127], v[44:47], v[92:95]
    ds_read_b128 v[124:127], v48 offset:56320
    v_add_f32 v54, v58, v59
    v_cvt_pk_bf16_f32 v136, v58, v59
    s_cbranch_vccnz L_back_15_h
L_back_15:
L_st2:
    s_waitcnt lgkmcnt(7)
    v_mfma_f32_16x16x32_bf16 v[192:195], v[96:99], v[128:131], v[192:195]
    s_waitcnt lgkmcnt(6)
    v_exp_f32 v60, v82
    v_mfma_f32_16x16x32_bf16 v[196:199], v[96:99], v[132:135], v[196:199]
    ds_read_b128 v[96:99], v48 offset:16384
    v_add_f32 v54, v60, v54
    v_add_f32 v56, v52, v56
    v_mfma_f32_16x16x32_bf16 v[200:203], v[100:103], v[128:131], v[200:203]
    s_waitcnt lgkmcnt(6)
    v_exp_f32 v61, v83
    v_mfma_f32_16x16x32_bf16 v[204:207], v[100:103], v[132:135], v[204:207]
    ds_read_b128 v[100:103], v48 offset:17408
    v_add_f32 v54, v61, v54
    v_cvt_pk_bf16_f32 v137, v60, v61
    v_mfma_f32_16x16x32_bf16 v[208:211], v[104:107], v[128:131], v[208:211]
    s_waitcnt lgkmcnt(6)
    v_exp_f32 v58, v84
    v_mfma_f32_16x16x32_bf16 v[212:215], v[104:107], v[132:135], v[212:215]
    ds_read_b128 v[104:107], v48 offset:18432
    v_add_f32 v57, v53, v57
    v_mfma_f32_16x16x32_bf16 v[216:219], v[108:111], v[128:131], v[216:219]
    s_waitcnt lgkmcnt(6)
    v_exp_f32 v59, v85
    v_mfma_f32_16x16x32_bf16 v[220:223], v[108:111], v[132:135], v[220:223]
    s_sub_i32 s64, s64, 1
    ds_read_b128 v[108:111], v48 offset:19456
    v_add_f32 v55, v58, v59
    v_cvt_pk_bf16_f32 v140, v58, v59
    v_mfma_f32_16x16x32_bf16 v[224:227], v[112:115], v[128:131], v[224:227]
    s_waitcnt lgkmcnt(6)
    v_exp_f32 v60, v86
    v_mfma_f32_16x16x32_bf16 v[228:231], v[112:115], v[132:135], v[228:231]
    ds_read_b128 v[112:115], v48 offset:20480
    v_add_f32 v55, v60, v55
    v_mfma_f32_16x16x32_bf16 v[232:235], v[116:119], v[128:131], v[232:235]
    s_waitcnt lgkmcnt(6)
    v_exp_f32 v61, v87
    v_mfma_f32_16x16x32_bf16 v[236:239], v[116:119], v[132:135], v[236:239]
    s_cmp_gt_i32 s64, 0
    ds_read_b128 v[116:119], v48 offset:21504
    v_add_f32 v55, v61, v55
    v_cvt_pk_bf16_f32 v141, v60, v61
    v_mfma_f32_16x16x32_bf16 v[240:243], v[120:123], v[128:131], v[240:243]
    s_waitcnt lgkmcnt(6)
    v_exp_f32 v58, v88
    v_mfma_f32_16x16x32_bf16 v[244:247], v[120:123], v[132:135], v[244:247]
    ds_read_b128 v[120:123], v48 offset:22528
    v_add_f32 v54, v58, v54
    v_mfma_f32_16x16x32_bf16 v[248:251], v[124:127], v[128:131], v[248:251]
    s_waitcnt lgkmcnt(6)
    v_exp_f32 v59, v89
    v_mfma_f32_16x16x32_bf16 v[252:255], v[124:127], v[132:135], v[252:255]
    s_cselect_b32 s65, s72, -1.0
    ds_read_b128 v[124:127], v48 offset:23552
    v_add_f32 v54, v59, v54
    v_cvt_pk_bf16_f32 v138, v58, v59
    v_mfma_f32_16x16x32_bf16 v[64:67], v[96:99], v[16:19], v[144:147]
    s_waitcnt lgkmcnt(6)
    v_exp_f32 v60, v90
    v_mfma_f32_16x16x32_bf16 v[68:71], v[96:99], v[32:35], v[148:151]
    ds_read_b128 v[96:99], v48 offset:57344
    v_add_f32 v54, v60, v54
    v_mfma_f32_16x16x32_bf16 v[64:67], v[100:103], v[20:23], v[64:67]
    s_waitcnt lgkmcnt(6)
    v_exp_f32 v61, v91
    v_mfma_f32_16x16x32_bf16 v[68:71], v[100:103], v[36:39], v[68:71]
    ds_read_b128 v[100:103], v48 offset:58368
    v_add_f32 v54, v61, v54
    v_cvt_pk_bf16_f32 v139, v60, v61
    v_mfma_f32_16x16x32_bf16 v[64:67], v[104:107], v[24:27], v[64:67]
    s_waitcnt lgkmcnt(6)
    v_exp_f32 v58, v92
    v_mfma_f32_16x16x32_bf16 v[68:71], v[104:107], v[40:43], v[68:71]
    ds_read_b128 v[104:107], v48 offset:59392
    v_add_f32 v55, v58, v55
    v_mfma_f32_16x16x32_bf16 v[64:67], v[108:111], v[28:31], v[64:67]
    s_waitcnt lgkmcnt(6)
    v_exp_f32 v59, v93
    v_mfma_f32_16x16x32_bf16 v[68:71], v[108:111], v[44:47], v[68:71]
    ds_read_b128 v[108:111], v48 offset:60416
    v_add_f32 v55, v59, v55
    v_cvt_pk_bf16_f32 v142, v58, v59
    v_mfma_f32_16x16x32_bf16 v[72:75], v[112:115], v[16:19], v[152:155]
    s_waitcnt lgkmcnt(6)
    v_exp_f32 v60, v94
    v_mfma_f32_16x16x32_bf16 v[76:79], v[112:115], v[32:35], v[156:159]
    ds_read_b128 v[112:115], v48 offset:61440
    v_add_f32 v55, v60, v55
    v_mfma_f32_16x16x32_bf16 v[72:75], v[116:119], v[20:23], v[72:75]
    s_waitcnt lgkmcnt(6)
    v_exp_f32 v61, v95
    v_mfma_f32_16x16x32_bf16 v[76:79], v[116:119], v[36:39], v[76:79]
    ds_read_b128 v[116:119], v48 offset:62464
    v_add_f32 v55, v61, v55
    v_cvt_pk_bf16_f32 v143, v60, v61
    v_mfma_f32_16x16x32_bf16 v[72:75], v[120:123], v[24:27], v[72:75]
    s_waitcnt lgkmcnt(6)
    v_exp_f32 v58, v64
    v_mfma_f32_16x16x32_bf16 v[76:79], v[120:123], v[40:43], v[76:79]
    ds_read_b128 v[120:123], v48 offset:63488
    v_add_f32 v62, v54, v55
    v_cmp_nge_f32 vcc, s65, v62
    v_mfma_f32_16x16x32_bf16 v[72:75], v[124:127], v[28:31], v[72:75]
    v_exp_f32 v59, v65
    v_mfma_f32_16x16x32_bf16 v[76:79], v[124:127], v[44:47], v[76:79]
    ds_read_b128 v[124:127], v48 offset:64512
    v_add_f32 v52, v58, v59
    v_cvt_pk_bf16_f32 v128, v58, v59
    s_cbranch_vccnz L_back_16_h
L_back_16:
    s_waitcnt lgkmcnt(7)
    v_mfma_f32_16x16x32_bf16 v[192:195], v[96:99], v[136:139], v[192:195]
    s_waitcnt lgkmcnt(6)
    v_exp_f32 v60, v66
    v_mfma_f32_16x16x32_bf16 v[196:199], v[96:99], v[140:143], v[196:199]
    ds_read_b128 v[96:99], v48 offset:24576
    v_add_f32 v52, v60, v52
    v_add_f32 v56, v54, v56
    v_mfma_f32_16x16x32_bf16 v[200:203], v[100:103], v[136:139], v[200:203]
    s_waitcnt lgkmcnt(6)
    v_exp_f32 v61, v67
    v_mfma_f32_16x16x32_bf16 v[204:207], v[100:103], v[140:143], v[204:207]
    ds_read_b128 v[100:103], v48 offset:25600
    v_add_f32 v52, v61, v52
    v_cvt_pk_bf16_f32 v129, v60, v61
    v_mfma_f32_16x16x32_bf16 v[208:211], v[104:107], v[136:139], v[208:211]
    s_waitcnt lgkmcnt(6)
    v_exp_f32 v58, v68
    v_mfma_f32_16x16x32_bf16 v[212:215], v[104:107], v[140:143], v[212:215]
    ds_read_b128 v[104:107], v48 offset:26624
    v_add_f32 v57, v55, v57
    v_mfma_f32_16x16x32_bf16 v[216:219], v[108:111], v[136:139], v[216:219]
    s_waitcnt lgkmcnt(6)
    v_exp_f32 v59, v69
    v_mfma_f32_16x16x32_bf16 v[220:223], v[108:111], v[140:143], v[220:223]
    s_sub_i32 s64, s64, 1
    ds_read_b128 v[108:111], v48 offset:27648
    v_add_f32 v53, v58, v59
    v_cvt_pk_bf16_f32 v132, v58, v59
    v_mfma_f32_16x16x32_bf16 v[224:227], v[112:115], v[136:139], v[224:227]
    s_waitcnt lgkmcnt(6)
    v_exp_f32 v60, v70
    v_mfma_f32_16x16x32_bf16 v[228:231], v[112:115], v[140:143], v[228:231]
    ds_read_b128 v[112:115], v48 offset:28672
    v_add_f32 v53, v60, v53
    v_mfma_f32_16x16x32_bf16 v[232:235], v[116:119], v[136:139], v[232:235]
    s_waitcnt lgkmcnt(6)
    v_exp_f32 v61, v71
    v_mfma_f32_16x16x32_bf16 v[236:239], v[116:119], v[140:143], v[236:239]
    s_cmp_gt_i32 s64, 0
    ds_read_b128 v[116:119], v48 offset:29696
    v_add_f32 v53, v61, v53
    v_cvt_pk_bf16_f32 v133, v60, v61
    v_mfma_f32_16x16x32_bf16 v[240:243], v[120:123], v[136:139], v[240:243]
    s_waitcnt lgkmcnt(6)
    v_exp_f32 v58, v72
    v_mfma_f32_16x16x32_bf16 v[244:247], v[120:123], v[140:143], v[244:247]
    ds_read_b128 v[120:123], v48 offset:30720
    v_add_f32 v52, v58, v52
    v_mfma_f32_16x16x32_bf16 v[248:251], v[124:127], v[136:139], v[248:251]
    s_waitcnt lgkmcnt(6)
    v_exp_f32 v59, v73
    v_mfma_f32_16x16x32_bf16 v[252:255], v[124:127], v[140:143], v[252:255]
    s_cselect_b32 s65, s72, -1.0
    ds_read_b128 v[124:127], v48 offset:31744
    v_add_f32 v52, v59, v52
    v_cvt_pk_bf16_f32 v130, v58, v59
    v_mfma_f32_16x16x32_bf16 v[80:83], v[96:99], v[16:19], v[144:147]
    s_waitcnt lgkmcnt(6)
    v_exp_f32 v60, v74
    v_mfma_f32_16x16x32_bf16 v[84:87], v[96:99], v[32:35], v[148:151]
    v_add_f32 v52, v60, v52
    v_mfma_f32_16x16x32_bf16 v[80:83], v[100:103], v[20:23], v[80:83]
    s_waitcnt lgkmcnt(5)
    v_exp_f32 v61, v75
    v_xor_b32 v48, 0x10000, v48
    v_mfma_f32_16x16x32_bf16 v[84:87], v[100:103], v[36:39], v[84:87]
    s_cmp_lg_u32 s89, 0
    s_cbranch_scc1 L_ldback_17_c
    s_waitcnt lgkmcnt(0)
    s_barrier
L_ldback_17:
    s_add_i32 s62, s62, 1
    ds_read_b128 v[96:99], v48 offset:32768
    ds_read_b128 v[100:103], v48 offset:33792
    v_add_f32 v52, v61, v52
    v_cvt_pk_bf16_f32 v131, v60, v61
    v_mfma_f32_16x16x32_bf16 v[80:83], v[104:107], v[24:27], v[80:83]
    v_exp_f32 v58, v76
    v_mfma_f32_16x16x32_bf16 v[84:87], v[104:107], v[40:43], v[84:87]
    ds_read_b128 v[104:107], v48 offset:34816
    v_add_f32 v53, v58, v53
    v_mfma_f32_16x16x32_bf16 v[80:83], v[108:111], v[28:31], v[80:83]
    v_exp_f32 v59, v77
    v_mfma_f32_16x16x32_bf16 v[84:87], v[108:111], v[44:47], v[84:87]
    ds_read_b128 v[108:111], v48 offset:35840
    v_add_f32 v53, v59, v53
    v_cvt_pk_bf16_f32 v134, v58, v59
    v_mfma_f32_16x16x32_bf16 v[88:91], v[112:115], v[16:19], v[152:155]
    v_exp_f32 v60, v78
    v_mfma_f32_16x16x32_bf16 v[92:95], v[112:115], v[32:35], v[156:159]
    ds_read_b128 v[112:115], v48 offset:36864
    v_add_f32 v53, v60, v53
    v_mfma_f32_16x16x32_bf16 v[88:91], v[116:119], v[20:23], v[88:91]
    v_exp_f32 v61, v79
    v_mfma_f32_16x16x32_bf16 v[92:95], v[116:119], v[36:39], v[92:95]
    ds_read_b128 v[116:119], v48 offset:37888
    v_add_f32 v53, v61, v53
    v_cvt_pk_bf16_f32 v135, v60, v61
    v_mfma_f32_16x16x32_bf16 v[88:91], v[120:123], v[24:27], v[88:91]
    v_exp_f32 v58, v80
    v_mfma_f32_16x16x32_bf16 v[92:95], v[120:123], v[40:43], v[92:95]
    ds_read_b128 v[120:123], v48 offset:38912
    v_add_f32 v62, v52, v53
    v_cmp_nge_f32 vcc, s65, v62
    v_mfma_f32_16x16x32_bf16 v[88:91], v[124:127], v[28:31], v[88:91]
    v_exp_f32 v59, v81
    v_mfma_f32_16x16x32_bf16 v[92:95], v[124:127], v[44:47], v[92:95]
    ds_read_b128 v[124:127], v48 offset:39936
    v_add_f32 v54, v58, v59
    v_cvt_pk_bf16_f32 v136, v58, v59
    s_cbranch_vccnz L_back_18_h
L_back_18:
    s_branch L_st0
L_tail0:
    s_mov_b32 s65, s72
    s_waitcnt lgkmcnt(7)
    v_mfma_f32_16x16x32_bf16 v[192:195], v[96:99], v[128:131], v[192:195]
    s_waitcnt lgkmcnt(6)
    v_exp_f32 v60, v82
    v_exp_f32 v61, v83
    v_mfma_f32_16x16x32_bf16 v[196:199], v[96:99], v[132:135], v[196:199]
    ds_read_b128 v[96:99], v48 offset:40960
    v_add_f32 v54, v60, v54
    v_add_f32 v54, v61, v54
    v_cvt_pk_bf16_f32 v137, v60, v61
    v_add_f32 v56, v52, v56
    v_mfma_f32_16x16x32_bf16 v[200:203], v[100:103], v[128:131], v[200:203]
    s_waitcnt lgkmcnt(6)
    v_exp_f32 v58, v84
    v_exp_f32 v59, v85
    v_mfma_f32_16x16x32_bf16 v[204:207], v[100:103], v[132:135], v[204:207]
    ds_read_b128 v[100:103], v48 offset:41984
    v_add_f32 v55, v58, v59
    v_cvt_pk_bf16_f32 v140, v58, v59
    v_mfma_f32_16x16x32_bf16 v[208:211], v[104:107], v[128:131], v[208:211]
    s_waitcnt lgkmcnt(6)
    v_exp_f32 v60, v86
    v_exp_f32 v61, v87
    v_mfma_f32_16x16x32_bf16 v[212:215], v[104:107], v[132:135], v[212:215]
    ds_read_b128 v[104:107], v48 offset:43008
    v_add_f32 v55, v60, v55
    v_add_f32 v55, v61, v55
    v_cvt_pk_bf16_f32 v141, v60, v61
    v_add_f32 v57, v53, v57
    v_mfma_f32_16x16x32_bf16 v[216:219], v[108:111], v[128:131], v[216:219]
    s_waitcnt lgkmcnt(6)
    v_exp_f32 v58, v88
    v_exp_f32 v59, v89
    v_mfma_f32_16x16x32_bf16 v[220:223], v[108:111], v[132:135], v[220:223]
    ds_read_b128 v[108:111], v48 offset:44032
    v_add_f32 v54, v58, v54
    v_add_f32 v54, v59, v54
    v_cvt_pk_bf16_f32 v138, v58, v59
    v_mfma_f32_16x16x32_bf16 v[224:227], v[112:115], v[128:131], v[224:227]
    s_waitcnt lgkmcnt(6)
    v_exp_f32 v60, v90
    v_exp_f32 v61, v91
    v_mfma_f32_16x16x32_bf16 v[228:231], v[112:115], v[132:135], v[228:231]
    ds_read_b128 v[112:115], v48 offset:45056
    v_add_f32 v54, v60, v54
    v_add_f32 v54, v61, v54
    v_cvt_pk_bf16_f32 v139, v60, v61
    v_mfma_f32_16x16x32_bf16 v[232:235], v[116:119], v[128:131], v[232:235]
    s_waitcnt lgkmcnt(6)
    v_exp_f32 v58, v92
    v_exp_f32 v59, v93
    v_mfma_f32_16x16x32_bf16 v[236:239], v[116:119], v[132:135], v[236:239]
    ds_read_b128 v[116:119], v48 offset:46080
    v_add_f32 v55, v58, v55
    v_add_f32 v55, v59, v55
    v_cvt_pk_bf16_f32 v142, v58, v59
    v_mfma_f32_16x16x32_bf16 v[240:243], v[120:123], v[128:131], v[240:243]
    s_waitcnt lgkmcnt(6)
    v_exp_f32 v60, v94
    v_exp_f32 v61, v95
    v_mfma_f32_16x16x32_bf16 v[244:247], v[120:123], v[132:135], v[244:247]
    ds_read_b128 v[120:123], v48 offset:47104
    v_add_f32 v55, v60, v55
    v_add_f32 v55, v61, v55
    v_cvt_pk_bf16_f32 v143, v60, v61
    v_mfma_f32_16x16x32_bf16 v[248:251], v[124:127], v[128:131], v[248:251]
    v_mfma_f32_16x16x32_bf16 v[252:255], v[124:127], v[132:135], v[252:255]
    ds_read_b128 v[124:127], v48 offset:48128
    v_add_f32 v62, v54, v55
    v_cmp_nge_f32 vcc, s65, v62
    s_cbranch_vccnz L_back_19_h
L_back_19:
L_pv1:
    s_waitcnt lgkmcnt(7)
    v_mfma_f32_16x16x32_bf16 v[192:195], v[96:99], v[136:139], v[192:195]
    s_waitcnt lgkmcnt(6)
    v_mfma_f32_16x16x32_bf16 v[196:199], v[96:99], v[140:143], v[196:199]
    v_add_f32 v56, v54, v56
    v_mfma_f32_16x16x32_bf16 v[200:203], v[100:103], v[136:139], v[200:203]
    s_waitcnt lgkmcnt(5)
    v_mfma_f32_16x16x32_bf16 v[204:207], v[100:103], v[140:143], v[204:207]
    v_mfma_f32_16x16x32_bf16 v[208:211], v[104:107], v[136:139], v[208:211]
    s_waitcnt lgkmcnt(4)
    v_mfma_f32_16x16x32_bf16 v[212:215], v[104:107], v[140:143], v[212:215]
    v_add_f32 v57, v55, v57
    v_mfma_f32_16x16x32_bf16 v[216:219], v[108:111], v[136:139], v[216:219]
    s_waitcnt lgkmcnt(3)
    v_mfma_f32_16x16x32_bf16 v[220:223], v[108:111], v[140:143], v[220:223]
    v_mfma_f32_16x16x32_bf16 v[224:227], v[112:115], v[136:139], v[224:227]
    s_waitcnt lgkmcnt(2)
    v_mfma_f32_16x16x32_bf16 v[228:231], v[112:115], v[140:143], v[228:231]
    v_mfma_f32_16x16x32_bf16 v[232:235], v[116:119], v[136:139], v[232:235]
    s_waitcnt lgkmcnt(1)
    v_mfma_f32_16x16x32_bf16 v[236:239], v[116:119], v[140:143], v[236:239]
    v_mfma_f32_16x16x32_bf16 v[240:243], v[120:123], v[136:139], v[240:243]
    s_waitcnt lgkmcnt(0)
    v_mfma_f32_16x16x32_bf16 v[244:247], v[120:123], v[140:143], v[244:247]
    v_mfma_f32_16x16x32_bf16 v[248:251], v[124:127], v[136:139], v[248:251]
    v_mfma_f32_16x16x32_bf16 v[252:255], v[124:127], v[140:143], v[252:255]
    s_branch L_fin
L_tail1:
    s_mov_b32 s65, s72
    s_waitcnt lgkmcnt(7)
    v_mfma_f32_16x16x32_bf16 v[192:195], v[96:99], v[136:139], v[192:195]
    s_waitcnt lgkmcnt(6)
    v_exp_f32 v60, v66
    v_exp_f32 v61, v67
    v_mfma_f32_16x16x32_bf16 v[196:199], v[96:99], v[140:143], v[196:199]
    ds_read_b128 v[96:99], v48 offset:49152
    v_add_f32 v52, v60, v52
    v_add_f32 v52, v61, v52
    v_cvt_pk_bf16_f32 v129, v60, v61
    v_add_f32 v56, v54, v56
    v_mfma_f32_16x16x32_bf16 v[200:203], v[100:103], v[136:139], v[200:203]
    s_waitcnt lgkmcnt(6)
    v_exp_f32 v58, v68
    v_exp_f32 v59, v69
    v_mfma_f32_16x16x32_bf16 v[204:207], v[100:103], v[140:143], v[204:207]
    ds_read_b128 v[100:103], v48 offset:50176
    v_add_f32 v53, v58, v59
    v_cvt_pk_bf16_f32 v132, v58, v59
    v_mfma_f32_16x16x32_bf16 v[208:211], v[104:107], v[136:139], v[208:211]
    s_waitcnt lgkmcnt(6)
    v_exp_f32 v60, v70
    v_exp_f32 v61, v71
    v_mfma_f32_16x16x32_bf16 v[212:215], v[104:107], v[140:143], v[212:215]
    ds_read_b128 v[104:107], v48 offset:51200
    v_add_f32 v53, v60, v53
    v_add_f32 v53, v61, v53
    v_cvt_pk_bf16_f32 v133, v60, v61
    v_add_f32 v57, v55, v57
    v_mfma_f32_16x16x32_bf16 v[216:219], v[108:111], v[136:139], v[216:219]
    s_waitcnt lgkmcnt(6)
    v_exp_f32 v58, v72
    v_exp_f32 v59, v73
    v_mfma_f32_16x16x32_bf16 v[220:223], v[108:111], v[140:143], v[220:223]
    ds_read_b128 v[108:111], v48 offset:52224
    v_add_f32 v52, v58, v52
    v_add_f32 v52, v59, v52
    v_cvt_pk_bf16_f32 v130, v58, v59
    v_mfma_f32_16x16x32_bf16 v[224:227], v[112:115], v[136:139], v[224:227]
    s_waitcnt lgkmcnt(6)
    v_exp_f32 v60, v74
    v_exp_f32 v61, v75
    v_mfma_f32_16x16x32_bf16 v[228:231], v[112:115], v[140:143], v[228:231]
    ds_read_b128 v[112:115], v48 offset:53248
    v_add_f32 v52, v60, v52
    v_add_f32 v52, v61, v52
    v_cvt_pk_bf16_f32 v131, v60, v61
    v_mfma_f32_16x16x32_bf16 v[232:235], v[116:119], v[136:139], v[232:235]
    s_waitcnt lgkmcnt(6)
    v_exp_f32 v58, v76
    v_exp_f32 v59, v77
    v_mfma_f32_16x16x32_bf16 v[236:239], v[116:119], v[140:143], v[236:239]
    ds_read_b128 v[116:119], v48 offset:54272
    v_add_f32 v53, v58, v53
    v_add_f32 v53, v59, v53
    v_cvt_pk_bf16_f32 v134, v58, v59
    v_mfma_f32_16x16x32_bf16 v[240:243], v[120:123], v[136:139], v[240:243]
    s_waitcnt lgkmcnt(6)
    v_exp_f32 v60, v78
    v_exp_f32 v61, v79
    v_mfma_f32_16x16x32_bf16 v[244:247], v[120:123], v[140:143], v[244:247]
    ds_read_b128 v[120:123], v48 offset:55296
    v_add_f32 v53, v60, v53
    v_add_f32 v53, v61, v53
    v_cvt_pk_bf16_f32 v135, v60, v61
    v_mfma_f32_16x16x32_bf16 v[248:251], v[124:127], v[136:139], v[248:251]
    v_mfma_f32_16x16x32_bf16 v[252:255], v[124:127], v[140:143], v[252:255]
    ds_read_b128 v[124:127], v48 offset:56320
    v_add_f32 v62, v52, v53
    v_cmp_nge_f32 vcc, s65, v62
    s_cbranch_vccnz L_back_20_h
L_back_20:
L_pv2:
    s_waitcnt lgkmcnt(7)
    v_mfma_f32_16x16x32_bf16 v[192:195], v[96:99], v[128:131], v[192:195]
    s_waitcnt lgkmcnt(6)
    v_mfma_f32_16x16x32_bf16 v[196:199], v[96:99], v[132:135], v[196:199]
    v_add_f32 v56, v52, v56
    v_mfma_f32_16x16x32_bf16 v[200:203], v[100:103], v[128:131], v[200:203]
    s_waitcnt lgkmcnt(5)
    v_mfma_f32_16x16x32_bf16 v[204:207], v[100:103], v[132:135], v[204:207]
    v_mfma_f32_16x16x32_bf16 v[208:211], v[104:107], v[128:131], v[208:211]
    s_waitcnt lgkmcnt(4)
    v_mfma_f32_16x16x32_bf16 v[212:215], v[104:107], v[132:135], v[212:215]
    v_add_f32 v57, v53, v57
    v_mfma_f32_16x16x32_bf16 v[216:219], v[108:111], v[128:131], v[216:219]
    s_waitcnt lgkmcnt(3)
    v_mfma_f32_16x16x32_bf16 v[220:223], v[108:111], v[132:135], v[220:223]
    v_mfma_f32_16x16x32_bf16 v[224:227], v[112:115], v[128:131], v[224:227]
    s_waitcnt lgkmcnt(2)
    v_mfma_f32_16x16x32_bf16 v[228:231], v[112:115], v[132:135], v[228:231]
    v_mfma_f32_16x16x32_bf16 v[232:235], v[116:119], v[128:131], v[232:235]
    s_waitcnt lgkmcnt(1)
    v_mfma_f32_16x16x32_bf16 v[236:239], v[116:119], v[132:135], v[236:239]
    v_mfma_f32_16x16x32_bf16 v[240:243], v[120:123], v[128:131], v[240:243]
    s_waitcnt lgkmcnt(0)
    v_mfma_f32_16x16x32_bf16 v[244:247], v[120:123], v[132:135], v[244:247]
    v_mfma_f32_16x16x32_bf16 v[248:251], v[124:127], v[128:131], v[248:251]
    v_mfma_f32_16x16x32_bf16 v[252:255], v[124:127], v[132:135], v[252:255]
    s_branch L_fin
L_tail2:
    s_mov_b32 s65, s72
    s_waitcnt lgkmcnt(7)
    v_mfma_f32_16x16x32_bf16 v[192:195], v[96:99], v[128:131], v[192:195]
    s_waitcnt lgkmcnt(6)
    v_exp_f32 v60, v82
    v_exp_f32 v61, v83
    v_mfma_f32_16x16x32_bf16 v[196:199], v[96:99], v[132:135], v[196:199]
    ds_read_b128 v[96:99], v48 offset:57344
    v_add_f32 v54, v60, v54
    v_add_f32 v54, v61, v54
    v_cvt_pk_bf16_f32 v137, v60, v61
    v_add_f32 v56, v52, v56
    v_mfma_f32_16x16x32_bf16 v[200:203], v[100:103], v[128:131], v[200:203]
    s_waitcnt lgkmcnt(6)
    v_exp_f32 v58, v84
    v_exp_f32 v59, v85
    v_mfma_f32_16x16x32_bf16 v[204:207], v[100:103], v[132:135], v[204:207]
    ds_read_b128 v[100:103], v48 offset:58368
    v_add_f32 v55, v58, v59
    v_cvt_pk_bf16_f32 v140, v58, v59
    v_mfma_f32_16x16x32_bf16 v[208:211], v[104:107], v[128:131], v[208:211]
    s_waitcnt lgkmcnt(6)
    v_exp_f32 v60, v86
    v_exp_f32 v61, v87
    v_mfma_f32_16x16x32_bf16 v[212:215], v[104:107], v[132:135], v[212:215]
    ds_read_b128 v[104:107], v48 offset:59392
    v_add_f32 v55, v60, v55
    v_add_f32 v55, v61, v55
    v_cvt_pk_bf16_f32 v141, v60, v61
    v_add_f32 v57, v53, v57
    v_mfma_f32_16x16x32_bf16 v[216:219], v[108:111], v[128:131], v[216:219]
    s_waitcnt lgkmcnt(6)
    v_exp_f32 v58, v88
    v_exp_f32 v59, v89
    v_mfma_f32_16x16x32_bf16 v[220:223], v[108:111], v[132:135], v[220:223]
    ds_read_b128 v[108:111], v48 offset:60416
    v_add_f32 v54, v58, v54
    v_add_f32 v54, v59, v54
    v_cvt_pk_bf16_f32 v138, v58, v59
    v_mfma_f32_16x16x32_bf16 v[224:227], v[112:115], v[128:131], v[224:227]
    s_waitcnt lgkmcnt(6)
    v_exp_f32 v60, v90
    v_exp_f32 v61, v91
    v_mfma_f32_16x16x32_bf16 v[228:231], v[112:115], v[132:135], v[228:231]
    ds_read_b128 v[112:115], v48 offset:61440
    v_add_f32 v54, v60, v54
    v_add_f32 v54, v61, v54
    v_cvt_pk_bf16_f32 v139, v60, v61
    v_mfma_f32_16x16x32_bf16 v[232:235], v[116:119], v[128:131], v[232:235]
    s_waitcnt lgkmcnt(6)
    v_exp_f32 v58, v92
    v_exp_f32 v59, v93
    v_mfma_f32_16x16x32_bf16 v[236:239], v[116:119], v[132:135], v[236:239]
    ds_read_b128 v[116:119], v48 offset:62464
    v_add_f32 v55, v58, v55
    v_add_f32 v55, v59, v55
    v_cvt_pk_bf16_f32 v142, v58, v59
    v_mfma_f32_16x16x32_bf16 v[240:243], v[120:123], v[128:131], v[240:243]
    s_waitcnt lgkmcnt(6)
    v_exp_f32 v60, v94
    v_exp_f32 v61, v95
    v_mfma_f32_16x16x32_bf16 v[244:247], v[120:123], v[132:135], v[244:247]
    ds_read_b128 v[120:123], v48 offset:63488
    v_add_f32 v55, v60, v55
    v_add_f32 v55, v61, v55
    v_cvt_pk_bf16_f32 v143, v60, v61
    v_mfma_f32_16x16x32_bf16 v[248:251], v[124:127], v[128:131], v[248:251]
    v_mfma_f32_16x16x32_bf16 v[252:255], v[124:127], v[132:135], v[252:255]
    ds_read_b128 v[124:127], v48 offset:64512
    v_add_f32 v62, v54, v55
    v_cmp_nge_f32 vcc, s65, v62
    s_cbranch_vccnz L_back_21_h
L_back_21:
L_pv3:
    s_waitcnt lgkmcnt(7)
    v_mfma_f32_16x16x32_bf16 v[192:195], v[96:99], v[136:139], v[192:195]
    s_waitcnt lgkmcnt(6)
    v_mfma_f32_16x16x32_bf16 v[196:199], v[96:99], v[140:143], v[196:199]
    v_add_f32 v56, v54, v56
    v_mfma_f32_16x16x32_bf16 v[200:203], v[100:103], v[136:139], v[200:203]
    s_waitcnt lgkmcnt(5)
    v_xor_b32 v48, 0x10000, v48
    v_mfma_f32_16x16x32_bf16 v[204:207], v[100:103], v[140:143], v[204:207]
    s_waitcnt vmcnt(0) lgkmcnt(0)
    s_call_b64 s[82:83], L_pend
    s_barrier
    s_call_b64 s[82:83], L_load
    s_add_i32 s62, s62, 1
    v_mfma_f32_16x16x32_bf16 v[208:211], v[104:107], v[136:139], v[208:211]
    v_mfma_f32_16x16x32_bf16 v[212:215], v[104:107], v[140:143], v[212:215]
    v_add_f32 v57, v55, v57
    v_mfma_f32_16x16x32_bf16 v[216:219], v[108:111], v[136:139], v[216:219]
    v_mfma_f32_16x16x32_bf16 v[220:223], v[108:111], v[140:143], v[220:223]
    v_mfma_f32_16x16x32_bf16 v[224:227], v[112:115], v[136:139], v[224:227]
    v_mfma_f32_16x16x32_bf16 v[228:231], v[112:115], v[140:143], v[228:231]
    v_mfma_f32_16x16x32_bf16 v[232:235], v[116:119], v[136:139], v[232:235]
    v_mfma_f32_16x16x32_bf16 v[236:239], v[116:119], v[140:143], v[236:239]
    v_mfma_f32_16x16x32_bf16 v[240:243], v[120:123], v[136:139], v[240:243]
    v_mfma_f32_16x16x32_bf16 v[244:247], v[120:123], v[140:143], v[244:247]
    v_mfma_f32_16x16x32_bf16 v[248:251], v[124:127], v[136:139], v[248:251]
    v_mfma_f32_16x16x32_bf16 v[252:255], v[124:127], v[140:143], v[252:255]
    s_branch L_fin
L_tail3:
    s_mov_b32 s65, s72
    s_waitcnt lgkmcnt(7)
    v_mfma_f32_16x16x32_bf16 v[192:195], v[96:99], v[136:139], v[192:195]
    s_waitcnt lgkmcnt(6)
    v_exp_f32 v60, v66
    v_exp_f32 v61, v67
    v_mfma_f32_16x16x32_bf16 v[196:199], v[96:99], v[140:143], v[196:199]
    v_add_f32 v52, v60, v52
    v_add_f32 v52, v61, v52
    v_cvt_pk_bf16_f32 v129, v60, v61
    v_add_f32 v56, v54, v56
    v_mfma_f32_16x16x32_bf16 v[200:203], v[100:103], v[136:139], v[200:203]
    s_waitcnt lgkmcnt(5)
    v_exp_f32 v58, v68
    v_exp_f32 v59, v69
    v_xor_b32 v48, 0x10000, v48
    v_mfma_f32_16x16x32_bf16 v[204:207], v[100:103], v[140:143], v[204:207]
    s_waitcnt vmcnt(0) lgkmcnt(0)
    s_call_b64 s[82:83], L_pend
    s_barrier
    s_call_b64 s[82:83], L_load
    s_add_i32 s62, s62, 1
    ds_read_b128 v[96:99], v48 offset:32768
    ds_read_b128 v[100:103], v48 offset:33792
    v_add_f32 v53, v58, v59
    v_cvt_pk_bf16_f32 v132, v58, v59
    v_mfma_f32_16x16x32_bf16 v[208:211], v[104:107], v[136:139], v[208:211]
    v_exp_f32 v60, v70
    v_exp_f32 v61, v71
    v_mfma_f32_16x16x32_bf16 v[212:215], v[104:107], v[140:143], v[212:215]
    ds_read_b128 v[104:107], v48 offset:34816
    v_add_f32 v53, v60, v53
    v_add_f32 v53, v61, v53
    v_cvt_pk_bf16_f32 v133, v60, v61
    v_add_f32 v57, v55, v57
    v_mfma_f32_16x16x32_bf16 v[216:219], v[108:111], v[136:139], v[216:219]
    v_exp_f32 v58, v72
    v_exp_f32 v59, v73
    v_mfma_f32_16x16x32_bf16 v[220:223], v[108:111], v[140:143], v[220:223]
    ds_read_b128 v[108:111], v48 offset:35840
    v_add_f32 v52, v58, v52
    v_add_f32 v52, v59, v52
    v_cvt_pk_bf16_f32 v130, v58, v59
    v_mfma_f32_16x16x32_bf16 v[224:227], v[112:115], v[136:139], v[224:227]
    v_exp_f32 v60, v74
    v_exp_f32 v61, v75
    v_mfma_f32_16x16x32_bf16 v[228:231], v[112:115], v[140:143], v[228:231]
    ds_read_b128 v[112:115], v48 offset:36864
    v_add_f32 v52, v60, v52
    v_add_f32 v52, v61, v52
    v_cvt_pk_bf16_f32 v131, v60, v61
    v_mfma_f32_16x16x32_bf16 v[232:235], v[116:119], v[136:139], v[232:235]
    v_exp_f32 v58, v76
    v_exp_f32 v59, v77
    v_mfma_f32_16x16x32_bf16 v[236:239], v[116:119], v[140:143], v[236:239]
    ds_read_b128 v[116:119], v48 offset:37888
    v_add_f32 v53, v58, v53
    v_add_f32 v53, v59, v53
    v_cvt_pk_bf16_f32 v134, v58, v59
    v_mfma_f32_16x16x32_bf16 v[240:243], v[120:123], v[136:139], v[240:243]
    v_exp_f32 v60, v78
    v_exp_f32 v61, v79
    v_mfma_f32_16x16x32_bf16 v[244:247], v[120:123], v[140:143], v[244:247]
    ds_read_b128 v[120:123], v48 offset:38912
    v_add_f32 v53, v60, v53
    v_add_f32 v53, v61, v53
    v_cvt_pk_bf16_f32 v135, v60, v61
    v_mfma_f32_16x16x32_bf16 v[248:251], v[124:127], v[136:139], v[248:251]
    v_mfma_f32_16x16x32_bf16 v[252:255], v[124:127], v[140:143], v[252:255]
    ds_read_b128 v[124:127], v48 offset:39936
    v_add_f32 v62, v52, v53
    v_cmp_nge_f32 vcc, s65, v62
    s_cbranch_vccnz L_back_24_h
L_back_24:
L_pv0:
    s_waitcnt lgkmcnt(7)
    v_mfma_f32_16x16x32_bf16 v[192:195], v[96:99], v[128:131], v[192:195]
    s_waitcnt lgkmcnt(6)
    v_mfma_f32_16x16x32_bf16 v[196:199], v[96:99], v[132:135], v[196:199]
    v_add_f32 v56, v52, v56
    v_mfma_f32_16x16x32_bf16 v[200:203], v[100:103], v[128:131], v[200:203]
    s_waitcnt lgkmcnt(5)
    v_mfma_f32_16x16x32_bf16 v[204:207], v[100:103], v[132:135], v[204:207]
    v_mfma_f32_16x16x32_bf16 v[208:211], v[104:107], v[128:131], v[208:211]
    s_waitcnt lgkmcnt(4)
    v_mfma_f32_16x16x32_bf16 v[212:215], v[104:107], v[132:135], v[212:215]
    v_add_f32 v57, v53, v57
    v_mfma_f32_16x16x32_bf16 v[216:219], v[108:111], v[128:131], v[216:219]
    s_waitcnt lgkmcnt(3)
    v_mfma_f32_16x16x32_bf16 v[220:223], v[108:111], v[132:135], v[220:223]
    v_mfma_f32_16x16x32_bf16 v[224:227], v[112:115], v[128:131], v[224:227]
    s_waitcnt lgkmcnt(2)
    v_mfma_f32_16x16x32_bf16 v[228:231], v[112:115], v[132:135], v[228:231]
    v_mfma_f32_16x16x32_bf16 v[232:235], v[116:119], v[128:131], v[232:235]
    s_waitcnt lgkmcnt(1)
    v_mfma_f32_16x16x32_bf16 v[236:239], v[116:119], v[132:135], v[236:239]
    v_mfma_f32_16x16x32_bf16 v[240:243], v[120:123], v[128:131], v[240:243]
    s_waitcnt lgkmcnt(0)
    v_mfma_f32_16x16x32_bf16 v[244:247], v[120:123], v[132:135], v[244:247]
    v_mfma_f32_16x16x32_bf16 v[248:251], v[124:127], v[128:131], v[248:251]
    v_mfma_f32_16x16x32_bf16 v[252:255], v[124:127], v[132:135], v[252:255]
L_fin:
    v_and_b32 v3, 7, v1
    v_lshlrev_b32 v3, 2, v3
    s_mov_b32 s72, 0x3a0000
    buffer_load_dword v51, v3, s[8:11], s72 offen sc1
    v_mov_b32 v58, v56
    s_nop 1
    v_permlane16_swap_b32 v56, v58
    s_nop 1
    v_add_f32 v56, v56, v58
    v_mov_b32 v58, v56
    s_nop 1
    v_permlane32_swap_b32 v56, v58
    s_nop 1
    v_add_f32 v56, v56, v58
    v_rcp_f32 v56, v56
    v_mov_b32 v58, v57
    s_nop 1
    v_permlane16_swap_b32 v57, v58
    s_nop 1
    v_add_f32 v57, v57, v58
    v_mov_b32 v58, v57
    s_nop 1
    v_permlane32_swap_b32 v57, v58
    s_nop 1
    v_add_f32 v57, v57, v58
    v_rcp_f32 v57, v57
    s_lshl_b32 s6, s60, 18
    s_lshl_b32 s7, s4, 12
    s_add_u32 s6, s6, s7
    s_add_u32 s6, s6, 50331648
    s_nop 4
    v_mul_f32 v192, v56, v192
    v_mul_f32 v193, v56, v193
    v_mul_f32 v194, v56, v194
    v_mul_f32 v195, v56, v195
    v_cvt_pk_bf16_f32 v16, v192, v193
    v_cvt_pk_bf16_f32 v17, v194, v195
    v_mul_f32 v200, v56, v200
    v_mul_f32 v201, v56, v201
    v_mul_f32 v202, v56, v202
    v_mul_f32 v203, v56, v203
    v_cvt_pk_bf16_f32 v18, v200, v201
    v_cvt_pk_bf16_f32 v19, v202, v203
    buffer_store_dwordx4 v[16:19], v13, s[8:11], s6 offen offset:0 sc1
    v_mul_f32 v208, v56, v208
    v_mul_f32 v209, v56, v209
    v_mul_f32 v210, v56, v210
    v_mul_f32 v211, v56, v211
    v_cvt_pk_bf16_f32 v20, v208, v209
    v_cvt_pk_bf16_f32 v21, v210, v211
    v_mul_f32 v216, v56, v216
    v_mul_f32 v217, v56, v217
    v_mul_f32 v218, v56, v218
    v_mul_f32 v219, v56, v219
    v_cvt_pk_bf16_f32 v22, v216, v217
    v_cvt_pk_bf16_f32 v23, v218, v219
    buffer_store_dwordx4 v[20:23], v13, s[8:11], s6 offen offset:1024 sc1
    v_mul_f32 v224, v56, v224
    v_mul_f32 v225, v56, v225
    v_mul_f32 v226, v56, v226
    v_mul_f32 v227, v56, v227
    v_cvt_pk_bf16_f32 v24, v224, v225
    v_cvt_pk_bf16_f32 v25, v226, v227
    v_mul_f32 v232, v56, v232
    v_mul_f32 v233, v56, v233
    v_mul_f32 v234, v56, v234
    v_mul_f32 v235, v56, v235
    v_cvt_pk_bf16_f32 v26, v232, v233
    v_cvt_pk_bf16_f32 v27, v234, v235
    buffer_store_dwordx4 v[24:27], v13, s[8:11], s6 offen offset:2048 sc1
    v_mul_f32 v240, v56, v240
    v_mul_f32 v241, v56, v241
    v_mul_f32 v242, v56, v242
    v_mul_f32 v243, v56, v243
    v_cvt_pk_bf16_f32 v28, v240, v241
    v_cvt_pk_bf16_f32 v29, v242, v243
    v_mul_f32 v248, v56, v248
    v_mul_f32 v249, v56, v249
    v_mul_f32 v250, v56, v250
    v_mul_f32 v251, v56, v251
    v_cvt_pk_bf16_f32 v30, v248, v249
    v_cvt_pk_bf16_f32 v31, v250, v251
    buffer_store_dwordx4 v[28:31], v13, s[8:11], s6 offen offset:3072 sc1
    s_add_u32 s6, s6, 0x20000
    v_mul_f32 v196, v57, v196
    v_mul_f32 v197, v57, v197
    v_mul_f32 v198, v57, v198
    v_mul_f32 v199, v57, v199
    v_cvt_pk_bf16_f32 v32, v196, v197
    v_cvt_pk_bf16_f32 v33, v198, v199
    v_mul_f32 v204, v57, v204
    v_mul_f32 v205, v57, v205
    v_mul_f32 v206, v57, v206
    v_mul_f32 v207, v57, v207
    v_cvt_pk_bf16_f32 v34, v204, v205
    v_cvt_pk_bf16_f32 v35, v206, v207
    buffer_store_dwordx4 v[32:35], v13, s[8:11], s6 offen offset:0 sc1
    v_mul_f32 v212, v57, v212
    v_mul_f32 v213, v57, v213
    v_mul_f32 v214, v57, v214
    v_mul_f32 v215, v57, v215
    v_cvt_pk_bf16_f32 v36, v212, v213
    v_cvt_pk_bf16_f32 v37, v214, v215
    v_mul_f32 v220, v57, v220
    v_mul_f32 v221, v57, v221
    v_mul_f32 v222, v57, v222
    v_mul_f32 v223, v57, v223
    v_cvt_pk_bf16_f32 v38, v220, v221
    v_cvt_pk_bf16_f32 v39, v222, v223
    buffer_store_dwordx4 v[36:39], v13, s[8:11], s6 offen offset:1024 sc1
    v_mul_f32 v228, v57, v228
    v_mul_f32 v229, v57, v229
    v_mul_f32 v230, v57, v230
    v_mul_f32 v231, v57, v231
    v_cvt_pk_bf16_f32 v40, v228, v229
    v_cvt_pk_bf16_f32 v41, v230, v231
    v_mul_f32 v236, v57, v236
    v_mul_f32 v237, v57, v237
    v_mul_f32 v238, v57, v238
    v_mul_f32 v239, v57, v239
    v_cvt_pk_bf16_f32 v42, v236, v237
    v_cvt_pk_bf16_f32 v43, v238, v239
    buffer_store_dwordx4 v[40:43], v13, s[8:11], s6 offen offset:2048 sc1
    v_mul_f32 v244, v57, v244
    v_mul_f32 v245, v57, v245
    v_mul_f32 v246, v57, v246
    v_mul_f32 v247, v57, v247
    v_cvt_pk_bf16_f32 v44, v244, v245
    v_cvt_pk_bf16_f32 v45, v246, v247
    v_mul_f32 v252, v57, v252
    v_mul_f32 v253, v57, v253
    v_mul_f32 v254, v57, v254
    v_mul_f32 v255, v57, v255
    v_cvt_pk_bf16_f32 v46, v252, v253
    v_cvt_pk_bf16_f32 v47, v254, v255
    buffer_store_dwordx4 v[44:47], v13, s[8:11], s6 offen offset:3072 sc1
    s_cmp_gt_i32 s62, s63
    s_cbranch_scc1 L_pre
    s_waitcnt vmcnt(8)
    s_call_b64 s[82:83], L_pend
    s_barrier
    s_waitcnt vmcnt(0)
    s_lshl_b32 s6, s60, 5
    s_add_u32 s6, s6, s4
    s_lshl_b32 s6, s6, 7
    s_add_u32 s6, s6, 3932160
    v_mov_b32 v2, 1
    v_mov_b32 v3, 0x5000000
    v_writelane_b32 v3, s6, 0
    buffer_store_dword v2, v3, s[8:11], 0 offen sc1
    s_call_b64 s[82:83], L_load
    s_add_i32 s62, s62, 1
    s_lshl_b32 s6, s3, 8
    s_add_u32 s6, s6, s2
    s_cmp_eq_u32 s6, 31
    s_cbranch_scc1 L_top
L_idle:
    s_sub_i32 s6, s63, 5
    s_cmp_gt_i32 s62, s6
    s_cbranch_scc1 L_pre
    s_waitcnt vmcnt(0) lgkmcnt(0)
    s_call_b64 s[82:83], L_pend
    s_barrier
    s_call_b64 s[82:83], L_load
    s_add_i32 s62, s62, 1
    s_cmp_lt_u32 s61, 54
    s_cbranch_scc1 L_moe
    s_branch L_idle
L_pre:
    s_cmp_lt_u32 s3, 4
    s_cbranch_scc1 L_pre1
    s_add_u32 s6, s76, 0
    s_and_b32 s6, s6, 3
    s_lshl_b32 s6, s6, 10
    v_add_u32 v44, s6, v13
    s_add_u32 s6, s76, 1
    s_and_b32 s6, s6, 3
    s_lshl_b32 s6, s6, 10
    v_add_u32 v45, s6, v13
    s_add_u32 s6, s76, 2
    s_and_b32 s6, s6, 3
    s_lshl_b32 s6, s6, 10
    v_add_u32 v46, s6, v13
    s_add_u32 s6, s76, 3
    s_and_b32 s6, s6, 3
    s_lshl_b32 s6, s6, 10
    v_add_u32 v47, s6, v13
    v_add_u32 v52, 4096, v13
    s_lshr_b32 s69, s4, 3
    s_lshl_b32 s69, s69, 2
    s_add_u32 s69, s69, s76
    s_mul_i32 s69, s69, 327680
    s_and_b32 s7, s4, 3
    s_mul_i32 s7, s7, 10240
    s_add_u32 s69, s69, s7
    s_add_u32 s69, s69, 4199424
    s_and_b32 s6, s4, 4
    s_lshr_b32 s7, s4, 3
    s_add_u32 s6, s6, s7
    s_lshl_b32 s7, s5, 3
    s_add_u32 s68, s6, s7
    s_sub_u32 s7, 120, s7
    s_add_u32 s61, s6, s7
    s_and_b32 s6, s63, 1
    s_lshl_b32 s6, s6, 16
    s_xor_b32 s6, s6, 0x10000
    s_lshl_b32 s7, s76, 12
    s_add_u32 s7, s7, s6
    v_add_u32 v5, s7, v13
    s_lshl_b32 s7, s76, 13
    s_add_u32 s6, s6, s7
    v_add_u32 v3, s6, v13
    s_add_u32 s7, s7, 131072
    v_add_u32 v2, s7, v13
    s_barrier
    ds_read_b128 v[96:99], v2 offset:0
    ds_read_b128 v[100:103], v2 offset:1024
    ds_read_b128 v[104:107], v2 offset:2048
    ds_read_b128 v[108:111], v2 offset:3072
    ds_read_b128 v[112:115], v2 offset:4096
    ds_read_b128 v[116:119], v2 offset:5120
    ds_read_b128 v[120:123], v2 offset:6144
    ds_read_b128 v[124:127], v2 offset:7168
    s_waitcnt lgkmcnt(6)
    ds_read_b128 v[128:131], v3 offset:0
    ds_read_b128 v[132:135], v3 offset:1024
    ds_read_b128 v[136:139], v3 offset:2048
    ds_read_b128 v[140:143], v3 offset:3072
    ds_read_b128 v[144:147], v3 offset:4096
    ds_read_b128 v[148:151], v3 offset:5120
    ds_read_b128 v[152:155], v3 offset:6144
    ds_read_b128 v[156:159], v3 offset:7168
    s_waitcnt lgkmcnt(6)
    ds_read_b128 v[160:163], v5 offset:49152
    ds_read_b128 v[164:167], v5 offset:50176
    ds_read_b128 v[168:171], v5 offset:51200
    ds_read_b128 v[172:175], v5 offset:52224
    s_waitcnt lgkmcnt(0)
    s_barrier
    s_add_u32 s75, s69, 163840
    buffer_load_dwordx4 v[176:179], v44, s[8:11], s75 offen sc1
    buffer_load_dwordx4 v[180:183], v45, s[8:11], s75 offen sc1
    buffer_load_dwordx4 v[184:187], v46, s[8:11], s75 offen sc1
    buffer_load_dwordx4 v[188:191], v47, s[8:11], s75 offen sc1
    buffer_load_dwordx4 v[192:195], v52, s[8:11], s75 offen sc1
    s_waitcnt vmcnt(13)
    v_cmp_le_i32 vcc, 0, v51
    s_cbranch_vccz L_idx_okb
    v_and_b32 v3, 7, v1
    v_lshlrev_b32 v3, 2, v3
    s_mov_b32 s72, 0x3a0000
    s_mov_b32 s79, 262144
L_poll_27:
    buffer_load_dword v51, v3, s[8:11], s72 offen sc1
    s_waitcnt vmcnt(0)
    v_cmp_le_i32 vcc, 0, v51
    s_cbranch_vccz L_polldone_28
    s_sleep 2
    s_sub_u32 s79, s79, 1
    s_cmp_lg_u32 s79, 0
    s_cbranch_scc1 L_poll_27
L_polldone_28:
L_idx_okb:
    s_call_b64 s[80:81], L_oprep
    s_waitcnt vmcnt(5)
    s_lshl_b32 s6, s60, 5
    s_add_u32 s6, s6, s4
    s_lshl_b32 s6, s6, 7
    s_add_u32 s6, s6, 3932160
    v_mov_b32 v2, 1
    v_mov_b32 v3, 0x5000000
    v_writelane_b32 v3, s6, 0
    buffer_store_dword v2, v3, s[8:11], 0 offen sc1
    s_branch L_adone
L_oprep:
    s_add_u32 s6, s76, 0
    s_and_b32 s6, s6, 3
    s_lshl_b32 s6, s6, 10
    v_add_u32 v44, s6, v13
    s_add_u32 s6, s76, 1
    s_and_b32 s6, s6, 3
    s_lshl_b32 s6, s6, 10
    v_add_u32 v45, s6, v13
    s_add_u32 s6, s76, 2
    s_and_b32 s6, s6, 3
    s_lshl_b32 s6, s6, 10
    v_add_u32 v46, s6, v13
    s_add_u32 s6, s76, 3
    s_and_b32 s6, s6, 3
    s_lshl_b32 s6, s6, 10
    v_add_u32 v47, s6, v13
    v_add_u32 v52, 4096, v13
    s_lshr_b32 s6, s3, 2
    s_lshl_b32 s6, s6, 1
    s_sub_u32 s71, s76, s6
    s_and_b32 s71, s71, 3
    s_lshr_b32 s6, s4, 3
    s_lshl_b32 s6, s6, 15
    s_lshl_b32 s99, s3, 12
    s_add_u32 s66, s6, s99
    s_add_u32 s66, s66, 50331648
    s_lshl_b32 s6, s76, 13
    v_add_u32 v4, s6, v13
    v_add_u32 v7, 65536, v4
    s_lshr_b32 s6, s3, 2
    s_mul_i32 s67, s6, 15360
    s_add_u32 s67, s67, 98304
    v_add_u32 v6, s67, v44
    s_and_b32 s96, s4, 7
    s_lshl_b32 s7, s5, 3
    s_add_u32 s96, s96, s7
    s_lshr_b32 s7, s4, 3
    s_add_u32 s7, s7, 0
    s_add_u32 s7, s7, 1
    s_and_b32 s7, s7, 3
    s_lshl_b32 s96, s96, 2
    s_add_u32 s96, s96, s7
    s_mul_i32 s96, s96, 3
    s_add_u32 s96, s96, 0
    s_mul_i32 s96, s96, 20480
    s_lshr_b32 s6, s3, 2
    s_mul_i32 s6, s6, 5120
    s_add_u32 s96, s96, s6
    s_add_u32 s96, s96, 67108864
    s_and_b32 s97, s4, 7
    s_lshl_b32 s7, s5, 3
    s_add_u32 s97, s97, s7
    s_lshr_b32 s7, s4, 3
    s_add_u32 s7, s7, 1
    s_add_u32 s7, s7, 1
    s_and_b32 s7, s7, 3
    s_lshl_b32 s97, s97, 2
    s_add_u32 s97, s97, s7
    s_mul_i32 s97, s97, 3
    s_add_u32 s97, s97, 1
    s_mul_i32 s97, s97, 20480
    s_lshr_b32 s6, s3, 2
    s_mul_i32 s6, s6, 5120
    s_add_u32 s97, s97, s6
    s_add_u32 s97, s97, 67108864
    s_and_b32 s98, s4, 7
    s_lshl_b32 s7, s5, 3
    s_add_u32 s98, s98, s7
    s_lshr_b32 s7, s4, 3
    s_add_u32 s7, s7, 2
    s_add_u32 s7, s7, 1
    s_and_b32 s7, s7, 3
    s_lshl_b32 s98, s98, 2
    s_add_u32 s98, s98, s7
    s_mul_i32 s98, s98, 3
    s_add_u32 s98, s98, 2
    s_mul_i32 s98, s98, 20480
    s_lshr_b32 s6, s3, 2
    s_mul_i32 s6, s6, 5120
    s_add_u32 s98, s98, s6
    s_add_u32 s98, s98, 67108864
    s_mov_b32 s12, s32
    s_mov_b32 s13, s33
    s_mov_b32 s14, 0x280000
    s_mov_b32 s15, 0x20000
    s_and_b32 s75, s4, 3
    s_mul_i32 s70, s75, 320
    s_add_u32 s73, s70, 3837952
    s_mul_i32 s72, s75, 5120
    v_lshrrev_b32 v2, 4, v1
    v_and_b32 v3, 15, v1
    v_mul_u32_u24 v54, 1280, v3
    v_lshl_add_u32 v54, v2, 4, v54
    v_lshlrev_b32 v3, 4, v3
    v_lshl_add_u32 v9, v2, 9, v3
    s_lshr_b32 s100, s3, 2
    s_cselect_b32 s6, s61, s68
    s_mul_i32 s6, s6, 20480
    s_lshl_b32 s7, s76, 6
    s_add_u32 s7, s7, s6
    v_add_u32 v53, s7, v54
    s_lshl_b32 s7, s76, 10
    s_add_u32 s7, s7, s6
    s_add_u32 s7, s7, s72
    v_add_u32 v48, s7, v13
    s_mul_i32 s6, s100, 10240
    s_lshl_b32 s7, s76, 11
    s_add_u32 s6, s6, s7
    v_add_u32 v8, s6, v9
    s_mul_i32 s6, s100, 30720
    s_add_u32 s6, s6, 65536
    v_add_u32 v10, s6, v8
    s_lshl_b32 s7, s76, 2
    v_add_u32 v2, s7, v2
    v_cmp_lt_u32 vcc, 9, v2
    v_add_u32 v3, 15360, v10
    s_nop 0
    v_cndmask_b32 v10, v10, v3, vcc
    s_and_b32 s100, s3, 1
    s_cselect_b32 s6, s61, s68
    s_mul_i32 s6, s6, 20480
    s_add_u32 s7, s6, 256
    v_add_u32 v54, s7, v54
    s_add_u32 s7, s6, s72
    s_add_u32 s7, s7, 4096
    v_add_u32 v49, s7, v13
    s_mul_i32 s6, s100, 10240
    s_add_u32 s6, s6, 8192
    v_add_u32 v9, s6, v9
    s_mul_i32 s6, s100, 30720
    s_add_u32 s6, s6, 80896
    v_add_u32 v55, s6, v9
    s_mov_b32 s64, 0
    v_and_b32 v2, 0x7ff, v51
    v_sub_u32 v2, 0x7ff, v2
    v_lshrrev_b32 v3, 4, v2
    v_cmp_eq_u32 vcc, s68, v3
    v_cmp_eq_u32 s[74:75], s61, v3
    s_nop 3
    s_or_b64 vcc, vcc, s[74:75]
    s_cbranch_scc0 L_notok_29
    v_readlane_b32 s84, v2, 0
    v_readlane_b32 s85, v2, 1
    v_readlane_b32 s86, v2, 2
    v_readlane_b32 s87, v2, 3
    v_readlane_b32 s88, v2, 4
    v_readlane_b32 s90, v2, 5
    v_readlane_b32 s91, v2, 6
    v_readlane_b32 s101, v2, 7
    s_lshl_b32 s7, s76, 6
    s_lshr_b32 s100, s3, 2
    s_cselect_b32 s6, s61, s68
    s_lshl_b32 s6, s6, 4
    v_and_b32 v2, 15, v1
    v_add_u32 v2, s6, v2
    s_add_u32 s7, s7, s73
    v_and_b32 v3, 48, v1
    v_add_u32 v3, s7, v3
    v_cmp_eq_u32 vcc, s84, v2
    s_nop 1
    v_cndmask_b32 v48, v48, v3, vcc
    v_add_u32 v3, 1280, v3
    v_cmp_eq_u32 vcc, s85, v2
    s_nop 1
    v_cndmask_b32 v48, v48, v3, vcc
    v_add_u32 v3, 1280, v3
    v_cmp_eq_u32 vcc, s86, v2
    s_nop 1
    v_cndmask_b32 v48, v48, v3, vcc
    v_add_u32 v3, 1280, v3
    v_cmp_eq_u32 vcc, s87, v2
    s_nop 1
    v_cndmask_b32 v48, v48, v3, vcc
    v_add_u32 v3, 1280, v3
    v_cmp_eq_u32 vcc, s88, v2
    s_nop 1
    v_cndmask_b32 v48, v48, v3, vcc
    v_add_u32 v3, 1280, v3
    v_cmp_eq_u32 vcc, s90, v2
    s_nop 1
    v_cndmask_b32 v48, v48, v3, vcc
    v_add_u32 v3, 1280, v3
    v_cmp_eq_u32 vcc, s91, v2
    s_nop 1
    v_cndmask_b32 v48, v48, v3, vcc
    v_add_u32 v3, 1280, v3
    v_cmp_eq_u32 vcc, s101, v2
    s_nop 1
    v_cndmask_b32 v48, v48, v3, vcc
    s_movk_i32 s7, 256
    s_and_b32 s100, s3, 1
    s_cselect_b32 s6, s61, s68
    s_lshl_b32 s6, s6, 4
    v_and_b32 v2, 15, v1
    v_add_u32 v2, s6, v2
    s_add_u32 s7, s7, s73
    v_and_b32 v3, 48, v1
    v_add_u32 v3, s7, v3
    v_cmp_eq_u32 vcc, s84, v2
    s_nop 1
    v_cndmask_b32 v49, v49, v3, vcc
    v_add_u32 v3, 1280, v3
    v_cmp_eq_u32 vcc, s85, v2
    s_nop 1
    v_cndmask_b32 v49, v49, v3, vcc
    v_add_u32 v3, 1280, v3
    v_cmp_eq_u32 vcc, s86, v2
    s_nop 1
    v_cndmask_b32 v49, v49, v3, vcc
    v_add_u32 v3, 1280, v3
    v_cmp_eq_u32 vcc, s87, v2
    s_nop 1
    v_cndmask_b32 v49, v49, v3, vcc
    v_add_u32 v3, 1280, v3
    v_cmp_eq_u32 vcc, s88, v2
    s_nop 1
    v_cndmask_b32 v49, v49, v3, vcc
    v_add_u32 v3, 1280, v3
    v_cmp_eq_u32 vcc, s90, v2
    s_nop 1
    v_cndmask_b32 v49, v49, v3, vcc
    v_add_u32 v3, 1280, v3
    v_cmp_eq_u32 vcc, s91, v2
    s_nop 1
    v_cndmask_b32 v49, v49, v3, vcc
    v_add_u32 v3, 1280, v3
    v_cmp_eq_u32 vcc, s101, v2
    s_nop 1
    v_cndmask_b32 v49, v49, v3, vcc
    s_mov_b32 s64, 1
L_notok_29:
    s_setpc_b64 s[80:81]
L_pre1:
    v_and_b32 v3, 7, v1
    v_lshlrev_b32 v3, 2, v3
    s_mov_b32 s72, 0x3a0000
    buffer_load_dword v51, v3, s[8:11], s72 offen sc1
    s_add_u32 s6, s76, 0
    s_and_b32 s6, s6, 3
    s_lshl_b32 s6, s6, 10
    v_add_u32 v44, s6, v13
    s_add_u32 s6, s76, 1
    s_and_b32 s6, s6, 3
    s_lshl_b32 s6, s6, 10
    v_add_u32 v45, s6, v13
    s_add_u32 s6, s76, 2
    s_and_b32 s6, s6, 3
    s_lshl_b32 s6, s6, 10
    v_add_u32 v46, s6, v13
    s_add_u32 s6, s76, 3
    s_and_b32 s6, s6, 3
    s_lshl_b32 s6, s6, 10
    v_add_u32 v47, s6, v13
    v_add_u32 v52, 4096, v13
    s_lshr_b32 s69, s4, 3
    s_lshl_b32 s69, s69, 2
    s_add_u32 s69, s69, s76
    s_mul_i32 s69, s69, 327680
    s_and_b32 s7, s4, 3
    s_mul_i32 s7, s7, 10240
    s_add_u32 s69, s69, s7
    s_add_u32 s69, s69, 4194304
    s_and_b32 s6, s4, 4
    s_lshr_b32 s7, s4, 3
    s_add_u32 s6, s6, s7
    s_lshl_b32 s7, s5, 3
    s_add_u32 s68, s6, s7
    s_sub_u32 s7, 120, s7
    s_add_u32 s61, s6, s7
    s_add_u32 s75, s69, 0
    buffer_load_dwordx4 v[96:99], v44, s[8:11], s75 offen sc1
    buffer_load_dwordx4 v[100:103], v45, s[8:11], s75 offen sc1
    buffer_load_dwordx4 v[104:107], v46, s[8:11], s75 offen sc1
    buffer_load_dwordx4 v[108:111], v47, s[8:11], s75 offen sc1
    buffer_load_dwordx4 v[112:115], v52, s[8:11], s75 offen sc1
    s_add_u32 s75, s69, 40960
    buffer_load_dwordx4 v[116:119], v44, s[8:11], s75 offen sc1
    buffer_load_dwordx4 v[120:123], v45, s[8:11], s75 offen sc1
    buffer_load_dwordx4 v[124:127], v46, s[8:11], s75 offen sc1
    buffer_load_dwordx4 v[128:131], v47, s[8:11], s75 offen sc1
    buffer_load_dwordx4 v[132:135], v52, s[8:11], s75 offen sc1
    s_cmp_gt_i32 s62, s63
    s_cbranch_scc1 L_e2
    s_cmp_eq_i32 s62, s63
    s_cbranch_scc1 L_lw0
    s_waitcnt vmcnt(11)
L_lw0:
    s_waitcnt vmcnt(21)
    s_call_b64 s[82:83], L_pend
    s_barrier
    s_call_b64 s[82:83], L_load
    s_add_i32 s62, s62, 1
L_e2:
    s_add_u32 s75, s69, 81920
    buffer_load_dwordx4 v[136:139], v44, s[8:11], s75 offen sc1
    buffer_load_dwordx4 v[140:143], v45, s[8:11], s75 offen sc1
    buffer_load_dwordx4 v[144:147], v46, s[8:11], s75 offen sc1
    buffer_load_dwordx4 v[148:151], v47, s[8:11], s75 offen sc1
    buffer_load_dwordx4 v[152:155], v52, s[8:11], s75 offen sc1
    s_add_u32 s75, s69, 122880
    buffer_load_dwordx4 v[156:159], v44, s[8:11], s75 offen sc1
    buffer_load_dwordx4 v[160:163], v45, s[8:11], s75 offen sc1
    buffer_load_dwordx4 v[164:167], v46, s[8:11], s75 offen sc1
    buffer_load_dwordx4 v[168:171], v47, s[8:11], s75 offen sc1
    buffer_load_dwordx4 v[172:175], v52, s[8:11], s75 offen sc1
    s_cmp_gt_i32 s62, s63
    s_cbranch_scc1 L_e3
    s_cmp_eq_i32 s62, s63
    s_cbranch_scc1 L_lw1
    s_waitcnt vmcnt(10)
L_lw1:
    s_waitcnt vmcnt(21)
    s_call_b64 s[82:83], L_pend
    s_barrier
    s_call_b64 s[82:83], L_load
    s_add_i32 s62, s62, 1
L_e3:
    s_add_u32 s75, s69, 163840
    buffer_load_dwordx4 v[176:179], v44, s[8:11], s75 offen sc1
    buffer_load_dwordx4 v[180:183], v45, s[8:11], s75 offen sc1
    buffer_load_dwordx4 v[184:187], v46, s[8:11], s75 offen sc1
    buffer_load_dwordx4 v[188:191], v47, s[8:11], s75 offen sc1
    buffer_load_dwordx4 v[192:195], v52, s[8:11], s75 offen sc1
    s_add_u32 s75, s69, 204800
    buffer_load_dwordx4 v[196:199], v44, s[8:11], s75 offen sc1
    buffer_load_dwordx4 v[200:203], v45, s[8:11], s75 offen sc1
    buffer_load_dwordx4 v[204:207], v46, s[8:11], s75 offen sc1
    buffer_load_dwordx4 v[208:211], v47, s[8:11], s75 offen sc1
    buffer_load_dwordx4 v[212:215], v52, s[8:11], s75 offen sc1
    s_cmp_gt_i32 s62, s63
    s_cbranch_scc1 L_e4
    s_cmp_eq_i32 s62, s63
    s_cbranch_scc1 L_lw2
    s_waitcnt vmcnt(10)
L_lw2:
    s_waitcnt vmcnt(21)
    s_call_b64 s[82:83], L_pend
    s_barrier
    s_call_b64 s[82:83], L_load
    s_add_i32 s62, s62, 1
L_e4:
    s_add_u32 s75, s69, 245760
    buffer_load_dwordx4 v[216:219], v44, s[8:11], s75 offen sc1
    buffer_load_dwordx4 v[220:223], v45, s[8:11], s75 offen sc1
    buffer_load_dwordx4 v[224:227], v46, s[8:11], s75 offen sc1
    buffer_load_dwordx4 v[228:231], v47, s[8:11], s75 offen sc1
    buffer_load_dwordx4 v[232:235], v52, s[8:11], s75 offen sc1
    s_add_u32 s75, s69, 286720
    buffer_load_dwordx4 v[236:239], v44, s[8:11], s75 offen sc1
    buffer_load_dwordx4 v[240:243], v45, s[8:11], s75 offen sc1
    buffer_load_dwordx4 v[244:247], v46, s[8:11], s75 offen sc1
    buffer_load_dwordx4 v[248:251], v47, s[8:11], s75 offen sc1
    buffer_load_dwordx4 v[252:255], v52, s[8:11], s75 offen sc1
    s_cmp_gt_i32 s62, s63
    s_cbranch_scc1 L_e5
    s_cmp_eq_i32 s62, s63
    s_cbranch_scc1 L_lw3
    s_waitcnt vmcnt(10)
L_lw3:
    s_waitcnt vmcnt(21)
    s_call_b64 s[82:83], L_pend
    s_barrier
    s_call_b64 s[82:83], L_load
    s_add_i32 s62, s62, 1
L_e5:
    s_waitcnt vmcnt(40)
    v_cmp_le_i32 vcc, 0, v51
    s_cbranch_vccz L_idx_oka
    v_and_b32 v3, 7, v1
    v_lshlrev_b32 v3, 2, v3
    s_mov_b32 s72, 0x3a0000
    s_mov_b32 s79, 262144
L_poll_34:
    buffer_load_dword v51, v3, s[8:11], s72 offen sc1
    s_waitcnt vmcnt(0)
    v_cmp_le_i32 vcc, 0, v51
    s_cbranch_vccz L_polldone_35
    s_sleep 2
    s_sub_u32 s79, s79, 1
    s_cmp_lg_u32 s79, 0
    s_cbranch_scc1 L_poll_34
L_polldone_35:
L_idx_oka:
    v_and_b32 v3, 1, v1
    v_lshlrev_b32 v3, 12, v3
    v_and_b32 v2, 2, v1
    v_lshl_add_u32 v3, v2, 8, v3
    s_lshr_b32 s72, s68, 2
    s_lshl_b32 s72, s72, 6
    s_andn2_b32 s6, s4, 7
    s_add_u32 s72, s72, s6
    s_add_u32 s72, s72, s76
    s_lshl_b32 s72, s72, 7
    s_add_u32 s72, s72, 3932160
    buffer_load_dword v50, v3, s[8:11], s72 offen sc1
    s_call_b64 s[80:81], L_oprep
    s_cmp_gt_i32 s62, s63
    s_cbranch_scc1 L_e6
    s_waitcnt vmcnt(21)
    s_call_b64 s[82:83], L_pend
    s_barrier
    s_call_b64 s[82:83], L_load
    s_add_i32 s62, s62, 1
L_e6:
    s_waitcnt vmcnt(0)
    s_lshr_b32 s6, s5, 1
    s_lshl_b32 s7, s3, 4
    s_add_u32 s6, s6, s7
    s_cmp_lg_u32 s6, 2
    s_cbranch_scc1 L_yd
    s_and_b32 s6, s5, 1
    s_xor_b32 s6, s6, 1
    s_lshl_b32 s6, s6, 2
    s_lshr_b32 s87, s4, 3
    s_add_u32 s87, s87, s6
    s_and_b32 s88, s4, 7
    s_mov_b32 m0, s87
    s_nop 3
    v_readlane_b32 s85, v51, m0
    s_nop 3
    s_and_b32 s86, s85, 0x7ff
    s_sub_u32 s86, 0x7ff, s86
    v_min_u32 v3, 53, v1
    v_lshlrev_b32 v3, 5, v3
    s_mov_b32 s72, 0x3a6000
    s_mov_b32 s79, 262144
L_poll_37:
    buffer_load_dwordx4 v[16:19], v3, s[8:11], s72 offen sc1
    s_waitcnt vmcnt(0)
    v_and_b32 v16, v16, v17
    v_and_b32 v16, v16, v18
    v_and_b32 v16, v16, v19
    v_cmp_ne_u32 vcc, 1, v16
    s_cbranch_vccz L_polldone_38
    s_sleep 16
    s_sub_u32 s79, s79, 1
    s_cmp_lg_u32 s79, 0
    s_cbranch_scc1 L_poll_37
L_polldone_38:
    v_mul_u32_u24 v2, 13, v1
    v_lshrrev_b32 v2, 8, v2
    v_mul_u32_u24 v3, 20, v2
    v_sub_u32 v4, v1, v3
    s_mov_b32 s6, 368640
    v_mul_lo_u32 v2, v2, s6
    v_lshl_add_u32 v2, v4, 4, v2
    v_cmp_lt_u32 vcc, 59, v1
    v_mov_b32 v3, 0x5000000
    s_nop 0
    v_cndmask_b32 v2, v2, v3, vcc
    s_mul_i32 s6, s87, 2560
    s_mul_i32 s7, s88, 320
    s_add_u32 s6, s6, s7
    s_add_u32 s6, s6, 2686976
    buffer_load_dwordx4 v[16:19], v2, s[8:11], s6 offen sc1
    s_add_u32 s6, s6, 20480
    buffer_load_dwordx4 v[20:23], v2, s[8:11], s6 offen sc1
    s_add_u32 s6, s6, 20480
    buffer_load_dwordx4 v[24:27], v2, s[8:11], s6 offen sc1
    s_add_u32 s6, s6, 20480
    buffer_load_dwordx4 v[28:31], v2, s[8:11], s6 offen sc1
    s_add_u32 s6, s6, 20480
    buffer_load_dwordx4 v[32:35], v2, s[8:11], s6 offen sc1
    s_add_u32 s6, s6, 20480
    buffer_load_dwordx4 v[36:39], v2, s[8:11], s6 offen sc1
    s_add_u32 s6, s6, 20480
    buffer_load_dwordx4 v[40:43], v2, s[8:11], s6 offen sc1
    s_add_u32 s6, s6, 20480
    buffer_load_dwordx4 v[44:47], v2, s[8:11], s6 offen sc1
    s_add_u32 s6, s6, 20480
    buffer_load_dwordx4 v[56:59], v2, s[8:11], s6 offen sc1
    s_add_u32 s6, s6, 20480
    buffer_load_dwordx4 v[60:63], v2, s[8:11], s6 offen sc1
    s_add_u32 s6, s6, 20480
    buffer_load_dwordx4 v[64:67], v2, s[8:11], s6 offen sc1
    s_add_u32 s6, s6, 20480
    buffer_load_dwordx4 v[68:71], v2, s[8:11], s6 offen sc1
    s_add_u32 s6, s6, 20480
    buffer_load_dwordx4 v[72:75], v2, s[8:11], s6 offen sc1
    s_add_u32 s6, s6, 20480
    buffer_load_dwordx4 v[76:79], v2, s[8:11], s6 offen sc1
    s_add_u32 s6, s6, 20480
    buffer_load_dwordx4 v[80:83], v2, s[8:11], s6 offen sc1
    s_add_u32 s6, s6, 20480
    buffer_load_dwordx4 v[84:87], v2, s[8:11], s6 offen sc1
    s_add_u32 s6, s6, 20480
    buffer_load_dwordx4 v[88:91], v2, s[8:11], s6 offen sc1
    s_add_u32 s6, s6, 20480
    buffer_load_dwordx4 v[92:95], v2, s[8:11], s6 offen sc1
    s_add_u32 s6, s6, 20480
    s_lshr_b32 s6, s86, 4
    s_mul_i32 s6, s6, 20480
    s_and_b32 s7, s86, 15
    s_lshl_b32 s7, s7, 4
    s_add_u32 s6, s6, s7
    s_mul_i32 s7, s88, 2560
    s_add_u32 s6, s6, s7
    v_lshrrev_b32 v5, 1, v4
    v_lshlrev_b32 v5, 8, v5
    v_and_b32 v6, 1, v4
    v_lshl_add_u32 v5, v6, 3, v5
    buffer_load_dwordx2 v[54:55], v5, s[8:11], s6 offen sc1
    s_bfe_u32 s6, s85, 0x10000b
    s_xor_b32 s7, s6, 0xffff
    s_bitcmp1_b32 s6, 15
    s_bitset0_b32 s6, 15
    s_cselect_b32 s6, s6, s7
    s_lshl_b32 s6, s6, 16
    v_mov_b32 v5, s6
    v_mul_f32 v5, 0xbfb8aa3b, v5
    v_exp_f32 v5, v5
    s_nop 0
    v_add_f32 v5, 1.0, v5
    v_rcp_f32 v5, v5
    s_nop 0
    v_cvt_pk_bf16_f32 v5, v5, v5
    v_lshlrev_b32 v5, 16, v5
    v_lshlrev_b32 v6, 2, v1
    s_waitcnt vmcnt(0)
    v_pk_add_f32 v[16:17], v[16:17], v[20:21]
    v_pk_add_f32 v[18:19], v[18:19], v[22:23]
    v_pk_add_f32 v[16:17], v[16:17], v[24:25]
    v_pk_add_f32 v[18:19], v[18:19], v[26:27]
    v_pk_add_f32 v[16:17], v[16:17], v[28:29]
    v_pk_add_f32 v[18:19], v[18:19], v[30:31]
    v_pk_add_f32 v[16:17], v[16:17], v[32:33]
    v_pk_add_f32 v[18:19], v[18:19], v[34:35]
    v_pk_add_f32 v[16:17], v[16:17], v[36:37]
    v_pk_add_f32 v[18:19], v[18:19], v[38:39]
    v_pk_add_f32 v[16:17], v[16:17], v[40:41]
    v_pk_add_f32 v[18:19], v[18:19], v[42:43]
    v_pk_add_f32 v[16:17], v[16:17], v[44:45]
    v_pk_add_f32 v[18:19], v[18:19], v[46:47]
    v_pk_add_f32 v[16:17], v[16:17], v[56:57]
    v_pk_add_f32 v[18:19], v[18:19], v[58:59]
    v_pk_add_f32 v[16:17], v[16:17], v[60:61]
    v_pk_add_f32 v[18:19], v[18:19], v[62:63]
    v_pk_add_f32 v[16:17], v[16:17], v[64:65]
    v_pk_add_f32 v[18:19], v[18:19], v[66:67]
    v_pk_add_f32 v[16:17], v[16:17], v[68:69]
    v_pk_add_f32 v[18:19], v[18:19], v[70:71]
    v_pk_add_f32 v[16:17], v[16:17], v[72:73]
    v_pk_add_f32 v[18:19], v[18:19], v[74:75]
    v_pk_add_f32 v[16:17], v[16:17], v[76:77]
    v_pk_add_f32 v[18:19], v[18:19], v[78:79]
    v_pk_add_f32 v[16:17], v[16:17], v[80:81]
    v_pk_add_f32 v[18:19], v[18:19], v[82:83]
    v_pk_add_f32 v[16:17], v[16:17], v[84:85]
    v_pk_add_f32 v[18:19], v[18:19], v[86:87]
    v_pk_add_f32 v[16:17], v[16:17], v[88:89]
    v_pk_add_f32 v[18:19], v[18:19], v[90:91]
    v_pk_add_f32 v[16:17], v[16:17], v[92:93]
    v_pk_add_f32 v[18:19], v[18:19], v[94:95]
    ds_bpermute_b32 v20, v6, v16 offset:80
    ds_bpermute_b32 v21, v6, v17 offset:80
    ds_bpermute_b32 v22, v6, v18 offset:80
    ds_bpermute_b32 v23, v6, v19 offset:80
    ds_bpermute_b32 v24, v6, v16 offset:160
    ds_bpermute_b32 v25, v6, v17 offset:160
    ds_bpermute_b32 v26, v6, v18 offset:160
    ds_bpermute_b32 v27, v6, v19 offset:160
    s_waitcnt lgkmcnt(0)
    v_add_f32 v16, v16, v20
    v_add_f32 v16, v16, v24
    v_cvt_pk_bf16_f32 v16, v16, v16
    v_lshlrev_b32 v16, 16, v16
    v_mul_f32 v16, v16, v5
    v_cvt_pk_bf16_f32 v16, v16, v16
    v_lshlrev_b32 v16, 16, v16
    v_lshlrev_b32 v7, 16, v54
    v_add_f32 v16, v16, v7
    v_add_f32 v17, v17, v21
    v_add_f32 v17, v17, v25
    v_cvt_pk_bf16_f32 v17, v17, v17
    v_lshlrev_b32 v17, 16, v17
    v_mul_f32 v17, v17, v5
    v_cvt_pk_bf16_f32 v17, v17, v17
    v_lshlrev_b32 v17, 16, v17
    v_and_b32 v7, 0xffff0000, v54
    v_add_f32 v17, v17, v7
    v_add_f32 v18, v18, v22
    v_add_f32 v18, v18, v26
    v_cvt_pk_bf16_f32 v18, v18, v18
    v_lshlrev_b32 v18, 16, v18
    v_mul_f32 v18, v18, v5
    v_cvt_pk_bf16_f32 v18, v18, v18
    v_lshlrev_b32 v18, 16, v18
    v_lshlrev_b32 v7, 16, v55
    v_add_f32 v18, v18, v7
    v_add_f32 v19, v19, v23
    v_add_f32 v19, v19, v27
    v_cvt_pk_bf16_f32 v19, v19, v19
    v_lshlrev_b32 v19, 16, v19
    v_mul_f32 v19, v19, v5
    v_cvt_pk_bf16_f32 v19, v19, v19
    v_lshlrev_b32 v19, 16, v19
    v_and_b32 v7, 0xffff0000, v55
    v_add_f32 v19, v19, v7
    v_cvt_pk_bf16_f32 v20, v16, v17
    v_cvt_pk_bf16_f32 v21, v18, v19
    v_lshlrev_b32 v2, 3, v1
    v_cmp_lt_u32 vcc, 19, v1
    s_mul_i32 s6, s87, 1280
    s_mul_i32 s7, s88, 160
    v_cndmask_b32 v2, v2, v3, vcc
    s_add_u32 s6, s6, s7
    s_add_u32 s6, s6, 3837952
    buffer_store_dwordx2 v[20:21], v2, s[8:11], s6 offen sc1
    s_call_b64 s[80:81], L_oprep
    s_waitcnt vmcnt(0)
    s_xor_b32 s6, s5, 1
    s_lshl_b32 s6, s6, 5
    s_add_u32 s6, s6, s4
    s_lshl_b32 s6, s6, 7
    s_add_u32 s6, s6, 3899392
    v_mov_b32 v2, 1
    v_mov_b32 v3, 0x5000000
    v_writelane_b32 v3, s6, 0
    buffer_store_dword v2, v3, s[8:11], 0 offen sc1
L_yd:
    v_cmp_ne_u32 vcc, 1, v50
    s_cbranch_vccz L_ce
    v_and_b32 v3, 1, v1
    v_lshlrev_b32 v3, 12, v3
    v_and_b32 v2, 2, v1
    v_lshl_add_u32 v3, v2, 8, v3
    s_lshr_b32 s72, s68, 2
    s_lshl_b32 s72, s72, 6
    s_andn2_b32 s6, s4, 7
    s_add_u32 s72, s72, s6
    s_add_u32 s72, s72, s76
    s_lshl_b32 s72, s72, 7
    s_add_u32 s72, s72, 3932160
    s_mov_b32 s79, 262144
L_poll_39:
    buffer_load_dword v2, v3, s[8:11], s72 offen sc1
    s_waitcnt vmcnt(0)
    v_cmp_ne_u32 vcc, 1, v2
    s_cbranch_vccz L_polldone_40
    s_sleep 4
    s_sub_u32 s79, s79, 1
    s_cmp_lg_u32 s79, 0
    s_cbranch_scc1 L_poll_39
L_polldone_40:
L_ce:
    s_setprio 0
    s_barrier
    s_barrier
    s_add_u32 s65, s68, 1
    s_and_b32 s65, s65, 3
    s_andn2_b32 s7, s68, 3
    s_add_u32 s65, s65, s7
    s_lshl_b32 s65, s65, 17
    s_add_u32 s65, s65, s66
    s_add_u32 m0, s99, 0
    s_add_u32 s65, s65, 0
    buffer_load_dwordx4 v13, s[8:11], s65 offen offset:0 sc1 lds
    buffer_load_dwordx4 v13, s[8:11], s65 offen offset:1024 sc1 lds
    buffer_load_dwordx4 v13, s[8:11], s65 offen offset:2048 sc1 lds
    buffer_load_dwordx4 v13, s[8:11], s65 offen offset:3072 sc1 lds
    s_add_u32 s65, s68, 1
    s_and_b32 s65, s65, 3
    s_andn2_b32 s7, s68, 3
    s_add_u32 s65, s65, s7
    s_lshl_b32 s65, s65, 17
    s_add_u32 s65, s65, s66
    s_add_u32 m0, s99, 16384
    s_add_u32 s65, s65, 16384
    buffer_load_dwordx4 v13, s[8:11], s65 offen offset:0 sc1 lds
    buffer_load_dwordx4 v13, s[8:11], s65 offen offset:1024 sc1 lds
    buffer_load_dwordx4 v13, s[8:11], s65 offen offset:2048 sc1 lds
    buffer_load_dwordx4 v13, s[8:11], s65 offen offset:3072 sc1 lds
    s_add_u32 s65, s68, 2
    s_and_b32 s65, s65, 3
    s_andn2_b32 s7, s68, 3
    s_add_u32 s65, s65, s7
    s_lshl_b32 s65, s65, 17
    s_add_u32 s65, s65, s66
    s_add_u32 m0, s99, 32768
    s_add_u32 s65, s65, 0
    buffer_load_dwordx4 v13, s[8:11], s65 offen offset:0 sc1 lds
    buffer_load_dwordx4 v13, s[8:11], s65 offen offset:1024 sc1 lds
    buffer_load_dwordx4 v13, s[8:11], s65 offen offset:2048 sc1 lds
    buffer_load_dwordx4 v13, s[8:11], s65 offen offset:3072 sc1 lds
    s_add_u32 s65, s68, 2
    s_and_b32 s65, s65, 3
    s_andn2_b32 s7, s68, 3
    s_add_u32 s65, s65, s7
    s_lshl_b32 s65, s65, 17
    s_add_u32 s65, s65, s66
    s_add_u32 m0, s99, 49152
    s_add_u32 s65, s65, 16384
    buffer_load_dwordx4 v13, s[8:11], s65 offen offset:0 sc1 lds
    buffer_load_dwordx4 v13, s[8:11], s65 offen offset:1024 sc1 lds
    buffer_load_dwordx4 v13, s[8:11], s65 offen offset:2048 sc1 lds
    buffer_load_dwordx4 v13, s[8:11], s65 offen offset:3072 sc1 lds
    s_waitcnt vmcnt(8)
    s_branch L_adone
L_moe:
    s_add_u32 s6, s62, s5
    s_cmp_lg_u32 s6, 5
    s_cbranch_scc1 L_idle
    s_mov_b32 s12, s48
    s_mov_b32 s13, s49
    s_mov_b32 s14, 0x21c000
    s_mov_b32 s15, 0x20000
    s_cmp_ge_u32 s3, 2
    s_cselect_b32 s12, s50, s12
    s_cselect_b32 s13, s51, s13
    s_mov_b32 s16, s52
    s_mov_b32 s17, s53
    s_mov_b32 s18, 0x21c000
    s_mov_b32 s19, 0x20000
    v_lshrrev_b32 v3, 2, v1
    v_mul_u32_u24 v3, 3456, v3
    v_and_b32 v4, 3, v1
    v_lshl_add_u32 v16, v4, 4, v3
    v_lshrrev_b32 v3, 3, v1
    v_mul_u32_u24 v3, 1280, v3
    v_and_b32 v4, 7, v1
    v_lshl_add_u32 v18, v4, 4, v3
    s_and_b32 s7, s3, 1
    s_mul_i32 s84, s7, 1105920
    s_lshl_b32 s6, s61, 6
    s_add_u32 s84, s84, s6
    s_lshl_b32 s85, s3, 13
    s_add_u32 s85, s85, 131072
    s_mul_i32 s86, s61, 40960
    s_lshl_b32 s6, s3, 7
    s_add_u32 s86, s86, s6
    s_add_u32 m0, s85, 0
    s_nop 0
    buffer_load_dwordx4 v16, s[12:15], s84 offen lds
    s_add_u32 s84, s84, 55296
    s_add_u32 m0, s85, 1024
    s_nop 0
    buffer_load_dwordx4 v16, s[12:15], s84 offen lds
    s_add_u32 s84, s84, 55296
    s_add_u32 m0, s85, 2048
    s_nop 0
    buffer_load_dwordx4 v16, s[12:15], s84 offen lds
    s_add_u32 s84, s84, 55296
    s_add_u32 m0, s85, 3072
    s_nop 0
    buffer_load_dwordx4 v16, s[12:15], s84 offen lds
    s_add_u32 s84, s84, 55296
    s_add_u32 m0, s85, 4096
    s_nop 0
    buffer_load_dwordx4 v16, s[12:15], s84 offen lds
    s_add_u32 s84, s84, 55296
    s_add_u32 m0, s85, 5120
    s_nop 0
    buffer_load_dwordx4 v16, s[12:15], s84 offen lds
    s_add_u32 s84, s84, 55296
    s_add_u32 m0, s85, 6144
    s_nop 0
    buffer_load_dwordx4 v16, s[12:15], s84 offen lds
    s_add_u32 s84, s84, 55296
    s_add_u32 m0, s85, 7168
    s_nop 0
    buffer_load_dwordx4 v16, s[12:15], s84 offen lds
    s_add_u32 s84, s84, 55296
    v_and_b32 v3, 7, v1
    v_lshlrev_b32 v3, 2, v3
    s_mov_b32 s72, 0x3a0000
    buffer_load_dword v51, v3, s[8:11], s72 offen sc1
    v_lshrrev_b32 v7, 4, v1
    v_and_b32 v2, 15, v1
    v_lshrrev_b32 v3, 2, v2
    v_lshl_add_u32 v8, v7, 3, v3
    v_lshlrev_b32 v8, 6, v8
    v_and_b32 v4, 3, v2
    v_lshl_add_u32 v8, v4, 3, v8
    v_add_u32 v17, s85, v8
    v_lshl_add_u32 v8, v7, 2, v3
    v_lshlrev_b32 v8, 7, v8
    v_lshl_add_u32 v8, v4, 3, v8
    s_add_u32 s6, s85, 4096
    v_add_u32 v19, s6, v8
    v_mul_u32_u24 v3, 2560, v2
    v_lshl_add_u32 v3, v7, 4, v3
    v_mov_b32 v4, 0x5000000
    v_cmp_gt_u32 vcc, 8, v2
    s_mul_i32 s87, s61, 20480
    s_lshl_b32 s7, s3, 8
    s_add_u32 s87, s87, s7
    s_add_u32 s87, s87, 2686976
    v_cndmask_b32 v20, v4, v3, vcc
    s_waitcnt vmcnt(0) lgkmcnt(0)
    s_call_b64 s[82:83], L_pend
    s_barrier
    s_call_b64 s[82:83], L_load
    s_add_i32 s62, s62, 1
    ds_read_b64_tr_b16 v[104:105], v17 offset:0
    ds_read_b64_tr_b16 v[106:107], v17 offset:256
    ds_read_b64_tr_b16 v[108:109], v17 offset:32
    ds_read_b64_tr_b16 v[110:111], v17 offset:288
    ds_read_b64_tr_b16 v[112:113], v17 offset:2048
    ds_read_b64_tr_b16 v[114:115], v17 offset:2304
    ds_read_b64_tr_b16 v[116:117], v17 offset:2080
    ds_read_b64_tr_b16 v[118:119], v17 offset:2336
    s_waitcnt lgkmcnt(0)
    ds_read_b64_tr_b16 v[120:121], v17 offset:4096
    ds_read_b64_tr_b16 v[122:123], v17 offset:4352
    ds_read_b64_tr_b16 v[124:125], v17 offset:4128
    ds_read_b64_tr_b16 v[126:127], v17 offset:4384
    ds_read_b64_tr_b16 v[128:129], v17 offset:6144
    ds_read_b64_tr_b16 v[130:131], v17 offset:6400
    ds_read_b64_tr_b16 v[132:133], v17 offset:6176
    ds_read_b64_tr_b16 v[134:135], v17 offset:6432
    v_cmp_le_i32 vcc, 0, v51
    s_cbranch_vccz L_idx_okm
    v_and_b32 v3, 7, v1
    v_lshlrev_b32 v3, 2, v3
    s_mov_b32 s72, 0x3a0000
    s_mov_b32 s79, 262144
L_poll_42:
    buffer_load_dword v51, v3, s[8:11], s72 offen sc1
    s_waitcnt vmcnt(0)
    v_cmp_le_i32 vcc, 0, v51
    s_cbranch_vccz L_polldone_43
    s_sleep 2
    s_sub_u32 s79, s79, 1
    s_cmp_lg_u32 s79, 0
    s_cbranch_scc1 L_poll_42
L_polldone_43:
L_idx_okm:
    s_waitcnt lgkmcnt(0)
    s_add_u32 m0, s85, 0
    s_nop 0
    buffer_load_dwordx4 v16, s[12:15], s84 offen lds
    s_add_u32 s84, s84, 55296
    s_add_u32 m0, s85, 1024
    s_nop 0
    buffer_load_dwordx4 v16, s[12:15], s84 offen lds
    s_add_u32 s84, s84, 55296
    s_add_u32 m0, s85, 2048
    s_nop 0
    buffer_load_dwordx4 v16, s[12:15], s84 offen lds
    s_add_u32 s84, s84, 55296
    s_add_u32 m0, s85, 3072
    s_nop 0
    buffer_load_dwordx4 v16, s[12:15], s84 offen lds
    s_add_u32 s84, s84, 55296
    s_add_u32 m0, s85, 4096
    s_nop 0
    buffer_load_dwordx4 v16, s[12:15], s84 offen lds
    s_add_u32 s84, s84, 55296
    s_add_u32 m0, s85, 5120
    s_nop 0
    buffer_load_dwordx4 v16, s[12:15], s84 offen lds
    s_add_u32 s84, s84, 55296
    s_add_u32 m0, s85, 6144
    s_nop 0
    buffer_load_dwordx4 v16, s[12:15], s84 offen lds
    s_add_u32 s84, s84, 55296
    s_add_u32 m0, s85, 7168
    s_nop 0
    buffer_load_dwordx4 v16, s[12:15], s84 offen lds
    s_add_u32 s84, s84, 55296
    v_and_b32 v4, 0x7ff, v51
    v_sub_u32 v4, 0x7ff, v4
    v_mul_u32_u24 v4, 1280, v4
    v_lshrrev_b32 v7, 4, v1
    v_lshl_add_u32 v4, v7, 4, v4
    s_and_b32 s7, s3, 1
    s_mul_i32 s6, s7, 640
    s_add_u32 s6, s6, 12582912
    v_add_u32 v4, s6, v4
    v_mov_b32 v5, 0x5000000
    v_and_b32 v2, 8, v1
    v_cmp_eq_u32 vcc, 0, v2
    s_nop 1
    v_cndmask_b32 v21, v5, v4, vcc
    buffer_load_dwordx4 v[64:67], v21, s[8:11], 0 offen offset:0 sc1
    buffer_load_dwordx4 v[68:71], v21, s[8:11], 0 offen offset:64 sc1
    buffer_load_dwordx4 v[72:75], v21, s[8:11], 0 offen offset:128 sc1
    buffer_load_dwordx4 v[76:79], v21, s[8:11], 0 offen offset:192 sc1
    buffer_load_dwordx4 v[80:83], v21, s[8:11], 0 offen offset:256 sc1
    s_waitcnt vmcnt(5) lgkmcnt(0)
    s_call_b64 s[82:83], L_pend
    s_barrier
    s_call_b64 s[82:83], L_load
    s_add_i32 s62, s62, 1
    ds_read_b64_tr_b16 v[136:137], v17 offset:0
    ds_read_b64_tr_b16 v[138:139], v17 offset:256
    ds_read_b64_tr_b16 v[140:141], v17 offset:32
    ds_read_b64_tr_b16 v[142:143], v17 offset:288
    ds_read_b64_tr_b16 v[144:145], v17 offset:2048
    ds_read_b64_tr_b16 v[146:147], v17 offset:2304
    ds_read_b64_tr_b16 v[148:149], v17 offset:2080
    ds_read_b64_tr_b16 v[150:151], v17 offset:2336
    s_waitcnt lgkmcnt(0)
    ds_read_b64_tr_b16 v[152:153], v17 offset:4096
    ds_read_b64_tr_b16 v[154:155], v17 offset:4352
    ds_read_b64_tr_b16 v[156:157], v17 offset:4128
    ds_read_b64_tr_b16 v[158:159], v17 offset:4384
    ds_read_b64_tr_b16 v[160:161], v17 offset:6144
    ds_read_b64_tr_b16 v[162:163], v17 offset:6400
    ds_read_b64_tr_b16 v[164:165], v17 offset:6176
    ds_read_b64_tr_b16 v[166:167], v17 offset:6432
    s_waitcnt lgkmcnt(0)
    s_add_u32 m0, s85, 0
    s_nop 0
    buffer_load_dwordx4 v16, s[12:15], s84 offen lds
    s_add_u32 s84, s84, 55296
    s_add_u32 m0, s85, 1024
    s_nop 0
    buffer_load_dwordx4 v16, s[12:15], s84 offen lds
    s_add_u32 s84, s84, 55296
    s_add_u32 m0, s85, 2048
    s_nop 0
    buffer_load_dwordx4 v16, s[12:15], s84 offen lds
    s_add_u32 s84, s84, 55296
    s_add_u32 m0, s85, 3072
    s_nop 0
    buffer_load_dwordx4 v16, s[12:15], s84 offen lds
    s_add_u32 s84, s84, 55296
    s_add_u32 m0, s85, 4096
    s_add_u32 s6, s86, 0
    buffer_load_dwordx4 v18, s[16:19], s6 offen lds
    s_add_u32 m0, s85, 5120
    s_add_u32 s6, s86, 10240
    buffer_load_dwordx4 v18, s[16:19], s6 offen lds
    s_add_u32 m0, s85, 6144
    s_add_u32 s6, s86, 20480
    buffer_load_dwordx4 v18, s[16:19], s6 offen lds
    s_add_u32 m0, s85, 7168
    s_add_u32 s6, s86, 30720
    buffer_load_dwordx4 v18, s[16:19], s6 offen lds
    s_add_u32 s86, s86, 512
    buffer_load_dwordx4 v[84:87], v21, s[8:11], 0 offen offset:320 sc1
    buffer_load_dwordx4 v[88:91], v21, s[8:11], 0 offen offset:384 sc1
    buffer_load_dwordx4 v[92:95], v21, s[8:11], 0 offen offset:448 sc1
    buffer_load_dwordx4 v[96:99], v21, s[8:11], 0 offen offset:512 sc1
    buffer_load_dwordx4 v[100:103], v21, s[8:11], 0 offen offset:576 sc1
    s_waitcnt vmcnt(0) lgkmcnt(0)
    s_call_b64 s[82:83], L_pend
    s_barrier
    s_call_b64 s[82:83], L_load
    s_add_i32 s62, s62, 1
    ds_read_b64_tr_b16 v[168:169], v17 offset:0
    ds_read_b64_tr_b16 v[170:171], v17 offset:256
    ds_read_b64_tr_b16 v[172:173], v17 offset:32
    ds_read_b64_tr_b16 v[174:175], v17 offset:288
    ds_read_b64_tr_b16 v[176:177], v17 offset:2048
    ds_read_b64_tr_b16 v[178:179], v17 offset:2304
    ds_read_b64_tr_b16 v[180:181], v17 offset:2080
    ds_read_b64_tr_b16 v[182:183], v17 offset:2336
    s_waitcnt lgkmcnt(0)
    ds_read_b64_tr_b16 v[32:33], v19 offset:0
    ds_read_b64_tr_b16 v[34:35], v19 offset:2048
    ds_read_b64_tr_b16 v[36:37], v19 offset:32
    ds_read_b64_tr_b16 v[38:39], v19 offset:2080
    ds_read_b64_tr_b16 v[40:41], v19 offset:64
    ds_read_b64_tr_b16 v[42:43], v19 offset:2112
    ds_read_b64_tr_b16 v[44:45], v19 offset:96
    ds_read_b64_tr_b16 v[46:47], v19 offset:2144
    s_waitcnt lgkmcnt(0)
    s_add_u32 m0, s85, 4096
    s_add_u32 s6, s86, 0
    buffer_load_dwordx4 v18, s[16:19], s6 offen lds
    s_add_u32 m0, s85, 5120
    s_add_u32 s6, s86, 10240
    buffer_load_dwordx4 v18, s[16:19], s6 offen lds
    s_add_u32 m0, s85, 6144
    s_add_u32 s6, s86, 20480
    buffer_load_dwordx4 v18, s[16:19], s6 offen lds
    s_add_u32 m0, s85, 7168
    s_add_u32 s6, s86, 30720
    buffer_load_dwordx4 v18, s[16:19], s6 offen lds
    s_add_u32 s86, s86, 512
    v_mfma_f32_16x16x32_bf16 v[24:27], v[104:107], v[64:67], 0
    v_mfma_f32_16x16x32_bf16 v[28:31], v[108:111], v[64:67], 0
    v_mfma_f32_16x16x32_bf16 v[24:27], v[112:115], v[68:71], v[24:27]
    v_mfma_f32_16x16x32_bf16 v[28:31], v[116:119], v[68:71], v[28:31]
    v_mfma_f32_16x16x32_bf16 v[24:27], v[120:123], v[72:75], v[24:27]
    v_mfma_f32_16x16x32_bf16 v[28:31], v[124:127], v[72:75], v[28:31]
    v_mfma_f32_16x16x32_bf16 v[24:27], v[128:131], v[76:79], v[24:27]
    v_mfma_f32_16x16x32_bf16 v[28:31], v[132:135], v[76:79], v[28:31]
    v_mfma_f32_16x16x32_bf16 v[24:27], v[136:139], v[80:83], v[24:27]
    v_mfma_f32_16x16x32_bf16 v[28:31], v[140:143], v[80:83], v[28:31]
    v_mfma_f32_16x16x32_bf16 v[24:27], v[144:147], v[84:87], v[24:27]
    v_mfma_f32_16x16x32_bf16 v[28:31], v[148:151], v[84:87], v[28:31]
    v_mfma_f32_16x16x32_bf16 v[24:27], v[152:155], v[88:91], v[24:27]
    v_mfma_f32_16x16x32_bf16 v[28:31], v[156:159], v[88:91], v[28:31]
    v_mfma_f32_16x16x32_bf16 v[24:27], v[160:163], v[92:95], v[24:27]
    v_mfma_f32_16x16x32_bf16 v[28:31], v[164:167], v[92:95], v[28:31]
    v_mfma_f32_16x16x32_bf16 v[24:27], v[168:171], v[96:99], v[24:27]
    v_mfma_f32_16x16x32_bf16 v[28:31], v[172:175], v[96:99], v[28:31]
    v_mfma_f32_16x16x32_bf16 v[24:27], v[176:179], v[100:103], v[24:27]
    v_mfma_f32_16x16x32_bf16 v[28:31], v[180:183], v[100:103], v[28:31]
    v_add_u32 v10, s85, v13
    s_nop 7
    ds_write_b128 v10, v[24:27]
    ds_write_b128 v10, v[28:31] offset:1024
    s_waitcnt vmcnt(0) lgkmcnt(0)
    s_call_b64 s[82:83], L_pend
    s_barrier
    s_call_b64 s[82:83], L_load
    s_add_i32 s62, s62, 1
    v_add_u32 v10, 131072, v13
    ds_read_b128 v[184:187], v10 offset:0
    ds_read_b128 v[188:191], v10 offset:1024
    ds_read_b128 v[192:195], v10 offset:8192
    ds_read_b128 v[196:199], v10 offset:9216
    ds_read_b128 v[200:203], v10 offset:16384
    ds_read_b128 v[204:207], v10 offset:17408
    ds_read_b128 v[208:211], v10 offset:24576
    ds_read_b128 v[212:215], v10 offset:25600
    s_waitcnt lgkmcnt(0)
    ds_read_b64_tr_b16 v[240:241], v19 offset:0
    ds_read_b64_tr_b16 v[242:243], v19 offset:2048
    ds_read_b64_tr_b16 v[244:245], v19 offset:32
    ds_read_b64_tr_b16 v[246:247], v19 offset:2080
    ds_read_b64_tr_b16 v[248:249], v19 offset:64
    ds_read_b64_tr_b16 v[250:251], v19 offset:2112
    ds_read_b64_tr_b16 v[252:253], v19 offset:96
    ds_read_b64_tr_b16 v[254:255], v19 offset:2144
    s_waitcnt lgkmcnt(0)
    s_cmp_ge_u32 s3, 2
    s_cbranch_scc1 L_moe4b
    s_add_u32 m0, s85, 4096
    s_add_u32 s6, s86, 0
    buffer_load_dwordx4 v18, s[16:19], s6 offen lds
    s_add_u32 m0, s85, 5120
    s_add_u32 s6, s86, 10240
    buffer_load_dwordx4 v18, s[16:19], s6 offen lds
    s_add_u32 m0, s85, 6144
    s_add_u32 s6, s86, 20480
    buffer_load_dwordx4 v18, s[16:19], s6 offen lds
    s_add_u32 m0, s85, 7168
    s_add_u32 s6, s86, 30720
    buffer_load_dwordx4 v18, s[16:19], s6 offen lds
    s_add_u32 s86, s86, 512
L_moe4b:
    s_mov_b32 s6, 0xbfb8aa3b
    v_add_f32 v184, v184, v192
    v_add_f32 v200, v200, v208
    v_cvt_pk_bf16_f32 v184, v184, v184
    v_lshlrev_b32 v184, 16, v184
    v_cvt_pk_bf16_f32 v200, v200, v200
    v_lshlrev_b32 v200, 16, v200
    v_mul_f32 v2, s6, v184
    v_exp_f32 v2, v2
    s_nop 0
    v_add_f32 v2, 1.0, v2
    v_rcp_f32 v2, v2
    s_nop 0
    v_mul_f32 v184, v184, v2
    v_cvt_pk_bf16_f32 v184, v184, v184
    v_lshlrev_b32 v184, 16, v184
    v_mul_f32 v184, v184, v200
    v_add_f32 v185, v185, v193
    v_add_f32 v201, v201, v209
    v_cvt_pk_bf16_f32 v185, v185, v185
    v_lshlrev_b32 v185, 16, v185
    v_cvt_pk_bf16_f32 v201, v201, v201
    v_lshlrev_b32 v201, 16, v201
    v_mul_f32 v2, s6, v185
    v_exp_f32 v2, v2
    s_nop 0
    v_add_f32 v2, 1.0, v2
    v_rcp_f32 v2, v2
    s_nop 0
    v_mul_f32 v185, v185, v2
    v_cvt_pk_bf16_f32 v185, v185, v185
    v_lshlrev_b32 v185, 16, v185
    v_mul_f32 v185, v185, v201
    v_add_f32 v186, v186, v194
    v_add_f32 v202, v202, v210
    v_cvt_pk_bf16_f32 v186, v186, v186
    v_lshlrev_b32 v186, 16, v186
    v_cvt_pk_bf16_f32 v202, v202, v202
    v_lshlrev_b32 v202, 16, v202
    v_mul_f32 v2, s6, v186
    v_exp_f32 v2, v2
    s_nop 0
    v_add_f32 v2, 1.0, v2
    v_rcp_f32 v2, v2
    s_nop 0
    v_mul_f32 v186, v186, v2
    v_cvt_pk_bf16_f32 v186, v186, v186
    v_lshlrev_b32 v186, 16, v186
    v_mul_f32 v186, v186, v202
    v_add_f32 v187, v187, v195
    v_add_f32 v203, v203, v211
    v_cvt_pk_bf16_f32 v187, v187, v187
    v_lshlrev_b32 v187, 16, v187
    v_cvt_pk_bf16_f32 v203, v203, v203
    v_lshlrev_b32 v203, 16, v203
    v_mul_f32 v2, s6, v187
    v_exp_f32 v2, v2
    s_nop 0
    v_add_f32 v2, 1.0, v2
    v_rcp_f32 v2, v2
    s_nop 0
    v_mul_f32 v187, v187, v2
    v_cvt_pk_bf16_f32 v187, v187, v187
    v_lshlrev_b32 v187, 16, v187
    v_mul_f32 v187, v187, v203
    v_add_f32 v188, v188, v196
    v_add_f32 v204, v204, v212
    v_cvt_pk_bf16_f32 v188, v188, v188
    v_lshlrev_b32 v188, 16, v188
    v_cvt_pk_bf16_f32 v204, v204, v204
    v_lshlrev_b32 v204, 16, v204
    v_mul_f32 v2, s6, v188
    v_exp_f32 v2, v2
    s_nop 0
    v_add_f32 v2, 1.0, v2
    v_rcp_f32 v2, v2
    s_nop 0
    v_mul_f32 v188, v188, v2
    v_cvt_pk_bf16_f32 v188, v188, v188
    v_lshlrev_b32 v188, 16, v188
    v_mul_f32 v188, v188, v204
    v_add_f32 v189, v189, v197
    v_add_f32 v205, v205, v213
    v_cvt_pk_bf16_f32 v189, v189, v189
    v_lshlrev_b32 v189, 16, v189
    v_cvt_pk_bf16_f32 v205, v205, v205
    v_lshlrev_b32 v205, 16, v205
    v_mul_f32 v2, s6, v189
    v_exp_f32 v2, v2
    s_nop 0
    v_add_f32 v2, 1.0, v2
    v_rcp_f32 v2, v2
    s_nop 0
    v_mul_f32 v189, v189, v2
    v_cvt_pk_bf16_f32 v189, v189, v189
    v_lshlrev_b32 v189, 16, v189
    v_mul_f32 v189, v189, v205
    v_add_f32 v190, v190, v198
    v_add_f32 v206, v206, v214
    v_cvt_pk_bf16_f32 v190, v190, v190
    v_lshlrev_b32 v190, 16, v190
    v_cvt_pk_bf16_f32 v206, v206, v206
    v_lshlrev_b32 v206, 16, v206
    v_mul_f32 v2, s6, v190
    v_exp_f32 v2, v2
    s_nop 0
    v_add_f32 v2, 1.0, v2
    v_rcp_f32 v2, v2
    s_nop 0
    v_mul_f32 v190, v190, v2
    v_cvt_pk_bf16_f32 v190, v190, v190
    v_lshlrev_b32 v190, 16, v190
    v_mul_f32 v190, v190, v206
    v_add_f32 v191, v191, v199
    v_add_f32 v207, v207, v215
    v_cvt_pk_bf16_f32 v191, v191, v191
    v_lshlrev_b32 v191, 16, v191
    v_cvt_pk_bf16_f32 v207, v207, v207
    v_lshlrev_b32 v207, 16, v207
    v_mul_f32 v2, s6, v191
    v_exp_f32 v2, v2
    s_nop 0
    v_add_f32 v2, 1.0, v2
    v_rcp_f32 v2, v2
    s_nop 0
    v_mul_f32 v191, v191, v2
    v_cvt_pk_bf16_f32 v191, v191, v191
    v_lshlrev_b32 v191, 16, v191
    v_mul_f32 v191, v191, v207
    v_cvt_pk_bf16_f32 v24, v184, v185
    v_cvt_pk_bf16_f32 v25, v186, v187
    v_cvt_pk_bf16_f32 v26, v188, v189
    v_cvt_pk_bf16_f32 v27, v190, v191
    s_nop 1
    v_mfma_f32_16x16x32_bf16 v[216:219], v[32:35], v[24:27], 0
    v_mfma_f32_16x16x32_bf16 v[220:223], v[36:39], v[24:27], 0
    v_mfma_f32_16x16x32_bf16 v[224:227], v[40:43], v[24:27], 0
    v_mfma_f32_16x16x32_bf16 v[228:231], v[44:47], v[24:27], 0
    s_nop 7
    buffer_store_dwordx4 v[216:219], v20, s[8:11], s87 offen offset:0 sc1
    buffer_store_dwordx4 v[220:223], v20, s[8:11], s87 offen offset:64 sc1
    buffer_store_dwordx4 v[224:227], v20, s[8:11], s87 offen offset:128 sc1
    buffer_store_dwordx4 v[228:231], v20, s[8:11], s87 offen offset:192 sc1
    s_nop 1
    s_waitcnt vmcnt(4) lgkmcnt(0)
    s_call_b64 s[82:83], L_pend
    s_barrier
    s_call_b64 s[82:83], L_load
    s_add_i32 s62, s62, 1
    v_mfma_f32_16x16x32_bf16 v[216:219], v[240:243], v[24:27], 0
    v_mfma_f32_16x16x32_bf16 v[220:223], v[244:247], v[24:27], 0
    v_mfma_f32_16x16x32_bf16 v[224:227], v[248:251], v[24:27], 0
    v_mfma_f32_16x16x32_bf16 v[228:231], v[252:255], v[24:27], 0
    s_nop 7
    buffer_store_dwordx4 v[216:219], v20, s[8:11], s87 offen offset:1024 sc1
    buffer_store_dwordx4 v[220:223], v20, s[8:11], s87 offen offset:1088 sc1
    buffer_store_dwordx4 v[224:227], v20, s[8:11], s87 offen offset:1152 sc1
    buffer_store_dwordx4 v[228:231], v20, s[8:11], s87 offen offset:1216 sc1
    s_nop 1
    s_cmp_ge_u32 s3, 2
    s_cbranch_scc1 L_moe5b
    ds_read_b64_tr_b16 v[32:33], v19 offset:0
    ds_read_b64_tr_b16 v[34:35], v19 offset:2048
    ds_read_b64_tr_b16 v[36:37], v19 offset:32
    ds_read_b64_tr_b16 v[38:39], v19 offset:2080
    ds_read_b64_tr_b16 v[40:41], v19 offset:64
    ds_read_b64_tr_b16 v[42:43], v19 offset:2112
    ds_read_b64_tr_b16 v[44:45], v19 offset:96
    ds_read_b64_tr_b16 v[46:47], v19 offset:2144
    s_waitcnt lgkmcnt(0)
    v_mfma_f32_16x16x32_bf16 v[216:219], v[32:35], v[24:27], 0
    v_mfma_f32_16x16x32_bf16 v[220:223], v[36:39], v[24:27], 0
    v_mfma_f32_16x16x32_bf16 v[224:227], v[40:43], v[24:27], 0
    v_mfma_f32_16x16x32_bf16 v[228:231], v[44:47], v[24:27], 0
    s_nop 7
    buffer_store_dwordx4 v[216:219], v20, s[8:11], s87 offen offset:2048 sc1
    buffer_store_dwordx4 v[220:223], v20, s[8:11], s87 offen offset:2112 sc1
    buffer_store_dwordx4 v[224:227], v20, s[8:11], s87 offen offset:2176 sc1
    buffer_store_dwordx4 v[228:231], v20, s[8:11], s87 offen offset:2240 sc1
    s_nop 1
L_moe5b:
    s_waitcnt vmcnt(4) lgkmcnt(0)
    s_call_b64 s[82:83], L_pend
    s_barrier
    s_waitcnt vmcnt(0)
    s_lshl_b32 s6, s61, 3
    s_add_u32 s6, s6, s3
    s_lshl_b32 s6, s6, 2
    s_add_u32 s6, s6, 3825664
    v_mov_b32 v2, 1
    v_mov_b32 v3, 0x5000000
    v_writelane_b32 v3, s6, 0
    buffer_store_dword v2, v3, s[8:11], 0 offen sc1
    s_call_b64 s[82:83], L_load
    s_add_i32 s62, s62, 1
    s_branch L_idle
L_top:
    s_mov_b32 s6, 0x280000
    s_mov_b32 s7, 0x281000
    buffer_load_dwordx4 v[64:67], v13, s[8:11], s6 offen offset:0 sc1
    buffer_load_dwordx4 v[68:71], v13, s[8:11], s6 offen offset:1024 sc1
    buffer_load_dwordx4 v[72:75], v13, s[8:11], s6 offen offset:2048 sc1
    buffer_load_dwordx4 v[76:79], v13, s[8:11], s6 offen offset:3072 sc1
    buffer_load_dwordx4 v[80:83], v13, s[8:11], s7 offen offset:0 sc1
    buffer_load_dwordx4 v[84:87], v13, s[8:11], s7 offen offset:1024 sc1
    buffer_load_dwordx4 v[88:91], v13, s[8:11], s7 offen offset:2048 sc1
    buffer_load_dwordx4 v[92:95], v13, s[8:11], s7 offen offset:3072 sc1
    s_waitcnt vmcnt(0)
    v_mov_b32 v24, 0
    s_mov_b32 s7, 0
    s_mov_b32 s84, 0
L_top_l:
    v_max3_u32 v4, v64, v65, v66
    v_max3_u32 v5, v67, v68, v69
    v_max3_u32 v4, v4, v70, v71
    v_max3_u32 v5, v5, v72, v73
    v_max3_u32 v4, v4, v74, v75
    v_max3_u32 v5, v5, v76, v77
    v_max3_u32 v4, v4, v78, v79
    v_max3_u32 v5, v5, v80, v81
    v_max3_u32 v4, v4, v82, v83
    v_max3_u32 v5, v5, v84, v85
    v_max3_u32 v4, v4, v86, v87
    v_max3_u32 v5, v5, v88, v89
    v_max3_u32 v4, v4, v90, v91
    v_max3_u32 v5, v5, v92, v93
    v_max3_u32 v4, v4, v94, v95
    v_max_u32 v4, v4, v5
    s_nop 1
    v_max_u32_dpp v4, v4, v4 quad_perm:[1,0,3,2] row_mask:0xf bank_mask:0xf
    s_nop 1
    v_max_u32_dpp v4, v4, v4 quad_perm:[2,3,0,1] row_mask:0xf bank_mask:0xf
    s_nop 1
    v_max_u32_dpp v4, v4, v4 row_half_mirror row_mask:0xf bank_mask:0xf
    s_nop 1
    v_max_u32_dpp v4, v4, v4 row_mirror row_mask:0xf bank_mask:0xf
    s_nop 1
    v_max_u32_dpp v4, v4, v4 row_bcast:15 row_mask:0xa bank_mask:0xf
    s_nop 1
    v_max_u32_dpp v4, v4, v4 row_bcast:31 row_mask:0xc bank_mask:0xf
    s_nop 1
    v_readlane_b32 s6, v4, 63
    s_mov_b32 m0, s7
    s_nop 3
    s_add_u32 s84, s84, s6
    v_writelane_b32 v24, s84, m0
    v_subrev_u32 v64, s6, v64
    v_subrev_u32 v65, s6, v65
    v_subrev_u32 v66, s6, v66
    v_subrev_u32 v67, s6, v67
    v_subrev_u32 v68, s6, v68
    v_subrev_u32 v69, s6, v69
    v_subrev_u32 v70, s6, v70
    v_subrev_u32 v71, s6, v71
    v_subrev_u32 v72, s6, v72
    v_subrev_u32 v73, s6, v73
    v_subrev_u32 v74, s6, v74
    v_subrev_u32 v75, s6, v75
    v_subrev_u32 v76, s6, v76
    v_subrev_u32 v77, s6, v77
    v_subrev_u32 v78, s6, v78
    v_subrev_u32 v79, s6, v79
    v_subrev_u32 v80, s6, v80
    v_subrev_u32 v81, s6, v81
    v_subrev_u32 v82, s6, v82
    v_subrev_u32 v83, s6, v83
    v_subrev_u32 v84, s6, v84
    v_subrev_u32 v85, s6, v85
    v_subrev_u32 v86, s6, v86
    v_subrev_u32 v87, s6, v87
    v_subrev_u32 v88, s6, v88
    v_subrev_u32 v89, s6, v89
    v_subrev_u32 v90, s6, v90
    v_subrev_u32 v91, s6, v91
    v_subrev_u32 v92, s6, v92
    v_subrev_u32 v93, s6, v93
    v_subrev_u32 v94, s6, v94
    v_subrev_u32 v95, s6, v95
    s_add_u32 s7, s7, 1
    s_cmp_lt_u32 s7, 8
    s_cbranch_scc1 L_top_l
    v_or_b32 v24, 0x80000000, v24
    v_lshlrev_b32 v5, 2, v1
    v_mov_b32 v6, 0x5000000
    v_cmp_gt_u32 vcc, 8, v1
    s_mov_b32 s6, 0x3a0000
    s_nop 0
    v_cndmask_b32 v5, v6, v5, vcc
    buffer_store_dword v24, v5, s[8:11], s6 offen sc1
    s_branch L_idle
L_back_13_h:
    v_cmp_nge_f32 vcc, s72, v62
    s_cbranch_vccz L_back_13_n
    s_call_b64 s[80:81], L_rare0
L_back_13_n:
    s_branch L_back_13
L_back_14_h:
    v_cmp_nge_f32 vcc, s72, v62
    s_cbranch_vccz L_back_14_n
    s_call_b64 s[80:81], L_rare1
    v_exp_f32 v58, v64
    v_exp_f32 v59, v65
    s_nop 0
    v_add_f32 v52, v58, v59
    v_cvt_pk_bf16_f32 v128, v58, v59
L_back_14_n:
    s_cmp_lt_i32 s64, 0
    s_cbranch_scc1 L_tail1
    s_cmp_gt_i32 s64, 0
    s_cbranch_scc1 L_back_14
    s_call_b64 s[82:83], L_mask
    s_branch L_back_14
L_back_15_h:
    v_cmp_nge_f32 vcc, s72, v62
    s_cbranch_vccz L_back_15_n
    s_call_b64 s[80:81], L_rare0
    v_exp_f32 v58, v80
    v_exp_f32 v59, v81
    s_nop 0
    v_add_f32 v54, v58, v59
    v_cvt_pk_bf16_f32 v136, v58, v59
L_back_15_n:
    s_cmp_lt_i32 s64, 0
    s_cbranch_scc1 L_tail2
    s_cmp_gt_i32 s64, 0
    s_cbranch_scc1 L_back_15
    s_call_b64 s[82:83], L_mask
    s_branch L_back_15
L_back_16_h:
    v_cmp_nge_f32 vcc, s72, v62
    s_cbranch_vccz L_back_16_n
    s_call_b64 s[80:81], L_rare1
    v_exp_f32 v58, v64
    v_exp_f32 v59, v65
    s_nop 0
    v_add_f32 v52, v58, v59
    v_cvt_pk_bf16_f32 v128, v58, v59
L_back_16_n:
    s_cmp_lt_i32 s64, 0
    s_cbranch_scc1 L_tail3
    s_cmp_gt_i32 s64, 0
    s_cbranch_scc1 L_back_16
    s_call_b64 s[82:83], L_mask
    s_branch L_back_16
L_ldback_17_c:
    s_waitcnt vmcnt(0) lgkmcnt(0)
    s_call_b64 s[82:83], L_pend
    s_barrier
    s_call_b64 s[82:83], L_load
    s_branch L_ldback_17
L_back_18_h:
    v_cmp_nge_f32 vcc, s72, v62
    s_cbranch_vccz L_back_18_n
    s_call_b64 s[80:81], L_rare0
    v_exp_f32 v58, v80
    v_exp_f32 v59, v81
    s_nop 0
    v_add_f32 v54, v58, v59
    v_cvt_pk_bf16_f32 v136, v58, v59
L_back_18_n:
    s_cmp_lt_i32 s64, 0
    s_cbranch_scc1 L_tail0
    s_cmp_gt_i32 s64, 0
    s_cbranch_scc1 L_back_18
    s_call_b64 s[82:83], L_mask
    s_branch L_back_18
L_back_19_h:
    v_cmp_nge_f32 vcc, s72, v62
    s_cbranch_vccz L_back_19_n
    s_call_b64 s[80:81], L_rare1
L_back_19_n:
    s_branch L_back_19
L_back_20_h:
    v_cmp_nge_f32 vcc, s72, v62
    s_cbranch_vccz L_back_20_n
    s_call_b64 s[80:81], L_rare0
L_back_20_n:
    s_branch L_back_20
L_back_21_h:
    v_cmp_nge_f32 vcc, s72, v62
    s_cbranch_vccz L_back_21_n
    s_call_b64 s[80:81], L_rare1
L_back_21_n:
    s_branch L_back_21
L_back_24_h:
    v_cmp_nge_f32 vcc, s72, v62
    s_cbranch_vccz L_back_24_n
    s_call_b64 s[80:81], L_rare0
L_back_24_n:
    s_branch L_back_24
L_load:
    s_bitcmp1_b32 s89, 0
    s_cbranch_scc0 L_load_r
    s_add_u32 s77, s77, 32768
    s_xor_b32 s78, s78, 0x10000
    s_add_i32 s73, s62, 1
    s_cmp_gt_i32 s73, s63
    s_cbranch_scc1 L_load_r
    s_cmp_eq_i32 s73, s63
    s_cbranch_scc1 L_load_v
    s_cmp_lg_i32 s73, 3
    s_cbranch_scc1 L_load_k
    s_lshl_b32 s7, s4, 10
    s_add_u32 s7, s7, 3866624
    v_lshrrev_b32 v2, 3, v1
    v_and_b32 v3, 7, v1
    v_lshlrev_b32 v3, 2, v3
    v_lshl_add_u32 v3, v2, 7, v3
    s_mov_b32 s79, 262144
L_poll_49:
    buffer_load_dword v2, v3, s[8:11], s7 offen sc1
    s_waitcnt vmcnt(0)
    v_cmp_gt_u32 vcc, 2, v2
    s_cbranch_vccz L_polldone_50
    s_sleep 2
    s_sub_u32 s79, s79, 1
    s_cmp_lg_u32 s79, 0
    s_cbranch_scc1 L_poll_49
L_polldone_50:
L_load_k:
    s_lshl_b32 s6, s76, 13
    s_add_u32 s6, s6, s78
    s_add_u32 m0, s6, 0
    s_add_u32 s7, s77, 0
    buffer_load_dwordx4 v49, s[8:11], s7 offen offset:0 sc1 lds
    buffer_load_dwordx4 v49, s[8:11], s7 offen offset:1024 sc1 lds
    buffer_load_dwordx4 v49, s[8:11], s7 offen offset:2048 sc1 lds
    buffer_load_dwordx4 v49, s[8:11], s7 offen offset:3072 sc1 lds
    s_lshl_b32 s6, s76, 13
    s_add_u32 s6, s6, s78
    s_add_u32 m0, s6, 4096
    s_add_u32 s7, s77, 4096
    buffer_load_dwordx4 v49, s[8:11], s7 offen offset:0 sc1 lds
    buffer_load_dwordx4 v49, s[8:11], s7 offen offset:1024 sc1 lds
    buffer_load_dwordx4 v49, s[8:11], s7 offen offset:2048 sc1 lds
    buffer_load_dwordx4 v49, s[8:11], s7 offen offset:3072 sc1 lds
    s_lshl_b32 s6, s76, 12
    s_add_u32 s6, s6, s78
    s_add_u32 m0, s6, 49152
    s_add_u32 s7, s77, 524288
    buffer_load_dwordx4 v50, s[8:11], s7 offen offset:0 sc1 lds
    buffer_load_dwordx4 v50, s[8:11], s7 offen offset:1024 sc1 lds
    buffer_load_dwordx4 v50, s[8:11], s7 offen offset:2048 sc1 lds
    buffer_load_dwordx4 v50, s[8:11], s7 offen offset:3072 sc1 lds
L_load_v:
    s_lshl_b32 s6, s76, 12
    s_add_u32 s6, s6, s78
    s_add_u32 m0, s6, 32768
    s_add_u32 s7, s77, 507904
    buffer_load_dwordx4 v50, s[8:11], s7 offen offset:0 sc1 lds
    buffer_load_dwordx4 v50, s[8:11], s7 offen offset:1024 sc1 lds
    buffer_load_dwordx4 v50, s[8:11], s7 offen offset:2048 sc1 lds
    buffer_load_dwordx4 v50, s[8:11], s7 offen offset:3072 sc1 lds
    s_cmp_eq_i32 s73, s63
    s_cbranch_scc1 L_xa
    s_cmp_lt_u32 s5, 4
    s_cbranch_scc1 L_load_r
    s_sub_i32 s79, s73, 1
    s_cmp_lt_u32 s79, 2
    s_cbranch_scc1 L_x3
L_load_r:
    s_setpc_b64 s[82:83]
L_pend:
    s_bitcmp1_b32 s89, 1
    s_cbranch_scc0 L_load_a
    s_cmp_lt_i32 s62, 0
    s_cbranch_scc1 L_load_a
    s_lshl_b32 s6, s4, 3
    s_add_u32 s6, s6, s5
    s_lshl_b32 s6, s6, 5
    s_add_u32 s6, s6, s3
    s_lshl_b32 s6, s6, 2
    s_add_u32 s6, s6, 3866624
    v_mov_b32 v2, 2
    v_mov_b32 v3, 0x5000000
    v_writelane_b32 v3, s6, 0
    buffer_store_dword v2, v3, s[8:11], 0 offen sc1
    s_and_b32 s89, s89, 1
L_load_a:
    s_setpc_b64 s[82:83]
L_xa:
    s_getpc_b64 s[80:81]
L_pc2:
    s_sub_u32 s80, s80, L_pc2-L_fin
    s_subb_u32 s81, s81, 0
    s_and_b32 s6, s4, 1
    s_lshl_b32 s6, s6, 14
    v_lshl_add_u32 v3, v0, 6, s6
    v_min_u32 v3, L_exit-L_fin, v3
    global_load_dword v11, v3, s[80:81]
    s_lshr_b32 s74, s4, 3
    s_lshl_b32 s74, s74, 2
    s_add_u32 s74, s74, s76
    s_mul_i32 s74, s74, 327680
    s_and_b32 s7, s4, 3
    s_mul_i32 s7, s7, 10240
    s_add_u32 s74, s74, s7
    s_add_u32 s74, s74, 4199424
    s_add_u32 s6, s76, 0
    s_and_b32 s6, s6, 3
    s_lshl_b32 s6, s6, 10
    v_add_u32 v4, s6, v13
    s_add_u32 s6, s76, 1
    s_and_b32 s6, s6, 3
    s_lshl_b32 s6, s6, 10
    v_add_u32 v5, s6, v13
    s_add_u32 s6, s76, 2
    s_and_b32 s6, s6, 3
    s_lshl_b32 s6, s6, 10
    v_add_u32 v6, s6, v13
    s_add_u32 s6, s76, 3
    s_and_b32 s6, s6, 3
    s_lshl_b32 s6, s6, 10
    v_add_u32 v7, s6, v13
    v_add_u32 v8, 4096, v13
    s_lshl_b32 s73, s3, 13
    s_add_u32 s75, s73, s78
    s_add_u32 m0, s73, 131072
    s_add_u32 s7, s74, 0
    buffer_load_dwordx4 v4, s[8:11], s7 offen sc1 lds
    s_add_u32 m0, s73, 132096
    s_add_u32 s7, s74, 0
    buffer_load_dwordx4 v5, s[8:11], s7 offen sc1 lds
    s_add_u32 m0, s73, 133120
    s_add_u32 s7, s74, 0
    buffer_load_dwordx4 v6, s[8:11], s7 offen sc1 lds
    s_add_u32 m0, s73, 134144
    s_add_u32 s7, s74, 0
    buffer_load_dwordx4 v7, s[8:11], s7 offen sc1 lds
    s_add_u32 m0, s73, 135168
    s_add_u32 s7, s74, 0
    buffer_load_dwordx4 v8, s[8:11], s7 offen sc1 lds
    s_add_u32 m0, s73, 136192
    s_add_u32 s7, s74, 40960
    buffer_load_dwordx4 v4, s[8:11], s7 offen sc1 lds
    s_add_u32 m0, s73, 137216
    s_add_u32 s7, s74, 40960
    buffer_load_dwordx4 v5, s[8:11], s7 offen sc1 lds
    s_add_u32 m0, s73, 138240
    s_add_u32 s7, s74, 40960
    buffer_load_dwordx4 v6, s[8:11], s7 offen sc1 lds
    s_add_u32 m0, s75, 0
    s_add_u32 s7, s74, 40960
    buffer_load_dwordx4 v7, s[8:11], s7 offen sc1 lds
    s_add_u32 m0, s75, 1024
    s_add_u32 s7, s74, 40960
    buffer_load_dwordx4 v8, s[8:11], s7 offen sc1 lds
    s_add_u32 m0, s75, 2048
    s_add_u32 s7, s74, 81920
    buffer_load_dwordx4 v4, s[8:11], s7 offen sc1 lds
    s_add_u32 m0, s75, 3072
    s_add_u32 s7, s74, 81920
    buffer_load_dwordx4 v5, s[8:11], s7 offen sc1 lds
    s_add_u32 m0, s75, 4096
    s_add_u32 s7, s74, 81920
    buffer_load_dwordx4 v6, s[8:11], s7 offen sc1 lds
    s_add_u32 m0, s75, 5120
    s_add_u32 s7, s74, 81920
    buffer_load_dwordx4 v7, s[8:11], s7 offen sc1 lds
    s_add_u32 m0, s75, 6144
    s_add_u32 s7, s74, 81920
    buffer_load_dwordx4 v8, s[8:11], s7 offen sc1 lds
    s_add_u32 m0, s75, 7168
    s_add_u32 s7, s74, 122880
    buffer_load_dwordx4 v4, s[8:11], s7 offen sc1 lds
    s_lshl_b32 s75, s3, 12
    s_add_u32 s75, s75, s78
    s_add_u32 m0, s75, 49152
    s_add_u32 s7, s74, 122880
    buffer_load_dwordx4 v5, s[8:11], s7 offen sc1 lds
    s_add_u32 m0, s75, 50176
    s_add_u32 s7, s74, 122880
    buffer_load_dwordx4 v6, s[8:11], s7 offen sc1 lds
    s_add_u32 m0, s75, 51200
    s_add_u32 s7, s74, 122880
    buffer_load_dwordx4 v7, s[8:11], s7 offen sc1 lds
    s_add_u32 m0, s75, 52224
    s_add_u32 s7, s74, 122880
    buffer_load_dwordx4 v8, s[8:11], s7 offen sc1 lds
    s_setpc_b64 s[82:83]
L_x3:
    s_mov_b32 s12, s48
    s_mov_b32 s13, s49
    s_mov_b32 s14, 0x21c000
    s_mov_b32 s15, 0x20000
    s_cmp_eq_u32 s3, 3
    s_cbranch_scc1 L_load_r
    s_cmp_eq_u32 s3, 1
    s_cselect_b32 s12, s50, s12
    s_cselect_b32 s13, s51, s13
    s_cmp_eq_u32 s3, 2
    s_cselect_b32 s12, s52, s12
    s_cselect_b32 s13, s53, s13
    s_mov_b32 s73, 3456
    s_cmov_b32 s73, 256
    s_mov_b32 s75, 256
    s_cmov_b32 s75, 163840
    s_lshr_b32 s6, s2, 3
    s_sub_u32 s6, s6, 16
    s_mul_i32 s6, s6, 40
    v_lshrrev_b32 v2, 2, v1
    v_add_u32 v2, s6, v2
    v_mul_lo_u32 v2, v2, s73
    v_and_b32 v3, 3, v1
    v_lshl_add_u32 v2, v3, 6, v2
    s_lshl_b32 s6, s79, 3
    s_lshr_b32 s7, s4, 2
    s_add_u32 s6, s6, s7
    s_mul_i32 s6, s6, s75
    v_mov_b32 v3, 0x5000000
    v_cmp_gt_u32 vcc, 32, v1
    s_lshl_b32 s73, s73, 4
    s_nop 0
    v_cndmask_b32 v3, v3, v2, vcc
    buffer_load_dword v11, v2, s[12:15], s6 offen
    s_add_u32 s7, s6, s73
    buffer_load_dword v11, v2, s[12:15], s7 offen
    s_add_u32 s7, s7, s73
    buffer_load_dword v11, v3, s[12:15], s7 offen
    s_setpc_b64 s[82:83]
L_mask:
    v_and_b32 v2, 15, v1
    v_lshrrev_b32 v3, 4, v1
    v_lshlrev_b32 v3, 2, v3
    v_sub_u32 v2, v2, v3
    v_mov_b32 v3, 0xff800000
    v_cmp_gt_i32 vcc, 0, v2
    v_mov_b32 v152, v3
    s_nop 0
    v_cndmask_b32 v144, v144, v3, vcc
    v_cndmask_b32 v156, v156, v3, vcc
    v_cmp_gt_i32 vcc, 1, v2
    v_mov_b32 v153, v3
    s_nop 0
    v_cndmask_b32 v145, v145, v3, vcc
    v_cndmask_b32 v157, v157, v3, vcc
    v_cmp_gt_i32 vcc, 2, v2
    v_mov_b32 v154, v3
    s_nop 0
    v_cndmask_b32 v146, v146, v3, vcc
    v_cndmask_b32 v158, v158, v3, vcc
    v_cmp_gt_i32 vcc, 3, v2
    v_mov_b32 v155, v3
    s_nop 0
    v_cndmask_b32 v147, v147, v3, vcc
    v_cndmask_b32 v159, v159, v3, vcc
    s_nop 1
    s_setpc_b64 s[82:83]
L_rare0:
    s_nop 15
    v_max3_f32 v62, 0, v64, v65
    v_max3_f32 v62, v62, v66, v67
    v_max3_f32 v62, v62, v72, v73
    v_max3_f32 v62, v62, v74, v75
    v_mov_b32 v58, v62
    s_nop 1
    v_permlane16_swap_b32 v62, v58
    s_nop 1
    v_max_f32 v62, v62, v58
    v_mov_b32 v58, v62
    s_nop 1
    v_permlane32_swap_b32 v62, v58
    s_nop 1
    v_max_f32 v62, v62, v58
    v_exp_f32 v58, -v62
    v_sub_f32 v64, v64, v62
    v_sub_f32 v80, v80, v62
    v_sub_f32 v144, v144, v62
    v_sub_f32 v65, v65, v62
    v_sub_f32 v81, v81, v62
    v_sub_f32 v145, v145, v62
    v_sub_f32 v66, v66, v62
    v_sub_f32 v82, v82, v62
    v_sub_f32 v146, v146, v62
    v_sub_f32 v67, v67, v62
    v_sub_f32 v83, v83, v62
    v_sub_f32 v147, v147, v62
    v_sub_f32 v72, v72, v62
    v_sub_f32 v88, v88, v62
    v_sub_f32 v152, v152, v62
    v_sub_f32 v73, v73, v62
    v_sub_f32 v89, v89, v62
    v_sub_f32 v153, v153, v62
    v_sub_f32 v74, v74, v62
    v_sub_f32 v90, v90, v62
    v_sub_f32 v154, v154, v62
    v_sub_f32 v75, v75, v62
    v_sub_f32 v91, v91, v62
    v_sub_f32 v155, v155, v62
    v_mul_f32 v56, v58, v56
    v_mul_f32 v192, v58, v192
    v_mul_f32 v193, v58, v193
    v_mul_f32 v194, v58, v194
    v_mul_f32 v195, v58, v195
    v_mul_f32 v200, v58, v200
    v_mul_f32 v201, v58, v201
    v_mul_f32 v202, v58, v202
    v_mul_f32 v203, v58, v203
    v_mul_f32 v208, v58, v208
    v_mul_f32 v209, v58, v209
    v_mul_f32 v210, v58, v210
    v_mul_f32 v211, v58, v211
    v_mul_f32 v216, v58, v216
    v_mul_f32 v217, v58, v217
    v_mul_f32 v218, v58, v218
    v_mul_f32 v219, v58, v219
    v_mul_f32 v224, v58, v224
    v_mul_f32 v225, v58, v225
    v_mul_f32 v226, v58, v226
    v_mul_f32 v227, v58, v227
    v_mul_f32 v232, v58, v232
    v_mul_f32 v233, v58, v233
    v_mul_f32 v234, v58, v234
    v_mul_f32 v235, v58, v235
    v_mul_f32 v240, v58, v240
    v_mul_f32 v241, v58, v241
    v_mul_f32 v242, v58, v242
    v_mul_f32 v243, v58, v243
    v_mul_f32 v248, v58, v248
    v_mul_f32 v249, v58, v249
    v_mul_f32 v250, v58, v250
    v_mul_f32 v251, v58, v251
    v_max3_f32 v62, 0, v68, v69
    v_max3_f32 v62, v62, v70, v71
    v_max3_f32 v62, v62, v76, v77
    v_max3_f32 v62, v62, v78, v79
    v_mov_b32 v58, v62
    s_nop 1
    v_permlane16_swap_b32 v62, v58
    s_nop 1
    v_max_f32 v62, v62, v58
    v_mov_b32 v58, v62
    s_nop 1
    v_permlane32_swap_b32 v62, v58
    s_nop 1
    v_max_f32 v62, v62, v58
    v_exp_f32 v58, -v62
    v_sub_f32 v68, v68, v62
    v_sub_f32 v84, v84, v62
    v_sub_f32 v148, v148, v62
    v_sub_f32 v69, v69, v62
    v_sub_f32 v85, v85, v62
    v_sub_f32 v149, v149, v62
    v_sub_f32 v70, v70, v62
    v_sub_f32 v86, v86, v62
    v_sub_f32 v150, v150, v62
    v_sub_f32 v71, v71, v62
    v_sub_f32 v87, v87, v62
    v_sub_f32 v151, v151, v62
    v_sub_f32 v76, v76, v62
    v_sub_f32 v92, v92, v62
    v_sub_f32 v156, v156, v62
    v_sub_f32 v77, v77, v62
    v_sub_f32 v93, v93, v62
    v_sub_f32 v157, v157, v62
    v_sub_f32 v78, v78, v62
    v_sub_f32 v94, v94, v62
    v_sub_f32 v158, v158, v62
    v_sub_f32 v79, v79, v62
    v_sub_f32 v95, v95, v62
    v_sub_f32 v159, v159, v62
    v_mul_f32 v57, v58, v57
    v_mul_f32 v196, v58, v196
    v_mul_f32 v197, v58, v197
    v_mul_f32 v198, v58, v198
    v_mul_f32 v199, v58, v199
    v_mul_f32 v204, v58, v204
    v_mul_f32 v205, v58, v205
    v_mul_f32 v206, v58, v206
    v_mul_f32 v207, v58, v207
    v_mul_f32 v212, v58, v212
    v_mul_f32 v213, v58, v213
    v_mul_f32 v214, v58, v214
    v_mul_f32 v215, v58, v215
    v_mul_f32 v220, v58, v220
    v_mul_f32 v221, v58, v221
    v_mul_f32 v222, v58, v222
    v_mul_f32 v223, v58, v223
    v_mul_f32 v228, v58, v228
    v_mul_f32 v229, v58, v229
    v_mul_f32 v230, v58, v230
    v_mul_f32 v231, v58, v231
    v_mul_f32 v236, v58, v236
    v_mul_f32 v237, v58, v237
    v_mul_f32 v238, v58, v238
    v_mul_f32 v239, v58, v239
    v_mul_f32 v244, v58, v244
    v_mul_f32 v245, v58, v245
    v_mul_f32 v246, v58, v246
    v_mul_f32 v247, v58, v247
    v_mul_f32 v252, v58, v252
    v_mul_f32 v253, v58, v253
    v_mul_f32 v254, v58, v254
    v_mul_f32 v255, v58, v255
    v_exp_f32 v58, v64
    s_nop 0
    v_exp_f32 v59, v65
    s_nop 0
    v_add_f32 v52, v58, v59
    v_cvt_pk_bf16_f32 v128, v58, v59
    v_exp_f32 v60, v66
    s_nop 0
    v_add_f32 v52, v60, v52
    v_exp_f32 v61, v67
    s_nop 0
    v_add_f32 v52, v61, v52
    v_cvt_pk_bf16_f32 v129, v60, v61
    v_exp_f32 v58, v68
    s_nop 0
    v_exp_f32 v59, v69
    s_nop 0
    v_add_f32 v53, v58, v59
    v_cvt_pk_bf16_f32 v132, v58, v59
    v_exp_f32 v60, v70
    s_nop 0
    v_add_f32 v53, v60, v53
    v_exp_f32 v61, v71
    s_nop 0
    v_add_f32 v53, v61, v53
    v_cvt_pk_bf16_f32 v133, v60, v61
    v_exp_f32 v58, v72
    s_nop 0
    v_add_f32 v52, v58, v52
    v_exp_f32 v59, v73
    s_nop 0
    v_add_f32 v52, v59, v52
    v_cvt_pk_bf16_f32 v130, v58, v59
    v_exp_f32 v60, v74
    s_nop 0
    v_add_f32 v52, v60, v52
    v_exp_f32 v61, v75
    s_nop 0
    v_add_f32 v52, v61, v52
    v_cvt_pk_bf16_f32 v131, v60, v61
    v_exp_f32 v58, v76
    s_nop 0
    v_add_f32 v53, v58, v53
    v_exp_f32 v59, v77
    s_nop 0
    v_add_f32 v53, v59, v53
    v_cvt_pk_bf16_f32 v134, v58, v59
    v_exp_f32 v60, v78
    s_nop 0
    v_add_f32 v53, v60, v53
    v_exp_f32 v61, v79
    s_nop 0
    v_add_f32 v53, v61, v53
    v_cvt_pk_bf16_f32 v135, v60, v61
    s_nop 1
    s_setpc_b64 s[80:81]
L_rare1:
    s_nop 15
    v_max3_f32 v62, 0, v80, v81
    v_max3_f32 v62, v62, v82, v83
    v_max3_f32 v62, v62, v88, v89
    v_max3_f32 v62, v62, v90, v91
    v_mov_b32 v58, v62
    s_nop 1
    v_permlane16_swap_b32 v62, v58
    s_nop 1
    v_max_f32 v62, v62, v58
    v_mov_b32 v58, v62
    s_nop 1
    v_permlane32_swap_b32 v62, v58
    s_nop 1
    v_max_f32 v62, v62, v58
    v_exp_f32 v58, -v62
    v_sub_f32 v64, v64, v62
    v_sub_f32 v80, v80, v62
    v_sub_f32 v144, v144, v62
    v_sub_f32 v65, v65, v62
    v_sub_f32 v81, v81, v62
    v_sub_f32 v145, v145, v62
    v_sub_f32 v66, v66, v62
    v_sub_f32 v82, v82, v62
    v_sub_f32 v146, v146, v62
    v_sub_f32 v67, v67, v62
    v_sub_f32 v83, v83, v62
    v_sub_f32 v147, v147, v62
    v_sub_f32 v72, v72, v62
    v_sub_f32 v88, v88, v62
    v_sub_f32 v152, v152, v62
    v_sub_f32 v73, v73, v62
    v_sub_f32 v89, v89, v62
    v_sub_f32 v153, v153, v62
    v_sub_f32 v74, v74, v62
    v_sub_f32 v90, v90, v62
    v_sub_f32 v154, v154, v62
    v_sub_f32 v75, v75, v62
    v_sub_f32 v91, v91, v62
    v_sub_f32 v155, v155, v62
    v_mul_f32 v56, v58, v56
    v_mul_f32 v192, v58, v192
    v_mul_f32 v193, v58, v193
    v_mul_f32 v194, v58, v194
    v_mul_f32 v195, v58, v195
    v_mul_f32 v200, v58, v200
    v_mul_f32 v201, v58, v201
    v_mul_f32 v202, v58, v202
    v_mul_f32 v203, v58, v203
    v_mul_f32 v208, v58, v208
    v_mul_f32 v209, v58, v209
    v_mul_f32 v210, v58, v210
    v_mul_f32 v211, v58, v211
    v_mul_f32 v216, v58, v216
    v_mul_f32 v217, v58, v217
    v_mul_f32 v218, v58, v218
    v_mul_f32 v219, v58, v219
    v_mul_f32 v224, v58, v224
    v_mul_f32 v225, v58, v225
    v_mul_f32 v226, v58, v226
    v_mul_f32 v227, v58, v227
    v_mul_f32 v232, v58, v232
    v_mul_f32 v233, v58, v233
    v_mul_f32 v234, v58, v234
    v_mul_f32 v235, v58, v235
    v_mul_f32 v240, v58, v240
    v_mul_f32 v241, v58, v241
    v_mul_f32 v242, v58, v242
    v_mul_f32 v243, v58, v243
    v_mul_f32 v248, v58, v248
    v_mul_f32 v249, v58, v249
    v_mul_f32 v250, v58, v250
    v_mul_f32 v251, v58, v251
    v_max3_f32 v62, 0, v84, v85
    v_max3_f32 v62, v62, v86, v87
    v_max3_f32 v62, v62, v92, v93
    v_max3_f32 v62, v62, v94, v95
    v_mov_b32 v58, v62
    s_nop 1
    v_permlane16_swap_b32 v62, v58
    s_nop 1
    v_max_f32 v62, v62, v58
    v_mov_b32 v58, v62
    s_nop 1
    v_permlane32_swap_b32 v62, v58
    s_nop 1
    v_max_f32 v62, v62, v58
    v_exp_f32 v58, -v62
    v_sub_f32 v68, v68, v62
    v_sub_f32 v84, v84, v62
    v_sub_f32 v148, v148, v62
    v_sub_f32 v69, v69, v62
    v_sub_f32 v85, v85, v62
    v_sub_f32 v149, v149, v62
    v_sub_f32 v70, v70, v62
    v_sub_f32 v86, v86, v62
    v_sub_f32 v150, v150, v62
    v_sub_f32 v71, v71, v62
    v_sub_f32 v87, v87, v62
    v_sub_f32 v151, v151, v62
    v_sub_f32 v76, v76, v62
    v_sub_f32 v92, v92, v62
    v_sub_f32 v156, v156, v62
    v_sub_f32 v77, v77, v62
    v_sub_f32 v93, v93, v62
    v_sub_f32 v157, v157, v62
    v_sub_f32 v78, v78, v62
    v_sub_f32 v94, v94, v62
    v_sub_f32 v158, v158, v62
    v_sub_f32 v79, v79, v62
    v_sub_f32 v95, v95, v62
    v_sub_f32 v159, v159, v62
    v_mul_f32 v57, v58, v57
    v_mul_f32 v196, v58, v196
    v_mul_f32 v197, v58, v197
    v_mul_f32 v198, v58, v198
    v_mul_f32 v199, v58, v199
    v_mul_f32 v204, v58, v204
    v_mul_f32 v205, v58, v205
    v_mul_f32 v206, v58, v206
    v_mul_f32 v207, v58, v207
    v_mul_f32 v212, v58, v212
    v_mul_f32 v213, v58, v213
    v_mul_f32 v214, v58, v214
    v_mul_f32 v215, v58, v215
    v_mul_f32 v220, v58, v220
    v_mul_f32 v221, v58, v221
    v_mul_f32 v222, v58, v222
    v_mul_f32 v223, v58, v223
    v_mul_f32 v228, v58, v228
    v_mul_f32 v229, v58, v229
    v_mul_f32 v230, v58, v230
    v_mul_f32 v231, v58, v231
    v_mul_f32 v236, v58, v236
    v_mul_f32 v237, v58, v237
    v_mul_f32 v238, v58, v238
    v_mul_f32 v239, v58, v239
    v_mul_f32 v244, v58, v244
    v_mul_f32 v245, v58, v245
    v_mul_f32 v246, v58, v246
    v_mul_f32 v247, v58, v247
    v_mul_f32 v252, v58, v252
    v_mul_f32 v253, v58, v253
    v_mul_f32 v254, v58, v254
    v_mul_f32 v255, v58, v255
    v_exp_f32 v58, v80
    s_nop 0
    v_exp_f32 v59, v81
    s_nop 0
    v_add_f32 v54, v58, v59
    v_cvt_pk_bf16_f32 v136, v58, v59
    v_exp_f32 v60, v82
    s_nop 0
    v_add_f32 v54, v60, v54
    v_exp_f32 v61, v83
    s_nop 0
    v_add_f32 v54, v61, v54
    v_cvt_pk_bf16_f32 v137, v60, v61
    v_exp_f32 v58, v84
    s_nop 0
    v_exp_f32 v59, v85
    s_nop 0
    v_add_f32 v55, v58, v59
    v_cvt_pk_bf16_f32 v140, v58, v59
    v_exp_f32 v60, v86
    s_nop 0
    v_add_f32 v55, v60, v55
    v_exp_f32 v61, v87
    s_nop 0
    v_add_f32 v55, v61, v55
    v_cvt_pk_bf16_f32 v141, v60, v61
    v_exp_f32 v58, v88
    s_nop 0
    v_add_f32 v54, v58, v54
    v_exp_f32 v59, v89
    s_nop 0
    v_add_f32 v54, v59, v54
    v_cvt_pk_bf16_f32 v138, v58, v59
    v_exp_f32 v60, v90
    s_nop 0
    v_add_f32 v54, v60, v54
    v_exp_f32 v61, v91
    s_nop 0
    v_add_f32 v54, v61, v54
    v_cvt_pk_bf16_f32 v139, v60, v61
    v_exp_f32 v58, v92
    s_nop 0
    v_add_f32 v55, v58, v55
    v_exp_f32 v59, v93
    s_nop 0
    v_add_f32 v55, v59, v55
    v_cvt_pk_bf16_f32 v142, v58, v59
    v_exp_f32 v60, v94
    s_nop 0
    v_add_f32 v55, v60, v55
    v_exp_f32 v61, v95
    s_nop 0
    v_add_f32 v55, v61, v55
    v_cvt_pk_bf16_f32 v143, v60, v61
    s_nop 1
    s_setpc_b64 s[80:81]
L_adone:
    s_barrier
    ds_read_b128 v[16:19], v4 offset:0
    ds_read_b128 v[20:23], v4 offset:1024
    ds_read_b128 v[24:27], v4 offset:2048
    ds_read_b128 v[28:31], v4 offset:3072
    s_waitcnt lgkmcnt(3)
    v_mfma_f32_16x16x32_bf16 v[56:59], v[96:99], v[16:19], 0
    v_mfma_f32_16x16x32_bf16 v[60:63], v[100:103], v[16:19], 0
    v_mfma_f32_16x16x32_bf16 v[64:67], v[104:107], v[16:19], 0
    v_mfma_f32_16x16x32_bf16 v[68:71], v[108:111], v[16:19], 0
    v_mfma_f32_16x16x32_bf16 v[72:75], v[112:115], v[16:19], 0
    ds_read_b128 v[16:19], v4 offset:4096
    s_cmp_lt_u32 s3, 4
    s_cbranch_scc1 L_nowl_51
    s_add_u32 s75, s69, 204800
    buffer_load_dwordx4 v[196:199], v44, s[8:11], s75 offen sc1
    buffer_load_dwordx4 v[200:203], v45, s[8:11], s75 offen sc1
    buffer_load_dwordx4 v[204:207], v46, s[8:11], s75 offen sc1
    buffer_load_dwordx4 v[208:211], v47, s[8:11], s75 offen sc1
    buffer_load_dwordx4 v[212:215], v52, s[8:11], s75 offen sc1
L_nowl_51:
    s_waitcnt lgkmcnt(3)
    v_mfma_f32_16x16x32_bf16 v[56:59], v[116:119], v[20:23], v[56:59]
    v_mfma_f32_16x16x32_bf16 v[60:63], v[120:123], v[20:23], v[60:63]
    v_mfma_f32_16x16x32_bf16 v[64:67], v[124:127], v[20:23], v[64:67]
    v_mfma_f32_16x16x32_bf16 v[68:71], v[128:131], v[20:23], v[68:71]
    v_mfma_f32_16x16x32_bf16 v[72:75], v[132:135], v[20:23], v[72:75]
    ds_read_b128 v[20:23], v4 offset:5120
    s_cmp_lt_u32 s3, 4
    s_cbranch_scc1 L_nowl_52
    s_add_u32 s75, s69, 245760
    buffer_load_dwordx4 v[216:219], v44, s[8:11], s75 offen sc1
    buffer_load_dwordx4 v[220:223], v45, s[8:11], s75 offen sc1
    buffer_load_dwordx4 v[224:227], v46, s[8:11], s75 offen sc1
    buffer_load_dwordx4 v[228:231], v47, s[8:11], s75 offen sc1
    buffer_load_dwordx4 v[232:235], v52, s[8:11], s75 offen sc1
L_nowl_52:
    s_waitcnt lgkmcnt(3)
    v_mfma_f32_16x16x32_bf16 v[56:59], v[136:139], v[24:27], v[56:59]
    v_mfma_f32_16x16x32_bf16 v[60:63], v[140:143], v[24:27], v[60:63]
    v_mfma_f32_16x16x32_bf16 v[64:67], v[144:147], v[24:27], v[64:67]
    v_mfma_f32_16x16x32_bf16 v[68:71], v[148:151], v[24:27], v[68:71]
    v_mfma_f32_16x16x32_bf16 v[72:75], v[152:155], v[24:27], v[72:75]
    ds_read_b128 v[24:27], v4 offset:6144
    s_cmp_lt_u32 s3, 4
    s_cbranch_scc1 L_nowl_53
    s_add_u32 s75, s69, 286720
    buffer_load_dwordx4 v[236:239], v44, s[8:11], s75 offen sc1
    buffer_load_dwordx4 v[240:243], v45, s[8:11], s75 offen sc1
    buffer_load_dwordx4 v[244:247], v46, s[8:11], s75 offen sc1
    buffer_load_dwordx4 v[248:251], v47, s[8:11], s75 offen sc1
    buffer_load_dwordx4 v[252:255], v52, s[8:11], s75 offen sc1
L_nowl_53:
    s_waitcnt lgkmcnt(3)
    v_mfma_f32_16x16x32_bf16 v[56:59], v[156:159], v[28:31], v[56:59]
    s_add_u32 s65, s68, 3
    s_and_b32 s65, s65, 3
    s_andn2_b32 s7, s68, 3
    s_add_u32 s65, s65, s7
    s_lshl_b32 s65, s65, 17
    s_add_u32 s65, s65, s66
    s_add_u32 m0, s99, 65536
    s_add_u32 s65, s65, 0
    buffer_load_dwordx4 v13, s[8:11], s65 offen offset:0 sc1 lds
    v_mfma_f32_16x16x32_bf16 v[60:63], v[160:163], v[28:31], v[60:63]
    buffer_load_dwordx4 v13, s[8:11], s65 offen offset:1024 sc1 lds
    v_mfma_f32_16x16x32_bf16 v[64:67], v[164:167], v[28:31], v[64:67]
    buffer_load_dwordx4 v13, s[8:11], s65 offen offset:2048 sc1 lds
    v_mfma_f32_16x16x32_bf16 v[68:71], v[168:171], v[28:31], v[68:71]
    buffer_load_dwordx4 v13, s[8:11], s65 offen offset:3072 sc1 lds
    v_mfma_f32_16x16x32_bf16 v[72:75], v[172:175], v[28:31], v[72:75]
    ds_read_b128 v[28:31], v4 offset:7168
    s_waitcnt vmcnt(20)
    s_waitcnt lgkmcnt(3)
    v_mfma_f32_16x16x32_bf16 v[56:59], v[176:179], v[16:19], v[56:59]
    v_mfma_f32_16x16x32_bf16 v[60:63], v[180:183], v[16:19], v[60:63]
    v_mfma_f32_16x16x32_bf16 v[64:67], v[184:187], v[16:19], v[64:67]
    v_mfma_f32_16x16x32_bf16 v[68:71], v[188:191], v[16:19], v[68:71]
    v_mfma_f32_16x16x32_bf16 v[72:75], v[192:195], v[16:19], v[72:75]
    s_waitcnt vmcnt(14)
    s_waitcnt lgkmcnt(2)
    v_mfma_f32_16x16x32_bf16 v[56:59], v[196:199], v[20:23], v[56:59]
    v_mfma_f32_16x16x32_bf16 v[60:63], v[200:203], v[20:23], v[60:63]
    v_mfma_f32_16x16x32_bf16 v[64:67], v[204:207], v[20:23], v[64:67]
    v_mfma_f32_16x16x32_bf16 v[68:71], v[208:211], v[20:23], v[68:71]
    v_mfma_f32_16x16x32_bf16 v[72:75], v[212:215], v[20:23], v[72:75]
    s_cmp_ge_u32 s3, 4
    s_cbranch_scc1 L_o0
    s_waitcnt vmcnt(4)
L_o0:
    s_waitcnt lgkmcnt(0)
    s_barrier
    ds_read_b128 v[16:19], v4 offset:32768
    ds_read_b128 v[20:23], v4 offset:33792
    s_waitcnt vmcnt(9)
    v_mfma_f32_16x16x32_bf16 v[56:59], v[216:219], v[24:27], v[56:59]
    v_mfma_f32_16x16x32_bf16 v[60:63], v[220:223], v[24:27], v[60:63]
    v_mfma_f32_16x16x32_bf16 v[64:67], v[224:227], v[24:27], v[64:67]
    v_mfma_f32_16x16x32_bf16 v[68:71], v[228:231], v[24:27], v[68:71]
    v_mfma_f32_16x16x32_bf16 v[72:75], v[232:235], v[24:27], v[72:75]
    ds_read_b128 v[24:27], v4 offset:34816
    s_waitcnt vmcnt(4)
    v_mfma_f32_16x16x32_bf16 v[56:59], v[236:239], v[28:31], v[56:59]
    v_mfma_f32_16x16x32_bf16 v[60:63], v[240:243], v[28:31], v[60:63]
    v_mfma_f32_16x16x32_bf16 v[64:67], v[244:247], v[28:31], v[64:67]
    v_mfma_f32_16x16x32_bf16 v[68:71], v[248:251], v[28:31], v[68:71]
    v_mfma_f32_16x16x32_bf16 v[72:75], v[252:255], v[28:31], v[72:75]
    ds_read_b128 v[28:31], v4 offset:35840
    s_waitcnt lgkmcnt(3)
    v_mfma_f32_16x16x32_bf16 v[76:79], v[96:99], v[16:19], 0
    v_mfma_f32_16x16x32_bf16 v[80:83], v[100:103], v[16:19], 0
    s_sub_u32 s6, s71, 1
    s_and_b32 s6, s6, 3
    s_mul_i32 s7, s6, 5120
    v_mfma_f32_16x16x32_bf16 v[84:87], v[104:107], v[16:19], 0
    s_add_u32 s7, s7, s67
    s_cmp_eq_u32 s6, 3
    s_cselect_b32 s7, 155648, s7
    v_mfma_f32_16x16x32_bf16 v[88:91], v[108:111], v[16:19], 0
    v_add_u32 v12, s7, v52
    v_mfma_f32_16x16x32_bf16 v[92:95], v[112:115], v[16:19], 0
    v_add_u32 v5, s67, v45
    ds_read_b128 v[16:19], v4 offset:36864
    s_waitcnt lgkmcnt(3)
    v_mfma_f32_16x16x32_bf16 v[76:79], v[116:119], v[20:23], v[76:79]
    ds_write_b128 v5, v[60:63] offset:0
    v_add_u32 v5, s67, v46
    v_mfma_f32_16x16x32_bf16 v[80:83], v[120:123], v[20:23], v[80:83]
    v_mfma_f32_16x16x32_bf16 v[84:87], v[124:127], v[20:23], v[84:87]
    v_mfma_f32_16x16x32_bf16 v[88:91], v[128:131], v[20:23], v[88:91]
    v_mfma_f32_16x16x32_bf16 v[92:95], v[132:135], v[20:23], v[92:95]
    ds_read_b128 v[20:23], v4 offset:37888
    s_waitcnt lgkmcnt(4)
    v_mfma_f32_16x16x32_bf16 v[76:79], v[136:139], v[24:27], v[76:79]
    ds_write_b128 v5, v[64:67] offset:5120
    v_add_u32 v5, s67, v47
    v_mfma_f32_16x16x32_bf16 v[80:83], v[140:143], v[24:27], v[80:83]
    v_mfma_f32_16x16x32_bf16 v[84:87], v[144:147], v[24:27], v[84:87]
    v_mfma_f32_16x16x32_bf16 v[88:91], v[148:151], v[24:27], v[88:91]
    v_mfma_f32_16x16x32_bf16 v[92:95], v[152:155], v[24:27], v[92:95]
    ds_read_b128 v[24:27], v4 offset:38912
    s_cmp_ge_u32 s3, 4
    s_cbranch_scc1 L_o1a
    v_and_b32 v3, 1, v1
    v_lshlrev_b32 v3, 12, v3
    v_and_b32 v2, 2, v1
    v_lshl_add_u32 v3, v2, 8, v3
    s_lshr_b32 s72, s61, 2
    s_lshl_b32 s72, s72, 6
    s_andn2_b32 s6, s4, 7
    s_add_u32 s72, s72, s6
    s_add_u32 s72, s72, s76
    s_lshl_b32 s72, s72, 7
    s_add_u32 s72, s72, 3932160
    buffer_load_dword v50, v3, s[8:11], s72 offen sc1
L_o1a:
    s_waitcnt lgkmcnt(5)
    v_mfma_f32_16x16x32_bf16 v[76:79], v[156:159], v[28:31], v[76:79]
    ds_write_b128 v5, v[68:71] offset:10240
    v_add_u32 v5, s67, v52
    v_mfma_f32_16x16x32_bf16 v[80:83], v[160:163], v[28:31], v[80:83]
    v_mfma_f32_16x16x32_bf16 v[84:87], v[164:167], v[28:31], v[84:87]
    v_mfma_f32_16x16x32_bf16 v[88:91], v[168:171], v[28:31], v[88:91]
    v_mfma_f32_16x16x32_bf16 v[92:95], v[172:175], v[28:31], v[92:95]
    ds_read_b128 v[28:31], v4 offset:39936
    s_waitcnt lgkmcnt(6)
    v_mfma_f32_16x16x32_bf16 v[76:79], v[176:179], v[16:19], v[76:79]
    ds_write_b128 v12, v[72:75] offset:0
    v_mfma_f32_16x16x32_bf16 v[80:83], v[180:183], v[16:19], v[80:83]
    v_mfma_f32_16x16x32_bf16 v[84:87], v[184:187], v[16:19], v[84:87]
    v_mfma_f32_16x16x32_bf16 v[88:91], v[188:191], v[16:19], v[88:91]
    v_mfma_f32_16x16x32_bf16 v[92:95], v[192:195], v[16:19], v[92:95]
    s_waitcnt lgkmcnt(5)
    v_mfma_f32_16x16x32_bf16 v[76:79], v[196:199], v[20:23], v[76:79]
    v_mfma_f32_16x16x32_bf16 v[80:83], v[200:203], v[20:23], v[80:83]
    v_mfma_f32_16x16x32_bf16 v[84:87], v[204:207], v[20:23], v[84:87]
    v_mfma_f32_16x16x32_bf16 v[88:91], v[208:211], v[20:23], v[88:91]
    v_mfma_f32_16x16x32_bf16 v[92:95], v[212:215], v[20:23], v[92:95]
    s_waitcnt vmcnt(0)
    s_cmp_ge_u32 s3, 4
    s_cbranch_scc1 L_o1
    v_cmp_ne_u32 vcc, 1, v50
    s_cbranch_vccz L_o1
    s_mov_b32 s79, 262144
L_poll_54:
    buffer_load_dword v2, v3, s[8:11], s72 offen sc1
    s_waitcnt vmcnt(0)
    v_cmp_ne_u32 vcc, 1, v2
    s_cbranch_vccz L_polldone_55
    s_sleep 1
    s_sub_u32 s79, s79, 1
    s_cmp_lg_u32 s79, 0
    s_cbranch_scc1 L_poll_54
L_polldone_55:
L_o1:
    s_waitcnt lgkmcnt(0)
    s_barrier
    ds_read_b128 v[32:35], v6 offset:0
    ds_read_b128 v[36:39], v6 offset:5120
    ds_read_b128 v[40:43], v6 offset:10240
    ds_read_b128 v[16:19], v7 offset:0
    ds_read_b128 v[20:23], v7 offset:1024
    s_add_u32 s65, s61, 1
    s_and_b32 s65, s65, 3
    s_andn2_b32 s7, s61, 3
    s_add_u32 s65, s65, s7
    s_lshl_b32 s65, s65, 17
    s_add_u32 s65, s65, s66
    s_add_u32 m0, s99, 0
    s_add_u32 s65, s65, 0
    buffer_load_dwordx4 v13, s[8:11], s65 offen offset:0 sc1 lds
    buffer_load_dwordx4 v13, s[8:11], s65 offen offset:1024 sc1 lds
    buffer_load_dwordx4 v13, s[8:11], s65 offen offset:2048 sc1 lds
    buffer_load_dwordx4 v13, s[8:11], s65 offen offset:3072 sc1 lds
    v_mfma_f32_16x16x32_bf16 v[76:79], v[216:219], v[24:27], v[76:79]
    s_add_u32 s65, s61, 2
    s_and_b32 s65, s65, 3
    s_andn2_b32 s7, s61, 3
    s_add_u32 s65, s65, s7
    s_lshl_b32 s65, s65, 17
    s_add_u32 s65, s65, s66
    s_add_u32 m0, s99, 32768
    s_add_u32 s65, s65, 0
    buffer_load_dwordx4 v13, s[8:11], s65 offen offset:0 sc1 lds
    v_mfma_f32_16x16x32_bf16 v[80:83], v[220:223], v[24:27], v[80:83]
    buffer_load_dwordx4 v13, s[8:11], s65 offen offset:1024 sc1 lds
    s_waitcnt lgkmcnt(2)
    v_mfma_f32_16x16x32_bf16 v[84:87], v[224:227], v[24:27], v[84:87]
    v_add_f32 v56, v56, v32
    v_add_f32 v57, v57, v33
    v_add_f32 v58, v58, v34
    v_add_f32 v59, v59, v35
    v_mfma_f32_16x16x32_bf16 v[88:91], v[228:231], v[24:27], v[88:91]
    v_add_f32 v56, v56, v36
    v_add_f32 v57, v57, v37
    v_add_f32 v58, v58, v38
    v_add_f32 v59, v59, v39
    v_mfma_f32_16x16x32_bf16 v[92:95], v[232:235], v[24:27], v[92:95]
    v_add_f32 v56, v56, v40
    v_add_f32 v57, v57, v41
    v_add_f32 v58, v58, v42
    v_add_f32 v59, v59, v43
    ds_read_b128 v[32:35], v5 offset:0
    ds_read_b128 v[36:39], v5 offset:5120
    ds_read_b128 v[40:43], v5 offset:10240
    ds_read_b128 v[24:27], v7 offset:2048
    v_mfma_f32_16x16x32_bf16 v[76:79], v[236:239], v[28:31], v[76:79]
    buffer_load_dwordx4 v13, s[8:11], s65 offen offset:2048 sc1 lds
    s_add_u32 s6, s96, 0
    v_mfma_f32_16x16x32_bf16 v[80:83], v[240:243], v[28:31], v[80:83]
    buffer_load_dwordx4 v13, s[8:11], s65 offen offset:3072 sc1 lds
    s_waitcnt lgkmcnt(1)
    v_mfma_f32_16x16x32_bf16 v[84:87], v[244:247], v[28:31], v[84:87]
    v_add_f32 v72, v72, v32
    v_add_f32 v73, v73, v33
    v_add_f32 v74, v74, v34
    v_add_f32 v75, v75, v35
    v_mfma_f32_16x16x32_bf16 v[88:91], v[248:251], v[28:31], v[88:91]
    v_add_f32 v72, v72, v36
    v_add_f32 v73, v73, v37
    v_add_f32 v74, v74, v38
    v_add_f32 v75, v75, v39
    v_mfma_f32_16x16x32_bf16 v[92:95], v[252:255], v[28:31], v[92:95]
    v_add_f32 v72, v72, v40
    v_add_f32 v73, v73, v41
    v_add_f32 v74, v74, v42
    v_add_f32 v75, v75, v43
    buffer_store_dwordx4 v[56:59], v44, s[8:11], s6 offen sc1
    s_cmp_lg_u32 s71, 0
    s_cbranch_scc1 L_nost_56
    buffer_store_dwordx4 v[72:75], v52, s[8:11], s6 offen sc1
L_nost_56:
    s_nop 0
    ds_read_b128 v[28:31], v7 offset:3072
    v_mfma_f32_16x16x32_bf16 v[56:59], v[96:99], v[16:19], 0
    v_mfma_f32_16x16x32_bf16 v[60:63], v[100:103], v[16:19], 0
    s_sub_u32 s6, s71, 2
    s_and_b32 s6, s6, 3
    s_mul_i32 s7, s6, 5120
    v_mfma_f32_16x16x32_bf16 v[64:67], v[104:107], v[16:19], 0
    s_add_u32 s7, s7, s67
    s_cmp_eq_u32 s6, 3
    s_cselect_b32 s7, 124928, s7
    v_mfma_f32_16x16x32_bf16 v[68:71], v[108:111], v[16:19], 0
    v_add_u32 v12, s7, v52
    v_mfma_f32_16x16x32_bf16 v[72:75], v[112:115], v[16:19], 0
    v_add_u32 v5, s67, v45
    ds_read_b128 v[16:19], v7 offset:4096
    v_mfma_f32_16x16x32_bf16 v[56:59], v[116:119], v[20:23], v[56:59]
    ds_write_b128 v5, v[80:83] offset:30720
    v_add_u32 v5, s67, v46
    v_mfma_f32_16x16x32_bf16 v[60:63], v[120:123], v[20:23], v[60:63]
    v_mfma_f32_16x16x32_bf16 v[64:67], v[124:127], v[20:23], v[64:67]
    v_mfma_f32_16x16x32_bf16 v[68:71], v[128:131], v[20:23], v[68:71]
    v_mfma_f32_16x16x32_bf16 v[72:75], v[132:135], v[20:23], v[72:75]
    ds_read_b128 v[20:23], v7 offset:5120
    s_waitcnt lgkmcnt(4)
    v_mfma_f32_16x16x32_bf16 v[56:59], v[136:139], v[24:27], v[56:59]
    ds_write_b128 v5, v[84:87] offset:35840
    v_add_u32 v5, s67, v47
    v_mfma_f32_16x16x32_bf16 v[60:63], v[140:143], v[24:27], v[60:63]
    v_mfma_f32_16x16x32_bf16 v[64:67], v[144:147], v[24:27], v[64:67]
    v_mfma_f32_16x16x32_bf16 v[68:71], v[148:151], v[24:27], v[68:71]
    v_mfma_f32_16x16x32_bf16 v[72:75], v[152:155], v[24:27], v[72:75]
    ds_read_b128 v[24:27], v7 offset:6144
    s_waitcnt lgkmcnt(5)
    v_mfma_f32_16x16x32_bf16 v[56:59], v[156:159], v[28:31], v[56:59]
    ds_write_b128 v5, v[88:91] offset:40960
    v_add_u32 v5, s67, v52
    v_mfma_f32_16x16x32_bf16 v[60:63], v[160:163], v[28:31], v[60:63]
    v_mfma_f32_16x16x32_bf16 v[64:67], v[164:167], v[28:31], v[64:67]
    v_mfma_f32_16x16x32_bf16 v[68:71], v[168:171], v[28:31], v[68:71]
    v_mfma_f32_16x16x32_bf16 v[72:75], v[172:175], v[28:31], v[72:75]
    ds_read_b128 v[28:31], v7 offset:7168
    s_waitcnt lgkmcnt(6)
    v_mfma_f32_16x16x32_bf16 v[56:59], v[176:179], v[16:19], v[56:59]
    ds_write_b128 v12, v[92:95] offset:30720
    v_mfma_f32_16x16x32_bf16 v[60:63], v[180:183], v[16:19], v[60:63]
    v_mfma_f32_16x16x32_bf16 v[64:67], v[184:187], v[16:19], v[64:67]
    v_mfma_f32_16x16x32_bf16 v[68:71], v[188:191], v[16:19], v[68:71]
    v_mfma_f32_16x16x32_bf16 v[72:75], v[192:195], v[16:19], v[72:75]
    s_waitcnt lgkmcnt(5)
    v_mfma_f32_16x16x32_bf16 v[56:59], v[196:199], v[20:23], v[56:59]
    v_mfma_f32_16x16x32_bf16 v[60:63], v[200:203], v[20:23], v[60:63]
    v_mfma_f32_16x16x32_bf16 v[64:67], v[204:207], v[20:23], v[64:67]
    v_mfma_f32_16x16x32_bf16 v[68:71], v[208:211], v[20:23], v[68:71]
    v_mfma_f32_16x16x32_bf16 v[72:75], v[212:215], v[20:23], v[72:75]
    s_waitcnt vmcnt(5)
    s_waitcnt lgkmcnt(0)
    s_barrier
    ds_read_b128 v[32:35], v6 offset:30720
    ds_read_b128 v[36:39], v6 offset:35840
    ds_read_b128 v[40:43], v6 offset:40960
    ds_read_b128 v[16:19], v4 offset:0
    ds_read_b128 v[20:23], v4 offset:1024
    v_mfma_f32_16x16x32_bf16 v[56:59], v[216:219], v[24:27], v[56:59]
    s_add_u32 s65, s61, 3
    s_and_b32 s65, s65, 3
    s_andn2_b32 s7, s61, 3
    s_add_u32 s65, s65, s7
    s_lshl_b32 s65, s65, 17
    s_add_u32 s65, s65, s66
    s_add_u32 m0, s99, 65536
    s_add_u32 s65, s65, 0
    buffer_load_dwordx4 v13, s[8:11], s65 offen offset:0 sc1 lds
    v_mfma_f32_16x16x32_bf16 v[60:63], v[220:223], v[24:27], v[60:63]
    buffer_load_dwordx4 v13, s[8:11], s65 offen offset:1024 sc1 lds
    s_waitcnt lgkmcnt(2)
    v_mfma_f32_16x16x32_bf16 v[64:67], v[224:227], v[24:27], v[64:67]
    v_add_f32 v76, v76, v32
    v_add_f32 v77, v77, v33
    v_add_f32 v78, v78, v34
    v_add_f32 v79, v79, v35
    v_mfma_f32_16x16x32_bf16 v[68:71], v[228:231], v[24:27], v[68:71]
    v_add_f32 v76, v76, v36
    v_add_f32 v77, v77, v37
    v_add_f32 v78, v78, v38
    v_add_f32 v79, v79, v39
    v_mfma_f32_16x16x32_bf16 v[72:75], v[232:235], v[24:27], v[72:75]
    v_add_f32 v76, v76, v40
    v_add_f32 v77, v77, v41
    v_add_f32 v78, v78, v42
    v_add_f32 v79, v79, v43
    ds_read_b128 v[32:35], v5 offset:30720
    ds_read_b128 v[36:39], v5 offset:35840
    ds_read_b128 v[40:43], v5 offset:40960
    ds_read_b128 v[24:27], v4 offset:2048
    v_mfma_f32_16x16x32_bf16 v[56:59], v[236:239], v[28:31], v[56:59]
    buffer_load_dwordx4 v13, s[8:11], s65 offen offset:2048 sc1 lds
    s_add_u32 s6, s97, 0
    v_mfma_f32_16x16x32_bf16 v[60:63], v[240:243], v[28:31], v[60:63]
    buffer_load_dwordx4 v13, s[8:11], s65 offen offset:3072 sc1 lds
    s_waitcnt lgkmcnt(1)
    v_mfma_f32_16x16x32_bf16 v[64:67], v[244:247], v[28:31], v[64:67]
    v_add_f32 v92, v92, v32
    v_add_f32 v93, v93, v33
    v_add_f32 v94, v94, v34
    v_add_f32 v95, v95, v35
    v_mfma_f32_16x16x32_bf16 v[68:71], v[248:251], v[28:31], v[68:71]
    v_add_f32 v92, v92, v36
    v_add_f32 v93, v93, v37
    v_add_f32 v94, v94, v38
    v_add_f32 v95, v95, v39
    v_mfma_f32_16x16x32_bf16 v[72:75], v[252:255], v[28:31], v[72:75]
    v_add_f32 v92, v92, v40
    v_add_f32 v93, v93, v41
    v_add_f32 v94, v94, v42
    v_add_f32 v95, v95, v43
    buffer_store_dwordx4 v[76:79], v44, s[8:11], s6 offen sc1
    s_cmp_lg_u32 s71, 1
    s_cbranch_scc1 L_nost_57
    buffer_store_dwordx4 v[92:95], v52, s[8:11], s6 offen sc1
L_nost_57:
    s_nop 0
    ds_read_b128 v[28:31], v4 offset:3072
    v_mfma_f32_16x16x32_bf16 v[76:79], v[96:99], v[16:19], 0
    v_mfma_f32_16x16x32_bf16 v[80:83], v[100:103], v[16:19], 0
    s_sub_u32 s6, s71, 3
    s_and_b32 s6, s6, 3
    s_mul_i32 s7, s6, 5120
    v_mfma_f32_16x16x32_bf16 v[84:87], v[104:107], v[16:19], 0
    s_add_u32 s7, s7, s67
    s_cmp_eq_u32 s6, 3
    s_cselect_b32 s7, 155648, s7
    v_mfma_f32_16x16x32_bf16 v[88:91], v[108:111], v[16:19], 0
    v_add_u32 v12, s7, v52
    v_mfma_f32_16x16x32_bf16 v[92:95], v[112:115], v[16:19], 0
    v_add_u32 v5, s67, v45
    ds_read_b128 v[16:19], v4 offset:4096
    v_mfma_f32_16x16x32_bf16 v[76:79], v[116:119], v[20:23], v[76:79]
    ds_write_b128 v5, v[60:63] offset:0
    v_add_u32 v5, s67, v46
    v_mfma_f32_16x16x32_bf16 v[80:83], v[120:123], v[20:23], v[80:83]
    v_mfma_f32_16x16x32_bf16 v[84:87], v[124:127], v[20:23], v[84:87]
    v_mfma_f32_16x16x32_bf16 v[88:91], v[128:131], v[20:23], v[88:91]
    v_mfma_f32_16x16x32_bf16 v[92:95], v[132:135], v[20:23], v[92:95]
    ds_read_b128 v[20:23], v4 offset:5120
    s_waitcnt lgkmcnt(4)
    v_mfma_f32_16x16x32_bf16 v[76:79], v[136:139], v[24:27], v[76:79]
    ds_write_b128 v5, v[64:67] offset:5120
    v_add_u32 v5, s67, v47
    v_mfma_f32_16x16x32_bf16 v[80:83], v[140:143], v[24:27], v[80:83]
    v_mfma_f32_16x16x32_bf16 v[84:87], v[144:147], v[24:27], v[84:87]
    v_mfma_f32_16x16x32_bf16 v[88:91], v[148:151], v[24:27], v[88:91]
    v_mfma_f32_16x16x32_bf16 v[92:95], v[152:155], v[24:27], v[92:95]
    ds_read_b128 v[24:27], v4 offset:6144
    s_waitcnt lgkmcnt(5)
    v_mfma_f32_16x16x32_bf16 v[76:79], v[156:159], v[28:31], v[76:79]
    ds_write_b128 v5, v[68:71] offset:10240
    v_add_u32 v5, s67, v52
    v_mfma_f32_16x16x32_bf16 v[80:83], v[160:163], v[28:31], v[80:83]
    v_mfma_f32_16x16x32_bf16 v[84:87], v[164:167], v[28:31], v[84:87]
    v_mfma_f32_16x16x32_bf16 v[88:91], v[168:171], v[28:31], v[88:91]
    v_mfma_f32_16x16x32_bf16 v[92:95], v[172:175], v[28:31], v[92:95]
    ds_read_b128 v[28:31], v4 offset:7168
    s_waitcnt lgkmcnt(6)
    v_mfma_f32_16x16x32_bf16 v[76:79], v[176:179], v[16:19], v[76:79]
    ds_write_b128 v12, v[72:75] offset:0
    v_mfma_f32_16x16x32_bf16 v[80:83], v[180:183], v[16:19], v[80:83]
    v_mfma_f32_16x16x32_bf16 v[84:87], v[184:187], v[16:19], v[84:87]
    v_mfma_f32_16x16x32_bf16 v[88:91], v[188:191], v[16:19], v[88:91]
    v_mfma_f32_16x16x32_bf16 v[92:95], v[192:195], v[16:19], v[92:95]
    s_waitcnt lgkmcnt(5)
    v_mfma_f32_16x16x32_bf16 v[76:79], v[196:199], v[20:23], v[76:79]
    v_mfma_f32_16x16x32_bf16 v[80:83], v[200:203], v[20:23], v[80:83]
    v_mfma_f32_16x16x32_bf16 v[84:87], v[204:207], v[20:23], v[84:87]
    v_mfma_f32_16x16x32_bf16 v[88:91], v[208:211], v[20:23], v[88:91]
    v_mfma_f32_16x16x32_bf16 v[92:95], v[212:215], v[20:23], v[92:95]
    s_waitcnt vmcnt(5)
    s_waitcnt lgkmcnt(0)
    s_barrier
    ds_read_b128 v[32:35], v6 offset:0
    ds_read_b128 v[36:39], v6 offset:5120
    ds_read_b128 v[40:43], v6 offset:10240
    ds_read_b128 v[16:19], v4 offset:32768
    ds_read_b128 v[20:23], v4 offset:33792
    v_mfma_f32_16x16x32_bf16 v[76:79], v[216:219], v[24:27], v[76:79]
    s_add_u32 s65, s68, 0
    s_and_b32 s65, s65, 3
    s_andn2_b32 s7, s68, 3
    s_add_u32 s65, s65, s7
    s_lshl_b32 s65, s65, 17
    s_add_u32 s65, s65, s66
    s_add_u32 m0, s99, 0
    s_add_u32 s65, s65, 0
    buffer_load_dwordx4 v13, s[8:11], s65 offen offset:0 sc1 lds
    v_mfma_f32_16x16x32_bf16 v[80:83], v[220:223], v[24:27], v[80:83]
    buffer_load_dwordx4 v13, s[8:11], s65 offen offset:1024 sc1 lds
    s_waitcnt lgkmcnt(2)
    v_mfma_f32_16x16x32_bf16 v[84:87], v[224:227], v[24:27], v[84:87]
    v_add_f32 v56, v56, v32
    v_add_f32 v57, v57, v33
    v_add_f32 v58, v58, v34
    v_add_f32 v59, v59, v35
    v_mfma_f32_16x16x32_bf16 v[88:91], v[228:231], v[24:27], v[88:91]
    v_add_f32 v56, v56, v36
    v_add_f32 v57, v57, v37
    v_add_f32 v58, v58, v38
    v_add_f32 v59, v59, v39
    v_mfma_f32_16x16x32_bf16 v[92:95], v[232:235], v[24:27], v[92:95]
    v_add_f32 v56, v56, v40
    v_add_f32 v57, v57, v41
    v_add_f32 v58, v58, v42
    v_add_f32 v59, v59, v43
    ds_read_b128 v[32:35], v5 offset:0
    ds_read_b128 v[36:39], v5 offset:5120
    ds_read_b128 v[40:43], v5 offset:10240
    ds_read_b128 v[24:27], v4 offset:34816
    v_mfma_f32_16x16x32_bf16 v[76:79], v[236:239], v[28:31], v[76:79]
    buffer_load_dwordx4 v13, s[8:11], s65 offen offset:2048 sc1 lds
    s_add_u32 s6, s98, 0
    v_mfma_f32_16x16x32_bf16 v[80:83], v[240:243], v[28:31], v[80:83]
    buffer_load_dwordx4 v13, s[8:11], s65 offen offset:3072 sc1 lds
    s_waitcnt lgkmcnt(1)
    v_mfma_f32_16x16x32_bf16 v[84:87], v[244:247], v[28:31], v[84:87]
    v_add_f32 v72, v72, v32
    v_add_f32 v73, v73, v33
    v_add_f32 v74, v74, v34
    v_add_f32 v75, v75, v35
    v_mfma_f32_16x16x32_bf16 v[88:91], v[248:251], v[28:31], v[88:91]
    v_add_f32 v72, v72, v36
    v_add_f32 v73, v73, v37
    v_add_f32 v74, v74, v38
    v_add_f32 v75, v75, v39
    v_mfma_f32_16x16x32_bf16 v[92:95], v[252:255], v[28:31], v[92:95]
    v_add_f32 v72, v72, v40
    v_add_f32 v73, v73, v41
    v_add_f32 v74, v74, v42
    v_add_f32 v75, v75, v43
    buffer_store_dwordx4 v[56:59], v44, s[8:11], s6 offen sc1
    s_cmp_lg_u32 s71, 2
    s_cbranch_scc1 L_nost_58
    buffer_store_dwordx4 v[72:75], v52, s[8:11], s6 offen sc1
L_nost_58:
    s_nop 0
    ds_read_b128 v[28:31], v4 offset:35840
    v_mfma_f32_16x16x32_bf16 v[56:59], v[96:99], v[16:19], 0
    v_mfma_f32_16x16x32_bf16 v[60:63], v[100:103], v[16:19], 0
    s_sub_u32 s6, s71, 4
    s_and_b32 s6, s6, 3
    s_mul_i32 s7, s6, 5120
    v_mfma_f32_16x16x32_bf16 v[64:67], v[104:107], v[16:19], 0
    s_add_u32 s7, s7, s67
    s_cmp_eq_u32 s6, 3
    s_cselect_b32 s7, 124928, s7
    v_mfma_f32_16x16x32_bf16 v[68:71], v[108:111], v[16:19], 0
    v_add_u32 v12, s7, v52
    v_mfma_f32_16x16x32_bf16 v[72:75], v[112:115], v[16:19], 0
    v_add_u32 v5, s67, v45
    ds_read_b128 v[16:19], v4 offset:36864
    v_mfma_f32_16x16x32_bf16 v[56:59], v[116:119], v[20:23], v[56:59]
    ds_write_b128 v5, v[80:83] offset:30720
    v_add_u32 v5, s67, v46
    v_mfma_f32_16x16x32_bf16 v[60:63], v[120:123], v[20:23], v[60:63]
    v_mfma_f32_16x16x32_bf16 v[64:67], v[124:127], v[20:23], v[64:67]
    v_mfma_f32_16x16x32_bf16 v[68:71], v[128:131], v[20:23], v[68:71]
    v_mfma_f32_16x16x32_bf16 v[72:75], v[132:135], v[20:23], v[72:75]
    ds_read_b128 v[20:23], v4 offset:37888
    s_waitcnt lgkmcnt(4)
    v_mfma_f32_16x16x32_bf16 v[56:59], v[136:139], v[24:27], v[56:59]
    ds_write_b128 v5, v[84:87] offset:35840
    v_add_u32 v5, s67, v47
    v_mfma_f32_16x16x32_bf16 v[60:63], v[140:143], v[24:27], v[60:63]
    v_mfma_f32_16x16x32_bf16 v[64:67], v[144:147], v[24:27], v[64:67]
    v_mfma_f32_16x16x32_bf16 v[68:71], v[148:151], v[24:27], v[68:71]
    v_mfma_f32_16x16x32_bf16 v[72:75], v[152:155], v[24:27], v[72:75]
    ds_read_b128 v[24:27], v4 offset:38912
    s_waitcnt lgkmcnt(5)
    v_mfma_f32_16x16x32_bf16 v[56:59], v[156:159], v[28:31], v[56:59]
    ds_write_b128 v5, v[88:91] offset:40960
    v_add_u32 v5, s67, v52
    v_mfma_f32_16x16x32_bf16 v[60:63], v[160:163], v[28:31], v[60:63]
    v_mfma_f32_16x16x32_bf16 v[64:67], v[164:167], v[28:31], v[64:67]
    v_mfma_f32_16x16x32_bf16 v[68:71], v[168:171], v[28:31], v[68:71]
    v_mfma_f32_16x16x32_bf16 v[72:75], v[172:175], v[28:31], v[72:75]
    ds_read_b128 v[28:31], v4 offset:39936
    s_waitcnt lgkmcnt(6)
    v_mfma_f32_16x16x32_bf16 v[56:59], v[176:179], v[16:19], v[56:59]
    ds_write_b128 v12, v[92:95] offset:30720
    v_mfma_f32_16x16x32_bf16 v[60:63], v[180:183], v[16:19], v[60:63]
    v_mfma_f32_16x16x32_bf16 v[64:67], v[184:187], v[16:19], v[64:67]
    v_mfma_f32_16x16x32_bf16 v[68:71], v[188:191], v[16:19], v[68:71]
    v_mfma_f32_16x16x32_bf16 v[72:75], v[192:195], v[16:19], v[72:75]
    s_waitcnt lgkmcnt(5)
    v_mfma_f32_16x16x32_bf16 v[56:59], v[196:199], v[20:23], v[56:59]
    v_mfma_f32_16x16x32_bf16 v[60:63], v[200:203], v[20:23], v[60:63]
    v_mfma_f32_16x16x32_bf16 v[64:67], v[204:207], v[20:23], v[64:67]
    v_mfma_f32_16x16x32_bf16 v[68:71], v[208:211], v[20:23], v[68:71]
    v_mfma_f32_16x16x32_bf16 v[72:75], v[212:215], v[20:23], v[72:75]
    s_waitcnt vmcnt(5)
    s_waitcnt lgkmcnt(0)
    s_barrier
    ds_read_b128 v[32:35], v6 offset:30720
    ds_read_b128 v[36:39], v6 offset:35840
    ds_read_b128 v[40:43], v6 offset:40960
    ds_read_b128 v[16:19], v7 offset:0
    ds_read_b128 v[20:23], v7 offset:1024
    v_mfma_f32_16x16x32_bf16 v[56:59], v[216:219], v[24:27], v[56:59]
    s_add_u32 s65, s61, 0
    s_and_b32 s65, s65, 3
    s_andn2_b32 s7, s61, 3
    s_add_u32 s65, s65, s7
    s_lshl_b32 s65, s65, 17
    s_add_u32 s65, s65, s66
    s_add_u32 m0, s99, 32768
    s_add_u32 s65, s65, 0
    buffer_load_dwordx4 v13, s[8:11], s65 offen offset:0 sc1 lds
    v_mfma_f32_16x16x32_bf16 v[60:63], v[220:223], v[24:27], v[60:63]
    buffer_load_dwordx4 v13, s[8:11], s65 offen offset:1024 sc1 lds
    s_waitcnt lgkmcnt(2)
    v_mfma_f32_16x16x32_bf16 v[64:67], v[224:227], v[24:27], v[64:67]
    v_add_f32 v76, v76, v32
    v_add_f32 v77, v77, v33
    v_add_f32 v78, v78, v34
    v_add_f32 v79, v79, v35
    v_mfma_f32_16x16x32_bf16 v[68:71], v[228:231], v[24:27], v[68:71]
    v_add_f32 v76, v76, v36
    v_add_f32 v77, v77, v37
    v_add_f32 v78, v78, v38
    v_add_f32 v79, v79, v39
    v_mfma_f32_16x16x32_bf16 v[72:75], v[232:235], v[24:27], v[72:75]
    v_add_f32 v76, v76, v40
    v_add_f32 v77, v77, v41
    v_add_f32 v78, v78, v42
    v_add_f32 v79, v79, v43
    ds_read_b128 v[32:35], v5 offset:30720
    ds_read_b128 v[36:39], v5 offset:35840
    ds_read_b128 v[40:43], v5 offset:40960
    ds_read_b128 v[24:27], v7 offset:2048
    v_mfma_f32_16x16x32_bf16 v[56:59], v[236:239], v[28:31], v[56:59]
    buffer_load_dwordx4 v13, s[8:11], s65 offen offset:2048 sc1 lds
    s_add_u32 s6, s96, 10240
    v_mfma_f32_16x16x32_bf16 v[60:63], v[240:243], v[28:31], v[60:63]
    buffer_load_dwordx4 v13, s[8:11], s65 offen offset:3072 sc1 lds
    s_waitcnt lgkmcnt(1)
    v_mfma_f32_16x16x32_bf16 v[64:67], v[244:247], v[28:31], v[64:67]
    v_add_f32 v92, v92, v32
    v_add_f32 v93, v93, v33
    v_add_f32 v94, v94, v34
    v_add_f32 v95, v95, v35
    v_mfma_f32_16x16x32_bf16 v[68:71], v[248:251], v[28:31], v[68:71]
    v_add_f32 v92, v92, v36
    v_add_f32 v93, v93, v37
    v_add_f32 v94, v94, v38
    v_add_f32 v95, v95, v39
    v_mfma_f32_16x16x32_bf16 v[72:75], v[252:255], v[28:31], v[72:75]
    v_add_f32 v92, v92, v40
    v_add_f32 v93, v93, v41
    v_add_f32 v94, v94, v42
    v_add_f32 v95, v95, v43
    buffer_store_dwordx4 v[76:79], v44, s[8:11], s6 offen sc1
    s_cmp_lg_u32 s71, 3
    s_cbranch_scc1 L_nost_59
    buffer_store_dwordx4 v[92:95], v52, s[8:11], s6 offen sc1
L_nost_59:
    s_nop 0
    ds_read_b128 v[28:31], v7 offset:3072
    v_mfma_f32_16x16x32_bf16 v[76:79], v[96:99], v[16:19], 0
    v_mfma_f32_16x16x32_bf16 v[80:83], v[100:103], v[16:19], 0
    s_sub_u32 s6, s71, 5
    s_and_b32 s6, s6, 3
    s_mul_i32 s7, s6, 5120
    v_mfma_f32_16x16x32_bf16 v[84:87], v[104:107], v[16:19], 0
    s_add_u32 s7, s7, s67
    s_cmp_eq_u32 s6, 3
    s_cselect_b32 s7, 155648, s7
    v_mfma_f32_16x16x32_bf16 v[88:91], v[108:111], v[16:19], 0
    v_add_u32 v12, s7, v52
    v_mfma_f32_16x16x32_bf16 v[92:95], v[112:115], v[16:19], 0
    v_add_u32 v5, s67, v45
    ds_read_b128 v[16:19], v7 offset:4096
    v_mfma_f32_16x16x32_bf16 v[76:79], v[116:119], v[20:23], v[76:79]
    ds_write_b128 v5, v[60:63] offset:0
    v_add_u32 v5, s67, v46
    v_mfma_f32_16x16x32_bf16 v[80:83], v[120:123], v[20:23], v[80:83]
    v_mfma_f32_16x16x32_bf16 v[84:87], v[124:127], v[20:23], v[84:87]
    v_mfma_f32_16x16x32_bf16 v[88:91], v[128:131], v[20:23], v[88:91]
    v_mfma_f32_16x16x32_bf16 v[92:95], v[132:135], v[20:23], v[92:95]
    ds_read_b128 v[20:23], v7 offset:5120
    s_waitcnt lgkmcnt(4)
    v_mfma_f32_16x16x32_bf16 v[76:79], v[136:139], v[24:27], v[76:79]
    ds_write_b128 v5, v[64:67] offset:5120
    v_add_u32 v5, s67, v47
    v_mfma_f32_16x16x32_bf16 v[80:83], v[140:143], v[24:27], v[80:83]
    v_mfma_f32_16x16x32_bf16 v[84:87], v[144:147], v[24:27], v[84:87]
    v_mfma_f32_16x16x32_bf16 v[88:91], v[148:151], v[24:27], v[88:91]
    v_mfma_f32_16x16x32_bf16 v[92:95], v[152:155], v[24:27], v[92:95]
    ds_read_b128 v[24:27], v7 offset:6144
    s_waitcnt lgkmcnt(5)
    v_mfma_f32_16x16x32_bf16 v[76:79], v[156:159], v[28:31], v[76:79]
    ds_write_b128 v5, v[68:71] offset:10240
    v_add_u32 v5, s67, v52
    v_mfma_f32_16x16x32_bf16 v[80:83], v[160:163], v[28:31], v[80:83]
    v_mfma_f32_16x16x32_bf16 v[84:87], v[164:167], v[28:31], v[84:87]
    v_mfma_f32_16x16x32_bf16 v[88:91], v[168:171], v[28:31], v[88:91]
    v_mfma_f32_16x16x32_bf16 v[92:95], v[172:175], v[28:31], v[92:95]
    ds_read_b128 v[28:31], v7 offset:7168
    s_waitcnt lgkmcnt(6)
    v_mfma_f32_16x16x32_bf16 v[76:79], v[176:179], v[16:19], v[76:79]
    ds_write_b128 v12, v[72:75] offset:0
    v_mfma_f32_16x16x32_bf16 v[80:83], v[180:183], v[16:19], v[80:83]
    v_mfma_f32_16x16x32_bf16 v[84:87], v[184:187], v[16:19], v[84:87]
    v_mfma_f32_16x16x32_bf16 v[88:91], v[188:191], v[16:19], v[88:91]
    v_mfma_f32_16x16x32_bf16 v[92:95], v[192:195], v[16:19], v[92:95]
    s_waitcnt lgkmcnt(5)
    v_mfma_f32_16x16x32_bf16 v[76:79], v[196:199], v[20:23], v[76:79]
    v_mfma_f32_16x16x32_bf16 v[80:83], v[200:203], v[20:23], v[80:83]
    v_mfma_f32_16x16x32_bf16 v[84:87], v[204:207], v[20:23], v[84:87]
    v_mfma_f32_16x16x32_bf16 v[88:91], v[208:211], v[20:23], v[88:91]
    v_mfma_f32_16x16x32_bf16 v[92:95], v[212:215], v[20:23], v[92:95]
    s_waitcnt vmcnt(5)
    s_waitcnt lgkmcnt(0)
    s_barrier
    ds_read_b128 v[32:35], v6 offset:0
    ds_read_b128 v[36:39], v6 offset:5120
    ds_read_b128 v[40:43], v6 offset:10240
    ds_read_b128 v[16:19], v4 offset:0
    ds_read_b128 v[20:23], v4 offset:1024
    v_mfma_f32_16x16x32_bf16 v[76:79], v[216:219], v[24:27], v[76:79]
    v_mfma_f32_16x16x32_bf16 v[80:83], v[220:223], v[24:27], v[80:83]
    s_waitcnt lgkmcnt(2)
    v_mfma_f32_16x16x32_bf16 v[84:87], v[224:227], v[24:27], v[84:87]
    v_add_f32 v56, v56, v32
    v_add_f32 v57, v57, v33
    v_add_f32 v58, v58, v34
    v_add_f32 v59, v59, v35
    v_mfma_f32_16x16x32_bf16 v[88:91], v[228:231], v[24:27], v[88:91]
    v_add_f32 v56, v56, v36
    v_add_f32 v57, v57, v37
    v_add_f32 v58, v58, v38
    v_add_f32 v59, v59, v39
    v_mfma_f32_16x16x32_bf16 v[92:95], v[232:235], v[24:27], v[92:95]
    v_add_f32 v56, v56, v40
    v_add_f32 v57, v57, v41
    v_add_f32 v58, v58, v42
    v_add_f32 v59, v59, v43
    ds_read_b128 v[32:35], v5 offset:0
    ds_read_b128 v[36:39], v5 offset:5120
    ds_read_b128 v[40:43], v5 offset:10240
    ds_read_b128 v[24:27], v4 offset:2048
    v_mfma_f32_16x16x32_bf16 v[76:79], v[236:239], v[28:31], v[76:79]
    s_add_u32 s6, s97, 10240
    v_mfma_f32_16x16x32_bf16 v[80:83], v[240:243], v[28:31], v[80:83]
    s_waitcnt lgkmcnt(1)
    v_mfma_f32_16x16x32_bf16 v[84:87], v[244:247], v[28:31], v[84:87]
    v_add_f32 v72, v72, v32
    v_add_f32 v73, v73, v33
    v_add_f32 v74, v74, v34
    v_add_f32 v75, v75, v35
    v_mfma_f32_16x16x32_bf16 v[88:91], v[248:251], v[28:31], v[88:91]
    v_add_f32 v72, v72, v36
    v_add_f32 v73, v73, v37
    v_add_f32 v74, v74, v38
    v_add_f32 v75, v75, v39
    v_mfma_f32_16x16x32_bf16 v[92:95], v[252:255], v[28:31], v[92:95]
    v_add_f32 v72, v72, v40
    v_add_f32 v73, v73, v41
    v_add_f32 v74, v74, v42
    v_add_f32 v75, v75, v43
    buffer_store_dwordx4 v[56:59], v44, s[8:11], s6 offen sc1
    s_cmp_lg_u32 s71, 0
    s_cbranch_scc1 L_nost_60
    buffer_store_dwordx4 v[72:75], v52, s[8:11], s6 offen sc1
L_nost_60:
    s_nop 0
    ds_read_b128 v[28:31], v4 offset:3072
    v_mfma_f32_16x16x32_bf16 v[56:59], v[96:99], v[16:19], 0
    v_mfma_f32_16x16x32_bf16 v[60:63], v[100:103], v[16:19], 0
    s_sub_u32 s6, s71, 6
    s_and_b32 s6, s6, 3
    s_mul_i32 s7, s6, 5120
    v_mfma_f32_16x16x32_bf16 v[64:67], v[104:107], v[16:19], 0
    s_add_u32 s7, s7, s67
    s_cmp_eq_u32 s6, 3
    s_cselect_b32 s7, 124928, s7
    v_mfma_f32_16x16x32_bf16 v[68:71], v[108:111], v[16:19], 0
    v_add_u32 v12, s7, v52
    v_mfma_f32_16x16x32_bf16 v[72:75], v[112:115], v[16:19], 0
    v_add_u32 v5, s67, v45
    ds_read_b128 v[16:19], v4 offset:4096
    v_mfma_f32_16x16x32_bf16 v[56:59], v[116:119], v[20:23], v[56:59]
    ds_write_b128 v5, v[80:83] offset:30720
    v_add_u32 v5, s67, v46
    v_mfma_f32_16x16x32_bf16 v[60:63], v[120:123], v[20:23], v[60:63]
    v_mfma_f32_16x16x32_bf16 v[64:67], v[124:127], v[20:23], v[64:67]
    v_mfma_f32_16x16x32_bf16 v[68:71], v[128:131], v[20:23], v[68:71]
    ds_write_b128 v5, v[84:87] offset:35840
    v_add_u32 v5, s67, v47
    v_mfma_f32_16x16x32_bf16 v[72:75], v[132:135], v[20:23], v[72:75]
    ds_read_b128 v[20:23], v4 offset:5120
    s_waitcnt lgkmcnt(5)
    v_mfma_f32_16x16x32_bf16 v[56:59], v[136:139], v[24:27], v[56:59]
    v_mfma_f32_16x16x32_bf16 v[60:63], v[140:143], v[24:27], v[60:63]
    ds_write_b128 v5, v[88:91] offset:40960
    v_add_u32 v5, s67, v52
    v_mfma_f32_16x16x32_bf16 v[64:67], v[144:147], v[24:27], v[64:67]
    v_mfma_f32_16x16x32_bf16 v[68:71], v[148:151], v[24:27], v[68:71]
    v_mfma_f32_16x16x32_bf16 v[72:75], v[152:155], v[24:27], v[72:75]
    ds_write_b128 v12, v[92:95] offset:30720
    ds_read_b128 v[24:27], v4 offset:6144
    s_waitcnt lgkmcnt(7)
    v_mfma_f32_16x16x32_bf16 v[56:59], v[156:159], v[28:31], v[56:59]
    v_mfma_f32_16x16x32_bf16 v[60:63], v[160:163], v[28:31], v[60:63]
    v_mfma_f32_16x16x32_bf16 v[64:67], v[164:167], v[28:31], v[64:67]
    v_mfma_f32_16x16x32_bf16 v[68:71], v[168:171], v[28:31], v[68:71]
    v_mfma_f32_16x16x32_bf16 v[72:75], v[172:175], v[28:31], v[72:75]
    ds_read_b128 v[28:31], v4 offset:7168
    s_waitcnt vmcnt(1)
    v_mov_b32 v3, 0x5000000
    s_and_b32 s6, s4, 7
    s_lshl_b32 s7, s5, 3
    s_add_u32 s6, s6, s7
    s_lshr_b32 s7, s4, 3
    s_add_u32 s7, s7, 0
    s_add_u32 s7, s7, 1
    s_and_b32 s7, s7, 3
    s_lshl_b32 s6, s6, 2
    s_add_u32 s6, s6, s7
    s_mul_i32 s6, s6, 3
    s_add_u32 s6, s6, 0
    s_lshl_b32 s6, s6, 5
    s_add_u32 s6, s6, s3
    s_lshl_b32 s6, s6, 2
    s_add_u32 s6, s6, 15728640
    v_writelane_b32 v3, s6, 0
    v_writelane_b32 v2, 2, 0
    s_and_b32 s6, s4, 7
    s_lshl_b32 s7, s5, 3
    s_add_u32 s6, s6, s7
    s_lshr_b32 s7, s4, 3
    s_add_u32 s7, s7, 1
    s_add_u32 s7, s7, 1
    s_and_b32 s7, s7, 3
    s_lshl_b32 s6, s6, 2
    s_add_u32 s6, s6, s7
    s_mul_i32 s6, s6, 3
    s_add_u32 s6, s6, 1
    s_lshl_b32 s6, s6, 5
    s_add_u32 s6, s6, s3
    s_lshl_b32 s6, s6, 2
    s_add_u32 s6, s6, 15728640
    v_writelane_b32 v3, s6, 1
    v_writelane_b32 v2, 1, 1
    s_and_b32 s6, s4, 7
    s_lshl_b32 s7, s5, 3
    s_add_u32 s6, s6, s7
    s_lshr_b32 s7, s4, 3
    s_add_u32 s7, s7, 2
    s_add_u32 s7, s7, 1
    s_and_b32 s7, s7, 3
    s_lshl_b32 s6, s6, 2
    s_add_u32 s6, s6, s7
    s_mul_i32 s6, s6, 3
    s_add_u32 s6, s6, 2
    s_lshl_b32 s6, s6, 5
    s_add_u32 s6, s6, s3
    s_lshl_b32 s6, s6, 2
    s_add_u32 s6, s6, 15728640
    v_writelane_b32 v3, s6, 2
    v_writelane_b32 v2, 1, 2
    buffer_store_dword v2, v3, s[8:11], 0 offen sc1
    s_waitcnt lgkmcnt(0)
    s_barrier
    ds_read_b128 v[32:35], v6 offset:30720
    ds_read_b128 v[36:39], v6 offset:35840
    ds_read_b128 v[40:43], v6 offset:40960
    v_mfma_f32_16x16x32_bf16 v[56:59], v[176:179], v[16:19], v[56:59]
    v_mfma_f32_16x16x32_bf16 v[60:63], v[180:183], v[16:19], v[60:63]
    s_waitcnt lgkmcnt(0)
    v_mfma_f32_16x16x32_bf16 v[64:67], v[184:187], v[16:19], v[64:67]
    v_add_f32 v76, v76, v32
    v_add_f32 v77, v77, v33
    v_add_f32 v78, v78, v34
    v_add_f32 v79, v79, v35
    v_mfma_f32_16x16x32_bf16 v[68:71], v[188:191], v[16:19], v[68:71]
    v_add_f32 v76, v76, v36
    v_add_f32 v77, v77, v37
    v_add_f32 v78, v78, v38
    v_add_f32 v79, v79, v39
    v_mfma_f32_16x16x32_bf16 v[72:75], v[192:195], v[16:19], v[72:75]
    v_add_f32 v76, v76, v40
    v_add_f32 v77, v77, v41
    v_add_f32 v78, v78, v42
    v_add_f32 v79, v79, v43
    ds_read_b128 v[32:35], v5 offset:30720
    ds_read_b128 v[36:39], v5 offset:35840
    ds_read_b128 v[40:43], v5 offset:40960
    v_mfma_f32_16x16x32_bf16 v[56:59], v[196:199], v[20:23], v[56:59]
    s_add_u32 s6, s98, 10240
    v_mfma_f32_16x16x32_bf16 v[60:63], v[200:203], v[20:23], v[60:63]
    s_waitcnt lgkmcnt(0)
    v_mfma_f32_16x16x32_bf16 v[64:67], v[204:207], v[20:23], v[64:67]
    v_add_f32 v92, v92, v32
    v_add_f32 v93, v93, v33
    v_add_f32 v94, v94, v34
    v_add_f32 v95, v95, v35
    v_mfma_f32_16x16x32_bf16 v[68:71], v[208:211], v[20:23], v[68:71]
    v_add_f32 v92, v92, v36
    v_add_f32 v93, v93, v37
    v_add_f32 v94, v94, v38
    v_add_f32 v95, v95, v39
    v_mfma_f32_16x16x32_bf16 v[72:75], v[212:215], v[20:23], v[72:75]
    v_add_f32 v92, v92, v40
    v_add_f32 v93, v93, v41
    v_add_f32 v94, v94, v42
    v_add_f32 v95, v95, v43
    buffer_store_dwordx4 v[76:79], v44, s[8:11], s6 offen sc1
    s_cmp_lg_u32 s71, 1
    s_cbranch_scc1 L_nost_61
    buffer_store_dwordx4 v[92:95], v52, s[8:11], s6 offen sc1
L_nost_61:
    s_nop 0
    s_waitcnt lgkmcnt(0)
    s_barrier
    ds_read_b128 v[16:19], v4 offset:32768
    ds_read_b128 v[20:23], v4 offset:33792
    v_mfma_f32_16x16x32_bf16 v[56:59], v[216:219], v[24:27], v[56:59]
    v_mfma_f32_16x16x32_bf16 v[60:63], v[220:223], v[24:27], v[60:63]
    v_mfma_f32_16x16x32_bf16 v[64:67], v[224:227], v[24:27], v[64:67]
    v_mfma_f32_16x16x32_bf16 v[68:71], v[228:231], v[24:27], v[68:71]
    v_mfma_f32_16x16x32_bf16 v[72:75], v[232:235], v[24:27], v[72:75]
    ds_read_b128 v[24:27], v4 offset:34816
    v_mfma_f32_16x16x32_bf16 v[56:59], v[236:239], v[28:31], v[56:59]
    v_mfma_f32_16x16x32_bf16 v[60:63], v[240:243], v[28:31], v[60:63]
    v_mfma_f32_16x16x32_bf16 v[64:67], v[244:247], v[28:31], v[64:67]
    v_mfma_f32_16x16x32_bf16 v[68:71], v[248:251], v[28:31], v[68:71]
    v_mfma_f32_16x16x32_bf16 v[72:75], v[252:255], v[28:31], v[72:75]
    ds_read_b128 v[28:31], v4 offset:35840
    s_waitcnt lgkmcnt(3)
    v_mfma_f32_16x16x32_bf16 v[76:79], v[96:99], v[16:19], 0
    v_mfma_f32_16x16x32_bf16 v[80:83], v[100:103], v[16:19], 0
    v_mfma_f32_16x16x32_bf16 v[84:87], v[104:107], v[16:19], 0
    v_mfma_f32_16x16x32_bf16 v[88:91], v[108:111], v[16:19], 0
    s_mul_i32 s73, s3, 5120
    s_add_u32 s73, s73, 65536
    v_mfma_f32_16x16x32_bf16 v[92:95], v[112:115], v[16:19], 0
    v_add_u32 v5, s73, v44
    ds_read_b128 v[16:19], v4 offset:36864
    s_waitcnt lgkmcnt(3)
    v_mfma_f32_16x16x32_bf16 v[76:79], v[116:119], v[20:23], v[76:79]
    ds_write_b128 v5, v[56:59]
    v_add_u32 v5, s73, v45
    v_mfma_f32_16x16x32_bf16 v[80:83], v[120:123], v[20:23], v[80:83]
    v_mfma_f32_16x16x32_bf16 v[84:87], v[124:127], v[20:23], v[84:87]
    v_mfma_f32_16x16x32_bf16 v[88:91], v[128:131], v[20:23], v[88:91]
    v_mfma_f32_16x16x32_bf16 v[92:95], v[132:135], v[20:23], v[92:95]
    ds_read_b128 v[20:23], v4 offset:37888
    s_waitcnt lgkmcnt(4)
    v_mfma_f32_16x16x32_bf16 v[76:79], v[136:139], v[24:27], v[76:79]
    ds_write_b128 v5, v[60:63]
    v_add_u32 v5, s73, v46
    v_mfma_f32_16x16x32_bf16 v[80:83], v[140:143], v[24:27], v[80:83]
    v_mfma_f32_16x16x32_bf16 v[84:87], v[144:147], v[24:27], v[84:87]
    v_mfma_f32_16x16x32_bf16 v[88:91], v[148:151], v[24:27], v[88:91]
    v_mfma_f32_16x16x32_bf16 v[92:95], v[152:155], v[24:27], v[92:95]
    ds_read_b128 v[24:27], v4 offset:38912
    s_waitcnt vmcnt(0)
    v_mov_b32 v3, 0x5000000
    s_and_b32 s6, s4, 7
    s_lshl_b32 s7, s5, 3
    s_add_u32 s6, s6, s7
    s_lshr_b32 s7, s4, 3
    s_add_u32 s7, s7, 1
    s_add_u32 s7, s7, 1
    s_and_b32 s7, s7, 3
    s_lshl_b32 s6, s6, 2
    s_add_u32 s6, s6, s7
    s_mul_i32 s6, s6, 3
    s_add_u32 s6, s6, 1
    s_lshl_b32 s6, s6, 5
    s_add_u32 s6, s6, s3
    s_lshl_b32 s6, s6, 2
    s_add_u32 s6, s6, 15728640
    v_writelane_b32 v3, s6, 1
    v_writelane_b32 v2, 2, 1
    s_and_b32 s6, s4, 7
    s_lshl_b32 s7, s5, 3
    s_add_u32 s6, s6, s7
    s_lshr_b32 s7, s4, 3
    s_add_u32 s7, s7, 2
    s_add_u32 s7, s7, 1
    s_and_b32 s7, s7, 3
    s_lshl_b32 s6, s6, 2
    s_add_u32 s6, s6, s7
    s_mul_i32 s6, s6, 3
    s_add_u32 s6, s6, 2
    s_lshl_b32 s6, s6, 5
    s_add_u32 s6, s6, s3
    s_lshl_b32 s6, s6, 2
    s_add_u32 s6, s6, 15728640
    v_writelane_b32 v3, s6, 2
    v_writelane_b32 v2, 2, 2
    buffer_store_dword v2, v3, s[8:11], 0 offen sc1
    s_waitcnt lgkmcnt(5)
    v_mfma_f32_16x16x32_bf16 v[76:79], v[156:159], v[28:31], v[76:79]
    ds_write_b128 v5, v[64:67]
    v_add_u32 v5, s73, v47
    v_mfma_f32_16x16x32_bf16 v[80:83], v[160:163], v[28:31], v[80:83]
    v_mfma_f32_16x16x32_bf16 v[84:87], v[164:167], v[28:31], v[84:87]
    v_mfma_f32_16x16x32_bf16 v[88:91], v[168:171], v[28:31], v[88:91]
    v_mfma_f32_16x16x32_bf16 v[92:95], v[172:175], v[28:31], v[92:95]
    ds_read_b128 v[28:31], v4 offset:39936
    s_cmp_eq_u32 s64, 0
    s_cbranch_scc1 L_nb
    v_bfe_u32 v2, v1, 1, 3
    v_and_b32 v3, 1, v1
    v_lshl_add_u32 v3, v2, 3, v3
    v_lshlrev_b32 v3, 7, v3
    s_and_b32 s6, s4, 3
    s_lshl_b32 s6, s6, 8
    s_add_u32 s6, s6, 3915776
    s_mov_b32 s79, 262144
L_poll_62:
    buffer_load_dword v2, v3, s[8:11], s6 offen sc1
    s_waitcnt vmcnt(0)
    v_cmp_ne_u32 vcc, 1, v2
    s_cbranch_vccz L_polldone_63
    s_sleep 2
    s_sub_u32 s79, s79, 1
    s_cmp_lg_u32 s79, 0
    s_cbranch_scc1 L_poll_62
L_polldone_63:
L_nb:
    buffer_load_dwordx4 v[96:99], v53, s[12:15], s70 offen
    buffer_load_dwordx4 v[100:103], v48, s[8:11], 0 offen sc1
    s_cmp_ge_u32 s3, 2
    s_cbranch_scc1 L_itskip_64
    buffer_load_dwordx4 v[104:107], v54, s[12:15], s70 offen
    buffer_load_dwordx4 v[108:111], v49, s[8:11], 0 offen sc1
L_itskip_64:
    s_waitcnt lgkmcnt(6)
    v_mfma_f32_16x16x32_bf16 v[76:79], v[176:179], v[16:19], v[76:79]
    ds_write_b128 v5, v[68:71]
    v_add_u32 v5, s73, v52
    v_mfma_f32_16x16x32_bf16 v[80:83], v[180:183], v[16:19], v[80:83]
    v_mfma_f32_16x16x32_bf16 v[84:87], v[184:187], v[16:19], v[84:87]
    v_mfma_f32_16x16x32_bf16 v[88:91], v[188:191], v[16:19], v[88:91]
    v_mfma_f32_16x16x32_bf16 v[92:95], v[192:195], v[16:19], v[92:95]
    s_waitcnt lgkmcnt(5)
    v_mfma_f32_16x16x32_bf16 v[76:79], v[196:199], v[20:23], v[76:79]
    ds_write_b128 v5, v[72:75]
    v_mfma_f32_16x16x32_bf16 v[80:83], v[200:203], v[20:23], v[80:83]
    v_mfma_f32_16x16x32_bf16 v[84:87], v[204:207], v[20:23], v[84:87]
    v_mfma_f32_16x16x32_bf16 v[88:91], v[208:211], v[20:23], v[88:91]
    v_mfma_f32_16x16x32_bf16 v[92:95], v[212:215], v[20:23], v[92:95]
    s_and_b32 s72, s4, 7
    s_lshl_b32 s7, s5, 3
    s_add_u32 s72, s72, s7
    s_lshl_b32 s72, s72, 2
    s_lshr_b32 s7, s4, 3
    s_add_u32 s72, s72, s7
    s_mul_i32 s75, s72, 61440
    s_add_u32 s75, s75, 67108864
    s_mul_i32 s72, s72, 384
    s_add_u32 s72, s72, 15728640
    v_bfe_u32 v2, v1, 3, 2
    v_min_u32 v2, 2, v2
    v_and_b32 v3, 7, v1
    v_lshlrev_b32 v3, 2, v3
    v_lshl_add_u32 v3, v2, 7, v3
    s_bitcmp1_b32 13, s3
    s_cselect_b32 s77, 1, 2
    buffer_load_dword v50, v3, s[8:11], s72 offen sc1
    s_waitcnt lgkmcnt(4)
    v_mfma_f32_16x16x32_bf16 v[76:79], v[216:219], v[24:27], v[76:79]
    v_mfma_f32_16x16x32_bf16 v[80:83], v[220:223], v[24:27], v[80:83]
    v_mfma_f32_16x16x32_bf16 v[84:87], v[224:227], v[24:27], v[84:87]
    v_mfma_f32_16x16x32_bf16 v[88:91], v[228:231], v[24:27], v[88:91]
    v_mfma_f32_16x16x32_bf16 v[92:95], v[232:235], v[24:27], v[92:95]
    s_waitcnt lgkmcnt(2)
    v_mfma_f32_16x16x32_bf16 v[76:79], v[236:239], v[28:31], v[76:79]
    v_mfma_f32_16x16x32_bf16 v[80:83], v[240:243], v[28:31], v[80:83]
    v_mfma_f32_16x16x32_bf16 v[84:87], v[244:247], v[28:31], v[84:87]
    v_mfma_f32_16x16x32_bf16 v[88:91], v[248:251], v[28:31], v[88:91]
    v_mfma_f32_16x16x32_bf16 v[92:95], v[252:255], v[28:31], v[92:95]
    s_nop 7
    v_add_u32 v5, s73, v44
    ds_write_b128 v5, v[76:79] offset:40960
    v_add_u32 v5, s73, v45
    ds_write_b128 v5, v[80:83] offset:40960
    v_add_u32 v5, s73, v46
    ds_write_b128 v5, v[84:87] offset:40960
    v_add_u32 v5, s73, v47
    ds_write_b128 v5, v[88:91] offset:40960
    v_add_u32 v5, s73, v52
    ds_write_b128 v5, v[92:95] offset:40960
    s_waitcnt vmcnt(0)
    v_cmp_gt_u32 s[78:79], s77, v50
    s_nop 3
    s_cmp_lg_u64 s[78:79], 0
    s_cbranch_scc1 L_x2a
    s_add_u32 s6, s75, 0
    buffer_load_dwordx4 v[112:115], v8, s[8:11], s6 offen offset:0 sc1
    buffer_load_dwordx4 v[116:119], v8, s[8:11], s6 offen offset:256 sc1
    s_add_u32 s6, s75, 20480
    buffer_load_dwordx4 v[120:123], v8, s[8:11], s6 offen offset:0 sc1
    buffer_load_dwordx4 v[124:127], v8, s[8:11], s6 offen offset:256 sc1
    s_add_u32 s6, s75, 40960
    buffer_load_dwordx4 v[128:131], v8, s[8:11], s6 offen offset:0 sc1
    buffer_load_dwordx4 v[132:135], v8, s[8:11], s6 offen offset:256 sc1
    s_cmp_ge_u32 s3, 2
    s_cbranch_scc1 L_xi_65
    s_add_u32 s6, s75, 0
    buffer_load_dwordx4 v[136:139], v9, s[8:11], s6 offen offset:0 sc1
    buffer_load_dwordx4 v[140:143], v9, s[8:11], s6 offen offset:256 sc1
    s_add_u32 s6, s75, 20480
    buffer_load_dwordx4 v[144:147], v9, s[8:11], s6 offen offset:0 sc1
    buffer_load_dwordx4 v[148:151], v9, s[8:11], s6 offen offset:256 sc1
    s_add_u32 s6, s75, 40960
    buffer_load_dwordx4 v[152:155], v9, s[8:11], s6 offen offset:0 sc1
    buffer_load_dwordx4 v[156:159], v9, s[8:11], s6 offen offset:256 sc1
L_xi_65:
L_x2a:
    s_waitcnt lgkmcnt(0)
    s_barrier
    ds_read_b128 v[160:163], v10 offset:0
    ds_read_b128 v[164:167], v10 offset:256
    ds_read_b128 v[168:171], v10 offset:5120
    ds_read_b128 v[172:175], v10 offset:5376
    ds_read_b128 v[176:179], v10 offset:10240
    ds_read_b128 v[180:183], v10 offset:10496
    ds_read_b128 v[184:187], v10 offset:15360
    ds_read_b128 v[188:191], v10 offset:15616
    ds_read_b128 v[192:195], v55 offset:0
    ds_read_b128 v[196:199], v55 offset:256
    ds_read_b128 v[200:203], v55 offset:5120
    ds_read_b128 v[204:207], v55 offset:5376
    ds_read_b128 v[208:211], v55 offset:10240
    ds_read_b128 v[212:215], v55 offset:10496
    ds_read_b128 v[216:219], v55 offset:15360
    ds_read_b128 v[220:223], v55 offset:15616
    s_cmp_eq_u64 s[78:79], 0
    s_cbranch_scc1 L_x2b
    s_mov_b32 s79, 262144
L_poll_66:
    buffer_load_dword v2, v3, s[8:11], s72 offen sc1
    s_waitcnt vmcnt(0)
    v_cmp_gt_u32 vcc, s77, v2
    s_cbranch_vccz L_polldone_67
    s_sleep 1
    s_sub_u32 s79, s79, 1
    s_cmp_lg_u32 s79, 0
    s_cbranch_scc1 L_poll_66
L_polldone_67:
    s_add_u32 s6, s75, 0
    buffer_load_dwordx4 v[112:115], v8, s[8:11], s6 offen offset:0 sc1
    buffer_load_dwordx4 v[116:119], v8, s[8:11], s6 offen offset:256 sc1
    s_add_u32 s6, s75, 20480
    buffer_load_dwordx4 v[120:123], v8, s[8:11], s6 offen offset:0 sc1
    buffer_load_dwordx4 v[124:127], v8, s[8:11], s6 offen offset:256 sc1
    s_add_u32 s6, s75, 40960
    buffer_load_dwordx4 v[128:131], v8, s[8:11], s6 offen offset:0 sc1
    buffer_load_dwordx4 v[132:135], v8, s[8:11], s6 offen offset:256 sc1
    s_cmp_ge_u32 s3, 2
    s_cbranch_scc1 L_xi_68
    s_add_u32 s6, s75, 0
    buffer_load_dwordx4 v[136:139], v9, s[8:11], s6 offen offset:0 sc1
    buffer_load_dwordx4 v[140:143], v9, s[8:11], s6 offen offset:256 sc1
    s_add_u32 s6, s75, 20480
    buffer_load_dwordx4 v[144:147], v9, s[8:11], s6 offen offset:0 sc1
    buffer_load_dwordx4 v[148:151], v9, s[8:11], s6 offen offset:256 sc1
    s_add_u32 s6, s75, 40960
    buffer_load_dwordx4 v[152:155], v9, s[8:11], s6 offen offset:0 sc1
    buffer_load_dwordx4 v[156:159], v9, s[8:11], s6 offen offset:256 sc1
L_xi_68:
L_x2b:
    s_mov_b32 s16, s54
    s_mov_b32 s17, s55
    s_mov_b32 s18, 0x280000
    s_mov_b32 s19, 0x20000
    s_waitcnt lgkmcnt(8)
    v_pk_add_f32 v[160:161], v[160:161], v[168:169]
    v_pk_add_f32 v[162:163], v[162:163], v[170:171]
    v_pk_add_f32 v[164:165], v[164:165], v[172:173]
    v_pk_add_f32 v[166:167], v[166:167], v[174:175]
    v_pk_add_f32 v[160:161], v[160:161], v[176:177]
    v_pk_add_f32 v[162:163], v[162:163], v[178:179]
    v_pk_add_f32 v[164:165], v[164:165], v[180:181]
    v_pk_add_f32 v[166:167], v[166:167], v[182:183]
    v_pk_add_f32 v[160:161], v[160:161], v[184:185]
    v_pk_add_f32 v[162:163], v[162:163], v[186:187]
    v_pk_add_f32 v[164:165], v[164:165], v[188:189]
    v_pk_add_f32 v[166:167], v[166:167], v[190:191]
    s_waitcnt vmcnt(0)
    v_pk_add_f32 v[160:161], v[160:161], v[112:113]
    v_pk_add_f32 v[162:163], v[162:163], v[114:115]
    v_pk_add_f32 v[164:165], v[164:165], v[116:117]
    v_pk_add_f32 v[166:167], v[166:167], v[118:119]
    v_pk_add_f32 v[160:161], v[160:161], v[120:121]
    v_pk_add_f32 v[162:163], v[162:163], v[122:123]
    v_pk_add_f32 v[164:165], v[164:165], v[124:125]
    v_pk_add_f32 v[166:167], v[166:167], v[126:127]
    v_pk_add_f32 v[160:161], v[160:161], v[128:129]
    v_pk_add_f32 v[162:163], v[162:163], v[130:131]
    v_pk_add_f32 v[164:165], v[164:165], v[132:133]
    v_pk_add_f32 v[166:167], v[166:167], v[134:135]
    v_cvt_pk_bf16_f32 v2, v160, v161
    v_lshlrev_b32 v160, 16, v2
    v_and_b32 v161, 0xffff0000, v2
    v_lshlrev_b32 v2, 16, v96
    v_and_b32 v3, 0xffff0000, v96
    v_pk_add_f32 v[160:161], v[160:161], v[2:3]
    v_cvt_pk_bf16_f32 v2, v160, v161
    v_lshlrev_b32 v160, 16, v2
    v_and_b32 v161, 0xffff0000, v2
    v_lshlrev_b32 v2, 16, v100
    v_and_b32 v3, 0xffff0000, v100
    v_pk_add_f32 v[160:161], v[160:161], v[2:3]
    v_cvt_pk_bf16_f32 v224, v160, v161
    v_cvt_pk_bf16_f32 v2, v162, v163
    v_lshlrev_b32 v162, 16, v2
    v_and_b32 v163, 0xffff0000, v2
    v_lshlrev_b32 v2, 16, v97
    v_and_b32 v3, 0xffff0000, v97
    v_pk_add_f32 v[162:163], v[162:163], v[2:3]
    v_cvt_pk_bf16_f32 v2, v162, v163
    v_lshlrev_b32 v162, 16, v2
    v_and_b32 v163, 0xffff0000, v2
    v_lshlrev_b32 v2, 16, v101
    v_and_b32 v3, 0xffff0000, v101
    v_pk_add_f32 v[162:163], v[162:163], v[2:3]
    v_cvt_pk_bf16_f32 v225, v162, v163
    v_cvt_pk_bf16_f32 v2, v164, v165
    v_lshlrev_b32 v164, 16, v2
    v_and_b32 v165, 0xffff0000, v2
    v_lshlrev_b32 v2, 16, v98
    v_and_b32 v3, 0xffff0000, v98
    v_pk_add_f32 v[164:165], v[164:165], v[2:3]
    v_cvt_pk_bf16_f32 v2, v164, v165
    v_lshlrev_b32 v164, 16, v2
    v_and_b32 v165, 0xffff0000, v2
    v_lshlrev_b32 v2, 16, v102
    v_and_b32 v3, 0xffff0000, v102
    v_pk_add_f32 v[164:165], v[164:165], v[2:3]
    v_cvt_pk_bf16_f32 v226, v164, v165
    v_cvt_pk_bf16_f32 v2, v166, v167
    v_lshlrev_b32 v166, 16, v2
    v_and_b32 v167, 0xffff0000, v2
    v_lshlrev_b32 v2, 16, v99
    v_and_b32 v3, 0xffff0000, v99
    v_pk_add_f32 v[166:167], v[166:167], v[2:3]
    v_cvt_pk_bf16_f32 v2, v166, v167
    v_lshlrev_b32 v166, 16, v2
    v_and_b32 v167, 0xffff0000, v2
    v_lshlrev_b32 v2, 16, v103
    v_and_b32 v3, 0xffff0000, v103
    v_pk_add_f32 v[166:167], v[166:167], v[2:3]
    v_cvt_pk_bf16_f32 v227, v166, v167
    buffer_store_dwordx4 v[224:227], v53, s[16:19], s70 offen
    s_cmp_ge_u32 s3, 2
    s_cbranch_scc1 L_end
    s_waitcnt lgkmcnt(0)
    v_pk_add_f32 v[192:193], v[192:193], v[200:201]
    v_pk_add_f32 v[194:195], v[194:195], v[202:203]
    v_pk_add_f32 v[196:197], v[196:197], v[204:205]
    v_pk_add_f32 v[198:199], v[198:199], v[206:207]
    v_pk_add_f32 v[192:193], v[192:193], v[208:209]
    v_pk_add_f32 v[194:195], v[194:195], v[210:211]
    v_pk_add_f32 v[196:197], v[196:197], v[212:213]
    v_pk_add_f32 v[198:199], v[198:199], v[214:215]
    v_pk_add_f32 v[192:193], v[192:193], v[216:217]
    v_pk_add_f32 v[194:195], v[194:195], v[218:219]
    v_pk_add_f32 v[196:197], v[196:197], v[220:221]
    v_pk_add_f32 v[198:199], v[198:199], v[222:223]
    s_nop 0
    v_pk_add_f32 v[192:193], v[192:193], v[136:137]
    v_pk_add_f32 v[194:195], v[194:195], v[138:139]
    v_pk_add_f32 v[196:197], v[196:197], v[140:141]
    v_pk_add_f32 v[198:199], v[198:199], v[142:143]
    v_pk_add_f32 v[192:193], v[192:193], v[144:145]
    v_pk_add_f32 v[194:195], v[194:195], v[146:147]
    v_pk_add_f32 v[196:197], v[196:197], v[148:149]
    v_pk_add_f32 v[198:199], v[198:199], v[150:151]
    v_pk_add_f32 v[192:193], v[192:193], v[152:153]
    v_pk_add_f32 v[194:195], v[194:195], v[154:155]
    v_pk_add_f32 v[196:197], v[196:197], v[156:157]
    v_pk_add_f32 v[198:199], v[198:199], v[158:159]
    v_cvt_pk_bf16_f32 v2, v192, v193
    v_lshlrev_b32 v192, 16, v2
    v_and_b32 v193, 0xffff0000, v2
    v_lshlrev_b32 v2, 16, v104
    v_and_b32 v3, 0xffff0000, v104
    v_pk_add_f32 v[192:193], v[192:193], v[2:3]
    v_cvt_pk_bf16_f32 v2, v192, v193
    v_lshlrev_b32 v192, 16, v2
    v_and_b32 v193, 0xffff0000, v2
    v_lshlrev_b32 v2, 16, v108
    v_and_b32 v3, 0xffff0000, v108
    v_pk_add_f32 v[192:193], v[192:193], v[2:3]
    v_cvt_pk_bf16_f32 v228, v192, v193
    v_cvt_pk_bf16_f32 v2, v194, v195
    v_lshlrev_b32 v194, 16, v2
    v_and_b32 v195, 0xffff0000, v2
    v_lshlrev_b32 v2, 16, v105
    v_and_b32 v3, 0xffff0000, v105
    v_pk_add_f32 v[194:195], v[194:195], v[2:3]
    v_cvt_pk_bf16_f32 v2, v194, v195
    v_lshlrev_b32 v194, 16, v2
    v_and_b32 v195, 0xffff0000, v2
    v_lshlrev_b32 v2, 16, v109
    v_and_b32 v3, 0xffff0000, v109
    v_pk_add_f32 v[194:195], v[194:195], v[2:3]
    v_cvt_pk_bf16_f32 v229, v194, v195
    v_cvt_pk_bf16_f32 v2, v196, v197
    v_lshlrev_b32 v196, 16, v2
    v_and_b32 v197, 0xffff0000, v2
    v_lshlrev_b32 v2, 16, v106
    v_and_b32 v3, 0xffff0000, v106
    v_pk_add_f32 v[196:197], v[196:197], v[2:3]
    v_cvt_pk_bf16_f32 v2, v196, v197
    v_lshlrev_b32 v196, 16, v2
    v_and_b32 v197, 0xffff0000, v2
    v_lshlrev_b32 v2, 16, v110
    v_and_b32 v3, 0xffff0000, v110
    v_pk_add_f32 v[196:197], v[196:197], v[2:3]
    v_cvt_pk_bf16_f32 v230, v196, v197
    v_cvt_pk_bf16_f32 v2, v198, v199
    v_lshlrev_b32 v198, 16, v2
    v_and_b32 v199, 0xffff0000, v2
    v_lshlrev_b32 v2, 16, v107
    v_and_b32 v3, 0xffff0000, v107
    v_pk_add_f32 v[198:199], v[198:199], v[2:3]
    v_cvt_pk_bf16_f32 v2, v198, v199
    v_lshlrev_b32 v198, 16, v2
    v_and_b32 v199, 0xffff0000, v2
    v_lshlrev_b32 v2, 16, v111
    v_and_b32 v3, 0xffff0000, v111
    v_pk_add_f32 v[198:199], v[198:199], v[2:3]
    v_cvt_pk_bf16_f32 v231, v198, v199
    buffer_store_dwordx4 v[228:231], v54, s[16:19], s70 offen
L_end:
L_exit:
    s_endpgm
.section .rodata,"a"
.p2align 6
.amdhsa_kernel parallel_sum__compressed_kv_cla__moe_arch_mod__prompt_kernel
  .amdhsa_next_free_vgpr 256
  .amdhsa_next_free_sgpr 102
  .amdhsa_accum_offset 256
  .amdhsa_group_segment_fixed_size 0
  .amdhsa_kernarg_size 112
  .amdhsa_user_sgpr_count 2
  .amdhsa_user_sgpr_kernarg_segment_ptr 1
  .amdhsa_system_sgpr_workgroup_id_x 1
  .amdhsa_float_denorm_mode_32 3
.end_amdhsa_kernel
```

```asm
; @launch grid=(256,1,1) block=(512,1,1) lds=163840
.amdgcn_target "amdgcn-amd-amdhsa--gfx950"
.text
.globl parallel_sum__compressed_kv_cla__moe_arch_mod__prompt_kernel
.p2align 8
.type parallel_sum__compressed_kv_cla__moe_arch_mod__prompt_kernel,@function
parallel_sum__compressed_kv_cla__moe_arch_mod__prompt_kernel:
    s_cmp_ge_u32 s2, 256
    s_cbranch_scc1 L_exit
    s_load_dwordx16 s[32:47], s[0:1], 0
    s_load_dwordx8 s[48:55], s[0:1], 64
    s_load_dwordx4 s[56:59], s[0:1], 96
    v_lshrrev_b32 v2, 6, v0
    v_and_b32 v1, 63, v0
    v_readfirstlane_b32 s3, v2
    s_getpc_b64 s[80:81]
L_pc:
    s_lshr_b32 s6, s2, 3
    s_and_b32 s6, s6, 15
    s_lshl_b32 s6, s6, 12
    s_cmp_lt_u32 s3, 2
    s_cselect_b32 s6, 0, s6
    v_lshl_add_u32 v3, v0, 6, s6
    v_min_u32 v3, L_exit-L_pc, v3
    s_cmp_ge_u32 s3, 3
    s_cbranch_scc1 L_noct
    global_load_dword v11, v3, s[80:81]
L_noct:
    v_lshrrev_b32 v62, 5, v0
    v_and_b32 v62, 7, v62
    v_and_b32 v2, 31, v0
    v_lshlrev_b32 v2, 3, v2
    v_mul_u32_u24 v63, 1280, v62
    v_add_u32 v63, v63, v2
    s_mul_i32 s6, s2, 10240
    v_add_u32 v10, s6, v63
    s_cmp_lt_u32 s3, 4
    s_cbranch_scc1 L_st_k0
    s_waitcnt lgkmcnt(0)
    global_load_dwordx2 v[16:17], v10, s[32:33] offset:0
    global_load_dwordx2 v[18:19], v10, s[32:33] offset:256
    global_load_dwordx2 v[20:21], v10, s[32:33] offset:512
    global_load_dwordx2 v[22:23], v10, s[32:33] offset:768
    global_load_dwordx2 v[24:25], v10, s[32:33] offset:1024
    global_load_dwordx2 v[26:27], v2, s[46:47] offset:0
    global_load_dwordx2 v[28:29], v2, s[46:47] offset:256
    global_load_dwordx2 v[30:31], v2, s[46:47] offset:512
    global_load_dwordx2 v[32:33], v2, s[46:47] offset:768
    global_load_dwordx2 v[34:35], v2, s[46:47] offset:1024
L_st_k0:
    s_and_b32 s6, s2, 7
    s_lshl_b32 s6, s6, 2
    s_lshr_b32 s7, s2, 3
    s_and_b32 s7, s7, 3
    s_add_u32 s4, s6, s7
    s_lshr_b32 s5, s2, 5
    s_and_b32 s76, s3, 3
    v_lshrrev_b32 v2, 3, v1
    v_and_b32 v3, 7, v1
    v_lshrrev_b32 v4, 4, v1
    v_xor_b32 v5, v3, v4
    v_lshlrev_b32 v5, 4, v5
    v_lshl_add_u32 v40, v2, 10, v5
    v_xor_b32 v5, 64, v40
    v_add_u32 v41, 7168, v5
    v_add_u32 v42, 14336, v40
    v_add_u32 v43, 14336, v41
    v_and_b32 v6, 15, v1
    s_lshl_b32 s6, s76, 4
    v_add_u32 v7, s6, v4
    v_lshlrev_b32 v5, 1, v4
    v_xor_b32 v5, v6, v5
    v_lshlrev_b32 v5, 4, v5
    v_lshl_add_u32 v44, v7, 13, v5
    v_add_u32 v45, 31744, v44
    v_xor_b32 v5, 0x80, v44
    v_add_u32 v46, 63488, v5
    v_add_u32 v47, 31744, v46
    s_and_b32 s6, s76, 1
    s_lshl_b32 s6, s6, 20
    s_lshr_b32 s7, s76, 1
    s_lshl_b32 s7, s7, 18
    s_add_u32 s6, s6, s7
    s_lshl_b32 s62, s5, 15
    s_add_u32 s62, s62, s6
    s_lshl_b32 s63, s4, 8
    s_lshl_b32 s64, s76, 13
    s_lshl_b32 s73, s76, 12
    s_add_u32 s73, s73, 32768
    s_waitcnt lgkmcnt(0)
    s_mov_b32 s12, s34
    s_mov_b32 s13, s35
    s_mov_b32 s14, 0x200000
    s_mov_b32 s15, 0x20000
    s_mov_b32 s16, s38
    s_mov_b32 s17, s39
    s_mov_b32 s18, 0x400000
    s_mov_b32 s19, 0x20000
    s_mov_b32 s20, s40
    s_mov_b32 s21, s41
    s_mov_b32 s22, 0x400000
    s_mov_b32 s23, 0x20000
    s_cmp_ge_u32 s3, 4
    s_cbranch_scc1 L_st_v0
    s_mov_b32 m0, s64
    s_add_u32 s72, s62, 524288
    buffer_load_dwordx4 v40, s[12:15], s62 offen offset:0 lds
    buffer_load_dwordx4 v41, s[12:15], s62 offen offset:1024 lds
    buffer_load_dwordx4 v42, s[12:15], s62 offen offset:2048 lds
    buffer_load_dwordx4 v43, s[12:15], s62 offen offset:3072 lds
    s_add_u32 m0, s64, 4096
    s_add_u32 s62, s62, 128
    s_bitset0_b32 s62, 10
    buffer_load_dwordx4 v40, s[12:15], s72 offen offset:0 lds
    buffer_load_dwordx4 v41, s[12:15], s72 offen offset:1024 lds
    buffer_load_dwordx4 v42, s[12:15], s72 offen offset:2048 lds
    buffer_load_dwordx4 v43, s[12:15], s72 offen offset:3072 lds
    s_mov_b32 m0, s73
    s_xor_b32 s64, s64, 0x10000
    buffer_load_dwordx4 v44, s[16:19], s63 offen offset:0 lds
    buffer_load_dwordx4 v45, s[16:19], s63 offen offset:1024 lds
    buffer_load_dwordx4 v46, s[16:19], s63 offen offset:2048 lds
    buffer_load_dwordx4 v47, s[16:19], s63 offen offset:3072 lds
    s_add_u32 m0, s73, 16384
    s_xor_b32 s73, s73, 0x10000
    buffer_load_dwordx4 v44, s[20:23], s63 offen offset:0 lds
    buffer_load_dwordx4 v45, s[20:23], s63 offen offset:1024 lds
    buffer_load_dwordx4 v46, s[20:23], s63 offen offset:2048 lds
    buffer_load_dwordx4 v47, s[20:23], s63 offen offset:3072 lds
    s_add_u32 s63, s63, 524288
    s_bitset0_b32 s63, 22
    s_setprio 1
L_st_v0:
    s_mov_b32 s8, s58
    s_mov_b32 s9, s59
    s_mov_b32 s10, 0x5000000
    s_mov_b32 s11, 0x20000
    s_mov_b32 s24, s36
    s_mov_b32 s25, s37
    s_mov_b32 s26, 0x500000
    s_mov_b32 s27, 0x20000
    v_lshlrev_b32 v13, 4, v1
    s_lshl_b32 s6, s5, 2
    s_add_u32 s7, s6, s3
    s_sub_u32 s6, 56, s6
    s_add_u32 s6, s6, s3
    s_cmp_lt_u32 s3, 4
    s_cselect_b32 s60, s7, s6
    s_xor_b32 s6, s5, 1
    s_lshl_b32 s6, s6, 5
    s_add_u32 s61, s6, s4
    v_and_b32 v2, 15, v1
    v_lshrrev_b32 v3, 4, v1
    s_and_b32 s6, s3, 1
    s_lshl_b32 s6, s6, 7
    v_add_u32 v4, s6, v2
    v_lshlrev_b32 v4, 7, v4
    v_lshrrev_b32 v5, 1, v2
    v_add_u32 v6, 0, v3
    v_xor_b32 v6, v6, v5
    v_lshl_add_u32 v48, v6, 4, v4
    v_add_u32 v6, 4, v3
    v_xor_b32 v6, v6, v5
    v_lshl_add_u32 v49, v6, 4, v4
    v_lshrrev_b32 v4, 2, v2
    v_lshl_add_u32 v5, v3, 3, v4
    v_lshlrev_b32 v5, 8, v5
    v_and_b32 v6, 1, v2
    v_lshl_add_u32 v5, v6, 3, v5
    v_and_b32 v6, 1, v3
    v_lshl_or_b32 v4, v6, 2, v4
    v_lshlrev_b32 v4, 1, v4
    v_bfe_u32 v6, v2, 1, 1
    v_add_u32 v8, 131072, v5
    v_add_u32 v7, 0, v6
    v_xor_b32 v7, v7, v4
    v_lshl_add_u32 v54, v7, 4, v8
    v_add_u32 v7, 2, v6
    v_xor_b32 v7, v7, v4
    v_lshl_add_u32 v55, v7, 4, v8
    v_add_u32 v7, 4, v6
    v_xor_b32 v7, v7, v4
    v_lshl_add_u32 v56, v7, 4, v8
    v_add_u32 v7, 6, v6
    v_xor_b32 v7, v7, v4
    v_lshl_add_u32 v57, v7, 4, v8
    v_add_u32 v7, 8, v6
    v_xor_b32 v7, v7, v4
    v_lshl_add_u32 v58, v7, 4, v8
    v_add_u32 v7, 10, v6
    v_xor_b32 v7, v7, v4
    v_lshl_add_u32 v59, v7, 4, v8
    v_add_u32 v7, 12, v6
    v_xor_b32 v7, v7, v4
    v_lshl_add_u32 v60, v7, 4, v8
    v_add_u32 v7, 14, v6
    v_xor_b32 v7, v7, v4
    v_lshl_add_u32 v61, v7, 4, v8
    s_lshr_b32 s6, s3, 2
    s_lshl_b32 s6, s6, 14
    s_add_u32 s6, s6, 32768
    v_add_u32 v5, s6, v5
    s_lshr_b32 s7, s3, 1
    s_and_b32 s7, s7, 1
    s_lshl_b32 s7, s7, 3
    s_add_u32 s6, s7, 0
    v_add_u32 v7, s6, v6
    v_xor_b32 v7, v7, v4
    v_lshl_add_u32 v50, v7, 4, v5
    s_add_u32 s6, s7, 2
    v_add_u32 v7, s6, v6
    v_xor_b32 v7, v7, v4
    v_lshl_add_u32 v51, v7, 4, v5
    s_add_u32 s6, s7, 4
    v_add_u32 v7, s6, v6
    v_xor_b32 v7, v7, v4
    v_lshl_add_u32 v52, v7, 4, v5
    s_add_u32 s6, s7, 6
    v_add_u32 v7, s6, v6
    v_xor_b32 v7, v7, v4
    v_lshl_add_u32 v53, v7, 4, v5
    v_mov_b64 v[128:129], 0
    v_mov_b64 v[130:131], 0
    v_mov_b64 v[132:133], 0
    v_mov_b64 v[134:135], 0
    v_mov_b64 v[136:137], 0
    v_mov_b64 v[138:139], 0
    v_mov_b64 v[140:141], 0
    v_mov_b64 v[142:143], 0
    v_mov_b64 v[144:145], 0
    v_mov_b64 v[146:147], 0
    v_mov_b64 v[148:149], 0
    v_mov_b64 v[150:151], 0
    v_mov_b64 v[152:153], 0
    v_mov_b64 v[154:155], 0
    v_mov_b64 v[156:157], 0
    v_mov_b64 v[158:159], 0
    v_mov_b64 v[160:161], 0
    v_mov_b64 v[162:163], 0
    v_mov_b64 v[164:165], 0
    v_mov_b64 v[166:167], 0
    v_mov_b64 v[168:169], 0
    v_mov_b64 v[170:171], 0
    v_mov_b64 v[172:173], 0
    v_mov_b64 v[174:175], 0
    v_mov_b64 v[176:177], 0
    v_mov_b64 v[178:179], 0
    v_mov_b64 v[180:181], 0
    v_mov_b64 v[182:183], 0
    v_mov_b64 v[184:185], 0
    v_mov_b64 v[186:187], 0
    v_mov_b64 v[188:189], 0
    v_mov_b64 v[190:191], 0
    v_mov_b64 v[192:193], 0
    v_mov_b64 v[194:195], 0
    v_mov_b64 v[196:197], 0
    v_mov_b64 v[198:199], 0
    v_mov_b64 v[200:201], 0
    v_mov_b64 v[202:203], 0
    v_mov_b64 v[204:205], 0
    v_mov_b64 v[206:207], 0
    v_mov_b64 v[208:209], 0
    v_mov_b64 v[210:211], 0
    v_mov_b64 v[212:213], 0
    v_mov_b64 v[214:215], 0
    v_mov_b64 v[216:217], 0
    v_mov_b64 v[218:219], 0
    v_mov_b64 v[220:221], 0
    v_mov_b64 v[222:223], 0
    v_mov_b64 v[224:225], 0
    v_mov_b64 v[226:227], 0
    v_mov_b64 v[228:229], 0
    v_mov_b64 v[230:231], 0
    v_mov_b64 v[232:233], 0
    v_mov_b64 v[234:235], 0
    v_mov_b64 v[236:237], 0
    v_mov_b64 v[238:239], 0
    v_mov_b64 v[240:241], 0
    v_mov_b64 v[242:243], 0
    v_mov_b64 v[244:245], 0
    v_mov_b64 v[246:247], 0
    v_mov_b64 v[248:249], 0
    v_mov_b64 v[250:251], 0
    v_mov_b64 v[252:253], 0
    v_mov_b64 v[254:255], 0
    v_add_u32 v12, 20480, v13
    s_mul_i32 s70, s60, 40960
    s_mov_b32 s65, 0
    s_lshl_b32 s6, s4, 20
    s_lshl_b32 s7, s5, 13
    s_add_u32 s6, s6, s7
    s_and_b32 s7, s3, 1
    s_lshl_b32 s7, s7, 16
    s_add_u32 s6, s6, s7
    s_add_u32 s67, s6, 16777216
    s_and_b32 s6, s4, 3
    s_add_u32 s6, s6, s5
    s_sub_u32 s7, s6, 5
    s_cselect_b32 s6, s6, s7
    s_sub_u32 s7, s6, 5
    s_cselect_b32 s6, s6, s7
    s_lshl_b32 s71, s6, 20
    s_lshl_b32 s7, s4, 8
    s_add_u32 s71, s71, s7
    s_lshl_b32 s7, s6, 12
    s_add_u32 s84, s70, s7
    s_add_u32 s6, s6, 1
    s_cmp_eq_u32 s6, 5
    s_cselect_b32 s6, 0, s6
    s_lshl_b32 s7, s6, 12
    s_add_u32 s85, s70, s7
    s_add_u32 s6, s6, 1
    s_cmp_eq_u32 s6, 5
    s_cselect_b32 s6, 0, s6
    s_lshl_b32 s7, s6, 12
    s_add_u32 s86, s70, s7
    s_add_u32 s6, s6, 1
    s_cmp_eq_u32 s6, 5
    s_cselect_b32 s6, 0, s6
    s_lshl_b32 s7, s6, 12
    s_add_u32 s87, s70, s7
    s_add_u32 s6, s6, 1
    s_cmp_eq_u32 s6, 5
    s_cselect_b32 s6, 0, s6
    s_lshl_b32 s7, s6, 12
    s_add_u32 s88, s70, s7
    s_lshr_b32 s7, s3, 1
    s_and_b32 s7, s7, 1
    s_cmp_ge_u32 s3, 4
    s_cbranch_scc1 L_c_v
    s_lshl_b32 s7, s7, 11
    s_add_u32 s67, s67, s7
    s_movk_i32 s68, 3072
    s_mov_b32 s69, 125952
    s_add_u32 s71, s71, 1048576
    s_sub_u32 s75, s71, 5242880
    s_cselect_b32 s71, s71, s75
    s_lshl_b32 s74, s76, 12
    s_branch L_c_j
L_c_v:
    s_lshl_b32 s7, s7, 12
    s_add_u32 s67, s67, s7
    s_add_u32 s67, s67, 0x80000
    s_movk_i32 s68, 1024
    s_mov_b32 s69, 128000
L_c_j:
    s_cmp_ge_u32 s3, 4
    s_cbranch_scc1 L_st_v1
    s_mov_b32 m0, s64
    s_add_u32 s72, s62, 524288
    buffer_load_dwordx4 v40, s[12:15], s62 offen offset:0 lds
    buffer_load_dwordx4 v41, s[12:15], s62 offen offset:1024 lds
    buffer_load_dwordx4 v42, s[12:15], s62 offen offset:2048 lds
    buffer_load_dwordx4 v43, s[12:15], s62 offen offset:3072 lds
    s_add_u32 m0, s64, 4096
    s_add_u32 s62, s62, 128
    s_bitset0_b32 s62, 10
    buffer_load_dwordx4 v40, s[12:15], s72 offen offset:0 lds
    buffer_load_dwordx4 v41, s[12:15], s72 offen offset:1024 lds
    buffer_load_dwordx4 v42, s[12:15], s72 offen offset:2048 lds
    buffer_load_dwordx4 v43, s[12:15], s72 offen offset:3072 lds
    s_waitcnt vmcnt(8)
    s_branch L_st_j1
L_st_v1:
    s_waitcnt vmcnt(0)
    v_lshlrev_b32 v64, 16, v16
    v_and_b32 v65, 0xffff0000, v16
    v_lshlrev_b32 v66, 16, v17
    v_and_b32 v67, 0xffff0000, v17
    v_lshlrev_b32 v68, 16, v18
    v_and_b32 v69, 0xffff0000, v18
    v_lshlrev_b32 v70, 16, v19
    v_and_b32 v71, 0xffff0000, v19
    v_lshlrev_b32 v72, 16, v20
    v_and_b32 v73, 0xffff0000, v20
    v_lshlrev_b32 v74, 16, v21
    v_and_b32 v75, 0xffff0000, v21
    v_lshlrev_b32 v76, 16, v22
    v_and_b32 v77, 0xffff0000, v22
    v_lshlrev_b32 v78, 16, v23
    v_and_b32 v79, 0xffff0000, v23
    v_lshlrev_b32 v80, 16, v24
    v_and_b32 v81, 0xffff0000, v24
    v_lshlrev_b32 v82, 16, v25
    v_and_b32 v83, 0xffff0000, v25
    v_pk_add_f32 v[2:3], v[64:65], v[66:67]
    v_pk_add_f32 v[2:3], v[2:3], v[68:69]
    v_pk_add_f32 v[2:3], v[2:3], v[70:71]
    v_pk_add_f32 v[2:3], v[2:3], v[72:73]
    v_pk_add_f32 v[2:3], v[2:3], v[74:75]
    v_pk_add_f32 v[2:3], v[2:3], v[76:77]
    v_pk_add_f32 v[2:3], v[2:3], v[78:79]
    v_pk_add_f32 v[2:3], v[2:3], v[80:81]
    v_pk_add_f32 v[2:3], v[2:3], v[82:83]
    v_add_f32 v2, v2, v3
    s_nop 1
    v_add_f32_dpp v2, v2, v2 quad_perm:[1,0,3,2] row_mask:0xf bank_mask:0xf
    s_nop 1
    v_add_f32_dpp v2, v2, v2 quad_perm:[2,3,0,1] row_mask:0xf bank_mask:0xf
    s_nop 1
    v_add_f32_dpp v2, v2, v2 row_half_mirror row_mask:0xf bank_mask:0xf
    s_nop 1
    v_add_f32_dpp v2, v2, v2 row_mirror row_mask:0xf bank_mask:0xf
    v_mov_b32 v8, v2
    s_nop 1
    v_permlane16_swap_b32 v2, v8
    s_nop 1
    v_add_f32 v2, v2, v8
    s_mov_b32 s7, 0x3acccccd
    v_mul_f32 v2, s7, v2
    v_mov_b64 v[4:5], 0
    v_pk_add_f32 v[6:7], v[64:65], v[2:3] op_sel_hi:[1,0] neg_lo:[0,1] neg_hi:[0,1]
    v_pk_fma_f32 v[4:5], v[6:7], v[6:7], v[4:5]
    v_pk_add_f32 v[6:7], v[66:67], v[2:3] op_sel_hi:[1,0] neg_lo:[0,1] neg_hi:[0,1]
    v_pk_fma_f32 v[4:5], v[6:7], v[6:7], v[4:5]
    v_pk_add_f32 v[6:7], v[68:69], v[2:3] op_sel_hi:[1,0] neg_lo:[0,1] neg_hi:[0,1]
    v_pk_fma_f32 v[4:5], v[6:7], v[6:7], v[4:5]
    v_pk_add_f32 v[6:7], v[70:71], v[2:3] op_sel_hi:[1,0] neg_lo:[0,1] neg_hi:[0,1]
    v_pk_fma_f32 v[4:5], v[6:7], v[6:7], v[4:5]
    v_pk_add_f32 v[6:7], v[72:73], v[2:3] op_sel_hi:[1,0] neg_lo:[0,1] neg_hi:[0,1]
    v_pk_fma_f32 v[4:5], v[6:7], v[6:7], v[4:5]
    v_pk_add_f32 v[6:7], v[74:75], v[2:3] op_sel_hi:[1,0] neg_lo:[0,1] neg_hi:[0,1]
    v_pk_fma_f32 v[4:5], v[6:7], v[6:7], v[4:5]
    v_pk_add_f32 v[6:7], v[76:77], v[2:3] op_sel_hi:[1,0] neg_lo:[0,1] neg_hi:[0,1]
    v_pk_fma_f32 v[4:5], v[6:7], v[6:7], v[4:5]
    v_pk_add_f32 v[6:7], v[78:79], v[2:3] op_sel_hi:[1,0] neg_lo:[0,1] neg_hi:[0,1]
    v_pk_fma_f32 v[4:5], v[6:7], v[6:7], v[4:5]
    v_pk_add_f32 v[6:7], v[80:81], v[2:3] op_sel_hi:[1,0] neg_lo:[0,1] neg_hi:[0,1]
    v_pk_fma_f32 v[4:5], v[6:7], v[6:7], v[4:5]
    v_pk_add_f32 v[6:7], v[82:83], v[2:3] op_sel_hi:[1,0] neg_lo:[0,1] neg_hi:[0,1]
    v_pk_fma_f32 v[4:5], v[6:7], v[6:7], v[4:5]
    v_add_f32 v4, v4, v5
    s_nop 1
    v_add_f32_dpp v4, v4, v4 quad_perm:[1,0,3,2] row_mask:0xf bank_mask:0xf
    s_nop 1
    v_add_f32_dpp v4, v4, v4 quad_perm:[2,3,0,1] row_mask:0xf bank_mask:0xf
    s_nop 1
    v_add_f32_dpp v4, v4, v4 row_half_mirror row_mask:0xf bank_mask:0xf
    s_nop 1
    v_add_f32_dpp v4, v4, v4 row_mirror row_mask:0xf bank_mask:0xf
    v_mov_b32 v8, v4
    s_nop 1
    v_permlane16_swap_b32 v4, v8
    s_nop 1
    v_add_f32 v4, v4, v8
    v_mul_f32 v4, s7, v4
    v_cvt_pk_bf16_f32 v2, v2, v2
    v_lshlrev_b32 v2, 16, v2
    v_cvt_pk_bf16_f32 v4, v4, v4
    v_lshlrev_b32 v4, 16, v4
    v_add_f32 v4, 0x3727c5ac, v4
    v_cvt_pk_bf16_f32 v4, v4, v4
    v_lshlrev_b32 v4, 16, v4
    v_sqrt_f32 v4, v4
    s_nop 0
    v_cvt_pk_bf16_f32 v4, v4, v4
    v_lshlrev_b32 v4, 16, v4
    v_rcp_f32 v6, v4
    s_nop 0
    v_fma_f32 v5, -v4, v6, 1.0
    v_fmac_f32 v6, v5, v6
    v_mov_b32 v9, 0
    v_pk_add_f32 v[64:65], v[64:65], v[2:3] op_sel_hi:[1,0] neg_lo:[0,1] neg_hi:[0,1]
    v_cvt_pk_bf16_f32 v5, v64, v65
    v_lshlrev_b32 v64, 16, v5
    v_and_b32 v65, 0xffff0000, v5
    v_pk_mul_f32 v[64:65], v[64:65], v[6:7] op_sel_hi:[1,0]
    v_cvt_pk_bf16_f32 v16, v64, v65
    v_pk_add_f32 v[66:67], v[66:67], v[2:3] op_sel_hi:[1,0] neg_lo:[0,1] neg_hi:[0,1]
    v_cvt_pk_bf16_f32 v5, v66, v67
    v_lshlrev_b32 v66, 16, v5
    v_and_b32 v67, 0xffff0000, v5
    v_pk_mul_f32 v[66:67], v[66:67], v[6:7] op_sel_hi:[1,0]
    v_cvt_pk_bf16_f32 v17, v66, v67
    v_pk_add_f32 v[68:69], v[68:69], v[2:3] op_sel_hi:[1,0] neg_lo:[0,1] neg_hi:[0,1]
    v_cvt_pk_bf16_f32 v5, v68, v69
    v_lshlrev_b32 v68, 16, v5
    v_and_b32 v69, 0xffff0000, v5
    v_pk_mul_f32 v[68:69], v[68:69], v[6:7] op_sel_hi:[1,0]
    v_cvt_pk_bf16_f32 v18, v68, v69
    v_pk_add_f32 v[70:71], v[70:71], v[2:3] op_sel_hi:[1,0] neg_lo:[0,1] neg_hi:[0,1]
    v_cvt_pk_bf16_f32 v5, v70, v71
    v_lshlrev_b32 v70, 16, v5
    v_and_b32 v71, 0xffff0000, v5
    v_pk_mul_f32 v[70:71], v[70:71], v[6:7] op_sel_hi:[1,0]
    v_cvt_pk_bf16_f32 v19, v70, v71
    v_pk_add_f32 v[72:73], v[72:73], v[2:3] op_sel_hi:[1,0] neg_lo:[0,1] neg_hi:[0,1]
    v_cvt_pk_bf16_f32 v5, v72, v73
    v_lshlrev_b32 v72, 16, v5
    v_and_b32 v73, 0xffff0000, v5
    v_pk_mul_f32 v[72:73], v[72:73], v[6:7] op_sel_hi:[1,0]
    v_cvt_pk_bf16_f32 v20, v72, v73
    v_pk_add_f32 v[74:75], v[74:75], v[2:3] op_sel_hi:[1,0] neg_lo:[0,1] neg_hi:[0,1]
    v_cvt_pk_bf16_f32 v5, v74, v75
    v_lshlrev_b32 v74, 16, v5
    v_and_b32 v75, 0xffff0000, v5
    v_pk_mul_f32 v[74:75], v[74:75], v[6:7] op_sel_hi:[1,0]
    v_cvt_pk_bf16_f32 v21, v74, v75
    v_pk_add_f32 v[76:77], v[76:77], v[2:3] op_sel_hi:[1,0] neg_lo:[0,1] neg_hi:[0,1]
    v_cvt_pk_bf16_f32 v5, v76, v77
    v_lshlrev_b32 v76, 16, v5
    v_and_b32 v77, 0xffff0000, v5
    v_pk_mul_f32 v[76:77], v[76:77], v[6:7] op_sel_hi:[1,0]
    v_cvt_pk_bf16_f32 v22, v76, v77
    v_pk_add_f32 v[78:79], v[78:79], v[2:3] op_sel_hi:[1,0] neg_lo:[0,1] neg_hi:[0,1]
    v_cvt_pk_bf16_f32 v5, v78, v79
    v_lshlrev_b32 v78, 16, v5
    v_and_b32 v79, 0xffff0000, v5
    v_pk_mul_f32 v[78:79], v[78:79], v[6:7] op_sel_hi:[1,0]
    v_cvt_pk_bf16_f32 v23, v78, v79
    v_pk_add_f32 v[80:81], v[80:81], v[2:3] op_sel_hi:[1,0] neg_lo:[0,1] neg_hi:[0,1]
    v_cvt_pk_bf16_f32 v5, v80, v81
    v_lshlrev_b32 v80, 16, v5
    v_and_b32 v81, 0xffff0000, v5
    v_pk_mul_f32 v[80:81], v[80:81], v[6:7] op_sel_hi:[1,0]
    v_cvt_pk_bf16_f32 v24, v80, v81
    v_pk_add_f32 v[82:83], v[82:83], v[2:3] op_sel_hi:[1,0] neg_lo:[0,1] neg_hi:[0,1]
    v_cvt_pk_bf16_f32 v5, v82, v83
    v_lshlrev_b32 v82, 16, v5
    v_and_b32 v83, 0xffff0000, v5
    v_pk_mul_f32 v[82:83], v[82:83], v[6:7] op_sel_hi:[1,0]
    v_cvt_pk_bf16_f32 v25, v82, v83
    v_add_u32 v10, 131072, v63
    ds_write_b64 v10, v[16:17] offset:0
    ds_write_b64 v10, v[18:19] offset:256
    ds_write_b64 v10, v[20:21] offset:512
    ds_write_b64 v10, v[22:23] offset:768
    ds_write_b64 v10, v[24:25] offset:1024
    s_waitcnt lgkmcnt(0)
    v_mov_b32 v2, 0
    v_lshlrev_b32 v4, 16, v16
    v_lshlrev_b32 v5, 16, v26
    v_fmac_f32 v2, v4, v5
    v_and_b32 v4, 0xffff0000, v16
    v_and_b32 v5, 0xffff0000, v26
    v_fmac_f32 v2, v4, v5
    v_lshlrev_b32 v4, 16, v17
    v_lshlrev_b32 v5, 16, v27
    v_fmac_f32 v2, v4, v5
    v_and_b32 v4, 0xffff0000, v17
    v_and_b32 v5, 0xffff0000, v27
    v_fmac_f32 v2, v4, v5
    v_lshlrev_b32 v4, 16, v18
    v_lshlrev_b32 v5, 16, v28
    v_fmac_f32 v2, v4, v5
    v_and_b32 v4, 0xffff0000, v18
    v_and_b32 v5, 0xffff0000, v28
    v_fmac_f32 v2, v4, v5
    v_lshlrev_b32 v4, 16, v19
    v_lshlrev_b32 v5, 16, v29
    v_fmac_f32 v2, v4, v5
    v_and_b32 v4, 0xffff0000, v19
    v_and_b32 v5, 0xffff0000, v29
    v_fmac_f32 v2, v4, v5
    v_lshlrev_b32 v4, 16, v20
    v_lshlrev_b32 v5, 16, v30
    v_fmac_f32 v2, v4, v5
    v_and_b32 v4, 0xffff0000, v20
    v_and_b32 v5, 0xffff0000, v30
    v_fmac_f32 v2, v4, v5
    v_lshlrev_b32 v4, 16, v21
    v_lshlrev_b32 v5, 16, v31
    v_fmac_f32 v2, v4, v5
    v_and_b32 v4, 0xffff0000, v21
    v_and_b32 v5, 0xffff0000, v31
    v_fmac_f32 v2, v4, v5
    v_lshlrev_b32 v4, 16, v22
    v_lshlrev_b32 v5, 16, v32
    v_fmac_f32 v2, v4, v5
    v_and_b32 v4, 0xffff0000, v22
    v_and_b32 v5, 0xffff0000, v32
    v_fmac_f32 v2, v4, v5
    v_lshlrev_b32 v4, 16, v23
    v_lshlrev_b32 v5, 16, v33
    v_fmac_f32 v2, v4, v5
    v_and_b32 v4, 0xffff0000, v23
    v_and_b32 v5, 0xffff0000, v33
    v_fmac_f32 v2, v4, v5
    v_lshlrev_b32 v4, 16, v24
    v_lshlrev_b32 v5, 16, v34
    v_fmac_f32 v2, v4, v5
    v_and_b32 v4, 0xffff0000, v24
    v_and_b32 v5, 0xffff0000, v34
    v_fmac_f32 v2, v4, v5
    v_lshlrev_b32 v4, 16, v25
    v_lshlrev_b32 v5, 16, v35
    v_fmac_f32 v2, v4, v5
    v_and_b32 v4, 0xffff0000, v25
    v_and_b32 v5, 0xffff0000, v35
    v_fmac_f32 v2, v4, v5
    s_nop 1
    v_add_f32_dpp v2, v2, v2 quad_perm:[1,0,3,2] row_mask:0xf bank_mask:0xf
    s_nop 1
    v_add_f32_dpp v2, v2, v2 quad_perm:[2,3,0,1] row_mask:0xf bank_mask:0xf
    s_nop 1
    v_add_f32_dpp v2, v2, v2 row_half_mirror row_mask:0xf bank_mask:0xf
    s_nop 1
    v_add_f32_dpp v2, v2, v2 row_mirror row_mask:0xf bank_mask:0xf
    v_mov_b32 v8, v2
    s_nop 1
    v_permlane16_swap_b32 v2, v8
    s_nop 1
    v_add_f32 v2, v2, v8
    v_cvt_pk_bf16_f32 v2, v2, v2
    v_and_b32 v2, 0xffff, v2
    v_bfe_i32 v3, v2, 15, 1
    v_and_b32 v3, 0x7fff, v3
    v_or_b32 v3, 0x8000, v3
    v_xor_b32 v2, v2, v3
    s_lshl_b32 s7, s2, 3
    s_sub_u32 s6, 2047, s7
    v_sub_u32 v3, s6, v62
    v_lshl_or_b32 v2, v2, 11, v3
    v_lshlrev_b32 v3, 2, v62
    v_add_u32 v3, 161792, v3
    ds_write_b32 v3, v2
    s_waitcnt lgkmcnt(0)
L_st_j1:
    s_barrier
    s_cmp_ge_u32 s3, 4
    s_cbranch_scc1 L_kv_v
    ds_read_b128 v[64:67], v48 offset:0
    ds_read_b128 v[68:71], v48 offset:2048
    ds_read_b64_tr_b16 v[96:97], v50 offset:0
    ds_read_b64_tr_b16 v[98:99], v50 offset:1024
    ds_read_b64_tr_b16 v[100:101], v51 offset:0
    ds_read_b64_tr_b16 v[102:103], v51 offset:1024
    ds_read_b128 v[72:75], v48 offset:4096
    ds_read_b64_tr_b16 v[104:105], v52 offset:0
    ds_read_b64_tr_b16 v[106:107], v52 offset:1024
    ds_read_b64_tr_b16 v[108:109], v53 offset:0
    ds_read_b64_tr_b16 v[110:111], v53 offset:1024
    ds_read_b128 v[76:79], v48 offset:6144
    ds_read_b128 v[80:83], v48 offset:8192
    ds_read_b128 v[84:87], v48 offset:10240
    ds_read_b128 v[88:91], v48 offset:12288
    ds_read_b128 v[92:95], v48 offset:14336
    s_mov_b32 m0, s73
    s_xor_b32 s64, s64, 0x10000
    buffer_load_dwordx4 v44, s[16:19], s63 offen offset:0 lds
    buffer_load_dwordx4 v45, s[16:19], s63 offen offset:1024 lds
    buffer_load_dwordx4 v46, s[16:19], s63 offen offset:2048 lds
    buffer_load_dwordx4 v47, s[16:19], s63 offen offset:3072 lds
    s_add_u32 m0, s73, 16384
    s_xor_b32 s73, s73, 0x10000
    buffer_load_dwordx4 v44, s[20:23], s63 offen offset:0 lds
    buffer_load_dwordx4 v45, s[20:23], s63 offen offset:1024 lds
    buffer_load_dwordx4 v46, s[20:23], s63 offen offset:2048 lds
    buffer_load_dwordx4 v47, s[20:23], s63 offen offset:3072 lds
    s_add_u32 s63, s63, 524288
    s_bitset0_b32 s63, 22
.p2align 4
L_kloopA:
    s_waitcnt lgkmcnt(12)
    v_mfma_f32_16x16x32_bf16 v[128:131], v[96:99], v[64:67], v[128:131]
    ds_read_b64_tr_b16 v[112:113], v50 offset:8192
    s_waitcnt lgkmcnt(11)
    v_mfma_f32_16x16x32_bf16 v[132:135], v[100:103], v[64:67], v[132:135]
    ds_read_b64_tr_b16 v[114:115], v50 offset:9216
    s_waitcnt lgkmcnt(9)
    v_mfma_f32_16x16x32_bf16 v[136:139], v[104:107], v[64:67], v[136:139]
    ds_read_b64_tr_b16 v[116:117], v51 offset:8192
    s_waitcnt lgkmcnt(8)
    v_mfma_f32_16x16x32_bf16 v[140:143], v[108:111], v[64:67], v[140:143]
    ds_read_b64_tr_b16 v[118:119], v51 offset:9216
    ds_read_b128 v[64:67], v49 offset:0
    v_mfma_f32_16x16x32_bf16 v[144:147], v[96:99], v[68:71], v[144:147]
    ds_read_b64_tr_b16 v[120:121], v52 offset:8192
    v_mfma_f32_16x16x32_bf16 v[148:151], v[100:103], v[68:71], v[148:151]
    ds_read_b64_tr_b16 v[122:123], v52 offset:9216
    v_mfma_f32_16x16x32_bf16 v[152:155], v[104:107], v[68:71], v[152:155]
    ds_read_b64_tr_b16 v[124:125], v53 offset:8192
    v_mfma_f32_16x16x32_bf16 v[156:159], v[108:111], v[68:71], v[156:159]
    ds_read_b64_tr_b16 v[126:127], v53 offset:9216
    ds_read_b128 v[68:71], v49 offset:2048
    v_mfma_f32_16x16x32_bf16 v[160:163], v[96:99], v[72:75], v[160:163]
    v_mfma_f32_16x16x32_bf16 v[164:167], v[100:103], v[72:75], v[164:167]
    v_mfma_f32_16x16x32_bf16 v[168:171], v[104:107], v[72:75], v[168:171]
    v_mfma_f32_16x16x32_bf16 v[172:175], v[108:111], v[72:75], v[172:175]
    ds_read_b128 v[72:75], v49 offset:4096
    s_waitcnt lgkmcnt(15)
    v_mfma_f32_16x16x32_bf16 v[176:179], v[96:99], v[76:79], v[176:179]
    v_mfma_f32_16x16x32_bf16 v[180:183], v[100:103], v[76:79], v[180:183]
    v_mfma_f32_16x16x32_bf16 v[184:187], v[104:107], v[76:79], v[184:187]
    v_mfma_f32_16x16x32_bf16 v[188:191], v[108:111], v[76:79], v[188:191]
    ds_read_b128 v[76:79], v49 offset:6144
    s_waitcnt lgkmcnt(15)
    v_mfma_f32_16x16x32_bf16 v[192:195], v[96:99], v[80:83], v[192:195]
    v_mfma_f32_16x16x32_bf16 v[196:199], v[100:103], v[80:83], v[196:199]
    v_mfma_f32_16x16x32_bf16 v[200:203], v[104:107], v[80:83], v[200:203]
    v_mfma_f32_16x16x32_bf16 v[204:207], v[108:111], v[80:83], v[204:207]
    ds_read_b128 v[80:83], v49 offset:8192
    s_waitcnt lgkmcnt(15)
    v_mfma_f32_16x16x32_bf16 v[208:211], v[96:99], v[84:87], v[208:211]
    v_mfma_f32_16x16x32_bf16 v[212:215], v[100:103], v[84:87], v[212:215]
    v_mfma_f32_16x16x32_bf16 v[216:219], v[104:107], v[84:87], v[216:219]
    v_mfma_f32_16x16x32_bf16 v[220:223], v[108:111], v[84:87], v[220:223]
    ds_read_b128 v[84:87], v49 offset:10240
    s_waitcnt lgkmcnt(15)
    v_mfma_f32_16x16x32_bf16 v[224:227], v[96:99], v[88:91], v[224:227]
    v_mfma_f32_16x16x32_bf16 v[228:231], v[100:103], v[88:91], v[228:231]
    v_mfma_f32_16x16x32_bf16 v[232:235], v[104:107], v[88:91], v[232:235]
    v_mfma_f32_16x16x32_bf16 v[236:239], v[108:111], v[88:91], v[236:239]
    ds_read_b128 v[88:91], v49 offset:12288
    s_waitcnt lgkmcnt(15)
    v_mfma_f32_16x16x32_bf16 v[240:243], v[96:99], v[92:95], v[240:243]
    v_mfma_f32_16x16x32_bf16 v[244:247], v[100:103], v[92:95], v[244:247]
    v_mfma_f32_16x16x32_bf16 v[248:251], v[104:107], v[92:95], v[248:251]
    v_mfma_f32_16x16x32_bf16 v[252:255], v[108:111], v[92:95], v[252:255]
    ds_read_b128 v[92:95], v49 offset:14336
    s_waitcnt lgkmcnt(11)
    v_mfma_f32_16x16x32_bf16 v[128:131], v[112:115], v[64:67], v[128:131]
    v_mfma_f32_16x16x32_bf16 v[132:135], v[116:119], v[64:67], v[132:135]
    s_waitcnt lgkmcnt(9)
    v_mfma_f32_16x16x32_bf16 v[136:139], v[120:123], v[64:67], v[136:139]
    s_waitcnt lgkmcnt(7)
    v_mfma_f32_16x16x32_bf16 v[140:143], v[124:127], v[64:67], v[140:143]
    s_waitcnt lgkmcnt(6)
    v_mfma_f32_16x16x32_bf16 v[144:147], v[112:115], v[68:71], v[144:147]
    v_mfma_f32_16x16x32_bf16 v[148:151], v[116:119], v[68:71], v[148:151]
    v_mfma_f32_16x16x32_bf16 v[152:155], v[120:123], v[68:71], v[152:155]
    v_mfma_f32_16x16x32_bf16 v[156:159], v[124:127], v[68:71], v[156:159]
    v_xor_b32 v48, 0x10000, v48
    v_xor_b32 v49, 0x10000, v49
    v_xor_b32 v50, 0x10000, v50
    v_xor_b32 v51, 0x10000, v51
    v_xor_b32 v52, 0x10000, v52
    v_xor_b32 v53, 0x10000, v53
    s_waitcnt vmcnt(0) lgkmcnt(0)
    s_barrier
    ds_read_b128 v[64:67], v48 offset:0
    ds_read_b128 v[68:71], v48 offset:2048
    v_mfma_f32_16x16x32_bf16 v[160:163], v[112:115], v[72:75], v[160:163]
    ds_read_b64_tr_b16 v[96:97], v50 offset:0
    s_mov_b32 m0, s64
    s_add_u32 s72, s62, 524288
    v_mfma_f32_16x16x32_bf16 v[164:167], v[116:119], v[72:75], v[164:167]
    ds_read_b64_tr_b16 v[98:99], v50 offset:1024
    buffer_load_dwordx4 v40, s[12:15], s62 offen offset:0 lds
    v_mfma_f32_16x16x32_bf16 v[168:171], v[120:123], v[72:75], v[168:171]
    ds_read_b64_tr_b16 v[100:101], v51 offset:0
    buffer_load_dwordx4 v41, s[12:15], s62 offen offset:1024 lds
    v_mfma_f32_16x16x32_bf16 v[172:175], v[124:127], v[72:75], v[172:175]
    ds_read_b64_tr_b16 v[102:103], v51 offset:1024
    buffer_load_dwordx4 v42, s[12:15], s62 offen offset:2048 lds
    ds_read_b128 v[72:75], v48 offset:4096
    v_mfma_f32_16x16x32_bf16 v[176:179], v[112:115], v[76:79], v[176:179]
    ds_read_b64_tr_b16 v[104:105], v52 offset:0
    buffer_load_dwordx4 v43, s[12:15], s62 offen offset:3072 lds
    v_mfma_f32_16x16x32_bf16 v[180:183], v[116:119], v[76:79], v[180:183]
    ds_read_b64_tr_b16 v[106:107], v52 offset:1024
    s_add_u32 m0, s64, 4096
    s_add_u32 s62, s62, 128
    s_bitset0_b32 s62, 10
    v_mfma_f32_16x16x32_bf16 v[184:187], v[120:123], v[76:79], v[184:187]
    ds_read_b64_tr_b16 v[108:109], v53 offset:0
    buffer_load_dwordx4 v40, s[12:15], s72 offen offset:0 lds
    v_mfma_f32_16x16x32_bf16 v[188:191], v[124:127], v[76:79], v[188:191]
    ds_read_b64_tr_b16 v[110:111], v53 offset:1024
    buffer_load_dwordx4 v41, s[12:15], s72 offen offset:1024 lds
    ds_read_b128 v[76:79], v48 offset:6144
    v_mfma_f32_16x16x32_bf16 v[192:195], v[112:115], v[80:83], v[192:195]
    buffer_load_dwordx4 v42, s[12:15], s72 offen offset:2048 lds
    v_mfma_f32_16x16x32_bf16 v[196:199], v[116:119], v[80:83], v[196:199]
    buffer_load_dwordx4 v43, s[12:15], s72 offen offset:3072 lds
    v_mfma_f32_16x16x32_bf16 v[200:203], v[120:123], v[80:83], v[200:203]
    s_mov_b32 m0, s73
    s_xor_b32 s64, s64, 0x10000
    v_mfma_f32_16x16x32_bf16 v[204:207], v[124:127], v[80:83], v[204:207]
    buffer_load_dwordx4 v44, s[16:19], s63 offen offset:0 lds
    ds_read_b128 v[80:83], v48 offset:8192
    v_mfma_f32_16x16x32_bf16 v[208:211], v[112:115], v[84:87], v[208:211]
    buffer_load_dwordx4 v45, s[16:19], s63 offen offset:1024 lds
    v_mfma_f32_16x16x32_bf16 v[212:215], v[116:119], v[84:87], v[212:215]
    buffer_load_dwordx4 v46, s[16:19], s63 offen offset:2048 lds
    v_mfma_f32_16x16x32_bf16 v[216:219], v[120:123], v[84:87], v[216:219]
    buffer_load_dwordx4 v47, s[16:19], s63 offen offset:3072 lds
    v_mfma_f32_16x16x32_bf16 v[220:223], v[124:127], v[84:87], v[220:223]
    s_add_u32 m0, s73, 16384
    s_xor_b32 s73, s73, 0x10000
    ds_read_b128 v[84:87], v48 offset:10240
    v_mfma_f32_16x16x32_bf16 v[224:227], v[112:115], v[88:91], v[224:227]
    buffer_load_dwordx4 v44, s[20:23], s63 offen offset:0 lds
    v_mfma_f32_16x16x32_bf16 v[228:231], v[116:119], v[88:91], v[228:231]
    buffer_load_dwordx4 v45, s[20:23], s63 offen offset:1024 lds
    v_mfma_f32_16x16x32_bf16 v[232:235], v[120:123], v[88:91], v[232:235]
    buffer_load_dwordx4 v46, s[20:23], s63 offen offset:2048 lds
    v_mfma_f32_16x16x32_bf16 v[236:239], v[124:127], v[88:91], v[236:239]
    buffer_load_dwordx4 v47, s[20:23], s63 offen offset:3072 lds
    ds_read_b128 v[88:91], v48 offset:12288
    v_mfma_f32_16x16x32_bf16 v[240:243], v[112:115], v[92:95], v[240:243]
    s_add_u32 s63, s63, 524288
    s_bitset0_b32 s63, 22
    v_mfma_f32_16x16x32_bf16 v[244:247], v[116:119], v[92:95], v[244:247]
    v_mfma_f32_16x16x32_bf16 v[248:251], v[120:123], v[92:95], v[248:251]
    v_mfma_f32_16x16x32_bf16 v[252:255], v[124:127], v[92:95], v[252:255]
    ds_read_b128 v[92:95], v48 offset:14336
    s_add_u32 s65, s65, 1
    s_cmp_lt_u32 s65, 6
    s_cbranch_scc1 L_kloopA
.p2align 4
L_kloopB:
    s_branch L_khook
L_khook_back:
    s_waitcnt lgkmcnt(12)
    v_mfma_f32_16x16x32_bf16 v[128:131], v[96:99], v[64:67], v[128:131]
    ds_read_b64_tr_b16 v[112:113], v50 offset:8192
    s_waitcnt lgkmcnt(11)
    v_mfma_f32_16x16x32_bf16 v[132:135], v[100:103], v[64:67], v[132:135]
    ds_read_b64_tr_b16 v[114:115], v50 offset:9216
    s_waitcnt lgkmcnt(9)
    v_mfma_f32_16x16x32_bf16 v[136:139], v[104:107], v[64:67], v[136:139]
    ds_read_b64_tr_b16 v[116:117], v51 offset:8192
    s_waitcnt lgkmcnt(8)
    v_mfma_f32_16x16x32_bf16 v[140:143], v[108:111], v[64:67], v[140:143]
    ds_read_b64_tr_b16 v[118:119], v51 offset:9216
    ds_read_b128 v[64:67], v49 offset:0
    v_mfma_f32_16x16x32_bf16 v[144:147], v[96:99], v[68:71], v[144:147]
    ds_read_b64_tr_b16 v[120:121], v52 offset:8192
    v_mfma_f32_16x16x32_bf16 v[148:151], v[100:103], v[68:71], v[148:151]
    ds_read_b64_tr_b16 v[122:123], v52 offset:9216
    v_mfma_f32_16x16x32_bf16 v[152:155], v[104:107], v[68:71], v[152:155]
    ds_read_b64_tr_b16 v[124:125], v53 offset:8192
    v_mfma_f32_16x16x32_bf16 v[156:159], v[108:111], v[68:71], v[156:159]
    ds_read_b64_tr_b16 v[126:127], v53 offset:9216
    ds_read_b128 v[68:71], v49 offset:2048
    v_mfma_f32_16x16x32_bf16 v[160:163], v[96:99], v[72:75], v[160:163]
    v_mfma_f32_16x16x32_bf16 v[164:167], v[100:103], v[72:75], v[164:167]
    v_mfma_f32_16x16x32_bf16 v[168:171], v[104:107], v[72:75], v[168:171]
    v_mfma_f32_16x16x32_bf16 v[172:175], v[108:111], v[72:75], v[172:175]
    ds_read_b128 v[72:75], v49 offset:4096
    s_waitcnt lgkmcnt(15)
    v_mfma_f32_16x16x32_bf16 v[176:179], v[96:99], v[76:79], v[176:179]
    v_mfma_f32_16x16x32_bf16 v[180:183], v[100:103], v[76:79], v[180:183]
    v_mfma_f32_16x16x32_bf16 v[184:187], v[104:107], v[76:79], v[184:187]
    v_mfma_f32_16x16x32_bf16 v[188:191], v[108:111], v[76:79], v[188:191]
    ds_read_b128 v[76:79], v49 offset:6144
    s_waitcnt lgkmcnt(15)
    v_mfma_f32_16x16x32_bf16 v[192:195], v[96:99], v[80:83], v[192:195]
    v_mfma_f32_16x16x32_bf16 v[196:199], v[100:103], v[80:83], v[196:199]
    v_mfma_f32_16x16x32_bf16 v[200:203], v[104:107], v[80:83], v[200:203]
    v_mfma_f32_16x16x32_bf16 v[204:207], v[108:111], v[80:83], v[204:207]
    ds_read_b128 v[80:83], v49 offset:8192
    s_waitcnt lgkmcnt(15)
    v_mfma_f32_16x16x32_bf16 v[208:211], v[96:99], v[84:87], v[208:211]
    v_mfma_f32_16x16x32_bf16 v[212:215], v[100:103], v[84:87], v[212:215]
    v_mfma_f32_16x16x32_bf16 v[216:219], v[104:107], v[84:87], v[216:219]
    v_mfma_f32_16x16x32_bf16 v[220:223], v[108:111], v[84:87], v[220:223]
    ds_read_b128 v[84:87], v49 offset:10240
    s_waitcnt lgkmcnt(15)
    v_mfma_f32_16x16x32_bf16 v[224:227], v[96:99], v[88:91], v[224:227]
    v_mfma_f32_16x16x32_bf16 v[228:231], v[100:103], v[88:91], v[228:231]
    v_mfma_f32_16x16x32_bf16 v[232:235], v[104:107], v[88:91], v[232:235]
    v_mfma_f32_16x16x32_bf16 v[236:239], v[108:111], v[88:91], v[236:239]
    ds_read_b128 v[88:91], v49 offset:12288
    s_waitcnt lgkmcnt(15)
    v_mfma_f32_16x16x32_bf16 v[240:243], v[96:99], v[92:95], v[240:243]
    v_mfma_f32_16x16x32_bf16 v[244:247], v[100:103], v[92:95], v[244:247]
    v_mfma_f32_16x16x32_bf16 v[248:251], v[104:107], v[92:95], v[248:251]
    v_mfma_f32_16x16x32_bf16 v[252:255], v[108:111], v[92:95], v[252:255]
    ds_read_b128 v[92:95], v49 offset:14336
    s_waitcnt lgkmcnt(11)
    v_mfma_f32_16x16x32_bf16 v[128:131], v[112:115], v[64:67], v[128:131]
    v_mfma_f32_16x16x32_bf16 v[132:135], v[116:119], v[64:67], v[132:135]
    s_waitcnt lgkmcnt(9)
    v_mfma_f32_16x16x32_bf16 v[136:139], v[120:123], v[64:67], v[136:139]
    s_waitcnt lgkmcnt(7)
    v_mfma_f32_16x16x32_bf16 v[140:143], v[124:127], v[64:67], v[140:143]
    s_waitcnt lgkmcnt(6)
    v_mfma_f32_16x16x32_bf16 v[144:147], v[112:115], v[68:71], v[144:147]
    v_mfma_f32_16x16x32_bf16 v[148:151], v[116:119], v[68:71], v[148:151]
    v_mfma_f32_16x16x32_bf16 v[152:155], v[120:123], v[68:71], v[152:155]
    v_mfma_f32_16x16x32_bf16 v[156:159], v[124:127], v[68:71], v[156:159]
    v_xor_b32 v48, 0x10000, v48
    v_xor_b32 v49, 0x10000, v49
    v_xor_b32 v50, 0x10000, v50
    v_xor_b32 v51, 0x10000, v51
    v_xor_b32 v52, 0x10000, v52
    v_xor_b32 v53, 0x10000, v53
    s_waitcnt vmcnt(0) lgkmcnt(0)
    s_barrier
    ds_read_b128 v[64:67], v48 offset:0
    ds_read_b128 v[68:71], v48 offset:2048
    v_mfma_f32_16x16x32_bf16 v[160:163], v[112:115], v[72:75], v[160:163]
    ds_read_b64_tr_b16 v[96:97], v50 offset:0
    s_mov_b32 m0, s74
    s_add_u32 s74, s74, 16384
    v_mfma_f32_16x16x32_bf16 v[164:167], v[116:119], v[72:75], v[164:167]
    ds_read_b64_tr_b16 v[98:99], v50 offset:1024
    buffer_load_dwordx4 v44, s[24:27], s71 offen offset:0 lds
    v_mfma_f32_16x16x32_bf16 v[168:171], v[120:123], v[72:75], v[168:171]
    ds_read_b64_tr_b16 v[100:101], v51 offset:0
    buffer_load_dwordx4 v45, s[24:27], s71 offen offset:1024 lds
    v_mfma_f32_16x16x32_bf16 v[172:175], v[124:127], v[72:75], v[172:175]
    ds_read_b64_tr_b16 v[102:103], v51 offset:1024
    buffer_load_dwordx4 v46, s[24:27], s71 offen offset:2048 lds
    ds_read_b128 v[72:75], v48 offset:4096
    v_mfma_f32_16x16x32_bf16 v[176:179], v[112:115], v[76:79], v[176:179]
    ds_read_b64_tr_b16 v[104:105], v52 offset:0
    buffer_load_dwordx4 v47, s[24:27], s71 offen offset:3072 lds
    v_mfma_f32_16x16x32_bf16 v[180:183], v[116:119], v[76:79], v[180:183]
    ds_read_b64_tr_b16 v[106:107], v52 offset:1024
    s_add_u32 s71, s71, 524288
    s_sub_u32 s75, s71, 5242880
    s_cselect_b32 s71, s71, s75
    v_mfma_f32_16x16x32_bf16 v[184:187], v[120:123], v[76:79], v[184:187]
    ds_read_b64_tr_b16 v[108:109], v53 offset:0
    s_mov_b32 m0, s74
    s_add_u32 s74, s74, 16384
    v_mfma_f32_16x16x32_bf16 v[188:191], v[124:127], v[76:79], v[188:191]
    ds_read_b64_tr_b16 v[110:111], v53 offset:1024
    buffer_load_dwordx4 v44, s[24:27], s71 offen offset:0 lds
    ds_read_b128 v[76:79], v48 offset:6144
    v_mfma_f32_16x16x32_bf16 v[192:195], v[112:115], v[80:83], v[192:195]
    buffer_load_dwordx4 v45, s[24:27], s71 offen offset:1024 lds
    v_mfma_f32_16x16x32_bf16 v[196:199], v[116:119], v[80:83], v[196:199]
    buffer_load_dwordx4 v46, s[24:27], s71 offen offset:2048 lds
    v_mfma_f32_16x16x32_bf16 v[200:203], v[120:123], v[80:83], v[200:203]
    buffer_load_dwordx4 v47, s[24:27], s71 offen offset:3072 lds
    v_mfma_f32_16x16x32_bf16 v[204:207], v[124:127], v[80:83], v[204:207]
    s_add_u32 s71, s71, 524288
    s_sub_u32 s75, s71, 5242880
    s_cselect_b32 s71, s71, s75
    ds_read_b128 v[80:83], v48 offset:8192
    v_mfma_f32_16x16x32_bf16 v[208:211], v[112:115], v[84:87], v[208:211]
    s_mov_b32 m0, s74
    s_add_u32 s74, s74, 16384
    v_mfma_f32_16x16x32_bf16 v[212:215], v[116:119], v[84:87], v[212:215]
    buffer_load_dwordx4 v44, s[24:27], s71 offen offset:0 lds
    v_mfma_f32_16x16x32_bf16 v[216:219], v[120:123], v[84:87], v[216:219]
    buffer_load_dwordx4 v45, s[24:27], s71 offen offset:1024 lds
    v_mfma_f32_16x16x32_bf16 v[220:223], v[124:127], v[84:87], v[220:223]
    buffer_load_dwordx4 v46, s[24:27], s71 offen offset:2048 lds
    ds_read_b128 v[84:87], v48 offset:10240
    v_mfma_f32_16x16x32_bf16 v[224:227], v[112:115], v[88:91], v[224:227]
    buffer_load_dwordx4 v47, s[24:27], s71 offen offset:3072 lds
    v_mfma_f32_16x16x32_bf16 v[228:231], v[116:119], v[88:91], v[228:231]
    s_add_u32 s71, s71, 524288
    s_sub_u32 s75, s71, 5242880
    s_cselect_b32 s71, s71, s75
    v_mfma_f32_16x16x32_bf16 v[232:235], v[120:123], v[88:91], v[232:235]
    s_mov_b32 m0, s74
    s_add_u32 s74, s74, 16384
    v_mfma_f32_16x16x32_bf16 v[236:239], v[124:127], v[88:91], v[236:239]
    buffer_load_dwordx4 v44, s[24:27], s71 offen offset:0 lds
    ds_read_b128 v[88:91], v48 offset:12288
    v_mfma_f32_16x16x32_bf16 v[240:243], v[112:115], v[92:95], v[240:243]
    buffer_load_dwordx4 v45, s[24:27], s71 offen offset:1024 lds
    v_mfma_f32_16x16x32_bf16 v[244:247], v[116:119], v[92:95], v[244:247]
    buffer_load_dwordx4 v46, s[24:27], s71 offen offset:2048 lds
    v_mfma_f32_16x16x32_bf16 v[248:251], v[120:123], v[92:95], v[248:251]
    buffer_load_dwordx4 v47, s[24:27], s71 offen offset:3072 lds
    v_mfma_f32_16x16x32_bf16 v[252:255], v[124:127], v[92:95], v[252:255]
    s_add_u32 s71, s71, 524288
    s_sub_u32 s75, s71, 5242880
    s_cselect_b32 s71, s71, s75
    ds_read_b128 v[92:95], v48 offset:14336
    s_add_u32 s65, s65, 1
    s_cmp_lt_u32 s65, 8
    s_cbranch_scc1 L_kloopB
    s_waitcnt lgkmcnt(0)
    s_nop 7
    v_cvt_pk_bf16_f32 v128, v128, v129
    v_cvt_pk_bf16_f32 v129, v130, v131
    v_cvt_pk_bf16_f32 v130, v132, v133
    v_cvt_pk_bf16_f32 v131, v134, v135
    v_cvt_pk_bf16_f32 v132, v136, v137
    v_cvt_pk_bf16_f32 v133, v138, v139
    v_cvt_pk_bf16_f32 v134, v140, v141
    v_cvt_pk_bf16_f32 v135, v142, v143
    v_cvt_pk_bf16_f32 v136, v144, v145
    v_cvt_pk_bf16_f32 v137, v146, v147
    v_cvt_pk_bf16_f32 v138, v148, v149
    v_cvt_pk_bf16_f32 v139, v150, v151
    v_cvt_pk_bf16_f32 v140, v152, v153
    v_cvt_pk_bf16_f32 v141, v154, v155
    v_cvt_pk_bf16_f32 v142, v156, v157
    v_cvt_pk_bf16_f32 v143, v158, v159
    v_cvt_pk_bf16_f32 v144, v160, v161
    v_cvt_pk_bf16_f32 v145, v162, v163
    v_cvt_pk_bf16_f32 v146, v164, v165
    v_cvt_pk_bf16_f32 v147, v166, v167
    v_cvt_pk_bf16_f32 v148, v168, v169
    v_cvt_pk_bf16_f32 v149, v170, v171
    v_cvt_pk_bf16_f32 v150, v172, v173
    v_cvt_pk_bf16_f32 v151, v174, v175
    v_cvt_pk_bf16_f32 v152, v176, v177
    v_cvt_pk_bf16_f32 v153, v178, v179
    v_cvt_pk_bf16_f32 v154, v180, v181
    v_cvt_pk_bf16_f32 v155, v182, v183
    v_cvt_pk_bf16_f32 v156, v184, v185
    v_cvt_pk_bf16_f32 v157, v186, v187
    v_cvt_pk_bf16_f32 v158, v188, v189
    v_cvt_pk_bf16_f32 v159, v190, v191
    v_cvt_pk_bf16_f32 v160, v192, v193
    v_cvt_pk_bf16_f32 v161, v194, v195
    v_cvt_pk_bf16_f32 v162, v196, v197
    v_cvt_pk_bf16_f32 v163, v198, v199
    v_cvt_pk_bf16_f32 v164, v200, v201
    v_cvt_pk_bf16_f32 v165, v202, v203
    v_cvt_pk_bf16_f32 v166, v204, v205
    v_cvt_pk_bf16_f32 v167, v206, v207
    v_cvt_pk_bf16_f32 v168, v208, v209
    v_cvt_pk_bf16_f32 v169, v210, v211
    v_cvt_pk_bf16_f32 v170, v212, v213
    v_cvt_pk_bf16_f32 v171, v214, v215
    v_cvt_pk_bf16_f32 v172, v216, v217
    v_cvt_pk_bf16_f32 v173, v218, v219
    v_cvt_pk_bf16_f32 v174, v220, v221
    v_cvt_pk_bf16_f32 v175, v222, v223
    v_cvt_pk_bf16_f32 v176, v224, v225
    v_cvt_pk_bf16_f32 v177, v226, v227
    v_cvt_pk_bf16_f32 v178, v228, v229
    v_cvt_pk_bf16_f32 v179, v230, v231
    v_cvt_pk_bf16_f32 v180, v232, v233
    v_cvt_pk_bf16_f32 v181, v234, v235
    v_cvt_pk_bf16_f32 v182, v236, v237
    v_cvt_pk_bf16_f32 v183, v238, v239
    v_cvt_pk_bf16_f32 v184, v240, v241
    v_cvt_pk_bf16_f32 v185, v242, v243
    v_cvt_pk_bf16_f32 v186, v244, v245
    v_cvt_pk_bf16_f32 v187, v246, v247
    v_cvt_pk_bf16_f32 v188, v248, v249
    v_cvt_pk_bf16_f32 v189, v250, v251
    v_cvt_pk_bf16_f32 v190, v252, v253
    v_cvt_pk_bf16_f32 v191, v254, v255
    s_branch L_q
L_hook:
    s_cmp_eq_u32 s65, 1
    s_cbranch_scc1 L_hook1
    s_cmp_eq_u32 s65, 2
    s_cbranch_scc1 L_hook2
    s_cmp_eq_u32 s65, 4
    s_cbranch_scc1 L_hook4
    s_cmp_eq_u32 s65, 5
    s_cbranch_scc1 L_hook5
    s_cmp_eq_u32 s65, 6
    s_cbranch_scc1 L_hook6
    s_cmp_lg_u32 s65, 7
    s_cbranch_scc1 L_hook_back
    buffer_load_dwordx4 v[16:19], v13, s[8:11], s84 offen offset:0 sc1
    buffer_load_dwordx4 v[20:23], v12, s[8:11], s84 offen offset:0 sc1
    buffer_load_dwordx4 v[24:27], v13, s[8:11], s84 offen offset:1024 sc1
    buffer_load_dwordx4 v[28:31], v12, s[8:11], s84 offen offset:1024 sc1
    buffer_load_dwordx4 v[32:35], v13, s[8:11], s84 offen offset:2048 sc1
    buffer_load_dwordx4 v[36:39], v12, s[8:11], s84 offen offset:2048 sc1
    s_branch L_hook_back
L_hook1:
    s_cmp_ge_u32 s76, 2
    s_cbranch_scc1 L_tch_1a
    s_and_b32 s6, s4, 3
    s_lshl_b32 s6, s6, 19
    s_lshl_b32 s7, s5, 15
    s_add_u32 s6, s6, s7
    s_lshl_b32 s7, s76, 7
    s_add_u32 s6, s6, s7
    s_add_u32 s6, s6, 512
    v_lshrrev_b32 v6, 1, v1
    v_lshlrev_b32 v6, 10, v6
    v_and_b32 v7, 1, v1
    v_lshl_add_u32 v6, v7, 6, v6
    buffer_load_dword v11, v6, s[12:15], s6 offen
    s_add_u32 s6, s6, 262144
    buffer_load_dword v11, v6, s[12:15], s6 offen
    s_branch L_tch_1c
L_tch_1a:
    v_lshrrev_b32 v6, 5, v1
    v_lshlrev_b32 v6, 6, v6
    v_bfe_u32 v7, v1, 2, 3
    v_add_u32 v6, v6, v7
    v_lshlrev_b32 v6, 13, v6
    v_and_b32 v7, 3, v1
    v_lshl_add_u32 v6, v7, 6, v6
    s_lshl_b32 s6, s4, 8
    s_lshl_b32 s7, s5, 16
    s_add_u32 s6, s6, s7
    s_add_u32 s6, s6, 2097152
    s_cmp_lg_u32 s76, 2
    s_cbranch_scc1 L_tch_1b
    buffer_load_dword v11, v6, s[16:19], s6 offen
    s_branch L_tch_1c
L_tch_1b:
    buffer_load_dword v11, v6, s[20:23], s6 offen
L_tch_1c:
    s_branch L_hook_back
L_hook2:
    s_lshr_b32 s72, s2, 1
    s_mul_i32 s72, s72, 20480
    s_and_b32 s7, s2, 1
    s_lshl_b32 s7, s7, 7
    s_add_u32 s72, s72, s7
    v_add_u32 v2, -256, v0
    v_lshrrev_b32 v3, 3, v2
    v_and_b32 v4, 7, v2
    v_mul_u32_u24 v5, 1280, v4
    v_lshl_add_u32 v5, v3, 4, v5
    v_add_u32 v5, 131072, v5
    ds_read_b128 v[16:19], v5
    v_lshlrev_b32 v5, 8, v3
    v_lshl_add_u32 v6, v4, 4, v5
    v_add_u32 v2, 0, v0
    v_lshrrev_b32 v3, 3, v2
    v_and_b32 v4, 7, v2
    v_mul_u32_u24 v5, 1280, v4
    v_lshl_add_u32 v5, v3, 4, v5
    v_add_u32 v5, 131072, v5
    ds_read_b128 v[24:27], v5
    v_lshlrev_b32 v5, 8, v3
    v_lshl_add_u32 v7, v4, 4, v5
    v_add_u32 v2, 256, v0
    v_lshrrev_b32 v3, 3, v2
    v_and_b32 v4, 7, v2
    v_mul_u32_u24 v5, 1280, v4
    v_lshl_add_u32 v5, v3, 4, v5
    v_add_u32 v5, 131072, v5
    ds_read_b128 v[32:35], v5
    v_lshlrev_b32 v5, 8, v3
    v_lshl_add_u32 v8, v4, 4, v5
    s_waitcnt lgkmcnt(0)
    buffer_store_dwordx4 v[16:19], v6, s[8:11], s72 offen sc1
    buffer_store_dwordx4 v[24:27], v7, s[8:11], s72 offen sc1
    s_cmp_ge_u32 s3, 6
    s_cbranch_scc1 L_lns
    buffer_store_dwordx4 v[32:35], v8, s[8:11], s72 offen sc1
L_lns:
    s_cmp_lt_u32 s3, 6
    s_cbranch_scc1 L_zd
    v_mov_b64 v[36:37], 0
    v_mov_b64 v[38:39], 0
    v_lshrrev_b32 v2, 3, v1
    s_cmp_eq_u32 s3, 6
    s_cbranch_scc1 L_z6
    s_lshl_b32 s6, s5, 2
    s_sub_u32 s7, 56, s6
    v_mov_b32 v3, s6
    v_mov_b32 v4, s7
    v_cmp_gt_u32 vcc, 4, v2
    s_lshl_b32 s6, s4, 7
    s_add_u32 s6, s6, 3932160
    v_cndmask_b32 v3, v4, v3, vcc
    v_add_u32 v3, v3, v2
    v_lshl_add_u32 v3, v3, 12, s6
    s_branch L_z7
L_z6:
    v_mov_b32 v3, 0x5000000
    s_lshl_b32 s6, s4, 3
    s_add_u32 s6, s6, s5
    s_lshl_b32 s6, s6, 5
    s_add_u32 s6, s6, s3
    s_lshl_b32 s6, s6, 2
    s_add_u32 s6, s6, 3866624
    s_andn2_b32 s6, s6, 127
    v_cmp_eq_u32 vcc, 0, v2
    v_mov_b32 v4, s6
    s_nop 0
    v_cndmask_b32 v3, v3, v4, vcc
    s_lshl_b32 s6, s61, 5
    s_add_u32 s6, s6, s3
    s_lshl_b32 s6, s6, 2
    s_add_u32 s6, s6, 15859712
    s_andn2_b32 s6, s6, 127
    v_cmp_eq_u32 vcc, 1, v2
    v_mov_b32 v4, s6
    s_nop 0
    v_cndmask_b32 v3, v3, v4, vcc
    s_xor_b32 s6, s5, 1
    s_lshl_b32 s6, s6, 5
    s_add_u32 s6, s6, s4
    s_lshl_b32 s6, s6, 7
    s_add_u32 s6, s6, 3899392
    s_andn2_b32 s6, s6, 127
    v_cmp_eq_u32 vcc, 2, v2
    v_mov_b32 v4, s6
    s_nop 0
    v_cndmask_b32 v3, v3, v4, vcc
    s_and_b32 s6, s4, 7
    s_lshl_b32 s7, s5, 3
    s_add_u32 s6, s6, s7
    s_lshr_b32 s7, s4, 3
    s_add_u32 s7, s7, 0
    s_add_u32 s7, s7, 1
    s_and_b32 s7, s7, 3
    s_lshl_b32 s6, s6, 2
    s_add_u32 s6, s6, s7
    s_mul_i32 s6, s6, 3
    s_add_u32 s6, s6, 0
    s_lshl_b32 s6, s6, 5
    s_add_u32 s6, s6, s3
    s_lshl_b32 s6, s6, 2
    s_add_u32 s6, s6, 15728640
    s_andn2_b32 s6, s6, 127
    v_cmp_eq_u32 vcc, 3, v2
    v_mov_b32 v4, s6
    s_nop 0
    v_cndmask_b32 v3, v3, v4, vcc
    s_and_b32 s6, s4, 7
    s_lshl_b32 s7, s5, 3
    s_add_u32 s6, s6, s7
    s_lshr_b32 s7, s4, 3
    s_add_u32 s7, s7, 1
    s_add_u32 s7, s7, 1
    s_and_b32 s7, s7, 3
    s_lshl_b32 s6, s6, 2
    s_add_u32 s6, s6, s7
    s_mul_i32 s6, s6, 3
    s_add_u32 s6, s6, 1
    s_lshl_b32 s6, s6, 5
    s_add_u32 s6, s6, s3
    s_lshl_b32 s6, s6, 2
    s_add_u32 s6, s6, 15728640
    s_andn2_b32 s6, s6, 127
    v_cmp_eq_u32 vcc, 4, v2
    v_mov_b32 v4, s6
    s_nop 0
    v_cndmask_b32 v3, v3, v4, vcc
    s_and_b32 s6, s4, 7
    s_lshl_b32 s7, s5, 3
    s_add_u32 s6, s6, s7
    s_lshr_b32 s7, s4, 3
    s_add_u32 s7, s7, 2
    s_add_u32 s7, s7, 1
    s_and_b32 s7, s7, 3
    s_lshl_b32 s6, s6, 2
    s_add_u32 s6, s6, s7
    s_mul_i32 s6, s6, 3
    s_add_u32 s6, s6, 2
    s_lshl_b32 s6, s6, 5
    s_add_u32 s6, s6, s3
    s_lshl_b32 s6, s6, 2
    s_add_u32 s6, s6, 15728640
    s_andn2_b32 s6, s6, 127
    v_cmp_eq_u32 vcc, 5, v2
    v_mov_b32 v4, s6
    s_nop 0
    v_cndmask_b32 v3, v3, v4, vcc
    s_mov_b32 s6, 0x5000000
    s_cmp_eq_u32 s2, 31
    s_cmov_b32 s6, 3801088
    s_andn2_b32 s6, s6, 127
    v_cmp_eq_u32 vcc, 6, v2
    v_mov_b32 v4, s6
    s_nop 0
    v_cndmask_b32 v3, v3, v4, vcc
    s_lshl_b32 s6, s2, 7
    s_add_u32 s6, s6, 2621440
    s_andn2_b32 s6, s6, 127
    v_cmp_eq_u32 vcc, 7, v2
    v_mov_b32 v4, s6
    s_nop 0
    v_cndmask_b32 v3, v3, v4, vcc
    v_add_u32 v4, 160896, v13
    s_mov_b32 exec_lo, 0
    s_mov_b32 exec_hi, 0x03000000
    ds_read_b128 v[36:39], v4
    s_mov_b64 exec, -1
    s_waitcnt lgkmcnt(0)
L_z7:
    v_and_b32 v2, 7, v1
    v_lshl_add_u32 v3, v2, 4, v3
    buffer_store_dwordx4 v[36:39], v3, s[8:11], 0 offen sc1
L_zd:
    s_cmp_ge_u32 s76, 2
    s_cbranch_scc1 L_tch_2a
    s_and_b32 s6, s4, 3
    s_lshl_b32 s6, s6, 19
    s_lshl_b32 s7, s5, 15
    s_add_u32 s6, s6, s7
    s_lshl_b32 s7, s76, 7
    s_add_u32 s6, s6, s7
    s_add_u32 s6, s6, 768
    v_lshrrev_b32 v6, 1, v1
    v_lshlrev_b32 v6, 10, v6
    v_and_b32 v7, 1, v1
    v_lshl_add_u32 v6, v7, 6, v6
    buffer_load_dword v11, v6, s[12:15], s6 offen
    s_add_u32 s6, s6, 262144
    buffer_load_dword v11, v6, s[12:15], s6 offen
    s_branch L_tch_2c
L_tch_2a:
    v_lshrrev_b32 v6, 5, v1
    v_lshlrev_b32 v6, 6, v6
    v_bfe_u32 v7, v1, 2, 3
    v_add_u32 v6, v6, v7
    v_lshlrev_b32 v6, 13, v6
    v_and_b32 v7, 3, v1
    v_lshl_add_u32 v6, v7, 6, v6
    s_lshl_b32 s6, s4, 8
    s_lshl_b32 s7, s5, 16
    s_add_u32 s6, s6, s7
    s_add_u32 s6, s6, 3145728
    s_cmp_lg_u32 s76, 2
    s_cbranch_scc1 L_tch_2b
    buffer_load_dword v11, v6, s[16:19], s6 offen
    s_branch L_tch_2c
L_tch_2b:
    buffer_load_dword v11, v6, s[20:23], s6 offen
L_tch_2c:
    s_mov_b32 s28, s42
    s_mov_b32 s29, s43
    s_mov_b32 s30, 0x500000
    s_mov_b32 s31, 0x20000
    s_lshr_b32 s73, s2, 1
    s_mul_i32 s73, s73, 40960
    s_and_b32 s6, s2, 1
    s_mul_i32 s6, s6, 640
    s_add_u32 s73, s73, s6
    s_movk_i32 s7, 1639
    s_mul_i32 s74, s76, 5120
    s_add_u32 s74, s74, 141312
    s_mul_i32 s6, s76, 320
    v_add_u32 v9, s6, v1
    v_add_u32 v2, 0, v9
    v_mul_lo_u32 v3, v2, s7
    v_lshrrev_b32 v3, 16, v3
    v_mul_u32_u24 v4, 40, v3
    v_sub_u32 v4, v2, v4
    v_mul_u32_u24 v3, 1280, v3
    v_lshl_add_u32 v3, v4, 4, v3
    s_add_u32 m0, s74, 0
    s_nop 0
    buffer_load_dwordx4 v3, s[28:31], s73 offen nt lds
    v_add_u32 v2, 64, v9
    v_mul_lo_u32 v3, v2, s7
    v_lshrrev_b32 v3, 16, v3
    v_mul_u32_u24 v4, 40, v3
    v_sub_u32 v4, v2, v4
    v_mul_u32_u24 v3, 1280, v3
    v_lshl_add_u32 v3, v4, 4, v3
    s_add_u32 m0, s74, 1024
    s_nop 0
    buffer_load_dwordx4 v3, s[28:31], s73 offen nt lds
    v_add_u32 v2, 128, v9
    v_mul_lo_u32 v3, v2, s7
    v_lshrrev_b32 v3, 16, v3
    v_mul_u32_u24 v4, 40, v3
    v_sub_u32 v4, v2, v4
    v_mul_u32_u24 v3, 1280, v3
    v_lshl_add_u32 v3, v4, 4, v3
    s_add_u32 m0, s74, 2048
    s_nop 0
    buffer_load_dwordx4 v3, s[28:31], s73 offen nt lds
    v_add_u32 v2, 192, v9
    v_mul_lo_u32 v3, v2, s7
    v_lshrrev_b32 v3, 16, v3
    v_mul_u32_u24 v4, 40, v3
    v_sub_u32 v4, v2, v4
    v_mul_u32_u24 v3, 1280, v3
    v_lshl_add_u32 v3, v4, 4, v3
    s_add_u32 m0, s74, 3072
    s_nop 0
    buffer_load_dwordx4 v3, s[28:31], s73 offen nt lds
    v_add_u32 v2, 256, v9
    v_mul_lo_u32 v3, v2, s7
    v_lshrrev_b32 v3, 16, v3
    v_mul_u32_u24 v4, 40, v3
    v_sub_u32 v4, v2, v4
    v_mul_u32_u24 v3, 1280, v3
    v_lshl_add_u32 v3, v4, 4, v3
    s_add_u32 m0, s74, 4096
    s_nop 0
    buffer_load_dwordx4 v3, s[28:31], s73 offen nt lds
    s_branch L_hook_back
L_hook4:
    s_cmp_lg_u32 s3, 4
    s_cbranch_scc1 L_hook4b
    s_mov_b32 s28, s56
    s_mov_b32 s29, s57
    s_mov_b32 s30, 0x100
    s_mov_b32 s31, 0x20000
    v_mov_b32 v2, 1
    v_lshlrev_b32 v3, 8, v1
    s_and_b32 s6, s2, 31
    s_lshl_b32 s6, s6, 2
    buffer_atomic_add v2, v3, s[28:31], s6 offen offset:0 sc1
L_hook4b:
    v_and_b32 v2, 15, v1
    v_lshrrev_b32 v3, 4, v1
    v_lshrrev_b32 v4, 2, v2
    v_lshl_add_u32 v4, v3, 2, v4
    v_mul_u32_u24 v4, 640, v4
    v_and_b32 v2, 3, v2
    v_lshl_add_u32 v4, v2, 3, v4
    s_mul_i32 s6, s76, 160
    s_add_u32 s6, s6, 141312
    v_add_u32 v4, s6, v4
    s_mul_i32 s6, s2, 20480
    s_mul_i32 s7, s76, 5120
    s_add_u32 s6, s6, s7
    s_add_u32 s6, s6, 4194304
    s_add_u32 s7, s6, 4096
    ds_read_b64_tr_b16 v[16:17], v4 offset:0
    ds_read_b64_tr_b16 v[18:19], v4 offset:10240
    ds_read_b64_tr_b16 v[20:21], v4 offset:32
    ds_read_b64_tr_b16 v[22:23], v4 offset:10272
    ds_read_b64_tr_b16 v[24:25], v4 offset:64
    ds_read_b64_tr_b16 v[26:27], v4 offset:10304
    ds_read_b64_tr_b16 v[28:29], v4 offset:96
    ds_read_b64_tr_b16 v[30:31], v4 offset:10336
    ds_read_b64_tr_b16 v[32:33], v4 offset:128
    ds_read_b64_tr_b16 v[34:35], v4 offset:10368
    s_waitcnt lgkmcnt(0)
    buffer_store_dwordx4 v[16:19], v13, s[8:11], s6 offen offset:0 sc1
    buffer_store_dwordx4 v[20:23], v13, s[8:11], s6 offen offset:1024 sc1
    buffer_store_dwordx4 v[24:27], v13, s[8:11], s6 offen offset:2048 sc1
    buffer_store_dwordx4 v[28:31], v13, s[8:11], s6 offen offset:3072 sc1
    buffer_store_dwordx4 v[32:35], v13, s[8:11], s7 offen offset:0 sc1
    s_branch L_hook_back
L_hook5:
    s_lshl_b32 s74, s76, 12
    s_add_u32 s74, s74, 131072
    s_mov_b32 m0, s74
    s_add_u32 s74, s74, 16384
    buffer_load_dwordx4 v44, s[24:27], s71 offen offset:0 lds
    buffer_load_dwordx4 v45, s[24:27], s71 offen offset:1024 lds
    buffer_load_dwordx4 v46, s[24:27], s71 offen offset:2048 lds
    buffer_load_dwordx4 v47, s[24:27], s71 offen offset:3072 lds
    s_add_u32 s71, s71, 524288
    s_sub_u32 s75, s71, 5242880
    s_cselect_b32 s71, s71, s75
    s_mov_b32 m0, s74
    s_add_u32 s74, s74, 16384
    buffer_load_dwordx4 v44, s[24:27], s71 offen offset:0 lds
    buffer_load_dwordx4 v45, s[24:27], s71 offen offset:1024 lds
    buffer_load_dwordx4 v46, s[24:27], s71 offen offset:2048 lds
    buffer_load_dwordx4 v47, s[24:27], s71 offen offset:3072 lds
    s_add_u32 s71, s71, 524288
    s_sub_u32 s75, s71, 5242880
    s_cselect_b32 s71, s71, s75
    s_branch L_hook_back
L_hook6:
    s_cmp_lg_u32 s3, 5
    s_cbranch_scc1 L_hook6b
    s_mov_b32 s28, s56
    s_mov_b32 s29, s57
    s_mov_b32 s30, 0x100
    s_mov_b32 s31, 0x20000
    v_and_b32 v3, 31, v1
    v_lshlrev_b32 v3, 2, v3
    buffer_load_dword v62, v3, s[28:31], 0 offen offset:0 sc1
L_hook6b:
    s_cmp_lg_u32 s3, 4
    s_cbranch_scc1 L_hook_back
    s_mov_b32 s28, s56
    s_mov_b32 s29, s57
    s_mov_b32 s30, 0x100
    s_mov_b32 s31, 0x20000
    v_mov_b32 v2, 1
    v_lshlrev_b32 v3, 8, v1
    s_and_b32 s6, s2, 31
    s_lshl_b32 s6, s6, 2
    buffer_atomic_add v2, v3, s[28:31], s6 offen offset:128 sc1
    s_branch L_hook_back
L_vpre:
    s_waitcnt vmcnt(8)
    s_cmp_eq_u32 s65, 5
    s_cbranch_scc1 L_vnow
    s_cmp_eq_u32 s65, 6
    s_cbranch_scc1 L_vpre6
    s_waitcnt vmcnt(0)
    s_branch L_vnow
L_vpre6:
    s_cmp_lg_u32 s3, 5
    s_cbranch_scc1 L_vnow
    s_waitcnt vmcnt(0)
    v_cmp_gt_u32 vcc, 8, v62
    s_cbranch_vccz L_cntok_3
    s_mov_b32 s28, s56
    s_mov_b32 s29, s57
    s_mov_b32 s30, 0x100
    s_mov_b32 s31, 0x20000
    v_and_b32 v3, 31, v1
    v_lshlrev_b32 v3, 2, v3
    s_mov_b32 s79, 262144
L_poll_4:
    buffer_load_dword v2, v3, s[28:31], 0 offen offset:0 sc1
    s_waitcnt vmcnt(0)
    v_cmp_gt_u32 vcc, 8, v2
    s_cbranch_vccz L_polldone_5
    s_sleep 8
    s_sub_u32 s79, s79, 1
    s_cmp_lg_u32 s79, 0
    s_cbranch_scc1 L_poll_4
L_polldone_5:
L_cntok_3:
    s_branch L_vnow
L_khook:
    s_cmp_lg_u32 s65, 7
    s_cbranch_scc1 L_khook_back
    buffer_load_dwordx4 v[16:19], v13, s[8:11], s84 offen offset:0 sc1
    buffer_load_dwordx4 v[20:23], v12, s[8:11], s84 offen offset:0 sc1
    buffer_load_dwordx4 v[24:27], v13, s[8:11], s84 offen offset:1024 sc1
    buffer_load_dwordx4 v[28:31], v12, s[8:11], s84 offen offset:1024 sc1
    buffer_load_dwordx4 v[32:35], v13, s[8:11], s84 offen offset:2048 sc1
    buffer_load_dwordx4 v[36:39], v12, s[8:11], s84 offen offset:2048 sc1
    s_branch L_khook_back
L_kv_v:
    ds_read_b128 v[64:67], v48 offset:0
    ds_read_b128 v[68:71], v48 offset:2048
    ds_read_b64_tr_b16 v[96:97], v50 offset:0
    ds_read_b64_tr_b16 v[98:99], v50 offset:1024
    ds_read_b64_tr_b16 v[100:101], v51 offset:0
    ds_read_b64_tr_b16 v[102:103], v51 offset:1024
    ds_read_b128 v[72:75], v48 offset:4096
    ds_read_b64_tr_b16 v[104:105], v52 offset:0
    ds_read_b64_tr_b16 v[106:107], v52 offset:1024
    ds_read_b64_tr_b16 v[108:109], v53 offset:0
    ds_read_b64_tr_b16 v[110:111], v53 offset:1024
    ds_read_b128 v[76:79], v48 offset:6144
    ds_read_b128 v[80:83], v48 offset:8192
    ds_read_b128 v[84:87], v48 offset:10240
    ds_read_b128 v[88:91], v48 offset:12288
    ds_read_b128 v[92:95], v48 offset:14336
    s_cmp_ge_u32 s76, 2
    s_cbranch_scc1 L_tch_6a
    s_and_b32 s6, s4, 3
    s_lshl_b32 s6, s6, 19
    s_lshl_b32 s7, s5, 15
    s_add_u32 s6, s6, s7
    s_lshl_b32 s7, s76, 7
    s_add_u32 s6, s6, s7
    s_add_u32 s6, s6, 256
    v_lshrrev_b32 v6, 1, v1
    v_lshlrev_b32 v6, 10, v6
    v_and_b32 v7, 1, v1
    v_lshl_add_u32 v6, v7, 6, v6
    buffer_load_dword v11, v6, s[12:15], s6 offen
    s_add_u32 s6, s6, 262144
    buffer_load_dword v11, v6, s[12:15], s6 offen
    s_branch L_tch_6c
L_tch_6a:
    v_lshrrev_b32 v6, 5, v1
    v_lshlrev_b32 v6, 6, v6
    v_bfe_u32 v7, v1, 2, 3
    v_add_u32 v6, v6, v7
    v_lshlrev_b32 v6, 13, v6
    v_and_b32 v7, 3, v1
    v_lshl_add_u32 v6, v7, 6, v6
    s_lshl_b32 s6, s4, 8
    s_lshl_b32 s7, s5, 16
    s_add_u32 s6, s6, s7
    s_add_u32 s6, s6, 1048576
    s_cmp_lg_u32 s76, 2
    s_cbranch_scc1 L_tch_6b
    buffer_load_dword v11, v6, s[16:19], s6 offen
    s_branch L_tch_6c
L_tch_6b:
    buffer_load_dword v11, v6, s[20:23], s6 offen
L_tch_6c:
.p2align 4
L_vloop:
    s_branch L_hook
L_hook_back:
    s_waitcnt lgkmcnt(12)
    v_mfma_f32_16x16x32_bf16 v[128:131], v[64:67], v[96:99], v[128:131]
    ds_read_b64_tr_b16 v[112:113], v50 offset:8192
    s_waitcnt lgkmcnt(11)
    v_mfma_f32_16x16x32_bf16 v[132:135], v[64:67], v[100:103], v[132:135]
    ds_read_b64_tr_b16 v[114:115], v50 offset:9216
    s_waitcnt lgkmcnt(9)
    v_mfma_f32_16x16x32_bf16 v[136:139], v[64:67], v[104:107], v[136:139]
    ds_read_b64_tr_b16 v[116:117], v51 offset:8192
    s_waitcnt lgkmcnt(8)
    v_mfma_f32_16x16x32_bf16 v[140:143], v[64:67], v[108:111], v[140:143]
    ds_read_b64_tr_b16 v[118:119], v51 offset:9216
    ds_read_b128 v[64:67], v49 offset:0
    v_mfma_f32_16x16x32_bf16 v[144:147], v[68:71], v[96:99], v[144:147]
    ds_read_b64_tr_b16 v[120:121], v52 offset:8192
    v_mfma_f32_16x16x32_bf16 v[148:151], v[68:71], v[100:103], v[148:151]
    ds_read_b64_tr_b16 v[122:123], v52 offset:9216
    v_mfma_f32_16x16x32_bf16 v[152:155], v[68:71], v[104:107], v[152:155]
    ds_read_b64_tr_b16 v[124:125], v53 offset:8192
    v_mfma_f32_16x16x32_bf16 v[156:159], v[68:71], v[108:111], v[156:159]
    ds_read_b64_tr_b16 v[126:127], v53 offset:9216
    ds_read_b128 v[68:71], v49 offset:2048
    v_mfma_f32_16x16x32_bf16 v[160:163], v[72:75], v[96:99], v[160:163]
    v_mfma_f32_16x16x32_bf16 v[164:167], v[72:75], v[100:103], v[164:167]
    v_mfma_f32_16x16x32_bf16 v[168:171], v[72:75], v[104:107], v[168:171]
    v_mfma_f32_16x16x32_bf16 v[172:175], v[72:75], v[108:111], v[172:175]
    ds_read_b128 v[72:75], v49 offset:4096
    s_waitcnt lgkmcnt(15)
    v_mfma_f32_16x16x32_bf16 v[176:179], v[76:79], v[96:99], v[176:179]
    v_mfma_f32_16x16x32_bf16 v[180:183], v[76:79], v[100:103], v[180:183]
    v_mfma_f32_16x16x32_bf16 v[184:187], v[76:79], v[104:107], v[184:187]
    v_mfma_f32_16x16x32_bf16 v[188:191], v[76:79], v[108:111], v[188:191]
    ds_read_b128 v[76:79], v49 offset:6144
    s_waitcnt lgkmcnt(15)
    v_mfma_f32_16x16x32_bf16 v[192:195], v[80:83], v[96:99], v[192:195]
    v_mfma_f32_16x16x32_bf16 v[196:199], v[80:83], v[100:103], v[196:199]
    v_mfma_f32_16x16x32_bf16 v[200:203], v[80:83], v[104:107], v[200:203]
    v_mfma_f32_16x16x32_bf16 v[204:207], v[80:83], v[108:111], v[204:207]
    ds_read_b128 v[80:83], v49 offset:8192
    s_waitcnt lgkmcnt(15)
    v_mfma_f32_16x16x32_bf16 v[208:211], v[84:87], v[96:99], v[208:211]
    v_mfma_f32_16x16x32_bf16 v[212:215], v[84:87], v[100:103], v[212:215]
    v_mfma_f32_16x16x32_bf16 v[216:219], v[84:87], v[104:107], v[216:219]
    v_mfma_f32_16x16x32_bf16 v[220:223], v[84:87], v[108:111], v[220:223]
    ds_read_b128 v[84:87], v49 offset:10240
    s_waitcnt lgkmcnt(15)
    v_mfma_f32_16x16x32_bf16 v[224:227], v[88:91], v[96:99], v[224:227]
    v_mfma_f32_16x16x32_bf16 v[228:231], v[88:91], v[100:103], v[228:231]
    v_mfma_f32_16x16x32_bf16 v[232:235], v[88:91], v[104:107], v[232:235]
    v_mfma_f32_16x16x32_bf16 v[236:239], v[88:91], v[108:111], v[236:239]
    ds_read_b128 v[88:91], v49 offset:12288
    s_waitcnt lgkmcnt(15)
    v_mfma_f32_16x16x32_bf16 v[240:243], v[92:95], v[96:99], v[240:243]
    v_mfma_f32_16x16x32_bf16 v[244:247], v[92:95], v[100:103], v[244:247]
    v_mfma_f32_16x16x32_bf16 v[248:251], v[92:95], v[104:107], v[248:251]
    v_mfma_f32_16x16x32_bf16 v[252:255], v[92:95], v[108:111], v[252:255]
    ds_read_b128 v[92:95], v49 offset:14336
    s_waitcnt lgkmcnt(11)
    v_mfma_f32_16x16x32_bf16 v[128:131], v[64:67], v[112:115], v[128:131]
    v_mfma_f32_16x16x32_bf16 v[132:135], v[64:67], v[116:119], v[132:135]
    s_waitcnt lgkmcnt(9)
    v_mfma_f32_16x16x32_bf16 v[136:139], v[64:67], v[120:123], v[136:139]
    s_waitcnt lgkmcnt(7)
    v_mfma_f32_16x16x32_bf16 v[140:143], v[64:67], v[124:127], v[140:143]
    s_waitcnt lgkmcnt(6)
    v_mfma_f32_16x16x32_bf16 v[144:147], v[68:71], v[112:115], v[144:147]
    v_mfma_f32_16x16x32_bf16 v[148:151], v[68:71], v[116:119], v[148:151]
    v_mfma_f32_16x16x32_bf16 v[152:155], v[68:71], v[120:123], v[152:155]
    v_mfma_f32_16x16x32_bf16 v[156:159], v[68:71], v[124:127], v[156:159]
    v_xor_b32 v48, 0x10000, v48
    v_xor_b32 v49, 0x10000, v49
    v_xor_b32 v50, 0x10000, v50
    v_xor_b32 v51, 0x10000, v51
    v_xor_b32 v52, 0x10000, v52
    v_xor_b32 v53, 0x10000, v53
    s_bitcmp1_b32 0xe8, s65
    s_cbranch_scc1 L_vpre
L_vnow:
    s_waitcnt lgkmcnt(0)
    s_barrier
    ds_read_b128 v[64:67], v48 offset:0
    ds_read_b128 v[68:71], v48 offset:2048
    v_mfma_f32_16x16x32_bf16 v[160:163], v[72:75], v[112:115], v[160:163]
    ds_read_b64_tr_b16 v[96:97], v50 offset:0
    v_mfma_f32_16x16x32_bf16 v[164:167], v[72:75], v[116:119], v[164:167]
    ds_read_b64_tr_b16 v[98:99], v50 offset:1024
    v_mfma_f32_16x16x32_bf16 v[168:171], v[72:75], v[120:123], v[168:171]
    ds_read_b64_tr_b16 v[100:101], v51 offset:0
    v_mfma_f32_16x16x32_bf16 v[172:175], v[72:75], v[124:127], v[172:175]
    ds_read_b64_tr_b16 v[102:103], v51 offset:1024
    ds_read_b128 v[72:75], v48 offset:4096
    v_mfma_f32_16x16x32_bf16 v[176:179], v[76:79], v[112:115], v[176:179]
    ds_read_b64_tr_b16 v[104:105], v52 offset:0
    v_mfma_f32_16x16x32_bf16 v[180:183], v[76:79], v[116:119], v[180:183]
    ds_read_b64_tr_b16 v[106:107], v52 offset:1024
    v_mfma_f32_16x16x32_bf16 v[184:187], v[76:79], v[120:123], v[184:187]
    ds_read_b64_tr_b16 v[108:109], v53 offset:0
    v_mfma_f32_16x16x32_bf16 v[188:191], v[76:79], v[124:127], v[188:191]
    ds_read_b64_tr_b16 v[110:111], v53 offset:1024
    ds_read_b128 v[76:79], v48 offset:6144
    v_mfma_f32_16x16x32_bf16 v[192:195], v[80:83], v[112:115], v[192:195]
    v_mfma_f32_16x16x32_bf16 v[196:199], v[80:83], v[116:119], v[196:199]
    v_mfma_f32_16x16x32_bf16 v[200:203], v[80:83], v[120:123], v[200:203]
    v_mfma_f32_16x16x32_bf16 v[204:207], v[80:83], v[124:127], v[204:207]
    ds_read_b128 v[80:83], v48 offset:8192
    v_mfma_f32_16x16x32_bf16 v[208:211], v[84:87], v[112:115], v[208:211]
    v_mfma_f32_16x16x32_bf16 v[212:215], v[84:87], v[116:119], v[212:215]
    v_mfma_f32_16x16x32_bf16 v[216:219], v[84:87], v[120:123], v[216:219]
    v_mfma_f32_16x16x32_bf16 v[220:223], v[84:87], v[124:127], v[220:223]
    ds_read_b128 v[84:87], v48 offset:10240
    v_mfma_f32_16x16x32_bf16 v[224:227], v[88:91], v[112:115], v[224:227]
    v_mfma_f32_16x16x32_bf16 v[228:231], v[88:91], v[116:119], v[228:231]
    v_mfma_f32_16x16x32_bf16 v[232:235], v[88:91], v[120:123], v[232:235]
    v_mfma_f32_16x16x32_bf16 v[236:239], v[88:91], v[124:127], v[236:239]
    ds_read_b128 v[88:91], v48 offset:12288
    v_mfma_f32_16x16x32_bf16 v[240:243], v[92:95], v[112:115], v[240:243]
    v_mfma_f32_16x16x32_bf16 v[244:247], v[92:95], v[116:119], v[244:247]
    v_mfma_f32_16x16x32_bf16 v[248:251], v[92:95], v[120:123], v[248:251]
    v_mfma_f32_16x16x32_bf16 v[252:255], v[92:95], v[124:127], v[252:255]
    ds_read_b128 v[92:95], v48 offset:14336
    s_add_u32 s65, s65, 1
    s_cmp_lt_u32 s65, 8
    s_cbranch_scc1 L_vloop
    s_waitcnt lgkmcnt(0)
    s_nop 7
    v_cvt_pk_bf16_f32 v128, v128, v129
    v_cvt_pk_bf16_f32 v129, v130, v131
    v_cvt_pk_bf16_f32 v130, v144, v145
    v_cvt_pk_bf16_f32 v131, v146, v147
    v_cvt_pk_bf16_f32 v132, v132, v133
    v_cvt_pk_bf16_f32 v133, v134, v135
    v_cvt_pk_bf16_f32 v134, v148, v149
    v_cvt_pk_bf16_f32 v135, v150, v151
    v_cvt_pk_bf16_f32 v136, v136, v137
    v_cvt_pk_bf16_f32 v137, v138, v139
    v_cvt_pk_bf16_f32 v138, v152, v153
    v_cvt_pk_bf16_f32 v139, v154, v155
    v_cvt_pk_bf16_f32 v140, v140, v141
    v_cvt_pk_bf16_f32 v141, v142, v143
    v_cvt_pk_bf16_f32 v142, v156, v157
    v_cvt_pk_bf16_f32 v143, v158, v159
    v_cvt_pk_bf16_f32 v144, v160, v161
    v_cvt_pk_bf16_f32 v145, v162, v163
    v_cvt_pk_bf16_f32 v146, v176, v177
    v_cvt_pk_bf16_f32 v147, v178, v179
    v_cvt_pk_bf16_f32 v148, v164, v165
    v_cvt_pk_bf16_f32 v149, v166, v167
    v_cvt_pk_bf16_f32 v150, v180, v181
    v_cvt_pk_bf16_f32 v151, v182, v183
    v_cvt_pk_bf16_f32 v152, v168, v169
    v_cvt_pk_bf16_f32 v153, v170, v171
    v_cvt_pk_bf16_f32 v154, v184, v185
    v_cvt_pk_bf16_f32 v155, v186, v187
    v_cvt_pk_bf16_f32 v156, v172, v173
    v_cvt_pk_bf16_f32 v157, v174, v175
    v_cvt_pk_bf16_f32 v158, v188, v189
    v_cvt_pk_bf16_f32 v159, v190, v191
    v_cvt_pk_bf16_f32 v160, v192, v193
    v_cvt_pk_bf16_f32 v161, v194, v195
    v_cvt_pk_bf16_f32 v162, v208, v209
    v_cvt_pk_bf16_f32 v163, v210, v211
    v_cvt_pk_bf16_f32 v164, v196, v197
    v_cvt_pk_bf16_f32 v165, v198, v199
    v_cvt_pk_bf16_f32 v166, v212, v213
    v_cvt_pk_bf16_f32 v167, v214, v215
    v_cvt_pk_bf16_f32 v168, v200, v201
    v_cvt_pk_bf16_f32 v169, v202, v203
    v_cvt_pk_bf16_f32 v170, v216, v217
    v_cvt_pk_bf16_f32 v171, v218, v219
    v_cvt_pk_bf16_f32 v172, v204, v205
    v_cvt_pk_bf16_f32 v173, v206, v207
    v_cvt_pk_bf16_f32 v174, v220, v221
    v_cvt_pk_bf16_f32 v175, v222, v223
    v_cvt_pk_bf16_f32 v176, v224, v225
    v_cvt_pk_bf16_f32 v177, v226, v227
    v_cvt_pk_bf16_f32 v178, v240, v241
    v_cvt_pk_bf16_f32 v179, v242, v243
    v_cvt_pk_bf16_f32 v180, v228, v229
    v_cvt_pk_bf16_f32 v181, v230, v231
    v_cvt_pk_bf16_f32 v182, v244, v245
    v_cvt_pk_bf16_f32 v183, v246, v247
    v_cvt_pk_bf16_f32 v184, v232, v233
    v_cvt_pk_bf16_f32 v185, v234, v235
    v_cvt_pk_bf16_f32 v186, v248, v249
    v_cvt_pk_bf16_f32 v187, v250, v251
    v_cvt_pk_bf16_f32 v188, v236, v237
    v_cvt_pk_bf16_f32 v189, v238, v239
    v_cvt_pk_bf16_f32 v190, v252, v253
    v_cvt_pk_bf16_f32 v191, v254, v255
L_q:
    s_mov_b32 s28, s56
    s_mov_b32 s29, s57
    s_mov_b32 s30, 0x100
    s_mov_b32 s31, 0x20000
    s_lshl_b32 s6, s76, 13
    v_add_u32 v49, s6, v13
    s_lshl_b32 s6, s76, 12
    v_add_u32 v50, s6, v13
    s_lshl_b32 s77, s4, 20
    s_add_u32 s77, s77, 16777216
    s_mov_b32 s78, 0
    s_mov_b32 s90, 0
    s_cmp_lt_u32 s3, 4
    s_cselect_b32 s89, 3, 2
    ds_read_b64_tr_b16 v[96:97], v54 offset:0
    ds_read_b64_tr_b16 v[98:99], v54 offset:1024
    ds_read_b64_tr_b16 v[100:101], v55 offset:0
    ds_read_b64_tr_b16 v[102:103], v55 offset:1024
    ds_read_b64_tr_b16 v[104:105], v56 offset:0
    ds_read_b64_tr_b16 v[106:107], v56 offset:1024
    ds_read_b64_tr_b16 v[108:109], v57 offset:0
    ds_read_b64_tr_b16 v[110:111], v57 offset:1024
    ds_read_b64_tr_b16 v[112:113], v58 offset:0
    ds_read_b64_tr_b16 v[114:115], v58 offset:1024
    ds_read_b64_tr_b16 v[116:117], v59 offset:0
    ds_read_b64_tr_b16 v[118:119], v59 offset:1024
    ds_read_b64_tr_b16 v[120:121], v60 offset:0
    ds_read_b64_tr_b16 v[122:123], v60 offset:1024
    ds_read_b64_tr_b16 v[124:125], v61 offset:0
    ds_read_b64_tr_b16 v[126:127], v61 offset:1024
    buffer_load_dwordx4 v[64:67], v13, s[8:11], s84 offen offset:3072 sc1
    buffer_load_dwordx4 v[68:71], v12, s[8:11], s84 offen offset:3072 sc1
    buffer_load_dwordx4 v[72:75], v13, s[8:11], s85 offen offset:0 sc1
    buffer_load_dwordx4 v[76:79], v12, s[8:11], s85 offen offset:0 sc1
    buffer_load_dwordx4 v[80:83], v13, s[8:11], s85 offen offset:1024 sc1
    buffer_load_dwordx4 v[84:87], v12, s[8:11], s85 offen offset:1024 sc1
    buffer_load_dwordx4 v[88:91], v13, s[8:11], s85 offen offset:2048 sc1
    buffer_load_dwordx4 v[92:95], v12, s[8:11], s85 offen offset:2048 sc1
    s_waitcnt lgkmcnt(14)
    v_mfma_f32_16x16x32_bf16 v[192:195], v[96:99], v[16:19], 0
    v_mfma_f32_16x16x32_bf16 v[196:199], v[96:99], v[20:23], 0
    ds_read_b64_tr_b16 v[96:97], v54 offset:8192
    s_waitcnt lgkmcnt(13)
    v_mfma_f32_16x16x32_bf16 v[200:203], v[100:103], v[16:19], 0
    ds_read_b64_tr_b16 v[98:99], v54 offset:9216
    v_mfma_f32_16x16x32_bf16 v[204:207], v[100:103], v[20:23], 0
    ds_read_b64_tr_b16 v[100:101], v55 offset:8192
    s_waitcnt lgkmcnt(13)
    v_mfma_f32_16x16x32_bf16 v[208:211], v[104:107], v[16:19], 0
    ds_read_b64_tr_b16 v[102:103], v55 offset:9216
    v_mfma_f32_16x16x32_bf16 v[212:215], v[104:107], v[20:23], 0
    ds_read_b64_tr_b16 v[104:105], v56 offset:8192
    s_waitcnt lgkmcnt(13)
    v_mfma_f32_16x16x32_bf16 v[216:219], v[108:111], v[16:19], 0
    ds_read_b64_tr_b16 v[106:107], v56 offset:9216
    buffer_store_dwordx4 v[128:131], v13, s[8:11], s67 offen sc1
    s_add_u32 s67, s67, 1024
    v_mfma_f32_16x16x32_bf16 v[220:223], v[108:111], v[20:23], 0
    ds_read_b64_tr_b16 v[108:109], v57 offset:8192
    s_waitcnt lgkmcnt(13)
    v_mfma_f32_16x16x32_bf16 v[224:227], v[112:115], v[16:19], 0
    ds_read_b64_tr_b16 v[110:111], v57 offset:9216
    v_mfma_f32_16x16x32_bf16 v[228:231], v[112:115], v[20:23], 0
    ds_read_b64_tr_b16 v[112:113], v58 offset:8192
    s_waitcnt lgkmcnt(13)
    v_mfma_f32_16x16x32_bf16 v[232:235], v[116:119], v[16:19], 0
    ds_read_b64_tr_b16 v[114:115], v58 offset:9216
    v_mfma_f32_16x16x32_bf16 v[236:239], v[116:119], v[20:23], 0
    ds_read_b64_tr_b16 v[116:117], v59 offset:8192
    s_waitcnt lgkmcnt(13)
    v_mfma_f32_16x16x32_bf16 v[240:243], v[120:123], v[16:19], 0
    ds_read_b64_tr_b16 v[118:119], v59 offset:9216
    v_mfma_f32_16x16x32_bf16 v[244:247], v[120:123], v[20:23], 0
    ds_read_b64_tr_b16 v[120:121], v60 offset:8192
    s_waitcnt lgkmcnt(13)
    v_mfma_f32_16x16x32_bf16 v[248:251], v[124:127], v[16:19], 0
    ds_read_b64_tr_b16 v[122:123], v60 offset:9216
    v_mfma_f32_16x16x32_bf16 v[252:255], v[124:127], v[20:23], 0
    ds_read_b64_tr_b16 v[124:125], v61 offset:8192
    ds_read_b64_tr_b16 v[126:127], v61 offset:9216
    buffer_load_dwordx4 v[16:19], v13, s[8:11], s85 offen offset:3072 sc1
    buffer_load_dwordx4 v[20:23], v12, s[8:11], s85 offen offset:3072 sc1
    s_waitcnt lgkmcnt(14)
    v_mfma_f32_16x16x32_bf16 v[192:195], v[96:99], v[24:27], v[192:195]
    v_mfma_f32_16x16x32_bf16 v[196:199], v[96:99], v[28:31], v[196:199]
    ds_read_b64_tr_b16 v[96:97], v54 offset:16384
    s_waitcnt lgkmcnt(13)
    v_mfma_f32_16x16x32_bf16 v[200:203], v[100:103], v[24:27], v[200:203]
    ds_read_b64_tr_b16 v[98:99], v54 offset:17408
    v_mfma_f32_16x16x32_bf16 v[204:207], v[100:103], v[28:31], v[204:207]
    ds_read_b64_tr_b16 v[100:101], v55 offset:16384
    s_waitcnt lgkmcnt(13)
    v_mfma_f32_16x16x32_bf16 v[208:211], v[104:107], v[24:27], v[208:211]
    ds_read_b64_tr_b16 v[102:103], v55 offset:17408
    v_mfma_f32_16x16x32_bf16 v[212:215], v[104:107], v[28:31], v[212:215]
    ds_read_b64_tr_b16 v[104:105], v56 offset:16384
    s_waitcnt lgkmcnt(13)
    v_mfma_f32_16x16x32_bf16 v[216:219], v[108:111], v[24:27], v[216:219]
    ds_read_b64_tr_b16 v[106:107], v56 offset:17408
    buffer_store_dwordx4 v[132:135], v13, s[8:11], s67 offen sc1
    s_add_u32 s67, s67, s68
    v_mfma_f32_16x16x32_bf16 v[220:223], v[108:111], v[28:31], v[220:223]
    ds_read_b64_tr_b16 v[108:109], v57 offset:16384
    s_waitcnt lgkmcnt(13)
    v_mfma_f32_16x16x32_bf16 v[224:227], v[112:115], v[24:27], v[224:227]
    ds_read_b64_tr_b16 v[110:111], v57 offset:17408
    v_mfma_f32_16x16x32_bf16 v[228:231], v[112:115], v[28:31], v[228:231]
    ds_read_b64_tr_b16 v[112:113], v58 offset:16384
    s_waitcnt lgkmcnt(13)
    v_mfma_f32_16x16x32_bf16 v[232:235], v[116:119], v[24:27], v[232:235]
    ds_read_b64_tr_b16 v[114:115], v58 offset:17408
    v_mfma_f32_16x16x32_bf16 v[236:239], v[116:119], v[28:31], v[236:239]
    ds_read_b64_tr_b16 v[116:117], v59 offset:16384
    s_waitcnt lgkmcnt(13)
    v_mfma_f32_16x16x32_bf16 v[240:243], v[120:123], v[24:27], v[240:243]
    ds_read_b64_tr_b16 v[118:119], v59 offset:17408
    v_mfma_f32_16x16x32_bf16 v[244:247], v[120:123], v[28:31], v[244:247]
    ds_read_b64_tr_b16 v[120:121], v60 offset:16384
    s_waitcnt lgkmcnt(13)
    v_mfma_f32_16x16x32_bf16 v[248:251], v[124:127], v[24:27], v[248:251]
    ds_read_b64_tr_b16 v[122:123], v60 offset:17408
    v_mfma_f32_16x16x32_bf16 v[252:255], v[124:127], v[28:31], v[252:255]
    ds_read_b64_tr_b16 v[124:125], v61 offset:16384
    ds_read_b64_tr_b16 v[126:127], v61 offset:17408
    buffer_load_dwordx4 v[24:27], v13, s[8:11], s86 offen offset:0 sc1
    buffer_load_dwordx4 v[28:31], v12, s[8:11], s86 offen offset:0 sc1
    s_waitcnt lgkmcnt(14)
    v_mfma_f32_16x16x32_bf16 v[192:195], v[96:99], v[32:35], v[192:195]
    v_mfma_f32_16x16x32_bf16 v[196:199], v[96:99], v[36:39], v[196:199]
    ds_read_b64_tr_b16 v[96:97], v54 offset:24576
    s_waitcnt lgkmcnt(13)
    v_mfma_f32_16x16x32_bf16 v[200:203], v[100:103], v[32:35], v[200:203]
    ds_read_b64_tr_b16 v[98:99], v54 offset:25600
    v_mfma_f32_16x16x32_bf16 v[204:207], v[100:103], v[36:39], v[204:207]
    ds_read_b64_tr_b16 v[100:101], v55 offset:24576
    s_waitcnt lgkmcnt(13)
    v_mfma_f32_16x16x32_bf16 v[208:211], v[104:107], v[32:35], v[208:211]
    ds_read_b64_tr_b16 v[102:103], v55 offset:25600
    v_mfma_f32_16x16x32_bf16 v[212:215], v[104:107], v[36:39], v[212:215]
    ds_read_b64_tr_b16 v[104:105], v56 offset:24576
    s_waitcnt lgkmcnt(13)
    v_mfma_f32_16x16x32_bf16 v[216:219], v[108:111], v[32:35], v[216:219]
    ds_read_b64_tr_b16 v[106:107], v56 offset:25600
    buffer_store_dwordx4 v[136:139], v13, s[8:11], s67 offen sc1
    s_add_u32 s67, s67, 1024
    v_mfma_f32_16x16x32_bf16 v[220:223], v[108:111], v[36:39], v[220:223]
    ds_read_b64_tr_b16 v[108:109], v57 offset:24576
    s_waitcnt lgkmcnt(13)
    v_mfma_f32_16x16x32_bf16 v[224:227], v[112:115], v[32:35], v[224:227]
    ds_read_b64_tr_b16 v[110:111], v57 offset:25600
    v_mfma_f32_16x16x32_bf16 v[228:231], v[112:115], v[36:39], v[228:231]
    ds_read_b64_tr_b16 v[112:113], v58 offset:24576
    s_waitcnt lgkmcnt(13)
    v_mfma_f32_16x16x32_bf16 v[232:235], v[116:119], v[32:35], v[232:235]
    ds_read_b64_tr_b16 v[114:115], v58 offset:25600
    v_mfma_f32_16x16x32_bf16 v[236:239], v[116:119], v[36:39], v[236:239]
    ds_read_b64_tr_b16 v[116:117], v59 offset:24576
    s_waitcnt lgkmcnt(13)
    v_mfma_f32_16x16x32_bf16 v[240:243], v[120:123], v[32:35], v[240:243]
    ds_read_b64_tr_b16 v[118:119], v59 offset:25600
    v_mfma_f32_16x16x32_bf16 v[244:247], v[120:123], v[36:39], v[244:247]
    ds_read_b64_tr_b16 v[120:121], v60 offset:24576
    s_waitcnt lgkmcnt(13)
    v_mfma_f32_16x16x32_bf16 v[248:251], v[124:127], v[32:35], v[248:251]
    ds_read_b64_tr_b16 v[122:123], v60 offset:25600
    v_mfma_f32_16x16x32_bf16 v[252:255], v[124:127], v[36:39], v[252:255]
    ds_read_b64_tr_b16 v[124:125], v61 offset:24576
    ds_read_b64_tr_b16 v[126:127], v61 offset:25600
    buffer_load_dwordx4 v[32:35], v13, s[8:11], s86 offen offset:1024 sc1
    buffer_load_dwordx4 v[36:39], v12, s[8:11], s86 offen offset:1024 sc1
    s_waitcnt vmcnt(15)
    s_waitcnt lgkmcnt(14)
    v_mfma_f32_16x16x32_bf16 v[192:195], v[96:99], v[64:67], v[192:195]
    v_add_u32 v54, 0xfffe0000, v54
    v_mfma_f32_16x16x32_bf16 v[196:199], v[96:99], v[68:71], v[196:199]
    ds_read_b64_tr_b16 v[96:97], v54 offset:0
    s_waitcnt lgkmcnt(13)
    v_mfma_f32_16x16x32_bf16 v[200:203], v[100:103], v[64:67], v[200:203]
    ds_read_b64_tr_b16 v[98:99], v54 offset:1024
    v_add_u32 v55, 0xfffe0000, v55
    v_mfma_f32_16x16x32_bf16 v[204:207], v[100:103], v[68:71], v[204:207]
    ds_read_b64_tr_b16 v[100:101], v55 offset:0
    s_waitcnt lgkmcnt(13)
    v_mfma_f32_16x16x32_bf16 v[208:211], v[104:107], v[64:67], v[208:211]
    ds_read_b64_tr_b16 v[102:103], v55 offset:1024
    v_add_u32 v56, 0xfffe0000, v56
    v_mfma_f32_16x16x32_bf16 v[212:215], v[104:107], v[68:71], v[212:215]
    ds_read_b64_tr_b16 v[104:105], v56 offset:0
    s_waitcnt lgkmcnt(13)
    v_mfma_f32_16x16x32_bf16 v[216:219], v[108:111], v[64:67], v[216:219]
    ds_read_b64_tr_b16 v[106:107], v56 offset:1024
    v_add_u32 v57, 0xfffe0000, v57
    buffer_store_dwordx4 v[140:143], v13, s[8:11], s67 offen sc1
    s_add_u32 s67, s67, s69
    v_mfma_f32_16x16x32_bf16 v[220:223], v[108:111], v[68:71], v[220:223]
    ds_read_b64_tr_b16 v[108:109], v57 offset:0
    s_waitcnt lgkmcnt(13)
    v_mfma_f32_16x16x32_bf16 v[224:227], v[112:115], v[64:67], v[224:227]
    ds_read_b64_tr_b16 v[110:111], v57 offset:1024
    v_add_u32 v58, 0xfffe0000, v58
    v_mfma_f32_16x16x32_bf16 v[228:231], v[112:115], v[68:71], v[228:231]
    ds_read_b64_tr_b16 v[112:113], v58 offset:0
    s_waitcnt lgkmcnt(13)
    v_mfma_f32_16x16x32_bf16 v[232:235], v[116:119], v[64:67], v[232:235]
    ds_read_b64_tr_b16 v[114:115], v58 offset:1024
    v_add_u32 v59, 0xfffe0000, v59
    v_mfma_f32_16x16x32_bf16 v[236:239], v[116:119], v[68:71], v[236:239]
    ds_read_b64_tr_b16 v[116:117], v59 offset:0
    s_waitcnt lgkmcnt(13)
    v_mfma_f32_16x16x32_bf16 v[240:243], v[120:123], v[64:67], v[240:243]
    ds_read_b64_tr_b16 v[118:119], v59 offset:1024
    v_add_u32 v60, 0xfffe0000, v60
    v_mfma_f32_16x16x32_bf16 v[244:247], v[120:123], v[68:71], v[244:247]
    ds_read_b64_tr_b16 v[120:121], v60 offset:0
    s_waitcnt lgkmcnt(13)
    v_mfma_f32_16x16x32_bf16 v[248:251], v[124:127], v[64:67], v[248:251]
    ds_read_b64_tr_b16 v[122:123], v60 offset:1024
    v_add_u32 v61, 0xfffe0000, v61
    v_mfma_f32_16x16x32_bf16 v[252:255], v[124:127], v[68:71], v[252:255]
    ds_read_b64_tr_b16 v[124:125], v61 offset:0
    ds_read_b64_tr_b16 v[126:127], v61 offset:1024
    buffer_load_dwordx4 v[64:67], v13, s[8:11], s86 offen offset:2048 sc1
    buffer_load_dwordx4 v[68:71], v12, s[8:11], s86 offen offset:2048 sc1
    s_waitcnt vmcnt(16)
    s_waitcnt lgkmcnt(14)
    v_mfma_f32_16x16x32_bf16 v[192:195], v[96:99], v[72:75], v[192:195]
    v_mfma_f32_16x16x32_bf16 v[196:199], v[96:99], v[76:79], v[196:199]
    ds_read_b64_tr_b16 v[96:97], v54 offset:8192
    s_waitcnt lgkmcnt(13)
    v_mfma_f32_16x16x32_bf16 v[200:203], v[100:103], v[72:75], v[200:203]
    ds_read_b64_tr_b16 v[98:99], v54 offset:9216
    v_mfma_f32_16x16x32_bf16 v[204:207], v[100:103], v[76:79], v[204:207]
    ds_read_b64_tr_b16 v[100:101], v55 offset:8192
    s_waitcnt lgkmcnt(13)
    v_mfma_f32_16x16x32_bf16 v[208:211], v[104:107], v[72:75], v[208:211]
    ds_read_b64_tr_b16 v[102:103], v55 offset:9216
    v_mfma_f32_16x16x32_bf16 v[212:215], v[104:107], v[76:79], v[212:215]
    ds_read_b64_tr_b16 v[104:105], v56 offset:8192
    s_waitcnt lgkmcnt(13)
    v_mfma_f32_16x16x32_bf16 v[216:219], v[108:111], v[72:75], v[216:219]
    ds_read_b64_tr_b16 v[106:107], v56 offset:9216
    v_mfma_f32_16x16x32_bf16 v[220:223], v[108:111], v[76:79], v[220:223]
    ds_read_b64_tr_b16 v[108:109], v57 offset:8192
    s_waitcnt lgkmcnt(13)
    v_mfma_f32_16x16x32_bf16 v[224:227], v[112:115], v[72:75], v[224:227]
    ds_read_b64_tr_b16 v[110:111], v57 offset:9216
    v_mfma_f32_16x16x32_bf16 v[228:231], v[112:115], v[76:79], v[228:231]
    ds_read_b64_tr_b16 v[112:113], v58 offset:8192
    s_waitcnt lgkmcnt(13)
    v_mfma_f32_16x16x32_bf16 v[232:235], v[116:119], v[72:75], v[232:235]
    ds_read_b64_tr_b16 v[114:115], v58 offset:9216
    v_mfma_f32_16x16x32_bf16 v[236:239], v[116:119], v[76:79], v[236:239]
    ds_read_b64_tr_b16 v[116:117], v59 offset:8192
    s_waitcnt lgkmcnt(13)
    v_mfma_f32_16x16x32_bf16 v[240:243], v[120:123], v[72:75], v[240:243]
    ds_read_b64_tr_b16 v[118:119], v59 offset:9216
    v_mfma_f32_16x16x32_bf16 v[244:247], v[120:123], v[76:79], v[244:247]
    ds_read_b64_tr_b16 v[120:121], v60 offset:8192
    s_waitcnt lgkmcnt(13)
    v_mfma_f32_16x16x32_bf16 v[248:251], v[124:127], v[72:75], v[248:251]
    ds_read_b64_tr_b16 v[122:123], v60 offset:9216
    v_mfma_f32_16x16x32_bf16 v[252:255], v[124:127], v[76:79], v[252:255]
    ds_read_b64_tr_b16 v[124:125], v61 offset:8192
    ds_read_b64_tr_b16 v[126:127], v61 offset:9216
    buffer_load_dwordx4 v[72:75], v13, s[8:11], s86 offen offset:3072 sc1
    buffer_load_dwordx4 v[76:79], v12, s[8:11], s86 offen offset:3072 sc1
    s_waitcnt vmcnt(16)
    s_waitcnt lgkmcnt(14)
    v_mfma_f32_16x16x32_bf16 v[192:195], v[96:99], v[80:83], v[192:195]
    v_mfma_f32_16x16x32_bf16 v[196:199], v[96:99], v[84:87], v[196:199]
    ds_read_b64_tr_b16 v[96:97], v54 offset:16384
    s_waitcnt lgkmcnt(13)
    v_mfma_f32_16x16x32_bf16 v[200:203], v[100:103], v[80:83], v[200:203]
    ds_read_b64_tr_b16 v[98:99], v54 offset:17408
    v_mfma_f32_16x16x32_bf16 v[204:207], v[100:103], v[84:87], v[204:207]
    ds_read_b64_tr_b16 v[100:101], v55 offset:16384
    s_waitcnt lgkmcnt(13)
    v_mfma_f32_16x16x32_bf16 v[208:211], v[104:107], v[80:83], v[208:211]
    ds_read_b64_tr_b16 v[102:103], v55 offset:17408
    v_mfma_f32_16x16x32_bf16 v[212:215], v[104:107], v[84:87], v[212:215]
    ds_read_b64_tr_b16 v[104:105], v56 offset:16384
    s_waitcnt lgkmcnt(13)
    v_mfma_f32_16x16x32_bf16 v[216:219], v[108:111], v[80:83], v[216:219]
    ds_read_b64_tr_b16 v[106:107], v56 offset:17408
    v_mfma_f32_16x16x32_bf16 v[220:223], v[108:111], v[84:87], v[220:223]
    ds_read_b64_tr_b16 v[108:109], v57 offset:16384
    s_waitcnt lgkmcnt(13)
    v_mfma_f32_16x16x32_bf16 v[224:227], v[112:115], v[80:83], v[224:227]
    ds_read_b64_tr_b16 v[110:111], v57 offset:17408
    v_mfma_f32_16x16x32_bf16 v[228:231], v[112:115], v[84:87], v[228:231]
    ds_read_b64_tr_b16 v[112:113], v58 offset:16384
    s_waitcnt lgkmcnt(13)
    v_mfma_f32_16x16x32_bf16 v[232:235], v[116:119], v[80:83], v[232:235]
    ds_read_b64_tr_b16 v[114:115], v58 offset:17408
    v_mfma_f32_16x16x32_bf16 v[236:239], v[116:119], v[84:87], v[236:239]
    ds_read_b64_tr_b16 v[116:117], v59 offset:16384
    s_waitcnt lgkmcnt(13)
    v_mfma_f32_16x16x32_bf16 v[240:243], v[120:123], v[80:83], v[240:243]
    ds_read_b64_tr_b16 v[118:119], v59 offset:17408
    v_mfma_f32_16x16x32_bf16 v[244:247], v[120:123], v[84:87], v[244:247]
    ds_read_b64_tr_b16 v[120:121], v60 offset:16384
    s_waitcnt lgkmcnt(13)
    v_mfma_f32_16x16x32_bf16 v[248:251], v[124:127], v[80:83], v[248:251]
    ds_read_b64_tr_b16 v[122:123], v60 offset:17408
    v_mfma_f32_16x16x32_bf16 v[252:255], v[124:127], v[84:87], v[252:255]
    ds_read_b64_tr_b16 v[124:125], v61 offset:16384
    ds_read_b64_tr_b16 v[126:127], v61 offset:17408
    buffer_load_dwordx4 v[80:83], v13, s[8:11], s87 offen offset:0 sc1
    buffer_load_dwordx4 v[84:87], v12, s[8:11], s87 offen offset:0 sc1
    s_waitcnt vmcnt(16)
    s_waitcnt lgkmcnt(14)
    v_mfma_f32_16x16x32_bf16 v[192:195], v[96:99], v[88:91], v[192:195]
    v_mfma_f32_16x16x32_bf16 v[196:199], v[96:99], v[92:95], v[196:199]
    ds_read_b64_tr_b16 v[96:97], v54 offset:24576
    s_waitcnt lgkmcnt(13)
    v_mfma_f32_16x16x32_bf16 v[200:203], v[100:103], v[88:91], v[200:203]
    ds_read_b64_tr_b16 v[98:99], v54 offset:25600
    v_mfma_f32_16x16x32_bf16 v[204:207], v[100:103], v[92:95], v[204:207]
    ds_read_b64_tr_b16 v[100:101], v55 offset:24576
    s_waitcnt lgkmcnt(13)
    v_mfma_f32_16x16x32_bf16 v[208:211], v[104:107], v[88:91], v[208:211]
    ds_read_b64_tr_b16 v[102:103], v55 offset:25600
    v_mfma_f32_16x16x32_bf16 v[212:215], v[104:107], v[92:95], v[212:215]
    ds_read_b64_tr_b16 v[104:105], v56 offset:24576
    s_waitcnt lgkmcnt(13)
    v_mfma_f32_16x16x32_bf16 v[216:219], v[108:111], v[88:91], v[216:219]
    ds_read_b64_tr_b16 v[106:107], v56 offset:25600
    v_mfma_f32_16x16x32_bf16 v[220:223], v[108:111], v[92:95], v[220:223]
    ds_read_b64_tr_b16 v[108:109], v57 offset:24576
    s_waitcnt lgkmcnt(13)
    v_mfma_f32_16x16x32_bf16 v[224:227], v[112:115], v[88:91], v[224:227]
    ds_read_b64_tr_b16 v[110:111], v57 offset:25600
    v_mfma_f32_16x16x32_bf16 v[228:231], v[112:115], v[92:95], v[228:231]
    ds_read_b64_tr_b16 v[112:113], v58 offset:24576
    s_waitcnt lgkmcnt(13)
    v_mfma_f32_16x16x32_bf16 v[232:235], v[116:119], v[88:91], v[232:235]
    ds_read_b64_tr_b16 v[114:115], v58 offset:25600
    v_mfma_f32_16x16x32_bf16 v[236:239], v[116:119], v[92:95], v[236:239]
    ds_read_b64_tr_b16 v[116:117], v59 offset:24576
    s_waitcnt lgkmcnt(13)
    v_mfma_f32_16x16x32_bf16 v[240:243], v[120:123], v[88:91], v[240:243]
    ds_read_b64_tr_b16 v[118:119], v59 offset:25600
    v_mfma_f32_16x16x32_bf16 v[244:247], v[120:123], v[92:95], v[244:247]
    ds_read_b64_tr_b16 v[120:121], v60 offset:24576
    s_waitcnt lgkmcnt(13)
    v_mfma_f32_16x16x32_bf16 v[248:251], v[124:127], v[88:91], v[248:251]
    ds_read_b64_tr_b16 v[122:123], v60 offset:25600
    v_mfma_f32_16x16x32_bf16 v[252:255], v[124:127], v[92:95], v[252:255]
    ds_read_b64_tr_b16 v[124:125], v61 offset:24576
    ds_read_b64_tr_b16 v[126:127], v61 offset:25600
    buffer_load_dwordx4 v[88:91], v13, s[8:11], s87 offen offset:1024 sc1
    buffer_load_dwordx4 v[92:95], v12, s[8:11], s87 offen offset:1024 sc1
    s_waitcnt vmcnt(8)
    s_lshl_b32 s6, s4, 3
    s_add_u32 s6, s6, s5
    s_lshl_b32 s6, s6, 5
    s_add_u32 s6, s6, s3
    s_lshl_b32 s6, s6, 2
    s_add_u32 s6, s6, 3866624
    v_mov_b32 v2, 1
    v_mov_b32 v3, 0x5000000
    v_writelane_b32 v3, s6, 0
    buffer_store_dword v2, v3, s[8:11], 0 offen sc1
    s_waitcnt lgkmcnt(14)
    v_mfma_f32_16x16x32_bf16 v[192:195], v[96:99], v[16:19], v[192:195]
    v_mfma_f32_16x16x32_bf16 v[196:199], v[96:99], v[20:23], v[196:199]
    ds_read_b64_tr_b16 v[96:97], v54 offset:32768
    s_waitcnt lgkmcnt(13)
    v_mfma_f32_16x16x32_bf16 v[200:203], v[100:103], v[16:19], v[200:203]
    ds_read_b64_tr_b16 v[98:99], v54 offset:33792
    v_mfma_f32_16x16x32_bf16 v[204:207], v[100:103], v[20:23], v[204:207]
    ds_read_b64_tr_b16 v[100:101], v55 offset:32768
    s_waitcnt lgkmcnt(13)
    v_mfma_f32_16x16x32_bf16 v[208:211], v[104:107], v[16:19], v[208:211]
    ds_read_b64_tr_b16 v[102:103], v55 offset:33792
    v_mfma_f32_16x16x32_bf16 v[212:215], v[104:107], v[20:23], v[212:215]
    ds_read_b64_tr_b16 v[104:105], v56 offset:32768
    s_waitcnt lgkmcnt(13)
    v_mfma_f32_16x16x32_bf16 v[216:219], v[108:111], v[16:19], v[216:219]
    ds_read_b64_tr_b16 v[106:107], v56 offset:33792
    v_mfma_f32_16x16x32_bf16 v[220:223], v[108:111], v[20:23], v[220:223]
    ds_read_b64_tr_b16 v[108:109], v57 offset:32768
    s_waitcnt lgkmcnt(13)
    v_mfma_f32_16x16x32_bf16 v[224:227], v[112:115], v[16:19], v[224:227]
    ds_read_b64_tr_b16 v[110:111], v57 offset:33792
    v_mfma_f32_16x16x32_bf16 v[228:231], v[112:115], v[20:23], v[228:231]
    ds_read_b64_tr_b16 v[112:113], v58 offset:32768
    s_waitcnt lgkmcnt(13)
    v_mfma_f32_16x16x32_bf16 v[232:235], v[116:119], v[16:19], v[232:235]
    ds_read_b64_tr_b16 v[114:115], v58 offset:33792
    v_mfma_f32_16x16x32_bf16 v[236:239], v[116:119], v[20:23], v[236:239]
    ds_read_b64_tr_b16 v[116:117], v59 offset:32768
    s_waitcnt lgkmcnt(13)
    v_mfma_f32_16x16x32_bf16 v[240:243], v[120:123], v[16:19], v[240:243]
    ds_read_b64_tr_b16 v[118:119], v59 offset:33792
    v_mfma_f32_16x16x32_bf16 v[244:247], v[120:123], v[20:23], v[244:247]
    ds_read_b64_tr_b16 v[120:121], v60 offset:32768
    s_waitcnt lgkmcnt(13)
    v_mfma_f32_16x16x32_bf16 v[248:251], v[124:127], v[16:19], v[248:251]
    ds_read_b64_tr_b16 v[122:123], v60 offset:33792
    v_mfma_f32_16x16x32_bf16 v[252:255], v[124:127], v[20:23], v[252:255]
    ds_read_b64_tr_b16 v[124:125], v61 offset:32768
    ds_read_b64_tr_b16 v[126:127], v61 offset:33792
    buffer_load_dwordx4 v[16:19], v13, s[8:11], s87 offen offset:2048 sc1
    buffer_load_dwordx4 v[20:23], v12, s[8:11], s87 offen offset:2048 sc1
    s_waitcnt lgkmcnt(14)
    v_mfma_f32_16x16x32_bf16 v[192:195], v[96:99], v[24:27], v[192:195]
    v_mfma_f32_16x16x32_bf16 v[196:199], v[96:99], v[28:31], v[196:199]
    ds_read_b64_tr_b16 v[96:97], v54 offset:40960
    s_waitcnt lgkmcnt(13)
    v_mfma_f32_16x16x32_bf16 v[200:203], v[100:103], v[24:27], v[200:203]
    ds_read_b64_tr_b16 v[98:99], v54 offset:41984
    v_mfma_f32_16x16x32_bf16 v[204:207], v[100:103], v[28:31], v[204:207]
    ds_read_b64_tr_b16 v[100:101], v55 offset:40960
    s_waitcnt lgkmcnt(13)
    v_mfma_f32_16x16x32_bf16 v[208:211], v[104:107], v[24:27], v[208:211]
    ds_read_b64_tr_b16 v[102:103], v55 offset:41984
    v_mfma_f32_16x16x32_bf16 v[212:215], v[104:107], v[28:31], v[212:215]
    ds_read_b64_tr_b16 v[104:105], v56 offset:40960
    s_waitcnt lgkmcnt(13)
    v_mfma_f32_16x16x32_bf16 v[216:219], v[108:111], v[24:27], v[216:219]
    ds_read_b64_tr_b16 v[106:107], v56 offset:41984
    v_mfma_f32_16x16x32_bf16 v[220:223], v[108:111], v[28:31], v[220:223]
    ds_read_b64_tr_b16 v[108:109], v57 offset:40960
    s_waitcnt lgkmcnt(13)
    v_mfma_f32_16x16x32_bf16 v[224:227], v[112:115], v[24:27], v[224:227]
    ds_read_b64_tr_b16 v[110:111], v57 offset:41984
    v_mfma_f32_16x16x32_bf16 v[228:231], v[112:115], v[28:31], v[228:231]
    ds_read_b64_tr_b16 v[112:113], v58 offset:40960
    s_waitcnt lgkmcnt(13)
    v_mfma_f32_16x16x32_bf16 v[232:235], v[116:119], v[24:27], v[232:235]
    ds_read_b64_tr_b16 v[114:115], v58 offset:41984
    v_mfma_f32_16x16x32_bf16 v[236:239], v[116:119], v[28:31], v[236:239]
    ds_read_b64_tr_b16 v[116:117], v59 offset:40960
    s_waitcnt lgkmcnt(13)
    v_mfma_f32_16x16x32_bf16 v[240:243], v[120:123], v[24:27], v[240:243]
    ds_read_b64_tr_b16 v[118:119], v59 offset:41984
    v_mfma_f32_16x16x32_bf16 v[244:247], v[120:123], v[28:31], v[244:247]
    ds_read_b64_tr_b16 v[120:121], v60 offset:40960
    s_waitcnt lgkmcnt(13)
    v_mfma_f32_16x16x32_bf16 v[248:251], v[124:127], v[24:27], v[248:251]
    ds_read_b64_tr_b16 v[122:123], v60 offset:41984
    v_mfma_f32_16x16x32_bf16 v[252:255], v[124:127], v[28:31], v[252:255]
    ds_read_b64_tr_b16 v[124:125], v61 offset:40960
    ds_read_b64_tr_b16 v[126:127], v61 offset:41984
    buffer_load_dwordx4 v[24:27], v13, s[8:11], s87 offen offset:3072 sc1
    buffer_load_dwordx4 v[28:31], v12, s[8:11], s87 offen offset:3072 sc1
    s_waitcnt lgkmcnt(14)
    v_mfma_f32_16x16x32_bf16 v[192:195], v[96:99], v[32:35], v[192:195]
    v_mfma_f32_16x16x32_bf16 v[196:199], v[96:99], v[36:39], v[196:199]
    ds_read_b64_tr_b16 v[96:97], v54 offset:49152
    s_waitcnt lgkmcnt(13)
    v_mfma_f32_16x16x32_bf16 v[200:203], v[100:103], v[32:35], v[200:203]
    ds_read_b64_tr_b16 v[98:99], v54 offset:50176
    v_mfma_f32_16x16x32_bf16 v[204:207], v[100:103], v[36:39], v[204:207]
    ds_read_b64_tr_b16 v[100:101], v55 offset:49152
    s_waitcnt lgkmcnt(13)
    v_mfma_f32_16x16x32_bf16 v[208:211], v[104:107], v[32:35], v[208:211]
    ds_read_b64_tr_b16 v[102:103], v55 offset:50176
    v_mfma_f32_16x16x32_bf16 v[212:215], v[104:107], v[36:39], v[212:215]
    ds_read_b64_tr_b16 v[104:105], v56 offset:49152
    s_waitcnt lgkmcnt(13)
    v_mfma_f32_16x16x32_bf16 v[216:219], v[108:111], v[32:35], v[216:219]
    ds_read_b64_tr_b16 v[106:107], v56 offset:50176
    v_mfma_f32_16x16x32_bf16 v[220:223], v[108:111], v[36:39], v[220:223]
    ds_read_b64_tr_b16 v[108:109], v57 offset:49152
    s_waitcnt lgkmcnt(13)
    v_mfma_f32_16x16x32_bf16 v[224:227], v[112:115], v[32:35], v[224:227]
    ds_read_b64_tr_b16 v[110:111], v57 offset:50176
    v_mfma_f32_16x16x32_bf16 v[228:231], v[112:115], v[36:39], v[228:231]
    ds_read_b64_tr_b16 v[112:113], v58 offset:49152
    s_waitcnt lgkmcnt(13)
    v_mfma_f32_16x16x32_bf16 v[232:235], v[116:119], v[32:35], v[232:235]
    ds_read_b64_tr_b16 v[114:115], v58 offset:50176
    v_mfma_f32_16x16x32_bf16 v[236:239], v[116:119], v[36:39], v[236:239]
    ds_read_b64_tr_b16 v[116:117], v59 offset:49152
    s_waitcnt lgkmcnt(13)
    v_mfma_f32_16x16x32_bf16 v[240:243], v[120:123], v[32:35], v[240:243]
    ds_read_b64_tr_b16 v[118:119], v59 offset:50176
    v_mfma_f32_16x16x32_bf16 v[244:247], v[120:123], v[36:39], v[244:247]
    ds_read_b64_tr_b16 v[120:121], v60 offset:49152
    s_waitcnt lgkmcnt(13)
    v_mfma_f32_16x16x32_bf16 v[248:251], v[124:127], v[32:35], v[248:251]
    ds_read_b64_tr_b16 v[122:123], v60 offset:50176
    v_mfma_f32_16x16x32_bf16 v[252:255], v[124:127], v[36:39], v[252:255]
    ds_read_b64_tr_b16 v[124:125], v61 offset:49152
    ds_read_b64_tr_b16 v[126:127], v61 offset:50176
    buffer_load_dwordx4 v[32:35], v13, s[8:11], s88 offen offset:0 sc1
    buffer_load_dwordx4 v[36:39], v12, s[8:11], s88 offen offset:0 sc1
    s_waitcnt vmcnt(13)
    s_waitcnt lgkmcnt(14)
    v_mfma_f32_16x16x32_bf16 v[192:195], v[96:99], v[64:67], v[192:195]
    v_mfma_f32_16x16x32_bf16 v[196:199], v[96:99], v[68:71], v[196:199]
    ds_read_b64_tr_b16 v[96:97], v54 offset:57344
    s_waitcnt lgkmcnt(13)
    v_mfma_f32_16x16x32_bf16 v[200:203], v[100:103], v[64:67], v[200:203]
    ds_read_b64_tr_b16 v[98:99], v54 offset:58368
    v_mfma_f32_16x16x32_bf16 v[204:207], v[100:103], v[68:71], v[204:207]
    ds_read_b64_tr_b16 v[100:101], v55 offset:57344
    s_waitcnt lgkmcnt(13)
    v_mfma_f32_16x16x32_bf16 v[208:211], v[104:107], v[64:67], v[208:211]
    ds_read_b64_tr_b16 v[102:103], v55 offset:58368
    v_mfma_f32_16x16x32_bf16 v[212:215], v[104:107], v[68:71], v[212:215]
    ds_read_b64_tr_b16 v[104:105], v56 offset:57344
    s_waitcnt lgkmcnt(13)
    v_mfma_f32_16x16x32_bf16 v[216:219], v[108:111], v[64:67], v[216:219]
    ds_read_b64_tr_b16 v[106:107], v56 offset:58368
    v_mfma_f32_16x16x32_bf16 v[220:223], v[108:111], v[68:71], v[220:223]
    ds_read_b64_tr_b16 v[108:109], v57 offset:57344
    s_waitcnt lgkmcnt(13)
    v_mfma_f32_16x16x32_bf16 v[224:227], v[112:115], v[64:67], v[224:227]
    ds_read_b64_tr_b16 v[110:111], v57 offset:58368
    v_mfma_f32_16x16x32_bf16 v[228:231], v[112:115], v[68:71], v[228:231]
    ds_read_b64_tr_b16 v[112:113], v58 offset:57344
    s_waitcnt lgkmcnt(13)
    v_mfma_f32_16x16x32_bf16 v[232:235], v[116:119], v[64:67], v[232:235]
    ds_read_b64_tr_b16 v[114:115], v58 offset:58368
    v_mfma_f32_16x16x32_bf16 v[236:239], v[116:119], v[68:71], v[236:239]
    ds_read_b64_tr_b16 v[116:117], v59 offset:57344
    s_waitcnt lgkmcnt(13)
    v_mfma_f32_16x16x32_bf16 v[240:243], v[120:123], v[64:67], v[240:243]
    ds_read_b64_tr_b16 v[118:119], v59 offset:58368
    v_mfma_f32_16x16x32_bf16 v[244:247], v[120:123], v[68:71], v[244:247]
    ds_read_b64_tr_b16 v[120:121], v60 offset:57344
    s_waitcnt lgkmcnt(13)
    v_mfma_f32_16x16x32_bf16 v[248:251], v[124:127], v[64:67], v[248:251]
    ds_read_b64_tr_b16 v[122:123], v60 offset:58368
    v_mfma_f32_16x16x32_bf16 v[252:255], v[124:127], v[68:71], v[252:255]
    ds_read_b64_tr_b16 v[124:125], v61 offset:57344
    ds_read_b64_tr_b16 v[126:127], v61 offset:58368
    buffer_load_dwordx4 v[64:67], v13, s[8:11], s88 offen offset:1024 sc1
    buffer_load_dwordx4 v[68:71], v12, s[8:11], s88 offen offset:1024 sc1
    s_waitcnt vmcnt(13)
    s_waitcnt lgkmcnt(14)
    v_mfma_f32_16x16x32_bf16 v[192:195], v[96:99], v[72:75], v[192:195]
    v_add_u32 v54, 0x10000, v54
    v_mfma_f32_16x16x32_bf16 v[196:199], v[96:99], v[76:79], v[196:199]
    s_waitcnt lgkmcnt(12)
    v_mfma_f32_16x16x32_bf16 v[200:203], v[100:103], v[72:75], v[200:203]
    v_add_u32 v55, 0x10000, v55
    v_mfma_f32_16x16x32_bf16 v[204:207], v[100:103], v[76:79], v[204:207]
    s_waitcnt lgkmcnt(0)
    s_barrier
    ds_read_b64_tr_b16 v[96:97], v54 offset:0
    ds_read_b64_tr_b16 v[98:99], v54 offset:1024
    ds_read_b64_tr_b16 v[100:101], v55 offset:0
    v_mfma_f32_16x16x32_bf16 v[208:211], v[104:107], v[72:75], v[208:211]
    ds_read_b64_tr_b16 v[102:103], v55 offset:1024
    v_add_u32 v56, 0x10000, v56
    v_mfma_f32_16x16x32_bf16 v[212:215], v[104:107], v[76:79], v[212:215]
    ds_read_b64_tr_b16 v[104:105], v56 offset:0
    v_mfma_f32_16x16x32_bf16 v[216:219], v[108:111], v[72:75], v[216:219]
    ds_read_b64_tr_b16 v[106:107], v56 offset:1024
    v_add_u32 v57, 0x10000, v57
    v_mfma_f32_16x16x32_bf16 v[220:223], v[108:111], v[76:79], v[220:223]
    ds_read_b64_tr_b16 v[108:109], v57 offset:0
    v_mfma_f32_16x16x32_bf16 v[224:227], v[112:115], v[72:75], v[224:227]
    ds_read_b64_tr_b16 v[110:111], v57 offset:1024
    v_add_u32 v58, 0x10000, v58
    v_mfma_f32_16x16x32_bf16 v[228:231], v[112:115], v[76:79], v[228:231]
    ds_read_b64_tr_b16 v[112:113], v58 offset:0
    v_mfma_f32_16x16x32_bf16 v[232:235], v[116:119], v[72:75], v[232:235]
    ds_read_b64_tr_b16 v[114:115], v58 offset:1024
    v_add_u32 v59, 0x10000, v59
    v_mfma_f32_16x16x32_bf16 v[236:239], v[116:119], v[76:79], v[236:239]
    ds_read_b64_tr_b16 v[116:117], v59 offset:0
    v_mfma_f32_16x16x32_bf16 v[240:243], v[120:123], v[72:75], v[240:243]
    ds_read_b64_tr_b16 v[118:119], v59 offset:1024
    v_add_u32 v60, 0x10000, v60
    v_mfma_f32_16x16x32_bf16 v[244:247], v[120:123], v[76:79], v[244:247]
    ds_read_b64_tr_b16 v[120:121], v60 offset:0
    v_mfma_f32_16x16x32_bf16 v[248:251], v[124:127], v[72:75], v[248:251]
    ds_read_b64_tr_b16 v[122:123], v60 offset:1024
    v_add_u32 v61, 0x10000, v61
    v_mfma_f32_16x16x32_bf16 v[252:255], v[124:127], v[76:79], v[252:255]
    ds_read_b64_tr_b16 v[124:125], v61 offset:0
    ds_read_b64_tr_b16 v[126:127], v61 offset:1024
    buffer_load_dwordx4 v[72:75], v13, s[8:11], s88 offen offset:2048 sc1
    buffer_load_dwordx4 v[76:79], v12, s[8:11], s88 offen offset:2048 sc1
    s_waitcnt vmcnt(13)
    s_waitcnt lgkmcnt(14)
    v_mfma_f32_16x16x32_bf16 v[192:195], v[96:99], v[80:83], v[192:195]
    v_mfma_f32_16x16x32_bf16 v[196:199], v[96:99], v[84:87], v[196:199]
    ds_read_b64_tr_b16 v[96:97], v54 offset:8192
    s_waitcnt lgkmcnt(13)
    v_mfma_f32_16x16x32_bf16 v[200:203], v[100:103], v[80:83], v[200:203]
    ds_read_b64_tr_b16 v[98:99], v54 offset:9216
    v_mfma_f32_16x16x32_bf16 v[204:207], v[100:103], v[84:87], v[204:207]
    ds_read_b64_tr_b16 v[100:101], v55 offset:8192
    s_waitcnt lgkmcnt(13)
    v_mfma_f32_16x16x32_bf16 v[208:211], v[104:107], v[80:83], v[208:211]
    ds_read_b64_tr_b16 v[102:103], v55 offset:9216
    v_mfma_f32_16x16x32_bf16 v[212:215], v[104:107], v[84:87], v[212:215]
    ds_read_b64_tr_b16 v[104:105], v56 offset:8192
    s_waitcnt lgkmcnt(13)
    v_mfma_f32_16x16x32_bf16 v[216:219], v[108:111], v[80:83], v[216:219]
    ds_read_b64_tr_b16 v[106:107], v56 offset:9216
    v_mfma_f32_16x16x32_bf16 v[220:223], v[108:111], v[84:87], v[220:223]
    ds_read_b64_tr_b16 v[108:109], v57 offset:8192
    s_waitcnt lgkmcnt(13)
    v_mfma_f32_16x16x32_bf16 v[224:227], v[112:115], v[80:83], v[224:227]
    ds_read_b64_tr_b16 v[110:111], v57 offset:9216
    v_mfma_f32_16x16x32_bf16 v[228:231], v[112:115], v[84:87], v[228:231]
    ds_read_b64_tr_b16 v[112:113], v58 offset:8192
    s_waitcnt lgkmcnt(13)
    v_mfma_f32_16x16x32_bf16 v[232:235], v[116:119], v[80:83], v[232:235]
    ds_read_b64_tr_b16 v[114:115], v58 offset:9216
    v_mfma_f32_16x16x32_bf16 v[236:239], v[116:119], v[84:87], v[236:239]
    ds_read_b64_tr_b16 v[116:117], v59 offset:8192
    s_waitcnt lgkmcnt(13)
    v_mfma_f32_16x16x32_bf16 v[240:243], v[120:123], v[80:83], v[240:243]
    ds_read_b64_tr_b16 v[118:119], v59 offset:9216
    v_mfma_f32_16x16x32_bf16 v[244:247], v[120:123], v[84:87], v[244:247]
    ds_read_b64_tr_b16 v[120:121], v60 offset:8192
    s_waitcnt lgkmcnt(13)
    v_mfma_f32_16x16x32_bf16 v[248:251], v[124:127], v[80:83], v[248:251]
    ds_read_b64_tr_b16 v[122:123], v60 offset:9216
    v_mfma_f32_16x16x32_bf16 v[252:255], v[124:127], v[84:87], v[252:255]
    ds_read_b64_tr_b16 v[124:125], v61 offset:8192
    ds_read_b64_tr_b16 v[126:127], v61 offset:9216
    buffer_load_dwordx4 v[80:83], v13, s[8:11], s88 offen offset:3072 sc1
    buffer_load_dwordx4 v[84:87], v12, s[8:11], s88 offen offset:3072 sc1
    s_waitcnt vmcnt(13)
    s_waitcnt lgkmcnt(14)
    v_mfma_f32_16x16x32_bf16 v[192:195], v[96:99], v[88:91], v[192:195]
    v_mfma_f32_16x16x32_bf16 v[196:199], v[96:99], v[92:95], v[196:199]
    ds_read_b64_tr_b16 v[96:97], v54 offset:16384
    s_waitcnt lgkmcnt(13)
    v_mfma_f32_16x16x32_bf16 v[200:203], v[100:103], v[88:91], v[200:203]
    ds_read_b64_tr_b16 v[98:99], v54 offset:17408
    v_mfma_f32_16x16x32_bf16 v[204:207], v[100:103], v[92:95], v[204:207]
    ds_read_b64_tr_b16 v[100:101], v55 offset:16384
    s_waitcnt lgkmcnt(13)
    v_mfma_f32_16x16x32_bf16 v[208:211], v[104:107], v[88:91], v[208:211]
    ds_read_b64_tr_b16 v[102:103], v55 offset:17408
    v_mfma_f32_16x16x32_bf16 v[212:215], v[104:107], v[92:95], v[212:215]
    ds_read_b64_tr_b16 v[104:105], v56 offset:16384
    s_waitcnt lgkmcnt(13)
    v_mfma_f32_16x16x32_bf16 v[216:219], v[108:111], v[88:91], v[216:219]
    ds_read_b64_tr_b16 v[106:107], v56 offset:17408
    v_mfma_f32_16x16x32_bf16 v[220:223], v[108:111], v[92:95], v[220:223]
    ds_read_b64_tr_b16 v[108:109], v57 offset:16384
    s_waitcnt lgkmcnt(13)
    v_mfma_f32_16x16x32_bf16 v[224:227], v[112:115], v[88:91], v[224:227]
    ds_read_b64_tr_b16 v[110:111], v57 offset:17408
    v_mfma_f32_16x16x32_bf16 v[228:231], v[112:115], v[92:95], v[228:231]
    ds_read_b64_tr_b16 v[112:113], v58 offset:16384
    s_waitcnt lgkmcnt(13)
    v_mfma_f32_16x16x32_bf16 v[232:235], v[116:119], v[88:91], v[232:235]
    ds_read_b64_tr_b16 v[114:115], v58 offset:17408
    v_mfma_f32_16x16x32_bf16 v[236:239], v[116:119], v[92:95], v[236:239]
    ds_read_b64_tr_b16 v[116:117], v59 offset:16384
    s_waitcnt lgkmcnt(13)
    v_mfma_f32_16x16x32_bf16 v[240:243], v[120:123], v[88:91], v[240:243]
    ds_read_b64_tr_b16 v[118:119], v59 offset:17408
    v_mfma_f32_16x16x32_bf16 v[244:247], v[120:123], v[92:95], v[244:247]
    ds_read_b64_tr_b16 v[120:121], v60 offset:16384
    s_waitcnt lgkmcnt(13)
    v_mfma_f32_16x16x32_bf16 v[248:251], v[124:127], v[88:91], v[248:251]
    ds_read_b64_tr_b16 v[122:123], v60 offset:17408
    v_mfma_f32_16x16x32_bf16 v[252:255], v[124:127], v[92:95], v[252:255]
    ds_read_b64_tr_b16 v[124:125], v61 offset:16384
    ds_read_b64_tr_b16 v[126:127], v61 offset:17408
    s_waitcnt vmcnt(10)
    s_waitcnt lgkmcnt(14)
    v_mfma_f32_16x16x32_bf16 v[192:195], v[96:99], v[16:19], v[192:195]
    v_mfma_f32_16x16x32_bf16 v[196:199], v[96:99], v[20:23], v[196:199]
    ds_read_b64_tr_b16 v[96:97], v54 offset:24576
    s_waitcnt lgkmcnt(13)
    v_mfma_f32_16x16x32_bf16 v[200:203], v[100:103], v[16:19], v[200:203]
    ds_read_b64_tr_b16 v[98:99], v54 offset:25600
    v_mfma_f32_16x16x32_bf16 v[204:207], v[100:103], v[20:23], v[204:207]
    ds_read_b64_tr_b16 v[100:101], v55 offset:24576
    s_waitcnt lgkmcnt(13)
    v_mfma_f32_16x16x32_bf16 v[208:211], v[104:107], v[16:19], v[208:211]
    ds_read_b64_tr_b16 v[102:103], v55 offset:25600
    v_mfma_f32_16x16x32_bf16 v[212:215], v[104:107], v[20:23], v[212:215]
    ds_read_b64_tr_b16 v[104:105], v56 offset:24576
    s_waitcnt lgkmcnt(13)
    v_mfma_f32_16x16x32_bf16 v[216:219], v[108:111], v[16:19], v[216:219]
    ds_read_b64_tr_b16 v[106:107], v56 offset:25600
    v_mfma_f32_16x16x32_bf16 v[220:223], v[108:111], v[20:23], v[220:223]
    ds_read_b64_tr_b16 v[108:109], v57 offset:24576
    s_waitcnt lgkmcnt(13)
    v_mfma_f32_16x16x32_bf16 v[224:227], v[112:115], v[16:19], v[224:227]
    ds_read_b64_tr_b16 v[110:111], v57 offset:25600
    v_mfma_f32_16x16x32_bf16 v[228:231], v[112:115], v[20:23], v[228:231]
    ds_read_b64_tr_b16 v[112:113], v58 offset:24576
    s_waitcnt lgkmcnt(13)
    v_mfma_f32_16x16x32_bf16 v[232:235], v[116:119], v[16:19], v[232:235]
    ds_read_b64_tr_b16 v[114:115], v58 offset:25600
    v_mfma_f32_16x16x32_bf16 v[236:239], v[116:119], v[20:23], v[236:239]
    ds_read_b64_tr_b16 v[116:117], v59 offset:24576
    s_waitcnt lgkmcnt(13)
    v_mfma_f32_16x16x32_bf16 v[240:243], v[120:123], v[16:19], v[240:243]
    ds_read_b64_tr_b16 v[118:119], v59 offset:25600
    v_mfma_f32_16x16x32_bf16 v[244:247], v[120:123], v[20:23], v[244:247]
    ds_read_b64_tr_b16 v[120:121], v60 offset:24576
    s_waitcnt lgkmcnt(13)
    v_mfma_f32_16x16x32_bf16 v[248:251], v[124:127], v[16:19], v[248:251]
    ds_read_b64_tr_b16 v[122:123], v60 offset:25600
    v_mfma_f32_16x16x32_bf16 v[252:255], v[124:127], v[20:23], v[252:255]
    ds_read_b64_tr_b16 v[124:125], v61 offset:24576
    ds_read_b64_tr_b16 v[126:127], v61 offset:25600
    s_waitcnt vmcnt(8)
    s_waitcnt lgkmcnt(14)
    v_mfma_f32_16x16x32_bf16 v[192:195], v[96:99], v[24:27], v[192:195]
    v_mfma_f32_16x16x32_bf16 v[196:199], v[96:99], v[28:31], v[196:199]
    ds_read_b64_tr_b16 v[96:97], v54 offset:32768
    s_waitcnt lgkmcnt(13)
    v_mfma_f32_16x16x32_bf16 v[200:203], v[100:103], v[24:27], v[200:203]
    ds_read_b64_tr_b16 v[98:99], v54 offset:33792
    v_mfma_f32_16x16x32_bf16 v[204:207], v[100:103], v[28:31], v[204:207]
    ds_read_b64_tr_b16 v[100:101], v55 offset:32768
    s_waitcnt lgkmcnt(13)
    v_mfma_f32_16x16x32_bf16 v[208:211], v[104:107], v[24:27], v[208:211]
    ds_read_b64_tr_b16 v[102:103], v55 offset:33792
    v_mfma_f32_16x16x32_bf16 v[212:215], v[104:107], v[28:31], v[212:215]
    ds_read_b64_tr_b16 v[104:105], v56 offset:32768
    s_waitcnt lgkmcnt(13)
    v_mfma_f32_16x16x32_bf16 v[216:219], v[108:111], v[24:27], v[216:219]
    ds_read_b64_tr_b16 v[106:107], v56 offset:33792
    v_mfma_f32_16x16x32_bf16 v[220:223], v[108:111], v[28:31], v[220:223]
    ds_read_b64_tr_b16 v[108:109], v57 offset:32768
    s_waitcnt lgkmcnt(13)
    v_mfma_f32_16x16x32_bf16 v[224:227], v[112:115], v[24:27], v[224:227]
    ds_read_b64_tr_b16 v[110:111], v57 offset:33792
    v_mfma_f32_16x16x32_bf16 v[228:231], v[112:115], v[28:31], v[228:231]
    ds_read_b64_tr_b16 v[112:113], v58 offset:32768
    s_waitcnt lgkmcnt(13)
    v_mfma_f32_16x16x32_bf16 v[232:235], v[116:119], v[24:27], v[232:235]
    ds_read_b64_tr_b16 v[114:115], v58 offset:33792
    v_mfma_f32_16x16x32_bf16 v[236:239], v[116:119], v[28:31], v[236:239]
    ds_read_b64_tr_b16 v[116:117], v59 offset:32768
    s_waitcnt lgkmcnt(13)
    v_mfma_f32_16x16x32_bf16 v[240:243], v[120:123], v[24:27], v[240:243]
    ds_read_b64_tr_b16 v[118:119], v59 offset:33792
    v_mfma_f32_16x16x32_bf16 v[244:247], v[120:123], v[28:31], v[244:247]
    ds_read_b64_tr_b16 v[120:121], v60 offset:32768
    s_waitcnt lgkmcnt(13)
    v_mfma_f32_16x16x32_bf16 v[248:251], v[124:127], v[24:27], v[248:251]
    ds_read_b64_tr_b16 v[122:123], v60 offset:33792
    v_mfma_f32_16x16x32_bf16 v[252:255], v[124:127], v[28:31], v[252:255]
    ds_read_b64_tr_b16 v[124:125], v61 offset:32768
    ds_read_b64_tr_b16 v[126:127], v61 offset:33792
    s_waitcnt vmcnt(0)
    s_cmp_ge_u32 s3, 4
    s_cbranch_scc1 L_q_nold
    s_lshl_b32 s7, s4, 10
    s_add_u32 s7, s7, 3866624
    v_lshrrev_b32 v2, 3, v1
    v_and_b32 v3, 7, v1
    v_lshlrev_b32 v3, 2, v3
    v_lshl_add_u32 v3, v2, 7, v3
    s_mov_b32 s79, 262144
L_poll_7:
    buffer_load_dword v2, v3, s[8:11], s7 offen sc1
    s_waitcnt vmcnt(0)
    v_cmp_gt_u32 vcc, 1, v2
    s_cbranch_vccz L_polldone_8
    s_sleep 2
    s_sub_u32 s79, s79, 1
    s_cmp_lg_u32 s79, 0
    s_cbranch_scc1 L_poll_7
L_polldone_8:
    s_lshl_b32 s6, s76, 13
    s_add_u32 s6, s6, s78
    s_add_u32 m0, s6, 0
    s_add_u32 s7, s77, 0
    buffer_load_dwordx4 v49, s[8:11], s7 offen offset:0 sc1 lds
    buffer_load_dwordx4 v49, s[8:11], s7 offen offset:1024 sc1 lds
    buffer_load_dwordx4 v49, s[8:11], s7 offen offset:2048 sc1 lds
    buffer_load_dwordx4 v49, s[8:11], s7 offen offset:3072 sc1 lds
    s_lshl_b32 s6, s76, 13
    s_add_u32 s6, s6, s78
    s_add_u32 m0, s6, 4096
    s_add_u32 s7, s77, 4096
    buffer_load_dwordx4 v49, s[8:11], s7 offen offset:0 sc1 lds
    buffer_load_dwordx4 v49, s[8:11], s7 offen offset:1024 sc1 lds
    buffer_load_dwordx4 v49, s[8:11], s7 offen offset:2048 sc1 lds
    buffer_load_dwordx4 v49, s[8:11], s7 offen offset:3072 sc1 lds
    s_lshl_b32 s6, s76, 12
    s_add_u32 s6, s6, s78
    s_add_u32 m0, s6, 49152
    s_add_u32 s7, s77, 524288
    buffer_load_dwordx4 v50, s[8:11], s7 offen offset:0 sc1 lds
    buffer_load_dwordx4 v50, s[8:11], s7 offen offset:1024 sc1 lds
    buffer_load_dwordx4 v50, s[8:11], s7 offen offset:2048 sc1 lds
    buffer_load_dwordx4 v50, s[8:11], s7 offen offset:3072 sc1 lds
    s_branch L_q_j
L_q_nold:
    s_cmp_lg_u32 s3, 5
    s_cbranch_scc1 L_q_j
    s_mov_b32 s28, s56
    s_mov_b32 s29, s57
    s_mov_b32 s30, 0x100
    s_mov_b32 s31, 0x20000
    v_and_b32 v3, 31, v1
    v_lshlrev_b32 v3, 2, v3
    buffer_load_dword v63, v3, s[28:31], 0 offen offset:128 sc1
L_q_j:
    s_waitcnt lgkmcnt(14)
    v_mfma_f32_16x16x32_bf16 v[192:195], v[96:99], v[32:35], v[192:195]
    v_mfma_f32_16x16x32_bf16 v[196:199], v[96:99], v[36:39], v[196:199]
    ds_read_b64_tr_b16 v[96:97], v54 offset:40960
    s_waitcnt lgkmcnt(13)
    v_mfma_f32_16x16x32_bf16 v[200:203], v[100:103], v[32:35], v[200:203]
    ds_read_b64_tr_b16 v[98:99], v54 offset:41984
    v_mfma_f32_16x16x32_bf16 v[204:207], v[100:103], v[36:39], v[204:207]
    ds_read_b64_tr_b16 v[100:101], v55 offset:40960
    s_waitcnt lgkmcnt(13)
    v_mfma_f32_16x16x32_bf16 v[208:211], v[104:107], v[32:35], v[208:211]
    ds_read_b64_tr_b16 v[102:103], v55 offset:41984
    v_mfma_f32_16x16x32_bf16 v[212:215], v[104:107], v[36:39], v[212:215]
    ds_read_b64_tr_b16 v[104:105], v56 offset:40960
    s_waitcnt lgkmcnt(13)
    v_mfma_f32_16x16x32_bf16 v[216:219], v[108:111], v[32:35], v[216:219]
    ds_read_b64_tr_b16 v[106:107], v56 offset:41984
    buffer_store_dwordx4 v[144:147], v13, s[8:11], s67 offen sc1
    s_add_u32 s67, s67, 1024
    v_mfma_f32_16x16x32_bf16 v[220:223], v[108:111], v[36:39], v[220:223]
    ds_read_b64_tr_b16 v[108:109], v57 offset:40960
    s_waitcnt lgkmcnt(13)
    v_mfma_f32_16x16x32_bf16 v[224:227], v[112:115], v[32:35], v[224:227]
    ds_read_b64_tr_b16 v[110:111], v57 offset:41984
    v_mfma_f32_16x16x32_bf16 v[228:231], v[112:115], v[36:39], v[228:231]
    ds_read_b64_tr_b16 v[112:113], v58 offset:40960
    s_waitcnt lgkmcnt(13)
    v_mfma_f32_16x16x32_bf16 v[232:235], v[116:119], v[32:35], v[232:235]
    ds_read_b64_tr_b16 v[114:115], v58 offset:41984
    v_mfma_f32_16x16x32_bf16 v[236:239], v[116:119], v[36:39], v[236:239]
    ds_read_b64_tr_b16 v[116:117], v59 offset:40960
    s_waitcnt lgkmcnt(13)
    v_mfma_f32_16x16x32_bf16 v[240:243], v[120:123], v[32:35], v[240:243]
    ds_read_b64_tr_b16 v[118:119], v59 offset:41984
    v_mfma_f32_16x16x32_bf16 v[244:247], v[120:123], v[36:39], v[244:247]
    ds_read_b64_tr_b16 v[120:121], v60 offset:40960
    s_waitcnt lgkmcnt(13)
    v_mfma_f32_16x16x32_bf16 v[248:251], v[124:127], v[32:35], v[248:251]
    ds_read_b64_tr_b16 v[122:123], v60 offset:41984
    v_mfma_f32_16x16x32_bf16 v[252:255], v[124:127], v[36:39], v[252:255]
    ds_read_b64_tr_b16 v[124:125], v61 offset:40960
    ds_read_b64_tr_b16 v[126:127], v61 offset:41984
    s_waitcnt lgkmcnt(14)
    v_mfma_f32_16x16x32_bf16 v[192:195], v[96:99], v[64:67], v[192:195]
    v_mfma_f32_16x16x32_bf16 v[196:199], v[96:99], v[68:71], v[196:199]
    ds_read_b64_tr_b16 v[96:97], v54 offset:49152
    s_waitcnt lgkmcnt(13)
    v_mfma_f32_16x16x32_bf16 v[200:203], v[100:103], v[64:67], v[200:203]
    ds_read_b64_tr_b16 v[98:99], v54 offset:50176
    v_mfma_f32_16x16x32_bf16 v[204:207], v[100:103], v[68:71], v[204:207]
    ds_read_b64_tr_b16 v[100:101], v55 offset:49152
    s_waitcnt lgkmcnt(13)
    v_mfma_f32_16x16x32_bf16 v[208:211], v[104:107], v[64:67], v[208:211]
    ds_read_b64_tr_b16 v[102:103], v55 offset:50176
    v_mfma_f32_16x16x32_bf16 v[212:215], v[104:107], v[68:71], v[212:215]
    ds_read_b64_tr_b16 v[104:105], v56 offset:49152
    s_waitcnt lgkmcnt(13)
    v_mfma_f32_16x16x32_bf16 v[216:219], v[108:111], v[64:67], v[216:219]
    ds_read_b64_tr_b16 v[106:107], v56 offset:50176
    buffer_store_dwordx4 v[148:151], v13, s[8:11], s67 offen sc1
    s_add_u32 s67, s67, s68
    v_mfma_f32_16x16x32_bf16 v[220:223], v[108:111], v[68:71], v[220:223]
    ds_read_b64_tr_b16 v[108:109], v57 offset:49152
    s_waitcnt lgkmcnt(13)
    v_mfma_f32_16x16x32_bf16 v[224:227], v[112:115], v[64:67], v[224:227]
    ds_read_b64_tr_b16 v[110:111], v57 offset:50176
    v_mfma_f32_16x16x32_bf16 v[228:231], v[112:115], v[68:71], v[228:231]
    ds_read_b64_tr_b16 v[112:113], v58 offset:49152
    s_waitcnt lgkmcnt(13)
    v_mfma_f32_16x16x32_bf16 v[232:235], v[116:119], v[64:67], v[232:235]
    ds_read_b64_tr_b16 v[114:115], v58 offset:50176
    v_mfma_f32_16x16x32_bf16 v[236:239], v[116:119], v[68:71], v[236:239]
    ds_read_b64_tr_b16 v[116:117], v59 offset:49152
    s_waitcnt lgkmcnt(13)
    v_mfma_f32_16x16x32_bf16 v[240:243], v[120:123], v[64:67], v[240:243]
    ds_read_b64_tr_b16 v[118:119], v59 offset:50176
    v_mfma_f32_16x16x32_bf16 v[244:247], v[120:123], v[68:71], v[244:247]
    ds_read_b64_tr_b16 v[120:121], v60 offset:49152
    s_waitcnt lgkmcnt(13)
    v_mfma_f32_16x16x32_bf16 v[248:251], v[124:127], v[64:67], v[248:251]
    ds_read_b64_tr_b16 v[122:123], v60 offset:50176
    v_mfma_f32_16x16x32_bf16 v[252:255], v[124:127], v[68:71], v[252:255]
    ds_read_b64_tr_b16 v[124:125], v61 offset:49152
    ds_read_b64_tr_b16 v[126:127], v61 offset:50176
    s_waitcnt lgkmcnt(14)
    v_mfma_f32_16x16x32_bf16 v[192:195], v[96:99], v[72:75], v[192:195]
    v_mfma_f32_16x16x32_bf16 v[196:199], v[96:99], v[76:79], v[196:199]
    ds_read_b64_tr_b16 v[96:97], v54 offset:57344
    s_waitcnt lgkmcnt(13)
    v_mfma_f32_16x16x32_bf16 v[200:203], v[100:103], v[72:75], v[200:203]
    ds_read_b64_tr_b16 v[98:99], v54 offset:58368
    v_mfma_f32_16x16x32_bf16 v[204:207], v[100:103], v[76:79], v[204:207]
    ds_read_b64_tr_b16 v[100:101], v55 offset:57344
    s_waitcnt lgkmcnt(13)
    v_mfma_f32_16x16x32_bf16 v[208:211], v[104:107], v[72:75], v[208:211]
    ds_read_b64_tr_b16 v[102:103], v55 offset:58368
    v_mfma_f32_16x16x32_bf16 v[212:215], v[104:107], v[76:79], v[212:215]
    ds_read_b64_tr_b16 v[104:105], v56 offset:57344
    s_waitcnt lgkmcnt(13)
    v_mfma_f32_16x16x32_bf16 v[216:219], v[108:111], v[72:75], v[216:219]
    ds_read_b64_tr_b16 v[106:107], v56 offset:58368
    buffer_store_dwordx4 v[152:155], v13, s[8:11], s67 offen sc1
    s_add_u32 s67, s67, 1024
    v_mfma_f32_16x16x32_bf16 v[220:223], v[108:111], v[76:79], v[220:223]
    ds_read_b64_tr_b16 v[108:109], v57 offset:57344
    s_waitcnt lgkmcnt(13)
    v_mfma_f32_16x16x32_bf16 v[224:227], v[112:115], v[72:75], v[224:227]
    ds_read_b64_tr_b16 v[110:111], v57 offset:58368
    v_mfma_f32_16x16x32_bf16 v[228:231], v[112:115], v[76:79], v[228:231]
    ds_read_b64_tr_b16 v[112:113], v58 offset:57344
    s_waitcnt lgkmcnt(13)
    v_mfma_f32_16x16x32_bf16 v[232:235], v[116:119], v[72:75], v[232:235]
    ds_read_b64_tr_b16 v[114:115], v58 offset:58368
    v_mfma_f32_16x16x32_bf16 v[236:239], v[116:119], v[76:79], v[236:239]
    ds_read_b64_tr_b16 v[116:117], v59 offset:57344
    s_waitcnt lgkmcnt(13)
    v_mfma_f32_16x16x32_bf16 v[240:243], v[120:123], v[72:75], v[240:243]
    ds_read_b64_tr_b16 v[118:119], v59 offset:58368
    v_mfma_f32_16x16x32_bf16 v[244:247], v[120:123], v[76:79], v[244:247]
    ds_read_b64_tr_b16 v[120:121], v60 offset:57344
    s_waitcnt lgkmcnt(13)
    v_mfma_f32_16x16x32_bf16 v[248:251], v[124:127], v[72:75], v[248:251]
    ds_read_b64_tr_b16 v[122:123], v60 offset:58368
    v_mfma_f32_16x16x32_bf16 v[252:255], v[124:127], v[76:79], v[252:255]
    ds_read_b64_tr_b16 v[124:125], v61 offset:57344
    ds_read_b64_tr_b16 v[126:127], v61 offset:58368
    s_waitcnt lgkmcnt(14)
    v_mfma_f32_16x16x32_bf16 v[192:195], v[96:99], v[80:83], v[192:195]
    v_mfma_f32_16x16x32_bf16 v[196:199], v[96:99], v[84:87], v[196:199]
    s_waitcnt lgkmcnt(12)
    v_mfma_f32_16x16x32_bf16 v[200:203], v[100:103], v[80:83], v[200:203]
    v_mfma_f32_16x16x32_bf16 v[204:207], v[100:103], v[84:87], v[204:207]
    s_waitcnt lgkmcnt(10)
    v_mfma_f32_16x16x32_bf16 v[208:211], v[104:107], v[80:83], v[208:211]
    v_mfma_f32_16x16x32_bf16 v[212:215], v[104:107], v[84:87], v[212:215]
    s_waitcnt lgkmcnt(8)
    v_mfma_f32_16x16x32_bf16 v[216:219], v[108:111], v[80:83], v[216:219]
    buffer_store_dwordx4 v[156:159], v13, s[8:11], s67 offen sc1
    s_add_u32 s67, s67, s69
    v_mfma_f32_16x16x32_bf16 v[220:223], v[108:111], v[84:87], v[220:223]
    s_waitcnt lgkmcnt(6)
    v_mfma_f32_16x16x32_bf16 v[224:227], v[112:115], v[80:83], v[224:227]
    v_mfma_f32_16x16x32_bf16 v[228:231], v[112:115], v[84:87], v[228:231]
    s_waitcnt lgkmcnt(4)
    v_mfma_f32_16x16x32_bf16 v[232:235], v[116:119], v[80:83], v[232:235]
    v_mfma_f32_16x16x32_bf16 v[236:239], v[116:119], v[84:87], v[236:239]
    s_waitcnt lgkmcnt(2)
    v_mfma_f32_16x16x32_bf16 v[240:243], v[120:123], v[80:83], v[240:243]
    v_mfma_f32_16x16x32_bf16 v[244:247], v[120:123], v[84:87], v[244:247]
    s_waitcnt lgkmcnt(0)
    v_mfma_f32_16x16x32_bf16 v[248:251], v[124:127], v[80:83], v[248:251]
    v_mfma_f32_16x16x32_bf16 v[252:255], v[124:127], v[84:87], v[252:255]
    s_cmp_lt_u32 s3, 4
    s_cbranch_scc1 L_qb
    s_barrier
L_qb:
    s_mov_b32 s6, 0x3e0293ee
    s_nop 7
    buffer_store_dwordx4 v[160:163], v13, s[8:11], s67 offen sc1
    s_add_u32 s67, s67, 1024
    buffer_store_dwordx4 v[164:167], v13, s[8:11], s67 offen sc1
    s_add_u32 s67, s67, s68
    buffer_store_dwordx4 v[168:171], v13, s[8:11], s67 offen sc1
    s_add_u32 s67, s67, 1024
    buffer_store_dwordx4 v[172:175], v13, s[8:11], s67 offen sc1
    s_add_u32 s67, s67, s69
    v_mul_f32 v192, s6, v192
    v_mul_f32 v193, s6, v193
    v_mul_f32 v194, s6, v194
    v_mul_f32 v195, s6, v195
    v_cvt_pk_bf16_f32 v16, v192, v193
    v_cvt_pk_bf16_f32 v17, v194, v195
    v_mul_f32 v200, s6, v200
    v_mul_f32 v201, s6, v201
    v_mul_f32 v202, s6, v202
    v_mul_f32 v203, s6, v203
    v_cvt_pk_bf16_f32 v18, v200, v201
    v_cvt_pk_bf16_f32 v19, v202, v203
    v_mul_f32 v208, s6, v208
    v_mul_f32 v209, s6, v209
    v_mul_f32 v210, s6, v210
    v_mul_f32 v211, s6, v211
    v_cvt_pk_bf16_f32 v20, v208, v209
    v_cvt_pk_bf16_f32 v21, v210, v211
    v_mul_f32 v216, s6, v216
    v_mul_f32 v217, s6, v217
    v_mul_f32 v218, s6, v218
    v_mul_f32 v219, s6, v219
    v_cvt_pk_bf16_f32 v22, v216, v217
    v_cvt_pk_bf16_f32 v23, v218, v219
    v_mul_f32 v224, s6, v224
    v_mul_f32 v225, s6, v225
    v_mul_f32 v226, s6, v226
    v_mul_f32 v227, s6, v227
    v_cvt_pk_bf16_f32 v24, v224, v225
    v_cvt_pk_bf16_f32 v25, v226, v227
    v_mul_f32 v232, s6, v232
    v_mul_f32 v233, s6, v233
    v_mul_f32 v234, s6, v234
    v_mul_f32 v235, s6, v235
    v_cvt_pk_bf16_f32 v26, v232, v233
    v_cvt_pk_bf16_f32 v27, v234, v235
    v_mul_f32 v240, s6, v240
    v_mul_f32 v241, s6, v241
    v_mul_f32 v242, s6, v242
    v_mul_f32 v243, s6, v243
    v_cvt_pk_bf16_f32 v28, v240, v241
    v_cvt_pk_bf16_f32 v29, v242, v243
    v_mul_f32 v248, s6, v248
    v_mul_f32 v249, s6, v249
    v_mul_f32 v250, s6, v250
    v_mul_f32 v251, s6, v251
    v_cvt_pk_bf16_f32 v30, v248, v249
    v_cvt_pk_bf16_f32 v31, v250, v251
    v_mul_f32 v196, s6, v196
    v_mul_f32 v197, s6, v197
    v_mul_f32 v198, s6, v198
    v_mul_f32 v199, s6, v199
    v_cvt_pk_bf16_f32 v32, v196, v197
    v_cvt_pk_bf16_f32 v33, v198, v199
    v_mul_f32 v204, s6, v204
    v_mul_f32 v205, s6, v205
    v_mul_f32 v206, s6, v206
    v_mul_f32 v207, s6, v207
    v_cvt_pk_bf16_f32 v34, v204, v205
    v_cvt_pk_bf16_f32 v35, v206, v207
    v_mul_f32 v212, s6, v212
    v_mul_f32 v213, s6, v213
    v_mul_f32 v214, s6, v214
    v_mul_f32 v215, s6, v215
    v_cvt_pk_bf16_f32 v36, v212, v213
    v_cvt_pk_bf16_f32 v37, v214, v215
    v_mul_f32 v220, s6, v220
    v_mul_f32 v221, s6, v221
    v_mul_f32 v222, s6, v222
    v_mul_f32 v223, s6, v223
    v_cvt_pk_bf16_f32 v38, v220, v221
    v_cvt_pk_bf16_f32 v39, v222, v223
    v_mul_f32 v228, s6, v228
    v_mul_f32 v229, s6, v229
    v_mul_f32 v230, s6, v230
    v_mul_f32 v231, s6, v231
    v_cvt_pk_bf16_f32 v40, v228, v229
    v_cvt_pk_bf16_f32 v41, v230, v231
    v_mul_f32 v236, s6, v236
    v_mul_f32 v237, s6, v237
    v_mul_f32 v238, s6, v238
    v_mul_f32 v239, s6, v239
    v_cvt_pk_bf16_f32 v42, v236, v237
    v_cvt_pk_bf16_f32 v43, v238, v239
    v_mul_f32 v244, s6, v244
    v_mul_f32 v245, s6, v245
    v_mul_f32 v246, s6, v246
    v_mul_f32 v247, s6, v247
    v_cvt_pk_bf16_f32 v44, v244, v245
    v_cvt_pk_bf16_f32 v45, v246, v247
    v_mul_f32 v252, s6, v252
    v_mul_f32 v253, s6, v253
    v_mul_f32 v254, s6, v254
    v_mul_f32 v255, s6, v255
    v_cvt_pk_bf16_f32 v46, v252, v253
    v_cvt_pk_bf16_f32 v47, v254, v255
    v_mov_b64 v[192:193], 0
    v_mov_b64 v[194:195], 0
    v_mov_b64 v[196:197], 0
    v_mov_b64 v[198:199], 0
    v_mov_b64 v[200:201], 0
    v_mov_b64 v[202:203], 0
    v_mov_b64 v[204:205], 0
    v_mov_b64 v[206:207], 0
    v_mov_b64 v[208:209], 0
    v_mov_b64 v[210:211], 0
    v_mov_b64 v[212:213], 0
    v_mov_b64 v[214:215], 0
    v_mov_b64 v[216:217], 0
    v_mov_b64 v[218:219], 0
    v_mov_b64 v[220:221], 0
    v_mov_b64 v[222:223], 0
    v_mov_b64 v[224:225], 0
    v_mov_b64 v[226:227], 0
    v_mov_b64 v[228:229], 0
    v_mov_b64 v[230:231], 0
    v_mov_b64 v[232:233], 0
    v_mov_b64 v[234:235], 0
    v_mov_b64 v[236:237], 0
    v_mov_b64 v[238:239], 0
    v_mov_b64 v[240:241], 0
    v_mov_b64 v[242:243], 0
    v_mov_b64 v[244:245], 0
    v_mov_b64 v[246:247], 0
    v_mov_b64 v[248:249], 0
    v_mov_b64 v[250:251], 0
    v_mov_b64 v[252:253], 0
    v_mov_b64 v[254:255], 0
    v_mov_b64 v[144:145], 0
    v_mov_b64 v[146:147], 0
    v_mov_b64 v[148:149], 0
    v_mov_b64 v[150:151], 0
    v_mov_b64 v[152:153], 0
    v_mov_b64 v[154:155], 0
    v_mov_b64 v[156:157], 0
    v_mov_b64 v[158:159], 0
    v_mov_b64 v[52:53], 0
    v_mov_b64 v[54:55], 0
    v_mov_b64 v[56:57], 0
    v_mov_b32 v48, v13
    s_waitcnt vmcnt(8)
    s_cmp_lg_u32 s3, 5
    s_cbranch_scc1 L_q_c
    v_cmp_gt_u32 vcc, 8, v63
    s_cbranch_vccz L_cntok_9
    s_mov_b32 s28, s56
    s_mov_b32 s29, s57
    s_mov_b32 s30, 0x100
    s_mov_b32 s31, 0x20000
    v_and_b32 v3, 31, v1
    v_lshlrev_b32 v3, 2, v3
    s_mov_b32 s79, 262144
L_poll_10:
    buffer_load_dword v2, v3, s[28:31], 0 offen offset:128 sc1
    s_waitcnt vmcnt(0)
    v_cmp_gt_u32 vcc, 8, v2
    s_cbranch_vccz L_polldone_11
    s_sleep 8
    s_sub_u32 s79, s79, 1
    s_cmp_lg_u32 s79, 0
    s_cbranch_scc1 L_poll_10
L_polldone_11:
L_cntok_9:
L_q_c:
    s_mov_b32 s72, 0x4b800000
    s_mov_b32 s65, s72
    s_sub_u32 s63, 15, s5
    s_mov_b32 s62, -1
    s_cmp_ge_u32 s3, 4
    s_cbranch_scc1 L_qb2
    s_barrier
L_qb2:
    ds_read_b128 v[96:99], v48 offset:0
    ds_read_b128 v[100:103], v48 offset:1024
    ds_read_b128 v[104:107], v48 offset:2048
    ds_read_b128 v[108:111], v48 offset:3072
    ds_read_b128 v[112:115], v48 offset:4096
    ds_read_b128 v[116:119], v48 offset:5120
    ds_read_b128 v[120:123], v48 offset:6144
    ds_read_b128 v[124:127], v48 offset:7168
    s_cmp_lg_u32 s60, 0
    s_cbranch_scc1 L_nm0
    s_call_b64 s[82:83], L_mask
L_nm0:
    s_waitcnt lgkmcnt(7)
    v_mfma_f32_16x16x32_bf16 v[64:67], v[96:99], v[16:19], v[144:147]
    v_mfma_f32_16x16x32_bf16 v[68:71], v[96:99], v[32:35], v[148:151]
    ds_read_b128 v[96:99], v48 offset:8192
    s_waitcnt lgkmcnt(7)
    v_mfma_f32_16x16x32_bf16 v[64:67], v[100:103], v[20:23], v[64:67]
    v_mfma_f32_16x16x32_bf16 v[68:71], v[100:103], v[36:39], v[68:71]
    ds_read_b128 v[100:103], v48 offset:9216
    s_waitcnt lgkmcnt(7)
    v_mfma_f32_16x16x32_bf16 v[64:67], v[104:107], v[24:27], v[64:67]
    v_mfma_f32_16x16x32_bf16 v[68:71], v[104:107], v[40:43], v[68:71]
    ds_read_b128 v[104:107], v48 offset:10240
    s_waitcnt lgkmcnt(7)
    v_mfma_f32_16x16x32_bf16 v[64:67], v[108:111], v[28:31], v[64:67]
    v_mfma_f32_16x16x32_bf16 v[68:71], v[108:111], v[44:47], v[68:71]
    ds_read_b128 v[108:111], v48 offset:11264
    s_waitcnt lgkmcnt(7)
    v_mfma_f32_16x16x32_bf16 v[72:75], v[112:115], v[16:19], v[152:155]
    v_mfma_f32_16x16x32_bf16 v[76:79], v[112:115], v[32:35], v[156:159]
    ds_read_b128 v[112:115], v48 offset:12288
    s_waitcnt lgkmcnt(7)
    v_mfma_f32_16x16x32_bf16 v[72:75], v[116:119], v[20:23], v[72:75]
    v_mfma_f32_16x16x32_bf16 v[76:79], v[116:119], v[36:39], v[76:79]
    ds_read_b128 v[116:119], v48 offset:13312
    s_waitcnt lgkmcnt(7)
    v_mfma_f32_16x16x32_bf16 v[72:75], v[120:123], v[24:27], v[72:75]
    v_mfma_f32_16x16x32_bf16 v[76:79], v[120:123], v[40:43], v[76:79]
    ds_read_b128 v[120:123], v48 offset:14336
    s_waitcnt lgkmcnt(7)
    v_mfma_f32_16x16x32_bf16 v[72:75], v[124:127], v[28:31], v[72:75]
    v_mfma_f32_16x16x32_bf16 v[76:79], v[124:127], v[44:47], v[76:79]
    ds_read_b128 v[124:127], v48 offset:15360
    s_nop 7
    v_max3_f32 v58, v64, v65, v66
    v_max3_f32 v58, v58, v67, v72
    v_max3_f32 v58, v58, v73, v74
    v_max_f32 v58, v58, v75
    v_mov_b32 v60, v58
    s_nop 1
    v_permlane16_swap_b32 v58, v60
    s_nop 1
    v_max_f32 v58, v58, v60
    v_mov_b32 v60, v58
    s_nop 1
    v_permlane32_swap_b32 v58, v60
    s_nop 1
    v_max_f32 v58, v58, v60
    v_sub_f32 v64, v64, v58
    v_sub_f32 v144, 0, v58
    v_sub_f32 v65, v65, v58
    v_sub_f32 v145, 0, v58
    v_sub_f32 v66, v66, v58
    v_sub_f32 v146, 0, v58
    v_sub_f32 v67, v67, v58
    v_sub_f32 v147, 0, v58
    v_sub_f32 v72, v72, v58
    v_sub_f32 v152, 0, v58
    v_sub_f32 v73, v73, v58
    v_sub_f32 v153, 0, v58
    v_sub_f32 v74, v74, v58
    v_sub_f32 v154, 0, v58
    v_sub_f32 v75, v75, v58
    v_sub_f32 v155, 0, v58
    v_max3_f32 v59, v68, v69, v70
    v_max3_f32 v59, v59, v71, v76
    v_max3_f32 v59, v59, v77, v78
    v_max_f32 v59, v59, v79
    v_mov_b32 v60, v59
    s_nop 1
    v_permlane16_swap_b32 v59, v60
    s_nop 1
    v_max_f32 v59, v59, v60
    v_mov_b32 v60, v59
    s_nop 1
    v_permlane32_swap_b32 v59, v60
    s_nop 1
    v_max_f32 v59, v59, v60
    v_sub_f32 v68, v68, v59
    v_sub_f32 v148, 0, v59
    v_sub_f32 v69, v69, v59
    v_sub_f32 v149, 0, v59
    v_sub_f32 v70, v70, v59
    v_sub_f32 v150, 0, v59
    v_sub_f32 v71, v71, v59
    v_sub_f32 v151, 0, v59
    v_sub_f32 v76, v76, v59
    v_sub_f32 v156, 0, v59
    v_sub_f32 v77, v77, v59
    v_sub_f32 v157, 0, v59
    v_sub_f32 v78, v78, v59
    v_sub_f32 v158, 0, v59
    v_sub_f32 v79, v79, v59
    v_sub_f32 v159, 0, v59
    s_cmp_lg_u32 s60, 1
    s_cbranch_scc1 L_nm1
    s_call_b64 s[82:83], L_mask
L_nm1:
    v_exp_f32 v58, v64
    v_exp_f32 v59, v65
    s_nop 0
    v_add_f32 v52, v58, v59
    v_cvt_pk_bf16_f32 v128, v58, v59
    s_waitcnt lgkmcnt(7)
    v_mfma_f32_16x16x32_bf16 v[80:83], v[96:99], v[16:19], v[144:147]
    s_waitcnt lgkmcnt(6)
    v_exp_f32 v60, v66
    v_exp_f32 v61, v67
    v_mfma_f32_16x16x32_bf16 v[84:87], v[96:99], v[32:35], v[148:151]
    ds_read_b128 v[96:99], v48 offset:49152
    v_add_f32 v52, v60, v52
    v_add_f32 v52, v61, v52
    v_cvt_pk_bf16_f32 v129, v60, v61
    v_add_f32 v56, v54, v56
    v_mfma_f32_16x16x32_bf16 v[80:83], v[100:103], v[20:23], v[80:83]
    s_waitcnt lgkmcnt(6)
    v_exp_f32 v58, v68
    v_exp_f32 v59, v69
    v_mfma_f32_16x16x32_bf16 v[84:87], v[100:103], v[36:39], v[84:87]
    ds_read_b128 v[100:103], v48 offset:50176
    v_add_f32 v53, v58, v59
    v_cvt_pk_bf16_f32 v132, v58, v59
    v_mfma_f32_16x16x32_bf16 v[80:83], v[104:107], v[24:27], v[80:83]
    s_waitcnt lgkmcnt(6)
    v_exp_f32 v60, v70
    v_exp_f32 v61, v71
    v_mfma_f32_16x16x32_bf16 v[84:87], v[104:107], v[40:43], v[84:87]
    ds_read_b128 v[104:107], v48 offset:51200
    v_add_f32 v53, v60, v53
    v_add_f32 v53, v61, v53
    v_cvt_pk_bf16_f32 v133, v60, v61
    v_add_f32 v57, v55, v57
    v_mfma_f32_16x16x32_bf16 v[80:83], v[108:111], v[28:31], v[80:83]
    s_waitcnt lgkmcnt(6)
    v_exp_f32 v58, v72
    v_exp_f32 v59, v73
    v_mfma_f32_16x16x32_bf16 v[84:87], v[108:111], v[44:47], v[84:87]
    ds_read_b128 v[108:111], v48 offset:52224
    v_add_f32 v52, v58, v52
    v_add_f32 v52, v59, v52
    v_cvt_pk_bf16_f32 v130, v58, v59
    v_mfma_f32_16x16x32_bf16 v[88:91], v[112:115], v[16:19], v[152:155]
    s_waitcnt lgkmcnt(6)
    v_exp_f32 v60, v74
    v_exp_f32 v61, v75
    v_mfma_f32_16x16x32_bf16 v[92:95], v[112:115], v[32:35], v[156:159]
    ds_read_b128 v[112:115], v48 offset:53248
    v_add_f32 v52, v60, v52
    v_add_f32 v52, v61, v52
    v_cvt_pk_bf16_f32 v131, v60, v61
    v_mfma_f32_16x16x32_bf16 v[88:91], v[116:119], v[20:23], v[88:91]
    s_waitcnt lgkmcnt(6)
    v_exp_f32 v58, v76
    v_exp_f32 v59, v77
    v_mfma_f32_16x16x32_bf16 v[92:95], v[116:119], v[36:39], v[92:95]
    ds_read_b128 v[116:119], v48 offset:54272
    v_add_f32 v53, v58, v53
    v_add_f32 v53, v59, v53
    v_cvt_pk_bf16_f32 v134, v58, v59
    v_mfma_f32_16x16x32_bf16 v[88:91], v[120:123], v[24:27], v[88:91]
    s_waitcnt lgkmcnt(6)
    v_exp_f32 v60, v78
    v_exp_f32 v61, v79
    v_mfma_f32_16x16x32_bf16 v[92:95], v[120:123], v[40:43], v[92:95]
    ds_read_b128 v[120:123], v48 offset:55296
    v_add_f32 v53, v60, v53
    v_add_f32 v53, v61, v53
    v_cvt_pk_bf16_f32 v135, v60, v61
    v_mfma_f32_16x16x32_bf16 v[88:91], v[124:127], v[28:31], v[88:91]
    v_mfma_f32_16x16x32_bf16 v[92:95], v[124:127], v[44:47], v[92:95]
    ds_read_b128 v[124:127], v48 offset:56320
    v_add_f32 v62, v52, v53
    v_cmp_nge_f32 vcc, s65, v62
    s_cbranch_vccnz L_back_12_h
L_back_12:
    s_nop 7
    v_exp_f32 v58, v80
    v_exp_f32 v59, v81
    s_nop 0
    v_add_f32 v54, v58, v59
    v_cvt_pk_bf16_f32 v136, v58, v59
    s_call_b64 s[82:83], L_load
    s_mov_b32 s62, 0
    buffer_store_dwordx4 v[176:179], v13, s[8:11], s67 offen sc1
    s_add_u32 s67, s67, 1024
    buffer_store_dwordx4 v[180:183], v13, s[8:11], s67 offen sc1
    s_add_u32 s67, s67, s68
    buffer_store_dwordx4 v[184:187], v13, s[8:11], s67 offen sc1
    s_add_u32 s67, s67, 1024
    buffer_store_dwordx4 v[188:191], v13, s[8:11], s67 offen sc1
    s_add_u32 s67, s67, s69
    s_sub_i32 s64, s60, 2
    s_cmp_eq_u32 s60, 0
    s_cbranch_scc1 L_pv2
    s_cmp_eq_u32 s60, 1
    s_cbranch_scc1 L_tail2
    s_cmp_lg_u32 s60, 2
    s_cbranch_scc1 L_st2
    s_call_b64 s[82:83], L_mask
    s_branch L_st2
.p2align 6
L_st0:
    s_waitcnt lgkmcnt(7)
    v_mfma_f32_16x16x32_bf16 v[192:195], v[96:99], v[128:131], v[192:195]
    s_waitcnt lgkmcnt(6)
    v_exp_f32 v60, v82
    v_mfma_f32_16x16x32_bf16 v[196:199], v[96:99], v[132:135], v[196:199]
    ds_read_b128 v[96:99], v48 offset:0
    v_add_f32 v54, v60, v54
    v_add_f32 v56, v52, v56
    v_mfma_f32_16x16x32_bf16 v[200:203], v[100:103], v[128:131], v[200:203]
    s_waitcnt lgkmcnt(6)
    v_exp_f32 v61, v83
    v_mfma_f32_16x16x32_bf16 v[204:207], v[100:103], v[132:135], v[204:207]
    ds_read_b128 v[100:103], v48 offset:1024
    v_add_f32 v54, v61, v54
    v_cvt_pk_bf16_f32 v137, v60, v61
    v_mfma_f32_16x16x32_bf16 v[208:211], v[104:107], v[128:131], v[208:211]
    s_waitcnt lgkmcnt(6)
    v_exp_f32 v58, v84
    v_mfma_f32_16x16x32_bf16 v[212:215], v[104:107], v[132:135], v[212:215]
    ds_read_b128 v[104:107], v48 offset:2048
    v_add_f32 v57, v53, v57
    v_mfma_f32_16x16x32_bf16 v[216:219], v[108:111], v[128:131], v[216:219]
    s_waitcnt lgkmcnt(6)
    v_exp_f32 v59, v85
    v_mfma_f32_16x16x32_bf16 v[220:223], v[108:111], v[132:135], v[220:223]
    s_sub_i32 s64, s64, 1
    ds_read_b128 v[108:111], v48 offset:3072
    v_add_f32 v55, v58, v59
    v_cvt_pk_bf16_f32 v140, v58, v59
    v_mfma_f32_16x16x32_bf16 v[224:227], v[112:115], v[128:131], v[224:227]
    s_waitcnt lgkmcnt(6)
    v_exp_f32 v60, v86
    v_mfma_f32_16x16x32_bf16 v[228:231], v[112:115], v[132:135], v[228:231]
    ds_read_b128 v[112:115], v48 offset:4096
    v_add_f32 v55, v60, v55
    v_mfma_f32_16x16x32_bf16 v[232:235], v[116:119], v[128:131], v[232:235]
    s_waitcnt lgkmcnt(6)
    v_exp_f32 v61, v87
    v_mfma_f32_16x16x32_bf16 v[236:239], v[116:119], v[132:135], v[236:239]
    s_cmp_gt_i32 s64, 0
    ds_read_b128 v[116:119], v48 offset:5120
    v_add_f32 v55, v61, v55
    v_cvt_pk_bf16_f32 v141, v60, v61
    v_mfma_f32_16x16x32_bf16 v[240:243], v[120:123], v[128:131], v[240:243]
    s_waitcnt lgkmcnt(6)
    v_exp_f32 v58, v88
    v_mfma_f32_16x16x32_bf16 v[244:247], v[120:123], v[132:135], v[244:247]
    ds_read_b128 v[120:123], v48 offset:6144
    v_add_f32 v54, v58, v54
    v_mfma_f32_16x16x32_bf16 v[248:251], v[124:127], v[128:131], v[248:251]
    s_waitcnt lgkmcnt(6)
    v_exp_f32 v59, v89
    v_mfma_f32_16x16x32_bf16 v[252:255], v[124:127], v[132:135], v[252:255]
    s_cselect_b32 s65, s72, -1.0
    ds_read_b128 v[124:127], v48 offset:7168
    v_add_f32 v54, v59, v54
    v_cvt_pk_bf16_f32 v138, v58, v59
    v_mfma_f32_16x16x32_bf16 v[64:67], v[96:99], v[16:19], v[144:147]
    s_waitcnt lgkmcnt(6)
    v_exp_f32 v60, v90
    v_mfma_f32_16x16x32_bf16 v[68:71], v[96:99], v[32:35], v[148:151]
    ds_read_b128 v[96:99], v48 offset:40960
    v_add_f32 v54, v60, v54
    v_mfma_f32_16x16x32_bf16 v[64:67], v[100:103], v[20:23], v[64:67]
    s_waitcnt lgkmcnt(6)
    v_exp_f32 v61, v91
    v_mfma_f32_16x16x32_bf16 v[68:71], v[100:103], v[36:39], v[68:71]
    ds_read_b128 v[100:103], v48 offset:41984
    v_add_f32 v54, v61, v54
    v_cvt_pk_bf16_f32 v139, v60, v61
    v_mfma_f32_16x16x32_bf16 v[64:67], v[104:107], v[24:27], v[64:67]
    s_waitcnt lgkmcnt(6)
    v_exp_f32 v58, v92
    v_mfma_f32_16x16x32_bf16 v[68:71], v[104:107], v[40:43], v[68:71]
    ds_read_b128 v[104:107], v48 offset:43008
    v_add_f32 v55, v58, v55
    v_mfma_f32_16x16x32_bf16 v[64:67], v[108:111], v[28:31], v[64:67]
    s_waitcnt lgkmcnt(6)
    v_exp_f32 v59, v93
    v_mfma_f32_16x16x32_bf16 v[68:71], v[108:111], v[44:47], v[68:71]
    ds_read_b128 v[108:111], v48 offset:44032
    v_add_f32 v55, v59, v55
    v_cvt_pk_bf16_f32 v142, v58, v59
    v_mfma_f32_16x16x32_bf16 v[72:75], v[112:115], v[16:19], v[152:155]
    s_waitcnt lgkmcnt(6)
    v_exp_f32 v60, v94
    v_mfma_f32_16x16x32_bf16 v[76:79], v[112:115], v[32:35], v[156:159]
    ds_read_b128 v[112:115], v48 offset:45056
    v_add_f32 v55, v60, v55
    v_mfma_f32_16x16x32_bf16 v[72:75], v[116:119], v[20:23], v[72:75]
    s_waitcnt lgkmcnt(6)
    v_exp_f32 v61, v95
    v_mfma_f32_16x16x32_bf16 v[76:79], v[116:119], v[36:39], v[76:79]
    ds_read_b128 v[116:119], v48 offset:46080
    v_add_f32 v55, v61, v55
    v_cvt_pk_bf16_f32 v143, v60, v61
    v_mfma_f32_16x16x32_bf16 v[72:75], v[120:123], v[24:27], v[72:75]
    s_waitcnt lgkmcnt(6)
    v_exp_f32 v58, v64
    v_mfma_f32_16x16x32_bf16 v[76:79], v[120:123], v[40:43], v[76:79]
    ds_read_b128 v[120:123], v48 offset:47104
    v_add_f32 v62, v54, v55
    v_cmp_nge_f32 vcc, s65, v62
    v_mfma_f32_16x16x32_bf16 v[72:75], v[124:127], v[28:31], v[72:75]
    v_exp_f32 v59, v65
    v_mfma_f32_16x16x32_bf16 v[76:79], v[124:127], v[44:47], v[76:79]
    ds_read_b128 v[124:127], v48 offset:48128
    v_add_f32 v52, v58, v59
    v_cvt_pk_bf16_f32 v128, v58, v59
    s_cbranch_vccnz L_back_13_h
L_back_13:
    s_waitcnt lgkmcnt(7)
    v_mfma_f32_16x16x32_bf16 v[192:195], v[96:99], v[136:139], v[192:195]
    s_waitcnt lgkmcnt(6)
    v_exp_f32 v60, v66
    v_mfma_f32_16x16x32_bf16 v[196:199], v[96:99], v[140:143], v[196:199]
    ds_read_b128 v[96:99], v48 offset:8192
    v_add_f32 v52, v60, v52
    v_add_f32 v56, v54, v56
    v_mfma_f32_16x16x32_bf16 v[200:203], v[100:103], v[136:139], v[200:203]
    s_waitcnt lgkmcnt(6)
    v_exp_f32 v61, v67
    v_mfma_f32_16x16x32_bf16 v[204:207], v[100:103], v[140:143], v[204:207]
    ds_read_b128 v[100:103], v48 offset:9216
    v_add_f32 v52, v61, v52
    v_cvt_pk_bf16_f32 v129, v60, v61
    v_mfma_f32_16x16x32_bf16 v[208:211], v[104:107], v[136:139], v[208:211]
    s_waitcnt lgkmcnt(6)
    v_exp_f32 v58, v68
    v_mfma_f32_16x16x32_bf16 v[212:215], v[104:107], v[140:143], v[212:215]
    ds_read_b128 v[104:107], v48 offset:10240
    v_add_f32 v57, v55, v57
    v_mfma_f32_16x16x32_bf16 v[216:219], v[108:111], v[136:139], v[216:219]
    s_waitcnt lgkmcnt(6)
    v_exp_f32 v59, v69
    v_mfma_f32_16x16x32_bf16 v[220:223], v[108:111], v[140:143], v[220:223]
    s_sub_i32 s64, s64, 1
    ds_read_b128 v[108:111], v48 offset:11264
    v_add_f32 v53, v58, v59
    v_cvt_pk_bf16_f32 v132, v58, v59
    v_mfma_f32_16x16x32_bf16 v[224:227], v[112:115], v[136:139], v[224:227]
    s_waitcnt lgkmcnt(6)
    v_exp_f32 v60, v70
    v_mfma_f32_16x16x32_bf16 v[228:231], v[112:115], v[140:143], v[228:231]
    ds_read_b128 v[112:115], v48 offset:12288
    v_add_f32 v53, v60, v53
    v_mfma_f32_16x16x32_bf16 v[232:235], v[116:119], v[136:139], v[232:235]
    s_waitcnt lgkmcnt(6)
    v_exp_f32 v61, v71
    v_mfma_f32_16x16x32_bf16 v[236:239], v[116:119], v[140:143], v[236:239]
    s_cmp_gt_i32 s64, 0
    ds_read_b128 v[116:119], v48 offset:13312
    v_add_f32 v53, v61, v53
    v_cvt_pk_bf16_f32 v133, v60, v61
    v_mfma_f32_16x16x32_bf16 v[240:243], v[120:123], v[136:139], v[240:243]
    s_waitcnt lgkmcnt(6)
    v_exp_f32 v58, v72
    v_mfma_f32_16x16x32_bf16 v[244:247], v[120:123], v[140:143], v[244:247]
    ds_read_b128 v[120:123], v48 offset:14336
    v_add_f32 v52, v58, v52
    v_mfma_f32_16x16x32_bf16 v[248:251], v[124:127], v[136:139], v[248:251]
    s_waitcnt lgkmcnt(6)
    v_exp_f32 v59, v73
    v_mfma_f32_16x16x32_bf16 v[252:255], v[124:127], v[140:143], v[252:255]
    s_cselect_b32 s65, s72, -1.0
    ds_read_b128 v[124:127], v48 offset:15360
    v_add_f32 v52, v59, v52
    v_cvt_pk_bf16_f32 v130, v58, v59
    v_mfma_f32_16x16x32_bf16 v[80:83], v[96:99], v[16:19], v[144:147]
    s_waitcnt lgkmcnt(6)
    v_exp_f32 v60, v74
    v_mfma_f32_16x16x32_bf16 v[84:87], v[96:99], v[32:35], v[148:151]
    ds_read_b128 v[96:99], v48 offset:49152
    v_add_f32 v52, v60, v52
    v_mfma_f32_16x16x32_bf16 v[80:83], v[100:103], v[20:23], v[80:83]
    s_waitcnt lgkmcnt(6)
    v_exp_f32 v61, v75
    v_mfma_f32_16x16x32_bf16 v[84:87], v[100:103], v[36:39], v[84:87]
    ds_read_b128 v[100:103], v48 offset:50176
    v_add_f32 v52, v61, v52
    v_cvt_pk_bf16_f32 v131, v60, v61
    v_mfma_f32_16x16x32_bf16 v[80:83], v[104:107], v[24:27], v[80:83]
    s_waitcnt lgkmcnt(6)
    v_exp_f32 v58, v76
    v_mfma_f32_16x16x32_bf16 v[84:87], v[104:107], v[40:43], v[84:87]
    ds_read_b128 v[104:107], v48 offset:51200
    v_add_f32 v53, v58, v53
    v_mfma_f32_16x16x32_bf16 v[80:83], v[108:111], v[28:31], v[80:83]
    s_waitcnt lgkmcnt(6)
    v_exp_f32 v59, v77
    v_mfma_f32_16x16x32_bf16 v[84:87], v[108:111], v[44:47], v[84:87]
    ds_read_b128 v[108:111], v48 offset:52224
    v_add_f32 v53, v59, v53
    v_cvt_pk_bf16_f32 v134, v58, v59
    v_mfma_f32_16x16x32_bf16 v[88:91], v[112:115], v[16:19], v[152:155]
    s_waitcnt lgkmcnt(6)
    v_exp_f32 v60, v78
    v_mfma_f32_16x16x32_bf16 v[92:95], v[112:115], v[32:35], v[156:159]
    ds_read_b128 v[112:115], v48 offset:53248
    v_add_f32 v53, v60, v53
    v_mfma_f32_16x16x32_bf16 v[88:91], v[116:119], v[20:23], v[88:91]
    s_waitcnt lgkmcnt(6)
    v_exp_f32 v61, v79
    v_mfma_f32_16x16x32_bf16 v[92:95], v[116:119], v[36:39], v[92:95]
    ds_read_b128 v[116:119], v48 offset:54272
    v_add_f32 v53, v61, v53
    v_cvt_pk_bf16_f32 v135, v60, v61
    v_mfma_f32_16x16x32_bf16 v[88:91], v[120:123], v[24:27], v[88:91]
    s_waitcnt lgkmcnt(6)
    v_exp_f32 v58, v80
    v_mfma_f32_16x16x32_bf16 v[92:95], v[120:123], v[40:43], v[92:95]
    ds_read_b128 v[120:123], v48 offset:55296
    v_add_f32 v62, v52, v53
    v_cmp_nge_f32 vcc, s65, v62
    v_mfma_f32_16x16x32_bf16 v[88:91], v[124:127], v[28:31], v[88:91]
    v_exp_f32 v59, v81
    v_mfma_f32_16x16x32_bf16 v[92:95], v[124:127], v[44:47], v[92:95]
    ds_read_b128 v[124:127], v48 offset:56320
    v_add_f32 v54, v58, v59
    v_cvt_pk_bf16_f32 v136, v58, v59
    s_cbranch_vccnz L_back_14_h
L_back_14:
L_st2:
    s_waitcnt lgkmcnt(7)
    v_mfma_f32_16x16x32_bf16 v[192:195], v[96:99], v[128:131], v[192:195]
    s_waitcnt lgkmcnt(6)
    v_exp_f32 v60, v82
    v_mfma_f32_16x16x32_bf16 v[196:199], v[96:99], v[132:135], v[196:199]
    ds_read_b128 v[96:99], v48 offset:16384
    v_add_f32 v54, v60, v54
    v_add_f32 v56, v52, v56
    v_mfma_f32_16x16x32_bf16 v[200:203], v[100:103], v[128:131], v[200:203]
    s_waitcnt lgkmcnt(6)
    v_exp_f32 v61, v83
    v_mfma_f32_16x16x32_bf16 v[204:207], v[100:103], v[132:135], v[204:207]
    ds_read_b128 v[100:103], v48 offset:17408
    v_add_f32 v54, v61, v54
    v_cvt_pk_bf16_f32 v137, v60, v61
    v_mfma_f32_16x16x32_bf16 v[208:211], v[104:107], v[128:131], v[208:211]
    s_waitcnt lgkmcnt(6)
    v_exp_f32 v58, v84
    v_mfma_f32_16x16x32_bf16 v[212:215], v[104:107], v[132:135], v[212:215]
    ds_read_b128 v[104:107], v48 offset:18432
    v_add_f32 v57, v53, v57
    v_mfma_f32_16x16x32_bf16 v[216:219], v[108:111], v[128:131], v[216:219]
    s_waitcnt lgkmcnt(6)
    v_exp_f32 v59, v85
    v_mfma_f32_16x16x32_bf16 v[220:223], v[108:111], v[132:135], v[220:223]
    s_sub_i32 s64, s64, 1
    ds_read_b128 v[108:111], v48 offset:19456
    v_add_f32 v55, v58, v59
    v_cvt_pk_bf16_f32 v140, v58, v59
    v_mfma_f32_16x16x32_bf16 v[224:227], v[112:115], v[128:131], v[224:227]
    s_waitcnt lgkmcnt(6)
    v_exp_f32 v60, v86
    v_mfma_f32_16x16x32_bf16 v[228:231], v[112:115], v[132:135], v[228:231]
    ds_read_b128 v[112:115], v48 offset:20480
    v_add_f32 v55, v60, v55
    v_mfma_f32_16x16x32_bf16 v[232:235], v[116:119], v[128:131], v[232:235]
    s_waitcnt lgkmcnt(6)
    v_exp_f32 v61, v87
    v_mfma_f32_16x16x32_bf16 v[236:239], v[116:119], v[132:135], v[236:239]
    s_cmp_gt_i32 s64, 0
    ds_read_b128 v[116:119], v48 offset:21504
    v_add_f32 v55, v61, v55
    v_cvt_pk_bf16_f32 v141, v60, v61
    v_mfma_f32_16x16x32_bf16 v[240:243], v[120:123], v[128:131], v[240:243]
    s_waitcnt lgkmcnt(6)
    v_exp_f32 v58, v88
    v_mfma_f32_16x16x32_bf16 v[244:247], v[120:123], v[132:135], v[244:247]
    ds_read_b128 v[120:123], v48 offset:22528
    v_add_f32 v54, v58, v54
    v_mfma_f32_16x16x32_bf16 v[248:251], v[124:127], v[128:131], v[248:251]
    s_waitcnt lgkmcnt(6)
    v_exp_f32 v59, v89
    v_mfma_f32_16x16x32_bf16 v[252:255], v[124:127], v[132:135], v[252:255]
    s_cselect_b32 s65, s72, -1.0
    ds_read_b128 v[124:127], v48 offset:23552
    v_add_f32 v54, v59, v54
    v_cvt_pk_bf16_f32 v138, v58, v59
    v_mfma_f32_16x16x32_bf16 v[64:67], v[96:99], v[16:19], v[144:147]
    s_waitcnt lgkmcnt(6)
    v_exp_f32 v60, v90
    v_mfma_f32_16x16x32_bf16 v[68:71], v[96:99], v[32:35], v[148:151]
    ds_read_b128 v[96:99], v48 offset:57344
    v_add_f32 v54, v60, v54
    v_mfma_f32_16x16x32_bf16 v[64:67], v[100:103], v[20:23], v[64:67]
    s_waitcnt lgkmcnt(6)
    v_exp_f32 v61, v91
    v_mfma_f32_16x16x32_bf16 v[68:71], v[100:103], v[36:39], v[68:71]
    ds_read_b128 v[100:103], v48 offset:58368
    v_add_f32 v54, v61, v54
    v_cvt_pk_bf16_f32 v139, v60, v61
    v_mfma_f32_16x16x32_bf16 v[64:67], v[104:107], v[24:27], v[64:67]
    s_waitcnt lgkmcnt(6)
    v_exp_f32 v58, v92
    v_mfma_f32_16x16x32_bf16 v[68:71], v[104:107], v[40:43], v[68:71]
    ds_read_b128 v[104:107], v48 offset:59392
    v_add_f32 v55, v58, v55
    v_mfma_f32_16x16x32_bf16 v[64:67], v[108:111], v[28:31], v[64:67]
    s_waitcnt lgkmcnt(6)
    v_exp_f32 v59, v93
    v_mfma_f32_16x16x32_bf16 v[68:71], v[108:111], v[44:47], v[68:71]
    ds_read_b128 v[108:111], v48 offset:60416
    v_add_f32 v55, v59, v55
    v_cvt_pk_bf16_f32 v142, v58, v59
    v_mfma_f32_16x16x32_bf16 v[72:75], v[112:115], v[16:19], v[152:155]
    s_waitcnt lgkmcnt(6)
    v_exp_f32 v60, v94
    v_mfma_f32_16x16x32_bf16 v[76:79], v[112:115], v[32:35], v[156:159]
    ds_read_b128 v[112:115], v48 offset:61440
    v_add_f32 v55, v60, v55
    v_mfma_f32_16x16x32_bf16 v[72:75], v[116:119], v[20:23], v[72:75]
    s_waitcnt lgkmcnt(6)
    v_exp_f32 v61, v95
    v_mfma_f32_16x16x32_bf16 v[76:79], v[116:119], v[36:39], v[76:79]
    ds_read_b128 v[116:119], v48 offset:62464
    v_add_f32 v55, v61, v55
    v_cvt_pk_bf16_f32 v143, v60, v61
    v_mfma_f32_16x16x32_bf16 v[72:75], v[120:123], v[24:27], v[72:75]
    s_waitcnt lgkmcnt(6)
    v_exp_f32 v58, v64
    v_mfma_f32_16x16x32_bf16 v[76:79], v[120:123], v[40:43], v[76:79]
    ds_read_b128 v[120:123], v48 offset:63488
    v_add_f32 v62, v54, v55
    v_cmp_nge_f32 vcc, s65, v62
    v_mfma_f32_16x16x32_bf16 v[72:75], v[124:127], v[28:31], v[72:75]
    v_exp_f32 v59, v65
    v_mfma_f32_16x16x32_bf16 v[76:79], v[124:127], v[44:47], v[76:79]
    ds_read_b128 v[124:127], v48 offset:64512
    v_add_f32 v52, v58, v59
    v_cvt_pk_bf16_f32 v128, v58, v59
    s_cbranch_vccnz L_back_15_h
L_back_15:
    s_waitcnt lgkmcnt(7)
    v_mfma_f32_16x16x32_bf16 v[192:195], v[96:99], v[136:139], v[192:195]
    s_waitcnt lgkmcnt(6)
    v_exp_f32 v60, v66
    v_mfma_f32_16x16x32_bf16 v[196:199], v[96:99], v[140:143], v[196:199]
    ds_read_b128 v[96:99], v48 offset:24576
    v_add_f32 v52, v60, v52
    v_add_f32 v56, v54, v56
    v_mfma_f32_16x16x32_bf16 v[200:203], v[100:103], v[136:139], v[200:203]
    s_waitcnt lgkmcnt(6)
    v_exp_f32 v61, v67
    v_mfma_f32_16x16x32_bf16 v[204:207], v[100:103], v[140:143], v[204:207]
    ds_read_b128 v[100:103], v48 offset:25600
    v_add_f32 v52, v61, v52
    v_cvt_pk_bf16_f32 v129, v60, v61
    v_mfma_f32_16x16x32_bf16 v[208:211], v[104:107], v[136:139], v[208:211]
    s_waitcnt lgkmcnt(6)
    v_exp_f32 v58, v68
    v_mfma_f32_16x16x32_bf16 v[212:215], v[104:107], v[140:143], v[212:215]
    ds_read_b128 v[104:107], v48 offset:26624
    v_add_f32 v57, v55, v57
    v_mfma_f32_16x16x32_bf16 v[216:219], v[108:111], v[136:139], v[216:219]
    s_waitcnt lgkmcnt(6)
    v_exp_f32 v59, v69
    v_mfma_f32_16x16x32_bf16 v[220:223], v[108:111], v[140:143], v[220:223]
    s_sub_i32 s64, s64, 1
    ds_read_b128 v[108:111], v48 offset:27648
    v_add_f32 v53, v58, v59
    v_cvt_pk_bf16_f32 v132, v58, v59
    v_mfma_f32_16x16x32_bf16 v[224:227], v[112:115], v[136:139], v[224:227]
    s_waitcnt lgkmcnt(6)
    v_exp_f32 v60, v70
    v_mfma_f32_16x16x32_bf16 v[228:231], v[112:115], v[140:143], v[228:231]
    ds_read_b128 v[112:115], v48 offset:28672
    v_add_f32 v53, v60, v53
    v_mfma_f32_16x16x32_bf16 v[232:235], v[116:119], v[136:139], v[232:235]
    s_waitcnt lgkmcnt(6)
    v_exp_f32 v61, v71
    v_mfma_f32_16x16x32_bf16 v[236:239], v[116:119], v[140:143], v[236:239]
    s_cmp_gt_i32 s64, 0
    ds_read_b128 v[116:119], v48 offset:29696
    v_add_f32 v53, v61, v53
    v_cvt_pk_bf16_f32 v133, v60, v61
    v_mfma_f32_16x16x32_bf16 v[240:243], v[120:123], v[136:139], v[240:243]
    s_waitcnt lgkmcnt(6)
    v_exp_f32 v58, v72
    v_mfma_f32_16x16x32_bf16 v[244:247], v[120:123], v[140:143], v[244:247]
    ds_read_b128 v[120:123], v48 offset:30720
    v_add_f32 v52, v58, v52
    v_mfma_f32_16x16x32_bf16 v[248:251], v[124:127], v[136:139], v[248:251]
    s_waitcnt lgkmcnt(6)
    v_exp_f32 v59, v73
    v_mfma_f32_16x16x32_bf16 v[252:255], v[124:127], v[140:143], v[252:255]
    s_cselect_b32 s65, s72, -1.0
    ds_read_b128 v[124:127], v48 offset:31744
    v_add_f32 v52, v59, v52
    v_cvt_pk_bf16_f32 v130, v58, v59
    v_mfma_f32_16x16x32_bf16 v[80:83], v[96:99], v[16:19], v[144:147]
    s_waitcnt lgkmcnt(6)
    v_exp_f32 v60, v74
    v_mfma_f32_16x16x32_bf16 v[84:87], v[96:99], v[32:35], v[148:151]
    v_add_f32 v52, v60, v52
    v_mfma_f32_16x16x32_bf16 v[80:83], v[100:103], v[20:23], v[80:83]
    s_waitcnt lgkmcnt(5)
    v_exp_f32 v61, v75
    v_xor_b32 v48, 0x10000, v48
    v_mfma_f32_16x16x32_bf16 v[84:87], v[100:103], v[36:39], v[84:87]
    s_cmp_lg_u32 s89, 0
    s_cbranch_scc1 L_ldback_16_c
    s_waitcnt lgkmcnt(0)
    s_barrier
L_ldback_16:
    s_add_i32 s62, s62, 1
    ds_read_b128 v[96:99], v48 offset:32768
    ds_read_b128 v[100:103], v48 offset:33792
    v_add_f32 v52, v61, v52
    v_cvt_pk_bf16_f32 v131, v60, v61
    v_mfma_f32_16x16x32_bf16 v[80:83], v[104:107], v[24:27], v[80:83]
    v_exp_f32 v58, v76
    v_mfma_f32_16x16x32_bf16 v[84:87], v[104:107], v[40:43], v[84:87]
    ds_read_b128 v[104:107], v48 offset:34816
    v_add_f32 v53, v58, v53
    v_mfma_f32_16x16x32_bf16 v[80:83], v[108:111], v[28:31], v[80:83]
    v_exp_f32 v59, v77
    v_mfma_f32_16x16x32_bf16 v[84:87], v[108:111], v[44:47], v[84:87]
    ds_read_b128 v[108:111], v48 offset:35840
    v_add_f32 v53, v59, v53
    v_cvt_pk_bf16_f32 v134, v58, v59
    v_mfma_f32_16x16x32_bf16 v[88:91], v[112:115], v[16:19], v[152:155]
    v_exp_f32 v60, v78
    v_mfma_f32_16x16x32_bf16 v[92:95], v[112:115], v[32:35], v[156:159]
    ds_read_b128 v[112:115], v48 offset:36864
    v_add_f32 v53, v60, v53
    v_mfma_f32_16x16x32_bf16 v[88:91], v[116:119], v[20:23], v[88:91]
    v_exp_f32 v61, v79
    v_mfma_f32_16x16x32_bf16 v[92:95], v[116:119], v[36:39], v[92:95]
    ds_read_b128 v[116:119], v48 offset:37888
    v_add_f32 v53, v61, v53
    v_cvt_pk_bf16_f32 v135, v60, v61
    v_mfma_f32_16x16x32_bf16 v[88:91], v[120:123], v[24:27], v[88:91]
    v_exp_f32 v58, v80
    v_mfma_f32_16x16x32_bf16 v[92:95], v[120:123], v[40:43], v[92:95]
    ds_read_b128 v[120:123], v48 offset:38912
    v_add_f32 v62, v52, v53
    v_cmp_nge_f32 vcc, s65, v62
    v_mfma_f32_16x16x32_bf16 v[88:91], v[124:127], v[28:31], v[88:91]
    v_exp_f32 v59, v81
    v_mfma_f32_16x16x32_bf16 v[92:95], v[124:127], v[44:47], v[92:95]
    ds_read_b128 v[124:127], v48 offset:39936
    v_add_f32 v54, v58, v59
    v_cvt_pk_bf16_f32 v136, v58, v59
    s_cbranch_vccnz L_back_17_h
L_back_17:
    s_branch L_st0
L_tail0:
    s_mov_b32 s65, s72
    s_waitcnt lgkmcnt(7)
    v_mfma_f32_16x16x32_bf16 v[192:195], v[96:99], v[128:131], v[192:195]
    s_waitcnt lgkmcnt(6)
    v_exp_f32 v60, v82
    v_exp_f32 v61, v83
    v_mfma_f32_16x16x32_bf16 v[196:199], v[96:99], v[132:135], v[196:199]
    ds_read_b128 v[96:99], v48 offset:40960
    v_add_f32 v54, v60, v54
    v_add_f32 v54, v61, v54
    v_cvt_pk_bf16_f32 v137, v60, v61
    v_add_f32 v56, v52, v56
    v_mfma_f32_16x16x32_bf16 v[200:203], v[100:103], v[128:131], v[200:203]
    s_waitcnt lgkmcnt(6)
    v_exp_f32 v58, v84
    v_exp_f32 v59, v85
    v_mfma_f32_16x16x32_bf16 v[204:207], v[100:103], v[132:135], v[204:207]
    ds_read_b128 v[100:103], v48 offset:41984
    v_add_f32 v55, v58, v59
    v_cvt_pk_bf16_f32 v140, v58, v59
    v_mfma_f32_16x16x32_bf16 v[208:211], v[104:107], v[128:131], v[208:211]
    s_waitcnt lgkmcnt(6)
    v_exp_f32 v60, v86
    v_exp_f32 v61, v87
    v_mfma_f32_16x16x32_bf16 v[212:215], v[104:107], v[132:135], v[212:215]
    ds_read_b128 v[104:107], v48 offset:43008
    v_add_f32 v55, v60, v55
    v_add_f32 v55, v61, v55
    v_cvt_pk_bf16_f32 v141, v60, v61
    v_add_f32 v57, v53, v57
    v_mfma_f32_16x16x32_bf16 v[216:219], v[108:111], v[128:131], v[216:219]
    s_waitcnt lgkmcnt(6)
    v_exp_f32 v58, v88
    v_exp_f32 v59, v89
    v_mfma_f32_16x16x32_bf16 v[220:223], v[108:111], v[132:135], v[220:223]
    ds_read_b128 v[108:111], v48 offset:44032
    v_add_f32 v54, v58, v54
    v_add_f32 v54, v59, v54
    v_cvt_pk_bf16_f32 v138, v58, v59
    v_mfma_f32_16x16x32_bf16 v[224:227], v[112:115], v[128:131], v[224:227]
    s_waitcnt lgkmcnt(6)
    v_exp_f32 v60, v90
    v_exp_f32 v61, v91
    v_mfma_f32_16x16x32_bf16 v[228:231], v[112:115], v[132:135], v[228:231]
    ds_read_b128 v[112:115], v48 offset:45056
    v_add_f32 v54, v60, v54
    v_add_f32 v54, v61, v54
    v_cvt_pk_bf16_f32 v139, v60, v61
    v_mfma_f32_16x16x32_bf16 v[232:235], v[116:119], v[128:131], v[232:235]
    s_waitcnt lgkmcnt(6)
    v_exp_f32 v58, v92
    v_exp_f32 v59, v93
    v_mfma_f32_16x16x32_bf16 v[236:239], v[116:119], v[132:135], v[236:239]
    ds_read_b128 v[116:119], v48 offset:46080
    v_add_f32 v55, v58, v55
    v_add_f32 v55, v59, v55
    v_cvt_pk_bf16_f32 v142, v58, v59
    v_mfma_f32_16x16x32_bf16 v[240:243], v[120:123], v[128:131], v[240:243]
    s_waitcnt lgkmcnt(6)
    v_exp_f32 v60, v94
    v_exp_f32 v61, v95
    v_mfma_f32_16x16x32_bf16 v[244:247], v[120:123], v[132:135], v[244:247]
    ds_read_b128 v[120:123], v48 offset:47104
    v_add_f32 v55, v60, v55
    v_add_f32 v55, v61, v55
    v_cvt_pk_bf16_f32 v143, v60, v61
    v_mfma_f32_16x16x32_bf16 v[248:251], v[124:127], v[128:131], v[248:251]
    v_mfma_f32_16x16x32_bf16 v[252:255], v[124:127], v[132:135], v[252:255]
    ds_read_b128 v[124:127], v48 offset:48128
    v_add_f32 v62, v54, v55
    v_cmp_nge_f32 vcc, s65, v62
    s_cbranch_vccnz L_back_18_h
L_back_18:
L_pv1:
    s_waitcnt lgkmcnt(7)
    v_mfma_f32_16x16x32_bf16 v[192:195], v[96:99], v[136:139], v[192:195]
    s_waitcnt lgkmcnt(6)
    v_mfma_f32_16x16x32_bf16 v[196:199], v[96:99], v[140:143], v[196:199]
    v_add_f32 v56, v54, v56
    v_mfma_f32_16x16x32_bf16 v[200:203], v[100:103], v[136:139], v[200:203]
    s_waitcnt lgkmcnt(5)
    v_mfma_f32_16x16x32_bf16 v[204:207], v[100:103], v[140:143], v[204:207]
    v_mfma_f32_16x16x32_bf16 v[208:211], v[104:107], v[136:139], v[208:211]
    s_waitcnt lgkmcnt(4)
    v_mfma_f32_16x16x32_bf16 v[212:215], v[104:107], v[140:143], v[212:215]
    v_add_f32 v57, v55, v57
    v_mfma_f32_16x16x32_bf16 v[216:219], v[108:111], v[136:139], v[216:219]
    s_waitcnt lgkmcnt(3)
    v_mfma_f32_16x16x32_bf16 v[220:223], v[108:111], v[140:143], v[220:223]
    v_mfma_f32_16x16x32_bf16 v[224:227], v[112:115], v[136:139], v[224:227]
    s_waitcnt lgkmcnt(2)
    v_mfma_f32_16x16x32_bf16 v[228:231], v[112:115], v[140:143], v[228:231]
    v_mfma_f32_16x16x32_bf16 v[232:235], v[116:119], v[136:139], v[232:235]
    s_waitcnt lgkmcnt(1)
    v_mfma_f32_16x16x32_bf16 v[236:239], v[116:119], v[140:143], v[236:239]
    v_mfma_f32_16x16x32_bf16 v[240:243], v[120:123], v[136:139], v[240:243]
    s_waitcnt lgkmcnt(0)
    v_mfma_f32_16x16x32_bf16 v[244:247], v[120:123], v[140:143], v[244:247]
    v_mfma_f32_16x16x32_bf16 v[248:251], v[124:127], v[136:139], v[248:251]
    v_mfma_f32_16x16x32_bf16 v[252:255], v[124:127], v[140:143], v[252:255]
    s_branch L_fin
L_tail1:
    s_mov_b32 s65, s72
    s_waitcnt lgkmcnt(7)
    v_mfma_f32_16x16x32_bf16 v[192:195], v[96:99], v[136:139], v[192:195]
    s_waitcnt lgkmcnt(6)
    v_exp_f32 v60, v66
    v_exp_f32 v61, v67
    v_mfma_f32_16x16x32_bf16 v[196:199], v[96:99], v[140:143], v[196:199]
    ds_read_b128 v[96:99], v48 offset:49152
    v_add_f32 v52, v60, v52
    v_add_f32 v52, v61, v52
    v_cvt_pk_bf16_f32 v129, v60, v61
    v_add_f32 v56, v54, v56
    v_mfma_f32_16x16x32_bf16 v[200:203], v[100:103], v[136:139], v[200:203]
    s_waitcnt lgkmcnt(6)
    v_exp_f32 v58, v68
    v_exp_f32 v59, v69
    v_mfma_f32_16x16x32_bf16 v[204:207], v[100:103], v[140:143], v[204:207]
    ds_read_b128 v[100:103], v48 offset:50176
    v_add_f32 v53, v58, v59
    v_cvt_pk_bf16_f32 v132, v58, v59
    v_mfma_f32_16x16x32_bf16 v[208:211], v[104:107], v[136:139], v[208:211]
    s_waitcnt lgkmcnt(6)
    v_exp_f32 v60, v70
    v_exp_f32 v61, v71
    v_mfma_f32_16x16x32_bf16 v[212:215], v[104:107], v[140:143], v[212:215]
    ds_read_b128 v[104:107], v48 offset:51200
    v_add_f32 v53, v60, v53
    v_add_f32 v53, v61, v53
    v_cvt_pk_bf16_f32 v133, v60, v61
    v_add_f32 v57, v55, v57
    v_mfma_f32_16x16x32_bf16 v[216:219], v[108:111], v[136:139], v[216:219]
    s_waitcnt lgkmcnt(6)
    v_exp_f32 v58, v72
    v_exp_f32 v59, v73
    v_mfma_f32_16x16x32_bf16 v[220:223], v[108:111], v[140:143], v[220:223]
    ds_read_b128 v[108:111], v48 offset:52224
    v_add_f32 v52, v58, v52
    v_add_f32 v52, v59, v52
    v_cvt_pk_bf16_f32 v130, v58, v59
    v_mfma_f32_16x16x32_bf16 v[224:227], v[112:115], v[136:139], v[224:227]
    s_waitcnt lgkmcnt(6)
    v_exp_f32 v60, v74
    v_exp_f32 v61, v75
    v_mfma_f32_16x16x32_bf16 v[228:231], v[112:115], v[140:143], v[228:231]
    ds_read_b128 v[112:115], v48 offset:53248
    v_add_f32 v52, v60, v52
    v_add_f32 v52, v61, v52
    v_cvt_pk_bf16_f32 v131, v60, v61
    v_mfma_f32_16x16x32_bf16 v[232:235], v[116:119], v[136:139], v[232:235]
    s_waitcnt lgkmcnt(6)
    v_exp_f32 v58, v76
    v_exp_f32 v59, v77
    v_mfma_f32_16x16x32_bf16 v[236:239], v[116:119], v[140:143], v[236:239]
    ds_read_b128 v[116:119], v48 offset:54272
    v_add_f32 v53, v58, v53
    v_add_f32 v53, v59, v53
    v_cvt_pk_bf16_f32 v134, v58, v59
    v_mfma_f32_16x16x32_bf16 v[240:243], v[120:123], v[136:139], v[240:243]
    s_waitcnt lgkmcnt(6)
    v_exp_f32 v60, v78
    v_exp_f32 v61, v79
    v_mfma_f32_16x16x32_bf16 v[244:247], v[120:123], v[140:143], v[244:247]
    ds_read_b128 v[120:123], v48 offset:55296
    v_add_f32 v53, v60, v53
    v_add_f32 v53, v61, v53
    v_cvt_pk_bf16_f32 v135, v60, v61
    v_mfma_f32_16x16x32_bf16 v[248:251], v[124:127], v[136:139], v[248:251]
    v_mfma_f32_16x16x32_bf16 v[252:255], v[124:127], v[140:143], v[252:255]
    ds_read_b128 v[124:127], v48 offset:56320
    v_add_f32 v62, v52, v53
    v_cmp_nge_f32 vcc, s65, v62
    s_cbranch_vccnz L_back_19_h
L_back_19:
L_pv2:
    s_waitcnt lgkmcnt(7)
    v_mfma_f32_16x16x32_bf16 v[192:195], v[96:99], v[128:131], v[192:195]
    s_waitcnt lgkmcnt(6)
    v_mfma_f32_16x16x32_bf16 v[196:199], v[96:99], v[132:135], v[196:199]
    v_add_f32 v56, v52, v56
    v_mfma_f32_16x16x32_bf16 v[200:203], v[100:103], v[128:131], v[200:203]
    s_waitcnt lgkmcnt(5)
    v_mfma_f32_16x16x32_bf16 v[204:207], v[100:103], v[132:135], v[204:207]
    v_mfma_f32_16x16x32_bf16 v[208:211], v[104:107], v[128:131], v[208:211]
    s_waitcnt lgkmcnt(4)
    v_mfma_f32_16x16x32_bf16 v[212:215], v[104:107], v[132:135], v[212:215]
    v_add_f32 v57, v53, v57
    v_mfma_f32_16x16x32_bf16 v[216:219], v[108:111], v[128:131], v[216:219]
    s_waitcnt lgkmcnt(3)
    v_mfma_f32_16x16x32_bf16 v[220:223], v[108:111], v[132:135], v[220:223]
    v_mfma_f32_16x16x32_bf16 v[224:227], v[112:115], v[128:131], v[224:227]
    s_waitcnt lgkmcnt(2)
    v_mfma_f32_16x16x32_bf16 v[228:231], v[112:115], v[132:135], v[228:231]
    v_mfma_f32_16x16x32_bf16 v[232:235], v[116:119], v[128:131], v[232:235]
    s_waitcnt lgkmcnt(1)
    v_mfma_f32_16x16x32_bf16 v[236:239], v[116:119], v[132:135], v[236:239]
    v_mfma_f32_16x16x32_bf16 v[240:243], v[120:123], v[128:131], v[240:243]
    s_waitcnt lgkmcnt(0)
    v_mfma_f32_16x16x32_bf16 v[244:247], v[120:123], v[132:135], v[244:247]
    v_mfma_f32_16x16x32_bf16 v[248:251], v[124:127], v[128:131], v[248:251]
    v_mfma_f32_16x16x32_bf16 v[252:255], v[124:127], v[132:135], v[252:255]
    s_branch L_fin
L_tail2:
    s_mov_b32 s65, s72
    s_waitcnt lgkmcnt(7)
    v_mfma_f32_16x16x32_bf16 v[192:195], v[96:99], v[128:131], v[192:195]
    s_waitcnt lgkmcnt(6)
    v_exp_f32 v60, v82
    v_exp_f32 v61, v83
    v_mfma_f32_16x16x32_bf16 v[196:199], v[96:99], v[132:135], v[196:199]
    ds_read_b128 v[96:99], v48 offset:57344
    v_add_f32 v54, v60, v54
    v_add_f32 v54, v61, v54
    v_cvt_pk_bf16_f32 v137, v60, v61
    v_add_f32 v56, v52, v56
    v_mfma_f32_16x16x32_bf16 v[200:203], v[100:103], v[128:131], v[200:203]
    s_waitcnt lgkmcnt(6)
    v_exp_f32 v58, v84
    v_exp_f32 v59, v85
    v_mfma_f32_16x16x32_bf16 v[204:207], v[100:103], v[132:135], v[204:207]
    ds_read_b128 v[100:103], v48 offset:58368
    v_add_f32 v55, v58, v59
    v_cvt_pk_bf16_f32 v140, v58, v59
    v_mfma_f32_16x16x32_bf16 v[208:211], v[104:107], v[128:131], v[208:211]
    s_waitcnt lgkmcnt(6)
    v_exp_f32 v60, v86
    v_exp_f32 v61, v87
    v_mfma_f32_16x16x32_bf16 v[212:215], v[104:107], v[132:135], v[212:215]
    ds_read_b128 v[104:107], v48 offset:59392
    v_add_f32 v55, v60, v55
    v_add_f32 v55, v61, v55
    v_cvt_pk_bf16_f32 v141, v60, v61
    v_add_f32 v57, v53, v57
    v_mfma_f32_16x16x32_bf16 v[216:219], v[108:111], v[128:131], v[216:219]
    s_waitcnt lgkmcnt(6)
    v_exp_f32 v58, v88
    v_exp_f32 v59, v89
    v_mfma_f32_16x16x32_bf16 v[220:223], v[108:111], v[132:135], v[220:223]
    ds_read_b128 v[108:111], v48 offset:60416
    v_add_f32 v54, v58, v54
    v_add_f32 v54, v59, v54
    v_cvt_pk_bf16_f32 v138, v58, v59
    v_mfma_f32_16x16x32_bf16 v[224:227], v[112:115], v[128:131], v[224:227]
    s_waitcnt lgkmcnt(6)
    v_exp_f32 v60, v90
    v_exp_f32 v61, v91
    v_mfma_f32_16x16x32_bf16 v[228:231], v[112:115], v[132:135], v[228:231]
    ds_read_b128 v[112:115], v48 offset:61440
    v_add_f32 v54, v60, v54
    v_add_f32 v54, v61, v54
    v_cvt_pk_bf16_f32 v139, v60, v61
    v_mfma_f32_16x16x32_bf16 v[232:235], v[116:119], v[128:131], v[232:235]
    s_waitcnt lgkmcnt(6)
    v_exp_f32 v58, v92
    v_exp_f32 v59, v93
    v_mfma_f32_16x16x32_bf16 v[236:239], v[116:119], v[132:135], v[236:239]
    ds_read_b128 v[116:119], v48 offset:62464
    v_add_f32 v55, v58, v55
    v_add_f32 v55, v59, v55
    v_cvt_pk_bf16_f32 v142, v58, v59
    v_mfma_f32_16x16x32_bf16 v[240:243], v[120:123], v[128:131], v[240:243]
    s_waitcnt lgkmcnt(6)
    v_exp_f32 v60, v94
    v_exp_f32 v61, v95
    v_mfma_f32_16x16x32_bf16 v[244:247], v[120:123], v[132:135], v[244:247]
    ds_read_b128 v[120:123], v48 offset:63488
    v_add_f32 v55, v60, v55
    v_add_f32 v55, v61, v55
    v_cvt_pk_bf16_f32 v143, v60, v61
    v_mfma_f32_16x16x32_bf16 v[248:251], v[124:127], v[128:131], v[248:251]
    v_mfma_f32_16x16x32_bf16 v[252:255], v[124:127], v[132:135], v[252:255]
    ds_read_b128 v[124:127], v48 offset:64512
    v_add_f32 v62, v54, v55
    v_cmp_nge_f32 vcc, s65, v62
    s_cbranch_vccnz L_back_20_h
L_back_20:
L_pv3:
    s_waitcnt lgkmcnt(7)
    v_mfma_f32_16x16x32_bf16 v[192:195], v[96:99], v[136:139], v[192:195]
    s_waitcnt lgkmcnt(6)
    v_mfma_f32_16x16x32_bf16 v[196:199], v[96:99], v[140:143], v[196:199]
    v_add_f32 v56, v54, v56
    v_mfma_f32_16x16x32_bf16 v[200:203], v[100:103], v[136:139], v[200:203]
    s_waitcnt lgkmcnt(5)
    v_xor_b32 v48, 0x10000, v48
    v_mfma_f32_16x16x32_bf16 v[204:207], v[100:103], v[140:143], v[204:207]
    s_waitcnt vmcnt(0) lgkmcnt(0)
    s_call_b64 s[82:83], L_pend
    s_barrier
    s_call_b64 s[82:83], L_load
    s_add_i32 s62, s62, 1
    v_mfma_f32_16x16x32_bf16 v[208:211], v[104:107], v[136:139], v[208:211]
    v_mfma_f32_16x16x32_bf16 v[212:215], v[104:107], v[140:143], v[212:215]
    v_add_f32 v57, v55, v57
    v_mfma_f32_16x16x32_bf16 v[216:219], v[108:111], v[136:139], v[216:219]
    v_mfma_f32_16x16x32_bf16 v[220:223], v[108:111], v[140:143], v[220:223]
    v_mfma_f32_16x16x32_bf16 v[224:227], v[112:115], v[136:139], v[224:227]
    v_mfma_f32_16x16x32_bf16 v[228:231], v[112:115], v[140:143], v[228:231]
    v_mfma_f32_16x16x32_bf16 v[232:235], v[116:119], v[136:139], v[232:235]
    v_mfma_f32_16x16x32_bf16 v[236:239], v[116:119], v[140:143], v[236:239]
    v_mfma_f32_16x16x32_bf16 v[240:243], v[120:123], v[136:139], v[240:243]
    v_mfma_f32_16x16x32_bf16 v[244:247], v[120:123], v[140:143], v[244:247]
    v_mfma_f32_16x16x32_bf16 v[248:251], v[124:127], v[136:139], v[248:251]
    v_mfma_f32_16x16x32_bf16 v[252:255], v[124:127], v[140:143], v[252:255]
    s_branch L_fin
L_tail3:
    s_mov_b32 s65, s72
    s_waitcnt lgkmcnt(7)
    v_mfma_f32_16x16x32_bf16 v[192:195], v[96:99], v[136:139], v[192:195]
    s_waitcnt lgkmcnt(6)
    v_exp_f32 v60, v66
    v_exp_f32 v61, v67
    v_mfma_f32_16x16x32_bf16 v[196:199], v[96:99], v[140:143], v[196:199]
    v_add_f32 v52, v60, v52
    v_add_f32 v52, v61, v52
    v_cvt_pk_bf16_f32 v129, v60, v61
    v_add_f32 v56, v54, v56
    v_mfma_f32_16x16x32_bf16 v[200:203], v[100:103], v[136:139], v[200:203]
    s_waitcnt lgkmcnt(5)
    v_exp_f32 v58, v68
    v_exp_f32 v59, v69
    v_xor_b32 v48, 0x10000, v48
    v_mfma_f32_16x16x32_bf16 v[204:207], v[100:103], v[140:143], v[204:207]
    s_waitcnt vmcnt(0) lgkmcnt(0)
    s_call_b64 s[82:83], L_pend
    s_barrier
    s_call_b64 s[82:83], L_load
    s_add_i32 s62, s62, 1
    ds_read_b128 v[96:99], v48 offset:32768
    ds_read_b128 v[100:103], v48 offset:33792
    v_add_f32 v53, v58, v59
    v_cvt_pk_bf16_f32 v132, v58, v59
    v_mfma_f32_16x16x32_bf16 v[208:211], v[104:107], v[136:139], v[208:211]
    v_exp_f32 v60, v70
    v_exp_f32 v61, v71
    v_mfma_f32_16x16x32_bf16 v[212:215], v[104:107], v[140:143], v[212:215]
    ds_read_b128 v[104:107], v48 offset:34816
    v_add_f32 v53, v60, v53
    v_add_f32 v53, v61, v53
    v_cvt_pk_bf16_f32 v133, v60, v61
    v_add_f32 v57, v55, v57
    v_mfma_f32_16x16x32_bf16 v[216:219], v[108:111], v[136:139], v[216:219]
    v_exp_f32 v58, v72
    v_exp_f32 v59, v73
    v_mfma_f32_16x16x32_bf16 v[220:223], v[108:111], v[140:143], v[220:223]
    ds_read_b128 v[108:111], v48 offset:35840
    v_add_f32 v52, v58, v52
    v_add_f32 v52, v59, v52
    v_cvt_pk_bf16_f32 v130, v58, v59
    v_mfma_f32_16x16x32_bf16 v[224:227], v[112:115], v[136:139], v[224:227]
    v_exp_f32 v60, v74
    v_exp_f32 v61, v75
    v_mfma_f32_16x16x32_bf16 v[228:231], v[112:115], v[140:143], v[228:231]
    ds_read_b128 v[112:115], v48 offset:36864
    v_add_f32 v52, v60, v52
    v_add_f32 v52, v61, v52
    v_cvt_pk_bf16_f32 v131, v60, v61
    v_mfma_f32_16x16x32_bf16 v[232:235], v[116:119], v[136:139], v[232:235]
    v_exp_f32 v58, v76
    v_exp_f32 v59, v77
    v_mfma_f32_16x16x32_bf16 v[236:239], v[116:119], v[140:143], v[236:239]
    ds_read_b128 v[116:119], v48 offset:37888
    v_add_f32 v53, v58, v53
    v_add_f32 v53, v59, v53
    v_cvt_pk_bf16_f32 v134, v58, v59
    v_mfma_f32_16x16x32_bf16 v[240:243], v[120:123], v[136:139], v[240:243]
    v_exp_f32 v60, v78
    v_exp_f32 v61, v79
    v_mfma_f32_16x16x32_bf16 v[244:247], v[120:123], v[140:143], v[244:247]
    ds_read_b128 v[120:123], v48 offset:38912
    v_add_f32 v53, v60, v53
    v_add_f32 v53, v61, v53
    v_cvt_pk_bf16_f32 v135, v60, v61
    v_mfma_f32_16x16x32_bf16 v[248:251], v[124:127], v[136:139], v[248:251]
    v_mfma_f32_16x16x32_bf16 v[252:255], v[124:127], v[140:143], v[252:255]
    ds_read_b128 v[124:127], v48 offset:39936
    v_add_f32 v62, v52, v53
    v_cmp_nge_f32 vcc, s65, v62
    s_cbranch_vccnz L_back_23_h
L_back_23:
L_pv0:
    s_waitcnt lgkmcnt(7)
    v_mfma_f32_16x16x32_bf16 v[192:195], v[96:99], v[128:131], v[192:195]
    s_waitcnt lgkmcnt(6)
    v_mfma_f32_16x16x32_bf16 v[196:199], v[96:99], v[132:135], v[196:199]
    v_add_f32 v56, v52, v56
    v_mfma_f32_16x16x32_bf16 v[200:203], v[100:103], v[128:131], v[200:203]
    s_waitcnt lgkmcnt(5)
    v_mfma_f32_16x16x32_bf16 v[204:207], v[100:103], v[132:135], v[204:207]
    v_mfma_f32_16x16x32_bf16 v[208:211], v[104:107], v[128:131], v[208:211]
    s_waitcnt lgkmcnt(4)
    v_mfma_f32_16x16x32_bf16 v[212:215], v[104:107], v[132:135], v[212:215]
    v_add_f32 v57, v53, v57
    v_mfma_f32_16x16x32_bf16 v[216:219], v[108:111], v[128:131], v[216:219]
    s_waitcnt lgkmcnt(3)
    v_mfma_f32_16x16x32_bf16 v[220:223], v[108:111], v[132:135], v[220:223]
    v_mfma_f32_16x16x32_bf16 v[224:227], v[112:115], v[128:131], v[224:227]
    s_waitcnt lgkmcnt(2)
    v_mfma_f32_16x16x32_bf16 v[228:231], v[112:115], v[132:135], v[228:231]
    v_mfma_f32_16x16x32_bf16 v[232:235], v[116:119], v[128:131], v[232:235]
    s_waitcnt lgkmcnt(1)
    v_mfma_f32_16x16x32_bf16 v[236:239], v[116:119], v[132:135], v[236:239]
    v_mfma_f32_16x16x32_bf16 v[240:243], v[120:123], v[128:131], v[240:243]
    s_waitcnt lgkmcnt(0)
    v_mfma_f32_16x16x32_bf16 v[244:247], v[120:123], v[132:135], v[244:247]
    v_mfma_f32_16x16x32_bf16 v[248:251], v[124:127], v[128:131], v[248:251]
    v_mfma_f32_16x16x32_bf16 v[252:255], v[124:127], v[132:135], v[252:255]
L_fin:
    v_and_b32 v3, 7, v1
    v_lshlrev_b32 v3, 2, v3
    s_mov_b32 s72, 0x3a0000
    buffer_load_dword v51, v3, s[8:11], s72 offen sc1
    v_mov_b32 v58, v56
    s_nop 1
    v_permlane16_swap_b32 v56, v58
    s_nop 1
    v_add_f32 v56, v56, v58
    v_mov_b32 v58, v56
    s_nop 1
    v_permlane32_swap_b32 v56, v58
    s_nop 1
    v_add_f32 v56, v56, v58
    v_rcp_f32 v56, v56
    v_mov_b32 v58, v57
    s_nop 1
    v_permlane16_swap_b32 v57, v58
    s_nop 1
    v_add_f32 v57, v57, v58
    v_mov_b32 v58, v57
    s_nop 1
    v_permlane32_swap_b32 v57, v58
    s_nop 1
    v_add_f32 v57, v57, v58
    v_rcp_f32 v57, v57
    s_lshl_b32 s6, s60, 18
    s_lshl_b32 s7, s4, 12
    s_add_u32 s6, s6, s7
    s_add_u32 s6, s6, 50331648
    s_nop 4
    v_mul_f32 v192, v56, v192
    v_mul_f32 v193, v56, v193
    v_mul_f32 v194, v56, v194
    v_mul_f32 v195, v56, v195
    v_cvt_pk_bf16_f32 v16, v192, v193
    v_cvt_pk_bf16_f32 v17, v194, v195
    v_mul_f32 v200, v56, v200
    v_mul_f32 v201, v56, v201
    v_mul_f32 v202, v56, v202
    v_mul_f32 v203, v56, v203
    v_cvt_pk_bf16_f32 v18, v200, v201
    v_cvt_pk_bf16_f32 v19, v202, v203
    buffer_store_dwordx4 v[16:19], v13, s[8:11], s6 offen offset:0 sc1
    v_mul_f32 v208, v56, v208
    v_mul_f32 v209, v56, v209
    v_mul_f32 v210, v56, v210
    v_mul_f32 v211, v56, v211
    v_cvt_pk_bf16_f32 v20, v208, v209
    v_cvt_pk_bf16_f32 v21, v210, v211
    v_mul_f32 v216, v56, v216
    v_mul_f32 v217, v56, v217
    v_mul_f32 v218, v56, v218
    v_mul_f32 v219, v56, v219
    v_cvt_pk_bf16_f32 v22, v216, v217
    v_cvt_pk_bf16_f32 v23, v218, v219
    buffer_store_dwordx4 v[20:23], v13, s[8:11], s6 offen offset:1024 sc1
    v_mul_f32 v224, v56, v224
    v_mul_f32 v225, v56, v225
    v_mul_f32 v226, v56, v226
    v_mul_f32 v227, v56, v227
    v_cvt_pk_bf16_f32 v24, v224, v225
    v_cvt_pk_bf16_f32 v25, v226, v227
    v_mul_f32 v232, v56, v232
    v_mul_f32 v233, v56, v233
    v_mul_f32 v234, v56, v234
    v_mul_f32 v235, v56, v235
    v_cvt_pk_bf16_f32 v26, v232, v233
    v_cvt_pk_bf16_f32 v27, v234, v235
    buffer_store_dwordx4 v[24:27], v13, s[8:11], s6 offen offset:2048 sc1
    v_mul_f32 v240, v56, v240
    v_mul_f32 v241, v56, v241
    v_mul_f32 v242, v56, v242
    v_mul_f32 v243, v56, v243
    v_cvt_pk_bf16_f32 v28, v240, v241
    v_cvt_pk_bf16_f32 v29, v242, v243
    v_mul_f32 v248, v56, v248
    v_mul_f32 v249, v56, v249
    v_mul_f32 v250, v56, v250
    v_mul_f32 v251, v56, v251
    v_cvt_pk_bf16_f32 v30, v248, v249
    v_cvt_pk_bf16_f32 v31, v250, v251
    buffer_store_dwordx4 v[28:31], v13, s[8:11], s6 offen offset:3072 sc1
    s_add_u32 s6, s6, 0x20000
    v_mul_f32 v196, v57, v196
    v_mul_f32 v197, v57, v197
    v_mul_f32 v198, v57, v198
    v_mul_f32 v199, v57, v199
    v_cvt_pk_bf16_f32 v32, v196, v197
    v_cvt_pk_bf16_f32 v33, v198, v199
    v_mul_f32 v204, v57, v204
    v_mul_f32 v205, v57, v205
    v_mul_f32 v206, v57, v206
    v_mul_f32 v207, v57, v207
    v_cvt_pk_bf16_f32 v34, v204, v205
    v_cvt_pk_bf16_f32 v35, v206, v207
    buffer_store_dwordx4 v[32:35], v13, s[8:11], s6 offen offset:0 sc1
    v_mul_f32 v212, v57, v212
    v_mul_f32 v213, v57, v213
    v_mul_f32 v214, v57, v214
    v_mul_f32 v215, v57, v215
    v_cvt_pk_bf16_f32 v36, v212, v213
    v_cvt_pk_bf16_f32 v37, v214, v215
    v_mul_f32 v220, v57, v220
    v_mul_f32 v221, v57, v221
    v_mul_f32 v222, v57, v222
    v_mul_f32 v223, v57, v223
    v_cvt_pk_bf16_f32 v38, v220, v221
    v_cvt_pk_bf16_f32 v39, v222, v223
    buffer_store_dwordx4 v[36:39], v13, s[8:11], s6 offen offset:1024 sc1
    v_mul_f32 v228, v57, v228
    v_mul_f32 v229, v57, v229
    v_mul_f32 v230, v57, v230
    v_mul_f32 v231, v57, v231
    v_cvt_pk_bf16_f32 v40, v228, v229
    v_cvt_pk_bf16_f32 v41, v230, v231
    v_mul_f32 v236, v57, v236
    v_mul_f32 v237, v57, v237
    v_mul_f32 v238, v57, v238
    v_mul_f32 v239, v57, v239
    v_cvt_pk_bf16_f32 v42, v236, v237
    v_cvt_pk_bf16_f32 v43, v238, v239
    buffer_store_dwordx4 v[40:43], v13, s[8:11], s6 offen offset:2048 sc1
    v_mul_f32 v244, v57, v244
    v_mul_f32 v245, v57, v245
    v_mul_f32 v246, v57, v246
    v_mul_f32 v247, v57, v247
    v_cvt_pk_bf16_f32 v44, v244, v245
    v_cvt_pk_bf16_f32 v45, v246, v247
    v_mul_f32 v252, v57, v252
    v_mul_f32 v253, v57, v253
    v_mul_f32 v254, v57, v254
    v_mul_f32 v255, v57, v255
    v_cvt_pk_bf16_f32 v46, v252, v253
    v_cvt_pk_bf16_f32 v47, v254, v255
    buffer_store_dwordx4 v[44:47], v13, s[8:11], s6 offen offset:3072 sc1
    s_cmp_gt_i32 s62, s63
    s_cbranch_scc1 L_pre
    s_waitcnt vmcnt(8)
    s_call_b64 s[82:83], L_pend
    s_barrier
    s_waitcnt vmcnt(0)
    s_lshl_b32 s6, s60, 5
    s_add_u32 s6, s6, s4
    s_lshl_b32 s6, s6, 7
    s_add_u32 s6, s6, 3932160
    v_mov_b32 v2, 1
    v_mov_b32 v3, 0x5000000
    v_writelane_b32 v3, s6, 0
    buffer_store_dword v2, v3, s[8:11], 0 offen sc1
    s_call_b64 s[82:83], L_load
    s_add_i32 s62, s62, 1
    s_lshl_b32 s6, s3, 8
    s_add_u32 s6, s6, s2
    s_cmp_eq_u32 s6, 31
    s_cbranch_scc1 L_top
L_idle:
    s_sub_i32 s6, s63, 5
    s_cmp_gt_i32 s62, s6
    s_cbranch_scc1 L_pre
    s_waitcnt vmcnt(0) lgkmcnt(0)
    s_call_b64 s[82:83], L_pend
    s_barrier
    s_call_b64 s[82:83], L_load
    s_add_i32 s62, s62, 1
    s_cmp_lt_u32 s61, 54
    s_cbranch_scc1 L_moe
    s_branch L_idle
L_pre:
    s_cmp_lt_u32 s3, 4
    s_cbranch_scc1 L_pre1
    s_add_u32 s6, s76, 0
    s_and_b32 s6, s6, 3
    s_lshl_b32 s6, s6, 10
    v_add_u32 v44, s6, v13
    s_add_u32 s6, s76, 1
    s_and_b32 s6, s6, 3
    s_lshl_b32 s6, s6, 10
    v_add_u32 v45, s6, v13
    s_add_u32 s6, s76, 2
    s_and_b32 s6, s6, 3
    s_lshl_b32 s6, s6, 10
    v_add_u32 v46, s6, v13
    s_add_u32 s6, s76, 3
    s_and_b32 s6, s6, 3
    s_lshl_b32 s6, s6, 10
    v_add_u32 v47, s6, v13
    v_add_u32 v52, 4096, v13
    s_lshr_b32 s69, s4, 3
    s_lshl_b32 s69, s69, 2
    s_add_u32 s69, s69, s76
    s_mul_i32 s69, s69, 327680
    s_and_b32 s7, s4, 3
    s_mul_i32 s7, s7, 10240
    s_add_u32 s69, s69, s7
    s_add_u32 s69, s69, 4199424
    s_and_b32 s6, s4, 4
    s_lshr_b32 s7, s4, 3
    s_add_u32 s6, s6, s7
    s_lshl_b32 s7, s5, 3
    s_add_u32 s68, s6, s7
    s_sub_u32 s7, 120, s7
    s_add_u32 s61, s6, s7
    s_and_b32 s6, s63, 1
    s_lshl_b32 s6, s6, 16
    s_xor_b32 s6, s6, 0x10000
    s_lshl_b32 s7, s76, 12
    s_add_u32 s7, s7, s6
    v_add_u32 v5, s7, v13
    s_lshl_b32 s7, s76, 13
    s_add_u32 s6, s6, s7
    v_add_u32 v3, s6, v13
    s_add_u32 s7, s7, 131072
    v_add_u32 v2, s7, v13
    s_barrier
    ds_read_b128 v[96:99], v2 offset:0
    ds_read_b128 v[100:103], v2 offset:1024
    ds_read_b128 v[104:107], v2 offset:2048
    ds_read_b128 v[108:111], v2 offset:3072
    ds_read_b128 v[112:115], v2 offset:4096
    ds_read_b128 v[116:119], v2 offset:5120
    ds_read_b128 v[120:123], v2 offset:6144
    ds_read_b128 v[124:127], v2 offset:7168
    s_waitcnt lgkmcnt(6)
    ds_read_b128 v[128:131], v3 offset:0
    ds_read_b128 v[132:135], v3 offset:1024
    ds_read_b128 v[136:139], v3 offset:2048
    ds_read_b128 v[140:143], v3 offset:3072
    ds_read_b128 v[144:147], v3 offset:4096
    ds_read_b128 v[148:151], v3 offset:5120
    ds_read_b128 v[152:155], v3 offset:6144
    ds_read_b128 v[156:159], v3 offset:7168
    s_waitcnt lgkmcnt(6)
    ds_read_b128 v[160:163], v5 offset:49152
    ds_read_b128 v[164:167], v5 offset:50176
    ds_read_b128 v[168:171], v5 offset:51200
    ds_read_b128 v[172:175], v5 offset:52224
    s_waitcnt lgkmcnt(0)
    s_barrier
    s_add_u32 s75, s69, 163840
    buffer_load_dwordx4 v[176:179], v44, s[8:11], s75 offen sc1
    buffer_load_dwordx4 v[180:183], v45, s[8:11], s75 offen sc1
    buffer_load_dwordx4 v[184:187], v46, s[8:11], s75 offen sc1
    buffer_load_dwordx4 v[188:191], v47, s[8:11], s75 offen sc1
    buffer_load_dwordx4 v[192:195], v52, s[8:11], s75 offen sc1
    s_waitcnt vmcnt(13)
    v_cmp_le_i32 vcc, 0, v51
    s_cbranch_vccz L_idx_okb
    v_and_b32 v3, 7, v1
    v_lshlrev_b32 v3, 2, v3
    s_mov_b32 s72, 0x3a0000
    s_mov_b32 s79, 262144
L_poll_26:
    buffer_load_dword v51, v3, s[8:11], s72 offen sc1
    s_waitcnt vmcnt(0)
    v_cmp_le_i32 vcc, 0, v51
    s_cbranch_vccz L_polldone_27
    s_sleep 2
    s_sub_u32 s79, s79, 1
    s_cmp_lg_u32 s79, 0
    s_cbranch_scc1 L_poll_26
L_polldone_27:
L_idx_okb:
    s_call_b64 s[80:81], L_oprep
    s_waitcnt vmcnt(5)
    s_lshl_b32 s6, s60, 5
    s_add_u32 s6, s6, s4
    s_lshl_b32 s6, s6, 7
    s_add_u32 s6, s6, 3932160
    v_mov_b32 v2, 1
    v_mov_b32 v3, 0x5000000
    v_writelane_b32 v3, s6, 0
    buffer_store_dword v2, v3, s[8:11], 0 offen sc1
    s_branch L_adone
L_oprep:
    s_add_u32 s6, s76, 0
    s_and_b32 s6, s6, 3
    s_lshl_b32 s6, s6, 10
    v_add_u32 v44, s6, v13
    s_add_u32 s6, s76, 1
    s_and_b32 s6, s6, 3
    s_lshl_b32 s6, s6, 10
    v_add_u32 v45, s6, v13
    s_add_u32 s6, s76, 2
    s_and_b32 s6, s6, 3
    s_lshl_b32 s6, s6, 10
    v_add_u32 v46, s6, v13
    s_add_u32 s6, s76, 3
    s_and_b32 s6, s6, 3
    s_lshl_b32 s6, s6, 10
    v_add_u32 v47, s6, v13
    v_add_u32 v52, 4096, v13
    s_lshr_b32 s6, s3, 2
    s_lshl_b32 s6, s6, 1
    s_sub_u32 s71, s76, s6
    s_and_b32 s71, s71, 3
    s_lshr_b32 s6, s4, 3
    s_lshl_b32 s6, s6, 15
    s_lshl_b32 s99, s3, 12
    s_add_u32 s66, s6, s99
    s_add_u32 s66, s66, 50331648
    s_lshl_b32 s6, s76, 13
    v_add_u32 v4, s6, v13
    v_add_u32 v7, 65536, v4
    s_lshr_b32 s6, s3, 2
    s_mul_i32 s67, s6, 15360
    s_add_u32 s67, s67, 98304
    v_add_u32 v6, s67, v44
    s_and_b32 s96, s4, 7
    s_lshl_b32 s7, s5, 3
    s_add_u32 s96, s96, s7
    s_lshr_b32 s7, s4, 3
    s_add_u32 s7, s7, 0
    s_add_u32 s7, s7, 1
    s_and_b32 s7, s7, 3
    s_lshl_b32 s96, s96, 2
    s_add_u32 s96, s96, s7
    s_mul_i32 s96, s96, 3
    s_add_u32 s96, s96, 0
    s_mul_i32 s96, s96, 20480
    s_lshr_b32 s6, s3, 2
    s_mul_i32 s6, s6, 5120
    s_add_u32 s96, s96, s6
    s_add_u32 s96, s96, 67108864
    s_and_b32 s97, s4, 7
    s_lshl_b32 s7, s5, 3
    s_add_u32 s97, s97, s7
    s_lshr_b32 s7, s4, 3
    s_add_u32 s7, s7, 1
    s_add_u32 s7, s7, 1
    s_and_b32 s7, s7, 3
    s_lshl_b32 s97, s97, 2
    s_add_u32 s97, s97, s7
    s_mul_i32 s97, s97, 3
    s_add_u32 s97, s97, 1
    s_mul_i32 s97, s97, 20480
    s_lshr_b32 s6, s3, 2
    s_mul_i32 s6, s6, 5120
    s_add_u32 s97, s97, s6
    s_add_u32 s97, s97, 67108864
    s_and_b32 s98, s4, 7
    s_lshl_b32 s7, s5, 3
    s_add_u32 s98, s98, s7
    s_lshr_b32 s7, s4, 3
    s_add_u32 s7, s7, 2
    s_add_u32 s7, s7, 1
    s_and_b32 s7, s7, 3
    s_lshl_b32 s98, s98, 2
    s_add_u32 s98, s98, s7
    s_mul_i32 s98, s98, 3
    s_add_u32 s98, s98, 2
    s_mul_i32 s98, s98, 20480
    s_lshr_b32 s6, s3, 2
    s_mul_i32 s6, s6, 5120
    s_add_u32 s98, s98, s6
    s_add_u32 s98, s98, 67108864
    s_mov_b32 s12, s32
    s_mov_b32 s13, s33
    s_mov_b32 s14, 0x280000
    s_mov_b32 s15, 0x20000
    s_and_b32 s75, s4, 3
    s_mul_i32 s70, s75, 320
    s_add_u32 s73, s70, 3837952
    s_mul_i32 s72, s75, 5120
    v_lshrrev_b32 v2, 4, v1
    v_and_b32 v3, 15, v1
    v_mul_u32_u24 v54, 1280, v3
    v_lshl_add_u32 v54, v2, 4, v54
    v_lshlrev_b32 v3, 4, v3
    v_lshl_add_u32 v9, v2, 9, v3
    s_lshr_b32 s100, s3, 2
    s_cselect_b32 s6, s61, s68
    s_mul_i32 s6, s6, 20480
    s_lshl_b32 s7, s76, 6
    s_add_u32 s7, s7, s6
    v_add_u32 v53, s7, v54
    s_lshl_b32 s7, s76, 10
    s_add_u32 s7, s7, s6
    s_add_u32 s7, s7, s72
    v_add_u32 v48, s7, v13
    s_mul_i32 s6, s100, 10240
    s_lshl_b32 s7, s76, 11
    s_add_u32 s6, s6, s7
    v_add_u32 v8, s6, v9
    s_mul_i32 s6, s100, 30720
    s_add_u32 s6, s6, 65536
    v_add_u32 v10, s6, v8
    s_lshl_b32 s7, s76, 2
    v_add_u32 v2, s7, v2
    v_cmp_lt_u32 vcc, 9, v2
    v_add_u32 v3, 15360, v10
    s_nop 0
    v_cndmask_b32 v10, v10, v3, vcc
    s_and_b32 s100, s3, 1
    s_cselect_b32 s6, s61, s68
    s_mul_i32 s6, s6, 20480
    s_add_u32 s7, s6, 256
    v_add_u32 v54, s7, v54
    s_add_u32 s7, s6, s72
    s_add_u32 s7, s7, 4096
    v_add_u32 v49, s7, v13
    s_mul_i32 s6, s100, 10240
    s_add_u32 s6, s6, 8192
    v_add_u32 v9, s6, v9
    s_mul_i32 s6, s100, 30720
    s_add_u32 s6, s6, 80896
    v_add_u32 v55, s6, v9
    s_mov_b32 s64, 0
    v_and_b32 v2, 0x7ff, v51
    v_sub_u32 v2, 0x7ff, v2
    v_lshrrev_b32 v3, 4, v2
    v_cmp_eq_u32 vcc, s68, v3
    v_cmp_eq_u32 s[74:75], s61, v3
    s_nop 3
    s_or_b64 vcc, vcc, s[74:75]
    s_cbranch_scc0 L_notok_28
    v_readlane_b32 s84, v2, 0
    v_readlane_b32 s85, v2, 1
    v_readlane_b32 s86, v2, 2
    v_readlane_b32 s87, v2, 3
    v_readlane_b32 s88, v2, 4
    v_readlane_b32 s90, v2, 5
    v_readlane_b32 s91, v2, 6
    v_readlane_b32 s101, v2, 7
    s_lshl_b32 s7, s76, 6
    s_lshr_b32 s100, s3, 2
    s_cselect_b32 s6, s61, s68
    s_lshl_b32 s6, s6, 4
    v_and_b32 v2, 15, v1
    v_add_u32 v2, s6, v2
    s_add_u32 s7, s7, s73
    v_and_b32 v3, 48, v1
    v_add_u32 v3, s7, v3
    v_cmp_eq_u32 vcc, s84, v2
    s_nop 1
    v_cndmask_b32 v48, v48, v3, vcc
    v_add_u32 v3, 1280, v3
    v_cmp_eq_u32 vcc, s85, v2
    s_nop 1
    v_cndmask_b32 v48, v48, v3, vcc
    v_add_u32 v3, 1280, v3
    v_cmp_eq_u32 vcc, s86, v2
    s_nop 1
    v_cndmask_b32 v48, v48, v3, vcc
    v_add_u32 v3, 1280, v3
    v_cmp_eq_u32 vcc, s87, v2
    s_nop 1
    v_cndmask_b32 v48, v48, v3, vcc
    v_add_u32 v3, 1280, v3
    v_cmp_eq_u32 vcc, s88, v2
    s_nop 1
    v_cndmask_b32 v48, v48, v3, vcc
    v_add_u32 v3, 1280, v3
    v_cmp_eq_u32 vcc, s90, v2
    s_nop 1
    v_cndmask_b32 v48, v48, v3, vcc
    v_add_u32 v3, 1280, v3
    v_cmp_eq_u32 vcc, s91, v2
    s_nop 1
    v_cndmask_b32 v48, v48, v3, vcc
    v_add_u32 v3, 1280, v3
    v_cmp_eq_u32 vcc, s101, v2
    s_nop 1
    v_cndmask_b32 v48, v48, v3, vcc
    s_movk_i32 s7, 256
    s_and_b32 s100, s3, 1
    s_cselect_b32 s6, s61, s68
    s_lshl_b32 s6, s6, 4
    v_and_b32 v2, 15, v1
    v_add_u32 v2, s6, v2
    s_add_u32 s7, s7, s73
    v_and_b32 v3, 48, v1
    v_add_u32 v3, s7, v3
    v_cmp_eq_u32 vcc, s84, v2
    s_nop 1
    v_cndmask_b32 v49, v49, v3, vcc
    v_add_u32 v3, 1280, v3
    v_cmp_eq_u32 vcc, s85, v2
    s_nop 1
    v_cndmask_b32 v49, v49, v3, vcc
    v_add_u32 v3, 1280, v3
    v_cmp_eq_u32 vcc, s86, v2
    s_nop 1
    v_cndmask_b32 v49, v49, v3, vcc
    v_add_u32 v3, 1280, v3
    v_cmp_eq_u32 vcc, s87, v2
    s_nop 1
    v_cndmask_b32 v49, v49, v3, vcc
    v_add_u32 v3, 1280, v3
    v_cmp_eq_u32 vcc, s88, v2
    s_nop 1
    v_cndmask_b32 v49, v49, v3, vcc
    v_add_u32 v3, 1280, v3
    v_cmp_eq_u32 vcc, s90, v2
    s_nop 1
    v_cndmask_b32 v49, v49, v3, vcc
    v_add_u32 v3, 1280, v3
    v_cmp_eq_u32 vcc, s91, v2
    s_nop 1
    v_cndmask_b32 v49, v49, v3, vcc
    v_add_u32 v3, 1280, v3
    v_cmp_eq_u32 vcc, s101, v2
    s_nop 1
    v_cndmask_b32 v49, v49, v3, vcc
    s_mov_b32 s64, 1
L_notok_28:
    s_setpc_b64 s[80:81]
L_pre1:
    v_and_b32 v3, 7, v1
    v_lshlrev_b32 v3, 2, v3
    s_mov_b32 s72, 0x3a0000
    buffer_load_dword v51, v3, s[8:11], s72 offen sc1
    s_add_u32 s6, s76, 0
    s_and_b32 s6, s6, 3
    s_lshl_b32 s6, s6, 10
    v_add_u32 v44, s6, v13
    s_add_u32 s6, s76, 1
    s_and_b32 s6, s6, 3
    s_lshl_b32 s6, s6, 10
    v_add_u32 v45, s6, v13
    s_add_u32 s6, s76, 2
    s_and_b32 s6, s6, 3
    s_lshl_b32 s6, s6, 10
    v_add_u32 v46, s6, v13
    s_add_u32 s6, s76, 3
    s_and_b32 s6, s6, 3
    s_lshl_b32 s6, s6, 10
    v_add_u32 v47, s6, v13
    v_add_u32 v52, 4096, v13
    s_lshr_b32 s69, s4, 3
    s_lshl_b32 s69, s69, 2
    s_add_u32 s69, s69, s76
    s_mul_i32 s69, s69, 327680
    s_and_b32 s7, s4, 3
    s_mul_i32 s7, s7, 10240
    s_add_u32 s69, s69, s7
    s_add_u32 s69, s69, 4194304
    s_and_b32 s6, s4, 4
    s_lshr_b32 s7, s4, 3
    s_add_u32 s6, s6, s7
    s_lshl_b32 s7, s5, 3
    s_add_u32 s68, s6, s7
    s_sub_u32 s7, 120, s7
    s_add_u32 s61, s6, s7
    s_add_u32 s75, s69, 0
    buffer_load_dwordx4 v[96:99], v44, s[8:11], s75 offen sc1
    buffer_load_dwordx4 v[100:103], v45, s[8:11], s75 offen sc1
    buffer_load_dwordx4 v[104:107], v46, s[8:11], s75 offen sc1
    buffer_load_dwordx4 v[108:111], v47, s[8:11], s75 offen sc1
    buffer_load_dwordx4 v[112:115], v52, s[8:11], s75 offen sc1
    s_add_u32 s75, s69, 40960
    buffer_load_dwordx4 v[116:119], v44, s[8:11], s75 offen sc1
    buffer_load_dwordx4 v[120:123], v45, s[8:11], s75 offen sc1
    buffer_load_dwordx4 v[124:127], v46, s[8:11], s75 offen sc1
    buffer_load_dwordx4 v[128:131], v47, s[8:11], s75 offen sc1
    buffer_load_dwordx4 v[132:135], v52, s[8:11], s75 offen sc1
    s_cmp_gt_i32 s62, s63
    s_cbranch_scc1 L_e2
    s_cmp_eq_i32 s62, s63
    s_cbranch_scc1 L_lw0
    s_waitcnt vmcnt(11)
L_lw0:
    s_waitcnt vmcnt(21)
    s_call_b64 s[82:83], L_pend
    s_barrier
    s_call_b64 s[82:83], L_load
    s_add_i32 s62, s62, 1
L_e2:
    s_add_u32 s75, s69, 81920
    buffer_load_dwordx4 v[136:139], v44, s[8:11], s75 offen sc1
    buffer_load_dwordx4 v[140:143], v45, s[8:11], s75 offen sc1
    buffer_load_dwordx4 v[144:147], v46, s[8:11], s75 offen sc1
    buffer_load_dwordx4 v[148:151], v47, s[8:11], s75 offen sc1
    buffer_load_dwordx4 v[152:155], v52, s[8:11], s75 offen sc1
    s_add_u32 s75, s69, 122880
    buffer_load_dwordx4 v[156:159], v44, s[8:11], s75 offen sc1
    buffer_load_dwordx4 v[160:163], v45, s[8:11], s75 offen sc1
    buffer_load_dwordx4 v[164:167], v46, s[8:11], s75 offen sc1
    buffer_load_dwordx4 v[168:171], v47, s[8:11], s75 offen sc1
    buffer_load_dwordx4 v[172:175], v52, s[8:11], s75 offen sc1
    s_cmp_gt_i32 s62, s63
    s_cbranch_scc1 L_e3
    s_cmp_eq_i32 s62, s63
    s_cbranch_scc1 L_lw1
    s_waitcnt vmcnt(10)
L_lw1:
    s_waitcnt vmcnt(21)
    s_call_b64 s[82:83], L_pend
    s_barrier
    s_call_b64 s[82:83], L_load
    s_add_i32 s62, s62, 1
L_e3:
    s_add_u32 s75, s69, 163840
    buffer_load_dwordx4 v[176:179], v44, s[8:11], s75 offen sc1
    buffer_load_dwordx4 v[180:183], v45, s[8:11], s75 offen sc1
    buffer_load_dwordx4 v[184:187], v46, s[8:11], s75 offen sc1
    buffer_load_dwordx4 v[188:191], v47, s[8:11], s75 offen sc1
    buffer_load_dwordx4 v[192:195], v52, s[8:11], s75 offen sc1
    s_add_u32 s75, s69, 204800
    buffer_load_dwordx4 v[196:199], v44, s[8:11], s75 offen sc1
    buffer_load_dwordx4 v[200:203], v45, s[8:11], s75 offen sc1
    buffer_load_dwordx4 v[204:207], v46, s[8:11], s75 offen sc1
    buffer_load_dwordx4 v[208:211], v47, s[8:11], s75 offen sc1
    buffer_load_dwordx4 v[212:215], v52, s[8:11], s75 offen sc1
    s_cmp_gt_i32 s62, s63
    s_cbranch_scc1 L_e4
    s_cmp_eq_i32 s62, s63
    s_cbranch_scc1 L_lw2
    s_waitcnt vmcnt(10)
L_lw2:
    s_waitcnt vmcnt(21)
    s_call_b64 s[82:83], L_pend
    s_barrier
    s_call_b64 s[82:83], L_load
    s_add_i32 s62, s62, 1
L_e4:
    s_add_u32 s75, s69, 245760
    buffer_load_dwordx4 v[216:219], v44, s[8:11], s75 offen sc1
    buffer_load_dwordx4 v[220:223], v45, s[8:11], s75 offen sc1
    buffer_load_dwordx4 v[224:227], v46, s[8:11], s75 offen sc1
    buffer_load_dwordx4 v[228:231], v47, s[8:11], s75 offen sc1
    buffer_load_dwordx4 v[232:235], v52, s[8:11], s75 offen sc1
    s_add_u32 s75, s69, 286720
    buffer_load_dwordx4 v[236:239], v44, s[8:11], s75 offen sc1
    buffer_load_dwordx4 v[240:243], v45, s[8:11], s75 offen sc1
    buffer_load_dwordx4 v[244:247], v46, s[8:11], s75 offen sc1
    buffer_load_dwordx4 v[248:251], v47, s[8:11], s75 offen sc1
    buffer_load_dwordx4 v[252:255], v52, s[8:11], s75 offen sc1
    s_cmp_gt_i32 s62, s63
    s_cbranch_scc1 L_e5
    s_cmp_eq_i32 s62, s63
    s_cbranch_scc1 L_lw3
    s_waitcnt vmcnt(10)
L_lw3:
    s_waitcnt vmcnt(21)
    s_call_b64 s[82:83], L_pend
    s_barrier
    s_call_b64 s[82:83], L_load
    s_add_i32 s62, s62, 1
L_e5:
    s_waitcnt vmcnt(40)
    v_cmp_le_i32 vcc, 0, v51
    s_cbranch_vccz L_idx_oka
    v_and_b32 v3, 7, v1
    v_lshlrev_b32 v3, 2, v3
    s_mov_b32 s72, 0x3a0000
    s_mov_b32 s79, 262144
L_poll_33:
    buffer_load_dword v51, v3, s[8:11], s72 offen sc1
    s_waitcnt vmcnt(0)
    v_cmp_le_i32 vcc, 0, v51
    s_cbranch_vccz L_polldone_34
    s_sleep 2
    s_sub_u32 s79, s79, 1
    s_cmp_lg_u32 s79, 0
    s_cbranch_scc1 L_poll_33
L_polldone_34:
L_idx_oka:
    v_and_b32 v3, 1, v1
    v_lshlrev_b32 v3, 12, v3
    v_and_b32 v2, 2, v1
    v_lshl_add_u32 v3, v2, 8, v3
    s_lshr_b32 s72, s68, 2
    s_lshl_b32 s72, s72, 6
    s_andn2_b32 s6, s4, 7
    s_add_u32 s72, s72, s6
    s_add_u32 s72, s72, s76
    s_lshl_b32 s72, s72, 7
    s_add_u32 s72, s72, 3932160
    buffer_load_dword v50, v3, s[8:11], s72 offen sc1
    s_call_b64 s[80:81], L_oprep
    s_cmp_gt_i32 s62, s63
    s_cbranch_scc1 L_e6
    s_waitcnt vmcnt(21)
    s_call_b64 s[82:83], L_pend
    s_barrier
    s_call_b64 s[82:83], L_load
    s_add_i32 s62, s62, 1
L_e6:
    s_waitcnt vmcnt(0)
    s_lshr_b32 s6, s5, 1
    s_lshl_b32 s7, s3, 4
    s_add_u32 s6, s6, s7
    s_cmp_lg_u32 s6, 2
    s_cbranch_scc1 L_yd
    s_and_b32 s6, s5, 1
    s_xor_b32 s6, s6, 1
    s_lshl_b32 s6, s6, 2
    s_lshr_b32 s87, s4, 3
    s_add_u32 s87, s87, s6
    s_and_b32 s88, s4, 7
    s_mov_b32 m0, s87
    s_nop 3
    v_readlane_b32 s85, v51, m0
    s_nop 3
    s_and_b32 s86, s85, 0x7ff
    s_sub_u32 s86, 0x7ff, s86
    v_min_u32 v3, 53, v1
    v_lshlrev_b32 v3, 7, v3
    s_mov_b32 s72, 0xf20000
    s_mov_b32 s79, 262144
L_poll_36:
    buffer_load_dwordx4 v[16:19], v3, s[8:11], s72 offen sc1
    s_waitcnt vmcnt(0)
    v_and_b32 v16, v16, v17
    v_and_b32 v16, v16, v18
    v_and_b32 v16, v16, v19
    v_cmp_ne_u32 vcc, 1, v16
    s_cbranch_vccz L_polldone_37
    s_sleep 16
    s_sub_u32 s79, s79, 1
    s_cmp_lg_u32 s79, 0
    s_cbranch_scc1 L_poll_36
L_polldone_37:
    v_mul_u32_u24 v2, 13, v1
    v_lshrrev_b32 v2, 8, v2
    v_mul_u32_u24 v3, 20, v2
    v_sub_u32 v4, v1, v3
    s_mov_b32 s6, 368640
    v_mul_lo_u32 v2, v2, s6
    v_lshl_add_u32 v2, v4, 4, v2
    v_cmp_lt_u32 vcc, 59, v1
    v_mov_b32 v3, 0x5000000
    s_nop 0
    v_cndmask_b32 v2, v2, v3, vcc
    s_mul_i32 s6, s87, 2560
    s_mul_i32 s7, s88, 320
    s_add_u32 s6, s6, s7
    s_add_u32 s6, s6, 2686976
    buffer_load_dwordx4 v[16:19], v2, s[8:11], s6 offen sc1
    s_add_u32 s6, s6, 20480
    buffer_load_dwordx4 v[20:23], v2, s[8:11], s6 offen sc1
    s_add_u32 s6, s6, 20480
    buffer_load_dwordx4 v[24:27], v2, s[8:11], s6 offen sc1
    s_add_u32 s6, s6, 20480
    buffer_load_dwordx4 v[28:31], v2, s[8:11], s6 offen sc1
    s_add_u32 s6, s6, 20480
    buffer_load_dwordx4 v[32:35], v2, s[8:11], s6 offen sc1
    s_add_u32 s6, s6, 20480
    buffer_load_dwordx4 v[36:39], v2, s[8:11], s6 offen sc1
    s_add_u32 s6, s6, 20480
    buffer_load_dwordx4 v[40:43], v2, s[8:11], s6 offen sc1
    s_add_u32 s6, s6, 20480
    buffer_load_dwordx4 v[44:47], v2, s[8:11], s6 offen sc1
    s_add_u32 s6, s6, 20480
    buffer_load_dwordx4 v[56:59], v2, s[8:11], s6 offen sc1
    s_add_u32 s6, s6, 20480
    buffer_load_dwordx4 v[60:63], v2, s[8:11], s6 offen sc1
    s_add_u32 s6, s6, 20480
    buffer_load_dwordx4 v[64:67], v2, s[8:11], s6 offen sc1
    s_add_u32 s6, s6, 20480
    buffer_load_dwordx4 v[68:71], v2, s[8:11], s6 offen sc1
    s_add_u32 s6, s6, 20480
    buffer_load_dwordx4 v[72:75], v2, s[8:11], s6 offen sc1
    s_add_u32 s6, s6, 20480
    buffer_load_dwordx4 v[76:79], v2, s[8:11], s6 offen sc1
    s_add_u32 s6, s6, 20480
    buffer_load_dwordx4 v[80:83], v2, s[8:11], s6 offen sc1
    s_add_u32 s6, s6, 20480
    buffer_load_dwordx4 v[84:87], v2, s[8:11], s6 offen sc1
    s_add_u32 s6, s6, 20480
    buffer_load_dwordx4 v[88:91], v2, s[8:11], s6 offen sc1
    s_add_u32 s6, s6, 20480
    buffer_load_dwordx4 v[92:95], v2, s[8:11], s6 offen sc1
    s_add_u32 s6, s6, 20480
    s_lshr_b32 s6, s86, 4
    s_mul_i32 s6, s6, 20480
    s_and_b32 s7, s86, 15
    s_lshl_b32 s7, s7, 4
    s_add_u32 s6, s6, s7
    s_mul_i32 s7, s88, 2560
    s_add_u32 s6, s6, s7
    v_lshrrev_b32 v5, 1, v4
    v_lshlrev_b32 v5, 8, v5
    v_and_b32 v6, 1, v4
    v_lshl_add_u32 v5, v6, 3, v5
    buffer_load_dwordx2 v[54:55], v5, s[8:11], s6 offen sc1
    s_bfe_u32 s6, s85, 0x10000b
    s_xor_b32 s7, s6, 0xffff
    s_bitcmp1_b32 s6, 15
    s_bitset0_b32 s6, 15
    s_cselect_b32 s6, s6, s7
    s_lshl_b32 s6, s6, 16
    v_mov_b32 v5, s6
    v_mul_f32 v5, 0xbfb8aa3b, v5
    v_exp_f32 v5, v5
    s_nop 0
    v_add_f32 v5, 1.0, v5
    v_rcp_f32 v5, v5
    s_nop 0
    v_cvt_pk_bf16_f32 v5, v5, v5
    v_lshlrev_b32 v5, 16, v5
    v_lshlrev_b32 v6, 2, v1
    s_waitcnt vmcnt(0)
    v_pk_add_f32 v[16:17], v[16:17], v[20:21]
    v_pk_add_f32 v[18:19], v[18:19], v[22:23]
    v_pk_add_f32 v[16:17], v[16:17], v[24:25]
    v_pk_add_f32 v[18:19], v[18:19], v[26:27]
    v_pk_add_f32 v[16:17], v[16:17], v[28:29]
    v_pk_add_f32 v[18:19], v[18:19], v[30:31]
    v_pk_add_f32 v[16:17], v[16:17], v[32:33]
    v_pk_add_f32 v[18:19], v[18:19], v[34:35]
    v_pk_add_f32 v[16:17], v[16:17], v[36:37]
    v_pk_add_f32 v[18:19], v[18:19], v[38:39]
    v_pk_add_f32 v[16:17], v[16:17], v[40:41]
    v_pk_add_f32 v[18:19], v[18:19], v[42:43]
    v_pk_add_f32 v[16:17], v[16:17], v[44:45]
    v_pk_add_f32 v[18:19], v[18:19], v[46:47]
    v_pk_add_f32 v[16:17], v[16:17], v[56:57]
    v_pk_add_f32 v[18:19], v[18:19], v[58:59]
    v_pk_add_f32 v[16:17], v[16:17], v[60:61]
    v_pk_add_f32 v[18:19], v[18:19], v[62:63]
    v_pk_add_f32 v[16:17], v[16:17], v[64:65]
    v_pk_add_f32 v[18:19], v[18:19], v[66:67]
    v_pk_add_f32 v[16:17], v[16:17], v[68:69]
    v_pk_add_f32 v[18:19], v[18:19], v[70:71]
    v_pk_add_f32 v[16:17], v[16:17], v[72:73]
    v_pk_add_f32 v[18:19], v[18:19], v[74:75]
    v_pk_add_f32 v[16:17], v[16:17], v[76:77]
    v_pk_add_f32 v[18:19], v[18:19], v[78:79]
    v_pk_add_f32 v[16:17], v[16:17], v[80:81]
    v_pk_add_f32 v[18:19], v[18:19], v[82:83]
    v_pk_add_f32 v[16:17], v[16:17], v[84:85]
    v_pk_add_f32 v[18:19], v[18:19], v[86:87]
    v_pk_add_f32 v[16:17], v[16:17], v[88:89]
    v_pk_add_f32 v[18:19], v[18:19], v[90:91]
    v_pk_add_f32 v[16:17], v[16:17], v[92:93]
    v_pk_add_f32 v[18:19], v[18:19], v[94:95]
    ds_bpermute_b32 v20, v6, v16 offset:80
    ds_bpermute_b32 v21, v6, v17 offset:80
    ds_bpermute_b32 v22, v6, v18 offset:80
    ds_bpermute_b32 v23, v6, v19 offset:80
    ds_bpermute_b32 v24, v6, v16 offset:160
    ds_bpermute_b32 v25, v6, v17 offset:160
    ds_bpermute_b32 v26, v6, v18 offset:160
    ds_bpermute_b32 v27, v6, v19 offset:160
    s_waitcnt lgkmcnt(0)
    v_add_f32 v16, v16, v20
    v_add_f32 v16, v16, v24
    v_cvt_pk_bf16_f32 v16, v16, v16
    v_lshlrev_b32 v16, 16, v16
    v_mul_f32 v16, v16, v5
    v_cvt_pk_bf16_f32 v16, v16, v16
    v_lshlrev_b32 v16, 16, v16
    v_lshlrev_b32 v7, 16, v54
    v_add_f32 v16, v16, v7
    v_add_f32 v17, v17, v21
    v_add_f32 v17, v17, v25
    v_cvt_pk_bf16_f32 v17, v17, v17
    v_lshlrev_b32 v17, 16, v17
    v_mul_f32 v17, v17, v5
    v_cvt_pk_bf16_f32 v17, v17, v17
    v_lshlrev_b32 v17, 16, v17
    v_and_b32 v7, 0xffff0000, v54
    v_add_f32 v17, v17, v7
    v_add_f32 v18, v18, v22
    v_add_f32 v18, v18, v26
    v_cvt_pk_bf16_f32 v18, v18, v18
    v_lshlrev_b32 v18, 16, v18
    v_mul_f32 v18, v18, v5
    v_cvt_pk_bf16_f32 v18, v18, v18
    v_lshlrev_b32 v18, 16, v18
    v_lshlrev_b32 v7, 16, v55
    v_add_f32 v18, v18, v7
    v_add_f32 v19, v19, v23
    v_add_f32 v19, v19, v27
    v_cvt_pk_bf16_f32 v19, v19, v19
    v_lshlrev_b32 v19, 16, v19
    v_mul_f32 v19, v19, v5
    v_cvt_pk_bf16_f32 v19, v19, v19
    v_lshlrev_b32 v19, 16, v19
    v_and_b32 v7, 0xffff0000, v55
    v_add_f32 v19, v19, v7
    v_cvt_pk_bf16_f32 v20, v16, v17
    v_cvt_pk_bf16_f32 v21, v18, v19
    v_lshlrev_b32 v2, 3, v1
    v_cmp_lt_u32 vcc, 19, v1
    s_mul_i32 s6, s87, 1280
    s_mul_i32 s7, s88, 160
    v_cndmask_b32 v2, v2, v3, vcc
    s_add_u32 s6, s6, s7
    s_add_u32 s6, s6, 3837952
    buffer_store_dwordx2 v[20:21], v2, s[8:11], s6 offen sc1
    s_call_b64 s[80:81], L_oprep
    s_waitcnt vmcnt(0)
    s_xor_b32 s6, s5, 1
    s_lshl_b32 s6, s6, 5
    s_add_u32 s6, s6, s4
    s_lshl_b32 s6, s6, 7
    s_add_u32 s6, s6, 3899392
    v_mov_b32 v2, 1
    v_mov_b32 v3, 0x5000000
    v_writelane_b32 v3, s6, 0
    buffer_store_dword v2, v3, s[8:11], 0 offen sc1
L_yd:
    v_cmp_ne_u32 vcc, 1, v50
    s_cbranch_vccz L_ce
    v_and_b32 v3, 1, v1
    v_lshlrev_b32 v3, 12, v3
    v_and_b32 v2, 2, v1
    v_lshl_add_u32 v3, v2, 8, v3
    s_lshr_b32 s72, s68, 2
    s_lshl_b32 s72, s72, 6
    s_andn2_b32 s6, s4, 7
    s_add_u32 s72, s72, s6
    s_add_u32 s72, s72, s76
    s_lshl_b32 s72, s72, 7
    s_add_u32 s72, s72, 3932160
    s_mov_b32 s79, 262144
L_poll_38:
    buffer_load_dword v2, v3, s[8:11], s72 offen sc1
    s_waitcnt vmcnt(0)
    v_cmp_ne_u32 vcc, 1, v2
    s_cbranch_vccz L_polldone_39
    s_sleep 4
    s_sub_u32 s79, s79, 1
    s_cmp_lg_u32 s79, 0
    s_cbranch_scc1 L_poll_38
L_polldone_39:
L_ce:
    s_setprio 0
    s_barrier
    s_barrier
    s_add_u32 s65, s68, 1
    s_and_b32 s65, s65, 3
    s_andn2_b32 s7, s68, 3
    s_add_u32 s65, s65, s7
    s_lshl_b32 s65, s65, 17
    s_add_u32 s65, s65, s66
    s_add_u32 m0, s99, 0
    s_add_u32 s65, s65, 0
    buffer_load_dwordx4 v13, s[8:11], s65 offen offset:0 sc1 lds
    buffer_load_dwordx4 v13, s[8:11], s65 offen offset:1024 sc1 lds
    buffer_load_dwordx4 v13, s[8:11], s65 offen offset:2048 sc1 lds
    buffer_load_dwordx4 v13, s[8:11], s65 offen offset:3072 sc1 lds
    s_add_u32 s65, s68, 1
    s_and_b32 s65, s65, 3
    s_andn2_b32 s7, s68, 3
    s_add_u32 s65, s65, s7
    s_lshl_b32 s65, s65, 17
    s_add_u32 s65, s65, s66
    s_add_u32 m0, s99, 16384
    s_add_u32 s65, s65, 16384
    buffer_load_dwordx4 v13, s[8:11], s65 offen offset:0 sc1 lds
    buffer_load_dwordx4 v13, s[8:11], s65 offen offset:1024 sc1 lds
    buffer_load_dwordx4 v13, s[8:11], s65 offen offset:2048 sc1 lds
    buffer_load_dwordx4 v13, s[8:11], s65 offen offset:3072 sc1 lds
    s_add_u32 s65, s68, 2
    s_and_b32 s65, s65, 3
    s_andn2_b32 s7, s68, 3
    s_add_u32 s65, s65, s7
    s_lshl_b32 s65, s65, 17
    s_add_u32 s65, s65, s66
    s_add_u32 m0, s99, 32768
    s_add_u32 s65, s65, 0
    buffer_load_dwordx4 v13, s[8:11], s65 offen offset:0 sc1 lds
    buffer_load_dwordx4 v13, s[8:11], s65 offen offset:1024 sc1 lds
    buffer_load_dwordx4 v13, s[8:11], s65 offen offset:2048 sc1 lds
    buffer_load_dwordx4 v13, s[8:11], s65 offen offset:3072 sc1 lds
    s_add_u32 s65, s68, 2
    s_and_b32 s65, s65, 3
    s_andn2_b32 s7, s68, 3
    s_add_u32 s65, s65, s7
    s_lshl_b32 s65, s65, 17
    s_add_u32 s65, s65, s66
    s_add_u32 m0, s99, 49152
    s_add_u32 s65, s65, 16384
    buffer_load_dwordx4 v13, s[8:11], s65 offen offset:0 sc1 lds
    buffer_load_dwordx4 v13, s[8:11], s65 offen offset:1024 sc1 lds
    buffer_load_dwordx4 v13, s[8:11], s65 offen offset:2048 sc1 lds
    buffer_load_dwordx4 v13, s[8:11], s65 offen offset:3072 sc1 lds
    s_waitcnt vmcnt(8)
    s_branch L_adone
L_moe:
    s_add_u32 s6, s62, s5
    s_cmp_lg_u32 s6, 5
    s_cbranch_scc1 L_idle
    s_mov_b32 s12, s48
    s_mov_b32 s13, s49
    s_mov_b32 s14, 0x21c000
    s_mov_b32 s15, 0x20000
    s_cmp_ge_u32 s3, 2
    s_cselect_b32 s12, s50, s12
    s_cselect_b32 s13, s51, s13
    s_mov_b32 s16, s52
    s_mov_b32 s17, s53
    s_mov_b32 s18, 0x21c000
    s_mov_b32 s19, 0x20000
    v_lshrrev_b32 v3, 2, v1
    v_mul_u32_u24 v3, 3456, v3
    v_and_b32 v4, 3, v1
    v_lshl_add_u32 v16, v4, 4, v3
    v_lshrrev_b32 v3, 3, v1
    v_mul_u32_u24 v3, 1280, v3
    v_and_b32 v4, 7, v1
    v_lshl_add_u32 v18, v4, 4, v3
    s_and_b32 s7, s3, 1
    s_mul_i32 s84, s7, 1105920
    s_lshl_b32 s6, s61, 6
    s_add_u32 s84, s84, s6
    s_lshl_b32 s85, s3, 13
    s_add_u32 s85, s85, 131072
    s_mul_i32 s86, s61, 40960
    s_lshl_b32 s6, s3, 7
    s_add_u32 s86, s86, s6
    s_add_u32 m0, s85, 0
    s_nop 0
    buffer_load_dwordx4 v16, s[12:15], s84 offen lds
    s_add_u32 s84, s84, 55296
    s_add_u32 m0, s85, 1024
    s_nop 0
    buffer_load_dwordx4 v16, s[12:15], s84 offen lds
    s_add_u32 s84, s84, 55296
    s_add_u32 m0, s85, 2048
    s_nop 0
    buffer_load_dwordx4 v16, s[12:15], s84 offen lds
    s_add_u32 s84, s84, 55296
    s_add_u32 m0, s85, 3072
    s_nop 0
    buffer_load_dwordx4 v16, s[12:15], s84 offen lds
    s_add_u32 s84, s84, 55296
    s_add_u32 m0, s85, 4096
    s_nop 0
    buffer_load_dwordx4 v16, s[12:15], s84 offen lds
    s_add_u32 s84, s84, 55296
    s_add_u32 m0, s85, 5120
    s_nop 0
    buffer_load_dwordx4 v16, s[12:15], s84 offen lds
    s_add_u32 s84, s84, 55296
    s_add_u32 m0, s85, 6144
    s_nop 0
    buffer_load_dwordx4 v16, s[12:15], s84 offen lds
    s_add_u32 s84, s84, 55296
    s_add_u32 m0, s85, 7168
    s_nop 0
    buffer_load_dwordx4 v16, s[12:15], s84 offen lds
    s_add_u32 s84, s84, 55296
    v_lshrrev_b32 v7, 4, v1
    v_and_b32 v2, 15, v1
    v_lshrrev_b32 v3, 2, v2
    v_lshl_add_u32 v8, v7, 3, v3
    v_lshlrev_b32 v8, 6, v8
    v_and_b32 v4, 3, v2
    v_lshl_add_u32 v8, v4, 3, v8
    v_add_u32 v17, s85, v8
    v_lshl_add_u32 v8, v7, 2, v3
    v_lshlrev_b32 v8, 7, v8
    v_lshl_add_u32 v8, v4, 3, v8
    s_add_u32 s6, s85, 4096
    v_add_u32 v19, s6, v8
    v_mul_u32_u24 v3, 2560, v2
    v_lshl_add_u32 v3, v7, 4, v3
    v_mov_b32 v4, 0x5000000
    v_cmp_gt_u32 vcc, 8, v2
    s_mul_i32 s87, s61, 20480
    s_lshl_b32 s7, s3, 8
    s_add_u32 s87, s87, s7
    s_add_u32 s87, s87, 2686976
    v_cndmask_b32 v20, v4, v3, vcc
    s_and_b32 s7, s3, 1
    s_mul_i32 s88, s7, 10240
    s_add_u32 s88, s88, 12582912
    s_waitcnt vmcnt(0) lgkmcnt(0)
    s_call_b64 s[82:83], L_pend
    s_barrier
    ds_read_b64_tr_b16 v[104:105], v17 offset:0
    ds_read_b64_tr_b16 v[106:107], v17 offset:256
    ds_read_b64_tr_b16 v[108:109], v17 offset:32
    ds_read_b64_tr_b16 v[110:111], v17 offset:288
    ds_read_b64_tr_b16 v[112:113], v17 offset:2048
    ds_read_b64_tr_b16 v[114:115], v17 offset:2304
    ds_read_b64_tr_b16 v[116:117], v17 offset:2080
    ds_read_b64_tr_b16 v[118:119], v17 offset:2336
    s_waitcnt lgkmcnt(0)
    ds_read_b64_tr_b16 v[120:121], v17 offset:4096
    ds_read_b64_tr_b16 v[122:123], v17 offset:4352
    ds_read_b64_tr_b16 v[124:125], v17 offset:4128
    ds_read_b64_tr_b16 v[126:127], v17 offset:4384
    ds_read_b64_tr_b16 v[128:129], v17 offset:6144
    ds_read_b64_tr_b16 v[130:131], v17 offset:6400
    ds_read_b64_tr_b16 v[132:133], v17 offset:6176
    ds_read_b64_tr_b16 v[134:135], v17 offset:6432
    s_waitcnt lgkmcnt(0)
    s_add_u32 m0, s85, 0
    s_nop 0
    buffer_load_dwordx4 v16, s[12:15], s84 offen lds
    s_add_u32 s84, s84, 55296
    s_add_u32 m0, s85, 1024
    s_nop 0
    buffer_load_dwordx4 v16, s[12:15], s84 offen lds
    s_add_u32 s84, s84, 55296
    s_add_u32 m0, s85, 2048
    s_nop 0
    buffer_load_dwordx4 v16, s[12:15], s84 offen lds
    s_add_u32 s84, s84, 55296
    s_add_u32 m0, s85, 3072
    s_nop 0
    buffer_load_dwordx4 v16, s[12:15], s84 offen lds
    s_add_u32 s84, s84, 55296
    s_add_u32 m0, s85, 4096
    s_nop 0
    buffer_load_dwordx4 v16, s[12:15], s84 offen lds
    s_add_u32 s84, s84, 55296
    s_add_u32 m0, s85, 5120
    s_nop 0
    buffer_load_dwordx4 v16, s[12:15], s84 offen lds
    s_add_u32 s84, s84, 55296
    s_add_u32 m0, s85, 6144
    s_nop 0
    buffer_load_dwordx4 v16, s[12:15], s84 offen lds
    s_add_u32 s84, s84, 55296
    s_add_u32 m0, s85, 7168
    s_nop 0
    buffer_load_dwordx4 v16, s[12:15], s84 offen lds
    s_add_u32 s84, s84, 55296
    s_call_b64 s[82:83], L_load
    s_add_i32 s62, s62, 1
    v_and_b32 v3, 7, v1
    v_lshlrev_b32 v3, 2, v3
    s_mov_b32 s72, 0x3a0000
    buffer_load_dword v51, v3, s[8:11], s72 offen sc1
    s_waitcnt vmcnt(0) lgkmcnt(0)
    s_call_b64 s[82:83], L_pend
    s_barrier
    ds_read_b64_tr_b16 v[136:137], v17 offset:0
    ds_read_b64_tr_b16 v[138:139], v17 offset:256
    ds_read_b64_tr_b16 v[140:141], v17 offset:32
    ds_read_b64_tr_b16 v[142:143], v17 offset:288
    ds_read_b64_tr_b16 v[144:145], v17 offset:2048
    ds_read_b64_tr_b16 v[146:147], v17 offset:2304
    ds_read_b64_tr_b16 v[148:149], v17 offset:2080
    ds_read_b64_tr_b16 v[150:151], v17 offset:2336
    s_waitcnt lgkmcnt(0)
    ds_read_b64_tr_b16 v[152:153], v17 offset:4096
    ds_read_b64_tr_b16 v[154:155], v17 offset:4352
    ds_read_b64_tr_b16 v[156:157], v17 offset:4128
    ds_read_b64_tr_b16 v[158:159], v17 offset:4384
    ds_read_b64_tr_b16 v[160:161], v17 offset:6144
    ds_read_b64_tr_b16 v[162:163], v17 offset:6400
    ds_read_b64_tr_b16 v[164:165], v17 offset:6176
    ds_read_b64_tr_b16 v[166:167], v17 offset:6432
    s_waitcnt lgkmcnt(0)
    s_add_u32 m0, s85, 0
    s_nop 0
    buffer_load_dwordx4 v16, s[12:15], s84 offen lds
    s_add_u32 s84, s84, 55296
    s_add_u32 m0, s85, 1024
    s_nop 0
    buffer_load_dwordx4 v16, s[12:15], s84 offen lds
    s_add_u32 s84, s84, 55296
    s_add_u32 m0, s85, 2048
    s_nop 0
    buffer_load_dwordx4 v16, s[12:15], s84 offen lds
    s_add_u32 s84, s84, 55296
    s_add_u32 m0, s85, 3072
    s_nop 0
    buffer_load_dwordx4 v16, s[12:15], s84 offen lds
    s_add_u32 s84, s84, 55296
    s_add_u32 m0, s85, 4096
    s_add_u32 s6, s86, 0
    buffer_load_dwordx4 v18, s[16:19], s6 offen lds
    s_add_u32 m0, s85, 5120
    s_add_u32 s6, s86, 10240
    buffer_load_dwordx4 v18, s[16:19], s6 offen lds
    s_add_u32 m0, s85, 6144
    s_add_u32 s6, s86, 20480
    buffer_load_dwordx4 v18, s[16:19], s6 offen lds
    s_add_u32 m0, s85, 7168
    s_add_u32 s6, s86, 30720
    buffer_load_dwordx4 v18, s[16:19], s6 offen lds
    s_add_u32 s86, s86, 512
    s_call_b64 s[82:83], L_load
    s_add_i32 s62, s62, 1
    v_cmp_le_i32 vcc, 0, v51
    s_cbranch_vccz L_idx_okm
    v_and_b32 v3, 7, v1
    v_lshlrev_b32 v3, 2, v3
    s_mov_b32 s72, 0x3a0000
    s_mov_b32 s79, 262144
L_poll_42:
    buffer_load_dword v51, v3, s[8:11], s72 offen sc1
    s_waitcnt vmcnt(0)
    v_cmp_le_i32 vcc, 0, v51
    s_cbranch_vccz L_polldone_43
    s_sleep 2
    s_sub_u32 s79, s79, 1
    s_cmp_lg_u32 s79, 0
    s_cbranch_scc1 L_poll_42
L_polldone_43:
L_idx_okm:
    buffer_load_dwordx4 v[64:67], v13, s[8:11], s88 offen sc1
    s_add_u32 s88, s88, 1024
    buffer_load_dwordx4 v[68:71], v13, s[8:11], s88 offen sc1
    s_add_u32 s88, s88, 1024
    buffer_load_dwordx4 v[72:75], v13, s[8:11], s88 offen sc1
    s_add_u32 s88, s88, 1024
    buffer_load_dwordx4 v[76:79], v13, s[8:11], s88 offen sc1
    s_add_u32 s88, s88, 1024
    buffer_load_dwordx4 v[80:83], v13, s[8:11], s88 offen sc1
    s_add_u32 s88, s88, 1024
    buffer_load_dwordx4 v[84:87], v13, s[8:11], s88 offen sc1
    s_add_u32 s88, s88, 1024
    buffer_load_dwordx4 v[88:91], v13, s[8:11], s88 offen sc1
    s_add_u32 s88, s88, 1024
    buffer_load_dwordx4 v[92:95], v13, s[8:11], s88 offen sc1
    s_add_u32 s88, s88, 1024
    buffer_load_dwordx4 v[96:99], v13, s[8:11], s88 offen sc1
    s_add_u32 s88, s88, 1024
    buffer_load_dwordx4 v[100:103], v13, s[8:11], s88 offen sc1
    s_add_u32 s88, s88, 1024
    s_waitcnt vmcnt(10) lgkmcnt(0)
    s_call_b64 s[82:83], L_pend
    s_barrier
    ds_read_b64_tr_b16 v[168:169], v17 offset:0
    ds_read_b64_tr_b16 v[170:171], v17 offset:256
    ds_read_b64_tr_b16 v[172:173], v17 offset:32
    ds_read_b64_tr_b16 v[174:175], v17 offset:288
    ds_read_b64_tr_b16 v[176:177], v17 offset:2048
    ds_read_b64_tr_b16 v[178:179], v17 offset:2304
    ds_read_b64_tr_b16 v[180:181], v17 offset:2080
    ds_read_b64_tr_b16 v[182:183], v17 offset:2336
    s_waitcnt lgkmcnt(0)
    ds_read_b64_tr_b16 v[32:33], v19 offset:0
    ds_read_b64_tr_b16 v[34:35], v19 offset:2048
    ds_read_b64_tr_b16 v[36:37], v19 offset:32
    ds_read_b64_tr_b16 v[38:39], v19 offset:2080
    ds_read_b64_tr_b16 v[40:41], v19 offset:64
    ds_read_b64_tr_b16 v[42:43], v19 offset:2112
    ds_read_b64_tr_b16 v[44:45], v19 offset:96
    ds_read_b64_tr_b16 v[46:47], v19 offset:2144
    s_waitcnt lgkmcnt(0)
    s_add_u32 m0, s85, 4096
    s_add_u32 s6, s86, 0
    buffer_load_dwordx4 v18, s[16:19], s6 offen lds
    s_add_u32 m0, s85, 5120
    s_add_u32 s6, s86, 10240
    buffer_load_dwordx4 v18, s[16:19], s6 offen lds
    s_add_u32 m0, s85, 6144
    s_add_u32 s6, s86, 20480
    buffer_load_dwordx4 v18, s[16:19], s6 offen lds
    s_add_u32 m0, s85, 7168
    s_add_u32 s6, s86, 30720
    buffer_load_dwordx4 v18, s[16:19], s6 offen lds
    s_add_u32 s86, s86, 512
    s_call_b64 s[82:83], L_load
    s_add_i32 s62, s62, 1
    s_waitcnt vmcnt(20)
    v_mfma_f32_16x16x32_bf16 v[24:27], v[104:107], v[64:67], 0
    v_mfma_f32_16x16x32_bf16 v[28:31], v[108:111], v[64:67], 0
    v_mfma_f32_16x16x32_bf16 v[24:27], v[112:115], v[68:71], v[24:27]
    v_mfma_f32_16x16x32_bf16 v[28:31], v[116:119], v[68:71], v[28:31]
    v_mfma_f32_16x16x32_bf16 v[24:27], v[120:123], v[72:75], v[24:27]
    v_mfma_f32_16x16x32_bf16 v[28:31], v[124:127], v[72:75], v[28:31]
    v_mfma_f32_16x16x32_bf16 v[24:27], v[128:131], v[76:79], v[24:27]
    v_mfma_f32_16x16x32_bf16 v[28:31], v[132:135], v[76:79], v[28:31]
    v_mfma_f32_16x16x32_bf16 v[24:27], v[136:139], v[80:83], v[24:27]
    v_mfma_f32_16x16x32_bf16 v[28:31], v[140:143], v[80:83], v[28:31]
    v_mfma_f32_16x16x32_bf16 v[24:27], v[144:147], v[84:87], v[24:27]
    v_mfma_f32_16x16x32_bf16 v[28:31], v[148:151], v[84:87], v[28:31]
    v_mfma_f32_16x16x32_bf16 v[24:27], v[152:155], v[88:91], v[24:27]
    v_mfma_f32_16x16x32_bf16 v[28:31], v[156:159], v[88:91], v[28:31]
    v_mfma_f32_16x16x32_bf16 v[24:27], v[160:163], v[92:95], v[24:27]
    v_mfma_f32_16x16x32_bf16 v[28:31], v[164:167], v[92:95], v[28:31]
    v_mfma_f32_16x16x32_bf16 v[24:27], v[168:171], v[96:99], v[24:27]
    v_mfma_f32_16x16x32_bf16 v[28:31], v[172:175], v[96:99], v[28:31]
    v_mfma_f32_16x16x32_bf16 v[24:27], v[176:179], v[100:103], v[24:27]
    v_mfma_f32_16x16x32_bf16 v[28:31], v[180:183], v[100:103], v[28:31]
    v_add_u32 v10, s85, v13
    s_nop 7
    ds_write_b128 v10, v[24:27]
    ds_write_b128 v10, v[28:31] offset:1024
    s_waitcnt vmcnt(0) lgkmcnt(0)
    s_call_b64 s[82:83], L_pend
    s_barrier
    ds_read_b64_tr_b16 v[240:241], v19 offset:0
    ds_read_b64_tr_b16 v[242:243], v19 offset:2048
    ds_read_b64_tr_b16 v[244:245], v19 offset:32
    ds_read_b64_tr_b16 v[246:247], v19 offset:2080
    ds_read_b64_tr_b16 v[248:249], v19 offset:64
    ds_read_b64_tr_b16 v[250:251], v19 offset:2112
    ds_read_b64_tr_b16 v[252:253], v19 offset:96
    ds_read_b64_tr_b16 v[254:255], v19 offset:2144
    v_add_u32 v10, 131072, v13
    s_waitcnt lgkmcnt(0)
    ds_read_b128 v[184:187], v10 offset:0
    ds_read_b128 v[188:191], v10 offset:1024
    ds_read_b128 v[192:195], v10 offset:8192
    ds_read_b128 v[196:199], v10 offset:9216
    ds_read_b128 v[200:203], v10 offset:16384
    ds_read_b128 v[204:207], v10 offset:17408
    ds_read_b128 v[208:211], v10 offset:24576
    ds_read_b128 v[212:215], v10 offset:25600
    s_cmp_ge_u32 s3, 2
    s_cbranch_scc1 L_moe4b
    s_add_u32 m0, s85, 4096
    s_add_u32 s6, s86, 0
    buffer_load_dwordx4 v18, s[16:19], s6 offen lds
    s_add_u32 m0, s85, 5120
    s_add_u32 s6, s86, 10240
    buffer_load_dwordx4 v18, s[16:19], s6 offen lds
    s_add_u32 m0, s85, 6144
    s_add_u32 s6, s86, 20480
    buffer_load_dwordx4 v18, s[16:19], s6 offen lds
    s_add_u32 m0, s85, 7168
    s_add_u32 s6, s86, 30720
    buffer_load_dwordx4 v18, s[16:19], s6 offen lds
    s_add_u32 s86, s86, 512
L_moe4b:
    s_call_b64 s[82:83], L_load
    s_add_i32 s62, s62, 1
    s_waitcnt lgkmcnt(0)
    s_mov_b32 s6, 0xbfb8aa3b
    v_add_f32 v184, v184, v192
    v_add_f32 v200, v200, v208
    v_add_f32 v185, v185, v193
    v_add_f32 v201, v201, v209
    v_cvt_pk_bf16_f32 v185, v184, v185
    v_lshlrev_b32 v184, 16, v185
    v_and_b32 v185, 0xffff0000, v185
    v_cvt_pk_bf16_f32 v201, v200, v201
    v_lshlrev_b32 v200, 16, v201
    v_and_b32 v201, 0xffff0000, v201
    v_mul_f32 v2, s6, v184
    v_mul_f32 v3, s6, v185
    v_exp_f32 v2, v2
    v_exp_f32 v3, v3
    s_nop 0
    v_add_f32 v2, 1.0, v2
    v_add_f32 v3, 1.0, v3
    v_rcp_f32 v2, v2
    v_rcp_f32 v3, v3
    s_nop 0
    v_mul_f32 v184, v184, v2
    v_mul_f32 v185, v185, v3
    v_cvt_pk_bf16_f32 v185, v184, v185
    v_lshlrev_b32 v184, 16, v185
    v_and_b32 v185, 0xffff0000, v185
    v_mul_f32 v184, v184, v200
    v_mul_f32 v185, v185, v201
    v_cvt_pk_bf16_f32 v24, v184, v185
    v_add_f32 v186, v186, v194
    v_add_f32 v202, v202, v210
    v_add_f32 v187, v187, v195
    v_add_f32 v203, v203, v211
    v_cvt_pk_bf16_f32 v187, v186, v187
    v_lshlrev_b32 v186, 16, v187
    v_and_b32 v187, 0xffff0000, v187
    v_cvt_pk_bf16_f32 v203, v202, v203
    v_lshlrev_b32 v202, 16, v203
    v_and_b32 v203, 0xffff0000, v203
    v_mul_f32 v2, s6, v186
    v_mul_f32 v3, s6, v187
    v_exp_f32 v2, v2
    v_exp_f32 v3, v3
    s_nop 0
    v_add_f32 v2, 1.0, v2
    v_add_f32 v3, 1.0, v3
    v_rcp_f32 v2, v2
    v_rcp_f32 v3, v3
    s_nop 0
    v_mul_f32 v186, v186, v2
    v_mul_f32 v187, v187, v3
    v_cvt_pk_bf16_f32 v187, v186, v187
    v_lshlrev_b32 v186, 16, v187
    v_and_b32 v187, 0xffff0000, v187
    v_mul_f32 v186, v186, v202
    v_mul_f32 v187, v187, v203
    v_cvt_pk_bf16_f32 v25, v186, v187
    v_add_f32 v188, v188, v196
    v_add_f32 v204, v204, v212
    v_add_f32 v189, v189, v197
    v_add_f32 v205, v205, v213
    v_cvt_pk_bf16_f32 v189, v188, v189
    v_lshlrev_b32 v188, 16, v189
    v_and_b32 v189, 0xffff0000, v189
    v_cvt_pk_bf16_f32 v205, v204, v205
    v_lshlrev_b32 v204, 16, v205
    v_and_b32 v205, 0xffff0000, v205
    v_mul_f32 v2, s6, v188
    v_mul_f32 v3, s6, v189
    v_exp_f32 v2, v2
    v_exp_f32 v3, v3
    s_nop 0
    v_add_f32 v2, 1.0, v2
    v_add_f32 v3, 1.0, v3
    v_rcp_f32 v2, v2
    v_rcp_f32 v3, v3
    s_nop 0
    v_mul_f32 v188, v188, v2
    v_mul_f32 v189, v189, v3
    v_cvt_pk_bf16_f32 v189, v188, v189
    v_lshlrev_b32 v188, 16, v189
    v_and_b32 v189, 0xffff0000, v189
    v_mul_f32 v188, v188, v204
    v_mul_f32 v189, v189, v205
    v_cvt_pk_bf16_f32 v26, v188, v189
    v_add_f32 v190, v190, v198
    v_add_f32 v206, v206, v214
    v_add_f32 v191, v191, v199
    v_add_f32 v207, v207, v215
    v_cvt_pk_bf16_f32 v191, v190, v191
    v_lshlrev_b32 v190, 16, v191
    v_and_b32 v191, 0xffff0000, v191
    v_cvt_pk_bf16_f32 v207, v206, v207
    v_lshlrev_b32 v206, 16, v207
    v_and_b32 v207, 0xffff0000, v207
    v_mul_f32 v2, s6, v190
    v_mul_f32 v3, s6, v191
    v_exp_f32 v2, v2
    v_exp_f32 v3, v3
    s_nop 0
    v_add_f32 v2, 1.0, v2
    v_add_f32 v3, 1.0, v3
    v_rcp_f32 v2, v2
    v_rcp_f32 v3, v3
    s_nop 0
    v_mul_f32 v190, v190, v2
    v_mul_f32 v191, v191, v3
    v_cvt_pk_bf16_f32 v191, v190, v191
    v_lshlrev_b32 v190, 16, v191
    v_and_b32 v191, 0xffff0000, v191
    v_mul_f32 v190, v190, v206
    v_mul_f32 v191, v191, v207
    v_cvt_pk_bf16_f32 v27, v190, v191
    s_nop 1
    v_mfma_f32_16x16x32_bf16 v[216:219], v[32:35], v[24:27], 0
    v_mfma_f32_16x16x32_bf16 v[220:223], v[36:39], v[24:27], 0
    v_mfma_f32_16x16x32_bf16 v[224:227], v[40:43], v[24:27], 0
    v_mfma_f32_16x16x32_bf16 v[228:231], v[44:47], v[24:27], 0
    s_nop 7
    buffer_store_dwordx4 v[216:219], v20, s[8:11], s87 offen offset:0 sc1
    buffer_store_dwordx4 v[220:223], v20, s[8:11], s87 offen offset:64 sc1
    buffer_store_dwordx4 v[224:227], v20, s[8:11], s87 offen offset:128 sc1
    buffer_store_dwordx4 v[228:231], v20, s[8:11], s87 offen offset:192 sc1
    s_nop 1
    s_waitcnt vmcnt(4) lgkmcnt(0)
    s_call_b64 s[82:83], L_pend
    s_barrier
    s_call_b64 s[82:83], L_load
    s_add_i32 s62, s62, 1
    v_mfma_f32_16x16x32_bf16 v[216:219], v[240:243], v[24:27], 0
    v_mfma_f32_16x16x32_bf16 v[220:223], v[244:247], v[24:27], 0
    v_mfma_f32_16x16x32_bf16 v[224:227], v[248:251], v[24:27], 0
    v_mfma_f32_16x16x32_bf16 v[228:231], v[252:255], v[24:27], 0
    s_nop 7
    buffer_store_dwordx4 v[216:219], v20, s[8:11], s87 offen offset:1024 sc1
    buffer_store_dwordx4 v[220:223], v20, s[8:11], s87 offen offset:1088 sc1
    buffer_store_dwordx4 v[224:227], v20, s[8:11], s87 offen offset:1152 sc1
    buffer_store_dwordx4 v[228:231], v20, s[8:11], s87 offen offset:1216 sc1
    s_nop 1
    s_cmp_ge_u32 s3, 2
    s_cbranch_scc1 L_moe5b
    ds_read_b64_tr_b16 v[32:33], v19 offset:0
    ds_read_b64_tr_b16 v[34:35], v19 offset:2048
    ds_read_b64_tr_b16 v[36:37], v19 offset:32
    ds_read_b64_tr_b16 v[38:39], v19 offset:2080
    ds_read_b64_tr_b16 v[40:41], v19 offset:64
    ds_read_b64_tr_b16 v[42:43], v19 offset:2112
    ds_read_b64_tr_b16 v[44:45], v19 offset:96
    ds_read_b64_tr_b16 v[46:47], v19 offset:2144
    s_waitcnt lgkmcnt(0)
    v_mfma_f32_16x16x32_bf16 v[216:219], v[32:35], v[24:27], 0
    v_mfma_f32_16x16x32_bf16 v[220:223], v[36:39], v[24:27], 0
    v_mfma_f32_16x16x32_bf16 v[224:227], v[40:43], v[24:27], 0
    v_mfma_f32_16x16x32_bf16 v[228:231], v[44:47], v[24:27], 0
    s_nop 7
    buffer_store_dwordx4 v[216:219], v20, s[8:11], s87 offen offset:2048 sc1
    buffer_store_dwordx4 v[220:223], v20, s[8:11], s87 offen offset:2112 sc1
    buffer_store_dwordx4 v[224:227], v20, s[8:11], s87 offen offset:2176 sc1
    buffer_store_dwordx4 v[228:231], v20, s[8:11], s87 offen offset:2240 sc1
    s_nop 1
L_moe5b:
    s_waitcnt vmcnt(4) lgkmcnt(0)
    s_call_b64 s[82:83], L_pend
    s_barrier
    s_waitcnt vmcnt(0)
    s_lshl_b32 s6, s61, 5
    s_add_u32 s6, s6, s3
    s_lshl_b32 s6, s6, 2
    s_add_u32 s6, s6, 15859712
    v_mov_b32 v2, 1
    v_mov_b32 v3, 0x5000000
    v_writelane_b32 v3, s6, 0
    buffer_store_dword v2, v3, s[8:11], 0 offen sc1
    s_call_b64 s[82:83], L_load
    s_add_i32 s62, s62, 1
    s_branch L_idle
L_top:
    s_mov_b32 s6, 0x280000
    v_lshrrev_b32 v2, 1, v1
    v_and_b32 v3, 1, v1
    v_lshlrev_b32 v3, 4, v3
    v_lshl_add_u32 v2, v2, 7, v3
    buffer_load_dwordx4 v[64:67], v2, s[8:11], s6 offen sc1
    s_add_u32 s6, s6, 4096
    buffer_load_dwordx4 v[68:71], v2, s[8:11], s6 offen sc1
    s_add_u32 s6, s6, 4096
    buffer_load_dwordx4 v[72:75], v2, s[8:11], s6 offen sc1
    s_add_u32 s6, s6, 4096
    buffer_load_dwordx4 v[76:79], v2, s[8:11], s6 offen sc1
    s_add_u32 s6, s6, 4096
    buffer_load_dwordx4 v[80:83], v2, s[8:11], s6 offen sc1
    s_add_u32 s6, s6, 4096
    buffer_load_dwordx4 v[84:87], v2, s[8:11], s6 offen sc1
    s_add_u32 s6, s6, 4096
    buffer_load_dwordx4 v[88:91], v2, s[8:11], s6 offen sc1
    s_add_u32 s6, s6, 4096
    buffer_load_dwordx4 v[92:95], v2, s[8:11], s6 offen sc1
    s_add_u32 s6, s6, 4096
    s_waitcnt vmcnt(0)
    v_mov_b32 v24, 0
    s_mov_b32 s7, 0
    s_mov_b32 s84, 0
L_top_l:
    v_max3_u32 v4, v64, v65, v66
    v_max3_u32 v5, v67, v68, v69
    v_max3_u32 v4, v4, v70, v71
    v_max3_u32 v5, v5, v72, v73
    v_max3_u32 v4, v4, v74, v75
    v_max3_u32 v5, v5, v76, v77
    v_max3_u32 v4, v4, v78, v79
    v_max3_u32 v5, v5, v80, v81
    v_max3_u32 v4, v4, v82, v83
    v_max3_u32 v5, v5, v84, v85
    v_max3_u32 v4, v4, v86, v87
    v_max3_u32 v5, v5, v88, v89
    v_max3_u32 v4, v4, v90, v91
    v_max3_u32 v5, v5, v92, v93
    v_max3_u32 v4, v4, v94, v95
    v_max_u32 v4, v4, v5
    s_nop 1
    v_max_u32_dpp v4, v4, v4 quad_perm:[1,0,3,2] row_mask:0xf bank_mask:0xf
    s_nop 1
    v_max_u32_dpp v4, v4, v4 quad_perm:[2,3,0,1] row_mask:0xf bank_mask:0xf
    s_nop 1
    v_max_u32_dpp v4, v4, v4 row_half_mirror row_mask:0xf bank_mask:0xf
    s_nop 1
    v_max_u32_dpp v4, v4, v4 row_mirror row_mask:0xf bank_mask:0xf
    s_nop 1
    v_max_u32_dpp v4, v4, v4 row_bcast:15 row_mask:0xa bank_mask:0xf
    s_nop 1
    v_max_u32_dpp v4, v4, v4 row_bcast:31 row_mask:0xc bank_mask:0xf
    s_nop 1
    v_readlane_b32 s6, v4, 63
    s_mov_b32 m0, s7
    s_nop 3
    s_add_u32 s84, s84, s6
    v_writelane_b32 v24, s84, m0
    v_subrev_u32 v64, s6, v64
    v_subrev_u32 v65, s6, v65
    v_subrev_u32 v66, s6, v66
    v_subrev_u32 v67, s6, v67
    v_subrev_u32 v68, s6, v68
    v_subrev_u32 v69, s6, v69
    v_subrev_u32 v70, s6, v70
    v_subrev_u32 v71, s6, v71
    v_subrev_u32 v72, s6, v72
    v_subrev_u32 v73, s6, v73
    v_subrev_u32 v74, s6, v74
    v_subrev_u32 v75, s6, v75
    v_subrev_u32 v76, s6, v76
    v_subrev_u32 v77, s6, v77
    v_subrev_u32 v78, s6, v78
    v_subrev_u32 v79, s6, v79
    v_subrev_u32 v80, s6, v80
    v_subrev_u32 v81, s6, v81
    v_subrev_u32 v82, s6, v82
    v_subrev_u32 v83, s6, v83
    v_subrev_u32 v84, s6, v84
    v_subrev_u32 v85, s6, v85
    v_subrev_u32 v86, s6, v86
    v_subrev_u32 v87, s6, v87
    v_subrev_u32 v88, s6, v88
    v_subrev_u32 v89, s6, v89
    v_subrev_u32 v90, s6, v90
    v_subrev_u32 v91, s6, v91
    v_subrev_u32 v92, s6, v92
    v_subrev_u32 v93, s6, v93
    v_subrev_u32 v94, s6, v94
    v_subrev_u32 v95, s6, v95
    s_add_u32 s7, s7, 1
    s_cmp_lt_u32 s7, 8
    s_cbranch_scc1 L_top_l
    v_and_b32 v2, 7, v1
    v_lshlrev_b32 v2, 2, v2
    ds_bpermute_b32 v4, v2, v24
    s_waitcnt lgkmcnt(0)
    v_and_b32 v4, 0x7ff, v4
    v_sub_u32 v4, 0x7ff, v4
    v_lshrrev_b32 v5, 4, v4
    v_mul_u32_u24 v5, 20480, v5
    v_and_b32 v4, 15, v4
    v_lshl_add_u32 v5, v4, 4, v5
    v_lshrrev_b32 v7, 4, v1
    v_lshl_add_u32 v5, v7, 8, v5
    v_mov_b32 v6, 0x5000000
    v_and_b32 v2, 8, v1
    v_cmp_eq_u32 vcc, 0, v2
    s_mov_b32 s6, 0
    s_nop 0
    v_cndmask_b32 v5, v6, v5, vcc
    buffer_load_dwordx4 v[64:67], v5, s[8:11], s6 offen offset:0 sc1
    buffer_load_dwordx4 v[68:71], v5, s[8:11], s6 offen offset:1024 sc1
    buffer_load_dwordx4 v[72:75], v5, s[8:11], s6 offen offset:2048 sc1
    buffer_load_dwordx4 v[76:79], v5, s[8:11], s6 offen offset:3072 sc1
    s_add_u32 s6, s6, 4096
    buffer_load_dwordx4 v[80:83], v5, s[8:11], s6 offen offset:0 sc1
    buffer_load_dwordx4 v[84:87], v5, s[8:11], s6 offen offset:1024 sc1
    buffer_load_dwordx4 v[88:91], v5, s[8:11], s6 offen offset:2048 sc1
    buffer_load_dwordx4 v[92:95], v5, s[8:11], s6 offen offset:3072 sc1
    s_add_u32 s6, s6, 4096
    buffer_load_dwordx4 v[96:99], v5, s[8:11], s6 offen offset:0 sc1
    buffer_load_dwordx4 v[100:103], v5, s[8:11], s6 offen offset:1024 sc1
    buffer_load_dwordx4 v[104:107], v5, s[8:11], s6 offen offset:2048 sc1
    buffer_load_dwordx4 v[108:111], v5, s[8:11], s6 offen offset:3072 sc1
    s_add_u32 s6, s6, 4096
    buffer_load_dwordx4 v[112:115], v5, s[8:11], s6 offen offset:0 sc1
    buffer_load_dwordx4 v[116:119], v5, s[8:11], s6 offen offset:1024 sc1
    buffer_load_dwordx4 v[120:123], v5, s[8:11], s6 offen offset:2048 sc1
    buffer_load_dwordx4 v[124:127], v5, s[8:11], s6 offen offset:3072 sc1
    s_add_u32 s6, s6, 4096
    buffer_load_dwordx4 v[128:131], v5, s[8:11], s6 offen offset:0 sc1
    buffer_load_dwordx4 v[132:135], v5, s[8:11], s6 offen offset:1024 sc1
    buffer_load_dwordx4 v[136:139], v5, s[8:11], s6 offen offset:2048 sc1
    buffer_load_dwordx4 v[140:143], v5, s[8:11], s6 offen offset:3072 sc1
    s_waitcnt vmcnt(20)
    s_call_b64 s[82:83], L_pend
    s_barrier
    s_waitcnt vmcnt(0)
    s_mov_b32 s6, 0xc00000
    buffer_store_dwordx4 v[64:67], v13, s[8:11], s6 offen offset:0 sc1
    buffer_store_dwordx4 v[68:71], v13, s[8:11], s6 offen offset:1024 sc1
    buffer_store_dwordx4 v[72:75], v13, s[8:11], s6 offen offset:2048 sc1
    buffer_store_dwordx4 v[76:79], v13, s[8:11], s6 offen offset:3072 sc1
    s_add_u32 s6, s6, 4096
    buffer_store_dwordx4 v[80:83], v13, s[8:11], s6 offen offset:0 sc1
    buffer_store_dwordx4 v[84:87], v13, s[8:11], s6 offen offset:1024 sc1
    buffer_store_dwordx4 v[88:91], v13, s[8:11], s6 offen offset:2048 sc1
    buffer_store_dwordx4 v[92:95], v13, s[8:11], s6 offen offset:3072 sc1
    s_add_u32 s6, s6, 4096
    buffer_store_dwordx4 v[96:99], v13, s[8:11], s6 offen offset:0 sc1
    buffer_store_dwordx4 v[100:103], v13, s[8:11], s6 offen offset:1024 sc1
    buffer_store_dwordx4 v[104:107], v13, s[8:11], s6 offen offset:2048 sc1
    buffer_store_dwordx4 v[108:111], v13, s[8:11], s6 offen offset:3072 sc1
    s_add_u32 s6, s6, 4096
    buffer_store_dwordx4 v[112:115], v13, s[8:11], s6 offen offset:0 sc1
    buffer_store_dwordx4 v[116:119], v13, s[8:11], s6 offen offset:1024 sc1
    buffer_store_dwordx4 v[120:123], v13, s[8:11], s6 offen offset:2048 sc1
    buffer_store_dwordx4 v[124:127], v13, s[8:11], s6 offen offset:3072 sc1
    s_add_u32 s6, s6, 4096
    buffer_store_dwordx4 v[128:131], v13, s[8:11], s6 offen offset:0 sc1
    buffer_store_dwordx4 v[132:135], v13, s[8:11], s6 offen offset:1024 sc1
    buffer_store_dwordx4 v[136:139], v13, s[8:11], s6 offen offset:2048 sc1
    buffer_store_dwordx4 v[140:143], v13, s[8:11], s6 offen offset:3072 sc1
    s_call_b64 s[82:83], L_load
    s_add_i32 s62, s62, 1
    s_waitcnt vmcnt(16)
    v_or_b32 v24, 0x80000000, v24
    v_lshlrev_b32 v5, 2, v1
    v_mov_b32 v6, 0x5000000
    v_cmp_gt_u32 vcc, 8, v1
    s_mov_b32 s6, 0x3a0000
    s_nop 0
    v_cndmask_b32 v5, v6, v5, vcc
    buffer_store_dword v24, v5, s[8:11], s6 offen sc1
    s_branch L_idle
L_back_12_h:
    v_cmp_nge_f32 vcc, s72, v62
    s_cbranch_vccz L_back_12_n
    s_call_b64 s[80:81], L_rare0
L_back_12_n:
    s_branch L_back_12
L_back_13_h:
    v_cmp_nge_f32 vcc, s72, v62
    s_cbranch_vccz L_back_13_n
    s_call_b64 s[80:81], L_rare1
    v_exp_f32 v58, v64
    v_exp_f32 v59, v65
    s_nop 0
    v_add_f32 v52, v58, v59
    v_cvt_pk_bf16_f32 v128, v58, v59
L_back_13_n:
    s_cmp_lt_i32 s64, 0
    s_cbranch_scc1 L_tail1
    s_cmp_gt_i32 s64, 0
    s_cbranch_scc1 L_back_13
    s_call_b64 s[82:83], L_mask
    s_branch L_back_13
L_back_14_h:
    v_cmp_nge_f32 vcc, s72, v62
    s_cbranch_vccz L_back_14_n
    s_call_b64 s[80:81], L_rare0
    v_exp_f32 v58, v80
    v_exp_f32 v59, v81
    s_nop 0
    v_add_f32 v54, v58, v59
    v_cvt_pk_bf16_f32 v136, v58, v59
L_back_14_n:
    s_cmp_lt_i32 s64, 0
    s_cbranch_scc1 L_tail2
    s_cmp_gt_i32 s64, 0
    s_cbranch_scc1 L_back_14
    s_call_b64 s[82:83], L_mask
    s_branch L_back_14
L_back_15_h:
    v_cmp_nge_f32 vcc, s72, v62
    s_cbranch_vccz L_back_15_n
    s_call_b64 s[80:81], L_rare1
    v_exp_f32 v58, v64
    v_exp_f32 v59, v65
    s_nop 0
    v_add_f32 v52, v58, v59
    v_cvt_pk_bf16_f32 v128, v58, v59
L_back_15_n:
    s_cmp_lt_i32 s64, 0
    s_cbranch_scc1 L_tail3
    s_cmp_gt_i32 s64, 0
    s_cbranch_scc1 L_back_15
    s_call_b64 s[82:83], L_mask
    s_branch L_back_15
L_ldback_16_c:
    s_waitcnt vmcnt(0) lgkmcnt(0)
    s_call_b64 s[82:83], L_pend
    s_barrier
    s_call_b64 s[82:83], L_load
    s_branch L_ldback_16
L_back_17_h:
    v_cmp_nge_f32 vcc, s72, v62
    s_cbranch_vccz L_back_17_n
    s_call_b64 s[80:81], L_rare0
    v_exp_f32 v58, v80
    v_exp_f32 v59, v81
    s_nop 0
    v_add_f32 v54, v58, v59
    v_cvt_pk_bf16_f32 v136, v58, v59
L_back_17_n:
    s_cmp_lt_i32 s64, 0
    s_cbranch_scc1 L_tail0
    s_cmp_gt_i32 s64, 0
    s_cbranch_scc1 L_back_17
    s_call_b64 s[82:83], L_mask
    s_branch L_back_17
L_back_18_h:
    v_cmp_nge_f32 vcc, s72, v62
    s_cbranch_vccz L_back_18_n
    s_call_b64 s[80:81], L_rare1
L_back_18_n:
    s_branch L_back_18
L_back_19_h:
    v_cmp_nge_f32 vcc, s72, v62
    s_cbranch_vccz L_back_19_n
    s_call_b64 s[80:81], L_rare0
L_back_19_n:
    s_branch L_back_19
L_back_20_h:
    v_cmp_nge_f32 vcc, s72, v62
    s_cbranch_vccz L_back_20_n
    s_call_b64 s[80:81], L_rare1
L_back_20_n:
    s_branch L_back_20
L_back_23_h:
    v_cmp_nge_f32 vcc, s72, v62
    s_cbranch_vccz L_back_23_n
    s_call_b64 s[80:81], L_rare0
L_back_23_n:
    s_branch L_back_23
L_load:
    s_bitcmp1_b32 s89, 0
    s_cbranch_scc0 L_load_r
    s_add_u32 s77, s77, 32768
    s_xor_b32 s78, s78, 0x10000
    s_add_i32 s73, s62, 1
    s_cmp_gt_i32 s73, s63
    s_cbranch_scc1 L_load_r
    s_cmp_eq_i32 s73, s63
    s_cbranch_scc1 L_load_v
    s_cmp_lg_i32 s73, 3
    s_cbranch_scc1 L_load_k
    s_lshl_b32 s7, s4, 10
    s_add_u32 s7, s7, 3866624
    v_lshrrev_b32 v2, 3, v1
    v_and_b32 v3, 7, v1
    v_lshlrev_b32 v3, 2, v3
    v_lshl_add_u32 v3, v2, 7, v3
    s_mov_b32 s79, 262144
L_poll_49:
    buffer_load_dword v2, v3, s[8:11], s7 offen sc1
    s_waitcnt vmcnt(0)
    v_cmp_gt_u32 vcc, 2, v2
    s_cbranch_vccz L_polldone_50
    s_sleep 2
    s_sub_u32 s79, s79, 1
    s_cmp_lg_u32 s79, 0
    s_cbranch_scc1 L_poll_49
L_polldone_50:
L_load_k:
    s_lshl_b32 s6, s76, 13
    s_add_u32 s6, s6, s78
    s_add_u32 m0, s6, 0
    s_add_u32 s7, s77, 0
    buffer_load_dwordx4 v49, s[8:11], s7 offen offset:0 sc1 lds
    buffer_load_dwordx4 v49, s[8:11], s7 offen offset:1024 sc1 lds
    buffer_load_dwordx4 v49, s[8:11], s7 offen offset:2048 sc1 lds
    buffer_load_dwordx4 v49, s[8:11], s7 offen offset:3072 sc1 lds
    s_lshl_b32 s6, s76, 13
    s_add_u32 s6, s6, s78
    s_add_u32 m0, s6, 4096
    s_add_u32 s7, s77, 4096
    buffer_load_dwordx4 v49, s[8:11], s7 offen offset:0 sc1 lds
    buffer_load_dwordx4 v49, s[8:11], s7 offen offset:1024 sc1 lds
    buffer_load_dwordx4 v49, s[8:11], s7 offen offset:2048 sc1 lds
    buffer_load_dwordx4 v49, s[8:11], s7 offen offset:3072 sc1 lds
    s_lshl_b32 s6, s76, 12
    s_add_u32 s6, s6, s78
    s_add_u32 m0, s6, 49152
    s_add_u32 s7, s77, 524288
    buffer_load_dwordx4 v50, s[8:11], s7 offen offset:0 sc1 lds
    buffer_load_dwordx4 v50, s[8:11], s7 offen offset:1024 sc1 lds
    buffer_load_dwordx4 v50, s[8:11], s7 offen offset:2048 sc1 lds
    buffer_load_dwordx4 v50, s[8:11], s7 offen offset:3072 sc1 lds
L_load_v:
    s_lshl_b32 s6, s76, 12
    s_add_u32 s6, s6, s78
    s_add_u32 m0, s6, 32768
    s_add_u32 s7, s77, 507904
    buffer_load_dwordx4 v50, s[8:11], s7 offen offset:0 sc1 lds
    buffer_load_dwordx4 v50, s[8:11], s7 offen offset:1024 sc1 lds
    buffer_load_dwordx4 v50, s[8:11], s7 offen offset:2048 sc1 lds
    buffer_load_dwordx4 v50, s[8:11], s7 offen offset:3072 sc1 lds
    s_cmp_eq_i32 s73, s63
    s_cbranch_scc1 L_xa
    s_cmp_lt_u32 s5, 4
    s_cbranch_scc1 L_load_r
    s_sub_i32 s79, s73, 1
    s_cmp_lt_u32 s79, 2
    s_cbranch_scc1 L_x3
L_load_r:
    s_setpc_b64 s[82:83]
L_pend:
    s_bitcmp1_b32 s89, 1
    s_cbranch_scc0 L_load_a
    s_cmp_lt_i32 s62, 0
    s_cbranch_scc1 L_load_a
    s_lshl_b32 s6, s4, 3
    s_add_u32 s6, s6, s5
    s_lshl_b32 s6, s6, 5
    s_add_u32 s6, s6, s3
    s_lshl_b32 s6, s6, 2
    s_add_u32 s6, s6, 3866624
    v_mov_b32 v2, 2
    v_mov_b32 v3, 0x5000000
    v_writelane_b32 v3, s6, 0
    buffer_store_dword v2, v3, s[8:11], 0 offen sc1
    s_and_b32 s89, s89, 1
L_load_a:
    s_setpc_b64 s[82:83]
L_xa:
    s_getpc_b64 s[80:81]
L_pc2:
    s_sub_u32 s80, s80, L_pc2-L_fin
    s_subb_u32 s81, s81, 0
    s_and_b32 s6, s4, 1
    s_lshl_b32 s6, s6, 14
    v_lshl_add_u32 v3, v0, 6, s6
    v_min_u32 v3, L_exit-L_fin, v3
    global_load_dword v11, v3, s[80:81]
    s_lshr_b32 s74, s4, 3
    s_lshl_b32 s74, s74, 2
    s_add_u32 s74, s74, s76
    s_mul_i32 s74, s74, 327680
    s_and_b32 s7, s4, 3
    s_mul_i32 s7, s7, 10240
    s_add_u32 s74, s74, s7
    s_add_u32 s74, s74, 4199424
    s_add_u32 s6, s76, 0
    s_and_b32 s6, s6, 3
    s_lshl_b32 s6, s6, 10
    v_add_u32 v4, s6, v13
    s_add_u32 s6, s76, 1
    s_and_b32 s6, s6, 3
    s_lshl_b32 s6, s6, 10
    v_add_u32 v5, s6, v13
    s_add_u32 s6, s76, 2
    s_and_b32 s6, s6, 3
    s_lshl_b32 s6, s6, 10
    v_add_u32 v6, s6, v13
    s_add_u32 s6, s76, 3
    s_and_b32 s6, s6, 3
    s_lshl_b32 s6, s6, 10
    v_add_u32 v7, s6, v13
    v_add_u32 v8, 4096, v13
    s_lshl_b32 s73, s3, 13
    s_add_u32 s75, s73, s78
    s_add_u32 m0, s73, 131072
    s_add_u32 s7, s74, 0
    buffer_load_dwordx4 v4, s[8:11], s7 offen sc1 lds
    s_add_u32 m0, s73, 132096
    s_add_u32 s7, s74, 0
    buffer_load_dwordx4 v5, s[8:11], s7 offen sc1 lds
    s_add_u32 m0, s73, 133120
    s_add_u32 s7, s74, 0
    buffer_load_dwordx4 v6, s[8:11], s7 offen sc1 lds
    s_add_u32 m0, s73, 134144
    s_add_u32 s7, s74, 0
    buffer_load_dwordx4 v7, s[8:11], s7 offen sc1 lds
    s_add_u32 m0, s73, 135168
    s_add_u32 s7, s74, 0
    buffer_load_dwordx4 v8, s[8:11], s7 offen sc1 lds
    s_add_u32 m0, s73, 136192
    s_add_u32 s7, s74, 40960
    buffer_load_dwordx4 v4, s[8:11], s7 offen sc1 lds
    s_add_u32 m0, s73, 137216
    s_add_u32 s7, s74, 40960
    buffer_load_dwordx4 v5, s[8:11], s7 offen sc1 lds
    s_add_u32 m0, s73, 138240
    s_add_u32 s7, s74, 40960
    buffer_load_dwordx4 v6, s[8:11], s7 offen sc1 lds
    s_add_u32 m0, s75, 0
    s_add_u32 s7, s74, 40960
    buffer_load_dwordx4 v7, s[8:11], s7 offen sc1 lds
    s_add_u32 m0, s75, 1024
    s_add_u32 s7, s74, 40960
    buffer_load_dwordx4 v8, s[8:11], s7 offen sc1 lds
    s_add_u32 m0, s75, 2048
    s_add_u32 s7, s74, 81920
    buffer_load_dwordx4 v4, s[8:11], s7 offen sc1 lds
    s_add_u32 m0, s75, 3072
    s_add_u32 s7, s74, 81920
    buffer_load_dwordx4 v5, s[8:11], s7 offen sc1 lds
    s_add_u32 m0, s75, 4096
    s_add_u32 s7, s74, 81920
    buffer_load_dwordx4 v6, s[8:11], s7 offen sc1 lds
    s_add_u32 m0, s75, 5120
    s_add_u32 s7, s74, 81920
    buffer_load_dwordx4 v7, s[8:11], s7 offen sc1 lds
    s_add_u32 m0, s75, 6144
    s_add_u32 s7, s74, 81920
    buffer_load_dwordx4 v8, s[8:11], s7 offen sc1 lds
    s_add_u32 m0, s75, 7168
    s_add_u32 s7, s74, 122880
    buffer_load_dwordx4 v4, s[8:11], s7 offen sc1 lds
    s_lshl_b32 s75, s3, 12
    s_add_u32 s75, s75, s78
    s_add_u32 m0, s75, 49152
    s_add_u32 s7, s74, 122880
    buffer_load_dwordx4 v5, s[8:11], s7 offen sc1 lds
    s_add_u32 m0, s75, 50176
    s_add_u32 s7, s74, 122880
    buffer_load_dwordx4 v6, s[8:11], s7 offen sc1 lds
    s_add_u32 m0, s75, 51200
    s_add_u32 s7, s74, 122880
    buffer_load_dwordx4 v7, s[8:11], s7 offen sc1 lds
    s_add_u32 m0, s75, 52224
    s_add_u32 s7, s74, 122880
    buffer_load_dwordx4 v8, s[8:11], s7 offen sc1 lds
    s_setpc_b64 s[82:83]
L_x3:
    s_mov_b32 s12, s48
    s_mov_b32 s13, s49
    s_mov_b32 s14, 0x21c000
    s_mov_b32 s15, 0x20000
    s_cmp_eq_u32 s3, 3
    s_cbranch_scc1 L_load_r
    s_cmp_eq_u32 s3, 1
    s_cselect_b32 s12, s50, s12
    s_cselect_b32 s13, s51, s13
    s_cmp_eq_u32 s3, 2
    s_cselect_b32 s12, s52, s12
    s_cselect_b32 s13, s53, s13
    s_mov_b32 s73, 3456
    s_cmov_b32 s73, 256
    s_mov_b32 s75, 256
    s_cmov_b32 s75, 163840
    s_lshr_b32 s6, s2, 3
    s_sub_u32 s6, s6, 16
    s_mul_i32 s6, s6, 40
    v_lshrrev_b32 v2, 2, v1
    v_add_u32 v2, s6, v2
    v_mul_lo_u32 v2, v2, s73
    v_and_b32 v3, 3, v1
    v_lshl_add_u32 v2, v3, 6, v2
    s_lshl_b32 s6, s79, 3
    s_lshr_b32 s7, s4, 2
    s_add_u32 s6, s6, s7
    s_mul_i32 s6, s6, s75
    v_mov_b32 v3, 0x5000000
    v_cmp_gt_u32 vcc, 32, v1
    s_lshl_b32 s73, s73, 4
    s_nop 0
    v_cndmask_b32 v3, v3, v2, vcc
    buffer_load_dword v11, v2, s[12:15], s6 offen
    s_add_u32 s7, s6, s73
    buffer_load_dword v11, v2, s[12:15], s7 offen
    s_add_u32 s7, s7, s73
    buffer_load_dword v11, v3, s[12:15], s7 offen
    s_setpc_b64 s[82:83]
L_mask:
    v_and_b32 v2, 15, v1
    v_lshrrev_b32 v3, 4, v1
    v_lshlrev_b32 v3, 2, v3
    v_sub_u32 v2, v2, v3
    v_mov_b32 v3, 0xff800000
    v_cmp_gt_i32 vcc, 0, v2
    v_mov_b32 v152, v3
    s_nop 0
    v_cndmask_b32 v144, v144, v3, vcc
    v_cndmask_b32 v156, v156, v3, vcc
    v_cmp_gt_i32 vcc, 1, v2
    v_mov_b32 v153, v3
    s_nop 0
    v_cndmask_b32 v145, v145, v3, vcc
    v_cndmask_b32 v157, v157, v3, vcc
    v_cmp_gt_i32 vcc, 2, v2
    v_mov_b32 v154, v3
    s_nop 0
    v_cndmask_b32 v146, v146, v3, vcc
    v_cndmask_b32 v158, v158, v3, vcc
    v_cmp_gt_i32 vcc, 3, v2
    v_mov_b32 v155, v3
    s_nop 0
    v_cndmask_b32 v147, v147, v3, vcc
    v_cndmask_b32 v159, v159, v3, vcc
    s_nop 1
    s_setpc_b64 s[82:83]
L_rare0:
    s_nop 15
    v_max3_f32 v62, 0, v64, v65
    v_max3_f32 v62, v62, v66, v67
    v_max3_f32 v62, v62, v72, v73
    v_max3_f32 v62, v62, v74, v75
    v_mov_b32 v58, v62
    s_nop 1
    v_permlane16_swap_b32 v62, v58
    s_nop 1
    v_max_f32 v62, v62, v58
    v_mov_b32 v58, v62
    s_nop 1
    v_permlane32_swap_b32 v62, v58
    s_nop 1
    v_max_f32 v62, v62, v58
    v_exp_f32 v58, -v62
    v_sub_f32 v64, v64, v62
    v_sub_f32 v80, v80, v62
    v_sub_f32 v144, v144, v62
    v_sub_f32 v65, v65, v62
    v_sub_f32 v81, v81, v62
    v_sub_f32 v145, v145, v62
    v_sub_f32 v66, v66, v62
    v_sub_f32 v82, v82, v62
    v_sub_f32 v146, v146, v62
    v_sub_f32 v67, v67, v62
    v_sub_f32 v83, v83, v62
    v_sub_f32 v147, v147, v62
    v_sub_f32 v72, v72, v62
    v_sub_f32 v88, v88, v62
    v_sub_f32 v152, v152, v62
    v_sub_f32 v73, v73, v62
    v_sub_f32 v89, v89, v62
    v_sub_f32 v153, v153, v62
    v_sub_f32 v74, v74, v62
    v_sub_f32 v90, v90, v62
    v_sub_f32 v154, v154, v62
    v_sub_f32 v75, v75, v62
    v_sub_f32 v91, v91, v62
    v_sub_f32 v155, v155, v62
    v_mul_f32 v56, v58, v56
    v_mul_f32 v192, v58, v192
    v_mul_f32 v193, v58, v193
    v_mul_f32 v194, v58, v194
    v_mul_f32 v195, v58, v195
    v_mul_f32 v200, v58, v200
    v_mul_f32 v201, v58, v201
    v_mul_f32 v202, v58, v202
    v_mul_f32 v203, v58, v203
    v_mul_f32 v208, v58, v208
    v_mul_f32 v209, v58, v209
    v_mul_f32 v210, v58, v210
    v_mul_f32 v211, v58, v211
    v_mul_f32 v216, v58, v216
    v_mul_f32 v217, v58, v217
    v_mul_f32 v218, v58, v218
    v_mul_f32 v219, v58, v219
    v_mul_f32 v224, v58, v224
    v_mul_f32 v225, v58, v225
    v_mul_f32 v226, v58, v226
    v_mul_f32 v227, v58, v227
    v_mul_f32 v232, v58, v232
    v_mul_f32 v233, v58, v233
    v_mul_f32 v234, v58, v234
    v_mul_f32 v235, v58, v235
    v_mul_f32 v240, v58, v240
    v_mul_f32 v241, v58, v241
    v_mul_f32 v242, v58, v242
    v_mul_f32 v243, v58, v243
    v_mul_f32 v248, v58, v248
    v_mul_f32 v249, v58, v249
    v_mul_f32 v250, v58, v250
    v_mul_f32 v251, v58, v251
    v_max3_f32 v62, 0, v68, v69
    v_max3_f32 v62, v62, v70, v71
    v_max3_f32 v62, v62, v76, v77
    v_max3_f32 v62, v62, v78, v79
    v_mov_b32 v58, v62
    s_nop 1
    v_permlane16_swap_b32 v62, v58
    s_nop 1
    v_max_f32 v62, v62, v58
    v_mov_b32 v58, v62
    s_nop 1
    v_permlane32_swap_b32 v62, v58
    s_nop 1
    v_max_f32 v62, v62, v58
    v_exp_f32 v58, -v62
    v_sub_f32 v68, v68, v62
    v_sub_f32 v84, v84, v62
    v_sub_f32 v148, v148, v62
    v_sub_f32 v69, v69, v62
    v_sub_f32 v85, v85, v62
    v_sub_f32 v149, v149, v62
    v_sub_f32 v70, v70, v62
    v_sub_f32 v86, v86, v62
    v_sub_f32 v150, v150, v62
    v_sub_f32 v71, v71, v62
    v_sub_f32 v87, v87, v62
    v_sub_f32 v151, v151, v62
    v_sub_f32 v76, v76, v62
    v_sub_f32 v92, v92, v62
    v_sub_f32 v156, v156, v62
    v_sub_f32 v77, v77, v62
    v_sub_f32 v93, v93, v62
    v_sub_f32 v157, v157, v62
    v_sub_f32 v78, v78, v62
    v_sub_f32 v94, v94, v62
    v_sub_f32 v158, v158, v62
    v_sub_f32 v79, v79, v62
    v_sub_f32 v95, v95, v62
    v_sub_f32 v159, v159, v62
    v_mul_f32 v57, v58, v57
    v_mul_f32 v196, v58, v196
    v_mul_f32 v197, v58, v197
    v_mul_f32 v198, v58, v198
    v_mul_f32 v199, v58, v199
    v_mul_f32 v204, v58, v204
    v_mul_f32 v205, v58, v205
    v_mul_f32 v206, v58, v206
    v_mul_f32 v207, v58, v207
    v_mul_f32 v212, v58, v212
    v_mul_f32 v213, v58, v213
    v_mul_f32 v214, v58, v214
    v_mul_f32 v215, v58, v215
    v_mul_f32 v220, v58, v220
    v_mul_f32 v221, v58, v221
    v_mul_f32 v222, v58, v222
    v_mul_f32 v223, v58, v223
    v_mul_f32 v228, v58, v228
    v_mul_f32 v229, v58, v229
    v_mul_f32 v230, v58, v230
    v_mul_f32 v231, v58, v231
    v_mul_f32 v236, v58, v236
    v_mul_f32 v237, v58, v237
    v_mul_f32 v238, v58, v238
    v_mul_f32 v239, v58, v239
    v_mul_f32 v244, v58, v244
    v_mul_f32 v245, v58, v245
    v_mul_f32 v246, v58, v246
    v_mul_f32 v247, v58, v247
    v_mul_f32 v252, v58, v252
    v_mul_f32 v253, v58, v253
    v_mul_f32 v254, v58, v254
    v_mul_f32 v255, v58, v255
    v_exp_f32 v58, v64
    s_nop 0
    v_exp_f32 v59, v65
    s_nop 0
    v_add_f32 v52, v58, v59
    v_cvt_pk_bf16_f32 v128, v58, v59
    v_exp_f32 v60, v66
    s_nop 0
    v_add_f32 v52, v60, v52
    v_exp_f32 v61, v67
    s_nop 0
    v_add_f32 v52, v61, v52
    v_cvt_pk_bf16_f32 v129, v60, v61
    v_exp_f32 v58, v68
    s_nop 0
    v_exp_f32 v59, v69
    s_nop 0
    v_add_f32 v53, v58, v59
    v_cvt_pk_bf16_f32 v132, v58, v59
    v_exp_f32 v60, v70
    s_nop 0
    v_add_f32 v53, v60, v53
    v_exp_f32 v61, v71
    s_nop 0
    v_add_f32 v53, v61, v53
    v_cvt_pk_bf16_f32 v133, v60, v61
    v_exp_f32 v58, v72
    s_nop 0
    v_add_f32 v52, v58, v52
    v_exp_f32 v59, v73
    s_nop 0
    v_add_f32 v52, v59, v52
    v_cvt_pk_bf16_f32 v130, v58, v59
    v_exp_f32 v60, v74
    s_nop 0
    v_add_f32 v52, v60, v52
    v_exp_f32 v61, v75
    s_nop 0
    v_add_f32 v52, v61, v52
    v_cvt_pk_bf16_f32 v131, v60, v61
    v_exp_f32 v58, v76
    s_nop 0
    v_add_f32 v53, v58, v53
    v_exp_f32 v59, v77
    s_nop 0
    v_add_f32 v53, v59, v53
    v_cvt_pk_bf16_f32 v134, v58, v59
    v_exp_f32 v60, v78
    s_nop 0
    v_add_f32 v53, v60, v53
    v_exp_f32 v61, v79
    s_nop 0
    v_add_f32 v53, v61, v53
    v_cvt_pk_bf16_f32 v135, v60, v61
    s_nop 1
    s_setpc_b64 s[80:81]
L_rare1:
    s_nop 15
    v_max3_f32 v62, 0, v80, v81
    v_max3_f32 v62, v62, v82, v83
    v_max3_f32 v62, v62, v88, v89
    v_max3_f32 v62, v62, v90, v91
    v_mov_b32 v58, v62
    s_nop 1
    v_permlane16_swap_b32 v62, v58
    s_nop 1
    v_max_f32 v62, v62, v58
    v_mov_b32 v58, v62
    s_nop 1
    v_permlane32_swap_b32 v62, v58
    s_nop 1
    v_max_f32 v62, v62, v58
    v_exp_f32 v58, -v62
    v_sub_f32 v64, v64, v62
    v_sub_f32 v80, v80, v62
    v_sub_f32 v144, v144, v62
    v_sub_f32 v65, v65, v62
    v_sub_f32 v81, v81, v62
    v_sub_f32 v145, v145, v62
    v_sub_f32 v66, v66, v62
    v_sub_f32 v82, v82, v62
    v_sub_f32 v146, v146, v62
    v_sub_f32 v67, v67, v62
    v_sub_f32 v83, v83, v62
    v_sub_f32 v147, v147, v62
    v_sub_f32 v72, v72, v62
    v_sub_f32 v88, v88, v62
    v_sub_f32 v152, v152, v62
    v_sub_f32 v73, v73, v62
    v_sub_f32 v89, v89, v62
    v_sub_f32 v153, v153, v62
    v_sub_f32 v74, v74, v62
    v_sub_f32 v90, v90, v62
    v_sub_f32 v154, v154, v62
    v_sub_f32 v75, v75, v62
    v_sub_f32 v91, v91, v62
    v_sub_f32 v155, v155, v62
    v_mul_f32 v56, v58, v56
    v_mul_f32 v192, v58, v192
    v_mul_f32 v193, v58, v193
    v_mul_f32 v194, v58, v194
    v_mul_f32 v195, v58, v195
    v_mul_f32 v200, v58, v200
    v_mul_f32 v201, v58, v201
    v_mul_f32 v202, v58, v202
    v_mul_f32 v203, v58, v203
    v_mul_f32 v208, v58, v208
    v_mul_f32 v209, v58, v209
    v_mul_f32 v210, v58, v210
    v_mul_f32 v211, v58, v211
    v_mul_f32 v216, v58, v216
    v_mul_f32 v217, v58, v217
    v_mul_f32 v218, v58, v218
    v_mul_f32 v219, v58, v219
    v_mul_f32 v224, v58, v224
    v_mul_f32 v225, v58, v225
    v_mul_f32 v226, v58, v226
    v_mul_f32 v227, v58, v227
    v_mul_f32 v232, v58, v232
    v_mul_f32 v233, v58, v233
    v_mul_f32 v234, v58, v234
    v_mul_f32 v235, v58, v235
    v_mul_f32 v240, v58, v240
    v_mul_f32 v241, v58, v241
    v_mul_f32 v242, v58, v242
    v_mul_f32 v243, v58, v243
    v_mul_f32 v248, v58, v248
    v_mul_f32 v249, v58, v249
    v_mul_f32 v250, v58, v250
    v_mul_f32 v251, v58, v251
    v_max3_f32 v62, 0, v84, v85
    v_max3_f32 v62, v62, v86, v87
    v_max3_f32 v62, v62, v92, v93
    v_max3_f32 v62, v62, v94, v95
    v_mov_b32 v58, v62
    s_nop 1
    v_permlane16_swap_b32 v62, v58
    s_nop 1
    v_max_f32 v62, v62, v58
    v_mov_b32 v58, v62
    s_nop 1
    v_permlane32_swap_b32 v62, v58
    s_nop 1
    v_max_f32 v62, v62, v58
    v_exp_f32 v58, -v62
    v_sub_f32 v68, v68, v62
    v_sub_f32 v84, v84, v62
    v_sub_f32 v148, v148, v62
    v_sub_f32 v69, v69, v62
    v_sub_f32 v85, v85, v62
    v_sub_f32 v149, v149, v62
    v_sub_f32 v70, v70, v62
    v_sub_f32 v86, v86, v62
    v_sub_f32 v150, v150, v62
    v_sub_f32 v71, v71, v62
    v_sub_f32 v87, v87, v62
    v_sub_f32 v151, v151, v62
    v_sub_f32 v76, v76, v62
    v_sub_f32 v92, v92, v62
    v_sub_f32 v156, v156, v62
    v_sub_f32 v77, v77, v62
    v_sub_f32 v93, v93, v62
    v_sub_f32 v157, v157, v62
    v_sub_f32 v78, v78, v62
    v_sub_f32 v94, v94, v62
    v_sub_f32 v158, v158, v62
    v_sub_f32 v79, v79, v62
    v_sub_f32 v95, v95, v62
    v_sub_f32 v159, v159, v62
    v_mul_f32 v57, v58, v57
    v_mul_f32 v196, v58, v196
    v_mul_f32 v197, v58, v197
    v_mul_f32 v198, v58, v198
    v_mul_f32 v199, v58, v199
    v_mul_f32 v204, v58, v204
    v_mul_f32 v205, v58, v205
    v_mul_f32 v206, v58, v206
    v_mul_f32 v207, v58, v207
    v_mul_f32 v212, v58, v212
    v_mul_f32 v213, v58, v213
    v_mul_f32 v214, v58, v214
    v_mul_f32 v215, v58, v215
    v_mul_f32 v220, v58, v220
    v_mul_f32 v221, v58, v221
    v_mul_f32 v222, v58, v222
    v_mul_f32 v223, v58, v223
    v_mul_f32 v228, v58, v228
    v_mul_f32 v229, v58, v229
    v_mul_f32 v230, v58, v230
    v_mul_f32 v231, v58, v231
    v_mul_f32 v236, v58, v236
    v_mul_f32 v237, v58, v237
    v_mul_f32 v238, v58, v238
    v_mul_f32 v239, v58, v239
    v_mul_f32 v244, v58, v244
    v_mul_f32 v245, v58, v245
    v_mul_f32 v246, v58, v246
    v_mul_f32 v247, v58, v247
    v_mul_f32 v252, v58, v252
    v_mul_f32 v253, v58, v253
    v_mul_f32 v254, v58, v254
    v_mul_f32 v255, v58, v255
    v_exp_f32 v58, v80
    s_nop 0
    v_exp_f32 v59, v81
    s_nop 0
    v_add_f32 v54, v58, v59
    v_cvt_pk_bf16_f32 v136, v58, v59
    v_exp_f32 v60, v82
    s_nop 0
    v_add_f32 v54, v60, v54
    v_exp_f32 v61, v83
    s_nop 0
    v_add_f32 v54, v61, v54
    v_cvt_pk_bf16_f32 v137, v60, v61
    v_exp_f32 v58, v84
    s_nop 0
    v_exp_f32 v59, v85
    s_nop 0
    v_add_f32 v55, v58, v59
    v_cvt_pk_bf16_f32 v140, v58, v59
    v_exp_f32 v60, v86
    s_nop 0
    v_add_f32 v55, v60, v55
    v_exp_f32 v61, v87
    s_nop 0
    v_add_f32 v55, v61, v55
    v_cvt_pk_bf16_f32 v141, v60, v61
    v_exp_f32 v58, v88
    s_nop 0
    v_add_f32 v54, v58, v54
    v_exp_f32 v59, v89
    s_nop 0
    v_add_f32 v54, v59, v54
    v_cvt_pk_bf16_f32 v138, v58, v59
    v_exp_f32 v60, v90
    s_nop 0
    v_add_f32 v54, v60, v54
    v_exp_f32 v61, v91
    s_nop 0
    v_add_f32 v54, v61, v54
    v_cvt_pk_bf16_f32 v139, v60, v61
    v_exp_f32 v58, v92
    s_nop 0
    v_add_f32 v55, v58, v55
    v_exp_f32 v59, v93
    s_nop 0
    v_add_f32 v55, v59, v55
    v_cvt_pk_bf16_f32 v142, v58, v59
    v_exp_f32 v60, v94
    s_nop 0
    v_add_f32 v55, v60, v55
    v_exp_f32 v61, v95
    s_nop 0
    v_add_f32 v55, v61, v55
    v_cvt_pk_bf16_f32 v143, v60, v61
    s_nop 1
    s_setpc_b64 s[80:81]
L_adone:
    s_barrier
    ds_read_b128 v[16:19], v4 offset:0
    ds_read_b128 v[20:23], v4 offset:1024
    ds_read_b128 v[24:27], v4 offset:2048
    ds_read_b128 v[28:31], v4 offset:3072
    s_waitcnt lgkmcnt(3)
    v_mfma_f32_16x16x32_bf16 v[56:59], v[96:99], v[16:19], 0
    v_mfma_f32_16x16x32_bf16 v[60:63], v[100:103], v[16:19], 0
    v_mfma_f32_16x16x32_bf16 v[64:67], v[104:107], v[16:19], 0
    v_mfma_f32_16x16x32_bf16 v[68:71], v[108:111], v[16:19], 0
    v_mfma_f32_16x16x32_bf16 v[72:75], v[112:115], v[16:19], 0
    ds_read_b128 v[16:19], v4 offset:4096
    s_cmp_lt_u32 s3, 4
    s_cbranch_scc1 L_nowl_51
    s_add_u32 s75, s69, 204800
    buffer_load_dwordx4 v[196:199], v44, s[8:11], s75 offen sc1
    buffer_load_dwordx4 v[200:203], v45, s[8:11], s75 offen sc1
    buffer_load_dwordx4 v[204:207], v46, s[8:11], s75 offen sc1
    buffer_load_dwordx4 v[208:211], v47, s[8:11], s75 offen sc1
    buffer_load_dwordx4 v[212:215], v52, s[8:11], s75 offen sc1
L_nowl_51:
    s_waitcnt lgkmcnt(3)
    v_mfma_f32_16x16x32_bf16 v[56:59], v[116:119], v[20:23], v[56:59]
    v_mfma_f32_16x16x32_bf16 v[60:63], v[120:123], v[20:23], v[60:63]
    v_mfma_f32_16x16x32_bf16 v[64:67], v[124:127], v[20:23], v[64:67]
    v_mfma_f32_16x16x32_bf16 v[68:71], v[128:131], v[20:23], v[68:71]
    v_mfma_f32_16x16x32_bf16 v[72:75], v[132:135], v[20:23], v[72:75]
    ds_read_b128 v[20:23], v4 offset:5120
    s_cmp_lt_u32 s3, 4
    s_cbranch_scc1 L_nowl_52
    s_add_u32 s75, s69, 245760
    buffer_load_dwordx4 v[216:219], v44, s[8:11], s75 offen sc1
    buffer_load_dwordx4 v[220:223], v45, s[8:11], s75 offen sc1
    buffer_load_dwordx4 v[224:227], v46, s[8:11], s75 offen sc1
    buffer_load_dwordx4 v[228:231], v47, s[8:11], s75 offen sc1
    buffer_load_dwordx4 v[232:235], v52, s[8:11], s75 offen sc1
L_nowl_52:
    s_waitcnt lgkmcnt(3)
    v_mfma_f32_16x16x32_bf16 v[56:59], v[136:139], v[24:27], v[56:59]
    v_mfma_f32_16x16x32_bf16 v[60:63], v[140:143], v[24:27], v[60:63]
    v_mfma_f32_16x16x32_bf16 v[64:67], v[144:147], v[24:27], v[64:67]
    v_mfma_f32_16x16x32_bf16 v[68:71], v[148:151], v[24:27], v[68:71]
    v_mfma_f32_16x16x32_bf16 v[72:75], v[152:155], v[24:27], v[72:75]
    ds_read_b128 v[24:27], v4 offset:6144
    s_cmp_lt_u32 s3, 4
    s_cbranch_scc1 L_nowl_53
    s_add_u32 s75, s69, 286720
    buffer_load_dwordx4 v[236:239], v44, s[8:11], s75 offen sc1
    buffer_load_dwordx4 v[240:243], v45, s[8:11], s75 offen sc1
    buffer_load_dwordx4 v[244:247], v46, s[8:11], s75 offen sc1
    buffer_load_dwordx4 v[248:251], v47, s[8:11], s75 offen sc1
    buffer_load_dwordx4 v[252:255], v52, s[8:11], s75 offen sc1
L_nowl_53:
    s_waitcnt lgkmcnt(3)
    v_mfma_f32_16x16x32_bf16 v[56:59], v[156:159], v[28:31], v[56:59]
    s_add_u32 s65, s68, 3
    s_and_b32 s65, s65, 3
    s_andn2_b32 s7, s68, 3
    s_add_u32 s65, s65, s7
    s_lshl_b32 s65, s65, 17
    s_add_u32 s65, s65, s66
    s_add_u32 m0, s99, 65536
    s_add_u32 s65, s65, 0
    buffer_load_dwordx4 v13, s[8:11], s65 offen offset:0 sc1 lds
    v_mfma_f32_16x16x32_bf16 v[60:63], v[160:163], v[28:31], v[60:63]
    buffer_load_dwordx4 v13, s[8:11], s65 offen offset:1024 sc1 lds
    v_mfma_f32_16x16x32_bf16 v[64:67], v[164:167], v[28:31], v[64:67]
    buffer_load_dwordx4 v13, s[8:11], s65 offen offset:2048 sc1 lds
    v_mfma_f32_16x16x32_bf16 v[68:71], v[168:171], v[28:31], v[68:71]
    buffer_load_dwordx4 v13, s[8:11], s65 offen offset:3072 sc1 lds
    v_mfma_f32_16x16x32_bf16 v[72:75], v[172:175], v[28:31], v[72:75]
    ds_read_b128 v[28:31], v4 offset:7168
    s_waitcnt vmcnt(20)
    s_waitcnt lgkmcnt(3)
    v_mfma_f32_16x16x32_bf16 v[56:59], v[176:179], v[16:19], v[56:59]
    v_mfma_f32_16x16x32_bf16 v[60:63], v[180:183], v[16:19], v[60:63]
    v_mfma_f32_16x16x32_bf16 v[64:67], v[184:187], v[16:19], v[64:67]
    v_mfma_f32_16x16x32_bf16 v[68:71], v[188:191], v[16:19], v[68:71]
    v_mfma_f32_16x16x32_bf16 v[72:75], v[192:195], v[16:19], v[72:75]
    s_waitcnt vmcnt(14)
    s_waitcnt lgkmcnt(2)
    v_mfma_f32_16x16x32_bf16 v[56:59], v[196:199], v[20:23], v[56:59]
    v_mfma_f32_16x16x32_bf16 v[60:63], v[200:203], v[20:23], v[60:63]
    v_mfma_f32_16x16x32_bf16 v[64:67], v[204:207], v[20:23], v[64:67]
    v_mfma_f32_16x16x32_bf16 v[68:71], v[208:211], v[20:23], v[68:71]
    v_mfma_f32_16x16x32_bf16 v[72:75], v[212:215], v[20:23], v[72:75]
    s_cmp_ge_u32 s3, 4
    s_cbranch_scc1 L_o0
    s_waitcnt vmcnt(4)
L_o0:
    s_waitcnt lgkmcnt(0)
    s_barrier
    ds_read_b128 v[16:19], v4 offset:32768
    ds_read_b128 v[20:23], v4 offset:33792
    s_waitcnt vmcnt(9)
    v_mfma_f32_16x16x32_bf16 v[56:59], v[216:219], v[24:27], v[56:59]
    v_mfma_f32_16x16x32_bf16 v[60:63], v[220:223], v[24:27], v[60:63]
    v_mfma_f32_16x16x32_bf16 v[64:67], v[224:227], v[24:27], v[64:67]
    v_mfma_f32_16x16x32_bf16 v[68:71], v[228:231], v[24:27], v[68:71]
    v_mfma_f32_16x16x32_bf16 v[72:75], v[232:235], v[24:27], v[72:75]
    ds_read_b128 v[24:27], v4 offset:34816
    s_waitcnt vmcnt(4)
    v_mfma_f32_16x16x32_bf16 v[56:59], v[236:239], v[28:31], v[56:59]
    v_mfma_f32_16x16x32_bf16 v[60:63], v[240:243], v[28:31], v[60:63]
    v_mfma_f32_16x16x32_bf16 v[64:67], v[244:247], v[28:31], v[64:67]
    v_mfma_f32_16x16x32_bf16 v[68:71], v[248:251], v[28:31], v[68:71]
    v_mfma_f32_16x16x32_bf16 v[72:75], v[252:255], v[28:31], v[72:75]
    ds_read_b128 v[28:31], v4 offset:35840
    s_waitcnt lgkmcnt(3)
    v_mfma_f32_16x16x32_bf16 v[76:79], v[96:99], v[16:19], 0
    v_mfma_f32_16x16x32_bf16 v[80:83], v[100:103], v[16:19], 0
    s_sub_u32 s6, s71, 1
    s_and_b32 s6, s6, 3
    s_mul_i32 s7, s6, 5120
    v_mfma_f32_16x16x32_bf16 v[84:87], v[104:107], v[16:19], 0
    s_add_u32 s7, s7, s67
    s_cmp_eq_u32 s6, 3
    s_cselect_b32 s7, 155648, s7
    v_mfma_f32_16x16x32_bf16 v[88:91], v[108:111], v[16:19], 0
    v_add_u32 v12, s7, v52
    v_mfma_f32_16x16x32_bf16 v[92:95], v[112:115], v[16:19], 0
    v_add_u32 v5, s67, v45
    ds_read_b128 v[16:19], v4 offset:36864
    s_waitcnt lgkmcnt(3)
    v_mfma_f32_16x16x32_bf16 v[76:79], v[116:119], v[20:23], v[76:79]
    ds_write_b128 v5, v[60:63] offset:0
    v_add_u32 v5, s67, v46
    v_mfma_f32_16x16x32_bf16 v[80:83], v[120:123], v[20:23], v[80:83]
    v_mfma_f32_16x16x32_bf16 v[84:87], v[124:127], v[20:23], v[84:87]
    v_mfma_f32_16x16x32_bf16 v[88:91], v[128:131], v[20:23], v[88:91]
    v_mfma_f32_16x16x32_bf16 v[92:95], v[132:135], v[20:23], v[92:95]
    ds_read_b128 v[20:23], v4 offset:37888
    s_waitcnt lgkmcnt(4)
    v_mfma_f32_16x16x32_bf16 v[76:79], v[136:139], v[24:27], v[76:79]
    ds_write_b128 v5, v[64:67] offset:5120
    v_add_u32 v5, s67, v47
    v_mfma_f32_16x16x32_bf16 v[80:83], v[140:143], v[24:27], v[80:83]
    v_mfma_f32_16x16x32_bf16 v[84:87], v[144:147], v[24:27], v[84:87]
    v_mfma_f32_16x16x32_bf16 v[88:91], v[148:151], v[24:27], v[88:91]
    v_mfma_f32_16x16x32_bf16 v[92:95], v[152:155], v[24:27], v[92:95]
    ds_read_b128 v[24:27], v4 offset:38912
    s_cmp_ge_u32 s3, 4
    s_cbranch_scc1 L_o1a
    v_and_b32 v3, 1, v1
    v_lshlrev_b32 v3, 12, v3
    v_and_b32 v2, 2, v1
    v_lshl_add_u32 v3, v2, 8, v3
    s_lshr_b32 s72, s61, 2
    s_lshl_b32 s72, s72, 6
    s_andn2_b32 s6, s4, 7
    s_add_u32 s72, s72, s6
    s_add_u32 s72, s72, s76
    s_lshl_b32 s72, s72, 7
    s_add_u32 s72, s72, 3932160
    buffer_load_dword v50, v3, s[8:11], s72 offen sc1
L_o1a:
    s_waitcnt lgkmcnt(5)
    v_mfma_f32_16x16x32_bf16 v[76:79], v[156:159], v[28:31], v[76:79]
    ds_write_b128 v5, v[68:71] offset:10240
    v_add_u32 v5, s67, v52
    v_mfma_f32_16x16x32_bf16 v[80:83], v[160:163], v[28:31], v[80:83]
    v_mfma_f32_16x16x32_bf16 v[84:87], v[164:167], v[28:31], v[84:87]
    v_mfma_f32_16x16x32_bf16 v[88:91], v[168:171], v[28:31], v[88:91]
    v_mfma_f32_16x16x32_bf16 v[92:95], v[172:175], v[28:31], v[92:95]
    ds_read_b128 v[28:31], v4 offset:39936
    s_waitcnt lgkmcnt(6)
    v_mfma_f32_16x16x32_bf16 v[76:79], v[176:179], v[16:19], v[76:79]
    ds_write_b128 v12, v[72:75] offset:0
    v_mfma_f32_16x16x32_bf16 v[80:83], v[180:183], v[16:19], v[80:83]
    v_mfma_f32_16x16x32_bf16 v[84:87], v[184:187], v[16:19], v[84:87]
    v_mfma_f32_16x16x32_bf16 v[88:91], v[188:191], v[16:19], v[88:91]
    v_mfma_f32_16x16x32_bf16 v[92:95], v[192:195], v[16:19], v[92:95]
    s_waitcnt lgkmcnt(5)
    v_mfma_f32_16x16x32_bf16 v[76:79], v[196:199], v[20:23], v[76:79]
    v_mfma_f32_16x16x32_bf16 v[80:83], v[200:203], v[20:23], v[80:83]
    v_mfma_f32_16x16x32_bf16 v[84:87], v[204:207], v[20:23], v[84:87]
    v_mfma_f32_16x16x32_bf16 v[88:91], v[208:211], v[20:23], v[88:91]
    v_mfma_f32_16x16x32_bf16 v[92:95], v[212:215], v[20:23], v[92:95]
    s_waitcnt vmcnt(0)
    s_cmp_ge_u32 s3, 4
    s_cbranch_scc1 L_o1
    v_cmp_ne_u32 vcc, 1, v50
    s_cbranch_vccz L_o1
    s_mov_b32 s79, 262144
L_poll_54:
    buffer_load_dword v2, v3, s[8:11], s72 offen sc1
    s_waitcnt vmcnt(0)
    v_cmp_ne_u32 vcc, 1, v2
    s_cbranch_vccz L_polldone_55
    s_sleep 1
    s_sub_u32 s79, s79, 1
    s_cmp_lg_u32 s79, 0
    s_cbranch_scc1 L_poll_54
L_polldone_55:
L_o1:
    s_waitcnt lgkmcnt(0)
    s_barrier
    ds_read_b128 v[32:35], v6 offset:0
    ds_read_b128 v[36:39], v6 offset:5120
    ds_read_b128 v[40:43], v6 offset:10240
    ds_read_b128 v[16:19], v7 offset:0
    ds_read_b128 v[20:23], v7 offset:1024
    s_add_u32 s65, s61, 1
    s_and_b32 s65, s65, 3
    s_andn2_b32 s7, s61, 3
    s_add_u32 s65, s65, s7
    s_lshl_b32 s65, s65, 17
    s_add_u32 s65, s65, s66
    s_add_u32 m0, s99, 0
    s_add_u32 s65, s65, 0
    buffer_load_dwordx4 v13, s[8:11], s65 offen offset:0 sc1 lds
    buffer_load_dwordx4 v13, s[8:11], s65 offen offset:1024 sc1 lds
    buffer_load_dwordx4 v13, s[8:11], s65 offen offset:2048 sc1 lds
    buffer_load_dwordx4 v13, s[8:11], s65 offen offset:3072 sc1 lds
    v_mfma_f32_16x16x32_bf16 v[76:79], v[216:219], v[24:27], v[76:79]
    s_add_u32 s65, s61, 2
    s_and_b32 s65, s65, 3
    s_andn2_b32 s7, s61, 3
    s_add_u32 s65, s65, s7
    s_lshl_b32 s65, s65, 17
    s_add_u32 s65, s65, s66
    s_add_u32 m0, s99, 32768
    s_add_u32 s65, s65, 0
    buffer_load_dwordx4 v13, s[8:11], s65 offen offset:0 sc1 lds
    v_mfma_f32_16x16x32_bf16 v[80:83], v[220:223], v[24:27], v[80:83]
    buffer_load_dwordx4 v13, s[8:11], s65 offen offset:1024 sc1 lds
    s_waitcnt lgkmcnt(2)
    v_mfma_f32_16x16x32_bf16 v[84:87], v[224:227], v[24:27], v[84:87]
    v_add_f32 v56, v56, v32
    v_add_f32 v57, v57, v33
    v_add_f32 v58, v58, v34
    v_add_f32 v59, v59, v35
    v_mfma_f32_16x16x32_bf16 v[88:91], v[228:231], v[24:27], v[88:91]
    v_add_f32 v56, v56, v36
    v_add_f32 v57, v57, v37
    v_add_f32 v58, v58, v38
    v_add_f32 v59, v59, v39
    v_mfma_f32_16x16x32_bf16 v[92:95], v[232:235], v[24:27], v[92:95]
    v_add_f32 v56, v56, v40
    v_add_f32 v57, v57, v41
    v_add_f32 v58, v58, v42
    v_add_f32 v59, v59, v43
    ds_read_b128 v[32:35], v5 offset:0
    ds_read_b128 v[36:39], v5 offset:5120
    ds_read_b128 v[40:43], v5 offset:10240
    ds_read_b128 v[24:27], v7 offset:2048
    v_mfma_f32_16x16x32_bf16 v[76:79], v[236:239], v[28:31], v[76:79]
    buffer_load_dwordx4 v13, s[8:11], s65 offen offset:2048 sc1 lds
    s_add_u32 s6, s96, 0
    v_mfma_f32_16x16x32_bf16 v[80:83], v[240:243], v[28:31], v[80:83]
    buffer_load_dwordx4 v13, s[8:11], s65 offen offset:3072 sc1 lds
    s_waitcnt lgkmcnt(1)
    v_mfma_f32_16x16x32_bf16 v[84:87], v[244:247], v[28:31], v[84:87]
    v_add_f32 v72, v72, v32
    v_add_f32 v73, v73, v33
    v_add_f32 v74, v74, v34
    v_add_f32 v75, v75, v35
    v_mfma_f32_16x16x32_bf16 v[88:91], v[248:251], v[28:31], v[88:91]
    v_add_f32 v72, v72, v36
    v_add_f32 v73, v73, v37
    v_add_f32 v74, v74, v38
    v_add_f32 v75, v75, v39
    v_mfma_f32_16x16x32_bf16 v[92:95], v[252:255], v[28:31], v[92:95]
    v_add_f32 v72, v72, v40
    v_add_f32 v73, v73, v41
    v_add_f32 v74, v74, v42
    v_add_f32 v75, v75, v43
    buffer_store_dwordx4 v[56:59], v44, s[8:11], s6 offen sc1
    s_cmp_lg_u32 s71, 0
    s_cbranch_scc1 L_nost_56
    buffer_store_dwordx4 v[72:75], v52, s[8:11], s6 offen sc1
L_nost_56:
    s_nop 0
    ds_read_b128 v[28:31], v7 offset:3072
    v_mfma_f32_16x16x32_bf16 v[56:59], v[96:99], v[16:19], 0
    v_mfma_f32_16x16x32_bf16 v[60:63], v[100:103], v[16:19], 0
    s_sub_u32 s6, s71, 2
    s_and_b32 s6, s6, 3
    s_mul_i32 s7, s6, 5120
    v_mfma_f32_16x16x32_bf16 v[64:67], v[104:107], v[16:19], 0
    s_add_u32 s7, s7, s67
    s_cmp_eq_u32 s6, 3
    s_cselect_b32 s7, 124928, s7
    v_mfma_f32_16x16x32_bf16 v[68:71], v[108:111], v[16:19], 0
    v_add_u32 v12, s7, v52
    v_mfma_f32_16x16x32_bf16 v[72:75], v[112:115], v[16:19], 0
    v_add_u32 v5, s67, v45
    ds_read_b128 v[16:19], v7 offset:4096
    v_mfma_f32_16x16x32_bf16 v[56:59], v[116:119], v[20:23], v[56:59]
    ds_write_b128 v5, v[80:83] offset:30720
    v_add_u32 v5, s67, v46
    v_mfma_f32_16x16x32_bf16 v[60:63], v[120:123], v[20:23], v[60:63]
    v_mfma_f32_16x16x32_bf16 v[64:67], v[124:127], v[20:23], v[64:67]
    v_mfma_f32_16x16x32_bf16 v[68:71], v[128:131], v[20:23], v[68:71]
    v_mfma_f32_16x16x32_bf16 v[72:75], v[132:135], v[20:23], v[72:75]
    ds_read_b128 v[20:23], v7 offset:5120
    s_waitcnt lgkmcnt(4)
    v_mfma_f32_16x16x32_bf16 v[56:59], v[136:139], v[24:27], v[56:59]
    ds_write_b128 v5, v[84:87] offset:35840
    v_add_u32 v5, s67, v47
    v_mfma_f32_16x16x32_bf16 v[60:63], v[140:143], v[24:27], v[60:63]
    v_mfma_f32_16x16x32_bf16 v[64:67], v[144:147], v[24:27], v[64:67]
    v_mfma_f32_16x16x32_bf16 v[68:71], v[148:151], v[24:27], v[68:71]
    v_mfma_f32_16x16x32_bf16 v[72:75], v[152:155], v[24:27], v[72:75]
    ds_read_b128 v[24:27], v7 offset:6144
    s_waitcnt lgkmcnt(5)
    v_mfma_f32_16x16x32_bf16 v[56:59], v[156:159], v[28:31], v[56:59]
    ds_write_b128 v5, v[88:91] offset:40960
    v_add_u32 v5, s67, v52
    v_mfma_f32_16x16x32_bf16 v[60:63], v[160:163], v[28:31], v[60:63]
    v_mfma_f32_16x16x32_bf16 v[64:67], v[164:167], v[28:31], v[64:67]
    v_mfma_f32_16x16x32_bf16 v[68:71], v[168:171], v[28:31], v[68:71]
    v_mfma_f32_16x16x32_bf16 v[72:75], v[172:175], v[28:31], v[72:75]
    ds_read_b128 v[28:31], v7 offset:7168
    s_waitcnt lgkmcnt(6)
    v_mfma_f32_16x16x32_bf16 v[56:59], v[176:179], v[16:19], v[56:59]
    ds_write_b128 v12, v[92:95] offset:30720
    v_mfma_f32_16x16x32_bf16 v[60:63], v[180:183], v[16:19], v[60:63]
    v_mfma_f32_16x16x32_bf16 v[64:67], v[184:187], v[16:19], v[64:67]
    v_mfma_f32_16x16x32_bf16 v[68:71], v[188:191], v[16:19], v[68:71]
    v_mfma_f32_16x16x32_bf16 v[72:75], v[192:195], v[16:19], v[72:75]
    s_waitcnt lgkmcnt(5)
    v_mfma_f32_16x16x32_bf16 v[56:59], v[196:199], v[20:23], v[56:59]
    v_mfma_f32_16x16x32_bf16 v[60:63], v[200:203], v[20:23], v[60:63]
    v_mfma_f32_16x16x32_bf16 v[64:67], v[204:207], v[20:23], v[64:67]
    v_mfma_f32_16x16x32_bf16 v[68:71], v[208:211], v[20:23], v[68:71]
    v_mfma_f32_16x16x32_bf16 v[72:75], v[212:215], v[20:23], v[72:75]
    s_waitcnt vmcnt(5)
    s_waitcnt lgkmcnt(0)
    s_barrier
    ds_read_b128 v[32:35], v6 offset:30720
    ds_read_b128 v[36:39], v6 offset:35840
    ds_read_b128 v[40:43], v6 offset:40960
    ds_read_b128 v[16:19], v4 offset:0
    ds_read_b128 v[20:23], v4 offset:1024
    v_mfma_f32_16x16x32_bf16 v[56:59], v[216:219], v[24:27], v[56:59]
    s_add_u32 s65, s61, 3
    s_and_b32 s65, s65, 3
    s_andn2_b32 s7, s61, 3
    s_add_u32 s65, s65, s7
    s_lshl_b32 s65, s65, 17
    s_add_u32 s65, s65, s66
    s_add_u32 m0, s99, 65536
    s_add_u32 s65, s65, 0
    buffer_load_dwordx4 v13, s[8:11], s65 offen offset:0 sc1 lds
    v_mfma_f32_16x16x32_bf16 v[60:63], v[220:223], v[24:27], v[60:63]
    buffer_load_dwordx4 v13, s[8:11], s65 offen offset:1024 sc1 lds
    s_waitcnt lgkmcnt(2)
    v_mfma_f32_16x16x32_bf16 v[64:67], v[224:227], v[24:27], v[64:67]
    v_add_f32 v76, v76, v32
    v_add_f32 v77, v77, v33
    v_add_f32 v78, v78, v34
    v_add_f32 v79, v79, v35
    v_mfma_f32_16x16x32_bf16 v[68:71], v[228:231], v[24:27], v[68:71]
    v_add_f32 v76, v76, v36
    v_add_f32 v77, v77, v37
    v_add_f32 v78, v78, v38
    v_add_f32 v79, v79, v39
    v_mfma_f32_16x16x32_bf16 v[72:75], v[232:235], v[24:27], v[72:75]
    v_add_f32 v76, v76, v40
    v_add_f32 v77, v77, v41
    v_add_f32 v78, v78, v42
    v_add_f32 v79, v79, v43
    ds_read_b128 v[32:35], v5 offset:30720
    ds_read_b128 v[36:39], v5 offset:35840
    ds_read_b128 v[40:43], v5 offset:40960
    ds_read_b128 v[24:27], v4 offset:2048
    v_mfma_f32_16x16x32_bf16 v[56:59], v[236:239], v[28:31], v[56:59]
    buffer_load_dwordx4 v13, s[8:11], s65 offen offset:2048 sc1 lds
    s_add_u32 s6, s97, 0
    v_mfma_f32_16x16x32_bf16 v[60:63], v[240:243], v[28:31], v[60:63]
    buffer_load_dwordx4 v13, s[8:11], s65 offen offset:3072 sc1 lds
    s_waitcnt lgkmcnt(1)
    v_mfma_f32_16x16x32_bf16 v[64:67], v[244:247], v[28:31], v[64:67]
    v_add_f32 v92, v92, v32
    v_add_f32 v93, v93, v33
    v_add_f32 v94, v94, v34
    v_add_f32 v95, v95, v35
    v_mfma_f32_16x16x32_bf16 v[68:71], v[248:251], v[28:31], v[68:71]
    v_add_f32 v92, v92, v36
    v_add_f32 v93, v93, v37
    v_add_f32 v94, v94, v38
    v_add_f32 v95, v95, v39
    v_mfma_f32_16x16x32_bf16 v[72:75], v[252:255], v[28:31], v[72:75]
    v_add_f32 v92, v92, v40
    v_add_f32 v93, v93, v41
    v_add_f32 v94, v94, v42
    v_add_f32 v95, v95, v43
    buffer_store_dwordx4 v[76:79], v44, s[8:11], s6 offen sc1
    s_cmp_lg_u32 s71, 1
    s_cbranch_scc1 L_nost_57
    buffer_store_dwordx4 v[92:95], v52, s[8:11], s6 offen sc1
L_nost_57:
    s_nop 0
    ds_read_b128 v[28:31], v4 offset:3072
    v_mfma_f32_16x16x32_bf16 v[76:79], v[96:99], v[16:19], 0
    v_mfma_f32_16x16x32_bf16 v[80:83], v[100:103], v[16:19], 0
    s_sub_u32 s6, s71, 3
    s_and_b32 s6, s6, 3
    s_mul_i32 s7, s6, 5120
    v_mfma_f32_16x16x32_bf16 v[84:87], v[104:107], v[16:19], 0
    s_add_u32 s7, s7, s67
    s_cmp_eq_u32 s6, 3
    s_cselect_b32 s7, 155648, s7
    v_mfma_f32_16x16x32_bf16 v[88:91], v[108:111], v[16:19], 0
    v_add_u32 v12, s7, v52
    v_mfma_f32_16x16x32_bf16 v[92:95], v[112:115], v[16:19], 0
    v_add_u32 v5, s67, v45
    ds_read_b128 v[16:19], v4 offset:4096
    v_mfma_f32_16x16x32_bf16 v[76:79], v[116:119], v[20:23], v[76:79]
    ds_write_b128 v5, v[60:63] offset:0
    v_add_u32 v5, s67, v46
    v_mfma_f32_16x16x32_bf16 v[80:83], v[120:123], v[20:23], v[80:83]
    v_mfma_f32_16x16x32_bf16 v[84:87], v[124:127], v[20:23], v[84:87]
    v_mfma_f32_16x16x32_bf16 v[88:91], v[128:131], v[20:23], v[88:91]
    v_mfma_f32_16x16x32_bf16 v[92:95], v[132:135], v[20:23], v[92:95]
    ds_read_b128 v[20:23], v4 offset:5120
    s_waitcnt lgkmcnt(4)
    v_mfma_f32_16x16x32_bf16 v[76:79], v[136:139], v[24:27], v[76:79]
    ds_write_b128 v5, v[64:67] offset:5120
    v_add_u32 v5, s67, v47
    v_mfma_f32_16x16x32_bf16 v[80:83], v[140:143], v[24:27], v[80:83]
    v_mfma_f32_16x16x32_bf16 v[84:87], v[144:147], v[24:27], v[84:87]
    v_mfma_f32_16x16x32_bf16 v[88:91], v[148:151], v[24:27], v[88:91]
    v_mfma_f32_16x16x32_bf16 v[92:95], v[152:155], v[24:27], v[92:95]
    ds_read_b128 v[24:27], v4 offset:6144
    s_waitcnt lgkmcnt(5)
    v_mfma_f32_16x16x32_bf16 v[76:79], v[156:159], v[28:31], v[76:79]
    ds_write_b128 v5, v[68:71] offset:10240
    v_add_u32 v5, s67, v52
    v_mfma_f32_16x16x32_bf16 v[80:83], v[160:163], v[28:31], v[80:83]
    v_mfma_f32_16x16x32_bf16 v[84:87], v[164:167], v[28:31], v[84:87]
    v_mfma_f32_16x16x32_bf16 v[88:91], v[168:171], v[28:31], v[88:91]
    v_mfma_f32_16x16x32_bf16 v[92:95], v[172:175], v[28:31], v[92:95]
    ds_read_b128 v[28:31], v4 offset:7168
    s_waitcnt lgkmcnt(6)
    v_mfma_f32_16x16x32_bf16 v[76:79], v[176:179], v[16:19], v[76:79]
    ds_write_b128 v12, v[72:75] offset:0
    v_mfma_f32_16x16x32_bf16 v[80:83], v[180:183], v[16:19], v[80:83]
    v_mfma_f32_16x16x32_bf16 v[84:87], v[184:187], v[16:19], v[84:87]
    v_mfma_f32_16x16x32_bf16 v[88:91], v[188:191], v[16:19], v[88:91]
    v_mfma_f32_16x16x32_bf16 v[92:95], v[192:195], v[16:19], v[92:95]
    s_waitcnt lgkmcnt(5)
    v_mfma_f32_16x16x32_bf16 v[76:79], v[196:199], v[20:23], v[76:79]
    v_mfma_f32_16x16x32_bf16 v[80:83], v[200:203], v[20:23], v[80:83]
    v_mfma_f32_16x16x32_bf16 v[84:87], v[204:207], v[20:23], v[84:87]
    v_mfma_f32_16x16x32_bf16 v[88:91], v[208:211], v[20:23], v[88:91]
    v_mfma_f32_16x16x32_bf16 v[92:95], v[212:215], v[20:23], v[92:95]
    s_waitcnt vmcnt(5)
    s_waitcnt lgkmcnt(0)
    s_barrier
    ds_read_b128 v[32:35], v6 offset:0
    ds_read_b128 v[36:39], v6 offset:5120
    ds_read_b128 v[40:43], v6 offset:10240
    ds_read_b128 v[16:19], v4 offset:32768
    ds_read_b128 v[20:23], v4 offset:33792
    v_mfma_f32_16x16x32_bf16 v[76:79], v[216:219], v[24:27], v[76:79]
    s_add_u32 s65, s68, 0
    s_and_b32 s65, s65, 3
    s_andn2_b32 s7, s68, 3
    s_add_u32 s65, s65, s7
    s_lshl_b32 s65, s65, 17
    s_add_u32 s65, s65, s66
    s_add_u32 m0, s99, 0
    s_add_u32 s65, s65, 0
    buffer_load_dwordx4 v13, s[8:11], s65 offen offset:0 sc1 lds
    v_mfma_f32_16x16x32_bf16 v[80:83], v[220:223], v[24:27], v[80:83]
    buffer_load_dwordx4 v13, s[8:11], s65 offen offset:1024 sc1 lds
    s_waitcnt lgkmcnt(2)
    v_mfma_f32_16x16x32_bf16 v[84:87], v[224:227], v[24:27], v[84:87]
    v_add_f32 v56, v56, v32
    v_add_f32 v57, v57, v33
    v_add_f32 v58, v58, v34
    v_add_f32 v59, v59, v35
    v_mfma_f32_16x16x32_bf16 v[88:91], v[228:231], v[24:27], v[88:91]
    v_add_f32 v56, v56, v36
    v_add_f32 v57, v57, v37
    v_add_f32 v58, v58, v38
    v_add_f32 v59, v59, v39
    v_mfma_f32_16x16x32_bf16 v[92:95], v[232:235], v[24:27], v[92:95]
    v_add_f32 v56, v56, v40
    v_add_f32 v57, v57, v41
    v_add_f32 v58, v58, v42
    v_add_f32 v59, v59, v43
    ds_read_b128 v[32:35], v5 offset:0
    ds_read_b128 v[36:39], v5 offset:5120
    ds_read_b128 v[40:43], v5 offset:10240
    ds_read_b128 v[24:27], v4 offset:34816
    v_mfma_f32_16x16x32_bf16 v[76:79], v[236:239], v[28:31], v[76:79]
    buffer_load_dwordx4 v13, s[8:11], s65 offen offset:2048 sc1 lds
    s_add_u32 s6, s98, 0
    v_mfma_f32_16x16x32_bf16 v[80:83], v[240:243], v[28:31], v[80:83]
    buffer_load_dwordx4 v13, s[8:11], s65 offen offset:3072 sc1 lds
    s_waitcnt lgkmcnt(1)
    v_mfma_f32_16x16x32_bf16 v[84:87], v[244:247], v[28:31], v[84:87]
    v_add_f32 v72, v72, v32
    v_add_f32 v73, v73, v33
    v_add_f32 v74, v74, v34
    v_add_f32 v75, v75, v35
    v_mfma_f32_16x16x32_bf16 v[88:91], v[248:251], v[28:31], v[88:91]
    v_add_f32 v72, v72, v36
    v_add_f32 v73, v73, v37
    v_add_f32 v74, v74, v38
    v_add_f32 v75, v75, v39
    v_mfma_f32_16x16x32_bf16 v[92:95], v[252:255], v[28:31], v[92:95]
    v_add_f32 v72, v72, v40
    v_add_f32 v73, v73, v41
    v_add_f32 v74, v74, v42
    v_add_f32 v75, v75, v43
    buffer_store_dwordx4 v[56:59], v44, s[8:11], s6 offen sc1
    s_cmp_lg_u32 s71, 2
    s_cbranch_scc1 L_nost_58
    buffer_store_dwordx4 v[72:75], v52, s[8:11], s6 offen sc1
L_nost_58:
    s_nop 0
    ds_read_b128 v[28:31], v4 offset:35840
    v_mfma_f32_16x16x32_bf16 v[56:59], v[96:99], v[16:19], 0
    v_mfma_f32_16x16x32_bf16 v[60:63], v[100:103], v[16:19], 0
    s_sub_u32 s6, s71, 4
    s_and_b32 s6, s6, 3
    s_mul_i32 s7, s6, 5120
    v_mfma_f32_16x16x32_bf16 v[64:67], v[104:107], v[16:19], 0
    s_add_u32 s7, s7, s67
    s_cmp_eq_u32 s6, 3
    s_cselect_b32 s7, 124928, s7
    v_mfma_f32_16x16x32_bf16 v[68:71], v[108:111], v[16:19], 0
    v_add_u32 v12, s7, v52
    v_mfma_f32_16x16x32_bf16 v[72:75], v[112:115], v[16:19], 0
    v_add_u32 v5, s67, v45
    ds_read_b128 v[16:19], v4 offset:36864
    v_mfma_f32_16x16x32_bf16 v[56:59], v[116:119], v[20:23], v[56:59]
    ds_write_b128 v5, v[80:83] offset:30720
    v_add_u32 v5, s67, v46
    v_mfma_f32_16x16x32_bf16 v[60:63], v[120:123], v[20:23], v[60:63]
    v_mfma_f32_16x16x32_bf16 v[64:67], v[124:127], v[20:23], v[64:67]
    v_mfma_f32_16x16x32_bf16 v[68:71], v[128:131], v[20:23], v[68:71]
    v_mfma_f32_16x16x32_bf16 v[72:75], v[132:135], v[20:23], v[72:75]
    ds_read_b128 v[20:23], v4 offset:37888
    s_waitcnt lgkmcnt(4)
    v_mfma_f32_16x16x32_bf16 v[56:59], v[136:139], v[24:27], v[56:59]
    ds_write_b128 v5, v[84:87] offset:35840
    v_add_u32 v5, s67, v47
    v_mfma_f32_16x16x32_bf16 v[60:63], v[140:143], v[24:27], v[60:63]
    v_mfma_f32_16x16x32_bf16 v[64:67], v[144:147], v[24:27], v[64:67]
    v_mfma_f32_16x16x32_bf16 v[68:71], v[148:151], v[24:27], v[68:71]
    v_mfma_f32_16x16x32_bf16 v[72:75], v[152:155], v[24:27], v[72:75]
    ds_read_b128 v[24:27], v4 offset:38912
    s_waitcnt lgkmcnt(5)
    v_mfma_f32_16x16x32_bf16 v[56:59], v[156:159], v[28:31], v[56:59]
    ds_write_b128 v5, v[88:91] offset:40960
    v_add_u32 v5, s67, v52
    v_mfma_f32_16x16x32_bf16 v[60:63], v[160:163], v[28:31], v[60:63]
    v_mfma_f32_16x16x32_bf16 v[64:67], v[164:167], v[28:31], v[64:67]
    v_mfma_f32_16x16x32_bf16 v[68:71], v[168:171], v[28:31], v[68:71]
    v_mfma_f32_16x16x32_bf16 v[72:75], v[172:175], v[28:31], v[72:75]
    ds_read_b128 v[28:31], v4 offset:39936
    s_waitcnt lgkmcnt(6)
    v_mfma_f32_16x16x32_bf16 v[56:59], v[176:179], v[16:19], v[56:59]
    ds_write_b128 v12, v[92:95] offset:30720
    v_mfma_f32_16x16x32_bf16 v[60:63], v[180:183], v[16:19], v[60:63]
    v_mfma_f32_16x16x32_bf16 v[64:67], v[184:187], v[16:19], v[64:67]
    v_mfma_f32_16x16x32_bf16 v[68:71], v[188:191], v[16:19], v[68:71]
    v_mfma_f32_16x16x32_bf16 v[72:75], v[192:195], v[16:19], v[72:75]
    s_waitcnt lgkmcnt(5)
    v_mfma_f32_16x16x32_bf16 v[56:59], v[196:199], v[20:23], v[56:59]
    v_mfma_f32_16x16x32_bf16 v[60:63], v[200:203], v[20:23], v[60:63]
    v_mfma_f32_16x16x32_bf16 v[64:67], v[204:207], v[20:23], v[64:67]
    v_mfma_f32_16x16x32_bf16 v[68:71], v[208:211], v[20:23], v[68:71]
    v_mfma_f32_16x16x32_bf16 v[72:75], v[212:215], v[20:23], v[72:75]
    s_waitcnt vmcnt(5)
    s_waitcnt lgkmcnt(0)
    s_barrier
    ds_read_b128 v[32:35], v6 offset:30720
    ds_read_b128 v[36:39], v6 offset:35840
    ds_read_b128 v[40:43], v6 offset:40960
    ds_read_b128 v[16:19], v7 offset:0
    ds_read_b128 v[20:23], v7 offset:1024
    v_mfma_f32_16x16x32_bf16 v[56:59], v[216:219], v[24:27], v[56:59]
    s_add_u32 s65, s61, 0
    s_and_b32 s65, s65, 3
    s_andn2_b32 s7, s61, 3
    s_add_u32 s65, s65, s7
    s_lshl_b32 s65, s65, 17
    s_add_u32 s65, s65, s66
    s_add_u32 m0, s99, 32768
    s_add_u32 s65, s65, 0
    buffer_load_dwordx4 v13, s[8:11], s65 offen offset:0 sc1 lds
    v_mfma_f32_16x16x32_bf16 v[60:63], v[220:223], v[24:27], v[60:63]
    buffer_load_dwordx4 v13, s[8:11], s65 offen offset:1024 sc1 lds
    s_waitcnt lgkmcnt(2)
    v_mfma_f32_16x16x32_bf16 v[64:67], v[224:227], v[24:27], v[64:67]
    v_add_f32 v76, v76, v32
    v_add_f32 v77, v77, v33
    v_add_f32 v78, v78, v34
    v_add_f32 v79, v79, v35
    v_mfma_f32_16x16x32_bf16 v[68:71], v[228:231], v[24:27], v[68:71]
    v_add_f32 v76, v76, v36
    v_add_f32 v77, v77, v37
    v_add_f32 v78, v78, v38
    v_add_f32 v79, v79, v39
    v_mfma_f32_16x16x32_bf16 v[72:75], v[232:235], v[24:27], v[72:75]
    v_add_f32 v76, v76, v40
    v_add_f32 v77, v77, v41
    v_add_f32 v78, v78, v42
    v_add_f32 v79, v79, v43
    ds_read_b128 v[32:35], v5 offset:30720
    ds_read_b128 v[36:39], v5 offset:35840
    ds_read_b128 v[40:43], v5 offset:40960
    ds_read_b128 v[24:27], v7 offset:2048
    v_mfma_f32_16x16x32_bf16 v[56:59], v[236:239], v[28:31], v[56:59]
    buffer_load_dwordx4 v13, s[8:11], s65 offen offset:2048 sc1 lds
    s_add_u32 s6, s96, 10240
    v_mfma_f32_16x16x32_bf16 v[60:63], v[240:243], v[28:31], v[60:63]
    buffer_load_dwordx4 v13, s[8:11], s65 offen offset:3072 sc1 lds
    s_waitcnt lgkmcnt(1)
    v_mfma_f32_16x16x32_bf16 v[64:67], v[244:247], v[28:31], v[64:67]
    v_add_f32 v92, v92, v32
    v_add_f32 v93, v93, v33
    v_add_f32 v94, v94, v34
    v_add_f32 v95, v95, v35
    v_mfma_f32_16x16x32_bf16 v[68:71], v[248:251], v[28:31], v[68:71]
    v_add_f32 v92, v92, v36
    v_add_f32 v93, v93, v37
    v_add_f32 v94, v94, v38
    v_add_f32 v95, v95, v39
    v_mfma_f32_16x16x32_bf16 v[72:75], v[252:255], v[28:31], v[72:75]
    v_add_f32 v92, v92, v40
    v_add_f32 v93, v93, v41
    v_add_f32 v94, v94, v42
    v_add_f32 v95, v95, v43
    buffer_store_dwordx4 v[76:79], v44, s[8:11], s6 offen sc1
    s_cmp_lg_u32 s71, 3
    s_cbranch_scc1 L_nost_59
    buffer_store_dwordx4 v[92:95], v52, s[8:11], s6 offen sc1
L_nost_59:
    s_nop 0
    ds_read_b128 v[28:31], v7 offset:3072
    v_mfma_f32_16x16x32_bf16 v[76:79], v[96:99], v[16:19], 0
    v_mfma_f32_16x16x32_bf16 v[80:83], v[100:103], v[16:19], 0
    s_sub_u32 s6, s71, 5
    s_and_b32 s6, s6, 3
    s_mul_i32 s7, s6, 5120
    v_mfma_f32_16x16x32_bf16 v[84:87], v[104:107], v[16:19], 0
    s_add_u32 s7, s7, s67
    s_cmp_eq_u32 s6, 3
    s_cselect_b32 s7, 155648, s7
    v_mfma_f32_16x16x32_bf16 v[88:91], v[108:111], v[16:19], 0
    v_add_u32 v12, s7, v52
    v_mfma_f32_16x16x32_bf16 v[92:95], v[112:115], v[16:19], 0
    v_add_u32 v5, s67, v45
    ds_read_b128 v[16:19], v7 offset:4096
    v_mfma_f32_16x16x32_bf16 v[76:79], v[116:119], v[20:23], v[76:79]
    ds_write_b128 v5, v[60:63] offset:0
    v_add_u32 v5, s67, v46
    v_mfma_f32_16x16x32_bf16 v[80:83], v[120:123], v[20:23], v[80:83]
    v_mfma_f32_16x16x32_bf16 v[84:87], v[124:127], v[20:23], v[84:87]
    v_mfma_f32_16x16x32_bf16 v[88:91], v[128:131], v[20:23], v[88:91]
    v_mfma_f32_16x16x32_bf16 v[92:95], v[132:135], v[20:23], v[92:95]
    ds_read_b128 v[20:23], v7 offset:5120
    s_waitcnt lgkmcnt(4)
    v_mfma_f32_16x16x32_bf16 v[76:79], v[136:139], v[24:27], v[76:79]
    ds_write_b128 v5, v[64:67] offset:5120
    v_add_u32 v5, s67, v47
    v_mfma_f32_16x16x32_bf16 v[80:83], v[140:143], v[24:27], v[80:83]
    v_mfma_f32_16x16x32_bf16 v[84:87], v[144:147], v[24:27], v[84:87]
    v_mfma_f32_16x16x32_bf16 v[88:91], v[148:151], v[24:27], v[88:91]
    v_mfma_f32_16x16x32_bf16 v[92:95], v[152:155], v[24:27], v[92:95]
    ds_read_b128 v[24:27], v7 offset:6144
    s_waitcnt lgkmcnt(5)
    v_mfma_f32_16x16x32_bf16 v[76:79], v[156:159], v[28:31], v[76:79]
    ds_write_b128 v5, v[68:71] offset:10240
    v_add_u32 v5, s67, v52
    v_mfma_f32_16x16x32_bf16 v[80:83], v[160:163], v[28:31], v[80:83]
    v_mfma_f32_16x16x32_bf16 v[84:87], v[164:167], v[28:31], v[84:87]
    v_mfma_f32_16x16x32_bf16 v[88:91], v[168:171], v[28:31], v[88:91]
    v_mfma_f32_16x16x32_bf16 v[92:95], v[172:175], v[28:31], v[92:95]
    ds_read_b128 v[28:31], v7 offset:7168
    s_waitcnt lgkmcnt(6)
    v_mfma_f32_16x16x32_bf16 v[76:79], v[176:179], v[16:19], v[76:79]
    ds_write_b128 v12, v[72:75] offset:0
    v_mfma_f32_16x16x32_bf16 v[80:83], v[180:183], v[16:19], v[80:83]
    v_mfma_f32_16x16x32_bf16 v[84:87], v[184:187], v[16:19], v[84:87]
    v_mfma_f32_16x16x32_bf16 v[88:91], v[188:191], v[16:19], v[88:91]
    v_mfma_f32_16x16x32_bf16 v[92:95], v[192:195], v[16:19], v[92:95]
    s_waitcnt lgkmcnt(5)
    v_mfma_f32_16x16x32_bf16 v[76:79], v[196:199], v[20:23], v[76:79]
    v_mfma_f32_16x16x32_bf16 v[80:83], v[200:203], v[20:23], v[80:83]
    v_mfma_f32_16x16x32_bf16 v[84:87], v[204:207], v[20:23], v[84:87]
    v_mfma_f32_16x16x32_bf16 v[88:91], v[208:211], v[20:23], v[88:91]
    v_mfma_f32_16x16x32_bf16 v[92:95], v[212:215], v[20:23], v[92:95]
    s_waitcnt vmcnt(5)
    s_waitcnt lgkmcnt(0)
    s_barrier
    ds_read_b128 v[32:35], v6 offset:0
    ds_read_b128 v[36:39], v6 offset:5120
    ds_read_b128 v[40:43], v6 offset:10240
    ds_read_b128 v[16:19], v4 offset:0
    ds_read_b128 v[20:23], v4 offset:1024
    v_mfma_f32_16x16x32_bf16 v[76:79], v[216:219], v[24:27], v[76:79]
    v_mfma_f32_16x16x32_bf16 v[80:83], v[220:223], v[24:27], v[80:83]
    s_waitcnt lgkmcnt(2)
    v_mfma_f32_16x16x32_bf16 v[84:87], v[224:227], v[24:27], v[84:87]
    v_add_f32 v56, v56, v32
    v_add_f32 v57, v57, v33
    v_add_f32 v58, v58, v34
    v_add_f32 v59, v59, v35
    v_mfma_f32_16x16x32_bf16 v[88:91], v[228:231], v[24:27], v[88:91]
    v_add_f32 v56, v56, v36
    v_add_f32 v57, v57, v37
    v_add_f32 v58, v58, v38
    v_add_f32 v59, v59, v39
    v_mfma_f32_16x16x32_bf16 v[92:95], v[232:235], v[24:27], v[92:95]
    v_add_f32 v56, v56, v40
    v_add_f32 v57, v57, v41
    v_add_f32 v58, v58, v42
    v_add_f32 v59, v59, v43
    ds_read_b128 v[32:35], v5 offset:0
    ds_read_b128 v[36:39], v5 offset:5120
    ds_read_b128 v[40:43], v5 offset:10240
    ds_read_b128 v[24:27], v4 offset:2048
    v_mfma_f32_16x16x32_bf16 v[76:79], v[236:239], v[28:31], v[76:79]
    s_add_u32 s6, s97, 10240
    v_mfma_f32_16x16x32_bf16 v[80:83], v[240:243], v[28:31], v[80:83]
    s_waitcnt lgkmcnt(1)
    v_mfma_f32_16x16x32_bf16 v[84:87], v[244:247], v[28:31], v[84:87]
    v_add_f32 v72, v72, v32
    v_add_f32 v73, v73, v33
    v_add_f32 v74, v74, v34
    v_add_f32 v75, v75, v35
    v_mfma_f32_16x16x32_bf16 v[88:91], v[248:251], v[28:31], v[88:91]
    v_add_f32 v72, v72, v36
    v_add_f32 v73, v73, v37
    v_add_f32 v74, v74, v38
    v_add_f32 v75, v75, v39
    v_mfma_f32_16x16x32_bf16 v[92:95], v[252:255], v[28:31], v[92:95]
    v_add_f32 v72, v72, v40
    v_add_f32 v73, v73, v41
    v_add_f32 v74, v74, v42
    v_add_f32 v75, v75, v43
    buffer_store_dwordx4 v[56:59], v44, s[8:11], s6 offen sc1
    s_cmp_lg_u32 s71, 0
    s_cbranch_scc1 L_nost_60
    buffer_store_dwordx4 v[72:75], v52, s[8:11], s6 offen sc1
L_nost_60:
    s_nop 0
    ds_read_b128 v[28:31], v4 offset:3072
    v_mfma_f32_16x16x32_bf16 v[56:59], v[96:99], v[16:19], 0
    v_mfma_f32_16x16x32_bf16 v[60:63], v[100:103], v[16:19], 0
    s_sub_u32 s6, s71, 6
    s_and_b32 s6, s6, 3
    s_mul_i32 s7, s6, 5120
    v_mfma_f32_16x16x32_bf16 v[64:67], v[104:107], v[16:19], 0
    s_add_u32 s7, s7, s67
    s_cmp_eq_u32 s6, 3
    s_cselect_b32 s7, 124928, s7
    v_mfma_f32_16x16x32_bf16 v[68:71], v[108:111], v[16:19], 0
    v_add_u32 v12, s7, v52
    v_mfma_f32_16x16x32_bf16 v[72:75], v[112:115], v[16:19], 0
    v_add_u32 v5, s67, v45
    ds_read_b128 v[16:19], v4 offset:4096
    v_mfma_f32_16x16x32_bf16 v[56:59], v[116:119], v[20:23], v[56:59]
    ds_write_b128 v5, v[80:83] offset:30720
    v_add_u32 v5, s67, v46
    v_mfma_f32_16x16x32_bf16 v[60:63], v[120:123], v[20:23], v[60:63]
    v_mfma_f32_16x16x32_bf16 v[64:67], v[124:127], v[20:23], v[64:67]
    v_mfma_f32_16x16x32_bf16 v[68:71], v[128:131], v[20:23], v[68:71]
    ds_write_b128 v5, v[84:87] offset:35840
    v_add_u32 v5, s67, v47
    v_mfma_f32_16x16x32_bf16 v[72:75], v[132:135], v[20:23], v[72:75]
    ds_read_b128 v[20:23], v4 offset:5120
    s_waitcnt lgkmcnt(5)
    v_mfma_f32_16x16x32_bf16 v[56:59], v[136:139], v[24:27], v[56:59]
    v_mfma_f32_16x16x32_bf16 v[60:63], v[140:143], v[24:27], v[60:63]
    ds_write_b128 v5, v[88:91] offset:40960
    v_add_u32 v5, s67, v52
    v_mfma_f32_16x16x32_bf16 v[64:67], v[144:147], v[24:27], v[64:67]
    v_mfma_f32_16x16x32_bf16 v[68:71], v[148:151], v[24:27], v[68:71]
    v_mfma_f32_16x16x32_bf16 v[72:75], v[152:155], v[24:27], v[72:75]
    ds_write_b128 v12, v[92:95] offset:30720
    ds_read_b128 v[24:27], v4 offset:6144
    s_waitcnt lgkmcnt(7)
    v_mfma_f32_16x16x32_bf16 v[56:59], v[156:159], v[28:31], v[56:59]
    v_mfma_f32_16x16x32_bf16 v[60:63], v[160:163], v[28:31], v[60:63]
    v_mfma_f32_16x16x32_bf16 v[64:67], v[164:167], v[28:31], v[64:67]
    v_mfma_f32_16x16x32_bf16 v[68:71], v[168:171], v[28:31], v[68:71]
    v_mfma_f32_16x16x32_bf16 v[72:75], v[172:175], v[28:31], v[72:75]
    ds_read_b128 v[28:31], v4 offset:7168
    s_waitcnt vmcnt(1)
    v_mov_b32 v3, 0x5000000
    s_and_b32 s6, s4, 7
    s_lshl_b32 s7, s5, 3
    s_add_u32 s6, s6, s7
    s_lshr_b32 s7, s4, 3
    s_add_u32 s7, s7, 0
    s_add_u32 s7, s7, 1
    s_and_b32 s7, s7, 3
    s_lshl_b32 s6, s6, 2
    s_add_u32 s6, s6, s7
    s_mul_i32 s6, s6, 3
    s_add_u32 s6, s6, 0
    s_lshl_b32 s6, s6, 5
    s_add_u32 s6, s6, s3
    s_lshl_b32 s6, s6, 2
    s_add_u32 s6, s6, 15728640
    v_writelane_b32 v3, s6, 0
    v_writelane_b32 v2, 2, 0
    s_and_b32 s6, s4, 7
    s_lshl_b32 s7, s5, 3
    s_add_u32 s6, s6, s7
    s_lshr_b32 s7, s4, 3
    s_add_u32 s7, s7, 1
    s_add_u32 s7, s7, 1
    s_and_b32 s7, s7, 3
    s_lshl_b32 s6, s6, 2
    s_add_u32 s6, s6, s7
    s_mul_i32 s6, s6, 3
    s_add_u32 s6, s6, 1
    s_lshl_b32 s6, s6, 5
    s_add_u32 s6, s6, s3
    s_lshl_b32 s6, s6, 2
    s_add_u32 s6, s6, 15728640
    v_writelane_b32 v3, s6, 1
    v_writelane_b32 v2, 1, 1
    s_and_b32 s6, s4, 7
    s_lshl_b32 s7, s5, 3
    s_add_u32 s6, s6, s7
    s_lshr_b32 s7, s4, 3
    s_add_u32 s7, s7, 2
    s_add_u32 s7, s7, 1
    s_and_b32 s7, s7, 3
    s_lshl_b32 s6, s6, 2
    s_add_u32 s6, s6, s7
    s_mul_i32 s6, s6, 3
    s_add_u32 s6, s6, 2
    s_lshl_b32 s6, s6, 5
    s_add_u32 s6, s6, s3
    s_lshl_b32 s6, s6, 2
    s_add_u32 s6, s6, 15728640
    v_writelane_b32 v3, s6, 2
    v_writelane_b32 v2, 1, 2
    buffer_store_dword v2, v3, s[8:11], 0 offen sc1
    s_waitcnt lgkmcnt(0)
    s_barrier
    ds_read_b128 v[32:35], v6 offset:30720
    ds_read_b128 v[36:39], v6 offset:35840
    ds_read_b128 v[40:43], v6 offset:40960
    v_mfma_f32_16x16x32_bf16 v[56:59], v[176:179], v[16:19], v[56:59]
    v_mfma_f32_16x16x32_bf16 v[60:63], v[180:183], v[16:19], v[60:63]
    s_waitcnt lgkmcnt(0)
    v_mfma_f32_16x16x32_bf16 v[64:67], v[184:187], v[16:19], v[64:67]
    v_add_f32 v76, v76, v32
    v_add_f32 v77, v77, v33
    v_add_f32 v78, v78, v34
    v_add_f32 v79, v79, v35
    v_mfma_f32_16x16x32_bf16 v[68:71], v[188:191], v[16:19], v[68:71]
    v_add_f32 v76, v76, v36
    v_add_f32 v77, v77, v37
    v_add_f32 v78, v78, v38
    v_add_f32 v79, v79, v39
    v_mfma_f32_16x16x32_bf16 v[72:75], v[192:195], v[16:19], v[72:75]
    v_add_f32 v76, v76, v40
    v_add_f32 v77, v77, v41
    v_add_f32 v78, v78, v42
    v_add_f32 v79, v79, v43
    ds_read_b128 v[32:35], v5 offset:30720
    ds_read_b128 v[36:39], v5 offset:35840
    ds_read_b128 v[40:43], v5 offset:40960
    v_mfma_f32_16x16x32_bf16 v[56:59], v[196:199], v[20:23], v[56:59]
    s_add_u32 s6, s98, 10240
    v_mfma_f32_16x16x32_bf16 v[60:63], v[200:203], v[20:23], v[60:63]
    s_waitcnt lgkmcnt(0)
    v_mfma_f32_16x16x32_bf16 v[64:67], v[204:207], v[20:23], v[64:67]
    v_add_f32 v92, v92, v32
    v_add_f32 v93, v93, v33
    v_add_f32 v94, v94, v34
    v_add_f32 v95, v95, v35
    v_mfma_f32_16x16x32_bf16 v[68:71], v[208:211], v[20:23], v[68:71]
    v_add_f32 v92, v92, v36
    v_add_f32 v93, v93, v37
    v_add_f32 v94, v94, v38
    v_add_f32 v95, v95, v39
    v_mfma_f32_16x16x32_bf16 v[72:75], v[212:215], v[20:23], v[72:75]
    v_add_f32 v92, v92, v40
    v_add_f32 v93, v93, v41
    v_add_f32 v94, v94, v42
    v_add_f32 v95, v95, v43
    buffer_store_dwordx4 v[76:79], v44, s[8:11], s6 offen sc1
    s_cmp_lg_u32 s71, 1
    s_cbranch_scc1 L_nost_61
    buffer_store_dwordx4 v[92:95], v52, s[8:11], s6 offen sc1
L_nost_61:
    s_nop 0
    s_waitcnt lgkmcnt(0)
    s_barrier
    ds_read_b128 v[16:19], v4 offset:32768
    ds_read_b128 v[20:23], v4 offset:33792
    v_mfma_f32_16x16x32_bf16 v[56:59], v[216:219], v[24:27], v[56:59]
    v_mfma_f32_16x16x32_bf16 v[60:63], v[220:223], v[24:27], v[60:63]
    v_mfma_f32_16x16x32_bf16 v[64:67], v[224:227], v[24:27], v[64:67]
    v_mfma_f32_16x16x32_bf16 v[68:71], v[228:231], v[24:27], v[68:71]
    v_mfma_f32_16x16x32_bf16 v[72:75], v[232:235], v[24:27], v[72:75]
    ds_read_b128 v[24:27], v4 offset:34816
    v_mfma_f32_16x16x32_bf16 v[56:59], v[236:239], v[28:31], v[56:59]
    v_mfma_f32_16x16x32_bf16 v[60:63], v[240:243], v[28:31], v[60:63]
    v_mfma_f32_16x16x32_bf16 v[64:67], v[244:247], v[28:31], v[64:67]
    v_mfma_f32_16x16x32_bf16 v[68:71], v[248:251], v[28:31], v[68:71]
    v_mfma_f32_16x16x32_bf16 v[72:75], v[252:255], v[28:31], v[72:75]
    ds_read_b128 v[28:31], v4 offset:35840
    s_waitcnt lgkmcnt(3)
    v_mfma_f32_16x16x32_bf16 v[76:79], v[96:99], v[16:19], 0
    v_mfma_f32_16x16x32_bf16 v[80:83], v[100:103], v[16:19], 0
    v_mfma_f32_16x16x32_bf16 v[84:87], v[104:107], v[16:19], 0
    v_mfma_f32_16x16x32_bf16 v[88:91], v[108:111], v[16:19], 0
    s_mul_i32 s73, s3, 5120
    s_add_u32 s73, s73, 65536
    v_mfma_f32_16x16x32_bf16 v[92:95], v[112:115], v[16:19], 0
    v_add_u32 v5, s73, v44
    ds_read_b128 v[16:19], v4 offset:36864
    s_waitcnt lgkmcnt(3)
    v_mfma_f32_16x16x32_bf16 v[76:79], v[116:119], v[20:23], v[76:79]
    ds_write_b128 v5, v[56:59]
    v_add_u32 v5, s73, v45
    v_mfma_f32_16x16x32_bf16 v[80:83], v[120:123], v[20:23], v[80:83]
    v_mfma_f32_16x16x32_bf16 v[84:87], v[124:127], v[20:23], v[84:87]
    v_mfma_f32_16x16x32_bf16 v[88:91], v[128:131], v[20:23], v[88:91]
    v_mfma_f32_16x16x32_bf16 v[92:95], v[132:135], v[20:23], v[92:95]
    ds_read_b128 v[20:23], v4 offset:37888
    s_waitcnt lgkmcnt(4)
    v_mfma_f32_16x16x32_bf16 v[76:79], v[136:139], v[24:27], v[76:79]
    ds_write_b128 v5, v[60:63]
    v_add_u32 v5, s73, v46
    v_mfma_f32_16x16x32_bf16 v[80:83], v[140:143], v[24:27], v[80:83]
    v_mfma_f32_16x16x32_bf16 v[84:87], v[144:147], v[24:27], v[84:87]
    v_mfma_f32_16x16x32_bf16 v[88:91], v[148:151], v[24:27], v[88:91]
    v_mfma_f32_16x16x32_bf16 v[92:95], v[152:155], v[24:27], v[92:95]
    ds_read_b128 v[24:27], v4 offset:38912
    s_waitcnt vmcnt(0)
    v_mov_b32 v3, 0x5000000
    s_and_b32 s6, s4, 7
    s_lshl_b32 s7, s5, 3
    s_add_u32 s6, s6, s7
    s_lshr_b32 s7, s4, 3
    s_add_u32 s7, s7, 1
    s_add_u32 s7, s7, 1
    s_and_b32 s7, s7, 3
    s_lshl_b32 s6, s6, 2
    s_add_u32 s6, s6, s7
    s_mul_i32 s6, s6, 3
    s_add_u32 s6, s6, 1
    s_lshl_b32 s6, s6, 5
    s_add_u32 s6, s6, s3
    s_lshl_b32 s6, s6, 2
    s_add_u32 s6, s6, 15728640
    v_writelane_b32 v3, s6, 1
    v_writelane_b32 v2, 2, 1
    s_and_b32 s6, s4, 7
    s_lshl_b32 s7, s5, 3
    s_add_u32 s6, s6, s7
    s_lshr_b32 s7, s4, 3
    s_add_u32 s7, s7, 2
    s_add_u32 s7, s7, 1
    s_and_b32 s7, s7, 3
    s_lshl_b32 s6, s6, 2
    s_add_u32 s6, s6, s7
    s_mul_i32 s6, s6, 3
    s_add_u32 s6, s6, 2
    s_lshl_b32 s6, s6, 5
    s_add_u32 s6, s6, s3
    s_lshl_b32 s6, s6, 2
    s_add_u32 s6, s6, 15728640
    v_writelane_b32 v3, s6, 2
    v_writelane_b32 v2, 2, 2
    buffer_store_dword v2, v3, s[8:11], 0 offen sc1
    s_waitcnt lgkmcnt(5)
    v_mfma_f32_16x16x32_bf16 v[76:79], v[156:159], v[28:31], v[76:79]
    ds_write_b128 v5, v[64:67]
    v_add_u32 v5, s73, v47
    v_mfma_f32_16x16x32_bf16 v[80:83], v[160:163], v[28:31], v[80:83]
    v_mfma_f32_16x16x32_bf16 v[84:87], v[164:167], v[28:31], v[84:87]
    v_mfma_f32_16x16x32_bf16 v[88:91], v[168:171], v[28:31], v[88:91]
    v_mfma_f32_16x16x32_bf16 v[92:95], v[172:175], v[28:31], v[92:95]
    ds_read_b128 v[28:31], v4 offset:39936
    s_cmp_eq_u32 s64, 0
    s_cbranch_scc1 L_nb
    v_bfe_u32 v2, v1, 1, 3
    v_and_b32 v3, 1, v1
    v_lshl_add_u32 v3, v2, 3, v3
    v_lshlrev_b32 v3, 7, v3
    s_and_b32 s6, s4, 3
    s_lshl_b32 s6, s6, 8
    s_add_u32 s6, s6, 3915776
    s_mov_b32 s79, 262144
L_poll_62:
    buffer_load_dword v2, v3, s[8:11], s6 offen sc1
    s_waitcnt vmcnt(0)
    v_cmp_ne_u32 vcc, 1, v2
    s_cbranch_vccz L_polldone_63
    s_sleep 2
    s_sub_u32 s79, s79, 1
    s_cmp_lg_u32 s79, 0
    s_cbranch_scc1 L_poll_62
L_polldone_63:
L_nb:
    buffer_load_dwordx4 v[96:99], v53, s[12:15], s70 offen
    buffer_load_dwordx4 v[100:103], v48, s[8:11], 0 offen sc1
    s_cmp_ge_u32 s3, 2
    s_cbranch_scc1 L_itskip_64
    buffer_load_dwordx4 v[104:107], v54, s[12:15], s70 offen
    buffer_load_dwordx4 v[108:111], v49, s[8:11], 0 offen sc1
L_itskip_64:
    s_waitcnt lgkmcnt(6)
    v_mfma_f32_16x16x32_bf16 v[76:79], v[176:179], v[16:19], v[76:79]
    ds_write_b128 v5, v[68:71]
    v_add_u32 v5, s73, v52
    v_mfma_f32_16x16x32_bf16 v[80:83], v[180:183], v[16:19], v[80:83]
    v_mfma_f32_16x16x32_bf16 v[84:87], v[184:187], v[16:19], v[84:87]
    v_mfma_f32_16x16x32_bf16 v[88:91], v[188:191], v[16:19], v[88:91]
    v_mfma_f32_16x16x32_bf16 v[92:95], v[192:195], v[16:19], v[92:95]
    s_waitcnt lgkmcnt(5)
    v_mfma_f32_16x16x32_bf16 v[76:79], v[196:199], v[20:23], v[76:79]
    ds_write_b128 v5, v[72:75]
    v_mfma_f32_16x16x32_bf16 v[80:83], v[200:203], v[20:23], v[80:83]
    v_mfma_f32_16x16x32_bf16 v[84:87], v[204:207], v[20:23], v[84:87]
    v_mfma_f32_16x16x32_bf16 v[88:91], v[208:211], v[20:23], v[88:91]
    v_mfma_f32_16x16x32_bf16 v[92:95], v[212:215], v[20:23], v[92:95]
    s_and_b32 s72, s4, 7
    s_lshl_b32 s7, s5, 3
    s_add_u32 s72, s72, s7
    s_lshl_b32 s72, s72, 2
    s_lshr_b32 s7, s4, 3
    s_add_u32 s72, s72, s7
    s_mul_i32 s75, s72, 61440
    s_add_u32 s75, s75, 67108864
    s_mul_i32 s72, s72, 384
    s_add_u32 s72, s72, 15728640
    v_bfe_u32 v2, v1, 3, 2
    v_min_u32 v2, 2, v2
    v_and_b32 v3, 7, v1
    v_lshlrev_b32 v3, 2, v3
    v_lshl_add_u32 v3, v2, 7, v3
    s_bitcmp1_b32 13, s3
    s_cselect_b32 s77, 1, 2
    buffer_load_dword v50, v3, s[8:11], s72 offen sc1
    s_waitcnt lgkmcnt(4)
    v_mfma_f32_16x16x32_bf16 v[76:79], v[216:219], v[24:27], v[76:79]
    v_mfma_f32_16x16x32_bf16 v[80:83], v[220:223], v[24:27], v[80:83]
    v_mfma_f32_16x16x32_bf16 v[84:87], v[224:227], v[24:27], v[84:87]
    v_mfma_f32_16x16x32_bf16 v[88:91], v[228:231], v[24:27], v[88:91]
    v_mfma_f32_16x16x32_bf16 v[92:95], v[232:235], v[24:27], v[92:95]
    s_waitcnt lgkmcnt(2)
    v_mfma_f32_16x16x32_bf16 v[76:79], v[236:239], v[28:31], v[76:79]
    v_mfma_f32_16x16x32_bf16 v[80:83], v[240:243], v[28:31], v[80:83]
    v_mfma_f32_16x16x32_bf16 v[84:87], v[244:247], v[28:31], v[84:87]
    v_mfma_f32_16x16x32_bf16 v[88:91], v[248:251], v[28:31], v[88:91]
    v_mfma_f32_16x16x32_bf16 v[92:95], v[252:255], v[28:31], v[92:95]
    s_nop 7
    v_add_u32 v5, s73, v44
    ds_write_b128 v5, v[76:79] offset:40960
    v_add_u32 v5, s73, v45
    ds_write_b128 v5, v[80:83] offset:40960
    v_add_u32 v5, s73, v46
    ds_write_b128 v5, v[84:87] offset:40960
    v_add_u32 v5, s73, v47
    ds_write_b128 v5, v[88:91] offset:40960
    v_add_u32 v5, s73, v52
    ds_write_b128 v5, v[92:95] offset:40960
    s_waitcnt vmcnt(0)
    v_cmp_gt_u32 s[78:79], s77, v50
    s_nop 3
    s_cmp_lg_u64 s[78:79], 0
    s_cbranch_scc1 L_x2a
    s_add_u32 s6, s75, 0
    buffer_load_dwordx4 v[112:115], v8, s[8:11], s6 offen offset:0 sc1
    buffer_load_dwordx4 v[116:119], v8, s[8:11], s6 offen offset:256 sc1
    s_add_u32 s6, s75, 20480
    buffer_load_dwordx4 v[120:123], v8, s[8:11], s6 offen offset:0 sc1
    buffer_load_dwordx4 v[124:127], v8, s[8:11], s6 offen offset:256 sc1
    s_add_u32 s6, s75, 40960
    buffer_load_dwordx4 v[128:131], v8, s[8:11], s6 offen offset:0 sc1
    buffer_load_dwordx4 v[132:135], v8, s[8:11], s6 offen offset:256 sc1
    s_cmp_ge_u32 s3, 2
    s_cbranch_scc1 L_xi_65
    s_add_u32 s6, s75, 0
    buffer_load_dwordx4 v[136:139], v9, s[8:11], s6 offen offset:0 sc1
    buffer_load_dwordx4 v[140:143], v9, s[8:11], s6 offen offset:256 sc1
    s_add_u32 s6, s75, 20480
    buffer_load_dwordx4 v[144:147], v9, s[8:11], s6 offen offset:0 sc1
    buffer_load_dwordx4 v[148:151], v9, s[8:11], s6 offen offset:256 sc1
    s_add_u32 s6, s75, 40960
    buffer_load_dwordx4 v[152:155], v9, s[8:11], s6 offen offset:0 sc1
    buffer_load_dwordx4 v[156:159], v9, s[8:11], s6 offen offset:256 sc1
L_xi_65:
L_x2a:
    s_waitcnt lgkmcnt(0)
    s_barrier
    ds_read_b128 v[160:163], v10 offset:0
    ds_read_b128 v[164:167], v10 offset:256
    ds_read_b128 v[168:171], v10 offset:5120
    ds_read_b128 v[172:175], v10 offset:5376
    ds_read_b128 v[176:179], v10 offset:10240
    ds_read_b128 v[180:183], v10 offset:10496
    ds_read_b128 v[184:187], v10 offset:15360
    ds_read_b128 v[188:191], v10 offset:15616
    ds_read_b128 v[192:195], v55 offset:0
    ds_read_b128 v[196:199], v55 offset:256
    ds_read_b128 v[200:203], v55 offset:5120
    ds_read_b128 v[204:207], v55 offset:5376
    ds_read_b128 v[208:211], v55 offset:10240
    ds_read_b128 v[212:215], v55 offset:10496
    ds_read_b128 v[216:219], v55 offset:15360
    ds_read_b128 v[220:223], v55 offset:15616
    s_cmp_eq_u64 s[78:79], 0
    s_cbranch_scc1 L_x2b
    s_mov_b32 s79, 262144
L_poll_66:
    buffer_load_dword v2, v3, s[8:11], s72 offen sc1
    s_waitcnt vmcnt(0)
    v_cmp_gt_u32 vcc, s77, v2
    s_cbranch_vccz L_polldone_67
    s_sleep 1
    s_sub_u32 s79, s79, 1
    s_cmp_lg_u32 s79, 0
    s_cbranch_scc1 L_poll_66
L_polldone_67:
    s_add_u32 s6, s75, 0
    buffer_load_dwordx4 v[112:115], v8, s[8:11], s6 offen offset:0 sc1
    buffer_load_dwordx4 v[116:119], v8, s[8:11], s6 offen offset:256 sc1
    s_add_u32 s6, s75, 20480
    buffer_load_dwordx4 v[120:123], v8, s[8:11], s6 offen offset:0 sc1
    buffer_load_dwordx4 v[124:127], v8, s[8:11], s6 offen offset:256 sc1
    s_add_u32 s6, s75, 40960
    buffer_load_dwordx4 v[128:131], v8, s[8:11], s6 offen offset:0 sc1
    buffer_load_dwordx4 v[132:135], v8, s[8:11], s6 offen offset:256 sc1
    s_cmp_ge_u32 s3, 2
    s_cbranch_scc1 L_xi_68
    s_add_u32 s6, s75, 0
    buffer_load_dwordx4 v[136:139], v9, s[8:11], s6 offen offset:0 sc1
    buffer_load_dwordx4 v[140:143], v9, s[8:11], s6 offen offset:256 sc1
    s_add_u32 s6, s75, 20480
    buffer_load_dwordx4 v[144:147], v9, s[8:11], s6 offen offset:0 sc1
    buffer_load_dwordx4 v[148:151], v9, s[8:11], s6 offen offset:256 sc1
    s_add_u32 s6, s75, 40960
    buffer_load_dwordx4 v[152:155], v9, s[8:11], s6 offen offset:0 sc1
    buffer_load_dwordx4 v[156:159], v9, s[8:11], s6 offen offset:256 sc1
L_xi_68:
L_x2b:
    s_mov_b32 s16, s54
    s_mov_b32 s17, s55
    s_mov_b32 s18, 0x280000
    s_mov_b32 s19, 0x20000
    s_waitcnt lgkmcnt(8)
    v_pk_add_f32 v[160:161], v[160:161], v[168:169]
    v_pk_add_f32 v[162:163], v[162:163], v[170:171]
    v_pk_add_f32 v[164:165], v[164:165], v[172:173]
    v_pk_add_f32 v[166:167], v[166:167], v[174:175]
    v_pk_add_f32 v[160:161], v[160:161], v[176:177]
    v_pk_add_f32 v[162:163], v[162:163], v[178:179]
    v_pk_add_f32 v[164:165], v[164:165], v[180:181]
    v_pk_add_f32 v[166:167], v[166:167], v[182:183]
    v_pk_add_f32 v[160:161], v[160:161], v[184:185]
    v_pk_add_f32 v[162:163], v[162:163], v[186:187]
    v_pk_add_f32 v[164:165], v[164:165], v[188:189]
    v_pk_add_f32 v[166:167], v[166:167], v[190:191]
    s_waitcnt vmcnt(0)
    v_pk_add_f32 v[160:161], v[160:161], v[112:113]
    v_pk_add_f32 v[162:163], v[162:163], v[114:115]
    v_pk_add_f32 v[164:165], v[164:165], v[116:117]
    v_pk_add_f32 v[166:167], v[166:167], v[118:119]
    v_pk_add_f32 v[160:161], v[160:161], v[120:121]
    v_pk_add_f32 v[162:163], v[162:163], v[122:123]
    v_pk_add_f32 v[164:165], v[164:165], v[124:125]
    v_pk_add_f32 v[166:167], v[166:167], v[126:127]
    v_pk_add_f32 v[160:161], v[160:161], v[128:129]
    v_pk_add_f32 v[162:163], v[162:163], v[130:131]
    v_pk_add_f32 v[164:165], v[164:165], v[132:133]
    v_pk_add_f32 v[166:167], v[166:167], v[134:135]
    v_cvt_pk_bf16_f32 v2, v160, v161
    v_lshlrev_b32 v160, 16, v2
    v_and_b32 v161, 0xffff0000, v2
    v_lshlrev_b32 v2, 16, v96
    v_and_b32 v3, 0xffff0000, v96
    v_pk_add_f32 v[160:161], v[160:161], v[2:3]
    v_cvt_pk_bf16_f32 v2, v160, v161
    v_lshlrev_b32 v160, 16, v2
    v_and_b32 v161, 0xffff0000, v2
    v_lshlrev_b32 v2, 16, v100
    v_and_b32 v3, 0xffff0000, v100
    v_pk_add_f32 v[160:161], v[160:161], v[2:3]
    v_cvt_pk_bf16_f32 v224, v160, v161
    v_cvt_pk_bf16_f32 v2, v162, v163
    v_lshlrev_b32 v162, 16, v2
    v_and_b32 v163, 0xffff0000, v2
    v_lshlrev_b32 v2, 16, v97
    v_and_b32 v3, 0xffff0000, v97
    v_pk_add_f32 v[162:163], v[162:163], v[2:3]
    v_cvt_pk_bf16_f32 v2, v162, v163
    v_lshlrev_b32 v162, 16, v2
    v_and_b32 v163, 0xffff0000, v2
    v_lshlrev_b32 v2, 16, v101
    v_and_b32 v3, 0xffff0000, v101
    v_pk_add_f32 v[162:163], v[162:163], v[2:3]
    v_cvt_pk_bf16_f32 v225, v162, v163
    v_cvt_pk_bf16_f32 v2, v164, v165
    v_lshlrev_b32 v164, 16, v2
    v_and_b32 v165, 0xffff0000, v2
    v_lshlrev_b32 v2, 16, v98
    v_and_b32 v3, 0xffff0000, v98
    v_pk_add_f32 v[164:165], v[164:165], v[2:3]
    v_cvt_pk_bf16_f32 v2, v164, v165
    v_lshlrev_b32 v164, 16, v2
    v_and_b32 v165, 0xffff0000, v2
    v_lshlrev_b32 v2, 16, v102
    v_and_b32 v3, 0xffff0000, v102
    v_pk_add_f32 v[164:165], v[164:165], v[2:3]
    v_cvt_pk_bf16_f32 v226, v164, v165
    v_cvt_pk_bf16_f32 v2, v166, v167
    v_lshlrev_b32 v166, 16, v2
    v_and_b32 v167, 0xffff0000, v2
    v_lshlrev_b32 v2, 16, v99
    v_and_b32 v3, 0xffff0000, v99
    v_pk_add_f32 v[166:167], v[166:167], v[2:3]
    v_cvt_pk_bf16_f32 v2, v166, v167
    v_lshlrev_b32 v166, 16, v2
    v_and_b32 v167, 0xffff0000, v2
    v_lshlrev_b32 v2, 16, v103
    v_and_b32 v3, 0xffff0000, v103
    v_pk_add_f32 v[166:167], v[166:167], v[2:3]
    v_cvt_pk_bf16_f32 v227, v166, v167
    buffer_store_dwordx4 v[224:227], v53, s[16:19], s70 offen
    s_cmp_ge_u32 s3, 2
    s_cbranch_scc1 L_end
    s_waitcnt lgkmcnt(0)
    v_pk_add_f32 v[192:193], v[192:193], v[200:201]
    v_pk_add_f32 v[194:195], v[194:195], v[202:203]
    v_pk_add_f32 v[196:197], v[196:197], v[204:205]
    v_pk_add_f32 v[198:199], v[198:199], v[206:207]
    v_pk_add_f32 v[192:193], v[192:193], v[208:209]
    v_pk_add_f32 v[194:195], v[194:195], v[210:211]
    v_pk_add_f32 v[196:197], v[196:197], v[212:213]
    v_pk_add_f32 v[198:199], v[198:199], v[214:215]
    v_pk_add_f32 v[192:193], v[192:193], v[216:217]
    v_pk_add_f32 v[194:195], v[194:195], v[218:219]
    v_pk_add_f32 v[196:197], v[196:197], v[220:221]
    v_pk_add_f32 v[198:199], v[198:199], v[222:223]
    s_nop 0
    v_pk_add_f32 v[192:193], v[192:193], v[136:137]
    v_pk_add_f32 v[194:195], v[194:195], v[138:139]
    v_pk_add_f32 v[196:197], v[196:197], v[140:141]
    v_pk_add_f32 v[198:199], v[198:199], v[142:143]
    v_pk_add_f32 v[192:193], v[192:193], v[144:145]
    v_pk_add_f32 v[194:195], v[194:195], v[146:147]
    v_pk_add_f32 v[196:197], v[196:197], v[148:149]
    v_pk_add_f32 v[198:199], v[198:199], v[150:151]
    v_pk_add_f32 v[192:193], v[192:193], v[152:153]
    v_pk_add_f32 v[194:195], v[194:195], v[154:155]
    v_pk_add_f32 v[196:197], v[196:197], v[156:157]
    v_pk_add_f32 v[198:199], v[198:199], v[158:159]
    v_cvt_pk_bf16_f32 v2, v192, v193
    v_lshlrev_b32 v192, 16, v2
    v_and_b32 v193, 0xffff0000, v2
    v_lshlrev_b32 v2, 16, v104
    v_and_b32 v3, 0xffff0000, v104
    v_pk_add_f32 v[192:193], v[192:193], v[2:3]
    v_cvt_pk_bf16_f32 v2, v192, v193
    v_lshlrev_b32 v192, 16, v2
    v_and_b32 v193, 0xffff0000, v2
    v_lshlrev_b32 v2, 16, v108
    v_and_b32 v3, 0xffff0000, v108
    v_pk_add_f32 v[192:193], v[192:193], v[2:3]
    v_cvt_pk_bf16_f32 v228, v192, v193
    v_cvt_pk_bf16_f32 v2, v194, v195
    v_lshlrev_b32 v194, 16, v2
    v_and_b32 v195, 0xffff0000, v2
    v_lshlrev_b32 v2, 16, v105
    v_and_b32 v3, 0xffff0000, v105
    v_pk_add_f32 v[194:195], v[194:195], v[2:3]
    v_cvt_pk_bf16_f32 v2, v194, v195
    v_lshlrev_b32 v194, 16, v2
    v_and_b32 v195, 0xffff0000, v2
    v_lshlrev_b32 v2, 16, v109
    v_and_b32 v3, 0xffff0000, v109
    v_pk_add_f32 v[194:195], v[194:195], v[2:3]
    v_cvt_pk_bf16_f32 v229, v194, v195
    v_cvt_pk_bf16_f32 v2, v196, v197
    v_lshlrev_b32 v196, 16, v2
    v_and_b32 v197, 0xffff0000, v2
    v_lshlrev_b32 v2, 16, v106
    v_and_b32 v3, 0xffff0000, v106
    v_pk_add_f32 v[196:197], v[196:197], v[2:3]
    v_cvt_pk_bf16_f32 v2, v196, v197
    v_lshlrev_b32 v196, 16, v2
    v_and_b32 v197, 0xffff0000, v2
    v_lshlrev_b32 v2, 16, v110
    v_and_b32 v3, 0xffff0000, v110
    v_pk_add_f32 v[196:197], v[196:197], v[2:3]
    v_cvt_pk_bf16_f32 v230, v196, v197
    v_cvt_pk_bf16_f32 v2, v198, v199
    v_lshlrev_b32 v198, 16, v2
    v_and_b32 v199, 0xffff0000, v2
    v_lshlrev_b32 v2, 16, v107
    v_and_b32 v3, 0xffff0000, v107
    v_pk_add_f32 v[198:199], v[198:199], v[2:3]
    v_cvt_pk_bf16_f32 v2, v198, v199
    v_lshlrev_b32 v198, 16, v2
    v_and_b32 v199, 0xffff0000, v2
    v_lshlrev_b32 v2, 16, v111
    v_and_b32 v3, 0xffff0000, v111
    v_pk_add_f32 v[198:199], v[198:199], v[2:3]
    v_cvt_pk_bf16_f32 v231, v198, v199
    buffer_store_dwordx4 v[228:231], v54, s[16:19], s70 offen
L_end:
L_exit:
    s_endpgm
.section .rodata,"a"
.p2align 6
.amdhsa_kernel parallel_sum__compressed_kv_cla__moe_arch_mod__prompt_kernel
  .amdhsa_next_free_vgpr 256
  .amdhsa_next_free_sgpr 102
  .amdhsa_accum_offset 256
  .amdhsa_group_segment_fixed_size 0
  .amdhsa_kernarg_size 112
  .amdhsa_user_sgpr_count 2
  .amdhsa_user_sgpr_kernarg_segment_ptr 1
  .amdhsa_system_sgpr_workgroup_id_x 1
  .amdhsa_float_denorm_mode_32 3
.end_amdhsa_kernel
```

```asm
; @launch grid=(256,1,1) block=(512,1,1) lds=163840
.amdgcn_target "amdgcn-amd-amdhsa--gfx950"
.text
.globl parallel_sum__compressed_kv_cla__moe_arch_mod__prompt_kernel
.p2align 8
.type parallel_sum__compressed_kv_cla__moe_arch_mod__prompt_kernel,@function
parallel_sum__compressed_kv_cla__moe_arch_mod__prompt_kernel:
    s_cmp_ge_u32 s2, 256
    s_cbranch_scc1 L_exit
    s_load_dwordx16 s[32:47], s[0:1], 0
    s_load_dwordx8 s[48:55], s[0:1], 64
    s_load_dwordx4 s[56:59], s[0:1], 96
    v_lshrrev_b32 v2, 6, v0
    v_and_b32 v1, 63, v0
    v_readfirstlane_b32 s3, v2
    s_getpc_b64 s[80:81]
L_pc:
    s_lshr_b32 s6, s2, 3
    s_and_b32 s6, s6, 15
    s_lshl_b32 s6, s6, 12
    s_cmp_lt_u32 s3, 2
    s_cselect_b32 s6, 0, s6
    v_lshl_add_u32 v3, v0, 6, s6
    v_min_u32 v3, L_exit-L_pc, v3
    s_cmp_ge_u32 s3, 3
    s_cbranch_scc1 L_noct
    global_load_dword v11, v3, s[80:81]
L_noct:
    v_lshrrev_b32 v62, 5, v0
    v_and_b32 v62, 7, v62
    v_and_b32 v2, 31, v0
    v_lshlrev_b32 v2, 3, v2
    v_mul_u32_u24 v63, 1280, v62
    v_add_u32 v63, v63, v2
    s_mul_i32 s6, s2, 10240
    v_add_u32 v10, s6, v63
    s_cmp_lt_u32 s3, 4
    s_cbranch_scc1 L_st_k0
    s_waitcnt lgkmcnt(0)
    global_load_dwordx2 v[16:17], v10, s[32:33] offset:0
    global_load_dwordx2 v[18:19], v10, s[32:33] offset:256
    global_load_dwordx2 v[20:21], v10, s[32:33] offset:512
    global_load_dwordx2 v[22:23], v10, s[32:33] offset:768
    global_load_dwordx2 v[24:25], v10, s[32:33] offset:1024
    global_load_dwordx2 v[26:27], v2, s[46:47] offset:0
    global_load_dwordx2 v[28:29], v2, s[46:47] offset:256
    global_load_dwordx2 v[30:31], v2, s[46:47] offset:512
    global_load_dwordx2 v[32:33], v2, s[46:47] offset:768
    global_load_dwordx2 v[34:35], v2, s[46:47] offset:1024
L_st_k0:
    s_and_b32 s6, s2, 7
    s_lshl_b32 s6, s6, 2
    s_lshr_b32 s7, s2, 3
    s_and_b32 s7, s7, 3
    s_add_u32 s4, s6, s7
    s_lshr_b32 s5, s2, 5
    s_and_b32 s76, s3, 3
    v_lshrrev_b32 v2, 3, v1
    v_and_b32 v3, 7, v1
    v_lshrrev_b32 v4, 4, v1
    v_xor_b32 v5, v3, v4
    v_lshlrev_b32 v5, 4, v5
    v_lshl_add_u32 v40, v2, 10, v5
    v_xor_b32 v5, 64, v40
    v_add_u32 v41, 7168, v5
    v_add_u32 v42, 14336, v40
    v_add_u32 v43, 14336, v41
    v_and_b32 v6, 15, v1
    s_lshl_b32 s6, s76, 4
    v_add_u32 v7, s6, v4
    v_lshlrev_b32 v5, 1, v4
    v_xor_b32 v5, v6, v5
    v_lshlrev_b32 v5, 4, v5
    v_lshl_add_u32 v44, v7, 13, v5
    v_add_u32 v45, 31744, v44
    v_xor_b32 v5, 0x80, v44
    v_add_u32 v46, 63488, v5
    v_add_u32 v47, 31744, v46
    s_and_b32 s6, s76, 1
    s_lshl_b32 s6, s6, 20
    s_lshr_b32 s7, s76, 1
    s_lshl_b32 s7, s7, 18
    s_add_u32 s6, s6, s7
    s_lshl_b32 s62, s5, 15
    s_add_u32 s62, s62, s6
    s_lshl_b32 s63, s4, 8
    s_lshl_b32 s64, s76, 13
    s_lshl_b32 s73, s76, 12
    s_add_u32 s73, s73, 32768
    s_waitcnt lgkmcnt(0)
    s_mov_b32 s12, s34
    s_mov_b32 s13, s35
    s_mov_b32 s14, 0x200000
    s_mov_b32 s15, 0x20000
    s_mov_b32 s16, s38
    s_mov_b32 s17, s39
    s_mov_b32 s18, 0x400000
    s_mov_b32 s19, 0x20000
    s_mov_b32 s20, s40
    s_mov_b32 s21, s41
    s_mov_b32 s22, 0x400000
    s_mov_b32 s23, 0x20000
    s_cmp_ge_u32 s3, 4
    s_cbranch_scc1 L_st_v0
    s_mov_b32 m0, s64
    s_add_u32 s72, s62, 524288
    buffer_load_dwordx4 v40, s[12:15], s62 offen offset:0 lds
    buffer_load_dwordx4 v41, s[12:15], s62 offen offset:1024 lds
    buffer_load_dwordx4 v42, s[12:15], s62 offen offset:2048 lds
    buffer_load_dwordx4 v43, s[12:15], s62 offen offset:3072 lds
    s_add_u32 m0, s64, 4096
    s_add_u32 s62, s62, 128
    s_bitset0_b32 s62, 10
    buffer_load_dwordx4 v40, s[12:15], s72 offen offset:0 lds
    buffer_load_dwordx4 v41, s[12:15], s72 offen offset:1024 lds
    buffer_load_dwordx4 v42, s[12:15], s72 offen offset:2048 lds
    buffer_load_dwordx4 v43, s[12:15], s72 offen offset:3072 lds
    s_mov_b32 m0, s73
    s_xor_b32 s64, s64, 0x10000
    buffer_load_dwordx4 v44, s[16:19], s63 offen offset:0 lds
    buffer_load_dwordx4 v45, s[16:19], s63 offen offset:1024 lds
    buffer_load_dwordx4 v46, s[16:19], s63 offen offset:2048 lds
    buffer_load_dwordx4 v47, s[16:19], s63 offen offset:3072 lds
    s_add_u32 m0, s73, 16384
    s_xor_b32 s73, s73, 0x10000
    buffer_load_dwordx4 v44, s[20:23], s63 offen offset:0 lds
    buffer_load_dwordx4 v45, s[20:23], s63 offen offset:1024 lds
    buffer_load_dwordx4 v46, s[20:23], s63 offen offset:2048 lds
    buffer_load_dwordx4 v47, s[20:23], s63 offen offset:3072 lds
    s_add_u32 s63, s63, 524288
    s_bitset0_b32 s63, 22
    s_setprio 1
L_st_v0:
    s_mov_b32 s8, s58
    s_mov_b32 s9, s59
    s_mov_b32 s10, 0x5000000
    s_mov_b32 s11, 0x20000
    s_mov_b32 s24, s36
    s_mov_b32 s25, s37
    s_mov_b32 s26, 0x500000
    s_mov_b32 s27, 0x20000
    v_lshlrev_b32 v13, 4, v1
    s_lshl_b32 s6, s5, 2
    s_add_u32 s7, s6, s3
    s_sub_u32 s6, 56, s6
    s_add_u32 s6, s6, s3
    s_cmp_lt_u32 s3, 4
    s_cselect_b32 s60, s7, s6
    s_sub_u32 s6, 2, s5
    s_and_b32 s6, s6, 7
    s_lshl_b32 s6, s6, 5
    s_add_u32 s61, s6, s4
    v_and_b32 v2, 15, v1
    v_lshrrev_b32 v3, 4, v1
    s_and_b32 s6, s3, 1
    s_lshl_b32 s6, s6, 7
    v_add_u32 v4, s6, v2
    v_lshlrev_b32 v4, 7, v4
    v_lshrrev_b32 v5, 1, v2
    v_add_u32 v6, 0, v3
    v_xor_b32 v6, v6, v5
    v_lshl_add_u32 v48, v6, 4, v4
    v_add_u32 v6, 4, v3
    v_xor_b32 v6, v6, v5
    v_lshl_add_u32 v49, v6, 4, v4
    v_lshrrev_b32 v4, 2, v2
    v_lshl_add_u32 v5, v3, 3, v4
    v_lshlrev_b32 v5, 8, v5
    v_and_b32 v6, 1, v2
    v_lshl_add_u32 v5, v6, 3, v5
    v_and_b32 v6, 1, v3
    v_lshl_or_b32 v4, v6, 2, v4
    v_lshlrev_b32 v4, 1, v4
    v_bfe_u32 v6, v2, 1, 1
    v_add_u32 v8, 131072, v5
    v_add_u32 v7, 0, v6
    v_xor_b32 v7, v7, v4
    v_lshl_add_u32 v54, v7, 4, v8
    v_add_u32 v7, 2, v6
    v_xor_b32 v7, v7, v4
    v_lshl_add_u32 v55, v7, 4, v8
    v_add_u32 v7, 4, v6
    v_xor_b32 v7, v7, v4
    v_lshl_add_u32 v56, v7, 4, v8
    v_add_u32 v7, 6, v6
    v_xor_b32 v7, v7, v4
    v_lshl_add_u32 v57, v7, 4, v8
    v_add_u32 v7, 8, v6
    v_xor_b32 v7, v7, v4
    v_lshl_add_u32 v58, v7, 4, v8
    v_add_u32 v7, 10, v6
    v_xor_b32 v7, v7, v4
    v_lshl_add_u32 v59, v7, 4, v8
    v_add_u32 v7, 12, v6
    v_xor_b32 v7, v7, v4
    v_lshl_add_u32 v60, v7, 4, v8
    v_add_u32 v7, 14, v6
    v_xor_b32 v7, v7, v4
    v_lshl_add_u32 v61, v7, 4, v8
    s_lshr_b32 s6, s3, 2
    s_lshl_b32 s6, s6, 14
    s_add_u32 s6, s6, 32768
    v_add_u32 v5, s6, v5
    s_lshr_b32 s7, s3, 1
    s_and_b32 s7, s7, 1
    s_lshl_b32 s7, s7, 3
    s_add_u32 s6, s7, 0
    v_add_u32 v7, s6, v6
    v_xor_b32 v7, v7, v4
    v_lshl_add_u32 v50, v7, 4, v5
    s_add_u32 s6, s7, 2
    v_add_u32 v7, s6, v6
    v_xor_b32 v7, v7, v4
    v_lshl_add_u32 v51, v7, 4, v5
    s_add_u32 s6, s7, 4
    v_add_u32 v7, s6, v6
    v_xor_b32 v7, v7, v4
    v_lshl_add_u32 v52, v7, 4, v5
    s_add_u32 s6, s7, 6
    v_add_u32 v7, s6, v6
    v_xor_b32 v7, v7, v4
    v_lshl_add_u32 v53, v7, 4, v5
    v_mov_b64 v[128:129], 0
    v_mov_b64 v[130:131], 0
    v_mov_b64 v[132:133], 0
    v_mov_b64 v[134:135], 0
    v_mov_b64 v[136:137], 0
    v_mov_b64 v[138:139], 0
    v_mov_b64 v[140:141], 0
    v_mov_b64 v[142:143], 0
    v_mov_b64 v[144:145], 0
    v_mov_b64 v[146:147], 0
    v_mov_b64 v[148:149], 0
    v_mov_b64 v[150:151], 0
    v_mov_b64 v[152:153], 0
    v_mov_b64 v[154:155], 0
    v_mov_b64 v[156:157], 0
    v_mov_b64 v[158:159], 0
    v_mov_b64 v[160:161], 0
    v_mov_b64 v[162:163], 0
    v_mov_b64 v[164:165], 0
    v_mov_b64 v[166:167], 0
    v_mov_b64 v[168:169], 0
    v_mov_b64 v[170:171], 0
    v_mov_b64 v[172:173], 0
    v_mov_b64 v[174:175], 0
    v_mov_b64 v[176:177], 0
    v_mov_b64 v[178:179], 0
    v_mov_b64 v[180:181], 0
    v_mov_b64 v[182:183], 0
    v_mov_b64 v[184:185], 0
    v_mov_b64 v[186:187], 0
    v_mov_b64 v[188:189], 0
    v_mov_b64 v[190:191], 0
    v_mov_b64 v[192:193], 0
    v_mov_b64 v[194:195], 0
    v_mov_b64 v[196:197], 0
    v_mov_b64 v[198:199], 0
    v_mov_b64 v[200:201], 0
    v_mov_b64 v[202:203], 0
    v_mov_b64 v[204:205], 0
    v_mov_b64 v[206:207], 0
    v_mov_b64 v[208:209], 0
    v_mov_b64 v[210:211], 0
    v_mov_b64 v[212:213], 0
    v_mov_b64 v[214:215], 0
    v_mov_b64 v[216:217], 0
    v_mov_b64 v[218:219], 0
    v_mov_b64 v[220:221], 0
    v_mov_b64 v[222:223], 0
    v_mov_b64 v[224:225], 0
    v_mov_b64 v[226:227], 0
    v_mov_b64 v[228:229], 0
    v_mov_b64 v[230:231], 0
    v_mov_b64 v[232:233], 0
    v_mov_b64 v[234:235], 0
    v_mov_b64 v[236:237], 0
    v_mov_b64 v[238:239], 0
    v_mov_b64 v[240:241], 0
    v_mov_b64 v[242:243], 0
    v_mov_b64 v[244:245], 0
    v_mov_b64 v[246:247], 0
    v_mov_b64 v[248:249], 0
    v_mov_b64 v[250:251], 0
    v_mov_b64 v[252:253], 0
    v_mov_b64 v[254:255], 0
    v_add_u32 v12, 20480, v13
    s_mul_i32 s70, s60, 40960
    s_mov_b32 s65, 0
    s_lshl_b32 s6, s4, 20
    s_lshl_b32 s7, s5, 13
    s_add_u32 s6, s6, s7
    s_and_b32 s7, s3, 1
    s_lshl_b32 s7, s7, 16
    s_add_u32 s6, s6, s7
    s_add_u32 s67, s6, 16777216
    s_and_b32 s6, s4, 3
    s_add_u32 s6, s6, s5
    s_sub_u32 s7, s6, 5
    s_cselect_b32 s6, s6, s7
    s_sub_u32 s7, s6, 5
    s_cselect_b32 s6, s6, s7
    s_lshl_b32 s71, s6, 20
    s_lshl_b32 s7, s4, 8
    s_add_u32 s71, s71, s7
    s_lshl_b32 s7, s6, 12
    s_add_u32 s84, s70, s7
    s_add_u32 s6, s6, 1
    s_cmp_eq_u32 s6, 5
    s_cselect_b32 s6, 0, s6
    s_lshl_b32 s7, s6, 12
    s_add_u32 s85, s70, s7
    s_add_u32 s6, s6, 1
    s_cmp_eq_u32 s6, 5
    s_cselect_b32 s6, 0, s6
    s_lshl_b32 s7, s6, 12
    s_add_u32 s86, s70, s7
    s_add_u32 s6, s6, 1
    s_cmp_eq_u32 s6, 5
    s_cselect_b32 s6, 0, s6
    s_lshl_b32 s7, s6, 12
    s_add_u32 s87, s70, s7
    s_add_u32 s6, s6, 1
    s_cmp_eq_u32 s6, 5
    s_cselect_b32 s6, 0, s6
    s_lshl_b32 s7, s6, 12
    s_add_u32 s88, s70, s7
    s_lshr_b32 s7, s3, 1
    s_and_b32 s7, s7, 1
    s_cmp_ge_u32 s3, 4
    s_cbranch_scc1 L_c_v
    s_lshl_b32 s7, s7, 11
    s_add_u32 s67, s67, s7
    s_movk_i32 s68, 3072
    s_mov_b32 s69, 125952
    s_add_u32 s71, s71, 1048576
    s_sub_u32 s75, s71, 5242880
    s_cselect_b32 s71, s71, s75
    s_lshl_b32 s74, s76, 12
    s_branch L_c_j
L_c_v:
    s_lshl_b32 s7, s7, 12
    s_add_u32 s67, s67, s7
    s_add_u32 s67, s67, 0x80000
    s_movk_i32 s68, 1024
    s_mov_b32 s69, 128000
L_c_j:
    s_cmp_ge_u32 s3, 4
    s_cbranch_scc1 L_st_v1
    s_mov_b32 m0, s64
    s_add_u32 s72, s62, 524288
    buffer_load_dwordx4 v40, s[12:15], s62 offen offset:0 lds
    buffer_load_dwordx4 v41, s[12:15], s62 offen offset:1024 lds
    buffer_load_dwordx4 v42, s[12:15], s62 offen offset:2048 lds
    buffer_load_dwordx4 v43, s[12:15], s62 offen offset:3072 lds
    s_add_u32 m0, s64, 4096
    s_add_u32 s62, s62, 128
    s_bitset0_b32 s62, 10
    buffer_load_dwordx4 v40, s[12:15], s72 offen offset:0 lds
    buffer_load_dwordx4 v41, s[12:15], s72 offen offset:1024 lds
    buffer_load_dwordx4 v42, s[12:15], s72 offen offset:2048 lds
    buffer_load_dwordx4 v43, s[12:15], s72 offen offset:3072 lds
    s_waitcnt vmcnt(8)
    s_branch L_st_j1
L_st_v1:
    s_waitcnt vmcnt(0)
    v_lshlrev_b32 v64, 16, v16
    v_and_b32 v65, 0xffff0000, v16
    v_lshlrev_b32 v66, 16, v17
    v_and_b32 v67, 0xffff0000, v17
    v_lshlrev_b32 v68, 16, v18
    v_and_b32 v69, 0xffff0000, v18
    v_lshlrev_b32 v70, 16, v19
    v_and_b32 v71, 0xffff0000, v19
    v_lshlrev_b32 v72, 16, v20
    v_and_b32 v73, 0xffff0000, v20
    v_lshlrev_b32 v74, 16, v21
    v_and_b32 v75, 0xffff0000, v21
    v_lshlrev_b32 v76, 16, v22
    v_and_b32 v77, 0xffff0000, v22
    v_lshlrev_b32 v78, 16, v23
    v_and_b32 v79, 0xffff0000, v23
    v_lshlrev_b32 v80, 16, v24
    v_and_b32 v81, 0xffff0000, v24
    v_lshlrev_b32 v82, 16, v25
    v_and_b32 v83, 0xffff0000, v25
    v_pk_add_f32 v[2:3], v[64:65], v[66:67]
    v_pk_add_f32 v[2:3], v[2:3], v[68:69]
    v_pk_add_f32 v[2:3], v[2:3], v[70:71]
    v_pk_add_f32 v[2:3], v[2:3], v[72:73]
    v_pk_add_f32 v[2:3], v[2:3], v[74:75]
    v_pk_add_f32 v[2:3], v[2:3], v[76:77]
    v_pk_add_f32 v[2:3], v[2:3], v[78:79]
    v_pk_add_f32 v[2:3], v[2:3], v[80:81]
    v_pk_add_f32 v[2:3], v[2:3], v[82:83]
    v_add_f32 v2, v2, v3
    s_nop 1
    v_add_f32_dpp v2, v2, v2 quad_perm:[1,0,3,2] row_mask:0xf bank_mask:0xf
    s_nop 1
    v_add_f32_dpp v2, v2, v2 quad_perm:[2,3,0,1] row_mask:0xf bank_mask:0xf
    s_nop 1
    v_add_f32_dpp v2, v2, v2 row_half_mirror row_mask:0xf bank_mask:0xf
    s_nop 1
    v_add_f32_dpp v2, v2, v2 row_mirror row_mask:0xf bank_mask:0xf
    v_mov_b32 v8, v2
    s_nop 1
    v_permlane16_swap_b32 v2, v8
    s_nop 1
    v_add_f32 v2, v2, v8
    s_mov_b32 s7, 0x3acccccd
    v_mul_f32 v2, s7, v2
    v_mov_b64 v[4:5], 0
    v_pk_add_f32 v[6:7], v[64:65], v[2:3] op_sel_hi:[1,0] neg_lo:[0,1] neg_hi:[0,1]
    v_pk_fma_f32 v[4:5], v[6:7], v[6:7], v[4:5]
    v_pk_add_f32 v[6:7], v[66:67], v[2:3] op_sel_hi:[1,0] neg_lo:[0,1] neg_hi:[0,1]
    v_pk_fma_f32 v[4:5], v[6:7], v[6:7], v[4:5]
    v_pk_add_f32 v[6:7], v[68:69], v[2:3] op_sel_hi:[1,0] neg_lo:[0,1] neg_hi:[0,1]
    v_pk_fma_f32 v[4:5], v[6:7], v[6:7], v[4:5]
    v_pk_add_f32 v[6:7], v[70:71], v[2:3] op_sel_hi:[1,0] neg_lo:[0,1] neg_hi:[0,1]
    v_pk_fma_f32 v[4:5], v[6:7], v[6:7], v[4:5]
    v_pk_add_f32 v[6:7], v[72:73], v[2:3] op_sel_hi:[1,0] neg_lo:[0,1] neg_hi:[0,1]
    v_pk_fma_f32 v[4:5], v[6:7], v[6:7], v[4:5]
    v_pk_add_f32 v[6:7], v[74:75], v[2:3] op_sel_hi:[1,0] neg_lo:[0,1] neg_hi:[0,1]
    v_pk_fma_f32 v[4:5], v[6:7], v[6:7], v[4:5]
    v_pk_add_f32 v[6:7], v[76:77], v[2:3] op_sel_hi:[1,0] neg_lo:[0,1] neg_hi:[0,1]
    v_pk_fma_f32 v[4:5], v[6:7], v[6:7], v[4:5]
    v_pk_add_f32 v[6:7], v[78:79], v[2:3] op_sel_hi:[1,0] neg_lo:[0,1] neg_hi:[0,1]
    v_pk_fma_f32 v[4:5], v[6:7], v[6:7], v[4:5]
    v_pk_add_f32 v[6:7], v[80:81], v[2:3] op_sel_hi:[1,0] neg_lo:[0,1] neg_hi:[0,1]
    v_pk_fma_f32 v[4:5], v[6:7], v[6:7], v[4:5]
    v_pk_add_f32 v[6:7], v[82:83], v[2:3] op_sel_hi:[1,0] neg_lo:[0,1] neg_hi:[0,1]
    v_pk_fma_f32 v[4:5], v[6:7], v[6:7], v[4:5]
    v_add_f32 v4, v4, v5
    s_nop 1
    v_add_f32_dpp v4, v4, v4 quad_perm:[1,0,3,2] row_mask:0xf bank_mask:0xf
    s_nop 1
    v_add_f32_dpp v4, v4, v4 quad_perm:[2,3,0,1] row_mask:0xf bank_mask:0xf
    s_nop 1
    v_add_f32_dpp v4, v4, v4 row_half_mirror row_mask:0xf bank_mask:0xf
    s_nop 1
    v_add_f32_dpp v4, v4, v4 row_mirror row_mask:0xf bank_mask:0xf
    v_mov_b32 v8, v4
    s_nop 1
    v_permlane16_swap_b32 v4, v8
    s_nop 1
    v_add_f32 v4, v4, v8
    v_mul_f32 v4, s7, v4
    v_cvt_pk_bf16_f32 v2, v2, v2
    v_lshlrev_b32 v2, 16, v2
    v_cvt_pk_bf16_f32 v4, v4, v4
    v_lshlrev_b32 v4, 16, v4
    v_add_f32 v4, 0x3727c5ac, v4
    v_cvt_pk_bf16_f32 v4, v4, v4
    v_lshlrev_b32 v4, 16, v4
    v_sqrt_f32 v4, v4
    s_nop 0
    v_cvt_pk_bf16_f32 v4, v4, v4
    v_lshlrev_b32 v4, 16, v4
    v_rcp_f32 v6, v4
    s_nop 0
    v_fma_f32 v5, -v4, v6, 1.0
    v_fmac_f32 v6, v5, v6
    v_mov_b32 v9, 0
    v_pk_add_f32 v[64:65], v[64:65], v[2:3] op_sel_hi:[1,0] neg_lo:[0,1] neg_hi:[0,1]
    v_cvt_pk_bf16_f32 v5, v64, v65
    v_lshlrev_b32 v64, 16, v5
    v_and_b32 v65, 0xffff0000, v5
    v_pk_mul_f32 v[64:65], v[64:65], v[6:7] op_sel_hi:[1,0]
    v_cvt_pk_bf16_f32 v16, v64, v65
    v_pk_add_f32 v[66:67], v[66:67], v[2:3] op_sel_hi:[1,0] neg_lo:[0,1] neg_hi:[0,1]
    v_cvt_pk_bf16_f32 v5, v66, v67
    v_lshlrev_b32 v66, 16, v5
    v_and_b32 v67, 0xffff0000, v5
    v_pk_mul_f32 v[66:67], v[66:67], v[6:7] op_sel_hi:[1,0]
    v_cvt_pk_bf16_f32 v17, v66, v67
    v_pk_add_f32 v[68:69], v[68:69], v[2:3] op_sel_hi:[1,0] neg_lo:[0,1] neg_hi:[0,1]
    v_cvt_pk_bf16_f32 v5, v68, v69
    v_lshlrev_b32 v68, 16, v5
    v_and_b32 v69, 0xffff0000, v5
    v_pk_mul_f32 v[68:69], v[68:69], v[6:7] op_sel_hi:[1,0]
    v_cvt_pk_bf16_f32 v18, v68, v69
    v_pk_add_f32 v[70:71], v[70:71], v[2:3] op_sel_hi:[1,0] neg_lo:[0,1] neg_hi:[0,1]
    v_cvt_pk_bf16_f32 v5, v70, v71
    v_lshlrev_b32 v70, 16, v5
    v_and_b32 v71, 0xffff0000, v5
    v_pk_mul_f32 v[70:71], v[70:71], v[6:7] op_sel_hi:[1,0]
    v_cvt_pk_bf16_f32 v19, v70, v71
    v_pk_add_f32 v[72:73], v[72:73], v[2:3] op_sel_hi:[1,0] neg_lo:[0,1] neg_hi:[0,1]
    v_cvt_pk_bf16_f32 v5, v72, v73
    v_lshlrev_b32 v72, 16, v5
    v_and_b32 v73, 0xffff0000, v5
    v_pk_mul_f32 v[72:73], v[72:73], v[6:7] op_sel_hi:[1,0]
    v_cvt_pk_bf16_f32 v20, v72, v73
    v_pk_add_f32 v[74:75], v[74:75], v[2:3] op_sel_hi:[1,0] neg_lo:[0,1] neg_hi:[0,1]
    v_cvt_pk_bf16_f32 v5, v74, v75
    v_lshlrev_b32 v74, 16, v5
    v_and_b32 v75, 0xffff0000, v5
    v_pk_mul_f32 v[74:75], v[74:75], v[6:7] op_sel_hi:[1,0]
    v_cvt_pk_bf16_f32 v21, v74, v75
    v_pk_add_f32 v[76:77], v[76:77], v[2:3] op_sel_hi:[1,0] neg_lo:[0,1] neg_hi:[0,1]
    v_cvt_pk_bf16_f32 v5, v76, v77
    v_lshlrev_b32 v76, 16, v5
    v_and_b32 v77, 0xffff0000, v5
    v_pk_mul_f32 v[76:77], v[76:77], v[6:7] op_sel_hi:[1,0]
    v_cvt_pk_bf16_f32 v22, v76, v77
    v_pk_add_f32 v[78:79], v[78:79], v[2:3] op_sel_hi:[1,0] neg_lo:[0,1] neg_hi:[0,1]
    v_cvt_pk_bf16_f32 v5, v78, v79
    v_lshlrev_b32 v78, 16, v5
    v_and_b32 v79, 0xffff0000, v5
    v_pk_mul_f32 v[78:79], v[78:79], v[6:7] op_sel_hi:[1,0]
    v_cvt_pk_bf16_f32 v23, v78, v79
    v_pk_add_f32 v[80:81], v[80:81], v[2:3] op_sel_hi:[1,0] neg_lo:[0,1] neg_hi:[0,1]
    v_cvt_pk_bf16_f32 v5, v80, v81
    v_lshlrev_b32 v80, 16, v5
    v_and_b32 v81, 0xffff0000, v5
    v_pk_mul_f32 v[80:81], v[80:81], v[6:7] op_sel_hi:[1,0]
    v_cvt_pk_bf16_f32 v24, v80, v81
    v_pk_add_f32 v[82:83], v[82:83], v[2:3] op_sel_hi:[1,0] neg_lo:[0,1] neg_hi:[0,1]
    v_cvt_pk_bf16_f32 v5, v82, v83
    v_lshlrev_b32 v82, 16, v5
    v_and_b32 v83, 0xffff0000, v5
    v_pk_mul_f32 v[82:83], v[82:83], v[6:7] op_sel_hi:[1,0]
    v_cvt_pk_bf16_f32 v25, v82, v83
    v_add_u32 v10, 131072, v63
    ds_write_b64 v10, v[16:17] offset:0
    ds_write_b64 v10, v[18:19] offset:256
    ds_write_b64 v10, v[20:21] offset:512
    ds_write_b64 v10, v[22:23] offset:768
    ds_write_b64 v10, v[24:25] offset:1024
    s_waitcnt lgkmcnt(0)
    v_mov_b32 v2, 0
    v_lshlrev_b32 v4, 16, v16
    v_lshlrev_b32 v5, 16, v26
    v_fmac_f32 v2, v4, v5
    v_and_b32 v4, 0xffff0000, v16
    v_and_b32 v5, 0xffff0000, v26
    v_fmac_f32 v2, v4, v5
    v_lshlrev_b32 v4, 16, v17
    v_lshlrev_b32 v5, 16, v27
    v_fmac_f32 v2, v4, v5
    v_and_b32 v4, 0xffff0000, v17
    v_and_b32 v5, 0xffff0000, v27
    v_fmac_f32 v2, v4, v5
    v_lshlrev_b32 v4, 16, v18
    v_lshlrev_b32 v5, 16, v28
    v_fmac_f32 v2, v4, v5
    v_and_b32 v4, 0xffff0000, v18
    v_and_b32 v5, 0xffff0000, v28
    v_fmac_f32 v2, v4, v5
    v_lshlrev_b32 v4, 16, v19
    v_lshlrev_b32 v5, 16, v29
    v_fmac_f32 v2, v4, v5
    v_and_b32 v4, 0xffff0000, v19
    v_and_b32 v5, 0xffff0000, v29
    v_fmac_f32 v2, v4, v5
    v_lshlrev_b32 v4, 16, v20
    v_lshlrev_b32 v5, 16, v30
    v_fmac_f32 v2, v4, v5
    v_and_b32 v4, 0xffff0000, v20
    v_and_b32 v5, 0xffff0000, v30
    v_fmac_f32 v2, v4, v5
    v_lshlrev_b32 v4, 16, v21
    v_lshlrev_b32 v5, 16, v31
    v_fmac_f32 v2, v4, v5
    v_and_b32 v4, 0xffff0000, v21
    v_and_b32 v5, 0xffff0000, v31
    v_fmac_f32 v2, v4, v5
    v_lshlrev_b32 v4, 16, v22
    v_lshlrev_b32 v5, 16, v32
    v_fmac_f32 v2, v4, v5
    v_and_b32 v4, 0xffff0000, v22
    v_and_b32 v5, 0xffff0000, v32
    v_fmac_f32 v2, v4, v5
    v_lshlrev_b32 v4, 16, v23
    v_lshlrev_b32 v5, 16, v33
    v_fmac_f32 v2, v4, v5
    v_and_b32 v4, 0xffff0000, v23
    v_and_b32 v5, 0xffff0000, v33
    v_fmac_f32 v2, v4, v5
    v_lshlrev_b32 v4, 16, v24
    v_lshlrev_b32 v5, 16, v34
    v_fmac_f32 v2, v4, v5
    v_and_b32 v4, 0xffff0000, v24
    v_and_b32 v5, 0xffff0000, v34
    v_fmac_f32 v2, v4, v5
    v_lshlrev_b32 v4, 16, v25
    v_lshlrev_b32 v5, 16, v35
    v_fmac_f32 v2, v4, v5
    v_and_b32 v4, 0xffff0000, v25
    v_and_b32 v5, 0xffff0000, v35
    v_fmac_f32 v2, v4, v5
    s_nop 1
    v_add_f32_dpp v2, v2, v2 quad_perm:[1,0,3,2] row_mask:0xf bank_mask:0xf
    s_nop 1
    v_add_f32_dpp v2, v2, v2 quad_perm:[2,3,0,1] row_mask:0xf bank_mask:0xf
    s_nop 1
    v_add_f32_dpp v2, v2, v2 row_half_mirror row_mask:0xf bank_mask:0xf
    s_nop 1
    v_add_f32_dpp v2, v2, v2 row_mirror row_mask:0xf bank_mask:0xf
    v_mov_b32 v8, v2
    s_nop 1
    v_permlane16_swap_b32 v2, v8
    s_nop 1
    v_add_f32 v2, v2, v8
    v_cvt_pk_bf16_f32 v2, v2, v2
    v_and_b32 v2, 0xffff, v2
    v_bfe_i32 v3, v2, 15, 1
    v_and_b32 v3, 0x7fff, v3
    v_or_b32 v3, 0x8000, v3
    v_xor_b32 v2, v2, v3
    s_lshl_b32 s7, s2, 3
    s_sub_u32 s6, 2047, s7
    v_sub_u32 v3, s6, v62
    v_lshl_or_b32 v2, v2, 11, v3
    v_lshlrev_b32 v3, 2, v62
    v_add_u32 v3, 161792, v3
    ds_write_b32 v3, v2
    s_waitcnt lgkmcnt(0)
L_st_j1:
    s_barrier
    s_cmp_ge_u32 s3, 4
    s_cbranch_scc1 L_kv_v
    ds_read_b128 v[64:67], v48 offset:0
    ds_read_b128 v[68:71], v48 offset:2048
    ds_read_b64_tr_b16 v[96:97], v50 offset:0
    ds_read_b64_tr_b16 v[98:99], v50 offset:1024
    ds_read_b64_tr_b16 v[100:101], v51 offset:0
    ds_read_b64_tr_b16 v[102:103], v51 offset:1024
    ds_read_b128 v[72:75], v48 offset:4096
    ds_read_b64_tr_b16 v[104:105], v52 offset:0
    ds_read_b64_tr_b16 v[106:107], v52 offset:1024
    ds_read_b64_tr_b16 v[108:109], v53 offset:0
    ds_read_b64_tr_b16 v[110:111], v53 offset:1024
    ds_read_b128 v[76:79], v48 offset:6144
    ds_read_b128 v[80:83], v48 offset:8192
    ds_read_b128 v[84:87], v48 offset:10240
    ds_read_b128 v[88:91], v48 offset:12288
    ds_read_b128 v[92:95], v48 offset:14336
    s_mov_b32 m0, s73
    s_xor_b32 s64, s64, 0x10000
    buffer_load_dwordx4 v44, s[16:19], s63 offen offset:0 lds
    buffer_load_dwordx4 v45, s[16:19], s63 offen offset:1024 lds
    buffer_load_dwordx4 v46, s[16:19], s63 offen offset:2048 lds
    buffer_load_dwordx4 v47, s[16:19], s63 offen offset:3072 lds
    s_add_u32 m0, s73, 16384
    s_xor_b32 s73, s73, 0x10000
    buffer_load_dwordx4 v44, s[20:23], s63 offen offset:0 lds
    buffer_load_dwordx4 v45, s[20:23], s63 offen offset:1024 lds
    buffer_load_dwordx4 v46, s[20:23], s63 offen offset:2048 lds
    buffer_load_dwordx4 v47, s[20:23], s63 offen offset:3072 lds
    s_add_u32 s63, s63, 524288
    s_bitset0_b32 s63, 22
.p2align 4
L_kloopA:
    s_waitcnt lgkmcnt(12)
    v_mfma_f32_16x16x32_bf16 v[128:131], v[96:99], v[64:67], v[128:131]
    ds_read_b64_tr_b16 v[112:113], v50 offset:8192
    s_waitcnt lgkmcnt(11)
    v_mfma_f32_16x16x32_bf16 v[132:135], v[100:103], v[64:67], v[132:135]
    ds_read_b64_tr_b16 v[114:115], v50 offset:9216
    s_waitcnt lgkmcnt(9)
    v_mfma_f32_16x16x32_bf16 v[136:139], v[104:107], v[64:67], v[136:139]
    ds_read_b64_tr_b16 v[116:117], v51 offset:8192
    s_waitcnt lgkmcnt(8)
    v_mfma_f32_16x16x32_bf16 v[140:143], v[108:111], v[64:67], v[140:143]
    ds_read_b64_tr_b16 v[118:119], v51 offset:9216
    ds_read_b128 v[64:67], v49 offset:0
    v_mfma_f32_16x16x32_bf16 v[144:147], v[96:99], v[68:71], v[144:147]
    ds_read_b64_tr_b16 v[120:121], v52 offset:8192
    v_mfma_f32_16x16x32_bf16 v[148:151], v[100:103], v[68:71], v[148:151]
    ds_read_b64_tr_b16 v[122:123], v52 offset:9216
    v_mfma_f32_16x16x32_bf16 v[152:155], v[104:107], v[68:71], v[152:155]
    ds_read_b64_tr_b16 v[124:125], v53 offset:8192
    v_mfma_f32_16x16x32_bf16 v[156:159], v[108:111], v[68:71], v[156:159]
    ds_read_b64_tr_b16 v[126:127], v53 offset:9216
    ds_read_b128 v[68:71], v49 offset:2048
    v_mfma_f32_16x16x32_bf16 v[160:163], v[96:99], v[72:75], v[160:163]
    v_mfma_f32_16x16x32_bf16 v[164:167], v[100:103], v[72:75], v[164:167]
    v_mfma_f32_16x16x32_bf16 v[168:171], v[104:107], v[72:75], v[168:171]
    v_mfma_f32_16x16x32_bf16 v[172:175], v[108:111], v[72:75], v[172:175]
    ds_read_b128 v[72:75], v49 offset:4096
    s_waitcnt lgkmcnt(15)
    v_mfma_f32_16x16x32_bf16 v[176:179], v[96:99], v[76:79], v[176:179]
    v_mfma_f32_16x16x32_bf16 v[180:183], v[100:103], v[76:79], v[180:183]
    v_mfma_f32_16x16x32_bf16 v[184:187], v[104:107], v[76:79], v[184:187]
    v_mfma_f32_16x16x32_bf16 v[188:191], v[108:111], v[76:79], v[188:191]
    ds_read_b128 v[76:79], v49 offset:6144
    s_waitcnt lgkmcnt(15)
    v_mfma_f32_16x16x32_bf16 v[192:195], v[96:99], v[80:83], v[192:195]
    v_mfma_f32_16x16x32_bf16 v[196:199], v[100:103], v[80:83], v[196:199]
    v_mfma_f32_16x16x32_bf16 v[200:203], v[104:107], v[80:83], v[200:203]
    v_mfma_f32_16x16x32_bf16 v[204:207], v[108:111], v[80:83], v[204:207]
    ds_read_b128 v[80:83], v49 offset:8192
    s_waitcnt lgkmcnt(15)
    v_mfma_f32_16x16x32_bf16 v[208:211], v[96:99], v[84:87], v[208:211]
    v_mfma_f32_16x16x32_bf16 v[212:215], v[100:103], v[84:87], v[212:215]
    v_mfma_f32_16x16x32_bf16 v[216:219], v[104:107], v[84:87], v[216:219]
    v_mfma_f32_16x16x32_bf16 v[220:223], v[108:111], v[84:87], v[220:223]
    ds_read_b128 v[84:87], v49 offset:10240
    s_waitcnt lgkmcnt(15)
    v_mfma_f32_16x16x32_bf16 v[224:227], v[96:99], v[88:91], v[224:227]
    v_mfma_f32_16x16x32_bf16 v[228:231], v[100:103], v[88:91], v[228:231]
    v_mfma_f32_16x16x32_bf16 v[232:235], v[104:107], v[88:91], v[232:235]
    v_mfma_f32_16x16x32_bf16 v[236:239], v[108:111], v[88:91], v[236:239]
    ds_read_b128 v[88:91], v49 offset:12288
    s_waitcnt lgkmcnt(15)
    v_mfma_f32_16x16x32_bf16 v[240:243], v[96:99], v[92:95], v[240:243]
    v_mfma_f32_16x16x32_bf16 v[244:247], v[100:103], v[92:95], v[244:247]
    v_mfma_f32_16x16x32_bf16 v[248:251], v[104:107], v[92:95], v[248:251]
    v_mfma_f32_16x16x32_bf16 v[252:255], v[108:111], v[92:95], v[252:255]
    ds_read_b128 v[92:95], v49 offset:14336
    s_waitcnt lgkmcnt(11)
    v_mfma_f32_16x16x32_bf16 v[128:131], v[112:115], v[64:67], v[128:131]
    v_mfma_f32_16x16x32_bf16 v[132:135], v[116:119], v[64:67], v[132:135]
    s_waitcnt lgkmcnt(9)
    v_mfma_f32_16x16x32_bf16 v[136:139], v[120:123], v[64:67], v[136:139]
    s_waitcnt lgkmcnt(7)
    v_mfma_f32_16x16x32_bf16 v[140:143], v[124:127], v[64:67], v[140:143]
    s_waitcnt lgkmcnt(6)
    v_mfma_f32_16x16x32_bf16 v[144:147], v[112:115], v[68:71], v[144:147]
    v_mfma_f32_16x16x32_bf16 v[148:151], v[116:119], v[68:71], v[148:151]
    v_mfma_f32_16x16x32_bf16 v[152:155], v[120:123], v[68:71], v[152:155]
    v_mfma_f32_16x16x32_bf16 v[156:159], v[124:127], v[68:71], v[156:159]
    v_xor_b32 v48, 0x10000, v48
    v_xor_b32 v49, 0x10000, v49
    v_xor_b32 v50, 0x10000, v50
    v_xor_b32 v51, 0x10000, v51
    v_xor_b32 v52, 0x10000, v52
    v_xor_b32 v53, 0x10000, v53
    s_waitcnt vmcnt(0) lgkmcnt(0)
    s_barrier
    ds_read_b128 v[64:67], v48 offset:0
    ds_read_b128 v[68:71], v48 offset:2048
    v_mfma_f32_16x16x32_bf16 v[160:163], v[112:115], v[72:75], v[160:163]
    ds_read_b64_tr_b16 v[96:97], v50 offset:0
    s_mov_b32 m0, s64
    s_add_u32 s72, s62, 524288
    v_mfma_f32_16x16x32_bf16 v[164:167], v[116:119], v[72:75], v[164:167]
    ds_read_b64_tr_b16 v[98:99], v50 offset:1024
    buffer_load_dwordx4 v40, s[12:15], s62 offen offset:0 lds
    v_mfma_f32_16x16x32_bf16 v[168:171], v[120:123], v[72:75], v[168:171]
    ds_read_b64_tr_b16 v[100:101], v51 offset:0
    buffer_load_dwordx4 v41, s[12:15], s62 offen offset:1024 lds
    v_mfma_f32_16x16x32_bf16 v[172:175], v[124:127], v[72:75], v[172:175]
    ds_read_b64_tr_b16 v[102:103], v51 offset:1024
    buffer_load_dwordx4 v42, s[12:15], s62 offen offset:2048 lds
    ds_read_b128 v[72:75], v48 offset:4096
    v_mfma_f32_16x16x32_bf16 v[176:179], v[112:115], v[76:79], v[176:179]
    ds_read_b64_tr_b16 v[104:105], v52 offset:0
    buffer_load_dwordx4 v43, s[12:15], s62 offen offset:3072 lds
    v_mfma_f32_16x16x32_bf16 v[180:183], v[116:119], v[76:79], v[180:183]
    ds_read_b64_tr_b16 v[106:107], v52 offset:1024
    s_add_u32 m0, s64, 4096
    s_add_u32 s62, s62, 128
    s_bitset0_b32 s62, 10
    v_mfma_f32_16x16x32_bf16 v[184:187], v[120:123], v[76:79], v[184:187]
    ds_read_b64_tr_b16 v[108:109], v53 offset:0
    buffer_load_dwordx4 v40, s[12:15], s72 offen offset:0 lds
    v_mfma_f32_16x16x32_bf16 v[188:191], v[124:127], v[76:79], v[188:191]
    ds_read_b64_tr_b16 v[110:111], v53 offset:1024
    buffer_load_dwordx4 v41, s[12:15], s72 offen offset:1024 lds
    ds_read_b128 v[76:79], v48 offset:6144
    v_mfma_f32_16x16x32_bf16 v[192:195], v[112:115], v[80:83], v[192:195]
    buffer_load_dwordx4 v42, s[12:15], s72 offen offset:2048 lds
    v_mfma_f32_16x16x32_bf16 v[196:199], v[116:119], v[80:83], v[196:199]
    buffer_load_dwordx4 v43, s[12:15], s72 offen offset:3072 lds
    v_mfma_f32_16x16x32_bf16 v[200:203], v[120:123], v[80:83], v[200:203]
    s_mov_b32 m0, s73
    s_xor_b32 s64, s64, 0x10000
    v_mfma_f32_16x16x32_bf16 v[204:207], v[124:127], v[80:83], v[204:207]
    buffer_load_dwordx4 v44, s[16:19], s63 offen offset:0 lds
    ds_read_b128 v[80:83], v48 offset:8192
    v_mfma_f32_16x16x32_bf16 v[208:211], v[112:115], v[84:87], v[208:211]
    buffer_load_dwordx4 v45, s[16:19], s63 offen offset:1024 lds
    v_mfma_f32_16x16x32_bf16 v[212:215], v[116:119], v[84:87], v[212:215]
    buffer_load_dwordx4 v46, s[16:19], s63 offen offset:2048 lds
    v_mfma_f32_16x16x32_bf16 v[216:219], v[120:123], v[84:87], v[216:219]
    buffer_load_dwordx4 v47, s[16:19], s63 offen offset:3072 lds
    v_mfma_f32_16x16x32_bf16 v[220:223], v[124:127], v[84:87], v[220:223]
    s_add_u32 m0, s73, 16384
    s_xor_b32 s73, s73, 0x10000
    ds_read_b128 v[84:87], v48 offset:10240
    v_mfma_f32_16x16x32_bf16 v[224:227], v[112:115], v[88:91], v[224:227]
    buffer_load_dwordx4 v44, s[20:23], s63 offen offset:0 lds
    v_mfma_f32_16x16x32_bf16 v[228:231], v[116:119], v[88:91], v[228:231]
    buffer_load_dwordx4 v45, s[20:23], s63 offen offset:1024 lds
    v_mfma_f32_16x16x32_bf16 v[232:235], v[120:123], v[88:91], v[232:235]
    buffer_load_dwordx4 v46, s[20:23], s63 offen offset:2048 lds
    v_mfma_f32_16x16x32_bf16 v[236:239], v[124:127], v[88:91], v[236:239]
    buffer_load_dwordx4 v47, s[20:23], s63 offen offset:3072 lds
    ds_read_b128 v[88:91], v48 offset:12288
    v_mfma_f32_16x16x32_bf16 v[240:243], v[112:115], v[92:95], v[240:243]
    s_add_u32 s63, s63, 524288
    s_bitset0_b32 s63, 22
    v_mfma_f32_16x16x32_bf16 v[244:247], v[116:119], v[92:95], v[244:247]
    v_mfma_f32_16x16x32_bf16 v[248:251], v[120:123], v[92:95], v[248:251]
    v_mfma_f32_16x16x32_bf16 v[252:255], v[124:127], v[92:95], v[252:255]
    ds_read_b128 v[92:95], v48 offset:14336
    s_add_u32 s65, s65, 1
    s_cmp_lt_u32 s65, 6
    s_cbranch_scc1 L_kloopA
.p2align 4
L_kloopB:
    s_bitcmp1_b32 128, s65
    s_cbranch_scc1 L_khook
L_khook_back:
    s_waitcnt lgkmcnt(12)
    v_mfma_f32_16x16x32_bf16 v[128:131], v[96:99], v[64:67], v[128:131]
    ds_read_b64_tr_b16 v[112:113], v50 offset:8192
    s_waitcnt lgkmcnt(11)
    v_mfma_f32_16x16x32_bf16 v[132:135], v[100:103], v[64:67], v[132:135]
    ds_read_b64_tr_b16 v[114:115], v50 offset:9216
    s_waitcnt lgkmcnt(9)
    v_mfma_f32_16x16x32_bf16 v[136:139], v[104:107], v[64:67], v[136:139]
    ds_read_b64_tr_b16 v[116:117], v51 offset:8192
    s_waitcnt lgkmcnt(8)
    v_mfma_f32_16x16x32_bf16 v[140:143], v[108:111], v[64:67], v[140:143]
    ds_read_b64_tr_b16 v[118:119], v51 offset:9216
    ds_read_b128 v[64:67], v49 offset:0
    v_mfma_f32_16x16x32_bf16 v[144:147], v[96:99], v[68:71], v[144:147]
    ds_read_b64_tr_b16 v[120:121], v52 offset:8192
    v_mfma_f32_16x16x32_bf16 v[148:151], v[100:103], v[68:71], v[148:151]
    ds_read_b64_tr_b16 v[122:123], v52 offset:9216
    v_mfma_f32_16x16x32_bf16 v[152:155], v[104:107], v[68:71], v[152:155]
    ds_read_b64_tr_b16 v[124:125], v53 offset:8192
    v_mfma_f32_16x16x32_bf16 v[156:159], v[108:111], v[68:71], v[156:159]
    ds_read_b64_tr_b16 v[126:127], v53 offset:9216
    ds_read_b128 v[68:71], v49 offset:2048
    v_mfma_f32_16x16x32_bf16 v[160:163], v[96:99], v[72:75], v[160:163]
    v_mfma_f32_16x16x32_bf16 v[164:167], v[100:103], v[72:75], v[164:167]
    v_mfma_f32_16x16x32_bf16 v[168:171], v[104:107], v[72:75], v[168:171]
    v_mfma_f32_16x16x32_bf16 v[172:175], v[108:111], v[72:75], v[172:175]
    ds_read_b128 v[72:75], v49 offset:4096
    s_waitcnt lgkmcnt(15)
    v_mfma_f32_16x16x32_bf16 v[176:179], v[96:99], v[76:79], v[176:179]
    v_mfma_f32_16x16x32_bf16 v[180:183], v[100:103], v[76:79], v[180:183]
    v_mfma_f32_16x16x32_bf16 v[184:187], v[104:107], v[76:79], v[184:187]
    v_mfma_f32_16x16x32_bf16 v[188:191], v[108:111], v[76:79], v[188:191]
    ds_read_b128 v[76:79], v49 offset:6144
    s_waitcnt lgkmcnt(15)
    v_mfma_f32_16x16x32_bf16 v[192:195], v[96:99], v[80:83], v[192:195]
    v_mfma_f32_16x16x32_bf16 v[196:199], v[100:103], v[80:83], v[196:199]
    v_mfma_f32_16x16x32_bf16 v[200:203], v[104:107], v[80:83], v[200:203]
    v_mfma_f32_16x16x32_bf16 v[204:207], v[108:111], v[80:83], v[204:207]
    ds_read_b128 v[80:83], v49 offset:8192
    s_waitcnt lgkmcnt(15)
    v_mfma_f32_16x16x32_bf16 v[208:211], v[96:99], v[84:87], v[208:211]
    v_mfma_f32_16x16x32_bf16 v[212:215], v[100:103], v[84:87], v[212:215]
    v_mfma_f32_16x16x32_bf16 v[216:219], v[104:107], v[84:87], v[216:219]
    v_mfma_f32_16x16x32_bf16 v[220:223], v[108:111], v[84:87], v[220:223]
    ds_read_b128 v[84:87], v49 offset:10240
    s_waitcnt lgkmcnt(15)
    v_mfma_f32_16x16x32_bf16 v[224:227], v[96:99], v[88:91], v[224:227]
    v_mfma_f32_16x16x32_bf16 v[228:231], v[100:103], v[88:91], v[228:231]
    v_mfma_f32_16x16x32_bf16 v[232:235], v[104:107], v[88:91], v[232:235]
    v_mfma_f32_16x16x32_bf16 v[236:239], v[108:111], v[88:91], v[236:239]
    ds_read_b128 v[88:91], v49 offset:12288
    s_waitcnt lgkmcnt(15)
    v_mfma_f32_16x16x32_bf16 v[240:243], v[96:99], v[92:95], v[240:243]
    v_mfma_f32_16x16x32_bf16 v[244:247], v[100:103], v[92:95], v[244:247]
    v_mfma_f32_16x16x32_bf16 v[248:251], v[104:107], v[92:95], v[248:251]
    v_mfma_f32_16x16x32_bf16 v[252:255], v[108:111], v[92:95], v[252:255]
    ds_read_b128 v[92:95], v49 offset:14336
    s_waitcnt lgkmcnt(11)
    v_mfma_f32_16x16x32_bf16 v[128:131], v[112:115], v[64:67], v[128:131]
    v_mfma_f32_16x16x32_bf16 v[132:135], v[116:119], v[64:67], v[132:135]
    s_waitcnt lgkmcnt(9)
    v_mfma_f32_16x16x32_bf16 v[136:139], v[120:123], v[64:67], v[136:139]
    s_waitcnt lgkmcnt(7)
    v_mfma_f32_16x16x32_bf16 v[140:143], v[124:127], v[64:67], v[140:143]
    s_waitcnt lgkmcnt(6)
    v_mfma_f32_16x16x32_bf16 v[144:147], v[112:115], v[68:71], v[144:147]
    v_mfma_f32_16x16x32_bf16 v[148:151], v[116:119], v[68:71], v[148:151]
    v_mfma_f32_16x16x32_bf16 v[152:155], v[120:123], v[68:71], v[152:155]
    v_mfma_f32_16x16x32_bf16 v[156:159], v[124:127], v[68:71], v[156:159]
    v_xor_b32 v48, 0x10000, v48
    v_xor_b32 v49, 0x10000, v49
    v_xor_b32 v50, 0x10000, v50
    v_xor_b32 v51, 0x10000, v51
    v_xor_b32 v52, 0x10000, v52
    v_xor_b32 v53, 0x10000, v53
    s_waitcnt vmcnt(0) lgkmcnt(0)
    s_barrier
    ds_read_b128 v[64:67], v48 offset:0
    ds_read_b128 v[68:71], v48 offset:2048
    v_mfma_f32_16x16x32_bf16 v[160:163], v[112:115], v[72:75], v[160:163]
    ds_read_b64_tr_b16 v[96:97], v50 offset:0
    s_mov_b32 m0, s74
    s_add_u32 s74, s74, 16384
    v_mfma_f32_16x16x32_bf16 v[164:167], v[116:119], v[72:75], v[164:167]
    ds_read_b64_tr_b16 v[98:99], v50 offset:1024
    buffer_load_dwordx4 v44, s[24:27], s71 offen offset:0 lds
    v_mfma_f32_16x16x32_bf16 v[168:171], v[120:123], v[72:75], v[168:171]
    ds_read_b64_tr_b16 v[100:101], v51 offset:0
    buffer_load_dwordx4 v45, s[24:27], s71 offen offset:1024 lds
    v_mfma_f32_16x16x32_bf16 v[172:175], v[124:127], v[72:75], v[172:175]
    ds_read_b64_tr_b16 v[102:103], v51 offset:1024
    buffer_load_dwordx4 v46, s[24:27], s71 offen offset:2048 lds
    ds_read_b128 v[72:75], v48 offset:4096
    v_mfma_f32_16x16x32_bf16 v[176:179], v[112:115], v[76:79], v[176:179]
    ds_read_b64_tr_b16 v[104:105], v52 offset:0
    buffer_load_dwordx4 v47, s[24:27], s71 offen offset:3072 lds
    v_mfma_f32_16x16x32_bf16 v[180:183], v[116:119], v[76:79], v[180:183]
    ds_read_b64_tr_b16 v[106:107], v52 offset:1024
    s_add_u32 s71, s71, 524288
    s_sub_u32 s75, s71, 5242880
    s_cselect_b32 s71, s71, s75
    v_mfma_f32_16x16x32_bf16 v[184:187], v[120:123], v[76:79], v[184:187]
    ds_read_b64_tr_b16 v[108:109], v53 offset:0
    s_mov_b32 m0, s74
    s_add_u32 s74, s74, 16384
    v_mfma_f32_16x16x32_bf16 v[188:191], v[124:127], v[76:79], v[188:191]
    ds_read_b64_tr_b16 v[110:111], v53 offset:1024
    buffer_load_dwordx4 v44, s[24:27], s71 offen offset:0 lds
    ds_read_b128 v[76:79], v48 offset:6144
    v_mfma_f32_16x16x32_bf16 v[192:195], v[112:115], v[80:83], v[192:195]
    buffer_load_dwordx4 v45, s[24:27], s71 offen offset:1024 lds
    v_mfma_f32_16x16x32_bf16 v[196:199], v[116:119], v[80:83], v[196:199]
    buffer_load_dwordx4 v46, s[24:27], s71 offen offset:2048 lds
    v_mfma_f32_16x16x32_bf16 v[200:203], v[120:123], v[80:83], v[200:203]
    buffer_load_dwordx4 v47, s[24:27], s71 offen offset:3072 lds
    v_mfma_f32_16x16x32_bf16 v[204:207], v[124:127], v[80:83], v[204:207]
    s_add_u32 s71, s71, 524288
    s_sub_u32 s75, s71, 5242880
    s_cselect_b32 s71, s71, s75
    ds_read_b128 v[80:83], v48 offset:8192
    v_mfma_f32_16x16x32_bf16 v[208:211], v[112:115], v[84:87], v[208:211]
    s_mov_b32 m0, s74
    s_add_u32 s74, s74, 16384
    v_mfma_f32_16x16x32_bf16 v[212:215], v[116:119], v[84:87], v[212:215]
    buffer_load_dwordx4 v44, s[24:27], s71 offen offset:0 lds
    v_mfma_f32_16x16x32_bf16 v[216:219], v[120:123], v[84:87], v[216:219]
    buffer_load_dwordx4 v45, s[24:27], s71 offen offset:1024 lds
    v_mfma_f32_16x16x32_bf16 v[220:223], v[124:127], v[84:87], v[220:223]
    buffer_load_dwordx4 v46, s[24:27], s71 offen offset:2048 lds
    ds_read_b128 v[84:87], v48 offset:10240
    v_mfma_f32_16x16x32_bf16 v[224:227], v[112:115], v[88:91], v[224:227]
    buffer_load_dwordx4 v47, s[24:27], s71 offen offset:3072 lds
    v_mfma_f32_16x16x32_bf16 v[228:231], v[116:119], v[88:91], v[228:231]
    s_add_u32 s71, s71, 524288
    s_sub_u32 s75, s71, 5242880
    s_cselect_b32 s71, s71, s75
    v_mfma_f32_16x16x32_bf16 v[232:235], v[120:123], v[88:91], v[232:235]
    s_mov_b32 m0, s74
    s_add_u32 s74, s74, 16384
    v_mfma_f32_16x16x32_bf16 v[236:239], v[124:127], v[88:91], v[236:239]
    buffer_load_dwordx4 v44, s[24:27], s71 offen offset:0 lds
    ds_read_b128 v[88:91], v48 offset:12288
    v_mfma_f32_16x16x32_bf16 v[240:243], v[112:115], v[92:95], v[240:243]
    buffer_load_dwordx4 v45, s[24:27], s71 offen offset:1024 lds
    v_mfma_f32_16x16x32_bf16 v[244:247], v[116:119], v[92:95], v[244:247]
    buffer_load_dwordx4 v46, s[24:27], s71 offen offset:2048 lds
    v_mfma_f32_16x16x32_bf16 v[248:251], v[120:123], v[92:95], v[248:251]
    buffer_load_dwordx4 v47, s[24:27], s71 offen offset:3072 lds
    v_mfma_f32_16x16x32_bf16 v[252:255], v[124:127], v[92:95], v[252:255]
    s_add_u32 s71, s71, 524288
    s_sub_u32 s75, s71, 5242880
    s_cselect_b32 s71, s71, s75
    ds_read_b128 v[92:95], v48 offset:14336
    s_add_u32 s65, s65, 1
    s_cmp_lt_u32 s65, 8
    s_cbranch_scc1 L_kloopB
    s_waitcnt lgkmcnt(0)
    s_nop 7
    v_cvt_pk_bf16_f32 v128, v128, v129
    v_cvt_pk_bf16_f32 v129, v130, v131
    v_cvt_pk_bf16_f32 v130, v132, v133
    v_cvt_pk_bf16_f32 v131, v134, v135
    v_cvt_pk_bf16_f32 v132, v136, v137
    v_cvt_pk_bf16_f32 v133, v138, v139
    v_cvt_pk_bf16_f32 v134, v140, v141
    v_cvt_pk_bf16_f32 v135, v142, v143
    v_cvt_pk_bf16_f32 v136, v144, v145
    v_cvt_pk_bf16_f32 v137, v146, v147
    v_cvt_pk_bf16_f32 v138, v148, v149
    v_cvt_pk_bf16_f32 v139, v150, v151
    v_cvt_pk_bf16_f32 v140, v152, v153
    v_cvt_pk_bf16_f32 v141, v154, v155
    v_cvt_pk_bf16_f32 v142, v156, v157
    v_cvt_pk_bf16_f32 v143, v158, v159
    v_cvt_pk_bf16_f32 v144, v160, v161
    v_cvt_pk_bf16_f32 v145, v162, v163
    v_cvt_pk_bf16_f32 v146, v164, v165
    v_cvt_pk_bf16_f32 v147, v166, v167
    v_cvt_pk_bf16_f32 v148, v168, v169
    v_cvt_pk_bf16_f32 v149, v170, v171
    v_cvt_pk_bf16_f32 v150, v172, v173
    v_cvt_pk_bf16_f32 v151, v174, v175
    v_cvt_pk_bf16_f32 v152, v176, v177
    v_cvt_pk_bf16_f32 v153, v178, v179
    v_cvt_pk_bf16_f32 v154, v180, v181
    v_cvt_pk_bf16_f32 v155, v182, v183
    v_cvt_pk_bf16_f32 v156, v184, v185
    v_cvt_pk_bf16_f32 v157, v186, v187
    v_cvt_pk_bf16_f32 v158, v188, v189
    v_cvt_pk_bf16_f32 v159, v190, v191
    v_cvt_pk_bf16_f32 v160, v192, v193
    v_cvt_pk_bf16_f32 v161, v194, v195
    v_cvt_pk_bf16_f32 v162, v196, v197
    v_cvt_pk_bf16_f32 v163, v198, v199
    v_cvt_pk_bf16_f32 v164, v200, v201
    v_cvt_pk_bf16_f32 v165, v202, v203
    v_cvt_pk_bf16_f32 v166, v204, v205
    v_cvt_pk_bf16_f32 v167, v206, v207
    v_cvt_pk_bf16_f32 v168, v208, v209
    v_cvt_pk_bf16_f32 v169, v210, v211
    v_cvt_pk_bf16_f32 v170, v212, v213
    v_cvt_pk_bf16_f32 v171, v214, v215
    v_cvt_pk_bf16_f32 v172, v216, v217
    v_cvt_pk_bf16_f32 v173, v218, v219
    v_cvt_pk_bf16_f32 v174, v220, v221
    v_cvt_pk_bf16_f32 v175, v222, v223
    v_cvt_pk_bf16_f32 v176, v224, v225
    v_cvt_pk_bf16_f32 v177, v226, v227
    v_cvt_pk_bf16_f32 v178, v228, v229
    v_cvt_pk_bf16_f32 v179, v230, v231
    v_cvt_pk_bf16_f32 v180, v232, v233
    v_cvt_pk_bf16_f32 v181, v234, v235
    v_cvt_pk_bf16_f32 v182, v236, v237
    v_cvt_pk_bf16_f32 v183, v238, v239
    v_cvt_pk_bf16_f32 v184, v240, v241
    v_cvt_pk_bf16_f32 v185, v242, v243
    v_cvt_pk_bf16_f32 v186, v244, v245
    v_cvt_pk_bf16_f32 v187, v246, v247
    v_cvt_pk_bf16_f32 v188, v248, v249
    v_cvt_pk_bf16_f32 v189, v250, v251
    v_cvt_pk_bf16_f32 v190, v252, v253
    v_cvt_pk_bf16_f32 v191, v254, v255
    s_branch L_q
L_hook:
    s_cmp_eq_u32 s65, 1
    s_cbranch_scc1 L_hook1
    s_cmp_eq_u32 s65, 2
    s_cbranch_scc1 L_hook2
    s_cmp_eq_u32 s65, 4
    s_cbranch_scc1 L_hook4
    s_cmp_eq_u32 s65, 6
    s_cbranch_scc1 L_hook6
    s_cmp_lg_u32 s65, 7
    s_cbranch_scc1 L_hook_back
    buffer_load_dwordx4 v[16:19], v13, s[8:11], s84 offen offset:0 sc1
    buffer_load_dwordx4 v[20:23], v12, s[8:11], s84 offen offset:0 sc1
    buffer_load_dwordx4 v[24:27], v13, s[8:11], s84 offen offset:1024 sc1
    buffer_load_dwordx4 v[28:31], v12, s[8:11], s84 offen offset:1024 sc1
    buffer_load_dwordx4 v[32:35], v13, s[8:11], s84 offen offset:2048 sc1
    buffer_load_dwordx4 v[36:39], v12, s[8:11], s84 offen offset:2048 sc1
    s_branch L_hook_back
L_hook1:
    s_cmp_ge_u32 s76, 2
    s_cbranch_scc1 L_tch_1a
    s_and_b32 s6, s4, 3
    s_lshl_b32 s6, s6, 19
    s_lshl_b32 s7, s5, 15
    s_add_u32 s6, s6, s7
    s_lshl_b32 s7, s76, 7
    s_add_u32 s6, s6, s7
    s_add_u32 s6, s6, 512
    v_lshrrev_b32 v6, 1, v1
    v_lshlrev_b32 v6, 10, v6
    v_and_b32 v7, 1, v1
    v_lshl_add_u32 v6, v7, 6, v6
    buffer_load_dword v11, v6, s[12:15], s6 offen
    s_add_u32 s6, s6, 262144
    buffer_load_dword v11, v6, s[12:15], s6 offen
    s_branch L_tch_1c
L_tch_1a:
    v_lshrrev_b32 v6, 5, v1
    v_lshlrev_b32 v6, 6, v6
    v_bfe_u32 v7, v1, 2, 3
    v_add_u32 v6, v6, v7
    v_lshlrev_b32 v6, 13, v6
    v_and_b32 v7, 3, v1
    v_lshl_add_u32 v6, v7, 6, v6
    s_lshl_b32 s6, s4, 8
    s_lshl_b32 s7, s5, 16
    s_add_u32 s6, s6, s7
    s_add_u32 s6, s6, 2097152
    s_cmp_lg_u32 s76, 2
    s_cbranch_scc1 L_tch_1b
    buffer_load_dword v11, v6, s[16:19], s6 offen
    s_branch L_tch_1c
L_tch_1b:
    buffer_load_dword v11, v6, s[20:23], s6 offen
L_tch_1c:
    s_branch L_hook_back
L_hook2:
    s_lshr_b32 s72, s2, 1
    s_mul_i32 s72, s72, 20480
    s_and_b32 s7, s2, 1
    s_lshl_b32 s7, s7, 7
    s_add_u32 s72, s72, s7
    v_add_u32 v2, -256, v0
    v_lshrrev_b32 v3, 3, v2
    v_and_b32 v4, 7, v2
    v_mul_u32_u24 v5, 1280, v4
    v_lshl_add_u32 v5, v3, 4, v5
    v_add_u32 v5, 131072, v5
    ds_read_b128 v[16:19], v5
    v_lshlrev_b32 v5, 8, v3
    v_lshl_add_u32 v6, v4, 4, v5
    v_add_u32 v2, 0, v0
    v_lshrrev_b32 v3, 3, v2
    v_and_b32 v4, 7, v2
    v_mul_u32_u24 v5, 1280, v4
    v_lshl_add_u32 v5, v3, 4, v5
    v_add_u32 v5, 131072, v5
    ds_read_b128 v[24:27], v5
    v_lshlrev_b32 v5, 8, v3
    v_lshl_add_u32 v7, v4, 4, v5
    v_add_u32 v2, 256, v0
    v_lshrrev_b32 v3, 3, v2
    v_and_b32 v4, 7, v2
    v_mul_u32_u24 v5, 1280, v4
    v_lshl_add_u32 v5, v3, 4, v5
    v_add_u32 v5, 131072, v5
    ds_read_b128 v[32:35], v5
    v_lshlrev_b32 v5, 8, v3
    v_lshl_add_u32 v8, v4, 4, v5
    s_waitcnt lgkmcnt(0)
    buffer_store_dwordx4 v[16:19], v6, s[8:11], s72 offen sc1
    buffer_store_dwordx4 v[24:27], v7, s[8:11], s72 offen sc1
    s_cmp_ge_u32 s3, 6
    s_cbranch_scc1 L_lns
    buffer_store_dwordx4 v[32:35], v8, s[8:11], s72 offen sc1
L_lns:
    s_cmp_lt_u32 s3, 6
    s_cbranch_scc1 L_zd
    v_mov_b64 v[36:37], 0
    v_mov_b64 v[38:39], 0
    v_lshrrev_b32 v2, 3, v1
    s_cmp_eq_u32 s3, 6
    s_cbranch_scc1 L_z6
    s_lshl_b32 s6, s5, 2
    s_sub_u32 s7, 56, s6
    v_mov_b32 v3, s6
    v_mov_b32 v4, s7
    v_cmp_gt_u32 vcc, 4, v2
    s_lshl_b32 s6, s4, 7
    s_add_u32 s6, s6, 3932160
    v_cndmask_b32 v3, v4, v3, vcc
    v_add_u32 v3, v3, v2
    v_lshl_add_u32 v3, v3, 12, s6
    s_branch L_z7
L_z6:
    v_mov_b32 v3, 0x5000000
    s_lshl_b32 s6, s4, 3
    s_add_u32 s6, s6, s5
    s_lshl_b32 s6, s6, 5
    s_add_u32 s6, s6, s3
    s_lshl_b32 s6, s6, 2
    s_add_u32 s6, s6, 3866624
    s_andn2_b32 s6, s6, 127
    v_cmp_eq_u32 vcc, 0, v2
    v_mov_b32 v4, s6
    s_nop 0
    v_cndmask_b32 v3, v3, v4, vcc
    s_lshl_b32 s6, s61, 5
    s_add_u32 s6, s6, s3
    s_lshl_b32 s6, s6, 2
    s_add_u32 s6, s6, 15859712
    s_andn2_b32 s6, s6, 127
    v_cmp_eq_u32 vcc, 1, v2
    v_mov_b32 v4, s6
    s_nop 0
    v_cndmask_b32 v3, v3, v4, vcc
    s_xor_b32 s6, s5, 1
    s_lshl_b32 s6, s6, 5
    s_add_u32 s6, s6, s4
    s_lshl_b32 s6, s6, 7
    s_add_u32 s6, s6, 3899392
    s_andn2_b32 s6, s6, 127
    v_cmp_eq_u32 vcc, 2, v2
    v_mov_b32 v4, s6
    s_nop 0
    v_cndmask_b32 v3, v3, v4, vcc
    s_and_b32 s6, s4, 7
    s_lshl_b32 s7, s5, 3
    s_add_u32 s6, s6, s7
    s_lshr_b32 s7, s4, 3
    s_add_u32 s7, s7, 0
    s_add_u32 s7, s7, 1
    s_and_b32 s7, s7, 3
    s_lshl_b32 s6, s6, 2
    s_add_u32 s6, s6, s7
    s_mul_i32 s6, s6, 3
    s_add_u32 s6, s6, 0
    s_lshl_b32 s6, s6, 5
    s_add_u32 s6, s6, s3
    s_lshl_b32 s6, s6, 2
    s_add_u32 s6, s6, 15728640
    s_andn2_b32 s6, s6, 127
    v_cmp_eq_u32 vcc, 3, v2
    v_mov_b32 v4, s6
    s_nop 0
    v_cndmask_b32 v3, v3, v4, vcc
    s_and_b32 s6, s4, 7
    s_lshl_b32 s7, s5, 3
    s_add_u32 s6, s6, s7
    s_lshr_b32 s7, s4, 3
    s_add_u32 s7, s7, 1
    s_add_u32 s7, s7, 1
    s_and_b32 s7, s7, 3
    s_lshl_b32 s6, s6, 2
    s_add_u32 s6, s6, s7
    s_mul_i32 s6, s6, 3
    s_add_u32 s6, s6, 1
    s_lshl_b32 s6, s6, 5
    s_add_u32 s6, s6, s3
    s_lshl_b32 s6, s6, 2
    s_add_u32 s6, s6, 15728640
    s_andn2_b32 s6, s6, 127
    v_cmp_eq_u32 vcc, 4, v2
    v_mov_b32 v4, s6
    s_nop 0
    v_cndmask_b32 v3, v3, v4, vcc
    s_and_b32 s6, s4, 7
    s_lshl_b32 s7, s5, 3
    s_add_u32 s6, s6, s7
    s_lshr_b32 s7, s4, 3
    s_add_u32 s7, s7, 2
    s_add_u32 s7, s7, 1
    s_and_b32 s7, s7, 3
    s_lshl_b32 s6, s6, 2
    s_add_u32 s6, s6, s7
    s_mul_i32 s6, s6, 3
    s_add_u32 s6, s6, 2
    s_lshl_b32 s6, s6, 5
    s_add_u32 s6, s6, s3
    s_lshl_b32 s6, s6, 2
    s_add_u32 s6, s6, 15728640
    s_andn2_b32 s6, s6, 127
    v_cmp_eq_u32 vcc, 5, v2
    v_mov_b32 v4, s6
    s_nop 0
    v_cndmask_b32 v3, v3, v4, vcc
    s_mov_b32 s6, 0x5000000
    s_cmp_eq_u32 s2, 31
    s_cmov_b32 s6, 3801088
    s_andn2_b32 s6, s6, 127
    v_cmp_eq_u32 vcc, 6, v2
    v_mov_b32 v4, s6
    s_nop 0
    v_cndmask_b32 v3, v3, v4, vcc
    s_lshl_b32 s6, s2, 7
    s_add_u32 s6, s6, 2621440
    s_andn2_b32 s6, s6, 127
    v_cmp_eq_u32 vcc, 7, v2
    v_mov_b32 v4, s6
    s_nop 0
    v_cndmask_b32 v3, v3, v4, vcc
    v_add_u32 v4, 160896, v13
    s_mov_b32 exec_lo, 0
    s_mov_b32 exec_hi, 0x03000000
    ds_read_b128 v[36:39], v4
    s_mov_b64 exec, -1
    s_waitcnt lgkmcnt(0)
L_z7:
    v_and_b32 v2, 7, v1
    v_lshl_add_u32 v3, v2, 4, v3
    buffer_store_dwordx4 v[36:39], v3, s[8:11], 0 offen sc1
L_zd:
    s_cmp_ge_u32 s76, 2
    s_cbranch_scc1 L_tch_2a
    s_and_b32 s6, s4, 3
    s_lshl_b32 s6, s6, 19
    s_lshl_b32 s7, s5, 15
    s_add_u32 s6, s6, s7
    s_lshl_b32 s7, s76, 7
    s_add_u32 s6, s6, s7
    s_add_u32 s6, s6, 768
    v_lshrrev_b32 v6, 1, v1
    v_lshlrev_b32 v6, 10, v6
    v_and_b32 v7, 1, v1
    v_lshl_add_u32 v6, v7, 6, v6
    buffer_load_dword v11, v6, s[12:15], s6 offen
    s_add_u32 s6, s6, 262144
    buffer_load_dword v11, v6, s[12:15], s6 offen
    s_branch L_tch_2c
L_tch_2a:
    v_lshrrev_b32 v6, 5, v1
    v_lshlrev_b32 v6, 6, v6
    v_bfe_u32 v7, v1, 2, 3
    v_add_u32 v6, v6, v7
    v_lshlrev_b32 v6, 13, v6
    v_and_b32 v7, 3, v1
    v_lshl_add_u32 v6, v7, 6, v6
    s_lshl_b32 s6, s4, 8
    s_lshl_b32 s7, s5, 16
    s_add_u32 s6, s6, s7
    s_add_u32 s6, s6, 3145728
    s_cmp_lg_u32 s76, 2
    s_cbranch_scc1 L_tch_2b
    buffer_load_dword v11, v6, s[16:19], s6 offen
    s_branch L_tch_2c
L_tch_2b:
    buffer_load_dword v11, v6, s[20:23], s6 offen
L_tch_2c:
    s_branch L_hook_back
L_hook4:
    s_cmp_lg_u32 s3, 4
    s_cbranch_scc1 L_hook4b
    s_mov_b32 s28, s56
    s_mov_b32 s29, s57
    s_mov_b32 s30, 0x100
    s_mov_b32 s31, 0x20000
    v_mov_b32 v2, 1
    v_lshlrev_b32 v3, 8, v1
    s_and_b32 s6, s2, 31
    s_lshl_b32 s6, s6, 2
    buffer_atomic_add v2, v3, s[28:31], s6 offen offset:0 sc1
L_hook4b:
    s_lshl_b32 s74, s76, 12
    s_add_u32 s74, s74, 131072
    s_mov_b32 m0, s74
    s_add_u32 s74, s74, 16384
    buffer_load_dwordx4 v44, s[24:27], s71 offen offset:0 lds
    buffer_load_dwordx4 v45, s[24:27], s71 offen offset:1024 lds
    buffer_load_dwordx4 v46, s[24:27], s71 offen offset:2048 lds
    buffer_load_dwordx4 v47, s[24:27], s71 offen offset:3072 lds
    s_add_u32 s71, s71, 524288
    s_sub_u32 s75, s71, 5242880
    s_cselect_b32 s71, s71, s75
    s_mov_b32 m0, s74
    s_add_u32 s74, s74, 16384
    buffer_load_dwordx4 v44, s[24:27], s71 offen offset:0 lds
    buffer_load_dwordx4 v45, s[24:27], s71 offen offset:1024 lds
    buffer_load_dwordx4 v46, s[24:27], s71 offen offset:2048 lds
    buffer_load_dwordx4 v47, s[24:27], s71 offen offset:3072 lds
    s_add_u32 s71, s71, 524288
    s_sub_u32 s75, s71, 5242880
    s_cselect_b32 s71, s71, s75
    s_branch L_hook_back
L_hook6:
    s_cmp_lg_u32 s3, 5
    s_cbranch_scc1 L_hook_back
    s_mov_b32 s28, s56
    s_mov_b32 s29, s57
    s_mov_b32 s30, 0x100
    s_mov_b32 s31, 0x20000
    v_and_b32 v3, 31, v1
    v_lshlrev_b32 v3, 2, v3
    buffer_load_dword v62, v3, s[28:31], 0 offen offset:0 sc1
    s_branch L_hook_back
L_vpre:
    s_waitcnt vmcnt(0)
    s_lshl_b32 s6, s65, 4
    s_add_u32 s6, s6, s3
    s_cmp_lg_u32 s6, 0x65
    s_cbranch_scc1 L_vnow
    v_cmp_gt_u32 vcc, 8, v62
    s_cbranch_vccz L_cntok_3
    s_mov_b32 s28, s56
    s_mov_b32 s29, s57
    s_mov_b32 s30, 0x100
    s_mov_b32 s31, 0x20000
    v_and_b32 v3, 31, v1
    v_lshlrev_b32 v3, 2, v3
    s_mov_b32 s79, 262144
L_poll_4:
    buffer_load_dword v2, v3, s[28:31], 0 offen offset:0 sc1
    s_waitcnt vmcnt(0)
    v_cmp_gt_u32 vcc, 8, v2
    s_cbranch_vccz L_polldone_5
    s_sleep 8
    s_sub_u32 s79, s79, 1
    s_cmp_lg_u32 s79, 0
    s_cbranch_scc1 L_poll_4
L_polldone_5:
L_cntok_3:
    s_branch L_vnow
L_khook:
    s_cmp_lg_u32 s65, 7
    s_cbranch_scc1 L_khook_back
    buffer_load_dwordx4 v[16:19], v13, s[8:11], s84 offen offset:0 sc1
    buffer_load_dwordx4 v[20:23], v12, s[8:11], s84 offen offset:0 sc1
    buffer_load_dwordx4 v[24:27], v13, s[8:11], s84 offen offset:1024 sc1
    buffer_load_dwordx4 v[28:31], v12, s[8:11], s84 offen offset:1024 sc1
    buffer_load_dwordx4 v[32:35], v13, s[8:11], s84 offen offset:2048 sc1
    buffer_load_dwordx4 v[36:39], v12, s[8:11], s84 offen offset:2048 sc1
    s_branch L_khook_back
L_kv_v:
    ds_read_b128 v[64:67], v48 offset:0
    ds_read_b128 v[68:71], v48 offset:2048
    ds_read_b64_tr_b16 v[96:97], v50 offset:0
    ds_read_b64_tr_b16 v[98:99], v50 offset:1024
    ds_read_b64_tr_b16 v[100:101], v51 offset:0
    ds_read_b64_tr_b16 v[102:103], v51 offset:1024
    ds_read_b128 v[72:75], v48 offset:4096
    ds_read_b64_tr_b16 v[104:105], v52 offset:0
    ds_read_b64_tr_b16 v[106:107], v52 offset:1024
    ds_read_b64_tr_b16 v[108:109], v53 offset:0
    ds_read_b64_tr_b16 v[110:111], v53 offset:1024
    ds_read_b128 v[76:79], v48 offset:6144
    ds_read_b128 v[80:83], v48 offset:8192
    ds_read_b128 v[84:87], v48 offset:10240
    ds_read_b128 v[88:91], v48 offset:12288
    ds_read_b128 v[92:95], v48 offset:14336
    s_cmp_ge_u32 s76, 2
    s_cbranch_scc1 L_tch_6a
    s_and_b32 s6, s4, 3
    s_lshl_b32 s6, s6, 19
    s_lshl_b32 s7, s5, 15
    s_add_u32 s6, s6, s7
    s_lshl_b32 s7, s76, 7
    s_add_u32 s6, s6, s7
    s_add_u32 s6, s6, 256
    v_lshrrev_b32 v6, 1, v1
    v_lshlrev_b32 v6, 10, v6
    v_and_b32 v7, 1, v1
    v_lshl_add_u32 v6, v7, 6, v6
    buffer_load_dword v11, v6, s[12:15], s6 offen
    s_add_u32 s6, s6, 262144
    buffer_load_dword v11, v6, s[12:15], s6 offen
    s_branch L_tch_6c
L_tch_6a:
    v_lshrrev_b32 v6, 5, v1
    v_lshlrev_b32 v6, 6, v6
    v_bfe_u32 v7, v1, 2, 3
    v_add_u32 v6, v6, v7
    v_lshlrev_b32 v6, 13, v6
    v_and_b32 v7, 3, v1
    v_lshl_add_u32 v6, v7, 6, v6
    s_lshl_b32 s6, s4, 8
    s_lshl_b32 s7, s5, 16
    s_add_u32 s6, s6, s7
    s_add_u32 s6, s6, 1048576
    s_cmp_lg_u32 s76, 2
    s_cbranch_scc1 L_tch_6b
    buffer_load_dword v11, v6, s[16:19], s6 offen
    s_branch L_tch_6c
L_tch_6b:
    buffer_load_dword v11, v6, s[20:23], s6 offen
L_tch_6c:
.p2align 4
L_vloop:
    s_bitcmp1_b32 214, s65
    s_cbranch_scc1 L_hook
L_hook_back:
    s_waitcnt lgkmcnt(12)
    v_mfma_f32_16x16x32_bf16 v[128:131], v[64:67], v[96:99], v[128:131]
    ds_read_b64_tr_b16 v[112:113], v50 offset:8192
    s_waitcnt lgkmcnt(11)
    v_mfma_f32_16x16x32_bf16 v[132:135], v[64:67], v[100:103], v[132:135]
    ds_read_b64_tr_b16 v[114:115], v50 offset:9216
    s_waitcnt lgkmcnt(9)
    v_mfma_f32_16x16x32_bf16 v[136:139], v[64:67], v[104:107], v[136:139]
    ds_read_b64_tr_b16 v[116:117], v51 offset:8192
    s_waitcnt lgkmcnt(8)
    v_mfma_f32_16x16x32_bf16 v[140:143], v[64:67], v[108:111], v[140:143]
    ds_read_b64_tr_b16 v[118:119], v51 offset:9216
    ds_read_b128 v[64:67], v49 offset:0
    v_mfma_f32_16x16x32_bf16 v[144:147], v[68:71], v[96:99], v[144:147]
    ds_read_b64_tr_b16 v[120:121], v52 offset:8192
    v_mfma_f32_16x16x32_bf16 v[148:151], v[68:71], v[100:103], v[148:151]
    ds_read_b64_tr_b16 v[122:123], v52 offset:9216
    v_mfma_f32_16x16x32_bf16 v[152:155], v[68:71], v[104:107], v[152:155]
    ds_read_b64_tr_b16 v[124:125], v53 offset:8192
    v_mfma_f32_16x16x32_bf16 v[156:159], v[68:71], v[108:111], v[156:159]
    ds_read_b64_tr_b16 v[126:127], v53 offset:9216
    ds_read_b128 v[68:71], v49 offset:2048
    v_mfma_f32_16x16x32_bf16 v[160:163], v[72:75], v[96:99], v[160:163]
    v_mfma_f32_16x16x32_bf16 v[164:167], v[72:75], v[100:103], v[164:167]
    v_mfma_f32_16x16x32_bf16 v[168:171], v[72:75], v[104:107], v[168:171]
    v_mfma_f32_16x16x32_bf16 v[172:175], v[72:75], v[108:111], v[172:175]
    ds_read_b128 v[72:75], v49 offset:4096
    s_waitcnt lgkmcnt(15)
    v_mfma_f32_16x16x32_bf16 v[176:179], v[76:79], v[96:99], v[176:179]
    v_mfma_f32_16x16x32_bf16 v[180:183], v[76:79], v[100:103], v[180:183]
    v_mfma_f32_16x16x32_bf16 v[184:187], v[76:79], v[104:107], v[184:187]
    v_mfma_f32_16x16x32_bf16 v[188:191], v[76:79], v[108:111], v[188:191]
    ds_read_b128 v[76:79], v49 offset:6144
    s_waitcnt lgkmcnt(15)
    v_mfma_f32_16x16x32_bf16 v[192:195], v[80:83], v[96:99], v[192:195]
    v_mfma_f32_16x16x32_bf16 v[196:199], v[80:83], v[100:103], v[196:199]
    v_mfma_f32_16x16x32_bf16 v[200:203], v[80:83], v[104:107], v[200:203]
    v_mfma_f32_16x16x32_bf16 v[204:207], v[80:83], v[108:111], v[204:207]
    ds_read_b128 v[80:83], v49 offset:8192
    s_waitcnt lgkmcnt(15)
    v_mfma_f32_16x16x32_bf16 v[208:211], v[84:87], v[96:99], v[208:211]
    v_mfma_f32_16x16x32_bf16 v[212:215], v[84:87], v[100:103], v[212:215]
    v_mfma_f32_16x16x32_bf16 v[216:219], v[84:87], v[104:107], v[216:219]
    v_mfma_f32_16x16x32_bf16 v[220:223], v[84:87], v[108:111], v[220:223]
    ds_read_b128 v[84:87], v49 offset:10240
    s_waitcnt lgkmcnt(15)
    v_mfma_f32_16x16x32_bf16 v[224:227], v[88:91], v[96:99], v[224:227]
    v_mfma_f32_16x16x32_bf16 v[228:231], v[88:91], v[100:103], v[228:231]
    v_mfma_f32_16x16x32_bf16 v[232:235], v[88:91], v[104:107], v[232:235]
    v_mfma_f32_16x16x32_bf16 v[236:239], v[88:91], v[108:111], v[236:239]
    ds_read_b128 v[88:91], v49 offset:12288
    s_waitcnt lgkmcnt(15)
    v_mfma_f32_16x16x32_bf16 v[240:243], v[92:95], v[96:99], v[240:243]
    v_mfma_f32_16x16x32_bf16 v[244:247], v[92:95], v[100:103], v[244:247]
    v_mfma_f32_16x16x32_bf16 v[248:251], v[92:95], v[104:107], v[248:251]
    v_mfma_f32_16x16x32_bf16 v[252:255], v[92:95], v[108:111], v[252:255]
    ds_read_b128 v[92:95], v49 offset:14336
    s_waitcnt lgkmcnt(11)
    v_mfma_f32_16x16x32_bf16 v[128:131], v[64:67], v[112:115], v[128:131]
    v_mfma_f32_16x16x32_bf16 v[132:135], v[64:67], v[116:119], v[132:135]
    s_waitcnt lgkmcnt(9)
    v_mfma_f32_16x16x32_bf16 v[136:139], v[64:67], v[120:123], v[136:139]
    s_waitcnt lgkmcnt(7)
    v_mfma_f32_16x16x32_bf16 v[140:143], v[64:67], v[124:127], v[140:143]
    s_waitcnt lgkmcnt(6)
    v_mfma_f32_16x16x32_bf16 v[144:147], v[68:71], v[112:115], v[144:147]
    v_mfma_f32_16x16x32_bf16 v[148:151], v[68:71], v[116:119], v[148:151]
    v_mfma_f32_16x16x32_bf16 v[152:155], v[68:71], v[120:123], v[152:155]
    v_mfma_f32_16x16x32_bf16 v[156:159], v[68:71], v[124:127], v[156:159]
    v_xor_b32 v48, 0x10000, v48
    v_xor_b32 v49, 0x10000, v49
    v_xor_b32 v50, 0x10000, v50
    v_xor_b32 v51, 0x10000, v51
    v_xor_b32 v52, 0x10000, v52
    v_xor_b32 v53, 0x10000, v53
    s_bitcmp1_b32 0x48, s65
    s_cbranch_scc1 L_vpre
L_vnow:
    s_waitcnt lgkmcnt(0)
    s_barrier
    ds_read_b128 v[64:67], v48 offset:0
    ds_read_b128 v[68:71], v48 offset:2048
    v_mfma_f32_16x16x32_bf16 v[160:163], v[72:75], v[112:115], v[160:163]
    ds_read_b64_tr_b16 v[96:97], v50 offset:0
    v_mfma_f32_16x16x32_bf16 v[164:167], v[72:75], v[116:119], v[164:167]
    ds_read_b64_tr_b16 v[98:99], v50 offset:1024
    v_mfma_f32_16x16x32_bf16 v[168:171], v[72:75], v[120:123], v[168:171]
    ds_read_b64_tr_b16 v[100:101], v51 offset:0
    v_mfma_f32_16x16x32_bf16 v[172:175], v[72:75], v[124:127], v[172:175]
    ds_read_b64_tr_b16 v[102:103], v51 offset:1024
    ds_read_b128 v[72:75], v48 offset:4096
    v_mfma_f32_16x16x32_bf16 v[176:179], v[76:79], v[112:115], v[176:179]
    ds_read_b64_tr_b16 v[104:105], v52 offset:0
    v_mfma_f32_16x16x32_bf16 v[180:183], v[76:79], v[116:119], v[180:183]
    ds_read_b64_tr_b16 v[106:107], v52 offset:1024
    v_mfma_f32_16x16x32_bf16 v[184:187], v[76:79], v[120:123], v[184:187]
    ds_read_b64_tr_b16 v[108:109], v53 offset:0
    v_mfma_f32_16x16x32_bf16 v[188:191], v[76:79], v[124:127], v[188:191]
    ds_read_b64_tr_b16 v[110:111], v53 offset:1024
    ds_read_b128 v[76:79], v48 offset:6144
    v_mfma_f32_16x16x32_bf16 v[192:195], v[80:83], v[112:115], v[192:195]
    v_mfma_f32_16x16x32_bf16 v[196:199], v[80:83], v[116:119], v[196:199]
    v_mfma_f32_16x16x32_bf16 v[200:203], v[80:83], v[120:123], v[200:203]
    v_mfma_f32_16x16x32_bf16 v[204:207], v[80:83], v[124:127], v[204:207]
    ds_read_b128 v[80:83], v48 offset:8192
    v_mfma_f32_16x16x32_bf16 v[208:211], v[84:87], v[112:115], v[208:211]
    v_mfma_f32_16x16x32_bf16 v[212:215], v[84:87], v[116:119], v[212:215]
    v_mfma_f32_16x16x32_bf16 v[216:219], v[84:87], v[120:123], v[216:219]
    v_mfma_f32_16x16x32_bf16 v[220:223], v[84:87], v[124:127], v[220:223]
    ds_read_b128 v[84:87], v48 offset:10240
    v_mfma_f32_16x16x32_bf16 v[224:227], v[88:91], v[112:115], v[224:227]
    v_mfma_f32_16x16x32_bf16 v[228:231], v[88:91], v[116:119], v[228:231]
    v_mfma_f32_16x16x32_bf16 v[232:235], v[88:91], v[120:123], v[232:235]
    v_mfma_f32_16x16x32_bf16 v[236:239], v[88:91], v[124:127], v[236:239]
    ds_read_b128 v[88:91], v48 offset:12288
    v_mfma_f32_16x16x32_bf16 v[240:243], v[92:95], v[112:115], v[240:243]
    v_mfma_f32_16x16x32_bf16 v[244:247], v[92:95], v[116:119], v[244:247]
    v_mfma_f32_16x16x32_bf16 v[248:251], v[92:95], v[120:123], v[248:251]
    v_mfma_f32_16x16x32_bf16 v[252:255], v[92:95], v[124:127], v[252:255]
    ds_read_b128 v[92:95], v48 offset:14336
    s_add_u32 s65, s65, 1
    s_cmp_lt_u32 s65, 8
    s_cbranch_scc1 L_vloop
    s_waitcnt lgkmcnt(0)
    s_nop 7
    v_cvt_pk_bf16_f32 v128, v128, v129
    v_cvt_pk_bf16_f32 v129, v130, v131
    v_cvt_pk_bf16_f32 v130, v144, v145
    v_cvt_pk_bf16_f32 v131, v146, v147
    v_cvt_pk_bf16_f32 v132, v132, v133
    v_cvt_pk_bf16_f32 v133, v134, v135
    v_cvt_pk_bf16_f32 v134, v148, v149
    v_cvt_pk_bf16_f32 v135, v150, v151
    v_cvt_pk_bf16_f32 v136, v136, v137
    v_cvt_pk_bf16_f32 v137, v138, v139
    v_cvt_pk_bf16_f32 v138, v152, v153
    v_cvt_pk_bf16_f32 v139, v154, v155
    v_cvt_pk_bf16_f32 v140, v140, v141
    v_cvt_pk_bf16_f32 v141, v142, v143
    v_cvt_pk_bf16_f32 v142, v156, v157
    v_cvt_pk_bf16_f32 v143, v158, v159
    v_cvt_pk_bf16_f32 v144, v160, v161
    v_cvt_pk_bf16_f32 v145, v162, v163
    v_cvt_pk_bf16_f32 v146, v176, v177
    v_cvt_pk_bf16_f32 v147, v178, v179
    v_cvt_pk_bf16_f32 v148, v164, v165
    v_cvt_pk_bf16_f32 v149, v166, v167
    v_cvt_pk_bf16_f32 v150, v180, v181
    v_cvt_pk_bf16_f32 v151, v182, v183
    v_cvt_pk_bf16_f32 v152, v168, v169
    v_cvt_pk_bf16_f32 v153, v170, v171
    v_cvt_pk_bf16_f32 v154, v184, v185
    v_cvt_pk_bf16_f32 v155, v186, v187
    v_cvt_pk_bf16_f32 v156, v172, v173
    v_cvt_pk_bf16_f32 v157, v174, v175
    v_cvt_pk_bf16_f32 v158, v188, v189
    v_cvt_pk_bf16_f32 v159, v190, v191
    v_cvt_pk_bf16_f32 v160, v192, v193
    v_cvt_pk_bf16_f32 v161, v194, v195
    v_cvt_pk_bf16_f32 v162, v208, v209
    v_cvt_pk_bf16_f32 v163, v210, v211
    v_cvt_pk_bf16_f32 v164, v196, v197
    v_cvt_pk_bf16_f32 v165, v198, v199
    v_cvt_pk_bf16_f32 v166, v212, v213
    v_cvt_pk_bf16_f32 v167, v214, v215
    v_cvt_pk_bf16_f32 v168, v200, v201
    v_cvt_pk_bf16_f32 v169, v202, v203
    v_cvt_pk_bf16_f32 v170, v216, v217
    v_cvt_pk_bf16_f32 v171, v218, v219
    v_cvt_pk_bf16_f32 v172, v204, v205
    v_cvt_pk_bf16_f32 v173, v206, v207
    v_cvt_pk_bf16_f32 v174, v220, v221
    v_cvt_pk_bf16_f32 v175, v222, v223
    v_cvt_pk_bf16_f32 v176, v224, v225
    v_cvt_pk_bf16_f32 v177, v226, v227
    v_cvt_pk_bf16_f32 v178, v240, v241
    v_cvt_pk_bf16_f32 v179, v242, v243
    v_cvt_pk_bf16_f32 v180, v228, v229
    v_cvt_pk_bf16_f32 v181, v230, v231
    v_cvt_pk_bf16_f32 v182, v244, v245
    v_cvt_pk_bf16_f32 v183, v246, v247
    v_cvt_pk_bf16_f32 v184, v232, v233
    v_cvt_pk_bf16_f32 v185, v234, v235
    v_cvt_pk_bf16_f32 v186, v248, v249
    v_cvt_pk_bf16_f32 v187, v250, v251
    v_cvt_pk_bf16_f32 v188, v236, v237
    v_cvt_pk_bf16_f32 v189, v238, v239
    v_cvt_pk_bf16_f32 v190, v252, v253
    v_cvt_pk_bf16_f32 v191, v254, v255
    s_waitcnt vmcnt(0)
L_q:
    s_mov_b32 s28, s56
    s_mov_b32 s29, s57
    s_mov_b32 s30, 0x100
    s_mov_b32 s31, 0x20000
    s_lshl_b32 s6, s76, 13
    v_add_u32 v49, s6, v13
    s_lshl_b32 s6, s76, 12
    v_add_u32 v50, s6, v13
    s_lshl_b32 s77, s4, 20
    s_add_u32 s77, s77, 16777216
    s_mov_b32 s78, 0
    s_mov_b32 s90, 0
    s_cmp_lt_u32 s3, 4
    s_cselect_b32 s89, 3, 2
    ds_read_b64_tr_b16 v[96:97], v54 offset:0
    ds_read_b64_tr_b16 v[98:99], v54 offset:1024
    ds_read_b64_tr_b16 v[100:101], v55 offset:0
    ds_read_b64_tr_b16 v[102:103], v55 offset:1024
    ds_read_b64_tr_b16 v[104:105], v56 offset:0
    ds_read_b64_tr_b16 v[106:107], v56 offset:1024
    ds_read_b64_tr_b16 v[108:109], v57 offset:0
    ds_read_b64_tr_b16 v[110:111], v57 offset:1024
    ds_read_b64_tr_b16 v[112:113], v58 offset:0
    ds_read_b64_tr_b16 v[114:115], v58 offset:1024
    ds_read_b64_tr_b16 v[116:117], v59 offset:0
    ds_read_b64_tr_b16 v[118:119], v59 offset:1024
    ds_read_b64_tr_b16 v[120:121], v60 offset:0
    ds_read_b64_tr_b16 v[122:123], v60 offset:1024
    ds_read_b64_tr_b16 v[124:125], v61 offset:0
    ds_read_b64_tr_b16 v[126:127], v61 offset:1024
    buffer_load_dwordx4 v[64:67], v13, s[8:11], s84 offen offset:3072 sc1
    buffer_load_dwordx4 v[68:71], v12, s[8:11], s84 offen offset:3072 sc1
    buffer_load_dwordx4 v[72:75], v13, s[8:11], s85 offen offset:0 sc1
    buffer_load_dwordx4 v[76:79], v12, s[8:11], s85 offen offset:0 sc1
    buffer_load_dwordx4 v[80:83], v13, s[8:11], s85 offen offset:1024 sc1
    buffer_load_dwordx4 v[84:87], v12, s[8:11], s85 offen offset:1024 sc1
    buffer_load_dwordx4 v[88:91], v13, s[8:11], s85 offen offset:2048 sc1
    buffer_load_dwordx4 v[92:95], v12, s[8:11], s85 offen offset:2048 sc1
    s_waitcnt lgkmcnt(14)
    v_mfma_f32_16x16x32_bf16 v[192:195], v[96:99], v[16:19], 0
    v_mfma_f32_16x16x32_bf16 v[196:199], v[96:99], v[20:23], 0
    ds_read_b64_tr_b16 v[96:97], v54 offset:8192
    s_waitcnt lgkmcnt(13)
    v_mfma_f32_16x16x32_bf16 v[200:203], v[100:103], v[16:19], 0
    ds_read_b64_tr_b16 v[98:99], v54 offset:9216
    v_mfma_f32_16x16x32_bf16 v[204:207], v[100:103], v[20:23], 0
    ds_read_b64_tr_b16 v[100:101], v55 offset:8192
    s_waitcnt lgkmcnt(13)
    v_mfma_f32_16x16x32_bf16 v[208:211], v[104:107], v[16:19], 0
    ds_read_b64_tr_b16 v[102:103], v55 offset:9216
    v_mfma_f32_16x16x32_bf16 v[212:215], v[104:107], v[20:23], 0
    ds_read_b64_tr_b16 v[104:105], v56 offset:8192
    s_waitcnt lgkmcnt(13)
    v_mfma_f32_16x16x32_bf16 v[216:219], v[108:111], v[16:19], 0
    ds_read_b64_tr_b16 v[106:107], v56 offset:9216
    buffer_store_dwordx4 v[128:131], v13, s[8:11], s67 offen sc1
    s_add_u32 s67, s67, 1024
    v_mfma_f32_16x16x32_bf16 v[220:223], v[108:111], v[20:23], 0
    ds_read_b64_tr_b16 v[108:109], v57 offset:8192
    s_waitcnt lgkmcnt(13)
    v_mfma_f32_16x16x32_bf16 v[224:227], v[112:115], v[16:19], 0
    ds_read_b64_tr_b16 v[110:111], v57 offset:9216
    v_mfma_f32_16x16x32_bf16 v[228:231], v[112:115], v[20:23], 0
    ds_read_b64_tr_b16 v[112:113], v58 offset:8192
    s_waitcnt lgkmcnt(13)
    v_mfma_f32_16x16x32_bf16 v[232:235], v[116:119], v[16:19], 0
    ds_read_b64_tr_b16 v[114:115], v58 offset:9216
    v_mfma_f32_16x16x32_bf16 v[236:239], v[116:119], v[20:23], 0
    ds_read_b64_tr_b16 v[116:117], v59 offset:8192
    s_waitcnt lgkmcnt(13)
    v_mfma_f32_16x16x32_bf16 v[240:243], v[120:123], v[16:19], 0
    ds_read_b64_tr_b16 v[118:119], v59 offset:9216
    v_mfma_f32_16x16x32_bf16 v[244:247], v[120:123], v[20:23], 0
    ds_read_b64_tr_b16 v[120:121], v60 offset:8192
    s_waitcnt lgkmcnt(13)
    v_mfma_f32_16x16x32_bf16 v[248:251], v[124:127], v[16:19], 0
    ds_read_b64_tr_b16 v[122:123], v60 offset:9216
    v_mfma_f32_16x16x32_bf16 v[252:255], v[124:127], v[20:23], 0
    ds_read_b64_tr_b16 v[124:125], v61 offset:8192
    ds_read_b64_tr_b16 v[126:127], v61 offset:9216
    buffer_load_dwordx4 v[16:19], v13, s[8:11], s85 offen offset:3072 sc1
    buffer_load_dwordx4 v[20:23], v12, s[8:11], s85 offen offset:3072 sc1
    s_waitcnt lgkmcnt(14)
    v_mfma_f32_16x16x32_bf16 v[192:195], v[96:99], v[24:27], v[192:195]
    v_mfma_f32_16x16x32_bf16 v[196:199], v[96:99], v[28:31], v[196:199]
    ds_read_b64_tr_b16 v[96:97], v54 offset:16384
    s_waitcnt lgkmcnt(13)
    v_mfma_f32_16x16x32_bf16 v[200:203], v[100:103], v[24:27], v[200:203]
    ds_read_b64_tr_b16 v[98:99], v54 offset:17408
    v_mfma_f32_16x16x32_bf16 v[204:207], v[100:103], v[28:31], v[204:207]
    ds_read_b64_tr_b16 v[100:101], v55 offset:16384
    s_waitcnt lgkmcnt(13)
    v_mfma_f32_16x16x32_bf16 v[208:211], v[104:107], v[24:27], v[208:211]
    ds_read_b64_tr_b16 v[102:103], v55 offset:17408
    v_mfma_f32_16x16x32_bf16 v[212:215], v[104:107], v[28:31], v[212:215]
    ds_read_b64_tr_b16 v[104:105], v56 offset:16384
    s_waitcnt lgkmcnt(13)
    v_mfma_f32_16x16x32_bf16 v[216:219], v[108:111], v[24:27], v[216:219]
    ds_read_b64_tr_b16 v[106:107], v56 offset:17408
    buffer_store_dwordx4 v[132:135], v13, s[8:11], s67 offen sc1
    s_add_u32 s67, s67, s68
    v_mfma_f32_16x16x32_bf16 v[220:223], v[108:111], v[28:31], v[220:223]
    ds_read_b64_tr_b16 v[108:109], v57 offset:16384
    s_waitcnt lgkmcnt(13)
    v_mfma_f32_16x16x32_bf16 v[224:227], v[112:115], v[24:27], v[224:227]
    ds_read_b64_tr_b16 v[110:111], v57 offset:17408
    v_mfma_f32_16x16x32_bf16 v[228:231], v[112:115], v[28:31], v[228:231]
    ds_read_b64_tr_b16 v[112:113], v58 offset:16384
    s_waitcnt lgkmcnt(13)
    v_mfma_f32_16x16x32_bf16 v[232:235], v[116:119], v[24:27], v[232:235]
    ds_read_b64_tr_b16 v[114:115], v58 offset:17408
    v_mfma_f32_16x16x32_bf16 v[236:239], v[116:119], v[28:31], v[236:239]
    ds_read_b64_tr_b16 v[116:117], v59 offset:16384
    s_waitcnt lgkmcnt(13)
    v_mfma_f32_16x16x32_bf16 v[240:243], v[120:123], v[24:27], v[240:243]
    ds_read_b64_tr_b16 v[118:119], v59 offset:17408
    v_mfma_f32_16x16x32_bf16 v[244:247], v[120:123], v[28:31], v[244:247]
    ds_read_b64_tr_b16 v[120:121], v60 offset:16384
    s_waitcnt lgkmcnt(13)
    v_mfma_f32_16x16x32_bf16 v[248:251], v[124:127], v[24:27], v[248:251]
    ds_read_b64_tr_b16 v[122:123], v60 offset:17408
    v_mfma_f32_16x16x32_bf16 v[252:255], v[124:127], v[28:31], v[252:255]
    ds_read_b64_tr_b16 v[124:125], v61 offset:16384
    ds_read_b64_tr_b16 v[126:127], v61 offset:17408
    buffer_load_dwordx4 v[24:27], v13, s[8:11], s86 offen offset:0 sc1
    buffer_load_dwordx4 v[28:31], v12, s[8:11], s86 offen offset:0 sc1
    s_waitcnt lgkmcnt(14)
    v_mfma_f32_16x16x32_bf16 v[192:195], v[96:99], v[32:35], v[192:195]
    v_mfma_f32_16x16x32_bf16 v[196:199], v[96:99], v[36:39], v[196:199]
    ds_read_b64_tr_b16 v[96:97], v54 offset:24576
    s_waitcnt lgkmcnt(13)
    v_mfma_f32_16x16x32_bf16 v[200:203], v[100:103], v[32:35], v[200:203]
    ds_read_b64_tr_b16 v[98:99], v54 offset:25600
    v_mfma_f32_16x16x32_bf16 v[204:207], v[100:103], v[36:39], v[204:207]
    ds_read_b64_tr_b16 v[100:101], v55 offset:24576
    s_waitcnt lgkmcnt(13)
    v_mfma_f32_16x16x32_bf16 v[208:211], v[104:107], v[32:35], v[208:211]
    ds_read_b64_tr_b16 v[102:103], v55 offset:25600
    v_mfma_f32_16x16x32_bf16 v[212:215], v[104:107], v[36:39], v[212:215]
    ds_read_b64_tr_b16 v[104:105], v56 offset:24576
    s_waitcnt lgkmcnt(13)
    v_mfma_f32_16x16x32_bf16 v[216:219], v[108:111], v[32:35], v[216:219]
    ds_read_b64_tr_b16 v[106:107], v56 offset:25600
    buffer_store_dwordx4 v[136:139], v13, s[8:11], s67 offen sc1
    s_add_u32 s67, s67, 1024
    v_mfma_f32_16x16x32_bf16 v[220:223], v[108:111], v[36:39], v[220:223]
    ds_read_b64_tr_b16 v[108:109], v57 offset:24576
    s_waitcnt lgkmcnt(13)
    v_mfma_f32_16x16x32_bf16 v[224:227], v[112:115], v[32:35], v[224:227]
    ds_read_b64_tr_b16 v[110:111], v57 offset:25600
    v_mfma_f32_16x16x32_bf16 v[228:231], v[112:115], v[36:39], v[228:231]
    ds_read_b64_tr_b16 v[112:113], v58 offset:24576
    s_waitcnt lgkmcnt(13)
    v_mfma_f32_16x16x32_bf16 v[232:235], v[116:119], v[32:35], v[232:235]
    ds_read_b64_tr_b16 v[114:115], v58 offset:25600
    v_mfma_f32_16x16x32_bf16 v[236:239], v[116:119], v[36:39], v[236:239]
    ds_read_b64_tr_b16 v[116:117], v59 offset:24576
    s_waitcnt lgkmcnt(13)
    v_mfma_f32_16x16x32_bf16 v[240:243], v[120:123], v[32:35], v[240:243]
    ds_read_b64_tr_b16 v[118:119], v59 offset:25600
    v_mfma_f32_16x16x32_bf16 v[244:247], v[120:123], v[36:39], v[244:247]
    ds_read_b64_tr_b16 v[120:121], v60 offset:24576
    s_waitcnt lgkmcnt(13)
    v_mfma_f32_16x16x32_bf16 v[248:251], v[124:127], v[32:35], v[248:251]
    ds_read_b64_tr_b16 v[122:123], v60 offset:25600
    v_mfma_f32_16x16x32_bf16 v[252:255], v[124:127], v[36:39], v[252:255]
    ds_read_b64_tr_b16 v[124:125], v61 offset:24576
    ds_read_b64_tr_b16 v[126:127], v61 offset:25600
    buffer_load_dwordx4 v[32:35], v13, s[8:11], s86 offen offset:1024 sc1
    buffer_load_dwordx4 v[36:39], v12, s[8:11], s86 offen offset:1024 sc1
    s_waitcnt vmcnt(15)
    s_waitcnt lgkmcnt(14)
    v_mfma_f32_16x16x32_bf16 v[192:195], v[96:99], v[64:67], v[192:195]
    v_add_u32 v54, 0xfffe0000, v54
    v_mfma_f32_16x16x32_bf16 v[196:199], v[96:99], v[68:71], v[196:199]
    ds_read_b64_tr_b16 v[96:97], v54 offset:0
    s_waitcnt lgkmcnt(13)
    v_mfma_f32_16x16x32_bf16 v[200:203], v[100:103], v[64:67], v[200:203]
    ds_read_b64_tr_b16 v[98:99], v54 offset:1024
    v_add_u32 v55, 0xfffe0000, v55
    v_mfma_f32_16x16x32_bf16 v[204:207], v[100:103], v[68:71], v[204:207]
    ds_read_b64_tr_b16 v[100:101], v55 offset:0
    s_waitcnt lgkmcnt(13)
    v_mfma_f32_16x16x32_bf16 v[208:211], v[104:107], v[64:67], v[208:211]
    ds_read_b64_tr_b16 v[102:103], v55 offset:1024
    v_add_u32 v56, 0xfffe0000, v56
    v_mfma_f32_16x16x32_bf16 v[212:215], v[104:107], v[68:71], v[212:215]
    ds_read_b64_tr_b16 v[104:105], v56 offset:0
    s_waitcnt lgkmcnt(13)
    v_mfma_f32_16x16x32_bf16 v[216:219], v[108:111], v[64:67], v[216:219]
    ds_read_b64_tr_b16 v[106:107], v56 offset:1024
    v_add_u32 v57, 0xfffe0000, v57
    buffer_store_dwordx4 v[140:143], v13, s[8:11], s67 offen sc1
    s_add_u32 s67, s67, s69
    v_mfma_f32_16x16x32_bf16 v[220:223], v[108:111], v[68:71], v[220:223]
    ds_read_b64_tr_b16 v[108:109], v57 offset:0
    s_waitcnt lgkmcnt(13)
    v_mfma_f32_16x16x32_bf16 v[224:227], v[112:115], v[64:67], v[224:227]
    ds_read_b64_tr_b16 v[110:111], v57 offset:1024
    v_add_u32 v58, 0xfffe0000, v58
    v_mfma_f32_16x16x32_bf16 v[228:231], v[112:115], v[68:71], v[228:231]
    ds_read_b64_tr_b16 v[112:113], v58 offset:0
    s_waitcnt lgkmcnt(13)
    v_mfma_f32_16x16x32_bf16 v[232:235], v[116:119], v[64:67], v[232:235]
    ds_read_b64_tr_b16 v[114:115], v58 offset:1024
    v_add_u32 v59, 0xfffe0000, v59
    v_mfma_f32_16x16x32_bf16 v[236:239], v[116:119], v[68:71], v[236:239]
    ds_read_b64_tr_b16 v[116:117], v59 offset:0
    s_waitcnt lgkmcnt(13)
    v_mfma_f32_16x16x32_bf16 v[240:243], v[120:123], v[64:67], v[240:243]
    ds_read_b64_tr_b16 v[118:119], v59 offset:1024
    v_add_u32 v60, 0xfffe0000, v60
    v_mfma_f32_16x16x32_bf16 v[244:247], v[120:123], v[68:71], v[244:247]
    ds_read_b64_tr_b16 v[120:121], v60 offset:0
    s_waitcnt lgkmcnt(13)
    v_mfma_f32_16x16x32_bf16 v[248:251], v[124:127], v[64:67], v[248:251]
    ds_read_b64_tr_b16 v[122:123], v60 offset:1024
    v_add_u32 v61, 0xfffe0000, v61
    v_mfma_f32_16x16x32_bf16 v[252:255], v[124:127], v[68:71], v[252:255]
    ds_read_b64_tr_b16 v[124:125], v61 offset:0
    ds_read_b64_tr_b16 v[126:127], v61 offset:1024
    buffer_load_dwordx4 v[64:67], v13, s[8:11], s86 offen offset:2048 sc1
    buffer_load_dwordx4 v[68:71], v12, s[8:11], s86 offen offset:2048 sc1
    s_waitcnt vmcnt(16)
    s_waitcnt lgkmcnt(14)
    v_mfma_f32_16x16x32_bf16 v[192:195], v[96:99], v[72:75], v[192:195]
    v_mfma_f32_16x16x32_bf16 v[196:199], v[96:99], v[76:79], v[196:199]
    ds_read_b64_tr_b16 v[96:97], v54 offset:8192
    s_waitcnt lgkmcnt(13)
    v_mfma_f32_16x16x32_bf16 v[200:203], v[100:103], v[72:75], v[200:203]
    ds_read_b64_tr_b16 v[98:99], v54 offset:9216
    v_mfma_f32_16x16x32_bf16 v[204:207], v[100:103], v[76:79], v[204:207]
    ds_read_b64_tr_b16 v[100:101], v55 offset:8192
    s_waitcnt lgkmcnt(13)
    v_mfma_f32_16x16x32_bf16 v[208:211], v[104:107], v[72:75], v[208:211]
    ds_read_b64_tr_b16 v[102:103], v55 offset:9216
    v_mfma_f32_16x16x32_bf16 v[212:215], v[104:107], v[76:79], v[212:215]
    ds_read_b64_tr_b16 v[104:105], v56 offset:8192
    s_waitcnt lgkmcnt(13)
    v_mfma_f32_16x16x32_bf16 v[216:219], v[108:111], v[72:75], v[216:219]
    ds_read_b64_tr_b16 v[106:107], v56 offset:9216
    v_mfma_f32_16x16x32_bf16 v[220:223], v[108:111], v[76:79], v[220:223]
    ds_read_b64_tr_b16 v[108:109], v57 offset:8192
    s_waitcnt lgkmcnt(13)
    v_mfma_f32_16x16x32_bf16 v[224:227], v[112:115], v[72:75], v[224:227]
    ds_read_b64_tr_b16 v[110:111], v57 offset:9216
    v_mfma_f32_16x16x32_bf16 v[228:231], v[112:115], v[76:79], v[228:231]
    ds_read_b64_tr_b16 v[112:113], v58 offset:8192
    s_waitcnt lgkmcnt(13)
    v_mfma_f32_16x16x32_bf16 v[232:235], v[116:119], v[72:75], v[232:235]
    ds_read_b64_tr_b16 v[114:115], v58 offset:9216
    v_mfma_f32_16x16x32_bf16 v[236:239], v[116:119], v[76:79], v[236:239]
    ds_read_b64_tr_b16 v[116:117], v59 offset:8192
    s_waitcnt lgkmcnt(13)
    v_mfma_f32_16x16x32_bf16 v[240:243], v[120:123], v[72:75], v[240:243]
    ds_read_b64_tr_b16 v[118:119], v59 offset:9216
    v_mfma_f32_16x16x32_bf16 v[244:247], v[120:123], v[76:79], v[244:247]
    ds_read_b64_tr_b16 v[120:121], v60 offset:8192
    s_waitcnt lgkmcnt(13)
    v_mfma_f32_16x16x32_bf16 v[248:251], v[124:127], v[72:75], v[248:251]
    ds_read_b64_tr_b16 v[122:123], v60 offset:9216
    v_mfma_f32_16x16x32_bf16 v[252:255], v[124:127], v[76:79], v[252:255]
    ds_read_b64_tr_b16 v[124:125], v61 offset:8192
    ds_read_b64_tr_b16 v[126:127], v61 offset:9216
    buffer_load_dwordx4 v[72:75], v13, s[8:11], s86 offen offset:3072 sc1
    buffer_load_dwordx4 v[76:79], v12, s[8:11], s86 offen offset:3072 sc1
    s_waitcnt vmcnt(16)
    s_waitcnt lgkmcnt(14)
    v_mfma_f32_16x16x32_bf16 v[192:195], v[96:99], v[80:83], v[192:195]
    v_mfma_f32_16x16x32_bf16 v[196:199], v[96:99], v[84:87], v[196:199]
    ds_read_b64_tr_b16 v[96:97], v54 offset:16384
    s_waitcnt lgkmcnt(13)
    v_mfma_f32_16x16x32_bf16 v[200:203], v[100:103], v[80:83], v[200:203]
    ds_read_b64_tr_b16 v[98:99], v54 offset:17408
    v_mfma_f32_16x16x32_bf16 v[204:207], v[100:103], v[84:87], v[204:207]
    ds_read_b64_tr_b16 v[100:101], v55 offset:16384
    s_waitcnt lgkmcnt(13)
    v_mfma_f32_16x16x32_bf16 v[208:211], v[104:107], v[80:83], v[208:211]
    ds_read_b64_tr_b16 v[102:103], v55 offset:17408
    v_mfma_f32_16x16x32_bf16 v[212:215], v[104:107], v[84:87], v[212:215]
    ds_read_b64_tr_b16 v[104:105], v56 offset:16384
    s_waitcnt lgkmcnt(13)
    v_mfma_f32_16x16x32_bf16 v[216:219], v[108:111], v[80:83], v[216:219]
    ds_read_b64_tr_b16 v[106:107], v56 offset:17408
    v_mfma_f32_16x16x32_bf16 v[220:223], v[108:111], v[84:87], v[220:223]
    ds_read_b64_tr_b16 v[108:109], v57 offset:16384
    s_waitcnt lgkmcnt(13)
    v_mfma_f32_16x16x32_bf16 v[224:227], v[112:115], v[80:83], v[224:227]
    ds_read_b64_tr_b16 v[110:111], v57 offset:17408
    v_mfma_f32_16x16x32_bf16 v[228:231], v[112:115], v[84:87], v[228:231]
    ds_read_b64_tr_b16 v[112:113], v58 offset:16384
    s_waitcnt lgkmcnt(13)
    v_mfma_f32_16x16x32_bf16 v[232:235], v[116:119], v[80:83], v[232:235]
    ds_read_b64_tr_b16 v[114:115], v58 offset:17408
    v_mfma_f32_16x16x32_bf16 v[236:239], v[116:119], v[84:87], v[236:239]
    ds_read_b64_tr_b16 v[116:117], v59 offset:16384
    s_waitcnt lgkmcnt(13)
    v_mfma_f32_16x16x32_bf16 v[240:243], v[120:123], v[80:83], v[240:243]
    ds_read_b64_tr_b16 v[118:119], v59 offset:17408
    v_mfma_f32_16x16x32_bf16 v[244:247], v[120:123], v[84:87], v[244:247]
    ds_read_b64_tr_b16 v[120:121], v60 offset:16384
    s_waitcnt lgkmcnt(13)
    v_mfma_f32_16x16x32_bf16 v[248:251], v[124:127], v[80:83], v[248:251]
    ds_read_b64_tr_b16 v[122:123], v60 offset:17408
    v_mfma_f32_16x16x32_bf16 v[252:255], v[124:127], v[84:87], v[252:255]
    ds_read_b64_tr_b16 v[124:125], v61 offset:16384
    ds_read_b64_tr_b16 v[126:127], v61 offset:17408
    buffer_load_dwordx4 v[80:83], v13, s[8:11], s87 offen offset:0 sc1
    buffer_load_dwordx4 v[84:87], v12, s[8:11], s87 offen offset:0 sc1
    s_waitcnt vmcnt(16)
    s_waitcnt lgkmcnt(14)
    v_mfma_f32_16x16x32_bf16 v[192:195], v[96:99], v[88:91], v[192:195]
    v_mfma_f32_16x16x32_bf16 v[196:199], v[96:99], v[92:95], v[196:199]
    ds_read_b64_tr_b16 v[96:97], v54 offset:24576
    s_waitcnt lgkmcnt(13)
    v_mfma_f32_16x16x32_bf16 v[200:203], v[100:103], v[88:91], v[200:203]
    ds_read_b64_tr_b16 v[98:99], v54 offset:25600
    v_mfma_f32_16x16x32_bf16 v[204:207], v[100:103], v[92:95], v[204:207]
    ds_read_b64_tr_b16 v[100:101], v55 offset:24576
    s_waitcnt lgkmcnt(13)
    v_mfma_f32_16x16x32_bf16 v[208:211], v[104:107], v[88:91], v[208:211]
    ds_read_b64_tr_b16 v[102:103], v55 offset:25600
    v_mfma_f32_16x16x32_bf16 v[212:215], v[104:107], v[92:95], v[212:215]
    ds_read_b64_tr_b16 v[104:105], v56 offset:24576
    s_waitcnt lgkmcnt(13)
    v_mfma_f32_16x16x32_bf16 v[216:219], v[108:111], v[88:91], v[216:219]
    ds_read_b64_tr_b16 v[106:107], v56 offset:25600
    v_mfma_f32_16x16x32_bf16 v[220:223], v[108:111], v[92:95], v[220:223]
    ds_read_b64_tr_b16 v[108:109], v57 offset:24576
    s_waitcnt lgkmcnt(13)
    v_mfma_f32_16x16x32_bf16 v[224:227], v[112:115], v[88:91], v[224:227]
    ds_read_b64_tr_b16 v[110:111], v57 offset:25600
    v_mfma_f32_16x16x32_bf16 v[228:231], v[112:115], v[92:95], v[228:231]
    ds_read_b64_tr_b16 v[112:113], v58 offset:24576
    s_waitcnt lgkmcnt(13)
    v_mfma_f32_16x16x32_bf16 v[232:235], v[116:119], v[88:91], v[232:235]
    ds_read_b64_tr_b16 v[114:115], v58 offset:25600
    v_mfma_f32_16x16x32_bf16 v[236:239], v[116:119], v[92:95], v[236:239]
    ds_read_b64_tr_b16 v[116:117], v59 offset:24576
    s_waitcnt lgkmcnt(13)
    v_mfma_f32_16x16x32_bf16 v[240:243], v[120:123], v[88:91], v[240:243]
    ds_read_b64_tr_b16 v[118:119], v59 offset:25600
    v_mfma_f32_16x16x32_bf16 v[244:247], v[120:123], v[92:95], v[244:247]
    ds_read_b64_tr_b16 v[120:121], v60 offset:24576
    s_waitcnt lgkmcnt(13)
    v_mfma_f32_16x16x32_bf16 v[248:251], v[124:127], v[88:91], v[248:251]
    ds_read_b64_tr_b16 v[122:123], v60 offset:25600
    v_mfma_f32_16x16x32_bf16 v[252:255], v[124:127], v[92:95], v[252:255]
    ds_read_b64_tr_b16 v[124:125], v61 offset:24576
    ds_read_b64_tr_b16 v[126:127], v61 offset:25600
    buffer_load_dwordx4 v[88:91], v13, s[8:11], s87 offen offset:1024 sc1
    buffer_load_dwordx4 v[92:95], v12, s[8:11], s87 offen offset:1024 sc1
    s_waitcnt vmcnt(8)
    s_lshl_b32 s6, s4, 3
    s_add_u32 s6, s6, s5
    s_lshl_b32 s6, s6, 5
    s_add_u32 s6, s6, s3
    s_lshl_b32 s6, s6, 2
    s_add_u32 s6, s6, 3866624
    v_mov_b32 v2, 1
    v_mov_b32 v3, 0x5000000
    v_writelane_b32 v3, s6, 0
    buffer_store_dword v2, v3, s[8:11], 0 offen sc1
    s_waitcnt lgkmcnt(14)
    v_mfma_f32_16x16x32_bf16 v[192:195], v[96:99], v[16:19], v[192:195]
    v_mfma_f32_16x16x32_bf16 v[196:199], v[96:99], v[20:23], v[196:199]
    ds_read_b64_tr_b16 v[96:97], v54 offset:32768
    s_waitcnt lgkmcnt(13)
    v_mfma_f32_16x16x32_bf16 v[200:203], v[100:103], v[16:19], v[200:203]
    ds_read_b64_tr_b16 v[98:99], v54 offset:33792
    v_mfma_f32_16x16x32_bf16 v[204:207], v[100:103], v[20:23], v[204:207]
    ds_read_b64_tr_b16 v[100:101], v55 offset:32768
    s_waitcnt lgkmcnt(13)
    v_mfma_f32_16x16x32_bf16 v[208:211], v[104:107], v[16:19], v[208:211]
    ds_read_b64_tr_b16 v[102:103], v55 offset:33792
    v_mfma_f32_16x16x32_bf16 v[212:215], v[104:107], v[20:23], v[212:215]
    ds_read_b64_tr_b16 v[104:105], v56 offset:32768
    s_waitcnt lgkmcnt(13)
    v_mfma_f32_16x16x32_bf16 v[216:219], v[108:111], v[16:19], v[216:219]
    ds_read_b64_tr_b16 v[106:107], v56 offset:33792
    v_mfma_f32_16x16x32_bf16 v[220:223], v[108:111], v[20:23], v[220:223]
    ds_read_b64_tr_b16 v[108:109], v57 offset:32768
    s_waitcnt lgkmcnt(13)
    v_mfma_f32_16x16x32_bf16 v[224:227], v[112:115], v[16:19], v[224:227]
    ds_read_b64_tr_b16 v[110:111], v57 offset:33792
    v_mfma_f32_16x16x32_bf16 v[228:231], v[112:115], v[20:23], v[228:231]
    ds_read_b64_tr_b16 v[112:113], v58 offset:32768
    s_waitcnt lgkmcnt(13)
    v_mfma_f32_16x16x32_bf16 v[232:235], v[116:119], v[16:19], v[232:235]
    ds_read_b64_tr_b16 v[114:115], v58 offset:33792
    v_mfma_f32_16x16x32_bf16 v[236:239], v[116:119], v[20:23], v[236:239]
    ds_read_b64_tr_b16 v[116:117], v59 offset:32768
    s_waitcnt lgkmcnt(13)
    v_mfma_f32_16x16x32_bf16 v[240:243], v[120:123], v[16:19], v[240:243]
    ds_read_b64_tr_b16 v[118:119], v59 offset:33792
    v_mfma_f32_16x16x32_bf16 v[244:247], v[120:123], v[20:23], v[244:247]
    ds_read_b64_tr_b16 v[120:121], v60 offset:32768
    s_waitcnt lgkmcnt(13)
    v_mfma_f32_16x16x32_bf16 v[248:251], v[124:127], v[16:19], v[248:251]
    ds_read_b64_tr_b16 v[122:123], v60 offset:33792
    v_mfma_f32_16x16x32_bf16 v[252:255], v[124:127], v[20:23], v[252:255]
    ds_read_b64_tr_b16 v[124:125], v61 offset:32768
    ds_read_b64_tr_b16 v[126:127], v61 offset:33792
    buffer_load_dwordx4 v[16:19], v13, s[8:11], s87 offen offset:2048 sc1
    buffer_load_dwordx4 v[20:23], v12, s[8:11], s87 offen offset:2048 sc1
    s_waitcnt lgkmcnt(14)
    v_mfma_f32_16x16x32_bf16 v[192:195], v[96:99], v[24:27], v[192:195]
    v_mfma_f32_16x16x32_bf16 v[196:199], v[96:99], v[28:31], v[196:199]
    ds_read_b64_tr_b16 v[96:97], v54 offset:40960
    s_waitcnt lgkmcnt(13)
    v_mfma_f32_16x16x32_bf16 v[200:203], v[100:103], v[24:27], v[200:203]
    ds_read_b64_tr_b16 v[98:99], v54 offset:41984
    v_mfma_f32_16x16x32_bf16 v[204:207], v[100:103], v[28:31], v[204:207]
    ds_read_b64_tr_b16 v[100:101], v55 offset:40960
    s_waitcnt lgkmcnt(13)
    v_mfma_f32_16x16x32_bf16 v[208:211], v[104:107], v[24:27], v[208:211]
    ds_read_b64_tr_b16 v[102:103], v55 offset:41984
    v_mfma_f32_16x16x32_bf16 v[212:215], v[104:107], v[28:31], v[212:215]
    ds_read_b64_tr_b16 v[104:105], v56 offset:40960
    s_waitcnt lgkmcnt(13)
    v_mfma_f32_16x16x32_bf16 v[216:219], v[108:111], v[24:27], v[216:219]
    ds_read_b64_tr_b16 v[106:107], v56 offset:41984
    v_mfma_f32_16x16x32_bf16 v[220:223], v[108:111], v[28:31], v[220:223]
    ds_read_b64_tr_b16 v[108:109], v57 offset:40960
    s_waitcnt lgkmcnt(13)
    v_mfma_f32_16x16x32_bf16 v[224:227], v[112:115], v[24:27], v[224:227]
    ds_read_b64_tr_b16 v[110:111], v57 offset:41984
    v_mfma_f32_16x16x32_bf16 v[228:231], v[112:115], v[28:31], v[228:231]
    ds_read_b64_tr_b16 v[112:113], v58 offset:40960
    s_waitcnt lgkmcnt(13)
    v_mfma_f32_16x16x32_bf16 v[232:235], v[116:119], v[24:27], v[232:235]
    ds_read_b64_tr_b16 v[114:115], v58 offset:41984
    v_mfma_f32_16x16x32_bf16 v[236:239], v[116:119], v[28:31], v[236:239]
    ds_read_b64_tr_b16 v[116:117], v59 offset:40960
    s_waitcnt lgkmcnt(13)
    v_mfma_f32_16x16x32_bf16 v[240:243], v[120:123], v[24:27], v[240:243]
    ds_read_b64_tr_b16 v[118:119], v59 offset:41984
    v_mfma_f32_16x16x32_bf16 v[244:247], v[120:123], v[28:31], v[244:247]
    ds_read_b64_tr_b16 v[120:121], v60 offset:40960
    s_waitcnt lgkmcnt(13)
    v_mfma_f32_16x16x32_bf16 v[248:251], v[124:127], v[24:27], v[248:251]
    ds_read_b64_tr_b16 v[122:123], v60 offset:41984
    v_mfma_f32_16x16x32_bf16 v[252:255], v[124:127], v[28:31], v[252:255]
    ds_read_b64_tr_b16 v[124:125], v61 offset:40960
    ds_read_b64_tr_b16 v[126:127], v61 offset:41984
    buffer_load_dwordx4 v[24:27], v13, s[8:11], s87 offen offset:3072 sc1
    buffer_load_dwordx4 v[28:31], v12, s[8:11], s87 offen offset:3072 sc1
    s_waitcnt lgkmcnt(14)
    v_mfma_f32_16x16x32_bf16 v[192:195], v[96:99], v[32:35], v[192:195]
    v_mfma_f32_16x16x32_bf16 v[196:199], v[96:99], v[36:39], v[196:199]
    ds_read_b64_tr_b16 v[96:97], v54 offset:49152
    s_waitcnt lgkmcnt(13)
    v_mfma_f32_16x16x32_bf16 v[200:203], v[100:103], v[32:35], v[200:203]
    ds_read_b64_tr_b16 v[98:99], v54 offset:50176
    v_mfma_f32_16x16x32_bf16 v[204:207], v[100:103], v[36:39], v[204:207]
    ds_read_b64_tr_b16 v[100:101], v55 offset:49152
    s_waitcnt lgkmcnt(13)
    v_mfma_f32_16x16x32_bf16 v[208:211], v[104:107], v[32:35], v[208:211]
    ds_read_b64_tr_b16 v[102:103], v55 offset:50176
    v_mfma_f32_16x16x32_bf16 v[212:215], v[104:107], v[36:39], v[212:215]
    ds_read_b64_tr_b16 v[104:105], v56 offset:49152
    s_waitcnt lgkmcnt(13)
    v_mfma_f32_16x16x32_bf16 v[216:219], v[108:111], v[32:35], v[216:219]
    ds_read_b64_tr_b16 v[106:107], v56 offset:50176
    v_mfma_f32_16x16x32_bf16 v[220:223], v[108:111], v[36:39], v[220:223]
    ds_read_b64_tr_b16 v[108:109], v57 offset:49152
    s_waitcnt lgkmcnt(13)
    v_mfma_f32_16x16x32_bf16 v[224:227], v[112:115], v[32:35], v[224:227]
    ds_read_b64_tr_b16 v[110:111], v57 offset:50176
    v_mfma_f32_16x16x32_bf16 v[228:231], v[112:115], v[36:39], v[228:231]
    ds_read_b64_tr_b16 v[112:113], v58 offset:49152
    s_waitcnt lgkmcnt(13)
    v_mfma_f32_16x16x32_bf16 v[232:235], v[116:119], v[32:35], v[232:235]
    ds_read_b64_tr_b16 v[114:115], v58 offset:50176
    v_mfma_f32_16x16x32_bf16 v[236:239], v[116:119], v[36:39], v[236:239]
    ds_read_b64_tr_b16 v[116:117], v59 offset:49152
    s_waitcnt lgkmcnt(13)
    v_mfma_f32_16x16x32_bf16 v[240:243], v[120:123], v[32:35], v[240:243]
    ds_read_b64_tr_b16 v[118:119], v59 offset:50176
    v_mfma_f32_16x16x32_bf16 v[244:247], v[120:123], v[36:39], v[244:247]
    ds_read_b64_tr_b16 v[120:121], v60 offset:49152
    s_waitcnt lgkmcnt(13)
    v_mfma_f32_16x16x32_bf16 v[248:251], v[124:127], v[32:35], v[248:251]
    ds_read_b64_tr_b16 v[122:123], v60 offset:50176
    v_mfma_f32_16x16x32_bf16 v[252:255], v[124:127], v[36:39], v[252:255]
    ds_read_b64_tr_b16 v[124:125], v61 offset:49152
    ds_read_b64_tr_b16 v[126:127], v61 offset:50176
    buffer_load_dwordx4 v[32:35], v13, s[8:11], s88 offen offset:0 sc1
    buffer_load_dwordx4 v[36:39], v12, s[8:11], s88 offen offset:0 sc1
    s_waitcnt vmcnt(13)
    s_waitcnt lgkmcnt(14)
    v_mfma_f32_16x16x32_bf16 v[192:195], v[96:99], v[64:67], v[192:195]
    v_mfma_f32_16x16x32_bf16 v[196:199], v[96:99], v[68:71], v[196:199]
    ds_read_b64_tr_b16 v[96:97], v54 offset:57344
    s_waitcnt lgkmcnt(13)
    v_mfma_f32_16x16x32_bf16 v[200:203], v[100:103], v[64:67], v[200:203]
    ds_read_b64_tr_b16 v[98:99], v54 offset:58368
    v_mfma_f32_16x16x32_bf16 v[204:207], v[100:103], v[68:71], v[204:207]
    ds_read_b64_tr_b16 v[100:101], v55 offset:57344
    s_waitcnt lgkmcnt(13)
    v_mfma_f32_16x16x32_bf16 v[208:211], v[104:107], v[64:67], v[208:211]
    ds_read_b64_tr_b16 v[102:103], v55 offset:58368
    v_mfma_f32_16x16x32_bf16 v[212:215], v[104:107], v[68:71], v[212:215]
    ds_read_b64_tr_b16 v[104:105], v56 offset:57344
    s_waitcnt lgkmcnt(13)
    v_mfma_f32_16x16x32_bf16 v[216:219], v[108:111], v[64:67], v[216:219]
    ds_read_b64_tr_b16 v[106:107], v56 offset:58368
    v_mfma_f32_16x16x32_bf16 v[220:223], v[108:111], v[68:71], v[220:223]
    ds_read_b64_tr_b16 v[108:109], v57 offset:57344
    s_waitcnt lgkmcnt(13)
    v_mfma_f32_16x16x32_bf16 v[224:227], v[112:115], v[64:67], v[224:227]
    ds_read_b64_tr_b16 v[110:111], v57 offset:58368
    v_mfma_f32_16x16x32_bf16 v[228:231], v[112:115], v[68:71], v[228:231]
    ds_read_b64_tr_b16 v[112:113], v58 offset:57344
    s_waitcnt lgkmcnt(13)
    v_mfma_f32_16x16x32_bf16 v[232:235], v[116:119], v[64:67], v[232:235]
    ds_read_b64_tr_b16 v[114:115], v58 offset:58368
    v_mfma_f32_16x16x32_bf16 v[236:239], v[116:119], v[68:71], v[236:239]
    ds_read_b64_tr_b16 v[116:117], v59 offset:57344
    s_waitcnt lgkmcnt(13)
    v_mfma_f32_16x16x32_bf16 v[240:243], v[120:123], v[64:67], v[240:243]
    ds_read_b64_tr_b16 v[118:119], v59 offset:58368
    v_mfma_f32_16x16x32_bf16 v[244:247], v[120:123], v[68:71], v[244:247]
    ds_read_b64_tr_b16 v[120:121], v60 offset:57344
    s_waitcnt lgkmcnt(13)
    v_mfma_f32_16x16x32_bf16 v[248:251], v[124:127], v[64:67], v[248:251]
    ds_read_b64_tr_b16 v[122:123], v60 offset:58368
    v_mfma_f32_16x16x32_bf16 v[252:255], v[124:127], v[68:71], v[252:255]
    ds_read_b64_tr_b16 v[124:125], v61 offset:57344
    ds_read_b64_tr_b16 v[126:127], v61 offset:58368
    buffer_load_dwordx4 v[64:67], v13, s[8:11], s88 offen offset:1024 sc1
    buffer_load_dwordx4 v[68:71], v12, s[8:11], s88 offen offset:1024 sc1
    s_waitcnt vmcnt(13)
    s_waitcnt lgkmcnt(14)
    v_mfma_f32_16x16x32_bf16 v[192:195], v[96:99], v[72:75], v[192:195]
    v_add_u32 v54, 0x10000, v54
    v_mfma_f32_16x16x32_bf16 v[196:199], v[96:99], v[76:79], v[196:199]
    s_waitcnt lgkmcnt(12)
    v_mfma_f32_16x16x32_bf16 v[200:203], v[100:103], v[72:75], v[200:203]
    v_add_u32 v55, 0x10000, v55
    v_mfma_f32_16x16x32_bf16 v[204:207], v[100:103], v[76:79], v[204:207]
    s_waitcnt lgkmcnt(0)
    s_barrier
    ds_read_b64_tr_b16 v[96:97], v54 offset:0
    ds_read_b64_tr_b16 v[98:99], v54 offset:1024
    ds_read_b64_tr_b16 v[100:101], v55 offset:0
    v_mfma_f32_16x16x32_bf16 v[208:211], v[104:107], v[72:75], v[208:211]
    ds_read_b64_tr_b16 v[102:103], v55 offset:1024
    v_add_u32 v56, 0x10000, v56
    v_mfma_f32_16x16x32_bf16 v[212:215], v[104:107], v[76:79], v[212:215]
    ds_read_b64_tr_b16 v[104:105], v56 offset:0
    v_mfma_f32_16x16x32_bf16 v[216:219], v[108:111], v[72:75], v[216:219]
    ds_read_b64_tr_b16 v[106:107], v56 offset:1024
    v_add_u32 v57, 0x10000, v57
    v_mfma_f32_16x16x32_bf16 v[220:223], v[108:111], v[76:79], v[220:223]
    ds_read_b64_tr_b16 v[108:109], v57 offset:0
    v_mfma_f32_16x16x32_bf16 v[224:227], v[112:115], v[72:75], v[224:227]
    ds_read_b64_tr_b16 v[110:111], v57 offset:1024
    v_add_u32 v58, 0x10000, v58
    v_mfma_f32_16x16x32_bf16 v[228:231], v[112:115], v[76:79], v[228:231]
    ds_read_b64_tr_b16 v[112:113], v58 offset:0
    v_mfma_f32_16x16x32_bf16 v[232:235], v[116:119], v[72:75], v[232:235]
    ds_read_b64_tr_b16 v[114:115], v58 offset:1024
    v_add_u32 v59, 0x10000, v59
    v_mfma_f32_16x16x32_bf16 v[236:239], v[116:119], v[76:79], v[236:239]
    ds_read_b64_tr_b16 v[116:117], v59 offset:0
    v_mfma_f32_16x16x32_bf16 v[240:243], v[120:123], v[72:75], v[240:243]
    ds_read_b64_tr_b16 v[118:119], v59 offset:1024
    v_add_u32 v60, 0x10000, v60
    v_mfma_f32_16x16x32_bf16 v[244:247], v[120:123], v[76:79], v[244:247]
    ds_read_b64_tr_b16 v[120:121], v60 offset:0
    v_mfma_f32_16x16x32_bf16 v[248:251], v[124:127], v[72:75], v[248:251]
    ds_read_b64_tr_b16 v[122:123], v60 offset:1024
    v_add_u32 v61, 0x10000, v61
    v_mfma_f32_16x16x32_bf16 v[252:255], v[124:127], v[76:79], v[252:255]
    ds_read_b64_tr_b16 v[124:125], v61 offset:0
    ds_read_b64_tr_b16 v[126:127], v61 offset:1024
    buffer_load_dwordx4 v[72:75], v13, s[8:11], s88 offen offset:2048 sc1
    buffer_load_dwordx4 v[76:79], v12, s[8:11], s88 offen offset:2048 sc1
    s_waitcnt vmcnt(13)
    s_waitcnt lgkmcnt(14)
    v_mfma_f32_16x16x32_bf16 v[192:195], v[96:99], v[80:83], v[192:195]
    v_mfma_f32_16x16x32_bf16 v[196:199], v[96:99], v[84:87], v[196:199]
    ds_read_b64_tr_b16 v[96:97], v54 offset:8192
    s_waitcnt lgkmcnt(13)
    v_mfma_f32_16x16x32_bf16 v[200:203], v[100:103], v[80:83], v[200:203]
    ds_read_b64_tr_b16 v[98:99], v54 offset:9216
    v_mfma_f32_16x16x32_bf16 v[204:207], v[100:103], v[84:87], v[204:207]
    ds_read_b64_tr_b16 v[100:101], v55 offset:8192
    s_waitcnt lgkmcnt(13)
    v_mfma_f32_16x16x32_bf16 v[208:211], v[104:107], v[80:83], v[208:211]
    ds_read_b64_tr_b16 v[102:103], v55 offset:9216
    v_mfma_f32_16x16x32_bf16 v[212:215], v[104:107], v[84:87], v[212:215]
    ds_read_b64_tr_b16 v[104:105], v56 offset:8192
    s_waitcnt lgkmcnt(13)
    v_mfma_f32_16x16x32_bf16 v[216:219], v[108:111], v[80:83], v[216:219]
    ds_read_b64_tr_b16 v[106:107], v56 offset:9216
    v_mfma_f32_16x16x32_bf16 v[220:223], v[108:111], v[84:87], v[220:223]
    ds_read_b64_tr_b16 v[108:109], v57 offset:8192
    s_waitcnt lgkmcnt(13)
    v_mfma_f32_16x16x32_bf16 v[224:227], v[112:115], v[80:83], v[224:227]
    ds_read_b64_tr_b16 v[110:111], v57 offset:9216
    v_mfma_f32_16x16x32_bf16 v[228:231], v[112:115], v[84:87], v[228:231]
    ds_read_b64_tr_b16 v[112:113], v58 offset:8192
    s_waitcnt lgkmcnt(13)
    v_mfma_f32_16x16x32_bf16 v[232:235], v[116:119], v[80:83], v[232:235]
    ds_read_b64_tr_b16 v[114:115], v58 offset:9216
    v_mfma_f32_16x16x32_bf16 v[236:239], v[116:119], v[84:87], v[236:239]
    ds_read_b64_tr_b16 v[116:117], v59 offset:8192
    s_waitcnt lgkmcnt(13)
    v_mfma_f32_16x16x32_bf16 v[240:243], v[120:123], v[80:83], v[240:243]
    ds_read_b64_tr_b16 v[118:119], v59 offset:9216
    v_mfma_f32_16x16x32_bf16 v[244:247], v[120:123], v[84:87], v[244:247]
    ds_read_b64_tr_b16 v[120:121], v60 offset:8192
    s_waitcnt lgkmcnt(13)
    v_mfma_f32_16x16x32_bf16 v[248:251], v[124:127], v[80:83], v[248:251]
    ds_read_b64_tr_b16 v[122:123], v60 offset:9216
    v_mfma_f32_16x16x32_bf16 v[252:255], v[124:127], v[84:87], v[252:255]
    ds_read_b64_tr_b16 v[124:125], v61 offset:8192
    ds_read_b64_tr_b16 v[126:127], v61 offset:9216
    buffer_load_dwordx4 v[80:83], v13, s[8:11], s88 offen offset:3072 sc1
    buffer_load_dwordx4 v[84:87], v12, s[8:11], s88 offen offset:3072 sc1
    s_waitcnt vmcnt(13)
    s_waitcnt lgkmcnt(14)
    v_mfma_f32_16x16x32_bf16 v[192:195], v[96:99], v[88:91], v[192:195]
    v_mfma_f32_16x16x32_bf16 v[196:199], v[96:99], v[92:95], v[196:199]
    ds_read_b64_tr_b16 v[96:97], v54 offset:16384
    s_waitcnt lgkmcnt(13)
    v_mfma_f32_16x16x32_bf16 v[200:203], v[100:103], v[88:91], v[200:203]
    ds_read_b64_tr_b16 v[98:99], v54 offset:17408
    v_mfma_f32_16x16x32_bf16 v[204:207], v[100:103], v[92:95], v[204:207]
    ds_read_b64_tr_b16 v[100:101], v55 offset:16384
    s_waitcnt lgkmcnt(13)
    v_mfma_f32_16x16x32_bf16 v[208:211], v[104:107], v[88:91], v[208:211]
    ds_read_b64_tr_b16 v[102:103], v55 offset:17408
    v_mfma_f32_16x16x32_bf16 v[212:215], v[104:107], v[92:95], v[212:215]
    ds_read_b64_tr_b16 v[104:105], v56 offset:16384
    s_waitcnt lgkmcnt(13)
    v_mfma_f32_16x16x32_bf16 v[216:219], v[108:111], v[88:91], v[216:219]
    ds_read_b64_tr_b16 v[106:107], v56 offset:17408
    v_mfma_f32_16x16x32_bf16 v[220:223], v[108:111], v[92:95], v[220:223]
    ds_read_b64_tr_b16 v[108:109], v57 offset:16384
    s_waitcnt lgkmcnt(13)
    v_mfma_f32_16x16x32_bf16 v[224:227], v[112:115], v[88:91], v[224:227]
    ds_read_b64_tr_b16 v[110:111], v57 offset:17408
    v_mfma_f32_16x16x32_bf16 v[228:231], v[112:115], v[92:95], v[228:231]
    ds_read_b64_tr_b16 v[112:113], v58 offset:16384
    s_waitcnt lgkmcnt(13)
    v_mfma_f32_16x16x32_bf16 v[232:235], v[116:119], v[88:91], v[232:235]
    ds_read_b64_tr_b16 v[114:115], v58 offset:17408
    v_mfma_f32_16x16x32_bf16 v[236:239], v[116:119], v[92:95], v[236:239]
    ds_read_b64_tr_b16 v[116:117], v59 offset:16384
    s_waitcnt lgkmcnt(13)
    v_mfma_f32_16x16x32_bf16 v[240:243], v[120:123], v[88:91], v[240:243]
    ds_read_b64_tr_b16 v[118:119], v59 offset:17408
    v_mfma_f32_16x16x32_bf16 v[244:247], v[120:123], v[92:95], v[244:247]
    ds_read_b64_tr_b16 v[120:121], v60 offset:16384
    s_waitcnt lgkmcnt(13)
    v_mfma_f32_16x16x32_bf16 v[248:251], v[124:127], v[88:91], v[248:251]
    ds_read_b64_tr_b16 v[122:123], v60 offset:17408
    v_mfma_f32_16x16x32_bf16 v[252:255], v[124:127], v[92:95], v[252:255]
    ds_read_b64_tr_b16 v[124:125], v61 offset:16384
    ds_read_b64_tr_b16 v[126:127], v61 offset:17408
    s_waitcnt vmcnt(10)
    s_waitcnt lgkmcnt(14)
    v_mfma_f32_16x16x32_bf16 v[192:195], v[96:99], v[16:19], v[192:195]
    v_mfma_f32_16x16x32_bf16 v[196:199], v[96:99], v[20:23], v[196:199]
    ds_read_b64_tr_b16 v[96:97], v54 offset:24576
    s_waitcnt lgkmcnt(13)
    v_mfma_f32_16x16x32_bf16 v[200:203], v[100:103], v[16:19], v[200:203]
    ds_read_b64_tr_b16 v[98:99], v54 offset:25600
    v_mfma_f32_16x16x32_bf16 v[204:207], v[100:103], v[20:23], v[204:207]
    ds_read_b64_tr_b16 v[100:101], v55 offset:24576
    s_waitcnt lgkmcnt(13)
    v_mfma_f32_16x16x32_bf16 v[208:211], v[104:107], v[16:19], v[208:211]
    ds_read_b64_tr_b16 v[102:103], v55 offset:25600
    v_mfma_f32_16x16x32_bf16 v[212:215], v[104:107], v[20:23], v[212:215]
    ds_read_b64_tr_b16 v[104:105], v56 offset:24576
    s_waitcnt lgkmcnt(13)
    v_mfma_f32_16x16x32_bf16 v[216:219], v[108:111], v[16:19], v[216:219]
    ds_read_b64_tr_b16 v[106:107], v56 offset:25600
    v_mfma_f32_16x16x32_bf16 v[220:223], v[108:111], v[20:23], v[220:223]
    ds_read_b64_tr_b16 v[108:109], v57 offset:24576
    s_waitcnt lgkmcnt(13)
    v_mfma_f32_16x16x32_bf16 v[224:227], v[112:115], v[16:19], v[224:227]
    ds_read_b64_tr_b16 v[110:111], v57 offset:25600
    v_mfma_f32_16x16x32_bf16 v[228:231], v[112:115], v[20:23], v[228:231]
    ds_read_b64_tr_b16 v[112:113], v58 offset:24576
    s_waitcnt lgkmcnt(13)
    v_mfma_f32_16x16x32_bf16 v[232:235], v[116:119], v[16:19], v[232:235]
    ds_read_b64_tr_b16 v[114:115], v58 offset:25600
    v_mfma_f32_16x16x32_bf16 v[236:239], v[116:119], v[20:23], v[236:239]
    ds_read_b64_tr_b16 v[116:117], v59 offset:24576
    s_waitcnt lgkmcnt(13)
    v_mfma_f32_16x16x32_bf16 v[240:243], v[120:123], v[16:19], v[240:243]
    ds_read_b64_tr_b16 v[118:119], v59 offset:25600
    v_mfma_f32_16x16x32_bf16 v[244:247], v[120:123], v[20:23], v[244:247]
    ds_read_b64_tr_b16 v[120:121], v60 offset:24576
    s_waitcnt lgkmcnt(13)
    v_mfma_f32_16x16x32_bf16 v[248:251], v[124:127], v[16:19], v[248:251]
    ds_read_b64_tr_b16 v[122:123], v60 offset:25600
    v_mfma_f32_16x16x32_bf16 v[252:255], v[124:127], v[20:23], v[252:255]
    ds_read_b64_tr_b16 v[124:125], v61 offset:24576
    ds_read_b64_tr_b16 v[126:127], v61 offset:25600
    s_waitcnt vmcnt(8)
    s_waitcnt lgkmcnt(14)
    v_mfma_f32_16x16x32_bf16 v[192:195], v[96:99], v[24:27], v[192:195]
    v_mfma_f32_16x16x32_bf16 v[196:199], v[96:99], v[28:31], v[196:199]
    ds_read_b64_tr_b16 v[96:97], v54 offset:32768
    s_waitcnt lgkmcnt(13)
    v_mfma_f32_16x16x32_bf16 v[200:203], v[100:103], v[24:27], v[200:203]
    ds_read_b64_tr_b16 v[98:99], v54 offset:33792
    v_mfma_f32_16x16x32_bf16 v[204:207], v[100:103], v[28:31], v[204:207]
    ds_read_b64_tr_b16 v[100:101], v55 offset:32768
    s_waitcnt lgkmcnt(13)
    v_mfma_f32_16x16x32_bf16 v[208:211], v[104:107], v[24:27], v[208:211]
    ds_read_b64_tr_b16 v[102:103], v55 offset:33792
    v_mfma_f32_16x16x32_bf16 v[212:215], v[104:107], v[28:31], v[212:215]
    ds_read_b64_tr_b16 v[104:105], v56 offset:32768
    s_waitcnt lgkmcnt(13)
    v_mfma_f32_16x16x32_bf16 v[216:219], v[108:111], v[24:27], v[216:219]
    ds_read_b64_tr_b16 v[106:107], v56 offset:33792
    v_mfma_f32_16x16x32_bf16 v[220:223], v[108:111], v[28:31], v[220:223]
    ds_read_b64_tr_b16 v[108:109], v57 offset:32768
    s_waitcnt lgkmcnt(13)
    v_mfma_f32_16x16x32_bf16 v[224:227], v[112:115], v[24:27], v[224:227]
    ds_read_b64_tr_b16 v[110:111], v57 offset:33792
    v_mfma_f32_16x16x32_bf16 v[228:231], v[112:115], v[28:31], v[228:231]
    ds_read_b64_tr_b16 v[112:113], v58 offset:32768
    s_waitcnt lgkmcnt(13)
    v_mfma_f32_16x16x32_bf16 v[232:235], v[116:119], v[24:27], v[232:235]
    ds_read_b64_tr_b16 v[114:115], v58 offset:33792
    v_mfma_f32_16x16x32_bf16 v[236:239], v[116:119], v[28:31], v[236:239]
    ds_read_b64_tr_b16 v[116:117], v59 offset:32768
    s_waitcnt lgkmcnt(13)
    v_mfma_f32_16x16x32_bf16 v[240:243], v[120:123], v[24:27], v[240:243]
    ds_read_b64_tr_b16 v[118:119], v59 offset:33792
    v_mfma_f32_16x16x32_bf16 v[244:247], v[120:123], v[28:31], v[244:247]
    ds_read_b64_tr_b16 v[120:121], v60 offset:32768
    s_waitcnt lgkmcnt(13)
    v_mfma_f32_16x16x32_bf16 v[248:251], v[124:127], v[24:27], v[248:251]
    ds_read_b64_tr_b16 v[122:123], v60 offset:33792
    v_mfma_f32_16x16x32_bf16 v[252:255], v[124:127], v[28:31], v[252:255]
    ds_read_b64_tr_b16 v[124:125], v61 offset:32768
    ds_read_b64_tr_b16 v[126:127], v61 offset:33792
    s_waitcnt vmcnt(0)
    s_cmp_ge_u32 s3, 4
    s_cbranch_scc1 L_q_nold
    s_lshl_b32 s7, s4, 10
    s_add_u32 s7, s7, 3866624
    v_lshrrev_b32 v2, 3, v1
    v_and_b32 v3, 7, v1
    v_lshlrev_b32 v3, 2, v3
    v_lshl_add_u32 v3, v2, 7, v3
    s_mov_b32 s79, 262144
L_poll_7:
    buffer_load_dword v2, v3, s[8:11], s7 offen sc1
    s_waitcnt vmcnt(0)
    v_cmp_gt_u32 vcc, 1, v2
    s_cbranch_vccz L_polldone_8
    s_sleep 2
    s_sub_u32 s79, s79, 1
    s_cmp_lg_u32 s79, 0
    s_cbranch_scc1 L_poll_7
L_polldone_8:
    s_lshl_b32 s6, s76, 13
    s_add_u32 s6, s6, s78
    s_add_u32 m0, s6, 0
    s_add_u32 s7, s77, 0
    buffer_load_dwordx4 v49, s[8:11], s7 offen offset:0 sc1 lds
    buffer_load_dwordx4 v49, s[8:11], s7 offen offset:1024 sc1 lds
    buffer_load_dwordx4 v49, s[8:11], s7 offen offset:2048 sc1 lds
    buffer_load_dwordx4 v49, s[8:11], s7 offen offset:3072 sc1 lds
    s_lshl_b32 s6, s76, 13
    s_add_u32 s6, s6, s78
    s_add_u32 m0, s6, 4096
    s_add_u32 s7, s77, 4096
    buffer_load_dwordx4 v49, s[8:11], s7 offen offset:0 sc1 lds
    buffer_load_dwordx4 v49, s[8:11], s7 offen offset:1024 sc1 lds
    buffer_load_dwordx4 v49, s[8:11], s7 offen offset:2048 sc1 lds
    buffer_load_dwordx4 v49, s[8:11], s7 offen offset:3072 sc1 lds
    s_lshl_b32 s6, s76, 12
    s_add_u32 s6, s6, s78
    s_add_u32 m0, s6, 49152
    s_add_u32 s7, s77, 524288
    buffer_load_dwordx4 v50, s[8:11], s7 offen offset:0 sc1 lds
    buffer_load_dwordx4 v50, s[8:11], s7 offen offset:1024 sc1 lds
    buffer_load_dwordx4 v50, s[8:11], s7 offen offset:2048 sc1 lds
    buffer_load_dwordx4 v50, s[8:11], s7 offen offset:3072 sc1 lds
L_q_nold:
    s_waitcnt lgkmcnt(14)
    v_mfma_f32_16x16x32_bf16 v[192:195], v[96:99], v[32:35], v[192:195]
    v_mfma_f32_16x16x32_bf16 v[196:199], v[96:99], v[36:39], v[196:199]
    ds_read_b64_tr_b16 v[96:97], v54 offset:40960
    s_waitcnt lgkmcnt(13)
    v_mfma_f32_16x16x32_bf16 v[200:203], v[100:103], v[32:35], v[200:203]
    ds_read_b64_tr_b16 v[98:99], v54 offset:41984
    v_mfma_f32_16x16x32_bf16 v[204:207], v[100:103], v[36:39], v[204:207]
    ds_read_b64_tr_b16 v[100:101], v55 offset:40960
    s_waitcnt lgkmcnt(13)
    v_mfma_f32_16x16x32_bf16 v[208:211], v[104:107], v[32:35], v[208:211]
    ds_read_b64_tr_b16 v[102:103], v55 offset:41984
    v_mfma_f32_16x16x32_bf16 v[212:215], v[104:107], v[36:39], v[212:215]
    ds_read_b64_tr_b16 v[104:105], v56 offset:40960
    s_waitcnt lgkmcnt(13)
    v_mfma_f32_16x16x32_bf16 v[216:219], v[108:111], v[32:35], v[216:219]
    ds_read_b64_tr_b16 v[106:107], v56 offset:41984
    buffer_store_dwordx4 v[144:147], v13, s[8:11], s67 offen sc1
    s_add_u32 s67, s67, 1024
    v_mfma_f32_16x16x32_bf16 v[220:223], v[108:111], v[36:39], v[220:223]
    ds_read_b64_tr_b16 v[108:109], v57 offset:40960
    s_waitcnt lgkmcnt(13)
    v_mfma_f32_16x16x32_bf16 v[224:227], v[112:115], v[32:35], v[224:227]
    ds_read_b64_tr_b16 v[110:111], v57 offset:41984
    v_mfma_f32_16x16x32_bf16 v[228:231], v[112:115], v[36:39], v[228:231]
    ds_read_b64_tr_b16 v[112:113], v58 offset:40960
    s_waitcnt lgkmcnt(13)
    v_mfma_f32_16x16x32_bf16 v[232:235], v[116:119], v[32:35], v[232:235]
    ds_read_b64_tr_b16 v[114:115], v58 offset:41984
    v_mfma_f32_16x16x32_bf16 v[236:239], v[116:119], v[36:39], v[236:239]
    ds_read_b64_tr_b16 v[116:117], v59 offset:40960
    s_waitcnt lgkmcnt(13)
    v_mfma_f32_16x16x32_bf16 v[240:243], v[120:123], v[32:35], v[240:243]
    ds_read_b64_tr_b16 v[118:119], v59 offset:41984
    v_mfma_f32_16x16x32_bf16 v[244:247], v[120:123], v[36:39], v[244:247]
    ds_read_b64_tr_b16 v[120:121], v60 offset:40960
    s_waitcnt lgkmcnt(13)
    v_mfma_f32_16x16x32_bf16 v[248:251], v[124:127], v[32:35], v[248:251]
    ds_read_b64_tr_b16 v[122:123], v60 offset:41984
    v_mfma_f32_16x16x32_bf16 v[252:255], v[124:127], v[36:39], v[252:255]
    ds_read_b64_tr_b16 v[124:125], v61 offset:40960
    ds_read_b64_tr_b16 v[126:127], v61 offset:41984
    s_waitcnt lgkmcnt(14)
    v_mfma_f32_16x16x32_bf16 v[192:195], v[96:99], v[64:67], v[192:195]
    v_mfma_f32_16x16x32_bf16 v[196:199], v[96:99], v[68:71], v[196:199]
    ds_read_b64_tr_b16 v[96:97], v54 offset:49152
    s_waitcnt lgkmcnt(13)
    v_mfma_f32_16x16x32_bf16 v[200:203], v[100:103], v[64:67], v[200:203]
    ds_read_b64_tr_b16 v[98:99], v54 offset:50176
    v_mfma_f32_16x16x32_bf16 v[204:207], v[100:103], v[68:71], v[204:207]
    ds_read_b64_tr_b16 v[100:101], v55 offset:49152
    s_waitcnt lgkmcnt(13)
    v_mfma_f32_16x16x32_bf16 v[208:211], v[104:107], v[64:67], v[208:211]
    ds_read_b64_tr_b16 v[102:103], v55 offset:50176
    v_mfma_f32_16x16x32_bf16 v[212:215], v[104:107], v[68:71], v[212:215]
    ds_read_b64_tr_b16 v[104:105], v56 offset:49152
    s_waitcnt lgkmcnt(13)
    v_mfma_f32_16x16x32_bf16 v[216:219], v[108:111], v[64:67], v[216:219]
    ds_read_b64_tr_b16 v[106:107], v56 offset:50176
    buffer_store_dwordx4 v[148:151], v13, s[8:11], s67 offen sc1
    s_add_u32 s67, s67, s68
    v_mfma_f32_16x16x32_bf16 v[220:223], v[108:111], v[68:71], v[220:223]
    ds_read_b64_tr_b16 v[108:109], v57 offset:49152
    s_waitcnt lgkmcnt(13)
    v_mfma_f32_16x16x32_bf16 v[224:227], v[112:115], v[64:67], v[224:227]
    ds_read_b64_tr_b16 v[110:111], v57 offset:50176
    v_mfma_f32_16x16x32_bf16 v[228:231], v[112:115], v[68:71], v[228:231]
    ds_read_b64_tr_b16 v[112:113], v58 offset:49152
    s_waitcnt lgkmcnt(13)
    v_mfma_f32_16x16x32_bf16 v[232:235], v[116:119], v[64:67], v[232:235]
    ds_read_b64_tr_b16 v[114:115], v58 offset:50176
    v_mfma_f32_16x16x32_bf16 v[236:239], v[116:119], v[68:71], v[236:239]
    ds_read_b64_tr_b16 v[116:117], v59 offset:49152
    s_waitcnt lgkmcnt(13)
    v_mfma_f32_16x16x32_bf16 v[240:243], v[120:123], v[64:67], v[240:243]
    ds_read_b64_tr_b16 v[118:119], v59 offset:50176
    v_mfma_f32_16x16x32_bf16 v[244:247], v[120:123], v[68:71], v[244:247]
    ds_read_b64_tr_b16 v[120:121], v60 offset:49152
    s_waitcnt lgkmcnt(13)
    v_mfma_f32_16x16x32_bf16 v[248:251], v[124:127], v[64:67], v[248:251]
    ds_read_b64_tr_b16 v[122:123], v60 offset:50176
    v_mfma_f32_16x16x32_bf16 v[252:255], v[124:127], v[68:71], v[252:255]
    ds_read_b64_tr_b16 v[124:125], v61 offset:49152
    ds_read_b64_tr_b16 v[126:127], v61 offset:50176
    s_waitcnt lgkmcnt(14)
    v_mfma_f32_16x16x32_bf16 v[192:195], v[96:99], v[72:75], v[192:195]
    v_mfma_f32_16x16x32_bf16 v[196:199], v[96:99], v[76:79], v[196:199]
    ds_read_b64_tr_b16 v[96:97], v54 offset:57344
    s_waitcnt lgkmcnt(13)
    v_mfma_f32_16x16x32_bf16 v[200:203], v[100:103], v[72:75], v[200:203]
    ds_read_b64_tr_b16 v[98:99], v54 offset:58368
    v_mfma_f32_16x16x32_bf16 v[204:207], v[100:103], v[76:79], v[204:207]
    ds_read_b64_tr_b16 v[100:101], v55 offset:57344
    s_waitcnt lgkmcnt(13)
    v_mfma_f32_16x16x32_bf16 v[208:211], v[104:107], v[72:75], v[208:211]
    ds_read_b64_tr_b16 v[102:103], v55 offset:58368
    v_mfma_f32_16x16x32_bf16 v[212:215], v[104:107], v[76:79], v[212:215]
    ds_read_b64_tr_b16 v[104:105], v56 offset:57344
    s_waitcnt lgkmcnt(13)
    v_mfma_f32_16x16x32_bf16 v[216:219], v[108:111], v[72:75], v[216:219]
    ds_read_b64_tr_b16 v[106:107], v56 offset:58368
    buffer_store_dwordx4 v[152:155], v13, s[8:11], s67 offen sc1
    s_add_u32 s67, s67, 1024
    v_mfma_f32_16x16x32_bf16 v[220:223], v[108:111], v[76:79], v[220:223]
    ds_read_b64_tr_b16 v[108:109], v57 offset:57344
    s_waitcnt lgkmcnt(13)
    v_mfma_f32_16x16x32_bf16 v[224:227], v[112:115], v[72:75], v[224:227]
    ds_read_b64_tr_b16 v[110:111], v57 offset:58368
    v_mfma_f32_16x16x32_bf16 v[228:231], v[112:115], v[76:79], v[228:231]
    ds_read_b64_tr_b16 v[112:113], v58 offset:57344
    s_waitcnt lgkmcnt(13)
    v_mfma_f32_16x16x32_bf16 v[232:235], v[116:119], v[72:75], v[232:235]
    ds_read_b64_tr_b16 v[114:115], v58 offset:58368
    v_mfma_f32_16x16x32_bf16 v[236:239], v[116:119], v[76:79], v[236:239]
    ds_read_b64_tr_b16 v[116:117], v59 offset:57344
    s_waitcnt lgkmcnt(13)
    v_mfma_f32_16x16x32_bf16 v[240:243], v[120:123], v[72:75], v[240:243]
    ds_read_b64_tr_b16 v[118:119], v59 offset:58368
    v_mfma_f32_16x16x32_bf16 v[244:247], v[120:123], v[76:79], v[244:247]
    ds_read_b64_tr_b16 v[120:121], v60 offset:57344
    s_waitcnt lgkmcnt(13)
    v_mfma_f32_16x16x32_bf16 v[248:251], v[124:127], v[72:75], v[248:251]
    ds_read_b64_tr_b16 v[122:123], v60 offset:58368
    v_mfma_f32_16x16x32_bf16 v[252:255], v[124:127], v[76:79], v[252:255]
    ds_read_b64_tr_b16 v[124:125], v61 offset:57344
    ds_read_b64_tr_b16 v[126:127], v61 offset:58368
    s_waitcnt lgkmcnt(14)
    v_mfma_f32_16x16x32_bf16 v[192:195], v[96:99], v[80:83], v[192:195]
    v_mfma_f32_16x16x32_bf16 v[196:199], v[96:99], v[84:87], v[196:199]
    s_waitcnt lgkmcnt(12)
    v_mfma_f32_16x16x32_bf16 v[200:203], v[100:103], v[80:83], v[200:203]
    v_mfma_f32_16x16x32_bf16 v[204:207], v[100:103], v[84:87], v[204:207]
    s_waitcnt lgkmcnt(10)
    v_mfma_f32_16x16x32_bf16 v[208:211], v[104:107], v[80:83], v[208:211]
    v_mfma_f32_16x16x32_bf16 v[212:215], v[104:107], v[84:87], v[212:215]
    s_waitcnt lgkmcnt(8)
    v_mfma_f32_16x16x32_bf16 v[216:219], v[108:111], v[80:83], v[216:219]
    buffer_store_dwordx4 v[156:159], v13, s[8:11], s67 offen sc1
    s_add_u32 s67, s67, s69
    v_mfma_f32_16x16x32_bf16 v[220:223], v[108:111], v[84:87], v[220:223]
    s_waitcnt lgkmcnt(6)
    v_mfma_f32_16x16x32_bf16 v[224:227], v[112:115], v[80:83], v[224:227]
    v_mfma_f32_16x16x32_bf16 v[228:231], v[112:115], v[84:87], v[228:231]
    s_waitcnt lgkmcnt(4)
    v_mfma_f32_16x16x32_bf16 v[232:235], v[116:119], v[80:83], v[232:235]
    v_mfma_f32_16x16x32_bf16 v[236:239], v[116:119], v[84:87], v[236:239]
    s_waitcnt lgkmcnt(2)
    v_mfma_f32_16x16x32_bf16 v[240:243], v[120:123], v[80:83], v[240:243]
    v_mfma_f32_16x16x32_bf16 v[244:247], v[120:123], v[84:87], v[244:247]
    s_waitcnt lgkmcnt(0)
    v_mfma_f32_16x16x32_bf16 v[248:251], v[124:127], v[80:83], v[248:251]
    v_mfma_f32_16x16x32_bf16 v[252:255], v[124:127], v[84:87], v[252:255]
    s_cmp_lt_u32 s3, 4
    s_cbranch_scc1 L_qb
    s_barrier
L_qb:
    s_mov_b32 s6, 0x3e0293ee
    s_nop 7
    buffer_store_dwordx4 v[160:163], v13, s[8:11], s67 offen sc1
    s_add_u32 s67, s67, 1024
    buffer_store_dwordx4 v[164:167], v13, s[8:11], s67 offen sc1
    s_add_u32 s67, s67, s68
    buffer_store_dwordx4 v[168:171], v13, s[8:11], s67 offen sc1
    s_add_u32 s67, s67, 1024
    buffer_store_dwordx4 v[172:175], v13, s[8:11], s67 offen sc1
    s_add_u32 s67, s67, s69
    v_mul_f32 v192, s6, v192
    v_mul_f32 v193, s6, v193
    v_mul_f32 v194, s6, v194
    v_mul_f32 v195, s6, v195
    v_cvt_pk_bf16_f32 v16, v192, v193
    v_cvt_pk_bf16_f32 v17, v194, v195
    v_mul_f32 v200, s6, v200
    v_mul_f32 v201, s6, v201
    v_mul_f32 v202, s6, v202
    v_mul_f32 v203, s6, v203
    v_cvt_pk_bf16_f32 v18, v200, v201
    v_cvt_pk_bf16_f32 v19, v202, v203
    v_mul_f32 v208, s6, v208
    v_mul_f32 v209, s6, v209
    v_mul_f32 v210, s6, v210
    v_mul_f32 v211, s6, v211
    v_cvt_pk_bf16_f32 v20, v208, v209
    v_cvt_pk_bf16_f32 v21, v210, v211
    v_mul_f32 v216, s6, v216
    v_mul_f32 v217, s6, v217
    v_mul_f32 v218, s6, v218
    v_mul_f32 v219, s6, v219
    v_cvt_pk_bf16_f32 v22, v216, v217
    v_cvt_pk_bf16_f32 v23, v218, v219
    v_mul_f32 v224, s6, v224
    v_mul_f32 v225, s6, v225
    v_mul_f32 v226, s6, v226
    v_mul_f32 v227, s6, v227
    v_cvt_pk_bf16_f32 v24, v224, v225
    v_cvt_pk_bf16_f32 v25, v226, v227
    v_mul_f32 v232, s6, v232
    v_mul_f32 v233, s6, v233
    v_mul_f32 v234, s6, v234
    v_mul_f32 v235, s6, v235
    v_cvt_pk_bf16_f32 v26, v232, v233
    v_cvt_pk_bf16_f32 v27, v234, v235
    v_mul_f32 v240, s6, v240
    v_mul_f32 v241, s6, v241
    v_mul_f32 v242, s6, v242
    v_mul_f32 v243, s6, v243
    v_cvt_pk_bf16_f32 v28, v240, v241
    v_cvt_pk_bf16_f32 v29, v242, v243
    v_mul_f32 v248, s6, v248
    v_mul_f32 v249, s6, v249
    v_mul_f32 v250, s6, v250
    v_mul_f32 v251, s6, v251
    v_cvt_pk_bf16_f32 v30, v248, v249
    v_cvt_pk_bf16_f32 v31, v250, v251
    v_mul_f32 v196, s6, v196
    v_mul_f32 v197, s6, v197
    v_mul_f32 v198, s6, v198
    v_mul_f32 v199, s6, v199
    v_cvt_pk_bf16_f32 v32, v196, v197
    v_cvt_pk_bf16_f32 v33, v198, v199
    v_mul_f32 v204, s6, v204
    v_mul_f32 v205, s6, v205
    v_mul_f32 v206, s6, v206
    v_mul_f32 v207, s6, v207
    v_cvt_pk_bf16_f32 v34, v204, v205
    v_cvt_pk_bf16_f32 v35, v206, v207
    v_mul_f32 v212, s6, v212
    v_mul_f32 v213, s6, v213
    v_mul_f32 v214, s6, v214
    v_mul_f32 v215, s6, v215
    v_cvt_pk_bf16_f32 v36, v212, v213
    v_cvt_pk_bf16_f32 v37, v214, v215
    v_mul_f32 v220, s6, v220
    v_mul_f32 v221, s6, v221
    v_mul_f32 v222, s6, v222
    v_mul_f32 v223, s6, v223
    v_cvt_pk_bf16_f32 v38, v220, v221
    v_cvt_pk_bf16_f32 v39, v222, v223
    v_mul_f32 v228, s6, v228
    v_mul_f32 v229, s6, v229
    v_mul_f32 v230, s6, v230
    v_mul_f32 v231, s6, v231
    v_cvt_pk_bf16_f32 v40, v228, v229
    v_cvt_pk_bf16_f32 v41, v230, v231
    v_mul_f32 v236, s6, v236
    v_mul_f32 v237, s6, v237
    v_mul_f32 v238, s6, v238
    v_mul_f32 v239, s6, v239
    v_cvt_pk_bf16_f32 v42, v236, v237
    v_cvt_pk_bf16_f32 v43, v238, v239
    v_mul_f32 v244, s6, v244
    v_mul_f32 v245, s6, v245
    v_mul_f32 v246, s6, v246
    v_mul_f32 v247, s6, v247
    v_cvt_pk_bf16_f32 v44, v244, v245
    v_cvt_pk_bf16_f32 v45, v246, v247
    v_mul_f32 v252, s6, v252
    v_mul_f32 v253, s6, v253
    v_mul_f32 v254, s6, v254
    v_mul_f32 v255, s6, v255
    v_cvt_pk_bf16_f32 v46, v252, v253
    v_cvt_pk_bf16_f32 v47, v254, v255
    v_mov_b64 v[192:193], 0
    v_mov_b64 v[194:195], 0
    v_mov_b64 v[196:197], 0
    v_mov_b64 v[198:199], 0
    v_mov_b64 v[200:201], 0
    v_mov_b64 v[202:203], 0
    v_mov_b64 v[204:205], 0
    v_mov_b64 v[206:207], 0
    v_mov_b64 v[208:209], 0
    v_mov_b64 v[210:211], 0
    v_mov_b64 v[212:213], 0
    v_mov_b64 v[214:215], 0
    v_mov_b64 v[216:217], 0
    v_mov_b64 v[218:219], 0
    v_mov_b64 v[220:221], 0
    v_mov_b64 v[222:223], 0
    v_mov_b64 v[224:225], 0
    v_mov_b64 v[226:227], 0
    v_mov_b64 v[228:229], 0
    v_mov_b64 v[230:231], 0
    v_mov_b64 v[232:233], 0
    v_mov_b64 v[234:235], 0
    v_mov_b64 v[236:237], 0
    v_mov_b64 v[238:239], 0
    v_mov_b64 v[240:241], 0
    v_mov_b64 v[242:243], 0
    v_mov_b64 v[244:245], 0
    v_mov_b64 v[246:247], 0
    v_mov_b64 v[248:249], 0
    v_mov_b64 v[250:251], 0
    v_mov_b64 v[252:253], 0
    v_mov_b64 v[254:255], 0
    v_mov_b64 v[144:145], 0
    v_mov_b64 v[146:147], 0
    v_mov_b64 v[148:149], 0
    v_mov_b64 v[150:151], 0
    v_mov_b64 v[152:153], 0
    v_mov_b64 v[154:155], 0
    v_mov_b64 v[156:157], 0
    v_mov_b64 v[158:159], 0
    v_mov_b64 v[52:53], 0
    v_mov_b64 v[54:55], 0
    v_mov_b64 v[56:57], 0
    v_mov_b32 v48, v13
    s_waitcnt vmcnt(8)
    s_mov_b32 s72, 0x4b800000
    s_mov_b32 s65, s72
    s_sub_u32 s63, 15, s5
    s_mov_b32 s62, -1
    s_cmp_ge_u32 s3, 4
    s_cbranch_scc1 L_qb2
    s_barrier
L_qb2:
    ds_read_b128 v[96:99], v48 offset:0
    ds_read_b128 v[100:103], v48 offset:1024
    ds_read_b128 v[104:107], v48 offset:2048
    ds_read_b128 v[108:111], v48 offset:3072
    ds_read_b128 v[112:115], v48 offset:4096
    ds_read_b128 v[116:119], v48 offset:5120
    ds_read_b128 v[120:123], v48 offset:6144
    ds_read_b128 v[124:127], v48 offset:7168
    s_cmp_lg_u32 s60, 0
    s_cbranch_scc1 L_nm0
    s_call_b64 s[82:83], L_mask
L_nm0:
    s_waitcnt lgkmcnt(7)
    v_mfma_f32_16x16x32_bf16 v[64:67], v[96:99], v[16:19], v[144:147]
    v_mfma_f32_16x16x32_bf16 v[68:71], v[96:99], v[32:35], v[148:151]
    ds_read_b128 v[96:99], v48 offset:8192
    s_waitcnt lgkmcnt(7)
    v_mfma_f32_16x16x32_bf16 v[64:67], v[100:103], v[20:23], v[64:67]
    v_mfma_f32_16x16x32_bf16 v[68:71], v[100:103], v[36:39], v[68:71]
    ds_read_b128 v[100:103], v48 offset:9216
    s_waitcnt lgkmcnt(7)
    v_mfma_f32_16x16x32_bf16 v[64:67], v[104:107], v[24:27], v[64:67]
    v_mfma_f32_16x16x32_bf16 v[68:71], v[104:107], v[40:43], v[68:71]
    ds_read_b128 v[104:107], v48 offset:10240
    s_waitcnt lgkmcnt(7)
    v_mfma_f32_16x16x32_bf16 v[64:67], v[108:111], v[28:31], v[64:67]
    v_mfma_f32_16x16x32_bf16 v[68:71], v[108:111], v[44:47], v[68:71]
    ds_read_b128 v[108:111], v48 offset:11264
    s_waitcnt lgkmcnt(7)
    v_mfma_f32_16x16x32_bf16 v[72:75], v[112:115], v[16:19], v[152:155]
    v_mfma_f32_16x16x32_bf16 v[76:79], v[112:115], v[32:35], v[156:159]
    ds_read_b128 v[112:115], v48 offset:12288
    s_waitcnt lgkmcnt(7)
    v_mfma_f32_16x16x32_bf16 v[72:75], v[116:119], v[20:23], v[72:75]
    v_mfma_f32_16x16x32_bf16 v[76:79], v[116:119], v[36:39], v[76:79]
    ds_read_b128 v[116:119], v48 offset:13312
    s_waitcnt lgkmcnt(7)
    v_mfma_f32_16x16x32_bf16 v[72:75], v[120:123], v[24:27], v[72:75]
    v_mfma_f32_16x16x32_bf16 v[76:79], v[120:123], v[40:43], v[76:79]
    ds_read_b128 v[120:123], v48 offset:14336
    s_waitcnt lgkmcnt(7)
    v_mfma_f32_16x16x32_bf16 v[72:75], v[124:127], v[28:31], v[72:75]
    v_mfma_f32_16x16x32_bf16 v[76:79], v[124:127], v[44:47], v[76:79]
    ds_read_b128 v[124:127], v48 offset:15360
    s_nop 7
    v_max3_f32 v58, v64, v65, v66
    v_max3_f32 v58, v58, v67, v72
    v_max3_f32 v58, v58, v73, v74
    v_max_f32 v58, v58, v75
    v_mov_b32 v60, v58
    s_nop 1
    v_permlane16_swap_b32 v58, v60
    s_nop 1
    v_max_f32 v58, v58, v60
    v_mov_b32 v60, v58
    s_nop 1
    v_permlane32_swap_b32 v58, v60
    s_nop 1
    v_max_f32 v58, v58, v60
    v_sub_f32 v64, v64, v58
    v_sub_f32 v144, 0, v58
    v_sub_f32 v65, v65, v58
    v_sub_f32 v145, 0, v58
    v_sub_f32 v66, v66, v58
    v_sub_f32 v146, 0, v58
    v_sub_f32 v67, v67, v58
    v_sub_f32 v147, 0, v58
    v_sub_f32 v72, v72, v58
    v_sub_f32 v152, 0, v58
    v_sub_f32 v73, v73, v58
    v_sub_f32 v153, 0, v58
    v_sub_f32 v74, v74, v58
    v_sub_f32 v154, 0, v58
    v_sub_f32 v75, v75, v58
    v_sub_f32 v155, 0, v58
    v_max3_f32 v59, v68, v69, v70
    v_max3_f32 v59, v59, v71, v76
    v_max3_f32 v59, v59, v77, v78
    v_max_f32 v59, v59, v79
    v_mov_b32 v60, v59
    s_nop 1
    v_permlane16_swap_b32 v59, v60
    s_nop 1
    v_max_f32 v59, v59, v60
    v_mov_b32 v60, v59
    s_nop 1
    v_permlane32_swap_b32 v59, v60
    s_nop 1
    v_max_f32 v59, v59, v60
    v_sub_f32 v68, v68, v59
    v_sub_f32 v148, 0, v59
    v_sub_f32 v69, v69, v59
    v_sub_f32 v149, 0, v59
    v_sub_f32 v70, v70, v59
    v_sub_f32 v150, 0, v59
    v_sub_f32 v71, v71, v59
    v_sub_f32 v151, 0, v59
    v_sub_f32 v76, v76, v59
    v_sub_f32 v156, 0, v59
    v_sub_f32 v77, v77, v59
    v_sub_f32 v157, 0, v59
    v_sub_f32 v78, v78, v59
    v_sub_f32 v158, 0, v59
    v_sub_f32 v79, v79, v59
    v_sub_f32 v159, 0, v59
    s_cmp_lg_u32 s60, 1
    s_cbranch_scc1 L_nm1
    s_call_b64 s[82:83], L_mask
L_nm1:
    v_exp_f32 v58, v64
    v_exp_f32 v59, v65
    s_nop 0
    v_add_f32 v52, v58, v59
    v_cvt_pk_bf16_f32 v128, v58, v59
    s_waitcnt lgkmcnt(7)
    v_mfma_f32_16x16x32_bf16 v[80:83], v[96:99], v[16:19], v[144:147]
    s_waitcnt lgkmcnt(6)
    v_exp_f32 v60, v66
    v_exp_f32 v61, v67
    v_mfma_f32_16x16x32_bf16 v[84:87], v[96:99], v[32:35], v[148:151]
    ds_read_b128 v[96:99], v48 offset:49152
    v_add_f32 v52, v60, v52
    v_add_f32 v52, v61, v52
    v_cvt_pk_bf16_f32 v129, v60, v61
    v_add_f32 v56, v54, v56
    v_mfma_f32_16x16x32_bf16 v[80:83], v[100:103], v[20:23], v[80:83]
    s_waitcnt lgkmcnt(6)
    v_exp_f32 v58, v68
    v_exp_f32 v59, v69
    v_mfma_f32_16x16x32_bf16 v[84:87], v[100:103], v[36:39], v[84:87]
    ds_read_b128 v[100:103], v48 offset:50176
    v_add_f32 v53, v58, v59
    v_cvt_pk_bf16_f32 v132, v58, v59
    v_mfma_f32_16x16x32_bf16 v[80:83], v[104:107], v[24:27], v[80:83]
    s_waitcnt lgkmcnt(6)
    v_exp_f32 v60, v70
    v_exp_f32 v61, v71
    v_mfma_f32_16x16x32_bf16 v[84:87], v[104:107], v[40:43], v[84:87]
    ds_read_b128 v[104:107], v48 offset:51200
    v_add_f32 v53, v60, v53
    v_add_f32 v53, v61, v53
    v_cvt_pk_bf16_f32 v133, v60, v61
    v_add_f32 v57, v55, v57
    v_mfma_f32_16x16x32_bf16 v[80:83], v[108:111], v[28:31], v[80:83]
    s_waitcnt lgkmcnt(6)
    v_exp_f32 v58, v72
    v_exp_f32 v59, v73
    v_mfma_f32_16x16x32_bf16 v[84:87], v[108:111], v[44:47], v[84:87]
    ds_read_b128 v[108:111], v48 offset:52224
    v_add_f32 v52, v58, v52
    v_add_f32 v52, v59, v52
    v_cvt_pk_bf16_f32 v130, v58, v59
    v_mfma_f32_16x16x32_bf16 v[88:91], v[112:115], v[16:19], v[152:155]
    s_waitcnt lgkmcnt(6)
    v_exp_f32 v60, v74
    v_exp_f32 v61, v75
    v_mfma_f32_16x16x32_bf16 v[92:95], v[112:115], v[32:35], v[156:159]
    ds_read_b128 v[112:115], v48 offset:53248
    v_add_f32 v52, v60, v52
    v_add_f32 v52, v61, v52
    v_cvt_pk_bf16_f32 v131, v60, v61
    v_mfma_f32_16x16x32_bf16 v[88:91], v[116:119], v[20:23], v[88:91]
    s_waitcnt lgkmcnt(6)
    v_exp_f32 v58, v76
    v_exp_f32 v59, v77
    v_mfma_f32_16x16x32_bf16 v[92:95], v[116:119], v[36:39], v[92:95]
    ds_read_b128 v[116:119], v48 offset:54272
    v_add_f32 v53, v58, v53
    v_add_f32 v53, v59, v53
    v_cvt_pk_bf16_f32 v134, v58, v59
    v_mfma_f32_16x16x32_bf16 v[88:91], v[120:123], v[24:27], v[88:91]
    s_waitcnt lgkmcnt(6)
    v_exp_f32 v60, v78
    v_exp_f32 v61, v79
    v_mfma_f32_16x16x32_bf16 v[92:95], v[120:123], v[40:43], v[92:95]
    ds_read_b128 v[120:123], v48 offset:55296
    v_add_f32 v53, v60, v53
    v_add_f32 v53, v61, v53
    v_cvt_pk_bf16_f32 v135, v60, v61
    v_mfma_f32_16x16x32_bf16 v[88:91], v[124:127], v[28:31], v[88:91]
    v_mfma_f32_16x16x32_bf16 v[92:95], v[124:127], v[44:47], v[92:95]
    ds_read_b128 v[124:127], v48 offset:56320
    v_add_f32 v62, v52, v53
    v_cmp_nge_f32 vcc, s65, v62
    s_cbranch_vccnz L_back_9_h
L_back_9:
    s_nop 7
    v_exp_f32 v58, v80
    v_exp_f32 v59, v81
    s_nop 0
    v_add_f32 v54, v58, v59
    v_cvt_pk_bf16_f32 v136, v58, v59
    s_call_b64 s[82:83], L_load
    s_mov_b32 s62, 0
    buffer_store_dwordx4 v[176:179], v13, s[8:11], s67 offen sc1
    s_add_u32 s67, s67, 1024
    buffer_store_dwordx4 v[180:183], v13, s[8:11], s67 offen sc1
    s_add_u32 s67, s67, s68
    buffer_store_dwordx4 v[184:187], v13, s[8:11], s67 offen sc1
    s_add_u32 s67, s67, 1024
    buffer_store_dwordx4 v[188:191], v13, s[8:11], s67 offen sc1
    s_add_u32 s67, s67, s69
    s_sub_i32 s64, s60, 2
    s_cmp_eq_u32 s60, 0
    s_cbranch_scc1 L_pv2
    s_cmp_eq_u32 s60, 1
    s_cbranch_scc1 L_tail2
    s_cmp_lg_u32 s60, 2
    s_cbranch_scc1 L_st2
    s_call_b64 s[82:83], L_mask
    s_branch L_st2
.p2align 6
L_st0:
    s_waitcnt lgkmcnt(7)
    v_mfma_f32_16x16x32_bf16 v[192:195], v[96:99], v[128:131], v[192:195]
    s_waitcnt lgkmcnt(6)
    v_exp_f32 v60, v82
    v_mfma_f32_16x16x32_bf16 v[196:199], v[96:99], v[132:135], v[196:199]
    ds_read_b128 v[96:99], v48 offset:0
    v_add_f32 v54, v60, v54
    v_add_f32 v56, v52, v56
    v_mfma_f32_16x16x32_bf16 v[200:203], v[100:103], v[128:131], v[200:203]
    s_waitcnt lgkmcnt(6)
    v_exp_f32 v61, v83
    v_mfma_f32_16x16x32_bf16 v[204:207], v[100:103], v[132:135], v[204:207]
    ds_read_b128 v[100:103], v48 offset:1024
    v_add_f32 v54, v61, v54
    v_cvt_pk_bf16_f32 v137, v60, v61
    v_mfma_f32_16x16x32_bf16 v[208:211], v[104:107], v[128:131], v[208:211]
    s_waitcnt lgkmcnt(6)
    v_exp_f32 v58, v84
    v_mfma_f32_16x16x32_bf16 v[212:215], v[104:107], v[132:135], v[212:215]
    ds_read_b128 v[104:107], v48 offset:2048
    v_add_f32 v57, v53, v57
    v_mfma_f32_16x16x32_bf16 v[216:219], v[108:111], v[128:131], v[216:219]
    s_waitcnt lgkmcnt(6)
    v_exp_f32 v59, v85
    v_mfma_f32_16x16x32_bf16 v[220:223], v[108:111], v[132:135], v[220:223]
    s_sub_i32 s64, s64, 1
    ds_read_b128 v[108:111], v48 offset:3072
    v_add_f32 v55, v58, v59
    v_cvt_pk_bf16_f32 v140, v58, v59
    v_mfma_f32_16x16x32_bf16 v[224:227], v[112:115], v[128:131], v[224:227]
    s_waitcnt lgkmcnt(6)
    v_exp_f32 v60, v86
    v_mfma_f32_16x16x32_bf16 v[228:231], v[112:115], v[132:135], v[228:231]
    ds_read_b128 v[112:115], v48 offset:4096
    v_add_f32 v55, v60, v55
    v_mfma_f32_16x16x32_bf16 v[232:235], v[116:119], v[128:131], v[232:235]
    s_waitcnt lgkmcnt(6)
    v_exp_f32 v61, v87
    v_mfma_f32_16x16x32_bf16 v[236:239], v[116:119], v[132:135], v[236:239]
    s_cmp_gt_i32 s64, 0
    ds_read_b128 v[116:119], v48 offset:5120
    v_add_f32 v55, v61, v55
    v_cvt_pk_bf16_f32 v141, v60, v61
    v_mfma_f32_16x16x32_bf16 v[240:243], v[120:123], v[128:131], v[240:243]
    s_waitcnt lgkmcnt(6)
    v_exp_f32 v58, v88
    v_mfma_f32_16x16x32_bf16 v[244:247], v[120:123], v[132:135], v[244:247]
    ds_read_b128 v[120:123], v48 offset:6144
    v_add_f32 v54, v58, v54
    v_mfma_f32_16x16x32_bf16 v[248:251], v[124:127], v[128:131], v[248:251]
    s_waitcnt lgkmcnt(6)
    v_exp_f32 v59, v89
    v_mfma_f32_16x16x32_bf16 v[252:255], v[124:127], v[132:135], v[252:255]
    s_cselect_b32 s65, s72, -1.0
    ds_read_b128 v[124:127], v48 offset:7168
    v_add_f32 v54, v59, v54
    v_cvt_pk_bf16_f32 v138, v58, v59
    v_mfma_f32_16x16x32_bf16 v[64:67], v[96:99], v[16:19], v[144:147]
    s_waitcnt lgkmcnt(6)
    v_exp_f32 v60, v90
    v_mfma_f32_16x16x32_bf16 v[68:71], v[96:99], v[32:35], v[148:151]
    ds_read_b128 v[96:99], v48 offset:40960
    v_add_f32 v54, v60, v54
    v_mfma_f32_16x16x32_bf16 v[64:67], v[100:103], v[20:23], v[64:67]
    s_waitcnt lgkmcnt(6)
    v_exp_f32 v61, v91
    v_mfma_f32_16x16x32_bf16 v[68:71], v[100:103], v[36:39], v[68:71]
    ds_read_b128 v[100:103], v48 offset:41984
    v_add_f32 v54, v61, v54
    v_cvt_pk_bf16_f32 v139, v60, v61
    v_mfma_f32_16x16x32_bf16 v[64:67], v[104:107], v[24:27], v[64:67]
    s_waitcnt lgkmcnt(6)
    v_exp_f32 v58, v92
    v_mfma_f32_16x16x32_bf16 v[68:71], v[104:107], v[40:43], v[68:71]
    ds_read_b128 v[104:107], v48 offset:43008
    v_add_f32 v55, v58, v55
    v_mfma_f32_16x16x32_bf16 v[64:67], v[108:111], v[28:31], v[64:67]
    s_waitcnt lgkmcnt(6)
    v_exp_f32 v59, v93
    v_mfma_f32_16x16x32_bf16 v[68:71], v[108:111], v[44:47], v[68:71]
    ds_read_b128 v[108:111], v48 offset:44032
    v_add_f32 v55, v59, v55
    v_cvt_pk_bf16_f32 v142, v58, v59
    v_mfma_f32_16x16x32_bf16 v[72:75], v[112:115], v[16:19], v[152:155]
    s_waitcnt lgkmcnt(6)
    v_exp_f32 v60, v94
    v_mfma_f32_16x16x32_bf16 v[76:79], v[112:115], v[32:35], v[156:159]
    ds_read_b128 v[112:115], v48 offset:45056
    v_add_f32 v55, v60, v55
    v_mfma_f32_16x16x32_bf16 v[72:75], v[116:119], v[20:23], v[72:75]
    s_waitcnt lgkmcnt(6)
    v_exp_f32 v61, v95
    v_mfma_f32_16x16x32_bf16 v[76:79], v[116:119], v[36:39], v[76:79]
    ds_read_b128 v[116:119], v48 offset:46080
    v_add_f32 v55, v61, v55
    v_cvt_pk_bf16_f32 v143, v60, v61
    v_mfma_f32_16x16x32_bf16 v[72:75], v[120:123], v[24:27], v[72:75]
    s_waitcnt lgkmcnt(6)
    v_exp_f32 v58, v64
    v_mfma_f32_16x16x32_bf16 v[76:79], v[120:123], v[40:43], v[76:79]
    ds_read_b128 v[120:123], v48 offset:47104
    v_add_f32 v62, v54, v55
    v_cmp_nge_f32 vcc, s65, v62
    v_mfma_f32_16x16x32_bf16 v[72:75], v[124:127], v[28:31], v[72:75]
    v_exp_f32 v59, v65
    v_mfma_f32_16x16x32_bf16 v[76:79], v[124:127], v[44:47], v[76:79]
    ds_read_b128 v[124:127], v48 offset:48128
    v_add_f32 v52, v58, v59
    v_cvt_pk_bf16_f32 v128, v58, v59
    s_cbranch_vccnz L_back_10_h
L_back_10:
    s_waitcnt lgkmcnt(7)
    v_mfma_f32_16x16x32_bf16 v[192:195], v[96:99], v[136:139], v[192:195]
    s_waitcnt lgkmcnt(6)
    v_exp_f32 v60, v66
    v_mfma_f32_16x16x32_bf16 v[196:199], v[96:99], v[140:143], v[196:199]
    ds_read_b128 v[96:99], v48 offset:8192
    v_add_f32 v52, v60, v52
    v_add_f32 v56, v54, v56
    v_mfma_f32_16x16x32_bf16 v[200:203], v[100:103], v[136:139], v[200:203]
    s_waitcnt lgkmcnt(6)
    v_exp_f32 v61, v67
    v_mfma_f32_16x16x32_bf16 v[204:207], v[100:103], v[140:143], v[204:207]
    ds_read_b128 v[100:103], v48 offset:9216
    v_add_f32 v52, v61, v52
    v_cvt_pk_bf16_f32 v129, v60, v61
    v_mfma_f32_16x16x32_bf16 v[208:211], v[104:107], v[136:139], v[208:211]
    s_waitcnt lgkmcnt(6)
    v_exp_f32 v58, v68
    v_mfma_f32_16x16x32_bf16 v[212:215], v[104:107], v[140:143], v[212:215]
    ds_read_b128 v[104:107], v48 offset:10240
    v_add_f32 v57, v55, v57
    v_mfma_f32_16x16x32_bf16 v[216:219], v[108:111], v[136:139], v[216:219]
    s_waitcnt lgkmcnt(6)
    v_exp_f32 v59, v69
    v_mfma_f32_16x16x32_bf16 v[220:223], v[108:111], v[140:143], v[220:223]
    s_sub_i32 s64, s64, 1
    ds_read_b128 v[108:111], v48 offset:11264
    v_add_f32 v53, v58, v59
    v_cvt_pk_bf16_f32 v132, v58, v59
    v_mfma_f32_16x16x32_bf16 v[224:227], v[112:115], v[136:139], v[224:227]
    s_waitcnt lgkmcnt(6)
    v_exp_f32 v60, v70
    v_mfma_f32_16x16x32_bf16 v[228:231], v[112:115], v[140:143], v[228:231]
    ds_read_b128 v[112:115], v48 offset:12288
    v_add_f32 v53, v60, v53
    v_mfma_f32_16x16x32_bf16 v[232:235], v[116:119], v[136:139], v[232:235]
    s_waitcnt lgkmcnt(6)
    v_exp_f32 v61, v71
    v_mfma_f32_16x16x32_bf16 v[236:239], v[116:119], v[140:143], v[236:239]
    s_cmp_gt_i32 s64, 0
    ds_read_b128 v[116:119], v48 offset:13312
    v_add_f32 v53, v61, v53
    v_cvt_pk_bf16_f32 v133, v60, v61
    v_mfma_f32_16x16x32_bf16 v[240:243], v[120:123], v[136:139], v[240:243]
    s_waitcnt lgkmcnt(6)
    v_exp_f32 v58, v72
    v_mfma_f32_16x16x32_bf16 v[244:247], v[120:123], v[140:143], v[244:247]
    ds_read_b128 v[120:123], v48 offset:14336
    v_add_f32 v52, v58, v52
    v_mfma_f32_16x16x32_bf16 v[248:251], v[124:127], v[136:139], v[248:251]
    s_waitcnt lgkmcnt(6)
    v_exp_f32 v59, v73
    v_mfma_f32_16x16x32_bf16 v[252:255], v[124:127], v[140:143], v[252:255]
    s_cselect_b32 s65, s72, -1.0
    ds_read_b128 v[124:127], v48 offset:15360
    v_add_f32 v52, v59, v52
    v_cvt_pk_bf16_f32 v130, v58, v59
    v_mfma_f32_16x16x32_bf16 v[80:83], v[96:99], v[16:19], v[144:147]
    s_waitcnt lgkmcnt(6)
    v_exp_f32 v60, v74
    v_mfma_f32_16x16x32_bf16 v[84:87], v[96:99], v[32:35], v[148:151]
    ds_read_b128 v[96:99], v48 offset:49152
    v_add_f32 v52, v60, v52
    v_mfma_f32_16x16x32_bf16 v[80:83], v[100:103], v[20:23], v[80:83]
    s_waitcnt lgkmcnt(6)
    v_exp_f32 v61, v75
    v_mfma_f32_16x16x32_bf16 v[84:87], v[100:103], v[36:39], v[84:87]
    ds_read_b128 v[100:103], v48 offset:50176
    v_add_f32 v52, v61, v52
    v_cvt_pk_bf16_f32 v131, v60, v61
    v_mfma_f32_16x16x32_bf16 v[80:83], v[104:107], v[24:27], v[80:83]
    s_waitcnt lgkmcnt(6)
    v_exp_f32 v58, v76
    v_mfma_f32_16x16x32_bf16 v[84:87], v[104:107], v[40:43], v[84:87]
    ds_read_b128 v[104:107], v48 offset:51200
    v_add_f32 v53, v58, v53
    v_mfma_f32_16x16x32_bf16 v[80:83], v[108:111], v[28:31], v[80:83]
    s_waitcnt lgkmcnt(6)
    v_exp_f32 v59, v77
    v_mfma_f32_16x16x32_bf16 v[84:87], v[108:111], v[44:47], v[84:87]
    ds_read_b128 v[108:111], v48 offset:52224
    v_add_f32 v53, v59, v53
    v_cvt_pk_bf16_f32 v134, v58, v59
    v_mfma_f32_16x16x32_bf16 v[88:91], v[112:115], v[16:19], v[152:155]
    s_waitcnt lgkmcnt(6)
    v_exp_f32 v60, v78
    v_mfma_f32_16x16x32_bf16 v[92:95], v[112:115], v[32:35], v[156:159]
    ds_read_b128 v[112:115], v48 offset:53248
    v_add_f32 v53, v60, v53
    v_mfma_f32_16x16x32_bf16 v[88:91], v[116:119], v[20:23], v[88:91]
    s_waitcnt lgkmcnt(6)
    v_exp_f32 v61, v79
    v_mfma_f32_16x16x32_bf16 v[92:95], v[116:119], v[36:39], v[92:95]
    ds_read_b128 v[116:119], v48 offset:54272
    v_add_f32 v53, v61, v53
    v_cvt_pk_bf16_f32 v135, v60, v61
    v_mfma_f32_16x16x32_bf16 v[88:91], v[120:123], v[24:27], v[88:91]
    s_waitcnt lgkmcnt(6)
    v_exp_f32 v58, v80
    v_mfma_f32_16x16x32_bf16 v[92:95], v[120:123], v[40:43], v[92:95]
    ds_read_b128 v[120:123], v48 offset:55296
    v_add_f32 v62, v52, v53
    v_cmp_nge_f32 vcc, s65, v62
    v_mfma_f32_16x16x32_bf16 v[88:91], v[124:127], v[28:31], v[88:91]
    v_exp_f32 v59, v81
    v_mfma_f32_16x16x32_bf16 v[92:95], v[124:127], v[44:47], v[92:95]
    ds_read_b128 v[124:127], v48 offset:56320
    v_add_f32 v54, v58, v59
    v_cvt_pk_bf16_f32 v136, v58, v59
    s_cbranch_vccnz L_back_11_h
L_back_11:
L_st2:
    s_waitcnt lgkmcnt(7)
    v_mfma_f32_16x16x32_bf16 v[192:195], v[96:99], v[128:131], v[192:195]
    s_waitcnt lgkmcnt(6)
    v_exp_f32 v60, v82
    v_mfma_f32_16x16x32_bf16 v[196:199], v[96:99], v[132:135], v[196:199]
    ds_read_b128 v[96:99], v48 offset:16384
    v_add_f32 v54, v60, v54
    v_add_f32 v56, v52, v56
    v_mfma_f32_16x16x32_bf16 v[200:203], v[100:103], v[128:131], v[200:203]
    s_waitcnt lgkmcnt(6)
    v_exp_f32 v61, v83
    v_mfma_f32_16x16x32_bf16 v[204:207], v[100:103], v[132:135], v[204:207]
    ds_read_b128 v[100:103], v48 offset:17408
    v_add_f32 v54, v61, v54
    v_cvt_pk_bf16_f32 v137, v60, v61
    v_mfma_f32_16x16x32_bf16 v[208:211], v[104:107], v[128:131], v[208:211]
    s_waitcnt lgkmcnt(6)
    v_exp_f32 v58, v84
    v_mfma_f32_16x16x32_bf16 v[212:215], v[104:107], v[132:135], v[212:215]
    ds_read_b128 v[104:107], v48 offset:18432
    v_add_f32 v57, v53, v57
    v_mfma_f32_16x16x32_bf16 v[216:219], v[108:111], v[128:131], v[216:219]
    s_waitcnt lgkmcnt(6)
    v_exp_f32 v59, v85
    v_mfma_f32_16x16x32_bf16 v[220:223], v[108:111], v[132:135], v[220:223]
    s_sub_i32 s64, s64, 1
    ds_read_b128 v[108:111], v48 offset:19456
    v_add_f32 v55, v58, v59
    v_cvt_pk_bf16_f32 v140, v58, v59
    v_mfma_f32_16x16x32_bf16 v[224:227], v[112:115], v[128:131], v[224:227]
    s_waitcnt lgkmcnt(6)
    v_exp_f32 v60, v86
    v_mfma_f32_16x16x32_bf16 v[228:231], v[112:115], v[132:135], v[228:231]
    ds_read_b128 v[112:115], v48 offset:20480
    v_add_f32 v55, v60, v55
    v_mfma_f32_16x16x32_bf16 v[232:235], v[116:119], v[128:131], v[232:235]
    s_waitcnt lgkmcnt(6)
    v_exp_f32 v61, v87
    v_mfma_f32_16x16x32_bf16 v[236:239], v[116:119], v[132:135], v[236:239]
    s_cmp_gt_i32 s64, 0
    ds_read_b128 v[116:119], v48 offset:21504
    v_add_f32 v55, v61, v55
    v_cvt_pk_bf16_f32 v141, v60, v61
    v_mfma_f32_16x16x32_bf16 v[240:243], v[120:123], v[128:131], v[240:243]
    s_waitcnt lgkmcnt(6)
    v_exp_f32 v58, v88
    v_mfma_f32_16x16x32_bf16 v[244:247], v[120:123], v[132:135], v[244:247]
    ds_read_b128 v[120:123], v48 offset:22528
    v_add_f32 v54, v58, v54
    v_mfma_f32_16x16x32_bf16 v[248:251], v[124:127], v[128:131], v[248:251]
    s_waitcnt lgkmcnt(6)
    v_exp_f32 v59, v89
    v_mfma_f32_16x16x32_bf16 v[252:255], v[124:127], v[132:135], v[252:255]
    s_cselect_b32 s65, s72, -1.0
    ds_read_b128 v[124:127], v48 offset:23552
    v_add_f32 v54, v59, v54
    v_cvt_pk_bf16_f32 v138, v58, v59
    v_mfma_f32_16x16x32_bf16 v[64:67], v[96:99], v[16:19], v[144:147]
    s_waitcnt lgkmcnt(6)
    v_exp_f32 v60, v90
    v_mfma_f32_16x16x32_bf16 v[68:71], v[96:99], v[32:35], v[148:151]
    ds_read_b128 v[96:99], v48 offset:57344
    v_add_f32 v54, v60, v54
    v_mfma_f32_16x16x32_bf16 v[64:67], v[100:103], v[20:23], v[64:67]
    s_waitcnt lgkmcnt(6)
    v_exp_f32 v61, v91
    v_mfma_f32_16x16x32_bf16 v[68:71], v[100:103], v[36:39], v[68:71]
    ds_read_b128 v[100:103], v48 offset:58368
    v_add_f32 v54, v61, v54
    v_cvt_pk_bf16_f32 v139, v60, v61
    v_mfma_f32_16x16x32_bf16 v[64:67], v[104:107], v[24:27], v[64:67]
    s_waitcnt lgkmcnt(6)
    v_exp_f32 v58, v92
    v_mfma_f32_16x16x32_bf16 v[68:71], v[104:107], v[40:43], v[68:71]
    ds_read_b128 v[104:107], v48 offset:59392
    v_add_f32 v55, v58, v55
    v_mfma_f32_16x16x32_bf16 v[64:67], v[108:111], v[28:31], v[64:67]
    s_waitcnt lgkmcnt(6)
    v_exp_f32 v59, v93
    v_mfma_f32_16x16x32_bf16 v[68:71], v[108:111], v[44:47], v[68:71]
    ds_read_b128 v[108:111], v48 offset:60416
    v_add_f32 v55, v59, v55
    v_cvt_pk_bf16_f32 v142, v58, v59
    v_mfma_f32_16x16x32_bf16 v[72:75], v[112:115], v[16:19], v[152:155]
    s_waitcnt lgkmcnt(6)
    v_exp_f32 v60, v94
    v_mfma_f32_16x16x32_bf16 v[76:79], v[112:115], v[32:35], v[156:159]
    ds_read_b128 v[112:115], v48 offset:61440
    v_add_f32 v55, v60, v55
    v_mfma_f32_16x16x32_bf16 v[72:75], v[116:119], v[20:23], v[72:75]
    s_waitcnt lgkmcnt(6)
    v_exp_f32 v61, v95
    v_mfma_f32_16x16x32_bf16 v[76:79], v[116:119], v[36:39], v[76:79]
    ds_read_b128 v[116:119], v48 offset:62464
    v_add_f32 v55, v61, v55
    v_cvt_pk_bf16_f32 v143, v60, v61
    v_mfma_f32_16x16x32_bf16 v[72:75], v[120:123], v[24:27], v[72:75]
    s_waitcnt lgkmcnt(6)
    v_exp_f32 v58, v64
    v_mfma_f32_16x16x32_bf16 v[76:79], v[120:123], v[40:43], v[76:79]
    ds_read_b128 v[120:123], v48 offset:63488
    v_add_f32 v62, v54, v55
    v_cmp_nge_f32 vcc, s65, v62
    v_mfma_f32_16x16x32_bf16 v[72:75], v[124:127], v[28:31], v[72:75]
    v_exp_f32 v59, v65
    v_mfma_f32_16x16x32_bf16 v[76:79], v[124:127], v[44:47], v[76:79]
    ds_read_b128 v[124:127], v48 offset:64512
    v_add_f32 v52, v58, v59
    v_cvt_pk_bf16_f32 v128, v58, v59
    s_cbranch_vccnz L_back_12_h
L_back_12:
    s_waitcnt lgkmcnt(7)
    v_mfma_f32_16x16x32_bf16 v[192:195], v[96:99], v[136:139], v[192:195]
    s_waitcnt lgkmcnt(6)
    v_exp_f32 v60, v66
    v_mfma_f32_16x16x32_bf16 v[196:199], v[96:99], v[140:143], v[196:199]
    ds_read_b128 v[96:99], v48 offset:24576
    v_add_f32 v52, v60, v52
    v_add_f32 v56, v54, v56
    v_mfma_f32_16x16x32_bf16 v[200:203], v[100:103], v[136:139], v[200:203]
    s_waitcnt lgkmcnt(6)
    v_exp_f32 v61, v67
    v_mfma_f32_16x16x32_bf16 v[204:207], v[100:103], v[140:143], v[204:207]
    ds_read_b128 v[100:103], v48 offset:25600
    v_add_f32 v52, v61, v52
    v_cvt_pk_bf16_f32 v129, v60, v61
    v_mfma_f32_16x16x32_bf16 v[208:211], v[104:107], v[136:139], v[208:211]
    s_waitcnt lgkmcnt(6)
    v_exp_f32 v58, v68
    v_mfma_f32_16x16x32_bf16 v[212:215], v[104:107], v[140:143], v[212:215]
    ds_read_b128 v[104:107], v48 offset:26624
    v_add_f32 v57, v55, v57
    v_mfma_f32_16x16x32_bf16 v[216:219], v[108:111], v[136:139], v[216:219]
    s_waitcnt lgkmcnt(6)
    v_exp_f32 v59, v69
    v_mfma_f32_16x16x32_bf16 v[220:223], v[108:111], v[140:143], v[220:223]
    s_sub_i32 s64, s64, 1
    ds_read_b128 v[108:111], v48 offset:27648
    v_add_f32 v53, v58, v59
    v_cvt_pk_bf16_f32 v132, v58, v59
    v_mfma_f32_16x16x32_bf16 v[224:227], v[112:115], v[136:139], v[224:227]
    s_waitcnt lgkmcnt(6)
    v_exp_f32 v60, v70
    v_mfma_f32_16x16x32_bf16 v[228:231], v[112:115], v[140:143], v[228:231]
    ds_read_b128 v[112:115], v48 offset:28672
    v_add_f32 v53, v60, v53
    v_mfma_f32_16x16x32_bf16 v[232:235], v[116:119], v[136:139], v[232:235]
    s_waitcnt lgkmcnt(6)
    v_exp_f32 v61, v71
    v_mfma_f32_16x16x32_bf16 v[236:239], v[116:119], v[140:143], v[236:239]
    s_cmp_gt_i32 s64, 0
    ds_read_b128 v[116:119], v48 offset:29696
    v_add_f32 v53, v61, v53
    v_cvt_pk_bf16_f32 v133, v60, v61
    v_mfma_f32_16x16x32_bf16 v[240:243], v[120:123], v[136:139], v[240:243]
    s_waitcnt lgkmcnt(6)
    v_exp_f32 v58, v72
    v_mfma_f32_16x16x32_bf16 v[244:247], v[120:123], v[140:143], v[244:247]
    ds_read_b128 v[120:123], v48 offset:30720
    v_add_f32 v52, v58, v52
    v_mfma_f32_16x16x32_bf16 v[248:251], v[124:127], v[136:139], v[248:251]
    s_waitcnt lgkmcnt(6)
    v_exp_f32 v59, v73
    v_mfma_f32_16x16x32_bf16 v[252:255], v[124:127], v[140:143], v[252:255]
    s_cselect_b32 s65, s72, -1.0
    ds_read_b128 v[124:127], v48 offset:31744
    v_add_f32 v52, v59, v52
    v_cvt_pk_bf16_f32 v130, v58, v59
    v_mfma_f32_16x16x32_bf16 v[80:83], v[96:99], v[16:19], v[144:147]
    s_waitcnt lgkmcnt(6)
    v_exp_f32 v60, v74
    v_mfma_f32_16x16x32_bf16 v[84:87], v[96:99], v[32:35], v[148:151]
    v_add_f32 v52, v60, v52
    v_mfma_f32_16x16x32_bf16 v[80:83], v[100:103], v[20:23], v[80:83]
    s_waitcnt lgkmcnt(5)
    v_exp_f32 v61, v75
    v_xor_b32 v48, 0x10000, v48
    v_mfma_f32_16x16x32_bf16 v[84:87], v[100:103], v[36:39], v[84:87]
    s_cmp_lg_u32 s89, 0
    s_cbranch_scc1 L_ldback_13_c
    s_waitcnt lgkmcnt(0)
    s_barrier
L_ldback_13:
    s_add_i32 s62, s62, 1
    ds_read_b128 v[96:99], v48 offset:32768
    ds_read_b128 v[100:103], v48 offset:33792
    v_add_f32 v52, v61, v52
    v_cvt_pk_bf16_f32 v131, v60, v61
    v_mfma_f32_16x16x32_bf16 v[80:83], v[104:107], v[24:27], v[80:83]
    v_exp_f32 v58, v76
    v_mfma_f32_16x16x32_bf16 v[84:87], v[104:107], v[40:43], v[84:87]
    ds_read_b128 v[104:107], v48 offset:34816
    v_add_f32 v53, v58, v53
    v_mfma_f32_16x16x32_bf16 v[80:83], v[108:111], v[28:31], v[80:83]
    v_exp_f32 v59, v77
    v_mfma_f32_16x16x32_bf16 v[84:87], v[108:111], v[44:47], v[84:87]
    ds_read_b128 v[108:111], v48 offset:35840
    v_add_f32 v53, v59, v53
    v_cvt_pk_bf16_f32 v134, v58, v59
    v_mfma_f32_16x16x32_bf16 v[88:91], v[112:115], v[16:19], v[152:155]
    v_exp_f32 v60, v78
    v_mfma_f32_16x16x32_bf16 v[92:95], v[112:115], v[32:35], v[156:159]
    ds_read_b128 v[112:115], v48 offset:36864
    v_add_f32 v53, v60, v53
    v_mfma_f32_16x16x32_bf16 v[88:91], v[116:119], v[20:23], v[88:91]
    v_exp_f32 v61, v79
    v_mfma_f32_16x16x32_bf16 v[92:95], v[116:119], v[36:39], v[92:95]
    ds_read_b128 v[116:119], v48 offset:37888
    v_add_f32 v53, v61, v53
    v_cvt_pk_bf16_f32 v135, v60, v61
    v_mfma_f32_16x16x32_bf16 v[88:91], v[120:123], v[24:27], v[88:91]
    v_exp_f32 v58, v80
    v_mfma_f32_16x16x32_bf16 v[92:95], v[120:123], v[40:43], v[92:95]
    ds_read_b128 v[120:123], v48 offset:38912
    v_add_f32 v62, v52, v53
    v_cmp_nge_f32 vcc, s65, v62
    v_mfma_f32_16x16x32_bf16 v[88:91], v[124:127], v[28:31], v[88:91]
    v_exp_f32 v59, v81
    v_mfma_f32_16x16x32_bf16 v[92:95], v[124:127], v[44:47], v[92:95]
    ds_read_b128 v[124:127], v48 offset:39936
    v_add_f32 v54, v58, v59
    v_cvt_pk_bf16_f32 v136, v58, v59
    s_cbranch_vccnz L_back_14_h
L_back_14:
    s_branch L_st0
L_tail0:
    s_mov_b32 s65, s72
    s_waitcnt lgkmcnt(7)
    v_mfma_f32_16x16x32_bf16 v[192:195], v[96:99], v[128:131], v[192:195]
    s_waitcnt lgkmcnt(6)
    v_exp_f32 v60, v82
    v_exp_f32 v61, v83
    v_mfma_f32_16x16x32_bf16 v[196:199], v[96:99], v[132:135], v[196:199]
    ds_read_b128 v[96:99], v48 offset:40960
    v_add_f32 v54, v60, v54
    v_add_f32 v54, v61, v54
    v_cvt_pk_bf16_f32 v137, v60, v61
    v_add_f32 v56, v52, v56
    v_mfma_f32_16x16x32_bf16 v[200:203], v[100:103], v[128:131], v[200:203]
    s_waitcnt lgkmcnt(6)
    v_exp_f32 v58, v84
    v_exp_f32 v59, v85
    v_mfma_f32_16x16x32_bf16 v[204:207], v[100:103], v[132:135], v[204:207]
    ds_read_b128 v[100:103], v48 offset:41984
    v_add_f32 v55, v58, v59
    v_cvt_pk_bf16_f32 v140, v58, v59
    v_mfma_f32_16x16x32_bf16 v[208:211], v[104:107], v[128:131], v[208:211]
    s_waitcnt lgkmcnt(6)
    v_exp_f32 v60, v86
    v_exp_f32 v61, v87
    v_mfma_f32_16x16x32_bf16 v[212:215], v[104:107], v[132:135], v[212:215]
    ds_read_b128 v[104:107], v48 offset:43008
    v_add_f32 v55, v60, v55
    v_add_f32 v55, v61, v55
    v_cvt_pk_bf16_f32 v141, v60, v61
    v_add_f32 v57, v53, v57
    v_mfma_f32_16x16x32_bf16 v[216:219], v[108:111], v[128:131], v[216:219]
    s_waitcnt lgkmcnt(6)
    v_exp_f32 v58, v88
    v_exp_f32 v59, v89
    v_mfma_f32_16x16x32_bf16 v[220:223], v[108:111], v[132:135], v[220:223]
    ds_read_b128 v[108:111], v48 offset:44032
    v_add_f32 v54, v58, v54
    v_add_f32 v54, v59, v54
    v_cvt_pk_bf16_f32 v138, v58, v59
    v_mfma_f32_16x16x32_bf16 v[224:227], v[112:115], v[128:131], v[224:227]
    s_waitcnt lgkmcnt(6)
    v_exp_f32 v60, v90
    v_exp_f32 v61, v91
    v_mfma_f32_16x16x32_bf16 v[228:231], v[112:115], v[132:135], v[228:231]
    ds_read_b128 v[112:115], v48 offset:45056
    v_add_f32 v54, v60, v54
    v_add_f32 v54, v61, v54
    v_cvt_pk_bf16_f32 v139, v60, v61
    v_mfma_f32_16x16x32_bf16 v[232:235], v[116:119], v[128:131], v[232:235]
    s_waitcnt lgkmcnt(6)
    v_exp_f32 v58, v92
    v_exp_f32 v59, v93
    v_mfma_f32_16x16x32_bf16 v[236:239], v[116:119], v[132:135], v[236:239]
    ds_read_b128 v[116:119], v48 offset:46080
    v_add_f32 v55, v58, v55
    v_add_f32 v55, v59, v55
    v_cvt_pk_bf16_f32 v142, v58, v59
    v_mfma_f32_16x16x32_bf16 v[240:243], v[120:123], v[128:131], v[240:243]
    s_waitcnt lgkmcnt(6)
    v_exp_f32 v60, v94
    v_exp_f32 v61, v95
    v_mfma_f32_16x16x32_bf16 v[244:247], v[120:123], v[132:135], v[244:247]
    ds_read_b128 v[120:123], v48 offset:47104
    v_add_f32 v55, v60, v55
    v_add_f32 v55, v61, v55
    v_cvt_pk_bf16_f32 v143, v60, v61
    v_mfma_f32_16x16x32_bf16 v[248:251], v[124:127], v[128:131], v[248:251]
    v_mfma_f32_16x16x32_bf16 v[252:255], v[124:127], v[132:135], v[252:255]
    ds_read_b128 v[124:127], v48 offset:48128
    v_add_f32 v62, v54, v55
    v_cmp_nge_f32 vcc, s65, v62
    s_cbranch_vccnz L_back_15_h
L_back_15:
L_pv1:
    s_waitcnt lgkmcnt(7)
    v_mfma_f32_16x16x32_bf16 v[192:195], v[96:99], v[136:139], v[192:195]
    s_waitcnt lgkmcnt(6)
    v_mfma_f32_16x16x32_bf16 v[196:199], v[96:99], v[140:143], v[196:199]
    v_add_f32 v56, v54, v56
    v_mfma_f32_16x16x32_bf16 v[200:203], v[100:103], v[136:139], v[200:203]
    s_waitcnt lgkmcnt(5)
    v_mfma_f32_16x16x32_bf16 v[204:207], v[100:103], v[140:143], v[204:207]
    v_mfma_f32_16x16x32_bf16 v[208:211], v[104:107], v[136:139], v[208:211]
    s_waitcnt lgkmcnt(4)
    v_mfma_f32_16x16x32_bf16 v[212:215], v[104:107], v[140:143], v[212:215]
    v_add_f32 v57, v55, v57
    v_mfma_f32_16x16x32_bf16 v[216:219], v[108:111], v[136:139], v[216:219]
    s_waitcnt lgkmcnt(3)
    v_mfma_f32_16x16x32_bf16 v[220:223], v[108:111], v[140:143], v[220:223]
    v_mfma_f32_16x16x32_bf16 v[224:227], v[112:115], v[136:139], v[224:227]
    s_waitcnt lgkmcnt(2)
    v_mfma_f32_16x16x32_bf16 v[228:231], v[112:115], v[140:143], v[228:231]
    v_mfma_f32_16x16x32_bf16 v[232:235], v[116:119], v[136:139], v[232:235]
    s_waitcnt lgkmcnt(1)
    v_mfma_f32_16x16x32_bf16 v[236:239], v[116:119], v[140:143], v[236:239]
    v_mfma_f32_16x16x32_bf16 v[240:243], v[120:123], v[136:139], v[240:243]
    s_waitcnt lgkmcnt(0)
    v_mfma_f32_16x16x32_bf16 v[244:247], v[120:123], v[140:143], v[244:247]
    v_mfma_f32_16x16x32_bf16 v[248:251], v[124:127], v[136:139], v[248:251]
    v_mfma_f32_16x16x32_bf16 v[252:255], v[124:127], v[140:143], v[252:255]
    s_branch L_fin
L_tail1:
    s_mov_b32 s65, s72
    s_waitcnt lgkmcnt(7)
    v_mfma_f32_16x16x32_bf16 v[192:195], v[96:99], v[136:139], v[192:195]
    s_waitcnt lgkmcnt(6)
    v_exp_f32 v60, v66
    v_exp_f32 v61, v67
    v_mfma_f32_16x16x32_bf16 v[196:199], v[96:99], v[140:143], v[196:199]
    ds_read_b128 v[96:99], v48 offset:49152
    v_add_f32 v52, v60, v52
    v_add_f32 v52, v61, v52
    v_cvt_pk_bf16_f32 v129, v60, v61
    v_add_f32 v56, v54, v56
    v_mfma_f32_16x16x32_bf16 v[200:203], v[100:103], v[136:139], v[200:203]
    s_waitcnt lgkmcnt(6)
    v_exp_f32 v58, v68
    v_exp_f32 v59, v69
    v_mfma_f32_16x16x32_bf16 v[204:207], v[100:103], v[140:143], v[204:207]
    ds_read_b128 v[100:103], v48 offset:50176
    v_add_f32 v53, v58, v59
    v_cvt_pk_bf16_f32 v132, v58, v59
    v_mfma_f32_16x16x32_bf16 v[208:211], v[104:107], v[136:139], v[208:211]
    s_waitcnt lgkmcnt(6)
    v_exp_f32 v60, v70
    v_exp_f32 v61, v71
    v_mfma_f32_16x16x32_bf16 v[212:215], v[104:107], v[140:143], v[212:215]
    ds_read_b128 v[104:107], v48 offset:51200
    v_add_f32 v53, v60, v53
    v_add_f32 v53, v61, v53
    v_cvt_pk_bf16_f32 v133, v60, v61
    v_add_f32 v57, v55, v57
    v_mfma_f32_16x16x32_bf16 v[216:219], v[108:111], v[136:139], v[216:219]
    s_waitcnt lgkmcnt(6)
    v_exp_f32 v58, v72
    v_exp_f32 v59, v73
    v_mfma_f32_16x16x32_bf16 v[220:223], v[108:111], v[140:143], v[220:223]
    ds_read_b128 v[108:111], v48 offset:52224
    v_add_f32 v52, v58, v52
    v_add_f32 v52, v59, v52
    v_cvt_pk_bf16_f32 v130, v58, v59
    v_mfma_f32_16x16x32_bf16 v[224:227], v[112:115], v[136:139], v[224:227]
    s_waitcnt lgkmcnt(6)
    v_exp_f32 v60, v74
    v_exp_f32 v61, v75
    v_mfma_f32_16x16x32_bf16 v[228:231], v[112:115], v[140:143], v[228:231]
    ds_read_b128 v[112:115], v48 offset:53248
    v_add_f32 v52, v60, v52
    v_add_f32 v52, v61, v52
    v_cvt_pk_bf16_f32 v131, v60, v61
    v_mfma_f32_16x16x32_bf16 v[232:235], v[116:119], v[136:139], v[232:235]
    s_waitcnt lgkmcnt(6)
    v_exp_f32 v58, v76
    v_exp_f32 v59, v77
    v_mfma_f32_16x16x32_bf16 v[236:239], v[116:119], v[140:143], v[236:239]
    ds_read_b128 v[116:119], v48 offset:54272
    v_add_f32 v53, v58, v53
    v_add_f32 v53, v59, v53
    v_cvt_pk_bf16_f32 v134, v58, v59
    v_mfma_f32_16x16x32_bf16 v[240:243], v[120:123], v[136:139], v[240:243]
    s_waitcnt lgkmcnt(6)
    v_exp_f32 v60, v78
    v_exp_f32 v61, v79
    v_mfma_f32_16x16x32_bf16 v[244:247], v[120:123], v[140:143], v[244:247]
    ds_read_b128 v[120:123], v48 offset:55296
    v_add_f32 v53, v60, v53
    v_add_f32 v53, v61, v53
    v_cvt_pk_bf16_f32 v135, v60, v61
    v_mfma_f32_16x16x32_bf16 v[248:251], v[124:127], v[136:139], v[248:251]
    v_mfma_f32_16x16x32_bf16 v[252:255], v[124:127], v[140:143], v[252:255]
    ds_read_b128 v[124:127], v48 offset:56320
    v_add_f32 v62, v52, v53
    v_cmp_nge_f32 vcc, s65, v62
    s_cbranch_vccnz L_back_16_h
L_back_16:
L_pv2:
    s_waitcnt lgkmcnt(7)
    v_mfma_f32_16x16x32_bf16 v[192:195], v[96:99], v[128:131], v[192:195]
    s_waitcnt lgkmcnt(6)
    v_mfma_f32_16x16x32_bf16 v[196:199], v[96:99], v[132:135], v[196:199]
    v_add_f32 v56, v52, v56
    v_mfma_f32_16x16x32_bf16 v[200:203], v[100:103], v[128:131], v[200:203]
    s_waitcnt lgkmcnt(5)
    v_mfma_f32_16x16x32_bf16 v[204:207], v[100:103], v[132:135], v[204:207]
    v_mfma_f32_16x16x32_bf16 v[208:211], v[104:107], v[128:131], v[208:211]
    s_waitcnt lgkmcnt(4)
    v_mfma_f32_16x16x32_bf16 v[212:215], v[104:107], v[132:135], v[212:215]
    v_add_f32 v57, v53, v57
    v_mfma_f32_16x16x32_bf16 v[216:219], v[108:111], v[128:131], v[216:219]
    s_waitcnt lgkmcnt(3)
    v_mfma_f32_16x16x32_bf16 v[220:223], v[108:111], v[132:135], v[220:223]
    v_mfma_f32_16x16x32_bf16 v[224:227], v[112:115], v[128:131], v[224:227]
    s_waitcnt lgkmcnt(2)
    v_mfma_f32_16x16x32_bf16 v[228:231], v[112:115], v[132:135], v[228:231]
    v_mfma_f32_16x16x32_bf16 v[232:235], v[116:119], v[128:131], v[232:235]
    s_waitcnt lgkmcnt(1)
    v_mfma_f32_16x16x32_bf16 v[236:239], v[116:119], v[132:135], v[236:239]
    v_mfma_f32_16x16x32_bf16 v[240:243], v[120:123], v[128:131], v[240:243]
    s_waitcnt lgkmcnt(0)
    v_mfma_f32_16x16x32_bf16 v[244:247], v[120:123], v[132:135], v[244:247]
    v_mfma_f32_16x16x32_bf16 v[248:251], v[124:127], v[128:131], v[248:251]
    v_mfma_f32_16x16x32_bf16 v[252:255], v[124:127], v[132:135], v[252:255]
    s_branch L_fin
L_tail2:
    s_mov_b32 s65, s72
    s_waitcnt lgkmcnt(7)
    v_mfma_f32_16x16x32_bf16 v[192:195], v[96:99], v[128:131], v[192:195]
    s_waitcnt lgkmcnt(6)
    v_exp_f32 v60, v82
    v_exp_f32 v61, v83
    v_mfma_f32_16x16x32_bf16 v[196:199], v[96:99], v[132:135], v[196:199]
    ds_read_b128 v[96:99], v48 offset:57344
    v_add_f32 v54, v60, v54
    v_add_f32 v54, v61, v54
    v_cvt_pk_bf16_f32 v137, v60, v61
    v_add_f32 v56, v52, v56
    v_mfma_f32_16x16x32_bf16 v[200:203], v[100:103], v[128:131], v[200:203]
    s_waitcnt lgkmcnt(6)
    v_exp_f32 v58, v84
    v_exp_f32 v59, v85
    v_mfma_f32_16x16x32_bf16 v[204:207], v[100:103], v[132:135], v[204:207]
    ds_read_b128 v[100:103], v48 offset:58368
    v_add_f32 v55, v58, v59
    v_cvt_pk_bf16_f32 v140, v58, v59
    v_mfma_f32_16x16x32_bf16 v[208:211], v[104:107], v[128:131], v[208:211]
    s_waitcnt lgkmcnt(6)
    v_exp_f32 v60, v86
    v_exp_f32 v61, v87
    v_mfma_f32_16x16x32_bf16 v[212:215], v[104:107], v[132:135], v[212:215]
    ds_read_b128 v[104:107], v48 offset:59392
    v_add_f32 v55, v60, v55
    v_add_f32 v55, v61, v55
    v_cvt_pk_bf16_f32 v141, v60, v61
    v_add_f32 v57, v53, v57
    v_mfma_f32_16x16x32_bf16 v[216:219], v[108:111], v[128:131], v[216:219]
    s_waitcnt lgkmcnt(6)
    v_exp_f32 v58, v88
    v_exp_f32 v59, v89
    v_mfma_f32_16x16x32_bf16 v[220:223], v[108:111], v[132:135], v[220:223]
    ds_read_b128 v[108:111], v48 offset:60416
    v_add_f32 v54, v58, v54
    v_add_f32 v54, v59, v54
    v_cvt_pk_bf16_f32 v138, v58, v59
    v_mfma_f32_16x16x32_bf16 v[224:227], v[112:115], v[128:131], v[224:227]
    s_waitcnt lgkmcnt(6)
    v_exp_f32 v60, v90
    v_exp_f32 v61, v91
    v_mfma_f32_16x16x32_bf16 v[228:231], v[112:115], v[132:135], v[228:231]
    ds_read_b128 v[112:115], v48 offset:61440
    v_add_f32 v54, v60, v54
    v_add_f32 v54, v61, v54
    v_cvt_pk_bf16_f32 v139, v60, v61
    v_mfma_f32_16x16x32_bf16 v[232:235], v[116:119], v[128:131], v[232:235]
    s_waitcnt lgkmcnt(6)
    v_exp_f32 v58, v92
    v_exp_f32 v59, v93
    v_mfma_f32_16x16x32_bf16 v[236:239], v[116:119], v[132:135], v[236:239]
    ds_read_b128 v[116:119], v48 offset:62464
    v_add_f32 v55, v58, v55
    v_add_f32 v55, v59, v55
    v_cvt_pk_bf16_f32 v142, v58, v59
    v_mfma_f32_16x16x32_bf16 v[240:243], v[120:123], v[128:131], v[240:243]
    s_waitcnt lgkmcnt(6)
    v_exp_f32 v60, v94
    v_exp_f32 v61, v95
    v_mfma_f32_16x16x32_bf16 v[244:247], v[120:123], v[132:135], v[244:247]
    ds_read_b128 v[120:123], v48 offset:63488
    v_add_f32 v55, v60, v55
    v_add_f32 v55, v61, v55
    v_cvt_pk_bf16_f32 v143, v60, v61
    v_mfma_f32_16x16x32_bf16 v[248:251], v[124:127], v[128:131], v[248:251]
    v_mfma_f32_16x16x32_bf16 v[252:255], v[124:127], v[132:135], v[252:255]
    ds_read_b128 v[124:127], v48 offset:64512
    v_add_f32 v62, v54, v55
    v_cmp_nge_f32 vcc, s65, v62
    s_cbranch_vccnz L_back_17_h
L_back_17:
L_pv3:
    s_waitcnt lgkmcnt(7)
    v_mfma_f32_16x16x32_bf16 v[192:195], v[96:99], v[136:139], v[192:195]
    s_waitcnt lgkmcnt(6)
    v_mfma_f32_16x16x32_bf16 v[196:199], v[96:99], v[140:143], v[196:199]
    v_add_f32 v56, v54, v56
    v_mfma_f32_16x16x32_bf16 v[200:203], v[100:103], v[136:139], v[200:203]
    s_waitcnt lgkmcnt(5)
    v_xor_b32 v48, 0x10000, v48
    v_mfma_f32_16x16x32_bf16 v[204:207], v[100:103], v[140:143], v[204:207]
    s_waitcnt vmcnt(0) lgkmcnt(0)
    s_call_b64 s[82:83], L_pend
    s_barrier
    s_call_b64 s[82:83], L_load
    s_add_i32 s62, s62, 1
    v_mfma_f32_16x16x32_bf16 v[208:211], v[104:107], v[136:139], v[208:211]
    v_mfma_f32_16x16x32_bf16 v[212:215], v[104:107], v[140:143], v[212:215]
    v_add_f32 v57, v55, v57
    v_mfma_f32_16x16x32_bf16 v[216:219], v[108:111], v[136:139], v[216:219]
    v_mfma_f32_16x16x32_bf16 v[220:223], v[108:111], v[140:143], v[220:223]
    v_mfma_f32_16x16x32_bf16 v[224:227], v[112:115], v[136:139], v[224:227]
    v_mfma_f32_16x16x32_bf16 v[228:231], v[112:115], v[140:143], v[228:231]
    v_mfma_f32_16x16x32_bf16 v[232:235], v[116:119], v[136:139], v[232:235]
    v_mfma_f32_16x16x32_bf16 v[236:239], v[116:119], v[140:143], v[236:239]
    v_mfma_f32_16x16x32_bf16 v[240:243], v[120:123], v[136:139], v[240:243]
    v_mfma_f32_16x16x32_bf16 v[244:247], v[120:123], v[140:143], v[244:247]
    v_mfma_f32_16x16x32_bf16 v[248:251], v[124:127], v[136:139], v[248:251]
    v_mfma_f32_16x16x32_bf16 v[252:255], v[124:127], v[140:143], v[252:255]
    s_branch L_fin
L_tail3:
    s_mov_b32 s65, s72
    s_waitcnt lgkmcnt(7)
    v_mfma_f32_16x16x32_bf16 v[192:195], v[96:99], v[136:139], v[192:195]
    s_waitcnt lgkmcnt(6)
    v_exp_f32 v60, v66
    v_exp_f32 v61, v67
    v_mfma_f32_16x16x32_bf16 v[196:199], v[96:99], v[140:143], v[196:199]
    v_add_f32 v52, v60, v52
    v_add_f32 v52, v61, v52
    v_cvt_pk_bf16_f32 v129, v60, v61
    v_add_f32 v56, v54, v56
    v_mfma_f32_16x16x32_bf16 v[200:203], v[100:103], v[136:139], v[200:203]
    s_waitcnt lgkmcnt(5)
    v_exp_f32 v58, v68
    v_exp_f32 v59, v69
    v_xor_b32 v48, 0x10000, v48
    v_mfma_f32_16x16x32_bf16 v[204:207], v[100:103], v[140:143], v[204:207]
    s_waitcnt vmcnt(0) lgkmcnt(0)
    s_call_b64 s[82:83], L_pend
    s_barrier
    s_call_b64 s[82:83], L_load
    s_add_i32 s62, s62, 1
    ds_read_b128 v[96:99], v48 offset:32768
    ds_read_b128 v[100:103], v48 offset:33792
    v_add_f32 v53, v58, v59
    v_cvt_pk_bf16_f32 v132, v58, v59
    v_mfma_f32_16x16x32_bf16 v[208:211], v[104:107], v[136:139], v[208:211]
    v_exp_f32 v60, v70
    v_exp_f32 v61, v71
    v_mfma_f32_16x16x32_bf16 v[212:215], v[104:107], v[140:143], v[212:215]
    ds_read_b128 v[104:107], v48 offset:34816
    v_add_f32 v53, v60, v53
    v_add_f32 v53, v61, v53
    v_cvt_pk_bf16_f32 v133, v60, v61
    v_add_f32 v57, v55, v57
    v_mfma_f32_16x16x32_bf16 v[216:219], v[108:111], v[136:139], v[216:219]
    v_exp_f32 v58, v72
    v_exp_f32 v59, v73
    v_mfma_f32_16x16x32_bf16 v[220:223], v[108:111], v[140:143], v[220:223]
    ds_read_b128 v[108:111], v48 offset:35840
    v_add_f32 v52, v58, v52
    v_add_f32 v52, v59, v52
    v_cvt_pk_bf16_f32 v130, v58, v59
    v_mfma_f32_16x16x32_bf16 v[224:227], v[112:115], v[136:139], v[224:227]
    v_exp_f32 v60, v74
    v_exp_f32 v61, v75
    v_mfma_f32_16x16x32_bf16 v[228:231], v[112:115], v[140:143], v[228:231]
    ds_read_b128 v[112:115], v48 offset:36864
    v_add_f32 v52, v60, v52
    v_add_f32 v52, v61, v52
    v_cvt_pk_bf16_f32 v131, v60, v61
    v_mfma_f32_16x16x32_bf16 v[232:235], v[116:119], v[136:139], v[232:235]
    v_exp_f32 v58, v76
    v_exp_f32 v59, v77
    v_mfma_f32_16x16x32_bf16 v[236:239], v[116:119], v[140:143], v[236:239]
    ds_read_b128 v[116:119], v48 offset:37888
    v_add_f32 v53, v58, v53
    v_add_f32 v53, v59, v53
    v_cvt_pk_bf16_f32 v134, v58, v59
    v_mfma_f32_16x16x32_bf16 v[240:243], v[120:123], v[136:139], v[240:243]
    v_exp_f32 v60, v78
    v_exp_f32 v61, v79
    v_mfma_f32_16x16x32_bf16 v[244:247], v[120:123], v[140:143], v[244:247]
    ds_read_b128 v[120:123], v48 offset:38912
    v_add_f32 v53, v60, v53
    v_add_f32 v53, v61, v53
    v_cvt_pk_bf16_f32 v135, v60, v61
    v_mfma_f32_16x16x32_bf16 v[248:251], v[124:127], v[136:139], v[248:251]
    v_mfma_f32_16x16x32_bf16 v[252:255], v[124:127], v[140:143], v[252:255]
    ds_read_b128 v[124:127], v48 offset:39936
    v_add_f32 v62, v52, v53
    v_cmp_nge_f32 vcc, s65, v62
    s_cbranch_vccnz L_back_20_h
L_back_20:
L_pv0:
    s_waitcnt lgkmcnt(7)
    v_mfma_f32_16x16x32_bf16 v[192:195], v[96:99], v[128:131], v[192:195]
    s_waitcnt lgkmcnt(6)
    v_mfma_f32_16x16x32_bf16 v[196:199], v[96:99], v[132:135], v[196:199]
    v_add_f32 v56, v52, v56
    v_mfma_f32_16x16x32_bf16 v[200:203], v[100:103], v[128:131], v[200:203]
    s_waitcnt lgkmcnt(5)
    v_mfma_f32_16x16x32_bf16 v[204:207], v[100:103], v[132:135], v[204:207]
    v_mfma_f32_16x16x32_bf16 v[208:211], v[104:107], v[128:131], v[208:211]
    s_waitcnt lgkmcnt(4)
    v_mfma_f32_16x16x32_bf16 v[212:215], v[104:107], v[132:135], v[212:215]
    v_add_f32 v57, v53, v57
    v_mfma_f32_16x16x32_bf16 v[216:219], v[108:111], v[128:131], v[216:219]
    s_waitcnt lgkmcnt(3)
    v_mfma_f32_16x16x32_bf16 v[220:223], v[108:111], v[132:135], v[220:223]
    v_mfma_f32_16x16x32_bf16 v[224:227], v[112:115], v[128:131], v[224:227]
    s_waitcnt lgkmcnt(2)
    v_mfma_f32_16x16x32_bf16 v[228:231], v[112:115], v[132:135], v[228:231]
    v_mfma_f32_16x16x32_bf16 v[232:235], v[116:119], v[128:131], v[232:235]
    s_waitcnt lgkmcnt(1)
    v_mfma_f32_16x16x32_bf16 v[236:239], v[116:119], v[132:135], v[236:239]
    v_mfma_f32_16x16x32_bf16 v[240:243], v[120:123], v[128:131], v[240:243]
    s_waitcnt lgkmcnt(0)
    v_mfma_f32_16x16x32_bf16 v[244:247], v[120:123], v[132:135], v[244:247]
    v_mfma_f32_16x16x32_bf16 v[248:251], v[124:127], v[128:131], v[248:251]
    v_mfma_f32_16x16x32_bf16 v[252:255], v[124:127], v[132:135], v[252:255]
L_fin:
    v_and_b32 v3, 7, v1
    v_lshlrev_b32 v3, 2, v3
    s_mov_b32 s72, 0x3a0000
    buffer_load_dword v51, v3, s[8:11], s72 offen sc1
    v_mov_b32 v58, v56
    s_nop 1
    v_permlane16_swap_b32 v56, v58
    s_nop 1
    v_add_f32 v56, v56, v58
    v_mov_b32 v58, v56
    s_nop 1
    v_permlane32_swap_b32 v56, v58
    s_nop 1
    v_add_f32 v56, v56, v58
    v_rcp_f32 v56, v56
    v_mov_b32 v58, v57
    s_nop 1
    v_permlane16_swap_b32 v57, v58
    s_nop 1
    v_add_f32 v57, v57, v58
    v_mov_b32 v58, v57
    s_nop 1
    v_permlane32_swap_b32 v57, v58
    s_nop 1
    v_add_f32 v57, v57, v58
    v_rcp_f32 v57, v57
    s_lshl_b32 s6, s60, 18
    s_lshl_b32 s7, s4, 12
    s_add_u32 s6, s6, s7
    s_add_u32 s6, s6, 50331648
    s_nop 4
    v_mul_f32 v192, v56, v192
    v_mul_f32 v193, v56, v193
    v_mul_f32 v194, v56, v194
    v_mul_f32 v195, v56, v195
    v_cvt_pk_bf16_f32 v16, v192, v193
    v_cvt_pk_bf16_f32 v17, v194, v195
    v_mul_f32 v200, v56, v200
    v_mul_f32 v201, v56, v201
    v_mul_f32 v202, v56, v202
    v_mul_f32 v203, v56, v203
    v_cvt_pk_bf16_f32 v18, v200, v201
    v_cvt_pk_bf16_f32 v19, v202, v203
    buffer_store_dwordx4 v[16:19], v13, s[8:11], s6 offen offset:0 sc1
    v_mul_f32 v208, v56, v208
    v_mul_f32 v209, v56, v209
    v_mul_f32 v210, v56, v210
    v_mul_f32 v211, v56, v211
    v_cvt_pk_bf16_f32 v20, v208, v209
    v_cvt_pk_bf16_f32 v21, v210, v211
    v_mul_f32 v216, v56, v216
    v_mul_f32 v217, v56, v217
    v_mul_f32 v218, v56, v218
    v_mul_f32 v219, v56, v219
    v_cvt_pk_bf16_f32 v22, v216, v217
    v_cvt_pk_bf16_f32 v23, v218, v219
    buffer_store_dwordx4 v[20:23], v13, s[8:11], s6 offen offset:1024 sc1
    v_mul_f32 v224, v56, v224
    v_mul_f32 v225, v56, v225
    v_mul_f32 v226, v56, v226
    v_mul_f32 v227, v56, v227
    v_cvt_pk_bf16_f32 v24, v224, v225
    v_cvt_pk_bf16_f32 v25, v226, v227
    v_mul_f32 v232, v56, v232
    v_mul_f32 v233, v56, v233
    v_mul_f32 v234, v56, v234
    v_mul_f32 v235, v56, v235
    v_cvt_pk_bf16_f32 v26, v232, v233
    v_cvt_pk_bf16_f32 v27, v234, v235
    buffer_store_dwordx4 v[24:27], v13, s[8:11], s6 offen offset:2048 sc1
    v_mul_f32 v240, v56, v240
    v_mul_f32 v241, v56, v241
    v_mul_f32 v242, v56, v242
    v_mul_f32 v243, v56, v243
    v_cvt_pk_bf16_f32 v28, v240, v241
    v_cvt_pk_bf16_f32 v29, v242, v243
    v_mul_f32 v248, v56, v248
    v_mul_f32 v249, v56, v249
    v_mul_f32 v250, v56, v250
    v_mul_f32 v251, v56, v251
    v_cvt_pk_bf16_f32 v30, v248, v249
    v_cvt_pk_bf16_f32 v31, v250, v251
    buffer_store_dwordx4 v[28:31], v13, s[8:11], s6 offen offset:3072 sc1
    s_add_u32 s6, s6, 0x20000
    v_mul_f32 v196, v57, v196
    v_mul_f32 v197, v57, v197
    v_mul_f32 v198, v57, v198
    v_mul_f32 v199, v57, v199
    v_cvt_pk_bf16_f32 v32, v196, v197
    v_cvt_pk_bf16_f32 v33, v198, v199
    v_mul_f32 v204, v57, v204
    v_mul_f32 v205, v57, v205
    v_mul_f32 v206, v57, v206
    v_mul_f32 v207, v57, v207
    v_cvt_pk_bf16_f32 v34, v204, v205
    v_cvt_pk_bf16_f32 v35, v206, v207
    buffer_store_dwordx4 v[32:35], v13, s[8:11], s6 offen offset:0 sc1
    v_mul_f32 v212, v57, v212
    v_mul_f32 v213, v57, v213
    v_mul_f32 v214, v57, v214
    v_mul_f32 v215, v57, v215
    v_cvt_pk_bf16_f32 v36, v212, v213
    v_cvt_pk_bf16_f32 v37, v214, v215
    v_mul_f32 v220, v57, v220
    v_mul_f32 v221, v57, v221
    v_mul_f32 v222, v57, v222
    v_mul_f32 v223, v57, v223
    v_cvt_pk_bf16_f32 v38, v220, v221
    v_cvt_pk_bf16_f32 v39, v222, v223
    buffer_store_dwordx4 v[36:39], v13, s[8:11], s6 offen offset:1024 sc1
    v_mul_f32 v228, v57, v228
    v_mul_f32 v229, v57, v229
    v_mul_f32 v230, v57, v230
    v_mul_f32 v231, v57, v231
    v_cvt_pk_bf16_f32 v40, v228, v229
    v_cvt_pk_bf16_f32 v41, v230, v231
    v_mul_f32 v236, v57, v236
    v_mul_f32 v237, v57, v237
    v_mul_f32 v238, v57, v238
    v_mul_f32 v239, v57, v239
    v_cvt_pk_bf16_f32 v42, v236, v237
    v_cvt_pk_bf16_f32 v43, v238, v239
    buffer_store_dwordx4 v[40:43], v13, s[8:11], s6 offen offset:2048 sc1
    v_mul_f32 v244, v57, v244
    v_mul_f32 v245, v57, v245
    v_mul_f32 v246, v57, v246
    v_mul_f32 v247, v57, v247
    v_cvt_pk_bf16_f32 v44, v244, v245
    v_cvt_pk_bf16_f32 v45, v246, v247
    v_mul_f32 v252, v57, v252
    v_mul_f32 v253, v57, v253
    v_mul_f32 v254, v57, v254
    v_mul_f32 v255, v57, v255
    v_cvt_pk_bf16_f32 v46, v252, v253
    v_cvt_pk_bf16_f32 v47, v254, v255
    buffer_store_dwordx4 v[44:47], v13, s[8:11], s6 offen offset:3072 sc1
    s_cmp_gt_i32 s62, s63
    s_cbranch_scc1 L_pre
    s_waitcnt vmcnt(8)
    s_call_b64 s[82:83], L_pend
    s_barrier
    s_waitcnt vmcnt(0)
    s_lshl_b32 s6, s60, 5
    s_add_u32 s6, s6, s4
    s_lshl_b32 s6, s6, 7
    s_add_u32 s6, s6, 3932160
    v_mov_b32 v2, 1
    v_mov_b32 v3, 0x5000000
    v_writelane_b32 v3, s6, 0
    buffer_store_dword v2, v3, s[8:11], 0 offen sc1
    s_call_b64 s[82:83], L_load
    s_add_i32 s62, s62, 1
    s_lshl_b32 s6, s3, 8
    s_add_u32 s6, s6, s2
    s_cmp_eq_u32 s6, 31
    s_cbranch_scc1 L_top
L_idle:
    s_sub_i32 s6, s63, 5
    s_cmp_gt_i32 s62, s6
    s_cbranch_scc1 L_pre
    s_waitcnt vmcnt(0) lgkmcnt(0)
    s_call_b64 s[82:83], L_pend
    s_barrier
    s_call_b64 s[82:83], L_load
    s_add_i32 s62, s62, 1
    s_cmp_lt_u32 s61, 54
    s_cbranch_scc1 L_moe
    s_branch L_idle
L_pre:
    s_cmp_lt_u32 s3, 4
    s_cbranch_scc1 L_pre1
    s_add_u32 s6, s76, 0
    s_and_b32 s6, s6, 3
    s_lshl_b32 s6, s6, 10
    v_add_u32 v44, s6, v13
    s_add_u32 s6, s76, 1
    s_and_b32 s6, s6, 3
    s_lshl_b32 s6, s6, 10
    v_add_u32 v45, s6, v13
    s_add_u32 s6, s76, 2
    s_and_b32 s6, s6, 3
    s_lshl_b32 s6, s6, 10
    v_add_u32 v46, s6, v13
    s_add_u32 s6, s76, 3
    s_and_b32 s6, s6, 3
    s_lshl_b32 s6, s6, 10
    v_add_u32 v47, s6, v13
    v_add_u32 v52, 4096, v13
    s_lshr_b32 s69, s4, 3
    s_lshl_b32 s69, s69, 2
    s_add_u32 s69, s69, s76
    s_mul_i32 s69, s69, 327680
    s_and_b32 s7, s4, 3
    s_mul_i32 s7, s7, 10240
    s_add_u32 s69, s69, s7
    s_add_u32 s69, s69, 4199424
    s_and_b32 s6, s4, 4
    s_lshr_b32 s7, s4, 3
    s_add_u32 s6, s6, s7
    s_lshl_b32 s7, s5, 3
    s_add_u32 s68, s6, s7
    s_sub_u32 s7, 120, s7
    s_add_u32 s61, s6, s7
    s_and_b32 s6, s63, 1
    s_lshl_b32 s6, s6, 16
    s_xor_b32 s6, s6, 0x10000
    s_lshl_b32 s7, s76, 12
    s_add_u32 s7, s7, s6
    v_add_u32 v5, s7, v13
    s_lshl_b32 s7, s76, 13
    s_add_u32 s6, s6, s7
    v_add_u32 v3, s6, v13
    s_add_u32 s7, s7, 131072
    v_add_u32 v2, s7, v13
    s_barrier
    ds_read_b128 v[96:99], v2 offset:0
    ds_read_b128 v[100:103], v2 offset:1024
    ds_read_b128 v[104:107], v2 offset:2048
    ds_read_b128 v[108:111], v2 offset:3072
    ds_read_b128 v[112:115], v2 offset:4096
    ds_read_b128 v[116:119], v2 offset:5120
    ds_read_b128 v[120:123], v2 offset:6144
    ds_read_b128 v[124:127], v2 offset:7168
    s_waitcnt lgkmcnt(6)
    ds_read_b128 v[128:131], v3 offset:0
    ds_read_b128 v[132:135], v3 offset:1024
    ds_read_b128 v[136:139], v3 offset:2048
    ds_read_b128 v[140:143], v3 offset:3072
    ds_read_b128 v[144:147], v3 offset:4096
    ds_read_b128 v[148:151], v3 offset:5120
    ds_read_b128 v[152:155], v3 offset:6144
    ds_read_b128 v[156:159], v3 offset:7168
    s_waitcnt lgkmcnt(6)
    ds_read_b128 v[160:163], v5 offset:49152
    ds_read_b128 v[164:167], v5 offset:50176
    ds_read_b128 v[168:171], v5 offset:51200
    ds_read_b128 v[172:175], v5 offset:52224
    s_waitcnt lgkmcnt(0)
    s_barrier
    s_add_u32 s75, s69, 163840
    buffer_load_dwordx4 v[176:179], v44, s[8:11], s75 offen sc1
    buffer_load_dwordx4 v[180:183], v45, s[8:11], s75 offen sc1
    buffer_load_dwordx4 v[184:187], v46, s[8:11], s75 offen sc1
    buffer_load_dwordx4 v[188:191], v47, s[8:11], s75 offen sc1
    buffer_load_dwordx4 v[192:195], v52, s[8:11], s75 offen sc1
    s_waitcnt vmcnt(13)
    v_cmp_le_i32 vcc, 0, v51
    s_cbranch_vccz L_idx_okb
    v_and_b32 v3, 7, v1
    v_lshlrev_b32 v3, 2, v3
    s_mov_b32 s72, 0x3a0000
    s_mov_b32 s79, 262144
L_poll_23:
    buffer_load_dword v51, v3, s[8:11], s72 offen sc1
    s_waitcnt vmcnt(0)
    v_cmp_le_i32 vcc, 0, v51
    s_cbranch_vccz L_polldone_24
    s_sleep 2
    s_sub_u32 s79, s79, 1
    s_cmp_lg_u32 s79, 0
    s_cbranch_scc1 L_poll_23
L_polldone_24:
L_idx_okb:
    s_call_b64 s[80:81], L_oprep
    s_waitcnt vmcnt(5)
    s_lshl_b32 s6, s60, 5
    s_add_u32 s6, s6, s4
    s_lshl_b32 s6, s6, 7
    s_add_u32 s6, s6, 3932160
    v_mov_b32 v2, 1
    v_mov_b32 v3, 0x5000000
    v_writelane_b32 v3, s6, 0
    buffer_store_dword v2, v3, s[8:11], 0 offen sc1
    s_branch L_adone
L_oprep:
    s_add_u32 s6, s76, 0
    s_and_b32 s6, s6, 3
    s_lshl_b32 s6, s6, 10
    v_add_u32 v44, s6, v13
    s_add_u32 s6, s76, 1
    s_and_b32 s6, s6, 3
    s_lshl_b32 s6, s6, 10
    v_add_u32 v45, s6, v13
    s_add_u32 s6, s76, 2
    s_and_b32 s6, s6, 3
    s_lshl_b32 s6, s6, 10
    v_add_u32 v46, s6, v13
    s_add_u32 s6, s76, 3
    s_and_b32 s6, s6, 3
    s_lshl_b32 s6, s6, 10
    v_add_u32 v47, s6, v13
    v_add_u32 v52, 4096, v13
    s_lshr_b32 s6, s3, 2
    s_lshl_b32 s6, s6, 1
    s_sub_u32 s71, s76, s6
    s_and_b32 s71, s71, 3
    s_lshr_b32 s6, s4, 3
    s_lshl_b32 s6, s6, 15
    s_lshl_b32 s99, s3, 12
    s_add_u32 s66, s6, s99
    s_add_u32 s66, s66, 50331648
    s_lshl_b32 s6, s76, 13
    v_add_u32 v4, s6, v13
    v_add_u32 v7, 65536, v4
    s_lshr_b32 s6, s3, 2
    s_mul_i32 s67, s6, 15360
    s_add_u32 s67, s67, 98304
    v_add_u32 v6, s67, v44
    s_and_b32 s96, s4, 7
    s_lshl_b32 s7, s5, 3
    s_add_u32 s96, s96, s7
    s_lshr_b32 s7, s4, 3
    s_add_u32 s7, s7, 0
    s_add_u32 s7, s7, 1
    s_and_b32 s7, s7, 3
    s_lshl_b32 s96, s96, 2
    s_add_u32 s96, s96, s7
    s_mul_i32 s96, s96, 3
    s_add_u32 s96, s96, 0
    s_mul_i32 s96, s96, 20480
    s_lshr_b32 s6, s3, 2
    s_mul_i32 s6, s6, 5120
    s_add_u32 s96, s96, s6
    s_add_u32 s96, s96, 67108864
    s_and_b32 s97, s4, 7
    s_lshl_b32 s7, s5, 3
    s_add_u32 s97, s97, s7
    s_lshr_b32 s7, s4, 3
    s_add_u32 s7, s7, 1
    s_add_u32 s7, s7, 1
    s_and_b32 s7, s7, 3
    s_lshl_b32 s97, s97, 2
    s_add_u32 s97, s97, s7
    s_mul_i32 s97, s97, 3
    s_add_u32 s97, s97, 1
    s_mul_i32 s97, s97, 20480
    s_lshr_b32 s6, s3, 2
    s_mul_i32 s6, s6, 5120
    s_add_u32 s97, s97, s6
    s_add_u32 s97, s97, 67108864
    s_and_b32 s98, s4, 7
    s_lshl_b32 s7, s5, 3
    s_add_u32 s98, s98, s7
    s_lshr_b32 s7, s4, 3
    s_add_u32 s7, s7, 2
    s_add_u32 s7, s7, 1
    s_and_b32 s7, s7, 3
    s_lshl_b32 s98, s98, 2
    s_add_u32 s98, s98, s7
    s_mul_i32 s98, s98, 3
    s_add_u32 s98, s98, 2
    s_mul_i32 s98, s98, 20480
    s_lshr_b32 s6, s3, 2
    s_mul_i32 s6, s6, 5120
    s_add_u32 s98, s98, s6
    s_add_u32 s98, s98, 67108864
    s_mov_b32 s12, s32
    s_mov_b32 s13, s33
    s_mov_b32 s14, 0x280000
    s_mov_b32 s15, 0x20000
    s_and_b32 s75, s4, 3
    s_mul_i32 s70, s75, 320
    s_add_u32 s73, s70, 3837952
    s_mul_i32 s72, s75, 5120
    v_lshrrev_b32 v2, 4, v1
    v_and_b32 v3, 15, v1
    v_mul_u32_u24 v54, 1280, v3
    v_lshl_add_u32 v54, v2, 4, v54
    v_lshlrev_b32 v3, 4, v3
    v_lshl_add_u32 v9, v2, 9, v3
    s_lshr_b32 s100, s3, 2
    s_cselect_b32 s6, s61, s68
    s_mul_i32 s6, s6, 20480
    s_lshl_b32 s7, s76, 6
    s_add_u32 s7, s7, s6
    v_add_u32 v53, s7, v54
    s_lshl_b32 s7, s76, 10
    s_add_u32 s7, s7, s6
    s_add_u32 s7, s7, s72
    v_add_u32 v48, s7, v13
    s_mul_i32 s6, s100, 10240
    s_lshl_b32 s7, s76, 11
    s_add_u32 s6, s6, s7
    v_add_u32 v8, s6, v9
    s_mul_i32 s6, s100, 30720
    s_add_u32 s6, s6, 65536
    v_add_u32 v10, s6, v8
    s_lshl_b32 s7, s76, 2
    v_add_u32 v2, s7, v2
    v_cmp_lt_u32 vcc, 9, v2
    v_add_u32 v3, 15360, v10
    s_nop 0
    v_cndmask_b32 v10, v10, v3, vcc
    s_and_b32 s100, s3, 1
    s_cselect_b32 s6, s61, s68
    s_mul_i32 s6, s6, 20480
    s_add_u32 s7, s6, 256
    v_add_u32 v54, s7, v54
    s_add_u32 s7, s6, s72
    s_add_u32 s7, s7, 4096
    v_add_u32 v49, s7, v13
    s_mul_i32 s6, s100, 10240
    s_add_u32 s6, s6, 8192
    v_add_u32 v9, s6, v9
    s_mul_i32 s6, s100, 30720
    s_add_u32 s6, s6, 80896
    v_add_u32 v55, s6, v9
    s_mov_b32 s64, 0
    v_and_b32 v2, 0x7ff, v51
    v_sub_u32 v2, 0x7ff, v2
    v_lshrrev_b32 v3, 4, v2
    v_cmp_eq_u32 vcc, s68, v3
    v_cmp_eq_u32 s[74:75], s61, v3
    s_nop 3
    s_or_b64 vcc, vcc, s[74:75]
    s_cbranch_scc0 L_notok_25
    v_readlane_b32 s84, v2, 0
    v_readlane_b32 s85, v2, 1
    v_readlane_b32 s86, v2, 2
    v_readlane_b32 s87, v2, 3
    v_readlane_b32 s88, v2, 4
    v_readlane_b32 s90, v2, 5
    v_readlane_b32 s91, v2, 6
    v_readlane_b32 s101, v2, 7
    s_lshl_b32 s7, s76, 6
    s_lshr_b32 s100, s3, 2
    s_cselect_b32 s6, s61, s68
    s_lshl_b32 s6, s6, 4
    v_and_b32 v2, 15, v1
    v_add_u32 v2, s6, v2
    s_add_u32 s7, s7, s73
    v_and_b32 v3, 48, v1
    v_add_u32 v3, s7, v3
    v_cmp_eq_u32 vcc, s84, v2
    s_nop 1
    v_cndmask_b32 v48, v48, v3, vcc
    v_add_u32 v3, 1280, v3
    v_cmp_eq_u32 vcc, s85, v2
    s_nop 1
    v_cndmask_b32 v48, v48, v3, vcc
    v_add_u32 v3, 1280, v3
    v_cmp_eq_u32 vcc, s86, v2
    s_nop 1
    v_cndmask_b32 v48, v48, v3, vcc
    v_add_u32 v3, 1280, v3
    v_cmp_eq_u32 vcc, s87, v2
    s_nop 1
    v_cndmask_b32 v48, v48, v3, vcc
    v_add_u32 v3, 1280, v3
    v_cmp_eq_u32 vcc, s88, v2
    s_nop 1
    v_cndmask_b32 v48, v48, v3, vcc
    v_add_u32 v3, 1280, v3
    v_cmp_eq_u32 vcc, s90, v2
    s_nop 1
    v_cndmask_b32 v48, v48, v3, vcc
    v_add_u32 v3, 1280, v3
    v_cmp_eq_u32 vcc, s91, v2
    s_nop 1
    v_cndmask_b32 v48, v48, v3, vcc
    v_add_u32 v3, 1280, v3
    v_cmp_eq_u32 vcc, s101, v2
    s_nop 1
    v_cndmask_b32 v48, v48, v3, vcc
    s_movk_i32 s7, 256
    s_and_b32 s100, s3, 1
    s_cselect_b32 s6, s61, s68
    s_lshl_b32 s6, s6, 4
    v_and_b32 v2, 15, v1
    v_add_u32 v2, s6, v2
    s_add_u32 s7, s7, s73
    v_and_b32 v3, 48, v1
    v_add_u32 v3, s7, v3
    v_cmp_eq_u32 vcc, s84, v2
    s_nop 1
    v_cndmask_b32 v49, v49, v3, vcc
    v_add_u32 v3, 1280, v3
    v_cmp_eq_u32 vcc, s85, v2
    s_nop 1
    v_cndmask_b32 v49, v49, v3, vcc
    v_add_u32 v3, 1280, v3
    v_cmp_eq_u32 vcc, s86, v2
    s_nop 1
    v_cndmask_b32 v49, v49, v3, vcc
    v_add_u32 v3, 1280, v3
    v_cmp_eq_u32 vcc, s87, v2
    s_nop 1
    v_cndmask_b32 v49, v49, v3, vcc
    v_add_u32 v3, 1280, v3
    v_cmp_eq_u32 vcc, s88, v2
    s_nop 1
    v_cndmask_b32 v49, v49, v3, vcc
    v_add_u32 v3, 1280, v3
    v_cmp_eq_u32 vcc, s90, v2
    s_nop 1
    v_cndmask_b32 v49, v49, v3, vcc
    v_add_u32 v3, 1280, v3
    v_cmp_eq_u32 vcc, s91, v2
    s_nop 1
    v_cndmask_b32 v49, v49, v3, vcc
    v_add_u32 v3, 1280, v3
    v_cmp_eq_u32 vcc, s101, v2
    s_nop 1
    v_cndmask_b32 v49, v49, v3, vcc
    s_mov_b32 s64, 1
L_notok_25:
    s_setpc_b64 s[80:81]
L_pre1:
    s_mov_b32 s28, s56
    s_mov_b32 s29, s57
    s_mov_b32 s30, 0x100
    s_mov_b32 s31, 0x20000
    v_and_b32 v3, 31, v1
    v_lshlrev_b32 v3, 2, v3
    s_mov_b32 s79, 262144
L_poll_26:
    buffer_load_dword v2, v3, s[28:31], 0 offen offset:128 sc1
    s_waitcnt vmcnt(0)
    v_cmp_gt_u32 vcc, 4, v2
    s_cbranch_vccz L_polldone_27
    s_sleep 8
    s_sub_u32 s79, s79, 1
    s_cmp_lg_u32 s79, 0
    s_cbranch_scc1 L_poll_26
L_polldone_27:
    s_mov_b32 s90, 1
    v_and_b32 v3, 7, v1
    v_lshlrev_b32 v3, 2, v3
    s_mov_b32 s72, 0x3a0000
    buffer_load_dword v51, v3, s[8:11], s72 offen sc1
    s_add_u32 s6, s76, 0
    s_and_b32 s6, s6, 3
    s_lshl_b32 s6, s6, 10
    v_add_u32 v44, s6, v13
    s_add_u32 s6, s76, 1
    s_and_b32 s6, s6, 3
    s_lshl_b32 s6, s6, 10
    v_add_u32 v45, s6, v13
    s_add_u32 s6, s76, 2
    s_and_b32 s6, s6, 3
    s_lshl_b32 s6, s6, 10
    v_add_u32 v46, s6, v13
    s_add_u32 s6, s76, 3
    s_and_b32 s6, s6, 3
    s_lshl_b32 s6, s6, 10
    v_add_u32 v47, s6, v13
    v_add_u32 v52, 4096, v13
    s_lshr_b32 s69, s4, 3
    s_lshl_b32 s69, s69, 2
    s_add_u32 s69, s69, s76
    s_mul_i32 s69, s69, 327680
    s_and_b32 s7, s4, 3
    s_mul_i32 s7, s7, 10240
    s_add_u32 s69, s69, s7
    s_add_u32 s69, s69, 4194304
    s_and_b32 s6, s4, 4
    s_lshr_b32 s7, s4, 3
    s_add_u32 s6, s6, s7
    s_lshl_b32 s7, s5, 3
    s_add_u32 s68, s6, s7
    s_sub_u32 s7, 120, s7
    s_add_u32 s61, s6, s7
    s_add_u32 s75, s69, 0
    buffer_load_dwordx4 v[96:99], v44, s[8:11], s75 offen sc1
    buffer_load_dwordx4 v[100:103], v45, s[8:11], s75 offen sc1
    buffer_load_dwordx4 v[104:107], v46, s[8:11], s75 offen sc1
    buffer_load_dwordx4 v[108:111], v47, s[8:11], s75 offen sc1
    buffer_load_dwordx4 v[112:115], v52, s[8:11], s75 offen sc1
    s_add_u32 s75, s69, 40960
    buffer_load_dwordx4 v[116:119], v44, s[8:11], s75 offen sc1
    buffer_load_dwordx4 v[120:123], v45, s[8:11], s75 offen sc1
    buffer_load_dwordx4 v[124:127], v46, s[8:11], s75 offen sc1
    buffer_load_dwordx4 v[128:131], v47, s[8:11], s75 offen sc1
    buffer_load_dwordx4 v[132:135], v52, s[8:11], s75 offen sc1
    s_cmp_gt_i32 s62, s63
    s_cbranch_scc1 L_e2
    s_cmp_eq_i32 s62, s63
    s_cbranch_scc1 L_lw0
    s_waitcnt vmcnt(11)
L_lw0:
    s_waitcnt vmcnt(21)
    s_call_b64 s[82:83], L_pend
    s_barrier
    s_call_b64 s[82:83], L_load
    s_add_i32 s62, s62, 1
L_e2:
    s_add_u32 s75, s69, 81920
    buffer_load_dwordx4 v[136:139], v44, s[8:11], s75 offen sc1
    buffer_load_dwordx4 v[140:143], v45, s[8:11], s75 offen sc1
    buffer_load_dwordx4 v[144:147], v46, s[8:11], s75 offen sc1
    buffer_load_dwordx4 v[148:151], v47, s[8:11], s75 offen sc1
    buffer_load_dwordx4 v[152:155], v52, s[8:11], s75 offen sc1
    s_add_u32 s75, s69, 122880
    buffer_load_dwordx4 v[156:159], v44, s[8:11], s75 offen sc1
    buffer_load_dwordx4 v[160:163], v45, s[8:11], s75 offen sc1
    buffer_load_dwordx4 v[164:167], v46, s[8:11], s75 offen sc1
    buffer_load_dwordx4 v[168:171], v47, s[8:11], s75 offen sc1
    buffer_load_dwordx4 v[172:175], v52, s[8:11], s75 offen sc1
    s_cmp_gt_i32 s62, s63
    s_cbranch_scc1 L_e3
    s_cmp_eq_i32 s62, s63
    s_cbranch_scc1 L_lw1
    s_waitcnt vmcnt(10)
L_lw1:
    s_waitcnt vmcnt(21)
    s_call_b64 s[82:83], L_pend
    s_barrier
    s_call_b64 s[82:83], L_load
    s_add_i32 s62, s62, 1
L_e3:
    s_add_u32 s75, s69, 163840
    buffer_load_dwordx4 v[176:179], v44, s[8:11], s75 offen sc1
    buffer_load_dwordx4 v[180:183], v45, s[8:11], s75 offen sc1
    buffer_load_dwordx4 v[184:187], v46, s[8:11], s75 offen sc1
    buffer_load_dwordx4 v[188:191], v47, s[8:11], s75 offen sc1
    buffer_load_dwordx4 v[192:195], v52, s[8:11], s75 offen sc1
    s_add_u32 s75, s69, 204800
    buffer_load_dwordx4 v[196:199], v44, s[8:11], s75 offen sc1
    buffer_load_dwordx4 v[200:203], v45, s[8:11], s75 offen sc1
    buffer_load_dwordx4 v[204:207], v46, s[8:11], s75 offen sc1
    buffer_load_dwordx4 v[208:211], v47, s[8:11], s75 offen sc1
    buffer_load_dwordx4 v[212:215], v52, s[8:11], s75 offen sc1
    s_cmp_gt_i32 s62, s63
    s_cbranch_scc1 L_e4
    s_cmp_eq_i32 s62, s63
    s_cbranch_scc1 L_lw2
    s_waitcnt vmcnt(10)
L_lw2:
    s_waitcnt vmcnt(21)
    s_call_b64 s[82:83], L_pend
    s_barrier
    s_call_b64 s[82:83], L_load
    s_add_i32 s62, s62, 1
L_e4:
    s_add_u32 s75, s69, 245760
    buffer_load_dwordx4 v[216:219], v44, s[8:11], s75 offen sc1
    buffer_load_dwordx4 v[220:223], v45, s[8:11], s75 offen sc1
    buffer_load_dwordx4 v[224:227], v46, s[8:11], s75 offen sc1
    buffer_load_dwordx4 v[228:231], v47, s[8:11], s75 offen sc1
    buffer_load_dwordx4 v[232:235], v52, s[8:11], s75 offen sc1
    s_add_u32 s75, s69, 286720
    buffer_load_dwordx4 v[236:239], v44, s[8:11], s75 offen sc1
    buffer_load_dwordx4 v[240:243], v45, s[8:11], s75 offen sc1
    buffer_load_dwordx4 v[244:247], v46, s[8:11], s75 offen sc1
    buffer_load_dwordx4 v[248:251], v47, s[8:11], s75 offen sc1
    buffer_load_dwordx4 v[252:255], v52, s[8:11], s75 offen sc1
    s_cmp_gt_i32 s62, s63
    s_cbranch_scc1 L_e5
    s_cmp_eq_i32 s62, s63
    s_cbranch_scc1 L_lw3
    s_waitcnt vmcnt(10)
L_lw3:
    s_waitcnt vmcnt(21)
    s_call_b64 s[82:83], L_pend
    s_barrier
    s_call_b64 s[82:83], L_load
    s_add_i32 s62, s62, 1
L_e5:
    s_waitcnt vmcnt(40)
    v_cmp_le_i32 vcc, 0, v51
    s_cbranch_vccz L_idx_oka
    v_and_b32 v3, 7, v1
    v_lshlrev_b32 v3, 2, v3
    s_mov_b32 s72, 0x3a0000
    s_mov_b32 s79, 262144
L_poll_32:
    buffer_load_dword v51, v3, s[8:11], s72 offen sc1
    s_waitcnt vmcnt(0)
    v_cmp_le_i32 vcc, 0, v51
    s_cbranch_vccz L_polldone_33
    s_sleep 2
    s_sub_u32 s79, s79, 1
    s_cmp_lg_u32 s79, 0
    s_cbranch_scc1 L_poll_32
L_polldone_33:
L_idx_oka:
    v_and_b32 v3, 1, v1
    v_lshlrev_b32 v3, 12, v3
    v_and_b32 v2, 2, v1
    v_lshl_add_u32 v3, v2, 8, v3
    s_lshr_b32 s72, s68, 2
    s_lshl_b32 s72, s72, 6
    s_andn2_b32 s6, s4, 7
    s_add_u32 s72, s72, s6
    s_add_u32 s72, s72, s76
    s_lshl_b32 s72, s72, 7
    s_add_u32 s72, s72, 3932160
    buffer_load_dword v50, v3, s[8:11], s72 offen sc1
    s_call_b64 s[80:81], L_oprep
    s_cmp_gt_i32 s62, s63
    s_cbranch_scc1 L_e6
    s_waitcnt vmcnt(21)
    s_call_b64 s[82:83], L_pend
    s_barrier
    s_call_b64 s[82:83], L_load
    s_add_i32 s62, s62, 1
L_e6:
    s_waitcnt vmcnt(0)
    s_lshr_b32 s6, s5, 1
    s_lshl_b32 s7, s3, 4
    s_add_u32 s6, s6, s7
    s_cmp_lg_u32 s6, 2
    s_cbranch_scc1 L_yd
    s_and_b32 s6, s5, 1
    s_xor_b32 s6, s6, 1
    s_lshl_b32 s6, s6, 2
    s_lshr_b32 s87, s4, 3
    s_add_u32 s87, s87, s6
    s_and_b32 s88, s4, 7
    s_mov_b32 m0, s87
    s_nop 3
    v_readlane_b32 s85, v51, m0
    s_nop 3
    s_and_b32 s86, s85, 0x7ff
    s_sub_u32 s86, 0x7ff, s86
    v_min_u32 v3, 53, v1
    v_lshlrev_b32 v3, 7, v3
    s_mov_b32 s72, 0xf20000
    s_mov_b32 s79, 262144
L_poll_35:
    buffer_load_dwordx4 v[16:19], v3, s[8:11], s72 offen sc1
    s_waitcnt vmcnt(0)
    v_and_b32 v16, v16, v17
    v_and_b32 v16, v16, v18
    v_and_b32 v16, v16, v19
    v_cmp_ne_u32 vcc, 1, v16
    s_cbranch_vccz L_polldone_36
    s_sleep 16
    s_sub_u32 s79, s79, 1
    s_cmp_lg_u32 s79, 0
    s_cbranch_scc1 L_poll_35
L_polldone_36:
    v_mul_u32_u24 v2, 13, v1
    v_lshrrev_b32 v2, 8, v2
    v_mul_u32_u24 v3, 20, v2
    v_sub_u32 v4, v1, v3
    s_mov_b32 s6, 368640
    v_mul_lo_u32 v2, v2, s6
    v_lshl_add_u32 v2, v4, 4, v2
    v_cmp_lt_u32 vcc, 59, v1
    v_mov_b32 v3, 0x5000000
    s_nop 0
    v_cndmask_b32 v2, v2, v3, vcc
    s_mul_i32 s6, s87, 2560
    s_mul_i32 s7, s88, 320
    s_add_u32 s6, s6, s7
    s_add_u32 s6, s6, 2686976
    buffer_load_dwordx4 v[16:19], v2, s[8:11], s6 offen sc1
    s_add_u32 s6, s6, 20480
    buffer_load_dwordx4 v[20:23], v2, s[8:11], s6 offen sc1
    s_add_u32 s6, s6, 20480
    buffer_load_dwordx4 v[24:27], v2, s[8:11], s6 offen sc1
    s_add_u32 s6, s6, 20480
    buffer_load_dwordx4 v[28:31], v2, s[8:11], s6 offen sc1
    s_add_u32 s6, s6, 20480
    buffer_load_dwordx4 v[32:35], v2, s[8:11], s6 offen sc1
    s_add_u32 s6, s6, 20480
    buffer_load_dwordx4 v[36:39], v2, s[8:11], s6 offen sc1
    s_add_u32 s6, s6, 20480
    buffer_load_dwordx4 v[40:43], v2, s[8:11], s6 offen sc1
    s_add_u32 s6, s6, 20480
    buffer_load_dwordx4 v[44:47], v2, s[8:11], s6 offen sc1
    s_add_u32 s6, s6, 20480
    buffer_load_dwordx4 v[56:59], v2, s[8:11], s6 offen sc1
    s_add_u32 s6, s6, 20480
    buffer_load_dwordx4 v[60:63], v2, s[8:11], s6 offen sc1
    s_add_u32 s6, s6, 20480
    buffer_load_dwordx4 v[64:67], v2, s[8:11], s6 offen sc1
    s_add_u32 s6, s6, 20480
    buffer_load_dwordx4 v[68:71], v2, s[8:11], s6 offen sc1
    s_add_u32 s6, s6, 20480
    buffer_load_dwordx4 v[72:75], v2, s[8:11], s6 offen sc1
    s_add_u32 s6, s6, 20480
    buffer_load_dwordx4 v[76:79], v2, s[8:11], s6 offen sc1
    s_add_u32 s6, s6, 20480
    buffer_load_dwordx4 v[80:83], v2, s[8:11], s6 offen sc1
    s_add_u32 s6, s6, 20480
    buffer_load_dwordx4 v[84:87], v2, s[8:11], s6 offen sc1
    s_add_u32 s6, s6, 20480
    buffer_load_dwordx4 v[88:91], v2, s[8:11], s6 offen sc1
    s_add_u32 s6, s6, 20480
    buffer_load_dwordx4 v[92:95], v2, s[8:11], s6 offen sc1
    s_add_u32 s6, s6, 20480
    s_lshr_b32 s6, s86, 4
    s_mul_i32 s6, s6, 20480
    s_and_b32 s7, s86, 15
    s_lshl_b32 s7, s7, 4
    s_add_u32 s6, s6, s7
    s_mul_i32 s7, s88, 2560
    s_add_u32 s6, s6, s7
    v_lshrrev_b32 v5, 1, v4
    v_lshlrev_b32 v5, 8, v5
    v_and_b32 v6, 1, v4
    v_lshl_add_u32 v5, v6, 3, v5
    buffer_load_dwordx2 v[54:55], v5, s[8:11], s6 offen sc1
    s_bfe_u32 s6, s85, 0x10000b
    s_xor_b32 s7, s6, 0xffff
    s_bitcmp1_b32 s6, 15
    s_bitset0_b32 s6, 15
    s_cselect_b32 s6, s6, s7
    s_lshl_b32 s6, s6, 16
    v_mov_b32 v5, s6
    v_mul_f32 v5, 0xbfb8aa3b, v5
    v_exp_f32 v5, v5
    s_nop 0
    v_add_f32 v5, 1.0, v5
    v_rcp_f32 v5, v5
    s_nop 0
    v_cvt_pk_bf16_f32 v5, v5, v5
    v_lshlrev_b32 v5, 16, v5
    v_lshlrev_b32 v6, 2, v1
    s_waitcnt vmcnt(0)
    v_pk_add_f32 v[16:17], v[16:17], v[20:21]
    v_pk_add_f32 v[18:19], v[18:19], v[22:23]
    v_pk_add_f32 v[16:17], v[16:17], v[24:25]
    v_pk_add_f32 v[18:19], v[18:19], v[26:27]
    v_pk_add_f32 v[16:17], v[16:17], v[28:29]
    v_pk_add_f32 v[18:19], v[18:19], v[30:31]
    v_pk_add_f32 v[16:17], v[16:17], v[32:33]
    v_pk_add_f32 v[18:19], v[18:19], v[34:35]
    v_pk_add_f32 v[16:17], v[16:17], v[36:37]
    v_pk_add_f32 v[18:19], v[18:19], v[38:39]
    v_pk_add_f32 v[16:17], v[16:17], v[40:41]
    v_pk_add_f32 v[18:19], v[18:19], v[42:43]
    v_pk_add_f32 v[16:17], v[16:17], v[44:45]
    v_pk_add_f32 v[18:19], v[18:19], v[46:47]
    v_pk_add_f32 v[16:17], v[16:17], v[56:57]
    v_pk_add_f32 v[18:19], v[18:19], v[58:59]
    v_pk_add_f32 v[16:17], v[16:17], v[60:61]
    v_pk_add_f32 v[18:19], v[18:19], v[62:63]
    v_pk_add_f32 v[16:17], v[16:17], v[64:65]
    v_pk_add_f32 v[18:19], v[18:19], v[66:67]
    v_pk_add_f32 v[16:17], v[16:17], v[68:69]
    v_pk_add_f32 v[18:19], v[18:19], v[70:71]
    v_pk_add_f32 v[16:17], v[16:17], v[72:73]
    v_pk_add_f32 v[18:19], v[18:19], v[74:75]
    v_pk_add_f32 v[16:17], v[16:17], v[76:77]
    v_pk_add_f32 v[18:19], v[18:19], v[78:79]
    v_pk_add_f32 v[16:17], v[16:17], v[80:81]
    v_pk_add_f32 v[18:19], v[18:19], v[82:83]
    v_pk_add_f32 v[16:17], v[16:17], v[84:85]
    v_pk_add_f32 v[18:19], v[18:19], v[86:87]
    v_pk_add_f32 v[16:17], v[16:17], v[88:89]
    v_pk_add_f32 v[18:19], v[18:19], v[90:91]
    v_pk_add_f32 v[16:17], v[16:17], v[92:93]
    v_pk_add_f32 v[18:19], v[18:19], v[94:95]
    ds_bpermute_b32 v20, v6, v16 offset:80
    ds_bpermute_b32 v21, v6, v17 offset:80
    ds_bpermute_b32 v22, v6, v18 offset:80
    ds_bpermute_b32 v23, v6, v19 offset:80
    ds_bpermute_b32 v24, v6, v16 offset:160
    ds_bpermute_b32 v25, v6, v17 offset:160
    ds_bpermute_b32 v26, v6, v18 offset:160
    ds_bpermute_b32 v27, v6, v19 offset:160
    s_waitcnt lgkmcnt(0)
    v_add_f32 v16, v16, v20
    v_add_f32 v16, v16, v24
    v_cvt_pk_bf16_f32 v16, v16, v16
    v_lshlrev_b32 v16, 16, v16
    v_mul_f32 v16, v16, v5
    v_cvt_pk_bf16_f32 v16, v16, v16
    v_lshlrev_b32 v16, 16, v16
    v_lshlrev_b32 v7, 16, v54
    v_add_f32 v16, v16, v7
    v_add_f32 v17, v17, v21
    v_add_f32 v17, v17, v25
    v_cvt_pk_bf16_f32 v17, v17, v17
    v_lshlrev_b32 v17, 16, v17
    v_mul_f32 v17, v17, v5
    v_cvt_pk_bf16_f32 v17, v17, v17
    v_lshlrev_b32 v17, 16, v17
    v_and_b32 v7, 0xffff0000, v54
    v_add_f32 v17, v17, v7
    v_add_f32 v18, v18, v22
    v_add_f32 v18, v18, v26
    v_cvt_pk_bf16_f32 v18, v18, v18
    v_lshlrev_b32 v18, 16, v18
    v_mul_f32 v18, v18, v5
    v_cvt_pk_bf16_f32 v18, v18, v18
    v_lshlrev_b32 v18, 16, v18
    v_lshlrev_b32 v7, 16, v55
    v_add_f32 v18, v18, v7
    v_add_f32 v19, v19, v23
    v_add_f32 v19, v19, v27
    v_cvt_pk_bf16_f32 v19, v19, v19
    v_lshlrev_b32 v19, 16, v19
    v_mul_f32 v19, v19, v5
    v_cvt_pk_bf16_f32 v19, v19, v19
    v_lshlrev_b32 v19, 16, v19
    v_and_b32 v7, 0xffff0000, v55
    v_add_f32 v19, v19, v7
    v_cvt_pk_bf16_f32 v20, v16, v17
    v_cvt_pk_bf16_f32 v21, v18, v19
    v_lshlrev_b32 v2, 3, v1
    v_cmp_lt_u32 vcc, 19, v1
    s_mul_i32 s6, s87, 1280
    s_mul_i32 s7, s88, 160
    v_cndmask_b32 v2, v2, v3, vcc
    s_add_u32 s6, s6, s7
    s_add_u32 s6, s6, 3837952
    buffer_store_dwordx2 v[20:21], v2, s[8:11], s6 offen sc1
    s_call_b64 s[80:81], L_oprep
    s_waitcnt vmcnt(0)
    s_xor_b32 s6, s5, 1
    s_lshl_b32 s6, s6, 5
    s_add_u32 s6, s6, s4
    s_lshl_b32 s6, s6, 7
    s_add_u32 s6, s6, 3899392
    v_mov_b32 v2, 1
    v_mov_b32 v3, 0x5000000
    v_writelane_b32 v3, s6, 0
    buffer_store_dword v2, v3, s[8:11], 0 offen sc1
L_yd:
    v_cmp_ne_u32 vcc, 1, v50
    s_cbranch_vccz L_ce
    v_and_b32 v3, 1, v1
    v_lshlrev_b32 v3, 12, v3
    v_and_b32 v2, 2, v1
    v_lshl_add_u32 v3, v2, 8, v3
    s_lshr_b32 s72, s68, 2
    s_lshl_b32 s72, s72, 6
    s_andn2_b32 s6, s4, 7
    s_add_u32 s72, s72, s6
    s_add_u32 s72, s72, s76
    s_lshl_b32 s72, s72, 7
    s_add_u32 s72, s72, 3932160
    s_mov_b32 s79, 262144
L_poll_37:
    buffer_load_dword v2, v3, s[8:11], s72 offen sc1
    s_waitcnt vmcnt(0)
    v_cmp_ne_u32 vcc, 1, v2
    s_cbranch_vccz L_polldone_38
    s_sleep 4
    s_sub_u32 s79, s79, 1
    s_cmp_lg_u32 s79, 0
    s_cbranch_scc1 L_poll_37
L_polldone_38:
L_ce:
    s_setprio 0
    s_barrier
    s_barrier
    s_add_u32 s65, s68, 1
    s_and_b32 s65, s65, 3
    s_andn2_b32 s7, s68, 3
    s_add_u32 s65, s65, s7
    s_lshl_b32 s65, s65, 17
    s_add_u32 s65, s65, s66
    s_add_u32 m0, s99, 0
    s_add_u32 s65, s65, 0
    buffer_load_dwordx4 v13, s[8:11], s65 offen offset:0 sc1 lds
    buffer_load_dwordx4 v13, s[8:11], s65 offen offset:1024 sc1 lds
    buffer_load_dwordx4 v13, s[8:11], s65 offen offset:2048 sc1 lds
    buffer_load_dwordx4 v13, s[8:11], s65 offen offset:3072 sc1 lds
    s_add_u32 s65, s68, 1
    s_and_b32 s65, s65, 3
    s_andn2_b32 s7, s68, 3
    s_add_u32 s65, s65, s7
    s_lshl_b32 s65, s65, 17
    s_add_u32 s65, s65, s66
    s_add_u32 m0, s99, 16384
    s_add_u32 s65, s65, 16384
    buffer_load_dwordx4 v13, s[8:11], s65 offen offset:0 sc1 lds
    buffer_load_dwordx4 v13, s[8:11], s65 offen offset:1024 sc1 lds
    buffer_load_dwordx4 v13, s[8:11], s65 offen offset:2048 sc1 lds
    buffer_load_dwordx4 v13, s[8:11], s65 offen offset:3072 sc1 lds
    s_add_u32 s65, s68, 2
    s_and_b32 s65, s65, 3
    s_andn2_b32 s7, s68, 3
    s_add_u32 s65, s65, s7
    s_lshl_b32 s65, s65, 17
    s_add_u32 s65, s65, s66
    s_add_u32 m0, s99, 32768
    s_add_u32 s65, s65, 0
    buffer_load_dwordx4 v13, s[8:11], s65 offen offset:0 sc1 lds
    buffer_load_dwordx4 v13, s[8:11], s65 offen offset:1024 sc1 lds
    buffer_load_dwordx4 v13, s[8:11], s65 offen offset:2048 sc1 lds
    buffer_load_dwordx4 v13, s[8:11], s65 offen offset:3072 sc1 lds
    s_add_u32 s65, s68, 2
    s_and_b32 s65, s65, 3
    s_andn2_b32 s7, s68, 3
    s_add_u32 s65, s65, s7
    s_lshl_b32 s65, s65, 17
    s_add_u32 s65, s65, s66
    s_add_u32 m0, s99, 49152
    s_add_u32 s65, s65, 16384
    buffer_load_dwordx4 v13, s[8:11], s65 offen offset:0 sc1 lds
    buffer_load_dwordx4 v13, s[8:11], s65 offen offset:1024 sc1 lds
    buffer_load_dwordx4 v13, s[8:11], s65 offen offset:2048 sc1 lds
    buffer_load_dwordx4 v13, s[8:11], s65 offen offset:3072 sc1 lds
    s_waitcnt vmcnt(8)
    s_branch L_adone
L_moe:
    s_sub_u32 s6, s62, s5
    s_cmp_lg_u32 s6, 3
    s_cbranch_scc1 L_idle
    s_mov_b32 s12, s48
    s_mov_b32 s13, s49
    s_mov_b32 s14, 0x21c000
    s_mov_b32 s15, 0x20000
    s_cmp_ge_u32 s3, 2
    s_cselect_b32 s12, s50, s12
    s_cselect_b32 s13, s51, s13
    s_mov_b32 s16, s52
    s_mov_b32 s17, s53
    s_mov_b32 s18, 0x21c000
    s_mov_b32 s19, 0x20000
    v_lshrrev_b32 v3, 2, v1
    v_mul_u32_u24 v3, 3456, v3
    v_and_b32 v4, 3, v1
    v_lshl_add_u32 v16, v4, 4, v3
    v_lshrrev_b32 v3, 3, v1
    v_mul_u32_u24 v3, 1280, v3
    v_and_b32 v4, 7, v1
    v_lshl_add_u32 v18, v4, 4, v3
    s_and_b32 s7, s3, 1
    s_mul_i32 s84, s7, 1105920
    s_lshl_b32 s6, s61, 6
    s_add_u32 s84, s84, s6
    s_lshl_b32 s85, s3, 13
    s_add_u32 s85, s85, 131072
    s_mul_i32 s86, s61, 40960
    s_lshl_b32 s6, s3, 7
    s_add_u32 s86, s86, s6
    s_add_u32 m0, s85, 0
    s_nop 0
    buffer_load_dwordx4 v16, s[12:15], s84 offen lds
    s_add_u32 s84, s84, 55296
    s_add_u32 m0, s85, 1024
    s_nop 0
    buffer_load_dwordx4 v16, s[12:15], s84 offen lds
    s_add_u32 s84, s84, 55296
    s_add_u32 m0, s85, 2048
    s_nop 0
    buffer_load_dwordx4 v16, s[12:15], s84 offen lds
    s_add_u32 s84, s84, 55296
    s_add_u32 m0, s85, 3072
    s_nop 0
    buffer_load_dwordx4 v16, s[12:15], s84 offen lds
    s_add_u32 s84, s84, 55296
    s_add_u32 m0, s85, 4096
    s_nop 0
    buffer_load_dwordx4 v16, s[12:15], s84 offen lds
    s_add_u32 s84, s84, 55296
    s_add_u32 m0, s85, 5120
    s_nop 0
    buffer_load_dwordx4 v16, s[12:15], s84 offen lds
    s_add_u32 s84, s84, 55296
    s_add_u32 m0, s85, 6144
    s_nop 0
    buffer_load_dwordx4 v16, s[12:15], s84 offen lds
    s_add_u32 s84, s84, 55296
    s_add_u32 m0, s85, 7168
    s_nop 0
    buffer_load_dwordx4 v16, s[12:15], s84 offen lds
    s_add_u32 s84, s84, 55296
    v_lshrrev_b32 v7, 4, v1
    v_and_b32 v2, 15, v1
    v_lshrrev_b32 v3, 2, v2
    v_lshl_add_u32 v8, v7, 3, v3
    v_lshlrev_b32 v8, 6, v8
    v_and_b32 v4, 3, v2
    v_lshl_add_u32 v8, v4, 3, v8
    v_add_u32 v17, s85, v8
    v_lshl_add_u32 v8, v7, 2, v3
    v_lshlrev_b32 v8, 7, v8
    v_lshl_add_u32 v8, v4, 3, v8
    s_add_u32 s6, s85, 4096
    v_add_u32 v19, s6, v8
    v_mul_u32_u24 v3, 2560, v2
    v_lshl_add_u32 v3, v7, 4, v3
    v_mov_b32 v4, 0x5000000
    v_cmp_gt_u32 vcc, 8, v2
    s_mul_i32 s87, s61, 20480
    s_lshl_b32 s7, s3, 8
    s_add_u32 s87, s87, s7
    s_add_u32 s87, s87, 2686976
    v_cndmask_b32 v20, v4, v3, vcc
    s_and_b32 s7, s3, 1
    s_mul_i32 s88, s7, 10240
    s_add_u32 s88, s88, 12582912
    s_waitcnt vmcnt(0) lgkmcnt(0)
    s_call_b64 s[82:83], L_pend
    s_barrier
    ds_read_b64_tr_b16 v[104:105], v17 offset:0
    ds_read_b64_tr_b16 v[106:107], v17 offset:256
    ds_read_b64_tr_b16 v[108:109], v17 offset:32
    ds_read_b64_tr_b16 v[110:111], v17 offset:288
    ds_read_b64_tr_b16 v[112:113], v17 offset:2048
    ds_read_b64_tr_b16 v[114:115], v17 offset:2304
    ds_read_b64_tr_b16 v[116:117], v17 offset:2080
    ds_read_b64_tr_b16 v[118:119], v17 offset:2336
    s_waitcnt lgkmcnt(0)
    ds_read_b64_tr_b16 v[120:121], v17 offset:4096
    ds_read_b64_tr_b16 v[122:123], v17 offset:4352
    ds_read_b64_tr_b16 v[124:125], v17 offset:4128
    ds_read_b64_tr_b16 v[126:127], v17 offset:4384
    ds_read_b64_tr_b16 v[128:129], v17 offset:6144
    ds_read_b64_tr_b16 v[130:131], v17 offset:6400
    ds_read_b64_tr_b16 v[132:133], v17 offset:6176
    ds_read_b64_tr_b16 v[134:135], v17 offset:6432
    s_waitcnt lgkmcnt(0)
    s_add_u32 m0, s85, 0
    s_nop 0
    buffer_load_dwordx4 v16, s[12:15], s84 offen lds
    s_add_u32 s84, s84, 55296
    s_add_u32 m0, s85, 1024
    s_nop 0
    buffer_load_dwordx4 v16, s[12:15], s84 offen lds
    s_add_u32 s84, s84, 55296
    s_add_u32 m0, s85, 2048
    s_nop 0
    buffer_load_dwordx4 v16, s[12:15], s84 offen lds
    s_add_u32 s84, s84, 55296
    s_add_u32 m0, s85, 3072
    s_nop 0
    buffer_load_dwordx4 v16, s[12:15], s84 offen lds
    s_add_u32 s84, s84, 55296
    s_add_u32 m0, s85, 4096
    s_nop 0
    buffer_load_dwordx4 v16, s[12:15], s84 offen lds
    s_add_u32 s84, s84, 55296
    s_add_u32 m0, s85, 5120
    s_nop 0
    buffer_load_dwordx4 v16, s[12:15], s84 offen lds
    s_add_u32 s84, s84, 55296
    s_add_u32 m0, s85, 6144
    s_nop 0
    buffer_load_dwordx4 v16, s[12:15], s84 offen lds
    s_add_u32 s84, s84, 55296
    s_add_u32 m0, s85, 7168
    s_nop 0
    buffer_load_dwordx4 v16, s[12:15], s84 offen lds
    s_add_u32 s84, s84, 55296
    s_call_b64 s[82:83], L_load
    s_add_i32 s62, s62, 1
    v_and_b32 v3, 7, v1
    v_lshlrev_b32 v3, 2, v3
    s_mov_b32 s72, 0x3a0000
    buffer_load_dword v51, v3, s[8:11], s72 offen sc1
    s_waitcnt vmcnt(0) lgkmcnt(0)
    s_call_b64 s[82:83], L_pend
    s_barrier
    ds_read_b64_tr_b16 v[136:137], v17 offset:0
    ds_read_b64_tr_b16 v[138:139], v17 offset:256
    ds_read_b64_tr_b16 v[140:141], v17 offset:32
    ds_read_b64_tr_b16 v[142:143], v17 offset:288
    ds_read_b64_tr_b16 v[144:145], v17 offset:2048
    ds_read_b64_tr_b16 v[146:147], v17 offset:2304
    ds_read_b64_tr_b16 v[148:149], v17 offset:2080
    ds_read_b64_tr_b16 v[150:151], v17 offset:2336
    s_waitcnt lgkmcnt(0)
    ds_read_b64_tr_b16 v[152:153], v17 offset:4096
    ds_read_b64_tr_b16 v[154:155], v17 offset:4352
    ds_read_b64_tr_b16 v[156:157], v17 offset:4128
    ds_read_b64_tr_b16 v[158:159], v17 offset:4384
    ds_read_b64_tr_b16 v[160:161], v17 offset:6144
    ds_read_b64_tr_b16 v[162:163], v17 offset:6400
    ds_read_b64_tr_b16 v[164:165], v17 offset:6176
    ds_read_b64_tr_b16 v[166:167], v17 offset:6432
    s_waitcnt lgkmcnt(0)
    s_add_u32 m0, s85, 0
    s_nop 0
    buffer_load_dwordx4 v16, s[12:15], s84 offen lds
    s_add_u32 s84, s84, 55296
    s_add_u32 m0, s85, 1024
    s_nop 0
    buffer_load_dwordx4 v16, s[12:15], s84 offen lds
    s_add_u32 s84, s84, 55296
    s_add_u32 m0, s85, 2048
    s_nop 0
    buffer_load_dwordx4 v16, s[12:15], s84 offen lds
    s_add_u32 s84, s84, 55296
    s_add_u32 m0, s85, 3072
    s_nop 0
    buffer_load_dwordx4 v16, s[12:15], s84 offen lds
    s_add_u32 s84, s84, 55296
    s_add_u32 m0, s85, 4096
    s_add_u32 s6, s86, 0
    buffer_load_dwordx4 v18, s[16:19], s6 offen lds
    s_add_u32 m0, s85, 5120
    s_add_u32 s6, s86, 10240
    buffer_load_dwordx4 v18, s[16:19], s6 offen lds
    s_add_u32 m0, s85, 6144
    s_add_u32 s6, s86, 20480
    buffer_load_dwordx4 v18, s[16:19], s6 offen lds
    s_add_u32 m0, s85, 7168
    s_add_u32 s6, s86, 30720
    buffer_load_dwordx4 v18, s[16:19], s6 offen lds
    s_add_u32 s86, s86, 512
    s_call_b64 s[82:83], L_load
    s_add_i32 s62, s62, 1
    v_cmp_le_i32 vcc, 0, v51
    s_cbranch_vccz L_idx_okm
    v_and_b32 v3, 7, v1
    v_lshlrev_b32 v3, 2, v3
    s_mov_b32 s72, 0x3a0000
    s_mov_b32 s79, 262144
L_poll_41:
    buffer_load_dword v51, v3, s[8:11], s72 offen sc1
    s_waitcnt vmcnt(0)
    v_cmp_le_i32 vcc, 0, v51
    s_cbranch_vccz L_polldone_42
    s_sleep 2
    s_sub_u32 s79, s79, 1
    s_cmp_lg_u32 s79, 0
    s_cbranch_scc1 L_poll_41
L_polldone_42:
L_idx_okm:
    buffer_load_dwordx4 v[64:67], v13, s[8:11], s88 offen sc1
    s_add_u32 s88, s88, 1024
    buffer_load_dwordx4 v[68:71], v13, s[8:11], s88 offen sc1
    s_add_u32 s88, s88, 1024
    buffer_load_dwordx4 v[72:75], v13, s[8:11], s88 offen sc1
    s_add_u32 s88, s88, 1024
    buffer_load_dwordx4 v[76:79], v13, s[8:11], s88 offen sc1
    s_add_u32 s88, s88, 1024
    buffer_load_dwordx4 v[80:83], v13, s[8:11], s88 offen sc1
    s_add_u32 s88, s88, 1024
    buffer_load_dwordx4 v[84:87], v13, s[8:11], s88 offen sc1
    s_add_u32 s88, s88, 1024
    buffer_load_dwordx4 v[88:91], v13, s[8:11], s88 offen sc1
    s_add_u32 s88, s88, 1024
    buffer_load_dwordx4 v[92:95], v13, s[8:11], s88 offen sc1
    s_add_u32 s88, s88, 1024
    buffer_load_dwordx4 v[96:99], v13, s[8:11], s88 offen sc1
    s_add_u32 s88, s88, 1024
    buffer_load_dwordx4 v[100:103], v13, s[8:11], s88 offen sc1
    s_add_u32 s88, s88, 1024
    s_waitcnt vmcnt(10) lgkmcnt(0)
    s_call_b64 s[82:83], L_pend
    s_barrier
    ds_read_b64_tr_b16 v[168:169], v17 offset:0
    ds_read_b64_tr_b16 v[170:171], v17 offset:256
    ds_read_b64_tr_b16 v[172:173], v17 offset:32
    ds_read_b64_tr_b16 v[174:175], v17 offset:288
    ds_read_b64_tr_b16 v[176:177], v17 offset:2048
    ds_read_b64_tr_b16 v[178:179], v17 offset:2304
    ds_read_b64_tr_b16 v[180:181], v17 offset:2080
    ds_read_b64_tr_b16 v[182:183], v17 offset:2336
    s_waitcnt lgkmcnt(0)
    ds_read_b64_tr_b16 v[32:33], v19 offset:0
    ds_read_b64_tr_b16 v[34:35], v19 offset:2048
    ds_read_b64_tr_b16 v[36:37], v19 offset:32
    ds_read_b64_tr_b16 v[38:39], v19 offset:2080
    ds_read_b64_tr_b16 v[40:41], v19 offset:64
    ds_read_b64_tr_b16 v[42:43], v19 offset:2112
    ds_read_b64_tr_b16 v[44:45], v19 offset:96
    ds_read_b64_tr_b16 v[46:47], v19 offset:2144
    s_waitcnt lgkmcnt(0)
    s_add_u32 m0, s85, 4096
    s_add_u32 s6, s86, 0
    buffer_load_dwordx4 v18, s[16:19], s6 offen lds
    s_add_u32 m0, s85, 5120
    s_add_u32 s6, s86, 10240
    buffer_load_dwordx4 v18, s[16:19], s6 offen lds
    s_add_u32 m0, s85, 6144
    s_add_u32 s6, s86, 20480
    buffer_load_dwordx4 v18, s[16:19], s6 offen lds
    s_add_u32 m0, s85, 7168
    s_add_u32 s6, s86, 30720
    buffer_load_dwordx4 v18, s[16:19], s6 offen lds
    s_add_u32 s86, s86, 512
    s_call_b64 s[82:83], L_load
    s_add_i32 s62, s62, 1
    s_waitcnt vmcnt(20)
    v_mfma_f32_16x16x32_bf16 v[24:27], v[104:107], v[64:67], 0
    v_mfma_f32_16x16x32_bf16 v[28:31], v[108:111], v[64:67], 0
    v_mfma_f32_16x16x32_bf16 v[24:27], v[112:115], v[68:71], v[24:27]
    v_mfma_f32_16x16x32_bf16 v[28:31], v[116:119], v[68:71], v[28:31]
    v_mfma_f32_16x16x32_bf16 v[24:27], v[120:123], v[72:75], v[24:27]
    v_mfma_f32_16x16x32_bf16 v[28:31], v[124:127], v[72:75], v[28:31]
    v_mfma_f32_16x16x32_bf16 v[24:27], v[128:131], v[76:79], v[24:27]
    v_mfma_f32_16x16x32_bf16 v[28:31], v[132:135], v[76:79], v[28:31]
    v_mfma_f32_16x16x32_bf16 v[24:27], v[136:139], v[80:83], v[24:27]
    v_mfma_f32_16x16x32_bf16 v[28:31], v[140:143], v[80:83], v[28:31]
    v_mfma_f32_16x16x32_bf16 v[24:27], v[144:147], v[84:87], v[24:27]
    v_mfma_f32_16x16x32_bf16 v[28:31], v[148:151], v[84:87], v[28:31]
    v_mfma_f32_16x16x32_bf16 v[24:27], v[152:155], v[88:91], v[24:27]
    v_mfma_f32_16x16x32_bf16 v[28:31], v[156:159], v[88:91], v[28:31]
    v_mfma_f32_16x16x32_bf16 v[24:27], v[160:163], v[92:95], v[24:27]
    v_mfma_f32_16x16x32_bf16 v[28:31], v[164:167], v[92:95], v[28:31]
    v_mfma_f32_16x16x32_bf16 v[24:27], v[168:171], v[96:99], v[24:27]
    v_mfma_f32_16x16x32_bf16 v[28:31], v[172:175], v[96:99], v[28:31]
    v_mfma_f32_16x16x32_bf16 v[24:27], v[176:179], v[100:103], v[24:27]
    v_mfma_f32_16x16x32_bf16 v[28:31], v[180:183], v[100:103], v[28:31]
    v_add_u32 v10, s85, v13
    s_nop 7
    ds_write_b128 v10, v[24:27]
    ds_write_b128 v10, v[28:31] offset:1024
    s_waitcnt vmcnt(0) lgkmcnt(0)
    s_call_b64 s[82:83], L_pend
    s_barrier
    ds_read_b64_tr_b16 v[240:241], v19 offset:0
    ds_read_b64_tr_b16 v[242:243], v19 offset:2048
    ds_read_b64_tr_b16 v[244:245], v19 offset:32
    ds_read_b64_tr_b16 v[246:247], v19 offset:2080
    ds_read_b64_tr_b16 v[248:249], v19 offset:64
    ds_read_b64_tr_b16 v[250:251], v19 offset:2112
    ds_read_b64_tr_b16 v[252:253], v19 offset:96
    ds_read_b64_tr_b16 v[254:255], v19 offset:2144
    v_add_u32 v10, 131072, v13
    s_waitcnt lgkmcnt(0)
    ds_read_b128 v[184:187], v10 offset:0
    ds_read_b128 v[188:191], v10 offset:1024
    ds_read_b128 v[192:195], v10 offset:8192
    ds_read_b128 v[196:199], v10 offset:9216
    ds_read_b128 v[200:203], v10 offset:16384
    ds_read_b128 v[204:207], v10 offset:17408
    ds_read_b128 v[208:211], v10 offset:24576
    ds_read_b128 v[212:215], v10 offset:25600
    s_cmp_ge_u32 s3, 2
    s_cbranch_scc1 L_moe4b
    s_add_u32 m0, s85, 4096
    s_add_u32 s6, s86, 0
    buffer_load_dwordx4 v18, s[16:19], s6 offen lds
    s_add_u32 m0, s85, 5120
    s_add_u32 s6, s86, 10240
    buffer_load_dwordx4 v18, s[16:19], s6 offen lds
    s_add_u32 m0, s85, 6144
    s_add_u32 s6, s86, 20480
    buffer_load_dwordx4 v18, s[16:19], s6 offen lds
    s_add_u32 m0, s85, 7168
    s_add_u32 s6, s86, 30720
    buffer_load_dwordx4 v18, s[16:19], s6 offen lds
    s_add_u32 s86, s86, 512
L_moe4b:
    s_call_b64 s[82:83], L_load
    s_add_i32 s62, s62, 1
    s_waitcnt lgkmcnt(0)
    s_mov_b32 s6, 0xbfb8aa3b
    v_add_f32 v184, v184, v192
    v_add_f32 v200, v200, v208
    v_add_f32 v185, v185, v193
    v_add_f32 v201, v201, v209
    v_cvt_pk_bf16_f32 v185, v184, v185
    v_lshlrev_b32 v184, 16, v185
    v_and_b32 v185, 0xffff0000, v185
    v_cvt_pk_bf16_f32 v201, v200, v201
    v_lshlrev_b32 v200, 16, v201
    v_and_b32 v201, 0xffff0000, v201
    v_mul_f32 v2, s6, v184
    v_mul_f32 v3, s6, v185
    v_exp_f32 v2, v2
    v_exp_f32 v3, v3
    s_nop 0
    v_add_f32 v2, 1.0, v2
    v_add_f32 v3, 1.0, v3
    v_rcp_f32 v2, v2
    v_rcp_f32 v3, v3
    s_nop 0
    v_mul_f32 v184, v184, v2
    v_mul_f32 v185, v185, v3
    v_cvt_pk_bf16_f32 v185, v184, v185
    v_lshlrev_b32 v184, 16, v185
    v_and_b32 v185, 0xffff0000, v185
    v_mul_f32 v184, v184, v200
    v_mul_f32 v185, v185, v201
    v_cvt_pk_bf16_f32 v24, v184, v185
    v_add_f32 v186, v186, v194
    v_add_f32 v202, v202, v210
    v_add_f32 v187, v187, v195
    v_add_f32 v203, v203, v211
    v_cvt_pk_bf16_f32 v187, v186, v187
    v_lshlrev_b32 v186, 16, v187
    v_and_b32 v187, 0xffff0000, v187
    v_cvt_pk_bf16_f32 v203, v202, v203
    v_lshlrev_b32 v202, 16, v203
    v_and_b32 v203, 0xffff0000, v203
    v_mul_f32 v2, s6, v186
    v_mul_f32 v3, s6, v187
    v_exp_f32 v2, v2
    v_exp_f32 v3, v3
    s_nop 0
    v_add_f32 v2, 1.0, v2
    v_add_f32 v3, 1.0, v3
    v_rcp_f32 v2, v2
    v_rcp_f32 v3, v3
    s_nop 0
    v_mul_f32 v186, v186, v2
    v_mul_f32 v187, v187, v3
    v_cvt_pk_bf16_f32 v187, v186, v187
    v_lshlrev_b32 v186, 16, v187
    v_and_b32 v187, 0xffff0000, v187
    v_mul_f32 v186, v186, v202
    v_mul_f32 v187, v187, v203
    v_cvt_pk_bf16_f32 v25, v186, v187
    v_add_f32 v188, v188, v196
    v_add_f32 v204, v204, v212
    v_add_f32 v189, v189, v197
    v_add_f32 v205, v205, v213
    v_cvt_pk_bf16_f32 v189, v188, v189
    v_lshlrev_b32 v188, 16, v189
    v_and_b32 v189, 0xffff0000, v189
    v_cvt_pk_bf16_f32 v205, v204, v205
    v_lshlrev_b32 v204, 16, v205
    v_and_b32 v205, 0xffff0000, v205
    v_mul_f32 v2, s6, v188
    v_mul_f32 v3, s6, v189
    v_exp_f32 v2, v2
    v_exp_f32 v3, v3
    s_nop 0
    v_add_f32 v2, 1.0, v2
    v_add_f32 v3, 1.0, v3
    v_rcp_f32 v2, v2
    v_rcp_f32 v3, v3
    s_nop 0
    v_mul_f32 v188, v188, v2
    v_mul_f32 v189, v189, v3
    v_cvt_pk_bf16_f32 v189, v188, v189
    v_lshlrev_b32 v188, 16, v189
    v_and_b32 v189, 0xffff0000, v189
    v_mul_f32 v188, v188, v204
    v_mul_f32 v189, v189, v205
    v_cvt_pk_bf16_f32 v26, v188, v189
    v_add_f32 v190, v190, v198
    v_add_f32 v206, v206, v214
    v_add_f32 v191, v191, v199
    v_add_f32 v207, v207, v215
    v_cvt_pk_bf16_f32 v191, v190, v191
    v_lshlrev_b32 v190, 16, v191
    v_and_b32 v191, 0xffff0000, v191
    v_cvt_pk_bf16_f32 v207, v206, v207
    v_lshlrev_b32 v206, 16, v207
    v_and_b32 v207, 0xffff0000, v207
    v_mul_f32 v2, s6, v190
    v_mul_f32 v3, s6, v191
    v_exp_f32 v2, v2
    v_exp_f32 v3, v3
    s_nop 0
    v_add_f32 v2, 1.0, v2
    v_add_f32 v3, 1.0, v3
    v_rcp_f32 v2, v2
    v_rcp_f32 v3, v3
    s_nop 0
    v_mul_f32 v190, v190, v2
    v_mul_f32 v191, v191, v3
    v_cvt_pk_bf16_f32 v191, v190, v191
    v_lshlrev_b32 v190, 16, v191
    v_and_b32 v191, 0xffff0000, v191
    v_mul_f32 v190, v190, v206
    v_mul_f32 v191, v191, v207
    v_cvt_pk_bf16_f32 v27, v190, v191
    s_nop 1
    v_mfma_f32_16x16x32_bf16 v[216:219], v[32:35], v[24:27], 0
    v_mfma_f32_16x16x32_bf16 v[220:223], v[36:39], v[24:27], 0
    v_mfma_f32_16x16x32_bf16 v[224:227], v[40:43], v[24:27], 0
    v_mfma_f32_16x16x32_bf16 v[228:231], v[44:47], v[24:27], 0
    s_nop 7
    buffer_store_dwordx4 v[216:219], v20, s[8:11], s87 offen offset:0 sc1
    buffer_store_dwordx4 v[220:223], v20, s[8:11], s87 offen offset:64 sc1
    buffer_store_dwordx4 v[224:227], v20, s[8:11], s87 offen offset:128 sc1
    buffer_store_dwordx4 v[228:231], v20, s[8:11], s87 offen offset:192 sc1
    s_nop 1
    s_waitcnt vmcnt(4) lgkmcnt(0)
    s_call_b64 s[82:83], L_pend
    s_barrier
    s_call_b64 s[82:83], L_load
    s_add_i32 s62, s62, 1
    v_mfma_f32_16x16x32_bf16 v[216:219], v[240:243], v[24:27], 0
    v_mfma_f32_16x16x32_bf16 v[220:223], v[244:247], v[24:27], 0
    v_mfma_f32_16x16x32_bf16 v[224:227], v[248:251], v[24:27], 0
    v_mfma_f32_16x16x32_bf16 v[228:231], v[252:255], v[24:27], 0
    s_nop 7
    buffer_store_dwordx4 v[216:219], v20, s[8:11], s87 offen offset:1024 sc1
    buffer_store_dwordx4 v[220:223], v20, s[8:11], s87 offen offset:1088 sc1
    buffer_store_dwordx4 v[224:227], v20, s[8:11], s87 offen offset:1152 sc1
    buffer_store_dwordx4 v[228:231], v20, s[8:11], s87 offen offset:1216 sc1
    s_nop 1
    s_cmp_ge_u32 s3, 2
    s_cbranch_scc1 L_moe5b
    ds_read_b64_tr_b16 v[32:33], v19 offset:0
    ds_read_b64_tr_b16 v[34:35], v19 offset:2048
    ds_read_b64_tr_b16 v[36:37], v19 offset:32
    ds_read_b64_tr_b16 v[38:39], v19 offset:2080
    ds_read_b64_tr_b16 v[40:41], v19 offset:64
    ds_read_b64_tr_b16 v[42:43], v19 offset:2112
    ds_read_b64_tr_b16 v[44:45], v19 offset:96
    ds_read_b64_tr_b16 v[46:47], v19 offset:2144
    s_waitcnt lgkmcnt(0)
    v_mfma_f32_16x16x32_bf16 v[216:219], v[32:35], v[24:27], 0
    v_mfma_f32_16x16x32_bf16 v[220:223], v[36:39], v[24:27], 0
    v_mfma_f32_16x16x32_bf16 v[224:227], v[40:43], v[24:27], 0
    v_mfma_f32_16x16x32_bf16 v[228:231], v[44:47], v[24:27], 0
    s_nop 7
    buffer_store_dwordx4 v[216:219], v20, s[8:11], s87 offen offset:2048 sc1
    buffer_store_dwordx4 v[220:223], v20, s[8:11], s87 offen offset:2112 sc1
    buffer_store_dwordx4 v[224:227], v20, s[8:11], s87 offen offset:2176 sc1
    buffer_store_dwordx4 v[228:231], v20, s[8:11], s87 offen offset:2240 sc1
    s_nop 1
L_moe5b:
    s_waitcnt vmcnt(4) lgkmcnt(0)
    s_call_b64 s[82:83], L_pend
    s_barrier
    s_waitcnt vmcnt(0)
    s_lshl_b32 s6, s61, 5
    s_add_u32 s6, s6, s3
    s_lshl_b32 s6, s6, 2
    s_add_u32 s6, s6, 15859712
    v_mov_b32 v2, 1
    v_mov_b32 v3, 0x5000000
    v_writelane_b32 v3, s6, 0
    buffer_store_dword v2, v3, s[8:11], 0 offen sc1
    s_call_b64 s[82:83], L_load
    s_add_i32 s62, s62, 1
    s_branch L_idle
L_top:
    s_mov_b32 s6, 0x280000
    v_lshrrev_b32 v2, 1, v1
    v_and_b32 v3, 1, v1
    v_lshlrev_b32 v3, 4, v3
    v_lshl_add_u32 v2, v2, 7, v3
    buffer_load_dwordx4 v[64:67], v2, s[8:11], s6 offen sc1
    s_add_u32 s6, s6, 4096
    buffer_load_dwordx4 v[68:71], v2, s[8:11], s6 offen sc1
    s_add_u32 s6, s6, 4096
    buffer_load_dwordx4 v[72:75], v2, s[8:11], s6 offen sc1
    s_add_u32 s6, s6, 4096
    buffer_load_dwordx4 v[76:79], v2, s[8:11], s6 offen sc1
    s_add_u32 s6, s6, 4096
    buffer_load_dwordx4 v[80:83], v2, s[8:11], s6 offen sc1
    s_add_u32 s6, s6, 4096
    buffer_load_dwordx4 v[84:87], v2, s[8:11], s6 offen sc1
    s_add_u32 s6, s6, 4096
    buffer_load_dwordx4 v[88:91], v2, s[8:11], s6 offen sc1
    s_add_u32 s6, s6, 4096
    buffer_load_dwordx4 v[92:95], v2, s[8:11], s6 offen sc1
    s_add_u32 s6, s6, 4096
    s_waitcnt vmcnt(0)
    v_mov_b32 v24, 0
    s_mov_b32 s7, 0
    s_mov_b32 s84, 0
L_top_l:
    v_max3_u32 v4, v64, v65, v66
    v_max3_u32 v5, v67, v68, v69
    v_max3_u32 v4, v4, v70, v71
    v_max3_u32 v5, v5, v72, v73
    v_max3_u32 v4, v4, v74, v75
    v_max3_u32 v5, v5, v76, v77
    v_max3_u32 v4, v4, v78, v79
    v_max3_u32 v5, v5, v80, v81
    v_max3_u32 v4, v4, v82, v83
    v_max3_u32 v5, v5, v84, v85
    v_max3_u32 v4, v4, v86, v87
    v_max3_u32 v5, v5, v88, v89
    v_max3_u32 v4, v4, v90, v91
    v_max3_u32 v5, v5, v92, v93
    v_max3_u32 v4, v4, v94, v95
    v_max_u32 v4, v4, v5
    s_nop 1
    v_max_u32_dpp v4, v4, v4 quad_perm:[1,0,3,2] row_mask:0xf bank_mask:0xf
    s_nop 1
    v_max_u32_dpp v4, v4, v4 quad_perm:[2,3,0,1] row_mask:0xf bank_mask:0xf
    s_nop 1
    v_max_u32_dpp v4, v4, v4 row_half_mirror row_mask:0xf bank_mask:0xf
    s_nop 1
    v_max_u32_dpp v4, v4, v4 row_mirror row_mask:0xf bank_mask:0xf
    s_nop 1
    v_max_u32_dpp v4, v4, v4 row_bcast:15 row_mask:0xa bank_mask:0xf
    s_nop 1
    v_max_u32_dpp v4, v4, v4 row_bcast:31 row_mask:0xc bank_mask:0xf
    s_nop 1
    v_readlane_b32 s6, v4, 63
    s_mov_b32 m0, s7
    s_nop 3
    s_add_u32 s84, s84, s6
    v_writelane_b32 v24, s84, m0
    v_subrev_u32 v64, s6, v64
    v_subrev_u32 v65, s6, v65
    v_subrev_u32 v66, s6, v66
    v_subrev_u32 v67, s6, v67
    v_subrev_u32 v68, s6, v68
    v_subrev_u32 v69, s6, v69
    v_subrev_u32 v70, s6, v70
    v_subrev_u32 v71, s6, v71
    v_subrev_u32 v72, s6, v72
    v_subrev_u32 v73, s6, v73
    v_subrev_u32 v74, s6, v74
    v_subrev_u32 v75, s6, v75
    v_subrev_u32 v76, s6, v76
    v_subrev_u32 v77, s6, v77
    v_subrev_u32 v78, s6, v78
    v_subrev_u32 v79, s6, v79
    v_subrev_u32 v80, s6, v80
    v_subrev_u32 v81, s6, v81
    v_subrev_u32 v82, s6, v82
    v_subrev_u32 v83, s6, v83
    v_subrev_u32 v84, s6, v84
    v_subrev_u32 v85, s6, v85
    v_subrev_u32 v86, s6, v86
    v_subrev_u32 v87, s6, v87
    v_subrev_u32 v88, s6, v88
    v_subrev_u32 v89, s6, v89
    v_subrev_u32 v90, s6, v90
    v_subrev_u32 v91, s6, v91
    v_subrev_u32 v92, s6, v92
    v_subrev_u32 v93, s6, v93
    v_subrev_u32 v94, s6, v94
    v_subrev_u32 v95, s6, v95
    s_add_u32 s7, s7, 1
    s_cmp_lt_u32 s7, 8
    s_cbranch_scc1 L_top_l
    v_and_b32 v2, 7, v1
    v_lshlrev_b32 v2, 2, v2
    ds_bpermute_b32 v4, v2, v24
    s_waitcnt lgkmcnt(0)
    v_and_b32 v4, 0x7ff, v4
    v_sub_u32 v4, 0x7ff, v4
    v_lshrrev_b32 v5, 4, v4
    v_mul_u32_u24 v5, 20480, v5
    v_and_b32 v4, 15, v4
    v_lshl_add_u32 v5, v4, 4, v5
    v_lshrrev_b32 v7, 4, v1
    v_lshl_add_u32 v5, v7, 8, v5
    v_mov_b32 v6, 0x5000000
    v_and_b32 v2, 8, v1
    v_cmp_eq_u32 vcc, 0, v2
    s_mov_b32 s6, 0
    s_nop 0
    v_cndmask_b32 v5, v6, v5, vcc
    buffer_load_dwordx4 v[64:67], v5, s[8:11], s6 offen offset:0 sc1
    buffer_load_dwordx4 v[68:71], v5, s[8:11], s6 offen offset:1024 sc1
    buffer_load_dwordx4 v[72:75], v5, s[8:11], s6 offen offset:2048 sc1
    buffer_load_dwordx4 v[76:79], v5, s[8:11], s6 offen offset:3072 sc1
    s_add_u32 s6, s6, 4096
    buffer_load_dwordx4 v[80:83], v5, s[8:11], s6 offen offset:0 sc1
    buffer_load_dwordx4 v[84:87], v5, s[8:11], s6 offen offset:1024 sc1
    buffer_load_dwordx4 v[88:91], v5, s[8:11], s6 offen offset:2048 sc1
    buffer_load_dwordx4 v[92:95], v5, s[8:11], s6 offen offset:3072 sc1
    s_add_u32 s6, s6, 4096
    buffer_load_dwordx4 v[96:99], v5, s[8:11], s6 offen offset:0 sc1
    buffer_load_dwordx4 v[100:103], v5, s[8:11], s6 offen offset:1024 sc1
    buffer_load_dwordx4 v[104:107], v5, s[8:11], s6 offen offset:2048 sc1
    buffer_load_dwordx4 v[108:111], v5, s[8:11], s6 offen offset:3072 sc1
    s_add_u32 s6, s6, 4096
    buffer_load_dwordx4 v[112:115], v5, s[8:11], s6 offen offset:0 sc1
    buffer_load_dwordx4 v[116:119], v5, s[8:11], s6 offen offset:1024 sc1
    buffer_load_dwordx4 v[120:123], v5, s[8:11], s6 offen offset:2048 sc1
    buffer_load_dwordx4 v[124:127], v5, s[8:11], s6 offen offset:3072 sc1
    s_add_u32 s6, s6, 4096
    buffer_load_dwordx4 v[128:131], v5, s[8:11], s6 offen offset:0 sc1
    buffer_load_dwordx4 v[132:135], v5, s[8:11], s6 offen offset:1024 sc1
    buffer_load_dwordx4 v[136:139], v5, s[8:11], s6 offen offset:2048 sc1
    buffer_load_dwordx4 v[140:143], v5, s[8:11], s6 offen offset:3072 sc1
    s_waitcnt vmcnt(20)
    s_call_b64 s[82:83], L_pend
    s_barrier
    s_waitcnt vmcnt(0)
    s_mov_b32 s6, 0xc00000
    buffer_store_dwordx4 v[64:67], v13, s[8:11], s6 offen offset:0 sc1
    buffer_store_dwordx4 v[68:71], v13, s[8:11], s6 offen offset:1024 sc1
    buffer_store_dwordx4 v[72:75], v13, s[8:11], s6 offen offset:2048 sc1
    buffer_store_dwordx4 v[76:79], v13, s[8:11], s6 offen offset:3072 sc1
    s_add_u32 s6, s6, 4096
    buffer_store_dwordx4 v[80:83], v13, s[8:11], s6 offen offset:0 sc1
    buffer_store_dwordx4 v[84:87], v13, s[8:11], s6 offen offset:1024 sc1
    buffer_store_dwordx4 v[88:91], v13, s[8:11], s6 offen offset:2048 sc1
    buffer_store_dwordx4 v[92:95], v13, s[8:11], s6 offen offset:3072 sc1
    s_add_u32 s6, s6, 4096
    buffer_store_dwordx4 v[96:99], v13, s[8:11], s6 offen offset:0 sc1
    buffer_store_dwordx4 v[100:103], v13, s[8:11], s6 offen offset:1024 sc1
    buffer_store_dwordx4 v[104:107], v13, s[8:11], s6 offen offset:2048 sc1
    buffer_store_dwordx4 v[108:111], v13, s[8:11], s6 offen offset:3072 sc1
    s_add_u32 s6, s6, 4096
    buffer_store_dwordx4 v[112:115], v13, s[8:11], s6 offen offset:0 sc1
    buffer_store_dwordx4 v[116:119], v13, s[8:11], s6 offen offset:1024 sc1
    buffer_store_dwordx4 v[120:123], v13, s[8:11], s6 offen offset:2048 sc1
    buffer_store_dwordx4 v[124:127], v13, s[8:11], s6 offen offset:3072 sc1
    s_add_u32 s6, s6, 4096
    buffer_store_dwordx4 v[128:131], v13, s[8:11], s6 offen offset:0 sc1
    buffer_store_dwordx4 v[132:135], v13, s[8:11], s6 offen offset:1024 sc1
    buffer_store_dwordx4 v[136:139], v13, s[8:11], s6 offen offset:2048 sc1
    buffer_store_dwordx4 v[140:143], v13, s[8:11], s6 offen offset:3072 sc1
    s_call_b64 s[82:83], L_load
    s_add_i32 s62, s62, 1
    s_waitcnt vmcnt(16)
    v_or_b32 v24, 0x80000000, v24
    v_lshlrev_b32 v5, 2, v1
    v_mov_b32 v6, 0x5000000
    v_cmp_gt_u32 vcc, 8, v1
    s_mov_b32 s6, 0x3a0000
    s_nop 0
    v_cndmask_b32 v5, v6, v5, vcc
    buffer_store_dword v24, v5, s[8:11], s6 offen sc1
    s_branch L_idle
L_back_9_h:
    v_cmp_nge_f32 vcc, s72, v62
    s_cbranch_vccz L_back_9_n
    s_call_b64 s[80:81], L_rare0
L_back_9_n:
    s_branch L_back_9
L_back_10_h:
    v_cmp_nge_f32 vcc, s72, v62
    s_cbranch_vccz L_back_10_n
    s_call_b64 s[80:81], L_rare1
    v_exp_f32 v58, v64
    v_exp_f32 v59, v65
    s_nop 0
    v_add_f32 v52, v58, v59
    v_cvt_pk_bf16_f32 v128, v58, v59
L_back_10_n:
    s_cmp_lt_i32 s64, 0
    s_cbranch_scc1 L_tail1
    s_cmp_gt_i32 s64, 0
    s_cbranch_scc1 L_back_10
    s_call_b64 s[82:83], L_mask
    s_branch L_back_10
L_back_11_h:
    v_cmp_nge_f32 vcc, s72, v62
    s_cbranch_vccz L_back_11_n
    s_call_b64 s[80:81], L_rare0
    v_exp_f32 v58, v80
    v_exp_f32 v59, v81
    s_nop 0
    v_add_f32 v54, v58, v59
    v_cvt_pk_bf16_f32 v136, v58, v59
L_back_11_n:
    s_cmp_lt_i32 s64, 0
    s_cbranch_scc1 L_tail2
    s_cmp_gt_i32 s64, 0
    s_cbranch_scc1 L_back_11
    s_call_b64 s[82:83], L_mask
    s_branch L_back_11
L_back_12_h:
    v_cmp_nge_f32 vcc, s72, v62
    s_cbranch_vccz L_back_12_n
    s_call_b64 s[80:81], L_rare1
    v_exp_f32 v58, v64
    v_exp_f32 v59, v65
    s_nop 0
    v_add_f32 v52, v58, v59
    v_cvt_pk_bf16_f32 v128, v58, v59
L_back_12_n:
    s_cmp_lt_i32 s64, 0
    s_cbranch_scc1 L_tail3
    s_cmp_gt_i32 s64, 0
    s_cbranch_scc1 L_back_12
    s_call_b64 s[82:83], L_mask
    s_branch L_back_12
L_ldback_13_c:
    s_waitcnt vmcnt(0) lgkmcnt(0)
    s_call_b64 s[82:83], L_pend
    s_barrier
    s_call_b64 s[82:83], L_load
    s_branch L_ldback_13
L_back_14_h:
    v_cmp_nge_f32 vcc, s72, v62
    s_cbranch_vccz L_back_14_n
    s_call_b64 s[80:81], L_rare0
    v_exp_f32 v58, v80
    v_exp_f32 v59, v81
    s_nop 0
    v_add_f32 v54, v58, v59
    v_cvt_pk_bf16_f32 v136, v58, v59
L_back_14_n:
    s_cmp_lt_i32 s64, 0
    s_cbranch_scc1 L_tail0
    s_cmp_gt_i32 s64, 0
    s_cbranch_scc1 L_back_14
    s_call_b64 s[82:83], L_mask
    s_branch L_back_14
L_back_15_h:
    v_cmp_nge_f32 vcc, s72, v62
    s_cbranch_vccz L_back_15_n
    s_call_b64 s[80:81], L_rare1
L_back_15_n:
    s_branch L_back_15
L_back_16_h:
    v_cmp_nge_f32 vcc, s72, v62
    s_cbranch_vccz L_back_16_n
    s_call_b64 s[80:81], L_rare0
L_back_16_n:
    s_branch L_back_16
L_back_17_h:
    v_cmp_nge_f32 vcc, s72, v62
    s_cbranch_vccz L_back_17_n
    s_call_b64 s[80:81], L_rare1
L_back_17_n:
    s_branch L_back_17
L_back_20_h:
    v_cmp_nge_f32 vcc, s72, v62
    s_cbranch_vccz L_back_20_n
    s_call_b64 s[80:81], L_rare0
L_back_20_n:
    s_branch L_back_20
L_load:
    s_bitcmp1_b32 s89, 0
    s_cbranch_scc0 L_load_r
    s_add_u32 s77, s77, 32768
    s_xor_b32 s78, s78, 0x10000
    s_add_i32 s73, s62, 1
    s_cmp_gt_i32 s73, s63
    s_cbranch_scc1 L_load_r
    s_cmp_eq_i32 s73, s63
    s_cbranch_scc1 L_load_v
    s_cmp_lg_i32 s73, 3
    s_cbranch_scc1 L_load_k
    s_lshl_b32 s7, s4, 10
    s_add_u32 s7, s7, 3866624
    v_lshrrev_b32 v2, 3, v1
    v_and_b32 v3, 7, v1
    v_lshlrev_b32 v3, 2, v3
    v_lshl_add_u32 v3, v2, 7, v3
    s_mov_b32 s79, 262144
L_poll_48:
    buffer_load_dword v2, v3, s[8:11], s7 offen sc1
    s_waitcnt vmcnt(0)
    v_cmp_gt_u32 vcc, 2, v2
    s_cbranch_vccz L_polldone_49
    s_sleep 2
    s_sub_u32 s79, s79, 1
    s_cmp_lg_u32 s79, 0
    s_cbranch_scc1 L_poll_48
L_polldone_49:
L_load_k:
    s_lshl_b32 s6, s76, 13
    s_add_u32 s6, s6, s78
    s_add_u32 m0, s6, 0
    s_add_u32 s7, s77, 0
    buffer_load_dwordx4 v49, s[8:11], s7 offen offset:0 sc1 lds
    buffer_load_dwordx4 v49, s[8:11], s7 offen offset:1024 sc1 lds
    buffer_load_dwordx4 v49, s[8:11], s7 offen offset:2048 sc1 lds
    buffer_load_dwordx4 v49, s[8:11], s7 offen offset:3072 sc1 lds
    s_lshl_b32 s6, s76, 13
    s_add_u32 s6, s6, s78
    s_add_u32 m0, s6, 4096
    s_add_u32 s7, s77, 4096
    buffer_load_dwordx4 v49, s[8:11], s7 offen offset:0 sc1 lds
    buffer_load_dwordx4 v49, s[8:11], s7 offen offset:1024 sc1 lds
    buffer_load_dwordx4 v49, s[8:11], s7 offen offset:2048 sc1 lds
    buffer_load_dwordx4 v49, s[8:11], s7 offen offset:3072 sc1 lds
    s_lshl_b32 s6, s76, 12
    s_add_u32 s6, s6, s78
    s_add_u32 m0, s6, 49152
    s_add_u32 s7, s77, 524288
    buffer_load_dwordx4 v50, s[8:11], s7 offen offset:0 sc1 lds
    buffer_load_dwordx4 v50, s[8:11], s7 offen offset:1024 sc1 lds
    buffer_load_dwordx4 v50, s[8:11], s7 offen offset:2048 sc1 lds
    buffer_load_dwordx4 v50, s[8:11], s7 offen offset:3072 sc1 lds
L_load_v:
    s_lshl_b32 s6, s76, 12
    s_add_u32 s6, s6, s78
    s_add_u32 m0, s6, 32768
    s_add_u32 s7, s77, 507904
    buffer_load_dwordx4 v50, s[8:11], s7 offen offset:0 sc1 lds
    buffer_load_dwordx4 v50, s[8:11], s7 offen offset:1024 sc1 lds
    buffer_load_dwordx4 v50, s[8:11], s7 offen offset:2048 sc1 lds
    buffer_load_dwordx4 v50, s[8:11], s7 offen offset:3072 sc1 lds
    s_cmp_eq_i32 s73, s63
    s_cbranch_scc1 L_xa
    s_cmp_lt_u32 s5, 4
    s_cbranch_scc1 L_load_r
    s_sub_i32 s6, s62, 0
    s_cmp_gt_u32 s6, 4
    s_cbranch_scc1 L_wb
    s_cbranch_scc0 L_wsel
L_wb:
    s_sub_i32 s79, s73, 1
    s_cmp_lt_u32 s79, 2
    s_cbranch_scc1 L_x3
L_load_r:
    s_setpc_b64 s[82:83]
L_pend:
    s_bitcmp1_b32 s89, 1
    s_cbranch_scc0 L_load_a
    s_cmp_lt_i32 s62, 0
    s_cbranch_scc1 L_load_a
    s_lshl_b32 s6, s4, 3
    s_add_u32 s6, s6, s5
    s_lshl_b32 s6, s6, 5
    s_add_u32 s6, s6, s3
    s_lshl_b32 s6, s6, 2
    s_add_u32 s6, s6, 3866624
    v_mov_b32 v2, 2
    v_mov_b32 v3, 0x5000000
    v_writelane_b32 v3, s6, 0
    buffer_store_dword v2, v3, s[8:11], 0 offen sc1
    s_and_b32 s89, s89, 1
L_load_a:
    s_setpc_b64 s[82:83]
L_wsel:
    s_lshr_b32 s7, s6, 1
    s_lshl_b32 s91, s2, 1
    s_add_u32 s91, s91, s7
    s_sub_u32 s91, s91, 256
    s_cmp_eq_u32 s6, 4
    s_cbranch_scc1 L_w2
    s_bitcmp1_b32 s6, 0
    s_cbranch_scc1 L_w1
L_w0:
    s_mov_b32 s28, s42
    s_mov_b32 s29, s43
    s_mov_b32 s30, 0x500000
    s_mov_b32 s31, 0x20000
    s_lshr_b32 s75, s91, 1
    s_mul_i32 s75, s75, 40960
    s_and_b32 s6, s91, 1
    s_mul_i32 s6, s6, 640
    s_add_u32 s75, s75, s6
    s_movk_i32 s7, 1639
    s_mul_i32 s74, s76, 5120
    s_add_u32 s74, s74, 141312
    s_mul_i32 s6, s76, 320
    v_add_u32 v9, s6, v1
    v_add_u32 v2, 0, v9
    v_mul_lo_u32 v3, v2, s7
    v_lshrrev_b32 v3, 16, v3
    v_mul_u32_u24 v4, 40, v3
    v_sub_u32 v4, v2, v4
    v_mul_u32_u24 v3, 1280, v3
    v_lshl_add_u32 v3, v4, 4, v3
    s_add_u32 m0, s74, 0
    s_nop 0
    buffer_load_dwordx4 v3, s[28:31], s75 offen nt lds
    v_add_u32 v2, 64, v9
    v_mul_lo_u32 v3, v2, s7
    v_lshrrev_b32 v3, 16, v3
    v_mul_u32_u24 v4, 40, v3
    v_sub_u32 v4, v2, v4
    v_mul_u32_u24 v3, 1280, v3
    v_lshl_add_u32 v3, v4, 4, v3
    s_add_u32 m0, s74, 1024
    s_nop 0
    buffer_load_dwordx4 v3, s[28:31], s75 offen nt lds
    v_add_u32 v2, 128, v9
    v_mul_lo_u32 v3, v2, s7
    v_lshrrev_b32 v3, 16, v3
    v_mul_u32_u24 v4, 40, v3
    v_sub_u32 v4, v2, v4
    v_mul_u32_u24 v3, 1280, v3
    v_lshl_add_u32 v3, v4, 4, v3
    s_add_u32 m0, s74, 2048
    s_nop 0
    buffer_load_dwordx4 v3, s[28:31], s75 offen nt lds
    v_add_u32 v2, 192, v9
    v_mul_lo_u32 v3, v2, s7
    v_lshrrev_b32 v3, 16, v3
    v_mul_u32_u24 v4, 40, v3
    v_sub_u32 v4, v2, v4
    v_mul_u32_u24 v3, 1280, v3
    v_lshl_add_u32 v3, v4, 4, v3
    s_add_u32 m0, s74, 3072
    s_nop 0
    buffer_load_dwordx4 v3, s[28:31], s75 offen nt lds
    v_add_u32 v2, 256, v9
    v_mul_lo_u32 v3, v2, s7
    v_lshrrev_b32 v3, 16, v3
    v_mul_u32_u24 v4, 40, v3
    v_sub_u32 v4, v2, v4
    v_mul_u32_u24 v3, 1280, v3
    v_lshl_add_u32 v3, v4, 4, v3
    s_add_u32 m0, s74, 4096
    s_nop 0
    buffer_load_dwordx4 v3, s[28:31], s75 offen nt lds
    s_branch L_wb
L_w1:
    v_and_b32 v2, 15, v1
    v_lshrrev_b32 v3, 4, v1
    v_lshrrev_b32 v4, 2, v2
    v_lshl_add_u32 v4, v3, 2, v4
    v_mul_u32_u24 v4, 640, v4
    v_and_b32 v2, 3, v2
    v_lshl_add_u32 v4, v2, 3, v4
    s_mul_i32 s6, s76, 160
    s_add_u32 s6, s6, 141312
    v_add_u32 v4, s6, v4
    s_mul_i32 s6, s91, 20480
    s_mul_i32 s7, s76, 5120
    s_add_u32 s6, s6, s7
    s_add_u32 s6, s6, 4194304
    s_add_u32 s7, s6, 4096
    ds_read_b64_tr_b16 v[160:161], v4 offset:0
    ds_read_b64_tr_b16 v[162:163], v4 offset:10240
    ds_read_b64_tr_b16 v[164:165], v4 offset:32
    ds_read_b64_tr_b16 v[166:167], v4 offset:10272
    ds_read_b64_tr_b16 v[168:169], v4 offset:64
    ds_read_b64_tr_b16 v[170:171], v4 offset:10304
    ds_read_b64_tr_b16 v[172:173], v4 offset:96
    ds_read_b64_tr_b16 v[174:175], v4 offset:10336
    ds_read_b64_tr_b16 v[176:177], v4 offset:128
    ds_read_b64_tr_b16 v[178:179], v4 offset:10368
    s_waitcnt lgkmcnt(0)
    buffer_store_dwordx4 v[160:163], v13, s[8:11], s6 offen offset:0 sc1
    buffer_store_dwordx4 v[164:167], v13, s[8:11], s6 offen offset:1024 sc1
    buffer_store_dwordx4 v[168:171], v13, s[8:11], s6 offen offset:2048 sc1
    buffer_store_dwordx4 v[172:175], v13, s[8:11], s6 offen offset:3072 sc1
    buffer_store_dwordx4 v[176:179], v13, s[8:11], s7 offen offset:0 sc1
    s_branch L_wb
L_w2:
    s_cmp_lg_u32 s3, 0
    s_cbranch_scc1 L_wb
    s_mov_b32 s28, s56
    s_mov_b32 s29, s57
    s_mov_b32 s30, 0x100
    s_mov_b32 s31, 0x20000
    v_mov_b32 v2, 1
    v_lshlrev_b32 v3, 8, v1
    s_and_b32 s6, s2, 31
    s_lshl_b32 s6, s6, 2
    buffer_atomic_add v2, v3, s[28:31], s6 offen offset:128 sc1
    s_branch L_wb
L_xa:
    s_cmp_lg_u32 s90, 0
    s_cbranch_scc1 L_xa1
    s_mov_b32 s28, s56
    s_mov_b32 s29, s57
    s_mov_b32 s30, 0x100
    s_mov_b32 s31, 0x20000
    v_and_b32 v3, 31, v1
    v_lshlrev_b32 v3, 2, v3
    s_mov_b32 s79, 262144
L_poll_50:
    buffer_load_dword v2, v3, s[28:31], 0 offen offset:128 sc1
    s_waitcnt vmcnt(0)
    v_cmp_gt_u32 vcc, 4, v2
    s_cbranch_vccz L_polldone_51
    s_sleep 8
    s_sub_u32 s79, s79, 1
    s_cmp_lg_u32 s79, 0
    s_cbranch_scc1 L_poll_50
L_polldone_51:
L_xa1:
    s_getpc_b64 s[80:81]
L_pc2:
    s_sub_u32 s80, s80, L_pc2-L_fin
    s_subb_u32 s81, s81, 0
    s_and_b32 s6, s4, 1
    s_lshl_b32 s6, s6, 14
    v_lshl_add_u32 v3, v0, 6, s6
    v_min_u32 v3, L_exit-L_fin, v3
    global_load_dword v11, v3, s[80:81]
    s_lshr_b32 s74, s4, 3
    s_lshl_b32 s74, s74, 2
    s_add_u32 s74, s74, s76
    s_mul_i32 s74, s74, 327680
    s_and_b32 s7, s4, 3
    s_mul_i32 s7, s7, 10240
    s_add_u32 s74, s74, s7
    s_add_u32 s74, s74, 4199424
    s_add_u32 s6, s76, 0
    s_and_b32 s6, s6, 3
    s_lshl_b32 s6, s6, 10
    v_add_u32 v4, s6, v13
    s_add_u32 s6, s76, 1
    s_and_b32 s6, s6, 3
    s_lshl_b32 s6, s6, 10
    v_add_u32 v5, s6, v13
    s_add_u32 s6, s76, 2
    s_and_b32 s6, s6, 3
    s_lshl_b32 s6, s6, 10
    v_add_u32 v6, s6, v13
    s_add_u32 s6, s76, 3
    s_and_b32 s6, s6, 3
    s_lshl_b32 s6, s6, 10
    v_add_u32 v7, s6, v13
    v_add_u32 v8, 4096, v13
    s_lshl_b32 s73, s3, 13
    s_add_u32 s75, s73, s78
    s_add_u32 m0, s73, 131072
    s_add_u32 s7, s74, 0
    buffer_load_dwordx4 v4, s[8:11], s7 offen sc1 lds
    s_add_u32 m0, s73, 132096
    s_add_u32 s7, s74, 0
    buffer_load_dwordx4 v5, s[8:11], s7 offen sc1 lds
    s_add_u32 m0, s73, 133120
    s_add_u32 s7, s74, 0
    buffer_load_dwordx4 v6, s[8:11], s7 offen sc1 lds
    s_add_u32 m0, s73, 134144
    s_add_u32 s7, s74, 0
    buffer_load_dwordx4 v7, s[8:11], s7 offen sc1 lds
    s_add_u32 m0, s73, 135168
    s_add_u32 s7, s74, 0
    buffer_load_dwordx4 v8, s[8:11], s7 offen sc1 lds
    s_add_u32 m0, s73, 136192
    s_add_u32 s7, s74, 40960
    buffer_load_dwordx4 v4, s[8:11], s7 offen sc1 lds
    s_add_u32 m0, s73, 137216
    s_add_u32 s7, s74, 40960
    buffer_load_dwordx4 v5, s[8:11], s7 offen sc1 lds
    s_add_u32 m0, s73, 138240
    s_add_u32 s7, s74, 40960
    buffer_load_dwordx4 v6, s[8:11], s7 offen sc1 lds
    s_add_u32 m0, s75, 0
    s_add_u32 s7, s74, 40960
    buffer_load_dwordx4 v7, s[8:11], s7 offen sc1 lds
    s_add_u32 m0, s75, 1024
    s_add_u32 s7, s74, 40960
    buffer_load_dwordx4 v8, s[8:11], s7 offen sc1 lds
    s_add_u32 m0, s75, 2048
    s_add_u32 s7, s74, 81920
    buffer_load_dwordx4 v4, s[8:11], s7 offen sc1 lds
    s_add_u32 m0, s75, 3072
    s_add_u32 s7, s74, 81920
    buffer_load_dwordx4 v5, s[8:11], s7 offen sc1 lds
    s_add_u32 m0, s75, 4096
    s_add_u32 s7, s74, 81920
    buffer_load_dwordx4 v6, s[8:11], s7 offen sc1 lds
    s_add_u32 m0, s75, 5120
    s_add_u32 s7, s74, 81920
    buffer_load_dwordx4 v7, s[8:11], s7 offen sc1 lds
    s_add_u32 m0, s75, 6144
    s_add_u32 s7, s74, 81920
    buffer_load_dwordx4 v8, s[8:11], s7 offen sc1 lds
    s_add_u32 m0, s75, 7168
    s_add_u32 s7, s74, 122880
    buffer_load_dwordx4 v4, s[8:11], s7 offen sc1 lds
    s_lshl_b32 s75, s3, 12
    s_add_u32 s75, s75, s78
    s_add_u32 m0, s75, 49152
    s_add_u32 s7, s74, 122880
    buffer_load_dwordx4 v5, s[8:11], s7 offen sc1 lds
    s_add_u32 m0, s75, 50176
    s_add_u32 s7, s74, 122880
    buffer_load_dwordx4 v6, s[8:11], s7 offen sc1 lds
    s_add_u32 m0, s75, 51200
    s_add_u32 s7, s74, 122880
    buffer_load_dwordx4 v7, s[8:11], s7 offen sc1 lds
    s_add_u32 m0, s75, 52224
    s_add_u32 s7, s74, 122880
    buffer_load_dwordx4 v8, s[8:11], s7 offen sc1 lds
    s_setpc_b64 s[82:83]
L_x3:
    s_mov_b32 s12, s48
    s_mov_b32 s13, s49
    s_mov_b32 s14, 0x21c000
    s_mov_b32 s15, 0x20000
    s_cmp_eq_u32 s3, 3
    s_cbranch_scc1 L_load_r
    s_cmp_eq_u32 s3, 1
    s_cselect_b32 s12, s50, s12
    s_cselect_b32 s13, s51, s13
    s_cmp_eq_u32 s3, 2
    s_cselect_b32 s12, s52, s12
    s_cselect_b32 s13, s53, s13
    s_mov_b32 s73, 3456
    s_cmov_b32 s73, 256
    s_mov_b32 s75, 256
    s_cmov_b32 s75, 163840
    s_lshr_b32 s6, s2, 3
    s_sub_u32 s6, s6, 16
    s_mul_i32 s6, s6, 40
    v_lshrrev_b32 v2, 2, v1
    v_add_u32 v2, s6, v2
    v_mul_lo_u32 v2, v2, s73
    v_and_b32 v3, 3, v1
    v_lshl_add_u32 v2, v3, 6, v2
    s_xor_b32 s79, s79, 1
    s_lshl_b32 s6, s79, 3
    s_lshr_b32 s7, s4, 2
    s_add_u32 s6, s6, s7
    s_mul_i32 s6, s6, s75
    v_mov_b32 v3, 0x5000000
    v_cmp_gt_u32 vcc, 32, v1
    s_lshl_b32 s73, s73, 4
    s_nop 0
    v_cndmask_b32 v3, v3, v2, vcc
    buffer_load_dword v11, v2, s[12:15], s6 offen
    s_add_u32 s7, s6, s73
    buffer_load_dword v11, v2, s[12:15], s7 offen
    s_add_u32 s7, s7, s73
    buffer_load_dword v11, v3, s[12:15], s7 offen
    s_setpc_b64 s[82:83]
L_mask:
    v_and_b32 v2, 15, v1
    v_lshrrev_b32 v3, 4, v1
    v_lshlrev_b32 v3, 2, v3
    v_sub_u32 v2, v2, v3
    v_mov_b32 v3, 0xff800000
    v_cmp_gt_i32 vcc, 0, v2
    v_mov_b32 v152, v3
    s_nop 0
    v_cndmask_b32 v144, v144, v3, vcc
    v_cndmask_b32 v156, v156, v3, vcc
    v_cmp_gt_i32 vcc, 1, v2
    v_mov_b32 v153, v3
    s_nop 0
    v_cndmask_b32 v145, v145, v3, vcc
    v_cndmask_b32 v157, v157, v3, vcc
    v_cmp_gt_i32 vcc, 2, v2
    v_mov_b32 v154, v3
    s_nop 0
    v_cndmask_b32 v146, v146, v3, vcc
    v_cndmask_b32 v158, v158, v3, vcc
    v_cmp_gt_i32 vcc, 3, v2
    v_mov_b32 v155, v3
    s_nop 0
    v_cndmask_b32 v147, v147, v3, vcc
    v_cndmask_b32 v159, v159, v3, vcc
    s_nop 1
    s_setpc_b64 s[82:83]
L_rare0:
    s_nop 15
    v_max3_f32 v62, 0, v64, v65
    v_max3_f32 v62, v62, v66, v67
    v_max3_f32 v62, v62, v72, v73
    v_max3_f32 v62, v62, v74, v75
    v_mov_b32 v58, v62
    s_nop 1
    v_permlane16_swap_b32 v62, v58
    s_nop 1
    v_max_f32 v62, v62, v58
    v_mov_b32 v58, v62
    s_nop 1
    v_permlane32_swap_b32 v62, v58
    s_nop 1
    v_max_f32 v62, v62, v58
    v_exp_f32 v58, -v62
    v_sub_f32 v64, v64, v62
    v_sub_f32 v80, v80, v62
    v_sub_f32 v144, v144, v62
    v_sub_f32 v65, v65, v62
    v_sub_f32 v81, v81, v62
    v_sub_f32 v145, v145, v62
    v_sub_f32 v66, v66, v62
    v_sub_f32 v82, v82, v62
    v_sub_f32 v146, v146, v62
    v_sub_f32 v67, v67, v62
    v_sub_f32 v83, v83, v62
    v_sub_f32 v147, v147, v62
    v_sub_f32 v72, v72, v62
    v_sub_f32 v88, v88, v62
    v_sub_f32 v152, v152, v62
    v_sub_f32 v73, v73, v62
    v_sub_f32 v89, v89, v62
    v_sub_f32 v153, v153, v62
    v_sub_f32 v74, v74, v62
    v_sub_f32 v90, v90, v62
    v_sub_f32 v154, v154, v62
    v_sub_f32 v75, v75, v62
    v_sub_f32 v91, v91, v62
    v_sub_f32 v155, v155, v62
    v_mul_f32 v56, v58, v56
    v_mul_f32 v192, v58, v192
    v_mul_f32 v193, v58, v193
    v_mul_f32 v194, v58, v194
    v_mul_f32 v195, v58, v195
    v_mul_f32 v200, v58, v200
    v_mul_f32 v201, v58, v201
    v_mul_f32 v202, v58, v202
    v_mul_f32 v203, v58, v203
    v_mul_f32 v208, v58, v208
    v_mul_f32 v209, v58, v209
    v_mul_f32 v210, v58, v210
    v_mul_f32 v211, v58, v211
    v_mul_f32 v216, v58, v216
    v_mul_f32 v217, v58, v217
    v_mul_f32 v218, v58, v218
    v_mul_f32 v219, v58, v219
    v_mul_f32 v224, v58, v224
    v_mul_f32 v225, v58, v225
    v_mul_f32 v226, v58, v226
    v_mul_f32 v227, v58, v227
    v_mul_f32 v232, v58, v232
    v_mul_f32 v233, v58, v233
    v_mul_f32 v234, v58, v234
    v_mul_f32 v235, v58, v235
    v_mul_f32 v240, v58, v240
    v_mul_f32 v241, v58, v241
    v_mul_f32 v242, v58, v242
    v_mul_f32 v243, v58, v243
    v_mul_f32 v248, v58, v248
    v_mul_f32 v249, v58, v249
    v_mul_f32 v250, v58, v250
    v_mul_f32 v251, v58, v251
    v_max3_f32 v62, 0, v68, v69
    v_max3_f32 v62, v62, v70, v71
    v_max3_f32 v62, v62, v76, v77
    v_max3_f32 v62, v62, v78, v79
    v_mov_b32 v58, v62
    s_nop 1
    v_permlane16_swap_b32 v62, v58
    s_nop 1
    v_max_f32 v62, v62, v58
    v_mov_b32 v58, v62
    s_nop 1
    v_permlane32_swap_b32 v62, v58
    s_nop 1
    v_max_f32 v62, v62, v58
    v_exp_f32 v58, -v62
    v_sub_f32 v68, v68, v62
    v_sub_f32 v84, v84, v62
    v_sub_f32 v148, v148, v62
    v_sub_f32 v69, v69, v62
    v_sub_f32 v85, v85, v62
    v_sub_f32 v149, v149, v62
    v_sub_f32 v70, v70, v62
    v_sub_f32 v86, v86, v62
    v_sub_f32 v150, v150, v62
    v_sub_f32 v71, v71, v62
    v_sub_f32 v87, v87, v62
    v_sub_f32 v151, v151, v62
    v_sub_f32 v76, v76, v62
    v_sub_f32 v92, v92, v62
    v_sub_f32 v156, v156, v62
    v_sub_f32 v77, v77, v62
    v_sub_f32 v93, v93, v62
    v_sub_f32 v157, v157, v62
    v_sub_f32 v78, v78, v62
    v_sub_f32 v94, v94, v62
    v_sub_f32 v158, v158, v62
    v_sub_f32 v79, v79, v62
    v_sub_f32 v95, v95, v62
    v_sub_f32 v159, v159, v62
    v_mul_f32 v57, v58, v57
    v_mul_f32 v196, v58, v196
    v_mul_f32 v197, v58, v197
    v_mul_f32 v198, v58, v198
    v_mul_f32 v199, v58, v199
    v_mul_f32 v204, v58, v204
    v_mul_f32 v205, v58, v205
    v_mul_f32 v206, v58, v206
    v_mul_f32 v207, v58, v207
    v_mul_f32 v212, v58, v212
    v_mul_f32 v213, v58, v213
    v_mul_f32 v214, v58, v214
    v_mul_f32 v215, v58, v215
    v_mul_f32 v220, v58, v220
    v_mul_f32 v221, v58, v221
    v_mul_f32 v222, v58, v222
    v_mul_f32 v223, v58, v223
    v_mul_f32 v228, v58, v228
    v_mul_f32 v229, v58, v229
    v_mul_f32 v230, v58, v230
    v_mul_f32 v231, v58, v231
    v_mul_f32 v236, v58, v236
    v_mul_f32 v237, v58, v237
    v_mul_f32 v238, v58, v238
    v_mul_f32 v239, v58, v239
    v_mul_f32 v244, v58, v244
    v_mul_f32 v245, v58, v245
    v_mul_f32 v246, v58, v246
    v_mul_f32 v247, v58, v247
    v_mul_f32 v252, v58, v252
    v_mul_f32 v253, v58, v253
    v_mul_f32 v254, v58, v254
    v_mul_f32 v255, v58, v255
    v_exp_f32 v58, v64
    s_nop 0
    v_exp_f32 v59, v65
    s_nop 0
    v_add_f32 v52, v58, v59
    v_cvt_pk_bf16_f32 v128, v58, v59
    v_exp_f32 v60, v66
    s_nop 0
    v_add_f32 v52, v60, v52
    v_exp_f32 v61, v67
    s_nop 0
    v_add_f32 v52, v61, v52
    v_cvt_pk_bf16_f32 v129, v60, v61
    v_exp_f32 v58, v68
    s_nop 0
    v_exp_f32 v59, v69
    s_nop 0
    v_add_f32 v53, v58, v59
    v_cvt_pk_bf16_f32 v132, v58, v59
    v_exp_f32 v60, v70
    s_nop 0
    v_add_f32 v53, v60, v53
    v_exp_f32 v61, v71
    s_nop 0
    v_add_f32 v53, v61, v53
    v_cvt_pk_bf16_f32 v133, v60, v61
    v_exp_f32 v58, v72
    s_nop 0
    v_add_f32 v52, v58, v52
    v_exp_f32 v59, v73
    s_nop 0
    v_add_f32 v52, v59, v52
    v_cvt_pk_bf16_f32 v130, v58, v59
    v_exp_f32 v60, v74
    s_nop 0
    v_add_f32 v52, v60, v52
    v_exp_f32 v61, v75
    s_nop 0
    v_add_f32 v52, v61, v52
    v_cvt_pk_bf16_f32 v131, v60, v61
    v_exp_f32 v58, v76
    s_nop 0
    v_add_f32 v53, v58, v53
    v_exp_f32 v59, v77
    s_nop 0
    v_add_f32 v53, v59, v53
    v_cvt_pk_bf16_f32 v134, v58, v59
    v_exp_f32 v60, v78
    s_nop 0
    v_add_f32 v53, v60, v53
    v_exp_f32 v61, v79
    s_nop 0
    v_add_f32 v53, v61, v53
    v_cvt_pk_bf16_f32 v135, v60, v61
    s_nop 1
    s_setpc_b64 s[80:81]
L_rare1:
    s_nop 15
    v_max3_f32 v62, 0, v80, v81
    v_max3_f32 v62, v62, v82, v83
    v_max3_f32 v62, v62, v88, v89
    v_max3_f32 v62, v62, v90, v91
    v_mov_b32 v58, v62
    s_nop 1
    v_permlane16_swap_b32 v62, v58
    s_nop 1
    v_max_f32 v62, v62, v58
    v_mov_b32 v58, v62
    s_nop 1
    v_permlane32_swap_b32 v62, v58
    s_nop 1
    v_max_f32 v62, v62, v58
    v_exp_f32 v58, -v62
    v_sub_f32 v64, v64, v62
    v_sub_f32 v80, v80, v62
    v_sub_f32 v144, v144, v62
    v_sub_f32 v65, v65, v62
    v_sub_f32 v81, v81, v62
    v_sub_f32 v145, v145, v62
    v_sub_f32 v66, v66, v62
    v_sub_f32 v82, v82, v62
    v_sub_f32 v146, v146, v62
    v_sub_f32 v67, v67, v62
    v_sub_f32 v83, v83, v62
    v_sub_f32 v147, v147, v62
    v_sub_f32 v72, v72, v62
    v_sub_f32 v88, v88, v62
    v_sub_f32 v152, v152, v62
    v_sub_f32 v73, v73, v62
    v_sub_f32 v89, v89, v62
    v_sub_f32 v153, v153, v62
    v_sub_f32 v74, v74, v62
    v_sub_f32 v90, v90, v62
    v_sub_f32 v154, v154, v62
    v_sub_f32 v75, v75, v62
    v_sub_f32 v91, v91, v62
    v_sub_f32 v155, v155, v62
    v_mul_f32 v56, v58, v56
    v_mul_f32 v192, v58, v192
    v_mul_f32 v193, v58, v193
    v_mul_f32 v194, v58, v194
    v_mul_f32 v195, v58, v195
    v_mul_f32 v200, v58, v200
    v_mul_f32 v201, v58, v201
    v_mul_f32 v202, v58, v202
    v_mul_f32 v203, v58, v203
    v_mul_f32 v208, v58, v208
    v_mul_f32 v209, v58, v209
    v_mul_f32 v210, v58, v210
    v_mul_f32 v211, v58, v211
    v_mul_f32 v216, v58, v216
    v_mul_f32 v217, v58, v217
    v_mul_f32 v218, v58, v218
    v_mul_f32 v219, v58, v219
    v_mul_f32 v224, v58, v224
    v_mul_f32 v225, v58, v225
    v_mul_f32 v226, v58, v226
    v_mul_f32 v227, v58, v227
    v_mul_f32 v232, v58, v232
    v_mul_f32 v233, v58, v233
    v_mul_f32 v234, v58, v234
    v_mul_f32 v235, v58, v235
    v_mul_f32 v240, v58, v240
    v_mul_f32 v241, v58, v241
    v_mul_f32 v242, v58, v242
    v_mul_f32 v243, v58, v243
    v_mul_f32 v248, v58, v248
    v_mul_f32 v249, v58, v249
    v_mul_f32 v250, v58, v250
    v_mul_f32 v251, v58, v251
    v_max3_f32 v62, 0, v84, v85
    v_max3_f32 v62, v62, v86, v87
    v_max3_f32 v62, v62, v92, v93
    v_max3_f32 v62, v62, v94, v95
    v_mov_b32 v58, v62
    s_nop 1
    v_permlane16_swap_b32 v62, v58
    s_nop 1
    v_max_f32 v62, v62, v58
    v_mov_b32 v58, v62
    s_nop 1
    v_permlane32_swap_b32 v62, v58
    s_nop 1
    v_max_f32 v62, v62, v58
    v_exp_f32 v58, -v62
    v_sub_f32 v68, v68, v62
    v_sub_f32 v84, v84, v62
    v_sub_f32 v148, v148, v62
    v_sub_f32 v69, v69, v62
    v_sub_f32 v85, v85, v62
    v_sub_f32 v149, v149, v62
    v_sub_f32 v70, v70, v62
    v_sub_f32 v86, v86, v62
    v_sub_f32 v150, v150, v62
    v_sub_f32 v71, v71, v62
    v_sub_f32 v87, v87, v62
    v_sub_f32 v151, v151, v62
    v_sub_f32 v76, v76, v62
    v_sub_f32 v92, v92, v62
    v_sub_f32 v156, v156, v62
    v_sub_f32 v77, v77, v62
    v_sub_f32 v93, v93, v62
    v_sub_f32 v157, v157, v62
    v_sub_f32 v78, v78, v62
    v_sub_f32 v94, v94, v62
    v_sub_f32 v158, v158, v62
    v_sub_f32 v79, v79, v62
    v_sub_f32 v95, v95, v62
    v_sub_f32 v159, v159, v62
    v_mul_f32 v57, v58, v57
    v_mul_f32 v196, v58, v196
    v_mul_f32 v197, v58, v197
    v_mul_f32 v198, v58, v198
    v_mul_f32 v199, v58, v199
    v_mul_f32 v204, v58, v204
    v_mul_f32 v205, v58, v205
    v_mul_f32 v206, v58, v206
    v_mul_f32 v207, v58, v207
    v_mul_f32 v212, v58, v212
    v_mul_f32 v213, v58, v213
    v_mul_f32 v214, v58, v214
    v_mul_f32 v215, v58, v215
    v_mul_f32 v220, v58, v220
    v_mul_f32 v221, v58, v221
    v_mul_f32 v222, v58, v222
    v_mul_f32 v223, v58, v223
    v_mul_f32 v228, v58, v228
    v_mul_f32 v229, v58, v229
    v_mul_f32 v230, v58, v230
    v_mul_f32 v231, v58, v231
    v_mul_f32 v236, v58, v236
    v_mul_f32 v237, v58, v237
    v_mul_f32 v238, v58, v238
    v_mul_f32 v239, v58, v239
    v_mul_f32 v244, v58, v244
    v_mul_f32 v245, v58, v245
    v_mul_f32 v246, v58, v246
    v_mul_f32 v247, v58, v247
    v_mul_f32 v252, v58, v252
    v_mul_f32 v253, v58, v253
    v_mul_f32 v254, v58, v254
    v_mul_f32 v255, v58, v255
    v_exp_f32 v58, v80
    s_nop 0
    v_exp_f32 v59, v81
    s_nop 0
    v_add_f32 v54, v58, v59
    v_cvt_pk_bf16_f32 v136, v58, v59
    v_exp_f32 v60, v82
    s_nop 0
    v_add_f32 v54, v60, v54
    v_exp_f32 v61, v83
    s_nop 0
    v_add_f32 v54, v61, v54
    v_cvt_pk_bf16_f32 v137, v60, v61
    v_exp_f32 v58, v84
    s_nop 0
    v_exp_f32 v59, v85
    s_nop 0
    v_add_f32 v55, v58, v59
    v_cvt_pk_bf16_f32 v140, v58, v59
    v_exp_f32 v60, v86
    s_nop 0
    v_add_f32 v55, v60, v55
    v_exp_f32 v61, v87
    s_nop 0
    v_add_f32 v55, v61, v55
    v_cvt_pk_bf16_f32 v141, v60, v61
    v_exp_f32 v58, v88
    s_nop 0
    v_add_f32 v54, v58, v54
    v_exp_f32 v59, v89
    s_nop 0
    v_add_f32 v54, v59, v54
    v_cvt_pk_bf16_f32 v138, v58, v59
    v_exp_f32 v60, v90
    s_nop 0
    v_add_f32 v54, v60, v54
    v_exp_f32 v61, v91
    s_nop 0
    v_add_f32 v54, v61, v54
    v_cvt_pk_bf16_f32 v139, v60, v61
    v_exp_f32 v58, v92
    s_nop 0
    v_add_f32 v55, v58, v55
    v_exp_f32 v59, v93
    s_nop 0
    v_add_f32 v55, v59, v55
    v_cvt_pk_bf16_f32 v142, v58, v59
    v_exp_f32 v60, v94
    s_nop 0
    v_add_f32 v55, v60, v55
    v_exp_f32 v61, v95
    s_nop 0
    v_add_f32 v55, v61, v55
    v_cvt_pk_bf16_f32 v143, v60, v61
    s_nop 1
    s_setpc_b64 s[80:81]
L_adone:
    s_barrier
    ds_read_b128 v[16:19], v4 offset:0
    ds_read_b128 v[20:23], v4 offset:1024
    ds_read_b128 v[24:27], v4 offset:2048
    ds_read_b128 v[28:31], v4 offset:3072
    s_waitcnt lgkmcnt(3)
    v_mfma_f32_16x16x32_bf16 v[56:59], v[96:99], v[16:19], 0
    v_mfma_f32_16x16x32_bf16 v[60:63], v[100:103], v[16:19], 0
    v_mfma_f32_16x16x32_bf16 v[64:67], v[104:107], v[16:19], 0
    v_mfma_f32_16x16x32_bf16 v[68:71], v[108:111], v[16:19], 0
    v_mfma_f32_16x16x32_bf16 v[72:75], v[112:115], v[16:19], 0
    ds_read_b128 v[16:19], v4 offset:4096
    s_cmp_lt_u32 s3, 4
    s_cbranch_scc1 L_nowl_52
    s_add_u32 s75, s69, 204800
    buffer_load_dwordx4 v[196:199], v44, s[8:11], s75 offen sc1
    buffer_load_dwordx4 v[200:203], v45, s[8:11], s75 offen sc1
    buffer_load_dwordx4 v[204:207], v46, s[8:11], s75 offen sc1
    buffer_load_dwordx4 v[208:211], v47, s[8:11], s75 offen sc1
    buffer_load_dwordx4 v[212:215], v52, s[8:11], s75 offen sc1
L_nowl_52:
    s_waitcnt lgkmcnt(3)
    v_mfma_f32_16x16x32_bf16 v[56:59], v[116:119], v[20:23], v[56:59]
    v_mfma_f32_16x16x32_bf16 v[60:63], v[120:123], v[20:23], v[60:63]
    v_mfma_f32_16x16x32_bf16 v[64:67], v[124:127], v[20:23], v[64:67]
    v_mfma_f32_16x16x32_bf16 v[68:71], v[128:131], v[20:23], v[68:71]
    v_mfma_f32_16x16x32_bf16 v[72:75], v[132:135], v[20:23], v[72:75]
    ds_read_b128 v[20:23], v4 offset:5120
    s_cmp_lt_u32 s3, 4
    s_cbranch_scc1 L_nowl_53
    s_add_u32 s75, s69, 245760
    buffer_load_dwordx4 v[216:219], v44, s[8:11], s75 offen sc1
    buffer_load_dwordx4 v[220:223], v45, s[8:11], s75 offen sc1
    buffer_load_dwordx4 v[224:227], v46, s[8:11], s75 offen sc1
    buffer_load_dwordx4 v[228:231], v47, s[8:11], s75 offen sc1
    buffer_load_dwordx4 v[232:235], v52, s[8:11], s75 offen sc1
L_nowl_53:
    s_waitcnt lgkmcnt(3)
    v_mfma_f32_16x16x32_bf16 v[56:59], v[136:139], v[24:27], v[56:59]
    v_mfma_f32_16x16x32_bf16 v[60:63], v[140:143], v[24:27], v[60:63]
    v_mfma_f32_16x16x32_bf16 v[64:67], v[144:147], v[24:27], v[64:67]
    v_mfma_f32_16x16x32_bf16 v[68:71], v[148:151], v[24:27], v[68:71]
    v_mfma_f32_16x16x32_bf16 v[72:75], v[152:155], v[24:27], v[72:75]
    ds_read_b128 v[24:27], v4 offset:6144
    s_cmp_lt_u32 s3, 4
    s_cbranch_scc1 L_nowl_54
    s_add_u32 s75, s69, 286720
    buffer_load_dwordx4 v[236:239], v44, s[8:11], s75 offen sc1
    buffer_load_dwordx4 v[240:243], v45, s[8:11], s75 offen sc1
    buffer_load_dwordx4 v[244:247], v46, s[8:11], s75 offen sc1
    buffer_load_dwordx4 v[248:251], v47, s[8:11], s75 offen sc1
    buffer_load_dwordx4 v[252:255], v52, s[8:11], s75 offen sc1
L_nowl_54:
    s_waitcnt lgkmcnt(3)
    v_mfma_f32_16x16x32_bf16 v[56:59], v[156:159], v[28:31], v[56:59]
    s_add_u32 s65, s68, 3
    s_and_b32 s65, s65, 3
    s_andn2_b32 s7, s68, 3
    s_add_u32 s65, s65, s7
    s_lshl_b32 s65, s65, 17
    s_add_u32 s65, s65, s66
    s_add_u32 m0, s99, 65536
    s_add_u32 s65, s65, 0
    buffer_load_dwordx4 v13, s[8:11], s65 offen offset:0 sc1 lds
    v_mfma_f32_16x16x32_bf16 v[60:63], v[160:163], v[28:31], v[60:63]
    buffer_load_dwordx4 v13, s[8:11], s65 offen offset:1024 sc1 lds
    v_mfma_f32_16x16x32_bf16 v[64:67], v[164:167], v[28:31], v[64:67]
    buffer_load_dwordx4 v13, s[8:11], s65 offen offset:2048 sc1 lds
    v_mfma_f32_16x16x32_bf16 v[68:71], v[168:171], v[28:31], v[68:71]
    buffer_load_dwordx4 v13, s[8:11], s65 offen offset:3072 sc1 lds
    v_mfma_f32_16x16x32_bf16 v[72:75], v[172:175], v[28:31], v[72:75]
    ds_read_b128 v[28:31], v4 offset:7168
    s_waitcnt vmcnt(20)
    s_waitcnt lgkmcnt(3)
    v_mfma_f32_16x16x32_bf16 v[56:59], v[176:179], v[16:19], v[56:59]
    v_mfma_f32_16x16x32_bf16 v[60:63], v[180:183], v[16:19], v[60:63]
    v_mfma_f32_16x16x32_bf16 v[64:67], v[184:187], v[16:19], v[64:67]
    v_mfma_f32_16x16x32_bf16 v[68:71], v[188:191], v[16:19], v[68:71]
    v_mfma_f32_16x16x32_bf16 v[72:75], v[192:195], v[16:19], v[72:75]
    s_waitcnt vmcnt(14)
    s_waitcnt lgkmcnt(2)
    v_mfma_f32_16x16x32_bf16 v[56:59], v[196:199], v[20:23], v[56:59]
    v_mfma_f32_16x16x32_bf16 v[60:63], v[200:203], v[20:23], v[60:63]
    v_mfma_f32_16x16x32_bf16 v[64:67], v[204:207], v[20:23], v[64:67]
    v_mfma_f32_16x16x32_bf16 v[68:71], v[208:211], v[20:23], v[68:71]
    v_mfma_f32_16x16x32_bf16 v[72:75], v[212:215], v[20:23], v[72:75]
    s_cmp_ge_u32 s3, 4
    s_cbranch_scc1 L_o0
    s_waitcnt vmcnt(4)
L_o0:
    s_waitcnt lgkmcnt(0)
    s_barrier
    ds_read_b128 v[16:19], v4 offset:32768
    ds_read_b128 v[20:23], v4 offset:33792
    s_waitcnt vmcnt(9)
    v_mfma_f32_16x16x32_bf16 v[56:59], v[216:219], v[24:27], v[56:59]
    v_mfma_f32_16x16x32_bf16 v[60:63], v[220:223], v[24:27], v[60:63]
    v_mfma_f32_16x16x32_bf16 v[64:67], v[224:227], v[24:27], v[64:67]
    v_mfma_f32_16x16x32_bf16 v[68:71], v[228:231], v[24:27], v[68:71]
    v_mfma_f32_16x16x32_bf16 v[72:75], v[232:235], v[24:27], v[72:75]
    ds_read_b128 v[24:27], v4 offset:34816
    s_waitcnt vmcnt(4)
    v_mfma_f32_16x16x32_bf16 v[56:59], v[236:239], v[28:31], v[56:59]
    v_mfma_f32_16x16x32_bf16 v[60:63], v[240:243], v[28:31], v[60:63]
    v_mfma_f32_16x16x32_bf16 v[64:67], v[244:247], v[28:31], v[64:67]
    v_mfma_f32_16x16x32_bf16 v[68:71], v[248:251], v[28:31], v[68:71]
    v_mfma_f32_16x16x32_bf16 v[72:75], v[252:255], v[28:31], v[72:75]
    ds_read_b128 v[28:31], v4 offset:35840
    s_waitcnt lgkmcnt(3)
    v_mfma_f32_16x16x32_bf16 v[76:79], v[96:99], v[16:19], 0
    v_mfma_f32_16x16x32_bf16 v[80:83], v[100:103], v[16:19], 0
    s_sub_u32 s6, s71, 1
    s_and_b32 s6, s6, 3
    s_mul_i32 s7, s6, 5120
    v_mfma_f32_16x16x32_bf16 v[84:87], v[104:107], v[16:19], 0
    s_add_u32 s7, s7, s67
    s_cmp_eq_u32 s6, 3
    s_cselect_b32 s7, 155648, s7
    v_mfma_f32_16x16x32_bf16 v[88:91], v[108:111], v[16:19], 0
    v_add_u32 v12, s7, v52
    v_mfma_f32_16x16x32_bf16 v[92:95], v[112:115], v[16:19], 0
    v_add_u32 v5, s67, v45
    ds_read_b128 v[16:19], v4 offset:36864
    s_waitcnt lgkmcnt(3)
    v_mfma_f32_16x16x32_bf16 v[76:79], v[116:119], v[20:23], v[76:79]
    ds_write_b128 v5, v[60:63] offset:0
    v_add_u32 v5, s67, v46
    v_mfma_f32_16x16x32_bf16 v[80:83], v[120:123], v[20:23], v[80:83]
    v_mfma_f32_16x16x32_bf16 v[84:87], v[124:127], v[20:23], v[84:87]
    v_mfma_f32_16x16x32_bf16 v[88:91], v[128:131], v[20:23], v[88:91]
    v_mfma_f32_16x16x32_bf16 v[92:95], v[132:135], v[20:23], v[92:95]
    ds_read_b128 v[20:23], v4 offset:37888
    s_waitcnt lgkmcnt(4)
    v_mfma_f32_16x16x32_bf16 v[76:79], v[136:139], v[24:27], v[76:79]
    ds_write_b128 v5, v[64:67] offset:5120
    v_add_u32 v5, s67, v47
    v_mfma_f32_16x16x32_bf16 v[80:83], v[140:143], v[24:27], v[80:83]
    v_mfma_f32_16x16x32_bf16 v[84:87], v[144:147], v[24:27], v[84:87]
    v_mfma_f32_16x16x32_bf16 v[88:91], v[148:151], v[24:27], v[88:91]
    v_mfma_f32_16x16x32_bf16 v[92:95], v[152:155], v[24:27], v[92:95]
    ds_read_b128 v[24:27], v4 offset:38912
    s_cmp_ge_u32 s3, 4
    s_cbranch_scc1 L_o1a
    v_and_b32 v3, 1, v1
    v_lshlrev_b32 v3, 12, v3
    v_and_b32 v2, 2, v1
    v_lshl_add_u32 v3, v2, 8, v3
    s_lshr_b32 s72, s61, 2
    s_lshl_b32 s72, s72, 6
    s_andn2_b32 s6, s4, 7
    s_add_u32 s72, s72, s6
    s_add_u32 s72, s72, s76
    s_lshl_b32 s72, s72, 7
    s_add_u32 s72, s72, 3932160
    buffer_load_dword v50, v3, s[8:11], s72 offen sc1
L_o1a:
    s_waitcnt lgkmcnt(5)
    v_mfma_f32_16x16x32_bf16 v[76:79], v[156:159], v[28:31], v[76:79]
    ds_write_b128 v5, v[68:71] offset:10240
    v_add_u32 v5, s67, v52
    v_mfma_f32_16x16x32_bf16 v[80:83], v[160:163], v[28:31], v[80:83]
    v_mfma_f32_16x16x32_bf16 v[84:87], v[164:167], v[28:31], v[84:87]
    v_mfma_f32_16x16x32_bf16 v[88:91], v[168:171], v[28:31], v[88:91]
    v_mfma_f32_16x16x32_bf16 v[92:95], v[172:175], v[28:31], v[92:95]
    ds_read_b128 v[28:31], v4 offset:39936
    s_waitcnt lgkmcnt(6)
    v_mfma_f32_16x16x32_bf16 v[76:79], v[176:179], v[16:19], v[76:79]
    ds_write_b128 v12, v[72:75] offset:0
    v_mfma_f32_16x16x32_bf16 v[80:83], v[180:183], v[16:19], v[80:83]
    v_mfma_f32_16x16x32_bf16 v[84:87], v[184:187], v[16:19], v[84:87]
    v_mfma_f32_16x16x32_bf16 v[88:91], v[188:191], v[16:19], v[88:91]
    v_mfma_f32_16x16x32_bf16 v[92:95], v[192:195], v[16:19], v[92:95]
    s_waitcnt lgkmcnt(5)
    v_mfma_f32_16x16x32_bf16 v[76:79], v[196:199], v[20:23], v[76:79]
    v_mfma_f32_16x16x32_bf16 v[80:83], v[200:203], v[20:23], v[80:83]
    v_mfma_f32_16x16x32_bf16 v[84:87], v[204:207], v[20:23], v[84:87]
    v_mfma_f32_16x16x32_bf16 v[88:91], v[208:211], v[20:23], v[88:91]
    v_mfma_f32_16x16x32_bf16 v[92:95], v[212:215], v[20:23], v[92:95]
    s_waitcnt vmcnt(0)
    s_cmp_ge_u32 s3, 4
    s_cbranch_scc1 L_o1
    v_cmp_ne_u32 vcc, 1, v50
    s_cbranch_vccz L_o1
    s_mov_b32 s79, 262144
L_poll_55:
    buffer_load_dword v2, v3, s[8:11], s72 offen sc1
    s_waitcnt vmcnt(0)
    v_cmp_ne_u32 vcc, 1, v2
    s_cbranch_vccz L_polldone_56
    s_sleep 1
    s_sub_u32 s79, s79, 1
    s_cmp_lg_u32 s79, 0
    s_cbranch_scc1 L_poll_55
L_polldone_56:
L_o1:
    s_waitcnt lgkmcnt(0)
    s_barrier
    ds_read_b128 v[32:35], v6 offset:0
    ds_read_b128 v[36:39], v6 offset:5120
    ds_read_b128 v[40:43], v6 offset:10240
    ds_read_b128 v[16:19], v7 offset:0
    ds_read_b128 v[20:23], v7 offset:1024
    s_add_u32 s65, s61, 1
    s_and_b32 s65, s65, 3
    s_andn2_b32 s7, s61, 3
    s_add_u32 s65, s65, s7
    s_lshl_b32 s65, s65, 17
    s_add_u32 s65, s65, s66
    s_add_u32 m0, s99, 0
    s_add_u32 s65, s65, 0
    buffer_load_dwordx4 v13, s[8:11], s65 offen offset:0 sc1 lds
    buffer_load_dwordx4 v13, s[8:11], s65 offen offset:1024 sc1 lds
    buffer_load_dwordx4 v13, s[8:11], s65 offen offset:2048 sc1 lds
    buffer_load_dwordx4 v13, s[8:11], s65 offen offset:3072 sc1 lds
    v_mfma_f32_16x16x32_bf16 v[76:79], v[216:219], v[24:27], v[76:79]
    s_add_u32 s65, s61, 2
    s_and_b32 s65, s65, 3
    s_andn2_b32 s7, s61, 3
    s_add_u32 s65, s65, s7
    s_lshl_b32 s65, s65, 17
    s_add_u32 s65, s65, s66
    s_add_u32 m0, s99, 32768
    s_add_u32 s65, s65, 0
    buffer_load_dwordx4 v13, s[8:11], s65 offen offset:0 sc1 lds
    v_mfma_f32_16x16x32_bf16 v[80:83], v[220:223], v[24:27], v[80:83]
    buffer_load_dwordx4 v13, s[8:11], s65 offen offset:1024 sc1 lds
    s_waitcnt lgkmcnt(2)
    v_mfma_f32_16x16x32_bf16 v[84:87], v[224:227], v[24:27], v[84:87]
    v_add_f32 v56, v56, v32
    v_add_f32 v57, v57, v33
    v_add_f32 v58, v58, v34
    v_add_f32 v59, v59, v35
    v_mfma_f32_16x16x32_bf16 v[88:91], v[228:231], v[24:27], v[88:91]
    v_add_f32 v56, v56, v36
    v_add_f32 v57, v57, v37
    v_add_f32 v58, v58, v38
    v_add_f32 v59, v59, v39
    v_mfma_f32_16x16x32_bf16 v[92:95], v[232:235], v[24:27], v[92:95]
    v_add_f32 v56, v56, v40
    v_add_f32 v57, v57, v41
    v_add_f32 v58, v58, v42
    v_add_f32 v59, v59, v43
    ds_read_b128 v[32:35], v5 offset:0
    ds_read_b128 v[36:39], v5 offset:5120
    ds_read_b128 v[40:43], v5 offset:10240
    ds_read_b128 v[24:27], v7 offset:2048
    v_mfma_f32_16x16x32_bf16 v[76:79], v[236:239], v[28:31], v[76:79]
    buffer_load_dwordx4 v13, s[8:11], s65 offen offset:2048 sc1 lds
    s_add_u32 s6, s96, 0
    v_mfma_f32_16x16x32_bf16 v[80:83], v[240:243], v[28:31], v[80:83]
    buffer_load_dwordx4 v13, s[8:11], s65 offen offset:3072 sc1 lds
    s_waitcnt lgkmcnt(1)
    v_mfma_f32_16x16x32_bf16 v[84:87], v[244:247], v[28:31], v[84:87]
    v_add_f32 v72, v72, v32
    v_add_f32 v73, v73, v33
    v_add_f32 v74, v74, v34
    v_add_f32 v75, v75, v35
    v_mfma_f32_16x16x32_bf16 v[88:91], v[248:251], v[28:31], v[88:91]
    v_add_f32 v72, v72, v36
    v_add_f32 v73, v73, v37
    v_add_f32 v74, v74, v38
    v_add_f32 v75, v75, v39
    v_mfma_f32_16x16x32_bf16 v[92:95], v[252:255], v[28:31], v[92:95]
    v_add_f32 v72, v72, v40
    v_add_f32 v73, v73, v41
    v_add_f32 v74, v74, v42
    v_add_f32 v75, v75, v43
    buffer_store_dwordx4 v[56:59], v44, s[8:11], s6 offen sc1
    s_cmp_lg_u32 s71, 0
    s_cbranch_scc1 L_nost_57
    buffer_store_dwordx4 v[72:75], v52, s[8:11], s6 offen sc1
L_nost_57:
    s_nop 0
    ds_read_b128 v[28:31], v7 offset:3072
    v_mfma_f32_16x16x32_bf16 v[56:59], v[96:99], v[16:19], 0
    v_mfma_f32_16x16x32_bf16 v[60:63], v[100:103], v[16:19], 0
    s_sub_u32 s6, s71, 2
    s_and_b32 s6, s6, 3
    s_mul_i32 s7, s6, 5120
    v_mfma_f32_16x16x32_bf16 v[64:67], v[104:107], v[16:19], 0
    s_add_u32 s7, s7, s67
    s_cmp_eq_u32 s6, 3
    s_cselect_b32 s7, 124928, s7
    v_mfma_f32_16x16x32_bf16 v[68:71], v[108:111], v[16:19], 0
    v_add_u32 v12, s7, v52
    v_mfma_f32_16x16x32_bf16 v[72:75], v[112:115], v[16:19], 0
    v_add_u32 v5, s67, v45
    ds_read_b128 v[16:19], v7 offset:4096
    v_mfma_f32_16x16x32_bf16 v[56:59], v[116:119], v[20:23], v[56:59]
    ds_write_b128 v5, v[80:83] offset:30720
    v_add_u32 v5, s67, v46
    v_mfma_f32_16x16x32_bf16 v[60:63], v[120:123], v[20:23], v[60:63]
    v_mfma_f32_16x16x32_bf16 v[64:67], v[124:127], v[20:23], v[64:67]
    v_mfma_f32_16x16x32_bf16 v[68:71], v[128:131], v[20:23], v[68:71]
    v_mfma_f32_16x16x32_bf16 v[72:75], v[132:135], v[20:23], v[72:75]
    ds_read_b128 v[20:23], v7 offset:5120
    s_waitcnt lgkmcnt(4)
    v_mfma_f32_16x16x32_bf16 v[56:59], v[136:139], v[24:27], v[56:59]
    ds_write_b128 v5, v[84:87] offset:35840
    v_add_u32 v5, s67, v47
    v_mfma_f32_16x16x32_bf16 v[60:63], v[140:143], v[24:27], v[60:63]
    v_mfma_f32_16x16x32_bf16 v[64:67], v[144:147], v[24:27], v[64:67]
    v_mfma_f32_16x16x32_bf16 v[68:71], v[148:151], v[24:27], v[68:71]
    v_mfma_f32_16x16x32_bf16 v[72:75], v[152:155], v[24:27], v[72:75]
    ds_read_b128 v[24:27], v7 offset:6144
    s_waitcnt lgkmcnt(5)
    v_mfma_f32_16x16x32_bf16 v[56:59], v[156:159], v[28:31], v[56:59]
    ds_write_b128 v5, v[88:91] offset:40960
    v_add_u32 v5, s67, v52
    v_mfma_f32_16x16x32_bf16 v[60:63], v[160:163], v[28:31], v[60:63]
    v_mfma_f32_16x16x32_bf16 v[64:67], v[164:167], v[28:31], v[64:67]
    v_mfma_f32_16x16x32_bf16 v[68:71], v[168:171], v[28:31], v[68:71]
    v_mfma_f32_16x16x32_bf16 v[72:75], v[172:175], v[28:31], v[72:75]
    ds_read_b128 v[28:31], v7 offset:7168
    s_waitcnt lgkmcnt(6)
    v_mfma_f32_16x16x32_bf16 v[56:59], v[176:179], v[16:19], v[56:59]
    ds_write_b128 v12, v[92:95] offset:30720
    v_mfma_f32_16x16x32_bf16 v[60:63], v[180:183], v[16:19], v[60:63]
    v_mfma_f32_16x16x32_bf16 v[64:67], v[184:187], v[16:19], v[64:67]
    v_mfma_f32_16x16x32_bf16 v[68:71], v[188:191], v[16:19], v[68:71]
    v_mfma_f32_16x16x32_bf16 v[72:75], v[192:195], v[16:19], v[72:75]
    s_waitcnt lgkmcnt(5)
    v_mfma_f32_16x16x32_bf16 v[56:59], v[196:199], v[20:23], v[56:59]
    v_mfma_f32_16x16x32_bf16 v[60:63], v[200:203], v[20:23], v[60:63]
    v_mfma_f32_16x16x32_bf16 v[64:67], v[204:207], v[20:23], v[64:67]
    v_mfma_f32_16x16x32_bf16 v[68:71], v[208:211], v[20:23], v[68:71]
    v_mfma_f32_16x16x32_bf16 v[72:75], v[212:215], v[20:23], v[72:75]
    s_waitcnt vmcnt(5)
    s_waitcnt lgkmcnt(0)
    s_barrier
    ds_read_b128 v[32:35], v6 offset:30720
    ds_read_b128 v[36:39], v6 offset:35840
    ds_read_b128 v[40:43], v6 offset:40960
    ds_read_b128 v[16:19], v4 offset:0
    ds_read_b128 v[20:23], v4 offset:1024
    v_mfma_f32_16x16x32_bf16 v[56:59], v[216:219], v[24:27], v[56:59]
    s_add_u32 s65, s61, 3
    s_and_b32 s65, s65, 3
    s_andn2_b32 s7, s61, 3
    s_add_u32 s65, s65, s7
    s_lshl_b32 s65, s65, 17
    s_add_u32 s65, s65, s66
    s_add_u32 m0, s99, 65536
    s_add_u32 s65, s65, 0
    buffer_load_dwordx4 v13, s[8:11], s65 offen offset:0 sc1 lds
    v_mfma_f32_16x16x32_bf16 v[60:63], v[220:223], v[24:27], v[60:63]
    buffer_load_dwordx4 v13, s[8:11], s65 offen offset:1024 sc1 lds
    s_waitcnt lgkmcnt(2)
    v_mfma_f32_16x16x32_bf16 v[64:67], v[224:227], v[24:27], v[64:67]
    v_add_f32 v76, v76, v32
    v_add_f32 v77, v77, v33
    v_add_f32 v78, v78, v34
    v_add_f32 v79, v79, v35
    v_mfma_f32_16x16x32_bf16 v[68:71], v[228:231], v[24:27], v[68:71]
    v_add_f32 v76, v76, v36
    v_add_f32 v77, v77, v37
    v_add_f32 v78, v78, v38
    v_add_f32 v79, v79, v39
    v_mfma_f32_16x16x32_bf16 v[72:75], v[232:235], v[24:27], v[72:75]
    v_add_f32 v76, v76, v40
    v_add_f32 v77, v77, v41
    v_add_f32 v78, v78, v42
    v_add_f32 v79, v79, v43
    ds_read_b128 v[32:35], v5 offset:30720
    ds_read_b128 v[36:39], v5 offset:35840
    ds_read_b128 v[40:43], v5 offset:40960
    ds_read_b128 v[24:27], v4 offset:2048
    v_mfma_f32_16x16x32_bf16 v[56:59], v[236:239], v[28:31], v[56:59]
    buffer_load_dwordx4 v13, s[8:11], s65 offen offset:2048 sc1 lds
    s_add_u32 s6, s97, 0
    v_mfma_f32_16x16x32_bf16 v[60:63], v[240:243], v[28:31], v[60:63]
    buffer_load_dwordx4 v13, s[8:11], s65 offen offset:3072 sc1 lds
    s_waitcnt lgkmcnt(1)
    v_mfma_f32_16x16x32_bf16 v[64:67], v[244:247], v[28:31], v[64:67]
    v_add_f32 v92, v92, v32
    v_add_f32 v93, v93, v33
    v_add_f32 v94, v94, v34
    v_add_f32 v95, v95, v35
    v_mfma_f32_16x16x32_bf16 v[68:71], v[248:251], v[28:31], v[68:71]
    v_add_f32 v92, v92, v36
    v_add_f32 v93, v93, v37
    v_add_f32 v94, v94, v38
    v_add_f32 v95, v95, v39
    v_mfma_f32_16x16x32_bf16 v[72:75], v[252:255], v[28:31], v[72:75]
    v_add_f32 v92, v92, v40
    v_add_f32 v93, v93, v41
    v_add_f32 v94, v94, v42
    v_add_f32 v95, v95, v43
    buffer_store_dwordx4 v[76:79], v44, s[8:11], s6 offen sc1
    s_cmp_lg_u32 s71, 1
    s_cbranch_scc1 L_nost_58
    buffer_store_dwordx4 v[92:95], v52, s[8:11], s6 offen sc1
L_nost_58:
    s_nop 0
    ds_read_b128 v[28:31], v4 offset:3072
    v_mfma_f32_16x16x32_bf16 v[76:79], v[96:99], v[16:19], 0
    v_mfma_f32_16x16x32_bf16 v[80:83], v[100:103], v[16:19], 0
    s_sub_u32 s6, s71, 3
    s_and_b32 s6, s6, 3
    s_mul_i32 s7, s6, 5120
    v_mfma_f32_16x16x32_bf16 v[84:87], v[104:107], v[16:19], 0
    s_add_u32 s7, s7, s67
    s_cmp_eq_u32 s6, 3
    s_cselect_b32 s7, 155648, s7
    v_mfma_f32_16x16x32_bf16 v[88:91], v[108:111], v[16:19], 0
    v_add_u32 v12, s7, v52
    v_mfma_f32_16x16x32_bf16 v[92:95], v[112:115], v[16:19], 0
    v_add_u32 v5, s67, v45
    ds_read_b128 v[16:19], v4 offset:4096
    v_mfma_f32_16x16x32_bf16 v[76:79], v[116:119], v[20:23], v[76:79]
    ds_write_b128 v5, v[60:63] offset:0
    v_add_u32 v5, s67, v46
    v_mfma_f32_16x16x32_bf16 v[80:83], v[120:123], v[20:23], v[80:83]
    v_mfma_f32_16x16x32_bf16 v[84:87], v[124:127], v[20:23], v[84:87]
    v_mfma_f32_16x16x32_bf16 v[88:91], v[128:131], v[20:23], v[88:91]
    v_mfma_f32_16x16x32_bf16 v[92:95], v[132:135], v[20:23], v[92:95]
    ds_read_b128 v[20:23], v4 offset:5120
    s_waitcnt lgkmcnt(4)
    v_mfma_f32_16x16x32_bf16 v[76:79], v[136:139], v[24:27], v[76:79]
    ds_write_b128 v5, v[64:67] offset:5120
    v_add_u32 v5, s67, v47
    v_mfma_f32_16x16x32_bf16 v[80:83], v[140:143], v[24:27], v[80:83]
    v_mfma_f32_16x16x32_bf16 v[84:87], v[144:147], v[24:27], v[84:87]
    v_mfma_f32_16x16x32_bf16 v[88:91], v[148:151], v[24:27], v[88:91]
    v_mfma_f32_16x16x32_bf16 v[92:95], v[152:155], v[24:27], v[92:95]
    ds_read_b128 v[24:27], v4 offset:6144
    s_waitcnt lgkmcnt(5)
    v_mfma_f32_16x16x32_bf16 v[76:79], v[156:159], v[28:31], v[76:79]
    ds_write_b128 v5, v[68:71] offset:10240
    v_add_u32 v5, s67, v52
    v_mfma_f32_16x16x32_bf16 v[80:83], v[160:163], v[28:31], v[80:83]
    v_mfma_f32_16x16x32_bf16 v[84:87], v[164:167], v[28:31], v[84:87]
    v_mfma_f32_16x16x32_bf16 v[88:91], v[168:171], v[28:31], v[88:91]
    v_mfma_f32_16x16x32_bf16 v[92:95], v[172:175], v[28:31], v[92:95]
    ds_read_b128 v[28:31], v4 offset:7168
    s_waitcnt lgkmcnt(6)
    v_mfma_f32_16x16x32_bf16 v[76:79], v[176:179], v[16:19], v[76:79]
    ds_write_b128 v12, v[72:75] offset:0
    v_mfma_f32_16x16x32_bf16 v[80:83], v[180:183], v[16:19], v[80:83]
    v_mfma_f32_16x16x32_bf16 v[84:87], v[184:187], v[16:19], v[84:87]
    v_mfma_f32_16x16x32_bf16 v[88:91], v[188:191], v[16:19], v[88:91]
    v_mfma_f32_16x16x32_bf16 v[92:95], v[192:195], v[16:19], v[92:95]
    s_waitcnt lgkmcnt(5)
    v_mfma_f32_16x16x32_bf16 v[76:79], v[196:199], v[20:23], v[76:79]
    v_mfma_f32_16x16x32_bf16 v[80:83], v[200:203], v[20:23], v[80:83]
    v_mfma_f32_16x16x32_bf16 v[84:87], v[204:207], v[20:23], v[84:87]
    v_mfma_f32_16x16x32_bf16 v[88:91], v[208:211], v[20:23], v[88:91]
    v_mfma_f32_16x16x32_bf16 v[92:95], v[212:215], v[20:23], v[92:95]
    s_waitcnt vmcnt(5)
    s_waitcnt lgkmcnt(0)
    s_barrier
    ds_read_b128 v[32:35], v6 offset:0
    ds_read_b128 v[36:39], v6 offset:5120
    ds_read_b128 v[40:43], v6 offset:10240
    ds_read_b128 v[16:19], v4 offset:32768
    ds_read_b128 v[20:23], v4 offset:33792
    v_mfma_f32_16x16x32_bf16 v[76:79], v[216:219], v[24:27], v[76:79]
    s_add_u32 s65, s68, 0
    s_and_b32 s65, s65, 3
    s_andn2_b32 s7, s68, 3
    s_add_u32 s65, s65, s7
    s_lshl_b32 s65, s65, 17
    s_add_u32 s65, s65, s66
    s_add_u32 m0, s99, 0
    s_add_u32 s65, s65, 0
    buffer_load_dwordx4 v13, s[8:11], s65 offen offset:0 sc1 lds
    v_mfma_f32_16x16x32_bf16 v[80:83], v[220:223], v[24:27], v[80:83]
    buffer_load_dwordx4 v13, s[8:11], s65 offen offset:1024 sc1 lds
    s_waitcnt lgkmcnt(2)
    v_mfma_f32_16x16x32_bf16 v[84:87], v[224:227], v[24:27], v[84:87]
    v_add_f32 v56, v56, v32
    v_add_f32 v57, v57, v33
    v_add_f32 v58, v58, v34
    v_add_f32 v59, v59, v35
    v_mfma_f32_16x16x32_bf16 v[88:91], v[228:231], v[24:27], v[88:91]
    v_add_f32 v56, v56, v36
    v_add_f32 v57, v57, v37
    v_add_f32 v58, v58, v38
    v_add_f32 v59, v59, v39
    v_mfma_f32_16x16x32_bf16 v[92:95], v[232:235], v[24:27], v[92:95]
    v_add_f32 v56, v56, v40
    v_add_f32 v57, v57, v41
    v_add_f32 v58, v58, v42
    v_add_f32 v59, v59, v43
    ds_read_b128 v[32:35], v5 offset:0
    ds_read_b128 v[36:39], v5 offset:5120
    ds_read_b128 v[40:43], v5 offset:10240
    ds_read_b128 v[24:27], v4 offset:34816
    v_mfma_f32_16x16x32_bf16 v[76:79], v[236:239], v[28:31], v[76:79]
    buffer_load_dwordx4 v13, s[8:11], s65 offen offset:2048 sc1 lds
    s_add_u32 s6, s98, 0
    v_mfma_f32_16x16x32_bf16 v[80:83], v[240:243], v[28:31], v[80:83]
    buffer_load_dwordx4 v13, s[8:11], s65 offen offset:3072 sc1 lds
    s_waitcnt lgkmcnt(1)
    v_mfma_f32_16x16x32_bf16 v[84:87], v[244:247], v[28:31], v[84:87]
    v_add_f32 v72, v72, v32
    v_add_f32 v73, v73, v33
    v_add_f32 v74, v74, v34
    v_add_f32 v75, v75, v35
    v_mfma_f32_16x16x32_bf16 v[88:91], v[248:251], v[28:31], v[88:91]
    v_add_f32 v72, v72, v36
    v_add_f32 v73, v73, v37
    v_add_f32 v74, v74, v38
    v_add_f32 v75, v75, v39
    v_mfma_f32_16x16x32_bf16 v[92:95], v[252:255], v[28:31], v[92:95]
    v_add_f32 v72, v72, v40
    v_add_f32 v73, v73, v41
    v_add_f32 v74, v74, v42
    v_add_f32 v75, v75, v43
    buffer_store_dwordx4 v[56:59], v44, s[8:11], s6 offen sc1
    s_cmp_lg_u32 s71, 2
    s_cbranch_scc1 L_nost_59
    buffer_store_dwordx4 v[72:75], v52, s[8:11], s6 offen sc1
L_nost_59:
    s_nop 0
    ds_read_b128 v[28:31], v4 offset:35840
    v_mfma_f32_16x16x32_bf16 v[56:59], v[96:99], v[16:19], 0
    v_mfma_f32_16x16x32_bf16 v[60:63], v[100:103], v[16:19], 0
    s_sub_u32 s6, s71, 4
    s_and_b32 s6, s6, 3
    s_mul_i32 s7, s6, 5120
    v_mfma_f32_16x16x32_bf16 v[64:67], v[104:107], v[16:19], 0
    s_add_u32 s7, s7, s67
    s_cmp_eq_u32 s6, 3
    s_cselect_b32 s7, 124928, s7
    v_mfma_f32_16x16x32_bf16 v[68:71], v[108:111], v[16:19], 0
    v_add_u32 v12, s7, v52
    v_mfma_f32_16x16x32_bf16 v[72:75], v[112:115], v[16:19], 0
    v_add_u32 v5, s67, v45
    ds_read_b128 v[16:19], v4 offset:36864
    v_mfma_f32_16x16x32_bf16 v[56:59], v[116:119], v[20:23], v[56:59]
    ds_write_b128 v5, v[80:83] offset:30720
    v_add_u32 v5, s67, v46
    v_mfma_f32_16x16x32_bf16 v[60:63], v[120:123], v[20:23], v[60:63]
    v_mfma_f32_16x16x32_bf16 v[64:67], v[124:127], v[20:23], v[64:67]
    v_mfma_f32_16x16x32_bf16 v[68:71], v[128:131], v[20:23], v[68:71]
    v_mfma_f32_16x16x32_bf16 v[72:75], v[132:135], v[20:23], v[72:75]
    ds_read_b128 v[20:23], v4 offset:37888
    s_waitcnt lgkmcnt(4)
    v_mfma_f32_16x16x32_bf16 v[56:59], v[136:139], v[24:27], v[56:59]
    ds_write_b128 v5, v[84:87] offset:35840
    v_add_u32 v5, s67, v47
    v_mfma_f32_16x16x32_bf16 v[60:63], v[140:143], v[24:27], v[60:63]
    v_mfma_f32_16x16x32_bf16 v[64:67], v[144:147], v[24:27], v[64:67]
    v_mfma_f32_16x16x32_bf16 v[68:71], v[148:151], v[24:27], v[68:71]
    v_mfma_f32_16x16x32_bf16 v[72:75], v[152:155], v[24:27], v[72:75]
    ds_read_b128 v[24:27], v4 offset:38912
    s_waitcnt lgkmcnt(5)
    v_mfma_f32_16x16x32_bf16 v[56:59], v[156:159], v[28:31], v[56:59]
    ds_write_b128 v5, v[88:91] offset:40960
    v_add_u32 v5, s67, v52
    v_mfma_f32_16x16x32_bf16 v[60:63], v[160:163], v[28:31], v[60:63]
    v_mfma_f32_16x16x32_bf16 v[64:67], v[164:167], v[28:31], v[64:67]
    v_mfma_f32_16x16x32_bf16 v[68:71], v[168:171], v[28:31], v[68:71]
    v_mfma_f32_16x16x32_bf16 v[72:75], v[172:175], v[28:31], v[72:75]
    ds_read_b128 v[28:31], v4 offset:39936
    s_waitcnt lgkmcnt(6)
    v_mfma_f32_16x16x32_bf16 v[56:59], v[176:179], v[16:19], v[56:59]
    ds_write_b128 v12, v[92:95] offset:30720
    v_mfma_f32_16x16x32_bf16 v[60:63], v[180:183], v[16:19], v[60:63]
    v_mfma_f32_16x16x32_bf16 v[64:67], v[184:187], v[16:19], v[64:67]
    v_mfma_f32_16x16x32_bf16 v[68:71], v[188:191], v[16:19], v[68:71]
    v_mfma_f32_16x16x32_bf16 v[72:75], v[192:195], v[16:19], v[72:75]
    s_waitcnt lgkmcnt(5)
    v_mfma_f32_16x16x32_bf16 v[56:59], v[196:199], v[20:23], v[56:59]
    v_mfma_f32_16x16x32_bf16 v[60:63], v[200:203], v[20:23], v[60:63]
    v_mfma_f32_16x16x32_bf16 v[64:67], v[204:207], v[20:23], v[64:67]
    v_mfma_f32_16x16x32_bf16 v[68:71], v[208:211], v[20:23], v[68:71]
    v_mfma_f32_16x16x32_bf16 v[72:75], v[212:215], v[20:23], v[72:75]
    s_waitcnt vmcnt(5)
    s_waitcnt lgkmcnt(0)
    s_barrier
    ds_read_b128 v[32:35], v6 offset:30720
    ds_read_b128 v[36:39], v6 offset:35840
    ds_read_b128 v[40:43], v6 offset:40960
    ds_read_b128 v[16:19], v7 offset:0
    ds_read_b128 v[20:23], v7 offset:1024
    v_mfma_f32_16x16x32_bf16 v[56:59], v[216:219], v[24:27], v[56:59]
    s_add_u32 s65, s61, 0
    s_and_b32 s65, s65, 3
    s_andn2_b32 s7, s61, 3
    s_add_u32 s65, s65, s7
    s_lshl_b32 s65, s65, 17
    s_add_u32 s65, s65, s66
    s_add_u32 m0, s99, 32768
    s_add_u32 s65, s65, 0
    buffer_load_dwordx4 v13, s[8:11], s65 offen offset:0 sc1 lds
    v_mfma_f32_16x16x32_bf16 v[60:63], v[220:223], v[24:27], v[60:63]
    buffer_load_dwordx4 v13, s[8:11], s65 offen offset:1024 sc1 lds
    s_waitcnt lgkmcnt(2)
    v_mfma_f32_16x16x32_bf16 v[64:67], v[224:227], v[24:27], v[64:67]
    v_add_f32 v76, v76, v32
    v_add_f32 v77, v77, v33
    v_add_f32 v78, v78, v34
    v_add_f32 v79, v79, v35
    v_mfma_f32_16x16x32_bf16 v[68:71], v[228:231], v[24:27], v[68:71]
    v_add_f32 v76, v76, v36
    v_add_f32 v77, v77, v37
    v_add_f32 v78, v78, v38
    v_add_f32 v79, v79, v39
    v_mfma_f32_16x16x32_bf16 v[72:75], v[232:235], v[24:27], v[72:75]
    v_add_f32 v76, v76, v40
    v_add_f32 v77, v77, v41
    v_add_f32 v78, v78, v42
    v_add_f32 v79, v79, v43
    ds_read_b128 v[32:35], v5 offset:30720
    ds_read_b128 v[36:39], v5 offset:35840
    ds_read_b128 v[40:43], v5 offset:40960
    ds_read_b128 v[24:27], v7 offset:2048
    v_mfma_f32_16x16x32_bf16 v[56:59], v[236:239], v[28:31], v[56:59]
    buffer_load_dwordx4 v13, s[8:11], s65 offen offset:2048 sc1 lds
    s_add_u32 s6, s96, 10240
    v_mfma_f32_16x16x32_bf16 v[60:63], v[240:243], v[28:31], v[60:63]
    buffer_load_dwordx4 v13, s[8:11], s65 offen offset:3072 sc1 lds
    s_waitcnt lgkmcnt(1)
    v_mfma_f32_16x16x32_bf16 v[64:67], v[244:247], v[28:31], v[64:67]
    v_add_f32 v92, v92, v32
    v_add_f32 v93, v93, v33
    v_add_f32 v94, v94, v34
    v_add_f32 v95, v95, v35
    v_mfma_f32_16x16x32_bf16 v[68:71], v[248:251], v[28:31], v[68:71]
    v_add_f32 v92, v92, v36
    v_add_f32 v93, v93, v37
    v_add_f32 v94, v94, v38
    v_add_f32 v95, v95, v39
    v_mfma_f32_16x16x32_bf16 v[72:75], v[252:255], v[28:31], v[72:75]
    v_add_f32 v92, v92, v40
    v_add_f32 v93, v93, v41
    v_add_f32 v94, v94, v42
    v_add_f32 v95, v95, v43
    buffer_store_dwordx4 v[76:79], v44, s[8:11], s6 offen sc1
    s_cmp_lg_u32 s71, 3
    s_cbranch_scc1 L_nost_60
    buffer_store_dwordx4 v[92:95], v52, s[8:11], s6 offen sc1
L_nost_60:
    s_nop 0
    ds_read_b128 v[28:31], v7 offset:3072
    v_mfma_f32_16x16x32_bf16 v[76:79], v[96:99], v[16:19], 0
    v_mfma_f32_16x16x32_bf16 v[80:83], v[100:103], v[16:19], 0
    s_sub_u32 s6, s71, 5
    s_and_b32 s6, s6, 3
    s_mul_i32 s7, s6, 5120
    v_mfma_f32_16x16x32_bf16 v[84:87], v[104:107], v[16:19], 0
    s_add_u32 s7, s7, s67
    s_cmp_eq_u32 s6, 3
    s_cselect_b32 s7, 155648, s7
    v_mfma_f32_16x16x32_bf16 v[88:91], v[108:111], v[16:19], 0
    v_add_u32 v12, s7, v52
    v_mfma_f32_16x16x32_bf16 v[92:95], v[112:115], v[16:19], 0
    v_add_u32 v5, s67, v45
    ds_read_b128 v[16:19], v7 offset:4096
    v_mfma_f32_16x16x32_bf16 v[76:79], v[116:119], v[20:23], v[76:79]
    ds_write_b128 v5, v[60:63] offset:0
    v_add_u32 v5, s67, v46
    v_mfma_f32_16x16x32_bf16 v[80:83], v[120:123], v[20:23], v[80:83]
    v_mfma_f32_16x16x32_bf16 v[84:87], v[124:127], v[20:23], v[84:87]
    v_mfma_f32_16x16x32_bf16 v[88:91], v[128:131], v[20:23], v[88:91]
    v_mfma_f32_16x16x32_bf16 v[92:95], v[132:135], v[20:23], v[92:95]
    ds_read_b128 v[20:23], v7 offset:5120
    s_waitcnt lgkmcnt(4)
    v_mfma_f32_16x16x32_bf16 v[76:79], v[136:139], v[24:27], v[76:79]
    ds_write_b128 v5, v[64:67] offset:5120
    v_add_u32 v5, s67, v47
    v_mfma_f32_16x16x32_bf16 v[80:83], v[140:143], v[24:27], v[80:83]
    v_mfma_f32_16x16x32_bf16 v[84:87], v[144:147], v[24:27], v[84:87]
    v_mfma_f32_16x16x32_bf16 v[88:91], v[148:151], v[24:27], v[88:91]
    v_mfma_f32_16x16x32_bf16 v[92:95], v[152:155], v[24:27], v[92:95]
    ds_read_b128 v[24:27], v7 offset:6144
    s_waitcnt lgkmcnt(5)
    v_mfma_f32_16x16x32_bf16 v[76:79], v[156:159], v[28:31], v[76:79]
    ds_write_b128 v5, v[68:71] offset:10240
    v_add_u32 v5, s67, v52
    v_mfma_f32_16x16x32_bf16 v[80:83], v[160:163], v[28:31], v[80:83]
    v_mfma_f32_16x16x32_bf16 v[84:87], v[164:167], v[28:31], v[84:87]
    v_mfma_f32_16x16x32_bf16 v[88:91], v[168:171], v[28:31], v[88:91]
    v_mfma_f32_16x16x32_bf16 v[92:95], v[172:175], v[28:31], v[92:95]
    ds_read_b128 v[28:31], v7 offset:7168
    s_waitcnt lgkmcnt(6)
    v_mfma_f32_16x16x32_bf16 v[76:79], v[176:179], v[16:19], v[76:79]
    ds_write_b128 v12, v[72:75] offset:0
    v_mfma_f32_16x16x32_bf16 v[80:83], v[180:183], v[16:19], v[80:83]
    v_mfma_f32_16x16x32_bf16 v[84:87], v[184:187], v[16:19], v[84:87]
    v_mfma_f32_16x16x32_bf16 v[88:91], v[188:191], v[16:19], v[88:91]
    v_mfma_f32_16x16x32_bf16 v[92:95], v[192:195], v[16:19], v[92:95]
    s_waitcnt lgkmcnt(5)
    v_mfma_f32_16x16x32_bf16 v[76:79], v[196:199], v[20:23], v[76:79]
    v_mfma_f32_16x16x32_bf16 v[80:83], v[200:203], v[20:23], v[80:83]
    v_mfma_f32_16x16x32_bf16 v[84:87], v[204:207], v[20:23], v[84:87]
    v_mfma_f32_16x16x32_bf16 v[88:91], v[208:211], v[20:23], v[88:91]
    v_mfma_f32_16x16x32_bf16 v[92:95], v[212:215], v[20:23], v[92:95]
    s_waitcnt vmcnt(5)
    s_waitcnt lgkmcnt(0)
    s_barrier
    ds_read_b128 v[32:35], v6 offset:0
    ds_read_b128 v[36:39], v6 offset:5120
    ds_read_b128 v[40:43], v6 offset:10240
    ds_read_b128 v[16:19], v4 offset:0
    ds_read_b128 v[20:23], v4 offset:1024
    v_mfma_f32_16x16x32_bf16 v[76:79], v[216:219], v[24:27], v[76:79]
    v_mfma_f32_16x16x32_bf16 v[80:83], v[220:223], v[24:27], v[80:83]
    s_waitcnt lgkmcnt(2)
    v_mfma_f32_16x16x32_bf16 v[84:87], v[224:227], v[24:27], v[84:87]
    v_add_f32 v56, v56, v32
    v_add_f32 v57, v57, v33
    v_add_f32 v58, v58, v34
    v_add_f32 v59, v59, v35
    v_mfma_f32_16x16x32_bf16 v[88:91], v[228:231], v[24:27], v[88:91]
    v_add_f32 v56, v56, v36
    v_add_f32 v57, v57, v37
    v_add_f32 v58, v58, v38
    v_add_f32 v59, v59, v39
    v_mfma_f32_16x16x32_bf16 v[92:95], v[232:235], v[24:27], v[92:95]
    v_add_f32 v56, v56, v40
    v_add_f32 v57, v57, v41
    v_add_f32 v58, v58, v42
    v_add_f32 v59, v59, v43
    ds_read_b128 v[32:35], v5 offset:0
    ds_read_b128 v[36:39], v5 offset:5120
    ds_read_b128 v[40:43], v5 offset:10240
    ds_read_b128 v[24:27], v4 offset:2048
    v_mfma_f32_16x16x32_bf16 v[76:79], v[236:239], v[28:31], v[76:79]
    s_add_u32 s6, s97, 10240
    v_mfma_f32_16x16x32_bf16 v[80:83], v[240:243], v[28:31], v[80:83]
    s_waitcnt lgkmcnt(1)
    v_mfma_f32_16x16x32_bf16 v[84:87], v[244:247], v[28:31], v[84:87]
    v_add_f32 v72, v72, v32
    v_add_f32 v73, v73, v33
    v_add_f32 v74, v74, v34
    v_add_f32 v75, v75, v35
    v_mfma_f32_16x16x32_bf16 v[88:91], v[248:251], v[28:31], v[88:91]
    v_add_f32 v72, v72, v36
    v_add_f32 v73, v73, v37
    v_add_f32 v74, v74, v38
    v_add_f32 v75, v75, v39
    v_mfma_f32_16x16x32_bf16 v[92:95], v[252:255], v[28:31], v[92:95]
    v_add_f32 v72, v72, v40
    v_add_f32 v73, v73, v41
    v_add_f32 v74, v74, v42
    v_add_f32 v75, v75, v43
    buffer_store_dwordx4 v[56:59], v44, s[8:11], s6 offen sc1
    s_cmp_lg_u32 s71, 0
    s_cbranch_scc1 L_nost_61
    buffer_store_dwordx4 v[72:75], v52, s[8:11], s6 offen sc1
L_nost_61:
    s_nop 0
    ds_read_b128 v[28:31], v4 offset:3072
    v_mfma_f32_16x16x32_bf16 v[56:59], v[96:99], v[16:19], 0
    v_mfma_f32_16x16x32_bf16 v[60:63], v[100:103], v[16:19], 0
    s_sub_u32 s6, s71, 6
    s_and_b32 s6, s6, 3
    s_mul_i32 s7, s6, 5120
    v_mfma_f32_16x16x32_bf16 v[64:67], v[104:107], v[16:19], 0
    s_add_u32 s7, s7, s67
    s_cmp_eq_u32 s6, 3
    s_cselect_b32 s7, 124928, s7
    v_mfma_f32_16x16x32_bf16 v[68:71], v[108:111], v[16:19], 0
    v_add_u32 v12, s7, v52
    v_mfma_f32_16x16x32_bf16 v[72:75], v[112:115], v[16:19], 0
    v_add_u32 v5, s67, v45
    ds_read_b128 v[16:19], v4 offset:4096
    v_mfma_f32_16x16x32_bf16 v[56:59], v[116:119], v[20:23], v[56:59]
    ds_write_b128 v5, v[80:83] offset:30720
    v_add_u32 v5, s67, v46
    v_mfma_f32_16x16x32_bf16 v[60:63], v[120:123], v[20:23], v[60:63]
    v_mfma_f32_16x16x32_bf16 v[64:67], v[124:127], v[20:23], v[64:67]
    v_mfma_f32_16x16x32_bf16 v[68:71], v[128:131], v[20:23], v[68:71]
    ds_write_b128 v5, v[84:87] offset:35840
    v_add_u32 v5, s67, v47
    v_mfma_f32_16x16x32_bf16 v[72:75], v[132:135], v[20:23], v[72:75]
    ds_read_b128 v[20:23], v4 offset:5120
    s_waitcnt lgkmcnt(5)
    v_mfma_f32_16x16x32_bf16 v[56:59], v[136:139], v[24:27], v[56:59]
    v_mfma_f32_16x16x32_bf16 v[60:63], v[140:143], v[24:27], v[60:63]
    ds_write_b128 v5, v[88:91] offset:40960
    v_add_u32 v5, s67, v52
    v_mfma_f32_16x16x32_bf16 v[64:67], v[144:147], v[24:27], v[64:67]
    v_mfma_f32_16x16x32_bf16 v[68:71], v[148:151], v[24:27], v[68:71]
    v_mfma_f32_16x16x32_bf16 v[72:75], v[152:155], v[24:27], v[72:75]
    ds_write_b128 v12, v[92:95] offset:30720
    ds_read_b128 v[24:27], v4 offset:6144
    s_waitcnt lgkmcnt(7)
    v_mfma_f32_16x16x32_bf16 v[56:59], v[156:159], v[28:31], v[56:59]
    v_mfma_f32_16x16x32_bf16 v[60:63], v[160:163], v[28:31], v[60:63]
    v_mfma_f32_16x16x32_bf16 v[64:67], v[164:167], v[28:31], v[64:67]
    v_mfma_f32_16x16x32_bf16 v[68:71], v[168:171], v[28:31], v[68:71]
    v_mfma_f32_16x16x32_bf16 v[72:75], v[172:175], v[28:31], v[72:75]
    ds_read_b128 v[28:31], v4 offset:7168
    s_waitcnt vmcnt(1)
    v_mov_b32 v3, 0x5000000
    s_and_b32 s6, s4, 7
    s_lshl_b32 s7, s5, 3
    s_add_u32 s6, s6, s7
    s_lshr_b32 s7, s4, 3
    s_add_u32 s7, s7, 0
    s_add_u32 s7, s7, 1
    s_and_b32 s7, s7, 3
    s_lshl_b32 s6, s6, 2
    s_add_u32 s6, s6, s7
    s_mul_i32 s6, s6, 3
    s_add_u32 s6, s6, 0
    s_lshl_b32 s6, s6, 5
    s_add_u32 s6, s6, s3
    s_lshl_b32 s6, s6, 2
    s_add_u32 s6, s6, 15728640
    v_writelane_b32 v3, s6, 0
    v_writelane_b32 v2, 2, 0
    s_and_b32 s6, s4, 7
    s_lshl_b32 s7, s5, 3
    s_add_u32 s6, s6, s7
    s_lshr_b32 s7, s4, 3
    s_add_u32 s7, s7, 1
    s_add_u32 s7, s7, 1
    s_and_b32 s7, s7, 3
    s_lshl_b32 s6, s6, 2
    s_add_u32 s6, s6, s7
    s_mul_i32 s6, s6, 3
    s_add_u32 s6, s6, 1
    s_lshl_b32 s6, s6, 5
    s_add_u32 s6, s6, s3
    s_lshl_b32 s6, s6, 2
    s_add_u32 s6, s6, 15728640
    v_writelane_b32 v3, s6, 1
    v_writelane_b32 v2, 1, 1
    s_and_b32 s6, s4, 7
    s_lshl_b32 s7, s5, 3
    s_add_u32 s6, s6, s7
    s_lshr_b32 s7, s4, 3
    s_add_u32 s7, s7, 2
    s_add_u32 s7, s7, 1
    s_and_b32 s7, s7, 3
    s_lshl_b32 s6, s6, 2
    s_add_u32 s6, s6, s7
    s_mul_i32 s6, s6, 3
    s_add_u32 s6, s6, 2
    s_lshl_b32 s6, s6, 5
    s_add_u32 s6, s6, s3
    s_lshl_b32 s6, s6, 2
    s_add_u32 s6, s6, 15728640
    v_writelane_b32 v3, s6, 2
    v_writelane_b32 v2, 1, 2
    buffer_store_dword v2, v3, s[8:11], 0 offen sc1
    s_waitcnt lgkmcnt(0)
    s_barrier
    ds_read_b128 v[32:35], v6 offset:30720
    ds_read_b128 v[36:39], v6 offset:35840
    ds_read_b128 v[40:43], v6 offset:40960
    v_mfma_f32_16x16x32_bf16 v[56:59], v[176:179], v[16:19], v[56:59]
    v_mfma_f32_16x16x32_bf16 v[60:63], v[180:183], v[16:19], v[60:63]
    s_waitcnt lgkmcnt(0)
    v_mfma_f32_16x16x32_bf16 v[64:67], v[184:187], v[16:19], v[64:67]
    v_add_f32 v76, v76, v32
    v_add_f32 v77, v77, v33
    v_add_f32 v78, v78, v34
    v_add_f32 v79, v79, v35
    v_mfma_f32_16x16x32_bf16 v[68:71], v[188:191], v[16:19], v[68:71]
    v_add_f32 v76, v76, v36
    v_add_f32 v77, v77, v37
    v_add_f32 v78, v78, v38
    v_add_f32 v79, v79, v39
    v_mfma_f32_16x16x32_bf16 v[72:75], v[192:195], v[16:19], v[72:75]
    v_add_f32 v76, v76, v40
    v_add_f32 v77, v77, v41
    v_add_f32 v78, v78, v42
    v_add_f32 v79, v79, v43
    ds_read_b128 v[32:35], v5 offset:30720
    ds_read_b128 v[36:39], v5 offset:35840
    ds_read_b128 v[40:43], v5 offset:40960
    v_mfma_f32_16x16x32_bf16 v[56:59], v[196:199], v[20:23], v[56:59]
    s_add_u32 s6, s98, 10240
    v_mfma_f32_16x16x32_bf16 v[60:63], v[200:203], v[20:23], v[60:63]
    s_waitcnt lgkmcnt(0)
    v_mfma_f32_16x16x32_bf16 v[64:67], v[204:207], v[20:23], v[64:67]
    v_add_f32 v92, v92, v32
    v_add_f32 v93, v93, v33
    v_add_f32 v94, v94, v34
    v_add_f32 v95, v95, v35
    v_mfma_f32_16x16x32_bf16 v[68:71], v[208:211], v[20:23], v[68:71]
    v_add_f32 v92, v92, v36
    v_add_f32 v93, v93, v37
    v_add_f32 v94, v94, v38
    v_add_f32 v95, v95, v39
    v_mfma_f32_16x16x32_bf16 v[72:75], v[212:215], v[20:23], v[72:75]
    v_add_f32 v92, v92, v40
    v_add_f32 v93, v93, v41
    v_add_f32 v94, v94, v42
    v_add_f32 v95, v95, v43
    buffer_store_dwordx4 v[76:79], v44, s[8:11], s6 offen sc1
    s_cmp_lg_u32 s71, 1
    s_cbranch_scc1 L_nost_62
    buffer_store_dwordx4 v[92:95], v52, s[8:11], s6 offen sc1
L_nost_62:
    s_nop 0
    s_waitcnt lgkmcnt(0)
    s_barrier
    ds_read_b128 v[16:19], v4 offset:32768
    ds_read_b128 v[20:23], v4 offset:33792
    v_mfma_f32_16x16x32_bf16 v[56:59], v[216:219], v[24:27], v[56:59]
    v_mfma_f32_16x16x32_bf16 v[60:63], v[220:223], v[24:27], v[60:63]
    v_mfma_f32_16x16x32_bf16 v[64:67], v[224:227], v[24:27], v[64:67]
    v_mfma_f32_16x16x32_bf16 v[68:71], v[228:231], v[24:27], v[68:71]
    v_mfma_f32_16x16x32_bf16 v[72:75], v[232:235], v[24:27], v[72:75]
    ds_read_b128 v[24:27], v4 offset:34816
    v_mfma_f32_16x16x32_bf16 v[56:59], v[236:239], v[28:31], v[56:59]
    v_mfma_f32_16x16x32_bf16 v[60:63], v[240:243], v[28:31], v[60:63]
    v_mfma_f32_16x16x32_bf16 v[64:67], v[244:247], v[28:31], v[64:67]
    v_mfma_f32_16x16x32_bf16 v[68:71], v[248:251], v[28:31], v[68:71]
    v_mfma_f32_16x16x32_bf16 v[72:75], v[252:255], v[28:31], v[72:75]
    ds_read_b128 v[28:31], v4 offset:35840
    s_waitcnt lgkmcnt(3)
    v_mfma_f32_16x16x32_bf16 v[76:79], v[96:99], v[16:19], 0
    v_mfma_f32_16x16x32_bf16 v[80:83], v[100:103], v[16:19], 0
    v_mfma_f32_16x16x32_bf16 v[84:87], v[104:107], v[16:19], 0
    v_mfma_f32_16x16x32_bf16 v[88:91], v[108:111], v[16:19], 0
    s_mul_i32 s73, s3, 5120
    s_add_u32 s73, s73, 65536
    v_mfma_f32_16x16x32_bf16 v[92:95], v[112:115], v[16:19], 0
    v_add_u32 v5, s73, v44
    ds_read_b128 v[16:19], v4 offset:36864
    s_waitcnt lgkmcnt(3)
    v_mfma_f32_16x16x32_bf16 v[76:79], v[116:119], v[20:23], v[76:79]
    ds_write_b128 v5, v[56:59]
    v_add_u32 v5, s73, v45
    v_mfma_f32_16x16x32_bf16 v[80:83], v[120:123], v[20:23], v[80:83]
    v_mfma_f32_16x16x32_bf16 v[84:87], v[124:127], v[20:23], v[84:87]
    v_mfma_f32_16x16x32_bf16 v[88:91], v[128:131], v[20:23], v[88:91]
    v_mfma_f32_16x16x32_bf16 v[92:95], v[132:135], v[20:23], v[92:95]
    ds_read_b128 v[20:23], v4 offset:37888
    s_waitcnt lgkmcnt(4)
    v_mfma_f32_16x16x32_bf16 v[76:79], v[136:139], v[24:27], v[76:79]
    ds_write_b128 v5, v[60:63]
    v_add_u32 v5, s73, v46
    v_mfma_f32_16x16x32_bf16 v[80:83], v[140:143], v[24:27], v[80:83]
    v_mfma_f32_16x16x32_bf16 v[84:87], v[144:147], v[24:27], v[84:87]
    v_mfma_f32_16x16x32_bf16 v[88:91], v[148:151], v[24:27], v[88:91]
    v_mfma_f32_16x16x32_bf16 v[92:95], v[152:155], v[24:27], v[92:95]
    ds_read_b128 v[24:27], v4 offset:38912
    s_waitcnt vmcnt(0)
    v_mov_b32 v3, 0x5000000
    s_and_b32 s6, s4, 7
    s_lshl_b32 s7, s5, 3
    s_add_u32 s6, s6, s7
    s_lshr_b32 s7, s4, 3
    s_add_u32 s7, s7, 1
    s_add_u32 s7, s7, 1
    s_and_b32 s7, s7, 3
    s_lshl_b32 s6, s6, 2
    s_add_u32 s6, s6, s7
    s_mul_i32 s6, s6, 3
    s_add_u32 s6, s6, 1
    s_lshl_b32 s6, s6, 5
    s_add_u32 s6, s6, s3
    s_lshl_b32 s6, s6, 2
    s_add_u32 s6, s6, 15728640
    v_writelane_b32 v3, s6, 1
    v_writelane_b32 v2, 2, 1
    s_and_b32 s6, s4, 7
    s_lshl_b32 s7, s5, 3
    s_add_u32 s6, s6, s7
    s_lshr_b32 s7, s4, 3
    s_add_u32 s7, s7, 2
    s_add_u32 s7, s7, 1
    s_and_b32 s7, s7, 3
    s_lshl_b32 s6, s6, 2
    s_add_u32 s6, s6, s7
    s_mul_i32 s6, s6, 3
    s_add_u32 s6, s6, 2
    s_lshl_b32 s6, s6, 5
    s_add_u32 s6, s6, s3
    s_lshl_b32 s6, s6, 2
    s_add_u32 s6, s6, 15728640
    v_writelane_b32 v3, s6, 2
    v_writelane_b32 v2, 2, 2
    buffer_store_dword v2, v3, s[8:11], 0 offen sc1
    s_waitcnt lgkmcnt(5)
    v_mfma_f32_16x16x32_bf16 v[76:79], v[156:159], v[28:31], v[76:79]
    ds_write_b128 v5, v[64:67]
    v_add_u32 v5, s73, v47
    v_mfma_f32_16x16x32_bf16 v[80:83], v[160:163], v[28:31], v[80:83]
    v_mfma_f32_16x16x32_bf16 v[84:87], v[164:167], v[28:31], v[84:87]
    v_mfma_f32_16x16x32_bf16 v[88:91], v[168:171], v[28:31], v[88:91]
    v_mfma_f32_16x16x32_bf16 v[92:95], v[172:175], v[28:31], v[92:95]
    ds_read_b128 v[28:31], v4 offset:39936
    s_cmp_eq_u32 s64, 0
    s_cbranch_scc1 L_nb
    v_bfe_u32 v2, v1, 1, 3
    v_and_b32 v3, 1, v1
    v_lshl_add_u32 v3, v2, 3, v3
    v_lshlrev_b32 v3, 7, v3
    s_and_b32 s6, s4, 3
    s_lshl_b32 s6, s6, 8
    s_add_u32 s6, s6, 3915776
    s_mov_b32 s79, 262144
L_poll_63:
    buffer_load_dword v2, v3, s[8:11], s6 offen sc1
    s_waitcnt vmcnt(0)
    v_cmp_ne_u32 vcc, 1, v2
    s_cbranch_vccz L_polldone_64
    s_sleep 2
    s_sub_u32 s79, s79, 1
    s_cmp_lg_u32 s79, 0
    s_cbranch_scc1 L_poll_63
L_polldone_64:
L_nb:
    buffer_load_dwordx4 v[96:99], v53, s[12:15], s70 offen
    buffer_load_dwordx4 v[100:103], v48, s[8:11], 0 offen sc1
    s_cmp_ge_u32 s3, 2
    s_cbranch_scc1 L_itskip_65
    buffer_load_dwordx4 v[104:107], v54, s[12:15], s70 offen
    buffer_load_dwordx4 v[108:111], v49, s[8:11], 0 offen sc1
L_itskip_65:
    s_waitcnt lgkmcnt(6)
    v_mfma_f32_16x16x32_bf16 v[76:79], v[176:179], v[16:19], v[76:79]
    ds_write_b128 v5, v[68:71]
    v_add_u32 v5, s73, v52
    v_mfma_f32_16x16x32_bf16 v[80:83], v[180:183], v[16:19], v[80:83]
    v_mfma_f32_16x16x32_bf16 v[84:87], v[184:187], v[16:19], v[84:87]
    v_mfma_f32_16x16x32_bf16 v[88:91], v[188:191], v[16:19], v[88:91]
    v_mfma_f32_16x16x32_bf16 v[92:95], v[192:195], v[16:19], v[92:95]
    s_waitcnt lgkmcnt(5)
    v_mfma_f32_16x16x32_bf16 v[76:79], v[196:199], v[20:23], v[76:79]
    ds_write_b128 v5, v[72:75]
    v_mfma_f32_16x16x32_bf16 v[80:83], v[200:203], v[20:23], v[80:83]
    v_mfma_f32_16x16x32_bf16 v[84:87], v[204:207], v[20:23], v[84:87]
    v_mfma_f32_16x16x32_bf16 v[88:91], v[208:211], v[20:23], v[88:91]
    v_mfma_f32_16x16x32_bf16 v[92:95], v[212:215], v[20:23], v[92:95]
    s_and_b32 s72, s4, 7
    s_lshl_b32 s7, s5, 3
    s_add_u32 s72, s72, s7
    s_lshl_b32 s72, s72, 2
    s_lshr_b32 s7, s4, 3
    s_add_u32 s72, s72, s7
    s_mul_i32 s75, s72, 61440
    s_add_u32 s75, s75, 67108864
    s_mul_i32 s72, s72, 384
    s_add_u32 s72, s72, 15728640
    v_bfe_u32 v2, v1, 3, 2
    v_min_u32 v2, 2, v2
    v_and_b32 v3, 7, v1
    v_lshlrev_b32 v3, 2, v3
    v_lshl_add_u32 v3, v2, 7, v3
    s_bitcmp1_b32 13, s3
    s_cselect_b32 s77, 1, 2
    buffer_load_dword v50, v3, s[8:11], s72 offen sc1
    s_waitcnt lgkmcnt(4)
    v_mfma_f32_16x16x32_bf16 v[76:79], v[216:219], v[24:27], v[76:79]
    v_mfma_f32_16x16x32_bf16 v[80:83], v[220:223], v[24:27], v[80:83]
    v_mfma_f32_16x16x32_bf16 v[84:87], v[224:227], v[24:27], v[84:87]
    v_mfma_f32_16x16x32_bf16 v[88:91], v[228:231], v[24:27], v[88:91]
    v_mfma_f32_16x16x32_bf16 v[92:95], v[232:235], v[24:27], v[92:95]
    s_waitcnt lgkmcnt(2)
    v_mfma_f32_16x16x32_bf16 v[76:79], v[236:239], v[28:31], v[76:79]
    v_mfma_f32_16x16x32_bf16 v[80:83], v[240:243], v[28:31], v[80:83]
    v_mfma_f32_16x16x32_bf16 v[84:87], v[244:247], v[28:31], v[84:87]
    v_mfma_f32_16x16x32_bf16 v[88:91], v[248:251], v[28:31], v[88:91]
    v_mfma_f32_16x16x32_bf16 v[92:95], v[252:255], v[28:31], v[92:95]
    s_nop 7
    v_add_u32 v5, s73, v44
    ds_write_b128 v5, v[76:79] offset:40960
    v_add_u32 v5, s73, v45
    ds_write_b128 v5, v[80:83] offset:40960
    v_add_u32 v5, s73, v46
    ds_write_b128 v5, v[84:87] offset:40960
    v_add_u32 v5, s73, v47
    ds_write_b128 v5, v[88:91] offset:40960
    v_add_u32 v5, s73, v52
    ds_write_b128 v5, v[92:95] offset:40960
    s_waitcnt vmcnt(0)
    v_cmp_gt_u32 s[78:79], s77, v50
    s_nop 3
    s_cmp_lg_u64 s[78:79], 0
    s_cbranch_scc1 L_x2a
    s_add_u32 s6, s75, 0
    buffer_load_dwordx4 v[112:115], v8, s[8:11], s6 offen offset:0 sc1
    buffer_load_dwordx4 v[116:119], v8, s[8:11], s6 offen offset:256 sc1
    s_add_u32 s6, s75, 20480
    buffer_load_dwordx4 v[120:123], v8, s[8:11], s6 offen offset:0 sc1
    buffer_load_dwordx4 v[124:127], v8, s[8:11], s6 offen offset:256 sc1
    s_add_u32 s6, s75, 40960
    buffer_load_dwordx4 v[128:131], v8, s[8:11], s6 offen offset:0 sc1
    buffer_load_dwordx4 v[132:135], v8, s[8:11], s6 offen offset:256 sc1
    s_cmp_ge_u32 s3, 2
    s_cbranch_scc1 L_xi_66
    s_add_u32 s6, s75, 0
    buffer_load_dwordx4 v[136:139], v9, s[8:11], s6 offen offset:0 sc1
    buffer_load_dwordx4 v[140:143], v9, s[8:11], s6 offen offset:256 sc1
    s_add_u32 s6, s75, 20480
    buffer_load_dwordx4 v[144:147], v9, s[8:11], s6 offen offset:0 sc1
    buffer_load_dwordx4 v[148:151], v9, s[8:11], s6 offen offset:256 sc1
    s_add_u32 s6, s75, 40960
    buffer_load_dwordx4 v[152:155], v9, s[8:11], s6 offen offset:0 sc1
    buffer_load_dwordx4 v[156:159], v9, s[8:11], s6 offen offset:256 sc1
L_xi_66:
L_x2a:
    s_waitcnt lgkmcnt(0)
    s_barrier
    ds_read_b128 v[160:163], v10 offset:0
    ds_read_b128 v[164:167], v10 offset:256
    ds_read_b128 v[168:171], v10 offset:5120
    ds_read_b128 v[172:175], v10 offset:5376
    ds_read_b128 v[176:179], v10 offset:10240
    ds_read_b128 v[180:183], v10 offset:10496
    ds_read_b128 v[184:187], v10 offset:15360
    ds_read_b128 v[188:191], v10 offset:15616
    ds_read_b128 v[192:195], v55 offset:0
    ds_read_b128 v[196:199], v55 offset:256
    ds_read_b128 v[200:203], v55 offset:5120
    ds_read_b128 v[204:207], v55 offset:5376
    ds_read_b128 v[208:211], v55 offset:10240
    ds_read_b128 v[212:215], v55 offset:10496
    ds_read_b128 v[216:219], v55 offset:15360
    ds_read_b128 v[220:223], v55 offset:15616
    s_cmp_eq_u64 s[78:79], 0
    s_cbranch_scc1 L_x2b
    s_mov_b32 s79, 262144
L_poll_67:
    buffer_load_dword v2, v3, s[8:11], s72 offen sc1
    s_waitcnt vmcnt(0)
    v_cmp_gt_u32 vcc, s77, v2
    s_cbranch_vccz L_polldone_68
    s_sleep 1
    s_sub_u32 s79, s79, 1
    s_cmp_lg_u32 s79, 0
    s_cbranch_scc1 L_poll_67
L_polldone_68:
    s_add_u32 s6, s75, 0
    buffer_load_dwordx4 v[112:115], v8, s[8:11], s6 offen offset:0 sc1
    buffer_load_dwordx4 v[116:119], v8, s[8:11], s6 offen offset:256 sc1
    s_add_u32 s6, s75, 20480
    buffer_load_dwordx4 v[120:123], v8, s[8:11], s6 offen offset:0 sc1
    buffer_load_dwordx4 v[124:127], v8, s[8:11], s6 offen offset:256 sc1
    s_add_u32 s6, s75, 40960
    buffer_load_dwordx4 v[128:131], v8, s[8:11], s6 offen offset:0 sc1
    buffer_load_dwordx4 v[132:135], v8, s[8:11], s6 offen offset:256 sc1
    s_cmp_ge_u32 s3, 2
    s_cbranch_scc1 L_xi_69
    s_add_u32 s6, s75, 0
    buffer_load_dwordx4 v[136:139], v9, s[8:11], s6 offen offset:0 sc1
    buffer_load_dwordx4 v[140:143], v9, s[8:11], s6 offen offset:256 sc1
    s_add_u32 s6, s75, 20480
    buffer_load_dwordx4 v[144:147], v9, s[8:11], s6 offen offset:0 sc1
    buffer_load_dwordx4 v[148:151], v9, s[8:11], s6 offen offset:256 sc1
    s_add_u32 s6, s75, 40960
    buffer_load_dwordx4 v[152:155], v9, s[8:11], s6 offen offset:0 sc1
    buffer_load_dwordx4 v[156:159], v9, s[8:11], s6 offen offset:256 sc1
L_xi_69:
L_x2b:
    s_mov_b32 s16, s54
    s_mov_b32 s17, s55
    s_mov_b32 s18, 0x280000
    s_mov_b32 s19, 0x20000
    s_waitcnt lgkmcnt(8)
    v_pk_add_f32 v[160:161], v[160:161], v[168:169]
    v_pk_add_f32 v[162:163], v[162:163], v[170:171]
    v_pk_add_f32 v[164:165], v[164:165], v[172:173]
    v_pk_add_f32 v[166:167], v[166:167], v[174:175]
    v_pk_add_f32 v[160:161], v[160:161], v[176:177]
    v_pk_add_f32 v[162:163], v[162:163], v[178:179]
    v_pk_add_f32 v[164:165], v[164:165], v[180:181]
    v_pk_add_f32 v[166:167], v[166:167], v[182:183]
    v_pk_add_f32 v[160:161], v[160:161], v[184:185]
    v_pk_add_f32 v[162:163], v[162:163], v[186:187]
    v_pk_add_f32 v[164:165], v[164:165], v[188:189]
    v_pk_add_f32 v[166:167], v[166:167], v[190:191]
    s_waitcnt vmcnt(0)
    v_pk_add_f32 v[160:161], v[160:161], v[112:113]
    v_pk_add_f32 v[162:163], v[162:163], v[114:115]
    v_pk_add_f32 v[164:165], v[164:165], v[116:117]
    v_pk_add_f32 v[166:167], v[166:167], v[118:119]
    v_pk_add_f32 v[160:161], v[160:161], v[120:121]
    v_pk_add_f32 v[162:163], v[162:163], v[122:123]
    v_pk_add_f32 v[164:165], v[164:165], v[124:125]
    v_pk_add_f32 v[166:167], v[166:167], v[126:127]
    v_pk_add_f32 v[160:161], v[160:161], v[128:129]
    v_pk_add_f32 v[162:163], v[162:163], v[130:131]
    v_pk_add_f32 v[164:165], v[164:165], v[132:133]
    v_pk_add_f32 v[166:167], v[166:167], v[134:135]
    v_cvt_pk_bf16_f32 v2, v160, v161
    v_lshlrev_b32 v160, 16, v2
    v_and_b32 v161, 0xffff0000, v2
    v_lshlrev_b32 v2, 16, v96
    v_and_b32 v3, 0xffff0000, v96
    v_pk_add_f32 v[160:161], v[160:161], v[2:3]
    v_cvt_pk_bf16_f32 v2, v160, v161
    v_lshlrev_b32 v160, 16, v2
    v_and_b32 v161, 0xffff0000, v2
    v_lshlrev_b32 v2, 16, v100
    v_and_b32 v3, 0xffff0000, v100
    v_pk_add_f32 v[160:161], v[160:161], v[2:3]
    v_cvt_pk_bf16_f32 v224, v160, v161
    v_cvt_pk_bf16_f32 v2, v162, v163
    v_lshlrev_b32 v162, 16, v2
    v_and_b32 v163, 0xffff0000, v2
    v_lshlrev_b32 v2, 16, v97
    v_and_b32 v3, 0xffff0000, v97
    v_pk_add_f32 v[162:163], v[162:163], v[2:3]
    v_cvt_pk_bf16_f32 v2, v162, v163
    v_lshlrev_b32 v162, 16, v2
    v_and_b32 v163, 0xffff0000, v2
    v_lshlrev_b32 v2, 16, v101
    v_and_b32 v3, 0xffff0000, v101
    v_pk_add_f32 v[162:163], v[162:163], v[2:3]
    v_cvt_pk_bf16_f32 v225, v162, v163
    v_cvt_pk_bf16_f32 v2, v164, v165
    v_lshlrev_b32 v164, 16, v2
    v_and_b32 v165, 0xffff0000, v2
    v_lshlrev_b32 v2, 16, v98
    v_and_b32 v3, 0xffff0000, v98
    v_pk_add_f32 v[164:165], v[164:165], v[2:3]
    v_cvt_pk_bf16_f32 v2, v164, v165
    v_lshlrev_b32 v164, 16, v2
    v_and_b32 v165, 0xffff0000, v2
    v_lshlrev_b32 v2, 16, v102
    v_and_b32 v3, 0xffff0000, v102
    v_pk_add_f32 v[164:165], v[164:165], v[2:3]
    v_cvt_pk_bf16_f32 v226, v164, v165
    v_cvt_pk_bf16_f32 v2, v166, v167
    v_lshlrev_b32 v166, 16, v2
    v_and_b32 v167, 0xffff0000, v2
    v_lshlrev_b32 v2, 16, v99
    v_and_b32 v3, 0xffff0000, v99
    v_pk_add_f32 v[166:167], v[166:167], v[2:3]
    v_cvt_pk_bf16_f32 v2, v166, v167
    v_lshlrev_b32 v166, 16, v2
    v_and_b32 v167, 0xffff0000, v2
    v_lshlrev_b32 v2, 16, v103
    v_and_b32 v3, 0xffff0000, v103
    v_pk_add_f32 v[166:167], v[166:167], v[2:3]
    v_cvt_pk_bf16_f32 v227, v166, v167
    buffer_store_dwordx4 v[224:227], v53, s[16:19], s70 offen
    s_cmp_ge_u32 s3, 2
    s_cbranch_scc1 L_end
    s_waitcnt lgkmcnt(0)
    v_pk_add_f32 v[192:193], v[192:193], v[200:201]
    v_pk_add_f32 v[194:195], v[194:195], v[202:203]
    v_pk_add_f32 v[196:197], v[196:197], v[204:205]
    v_pk_add_f32 v[198:199], v[198:199], v[206:207]
    v_pk_add_f32 v[192:193], v[192:193], v[208:209]
    v_pk_add_f32 v[194:195], v[194:195], v[210:211]
    v_pk_add_f32 v[196:197], v[196:197], v[212:213]
    v_pk_add_f32 v[198:199], v[198:199], v[214:215]
    v_pk_add_f32 v[192:193], v[192:193], v[216:217]
    v_pk_add_f32 v[194:195], v[194:195], v[218:219]
    v_pk_add_f32 v[196:197], v[196:197], v[220:221]
    v_pk_add_f32 v[198:199], v[198:199], v[222:223]
    s_nop 0
    v_pk_add_f32 v[192:193], v[192:193], v[136:137]
    v_pk_add_f32 v[194:195], v[194:195], v[138:139]
    v_pk_add_f32 v[196:197], v[196:197], v[140:141]
    v_pk_add_f32 v[198:199], v[198:199], v[142:143]
    v_pk_add_f32 v[192:193], v[192:193], v[144:145]
    v_pk_add_f32 v[194:195], v[194:195], v[146:147]
    v_pk_add_f32 v[196:197], v[196:197], v[148:149]
    v_pk_add_f32 v[198:199], v[198:199], v[150:151]
    v_pk_add_f32 v[192:193], v[192:193], v[152:153]
    v_pk_add_f32 v[194:195], v[194:195], v[154:155]
    v_pk_add_f32 v[196:197], v[196:197], v[156:157]
    v_pk_add_f32 v[198:199], v[198:199], v[158:159]
    v_cvt_pk_bf16_f32 v2, v192, v193
    v_lshlrev_b32 v192, 16, v2
    v_and_b32 v193, 0xffff0000, v2
    v_lshlrev_b32 v2, 16, v104
    v_and_b32 v3, 0xffff0000, v104
    v_pk_add_f32 v[192:193], v[192:193], v[2:3]
    v_cvt_pk_bf16_f32 v2, v192, v193
    v_lshlrev_b32 v192, 16, v2
    v_and_b32 v193, 0xffff0000, v2
    v_lshlrev_b32 v2, 16, v108
    v_and_b32 v3, 0xffff0000, v108
    v_pk_add_f32 v[192:193], v[192:193], v[2:3]
    v_cvt_pk_bf16_f32 v228, v192, v193
    v_cvt_pk_bf16_f32 v2, v194, v195
    v_lshlrev_b32 v194, 16, v2
    v_and_b32 v195, 0xffff0000, v2
    v_lshlrev_b32 v2, 16, v105
    v_and_b32 v3, 0xffff0000, v105
    v_pk_add_f32 v[194:195], v[194:195], v[2:3]
    v_cvt_pk_bf16_f32 v2, v194, v195
    v_lshlrev_b32 v194, 16, v2
    v_and_b32 v195, 0xffff0000, v2
    v_lshlrev_b32 v2, 16, v109
    v_and_b32 v3, 0xffff0000, v109
    v_pk_add_f32 v[194:195], v[194:195], v[2:3]
    v_cvt_pk_bf16_f32 v229, v194, v195
    v_cvt_pk_bf16_f32 v2, v196, v197
    v_lshlrev_b32 v196, 16, v2
    v_and_b32 v197, 0xffff0000, v2
    v_lshlrev_b32 v2, 16, v106
    v_and_b32 v3, 0xffff0000, v106
    v_pk_add_f32 v[196:197], v[196:197], v[2:3]
    v_cvt_pk_bf16_f32 v2, v196, v197
    v_lshlrev_b32 v196, 16, v2
    v_and_b32 v197, 0xffff0000, v2
    v_lshlrev_b32 v2, 16, v110
    v_and_b32 v3, 0xffff0000, v110
    v_pk_add_f32 v[196:197], v[196:197], v[2:3]
    v_cvt_pk_bf16_f32 v230, v196, v197
    v_cvt_pk_bf16_f32 v2, v198, v199
    v_lshlrev_b32 v198, 16, v2
    v_and_b32 v199, 0xffff0000, v2
    v_lshlrev_b32 v2, 16, v107
    v_and_b32 v3, 0xffff0000, v107
    v_pk_add_f32 v[198:199], v[198:199], v[2:3]
    v_cvt_pk_bf16_f32 v2, v198, v199
    v_lshlrev_b32 v198, 16, v2
    v_and_b32 v199, 0xffff0000, v2
    v_lshlrev_b32 v2, 16, v111
    v_and_b32 v3, 0xffff0000, v111
    v_pk_add_f32 v[198:199], v[198:199], v[2:3]
    v_cvt_pk_bf16_f32 v231, v198, v199
    buffer_store_dwordx4 v[228:231], v54, s[16:19], s70 offen
L_end:
L_exit:
    s_endpgm
.section .rodata,"a"
.p2align 6
.amdhsa_kernel parallel_sum__compressed_kv_cla__moe_arch_mod__prompt_kernel
  .amdhsa_next_free_vgpr 256
  .amdhsa_next_free_sgpr 102
  .amdhsa_accum_offset 256
  .amdhsa_group_segment_fixed_size 0
  .amdhsa_kernarg_size 112
  .amdhsa_user_sgpr_count 2
  .amdhsa_user_sgpr_kernarg_segment_ptr 1
  .amdhsa_system_sgpr_workgroup_id_x 1
  .amdhsa_float_denorm_mode_32 3
.end_amdhsa_kernel
```

```asm
; @launch grid=(256,1,1) block=(512,1,1) lds=163840
.amdgcn_target "amdgcn-amd-amdhsa--gfx950"
.text
.globl parallel_sum__compressed_kv_cla__moe_arch_mod__prompt_kernel
.p2align 8
.type parallel_sum__compressed_kv_cla__moe_arch_mod__prompt_kernel,@function
parallel_sum__compressed_kv_cla__moe_arch_mod__prompt_kernel:
    s_cmp_ge_u32 s2, 256
    s_cbranch_scc1 L_exit
    s_load_dwordx16 s[32:47], s[0:1], 0
    s_load_dwordx8 s[48:55], s[0:1], 64
    s_load_dwordx4 s[56:59], s[0:1], 96
    v_lshrrev_b32 v2, 6, v0
    v_and_b32 v1, 63, v0
    v_readfirstlane_b32 s3, v2
    s_getpc_b64 s[80:81]
L_pc:
    s_lshr_b32 s6, s2, 3
    s_and_b32 s6, s6, 15
    s_lshl_b32 s6, s6, 12
    s_cmp_lt_u32 s3, 2
    s_cselect_b32 s6, 0, s6
    v_lshl_add_u32 v3, v0, 6, s6
    v_min_u32 v3, L_exit-L_pc, v3
    s_cmp_ge_u32 s3, 3
    s_cbranch_scc1 L_noct
    global_load_dword v11, v3, s[80:81]
L_noct:
    v_lshrrev_b32 v62, 5, v0
    v_and_b32 v62, 7, v62
    v_and_b32 v2, 31, v0
    v_lshlrev_b32 v2, 3, v2
    v_mul_u32_u24 v63, 1280, v62
    v_add_u32 v63, v63, v2
    s_mul_i32 s6, s2, 10240
    v_add_u32 v10, s6, v63
    s_cmp_lt_u32 s3, 4
    s_cbranch_scc1 L_st_k0
    s_waitcnt lgkmcnt(0)
    global_load_dwordx2 v[16:17], v10, s[32:33] offset:0
    global_load_dwordx2 v[18:19], v10, s[32:33] offset:256
    global_load_dwordx2 v[20:21], v10, s[32:33] offset:512
    global_load_dwordx2 v[22:23], v10, s[32:33] offset:768
    global_load_dwordx2 v[24:25], v10, s[32:33] offset:1024
    global_load_dwordx2 v[26:27], v2, s[46:47] offset:0
    global_load_dwordx2 v[28:29], v2, s[46:47] offset:256
    global_load_dwordx2 v[30:31], v2, s[46:47] offset:512
    global_load_dwordx2 v[32:33], v2, s[46:47] offset:768
    global_load_dwordx2 v[34:35], v2, s[46:47] offset:1024
L_st_k0:
    s_and_b32 s6, s2, 7
    s_lshl_b32 s6, s6, 2
    s_lshr_b32 s7, s2, 3
    s_and_b32 s7, s7, 3
    s_add_u32 s4, s6, s7
    s_lshr_b32 s5, s2, 5
    s_and_b32 s76, s3, 3
    v_lshrrev_b32 v2, 3, v1
    v_and_b32 v3, 7, v1
    v_lshrrev_b32 v4, 4, v1
    v_xor_b32 v5, v3, v4
    v_lshlrev_b32 v5, 4, v5
    v_lshl_add_u32 v40, v2, 10, v5
    v_xor_b32 v5, 64, v40
    v_add_u32 v41, 7168, v5
    v_add_u32 v42, 14336, v40
    v_add_u32 v43, 14336, v41
    v_and_b32 v6, 15, v1
    s_lshl_b32 s6, s76, 4
    v_add_u32 v7, s6, v4
    v_lshlrev_b32 v5, 1, v4
    v_xor_b32 v5, v6, v5
    v_lshlrev_b32 v5, 4, v5
    v_lshl_add_u32 v44, v7, 13, v5
    v_add_u32 v45, 31744, v44
    v_xor_b32 v5, 0x80, v44
    v_add_u32 v46, 63488, v5
    v_add_u32 v47, 31744, v46
    s_and_b32 s6, s76, 1
    s_lshl_b32 s6, s6, 20
    s_lshr_b32 s7, s76, 1
    s_lshl_b32 s7, s7, 18
    s_add_u32 s6, s6, s7
    s_lshl_b32 s62, s5, 15
    s_add_u32 s62, s62, s6
    s_lshl_b32 s63, s4, 8
    s_lshl_b32 s64, s76, 13
    s_lshl_b32 s73, s76, 12
    s_add_u32 s73, s73, 32768
    s_andn2_b32 s100, 1, s5
    s_lshl_b32 s100, s100, 16
    s_add_u32 s64, s64, s100
    s_add_u32 s73, s73, s100
    s_waitcnt lgkmcnt(0)
    s_mov_b32 s12, s34
    s_mov_b32 s13, s35
    s_mov_b32 s14, 0x200000
    s_mov_b32 s15, 0x20000
    s_mov_b32 s16, s38
    s_mov_b32 s17, s39
    s_mov_b32 s18, 0x400000
    s_mov_b32 s19, 0x20000
    s_mov_b32 s20, s40
    s_mov_b32 s21, s41
    s_mov_b32 s22, 0x400000
    s_mov_b32 s23, 0x20000
    s_cmp_ge_u32 s3, 4
    s_cbranch_scc1 L_st_v0
    s_mov_b32 m0, s64
    s_add_u32 s72, s62, 524288
    buffer_load_dwordx4 v40, s[12:15], s62 offen offset:0 lds
    buffer_load_dwordx4 v41, s[12:15], s62 offen offset:1024 lds
    buffer_load_dwordx4 v42, s[12:15], s62 offen offset:2048 lds
    buffer_load_dwordx4 v43, s[12:15], s62 offen offset:3072 lds
    s_add_u32 m0, s64, 4096
    s_add_u32 s62, s62, 128
    s_bitset0_b32 s62, 10
    buffer_load_dwordx4 v40, s[12:15], s72 offen offset:0 lds
    buffer_load_dwordx4 v41, s[12:15], s72 offen offset:1024 lds
    buffer_load_dwordx4 v42, s[12:15], s72 offen offset:2048 lds
    buffer_load_dwordx4 v43, s[12:15], s72 offen offset:3072 lds
    s_mov_b32 m0, s73
    s_xor_b32 s64, s64, 0x10000
    buffer_load_dwordx4 v44, s[16:19], s63 offen offset:0 lds
    buffer_load_dwordx4 v45, s[16:19], s63 offen offset:1024 lds
    buffer_load_dwordx4 v46, s[16:19], s63 offen offset:2048 lds
    buffer_load_dwordx4 v47, s[16:19], s63 offen offset:3072 lds
    s_add_u32 m0, s73, 16384
    s_xor_b32 s73, s73, 0x10000
    buffer_load_dwordx4 v44, s[20:23], s63 offen offset:0 lds
    buffer_load_dwordx4 v45, s[20:23], s63 offen offset:1024 lds
    buffer_load_dwordx4 v46, s[20:23], s63 offen offset:2048 lds
    buffer_load_dwordx4 v47, s[20:23], s63 offen offset:3072 lds
    s_add_u32 s63, s63, 524288
    s_bitset0_b32 s63, 22
    s_setprio 1
L_st_v0:
    s_mov_b32 s8, s58
    s_mov_b32 s9, s59
    s_mov_b32 s10, 0x5000000
    s_mov_b32 s11, 0x20000
    s_mov_b32 s24, s36
    s_mov_b32 s25, s37
    s_mov_b32 s26, 0x500000
    s_mov_b32 s27, 0x20000
    v_lshlrev_b32 v13, 4, v1
    s_lshl_b32 s6, s5, 2
    s_add_u32 s7, s6, s3
    s_sub_u32 s6, 56, s6
    s_add_u32 s6, s6, s3
    s_cmp_lt_u32 s3, 4
    s_cselect_b32 s60, s7, s6
    s_sub_u32 s6, 2, s5
    s_and_b32 s6, s6, 7
    s_lshl_b32 s6, s6, 5
    s_add_u32 s61, s6, s4
    v_and_b32 v2, 15, v1
    v_lshrrev_b32 v3, 4, v1
    s_and_b32 s6, s3, 1
    s_lshl_b32 s6, s6, 7
    v_add_u32 v4, s6, v2
    v_lshlrev_b32 v4, 7, v4
    v_add_u32 v4, s100, v4
    v_lshrrev_b32 v5, 1, v2
    v_add_u32 v6, 0, v3
    v_xor_b32 v6, v6, v5
    v_lshl_add_u32 v48, v6, 4, v4
    v_add_u32 v6, 4, v3
    v_xor_b32 v6, v6, v5
    v_lshl_add_u32 v49, v6, 4, v4
    v_lshrrev_b32 v4, 2, v2
    v_lshl_add_u32 v5, v3, 3, v4
    v_lshlrev_b32 v5, 8, v5
    v_and_b32 v6, 1, v2
    v_lshl_add_u32 v5, v6, 3, v5
    v_and_b32 v6, 1, v3
    v_lshl_or_b32 v4, v6, 2, v4
    v_lshlrev_b32 v4, 1, v4
    v_bfe_u32 v6, v2, 1, 1
    v_add_u32 v8, 131072, v5
    v_add_u32 v7, 0, v6
    v_xor_b32 v7, v7, v4
    v_lshl_add_u32 v54, v7, 4, v8
    v_add_u32 v7, 2, v6
    v_xor_b32 v7, v7, v4
    v_lshl_add_u32 v55, v7, 4, v8
    v_add_u32 v7, 4, v6
    v_xor_b32 v7, v7, v4
    v_lshl_add_u32 v56, v7, 4, v8
    v_add_u32 v7, 6, v6
    v_xor_b32 v7, v7, v4
    v_lshl_add_u32 v57, v7, 4, v8
    v_add_u32 v7, 8, v6
    v_xor_b32 v7, v7, v4
    v_lshl_add_u32 v58, v7, 4, v8
    v_add_u32 v7, 10, v6
    v_xor_b32 v7, v7, v4
    v_lshl_add_u32 v59, v7, 4, v8
    v_add_u32 v7, 12, v6
    v_xor_b32 v7, v7, v4
    v_lshl_add_u32 v60, v7, 4, v8
    v_add_u32 v7, 14, v6
    v_xor_b32 v7, v7, v4
    v_lshl_add_u32 v61, v7, 4, v8
    s_lshr_b32 s6, s3, 2
    s_lshl_b32 s6, s6, 14
    s_add_u32 s6, s6, 32768
    s_add_u32 s6, s6, s100
    v_add_u32 v5, s6, v5
    s_lshr_b32 s7, s3, 1
    s_and_b32 s7, s7, 1
    s_lshl_b32 s7, s7, 3
    s_add_u32 s6, s7, 0
    v_add_u32 v7, s6, v6
    v_xor_b32 v7, v7, v4
    v_lshl_add_u32 v50, v7, 4, v5
    s_add_u32 s6, s7, 2
    v_add_u32 v7, s6, v6
    v_xor_b32 v7, v7, v4
    v_lshl_add_u32 v51, v7, 4, v5
    s_add_u32 s6, s7, 4
    v_add_u32 v7, s6, v6
    v_xor_b32 v7, v7, v4
    v_lshl_add_u32 v52, v7, 4, v5
    s_add_u32 s6, s7, 6
    v_add_u32 v7, s6, v6
    v_xor_b32 v7, v7, v4
    v_lshl_add_u32 v53, v7, 4, v5
    v_mov_b64 v[128:129], 0
    v_mov_b64 v[130:131], 0
    v_mov_b64 v[132:133], 0
    v_mov_b64 v[134:135], 0
    v_mov_b64 v[136:137], 0
    v_mov_b64 v[138:139], 0
    v_mov_b64 v[140:141], 0
    v_mov_b64 v[142:143], 0
    v_mov_b64 v[144:145], 0
    v_mov_b64 v[146:147], 0
    v_mov_b64 v[148:149], 0
    v_mov_b64 v[150:151], 0
    v_mov_b64 v[152:153], 0
    v_mov_b64 v[154:155], 0
    v_mov_b64 v[156:157], 0
    v_mov_b64 v[158:159], 0
    v_mov_b64 v[160:161], 0
    v_mov_b64 v[162:163], 0
    v_mov_b64 v[164:165], 0
    v_mov_b64 v[166:167], 0
    v_mov_b64 v[168:169], 0
    v_mov_b64 v[170:171], 0
    v_mov_b64 v[172:173], 0
    v_mov_b64 v[174:175], 0
    v_mov_b64 v[176:177], 0
    v_mov_b64 v[178:179], 0
    v_mov_b64 v[180:181], 0
    v_mov_b64 v[182:183], 0
    v_mov_b64 v[184:185], 0
    v_mov_b64 v[186:187], 0
    v_mov_b64 v[188:189], 0
    v_mov_b64 v[190:191], 0
    v_mov_b64 v[192:193], 0
    v_mov_b64 v[194:195], 0
    v_mov_b64 v[196:197], 0
    v_mov_b64 v[198:199], 0
    v_mov_b64 v[200:201], 0
    v_mov_b64 v[202:203], 0
    v_mov_b64 v[204:205], 0
    v_mov_b64 v[206:207], 0
    v_mov_b64 v[208:209], 0
    v_mov_b64 v[210:211], 0
    v_mov_b64 v[212:213], 0
    v_mov_b64 v[214:215], 0
    v_mov_b64 v[216:217], 0
    v_mov_b64 v[218:219], 0
    v_mov_b64 v[220:221], 0
    v_mov_b64 v[222:223], 0
    v_mov_b64 v[224:225], 0
    v_mov_b64 v[226:227], 0
    v_mov_b64 v[228:229], 0
    v_mov_b64 v[230:231], 0
    v_mov_b64 v[232:233], 0
    v_mov_b64 v[234:235], 0
    v_mov_b64 v[236:237], 0
    v_mov_b64 v[238:239], 0
    v_mov_b64 v[240:241], 0
    v_mov_b64 v[242:243], 0
    v_mov_b64 v[244:245], 0
    v_mov_b64 v[246:247], 0
    v_mov_b64 v[248:249], 0
    v_mov_b64 v[250:251], 0
    v_mov_b64 v[252:253], 0
    v_mov_b64 v[254:255], 0
    v_add_u32 v12, 20480, v13
    s_mul_i32 s70, s60, 40960
    s_mov_b32 s65, 0
    s_lshl_b32 s6, s4, 20
    s_lshl_b32 s7, s5, 13
    s_add_u32 s6, s6, s7
    s_and_b32 s7, s3, 1
    s_lshl_b32 s7, s7, 16
    s_add_u32 s6, s6, s7
    s_add_u32 s67, s6, 16777216
    s_and_b32 s6, s4, 3
    s_add_u32 s6, s6, s5
    s_sub_u32 s7, s6, 5
    s_cselect_b32 s6, s6, s7
    s_sub_u32 s7, s6, 5
    s_cselect_b32 s6, s6, s7
    s_lshl_b32 s71, s6, 20
    s_lshl_b32 s7, s4, 8
    s_add_u32 s71, s71, s7
    s_lshl_b32 s7, s6, 12
    s_add_u32 s84, s70, s7
    s_add_u32 s6, s6, 1
    s_cmp_eq_u32 s6, 5
    s_cselect_b32 s6, 0, s6
    s_lshl_b32 s7, s6, 12
    s_add_u32 s85, s70, s7
    s_add_u32 s6, s6, 1
    s_cmp_eq_u32 s6, 5
    s_cselect_b32 s6, 0, s6
    s_lshl_b32 s7, s6, 12
    s_add_u32 s86, s70, s7
    s_add_u32 s6, s6, 1
    s_cmp_eq_u32 s6, 5
    s_cselect_b32 s6, 0, s6
    s_lshl_b32 s7, s6, 12
    s_add_u32 s87, s70, s7
    s_add_u32 s6, s6, 1
    s_cmp_eq_u32 s6, 5
    s_cselect_b32 s6, 0, s6
    s_lshl_b32 s7, s6, 12
    s_add_u32 s88, s70, s7
    s_lshr_b32 s7, s3, 1
    s_and_b32 s7, s7, 1
    s_cmp_ge_u32 s3, 4
    s_cbranch_scc1 L_c_v
    s_lshl_b32 s7, s7, 11
    s_add_u32 s67, s67, s7
    s_movk_i32 s68, 3072
    s_mov_b32 s69, 125952
    s_add_u32 s71, s71, 1048576
    s_sub_u32 s75, s71, 5242880
    s_cselect_b32 s71, s71, s75
    s_lshl_b32 s74, s76, 12
    s_add_u32 s74, s74, s100
    s_branch L_c_j
L_c_v:
    s_lshl_b32 s7, s7, 12
    s_add_u32 s67, s67, s7
    s_add_u32 s67, s67, 0x80000
    s_movk_i32 s68, 1024
    s_mov_b32 s69, 128000
L_c_j:
    s_cmp_ge_u32 s3, 4
    s_cbranch_scc1 L_st_v1
    s_mov_b32 m0, s64
    s_add_u32 s72, s62, 524288
    buffer_load_dwordx4 v40, s[12:15], s62 offen offset:0 lds
    buffer_load_dwordx4 v41, s[12:15], s62 offen offset:1024 lds
    buffer_load_dwordx4 v42, s[12:15], s62 offen offset:2048 lds
    buffer_load_dwordx4 v43, s[12:15], s62 offen offset:3072 lds
    s_add_u32 m0, s64, 4096
    s_add_u32 s62, s62, 128
    s_bitset0_b32 s62, 10
    buffer_load_dwordx4 v40, s[12:15], s72 offen offset:0 lds
    buffer_load_dwordx4 v41, s[12:15], s72 offen offset:1024 lds
    buffer_load_dwordx4 v42, s[12:15], s72 offen offset:2048 lds
    buffer_load_dwordx4 v43, s[12:15], s72 offen offset:3072 lds
    s_waitcnt vmcnt(8)
    s_branch L_st_j1
L_st_v1:
    s_waitcnt vmcnt(0)
    v_lshlrev_b32 v64, 16, v16
    v_and_b32 v65, 0xffff0000, v16
    v_lshlrev_b32 v66, 16, v17
    v_and_b32 v67, 0xffff0000, v17
    v_lshlrev_b32 v68, 16, v18
    v_and_b32 v69, 0xffff0000, v18
    v_lshlrev_b32 v70, 16, v19
    v_and_b32 v71, 0xffff0000, v19
    v_lshlrev_b32 v72, 16, v20
    v_and_b32 v73, 0xffff0000, v20
    v_lshlrev_b32 v74, 16, v21
    v_and_b32 v75, 0xffff0000, v21
    v_lshlrev_b32 v76, 16, v22
    v_and_b32 v77, 0xffff0000, v22
    v_lshlrev_b32 v78, 16, v23
    v_and_b32 v79, 0xffff0000, v23
    v_lshlrev_b32 v80, 16, v24
    v_and_b32 v81, 0xffff0000, v24
    v_lshlrev_b32 v82, 16, v25
    v_and_b32 v83, 0xffff0000, v25
    v_pk_add_f32 v[2:3], v[64:65], v[66:67]
    v_pk_add_f32 v[2:3], v[2:3], v[68:69]
    v_pk_add_f32 v[2:3], v[2:3], v[70:71]
    v_pk_add_f32 v[2:3], v[2:3], v[72:73]
    v_pk_add_f32 v[2:3], v[2:3], v[74:75]
    v_pk_add_f32 v[2:3], v[2:3], v[76:77]
    v_pk_add_f32 v[2:3], v[2:3], v[78:79]
    v_pk_add_f32 v[2:3], v[2:3], v[80:81]
    v_pk_add_f32 v[2:3], v[2:3], v[82:83]
    v_add_f32 v2, v2, v3
    s_nop 1
    v_add_f32_dpp v2, v2, v2 quad_perm:[1,0,3,2] row_mask:0xf bank_mask:0xf
    s_nop 1
    v_add_f32_dpp v2, v2, v2 quad_perm:[2,3,0,1] row_mask:0xf bank_mask:0xf
    s_nop 1
    v_add_f32_dpp v2, v2, v2 row_half_mirror row_mask:0xf bank_mask:0xf
    s_nop 1
    v_add_f32_dpp v2, v2, v2 row_mirror row_mask:0xf bank_mask:0xf
    v_mov_b32 v8, v2
    s_nop 1
    v_permlane16_swap_b32 v2, v8
    s_nop 1
    v_add_f32 v2, v2, v8
    s_mov_b32 s7, 0x3acccccd
    v_mul_f32 v2, s7, v2
    v_mov_b64 v[4:5], 0
    v_pk_add_f32 v[6:7], v[64:65], v[2:3] op_sel_hi:[1,0] neg_lo:[0,1] neg_hi:[0,1]
    v_pk_fma_f32 v[4:5], v[6:7], v[6:7], v[4:5]
    v_pk_add_f32 v[6:7], v[66:67], v[2:3] op_sel_hi:[1,0] neg_lo:[0,1] neg_hi:[0,1]
    v_pk_fma_f32 v[4:5], v[6:7], v[6:7], v[4:5]
    v_pk_add_f32 v[6:7], v[68:69], v[2:3] op_sel_hi:[1,0] neg_lo:[0,1] neg_hi:[0,1]
    v_pk_fma_f32 v[4:5], v[6:7], v[6:7], v[4:5]
    v_pk_add_f32 v[6:7], v[70:71], v[2:3] op_sel_hi:[1,0] neg_lo:[0,1] neg_hi:[0,1]
    v_pk_fma_f32 v[4:5], v[6:7], v[6:7], v[4:5]
    v_pk_add_f32 v[6:7], v[72:73], v[2:3] op_sel_hi:[1,0] neg_lo:[0,1] neg_hi:[0,1]
    v_pk_fma_f32 v[4:5], v[6:7], v[6:7], v[4:5]
    v_pk_add_f32 v[6:7], v[74:75], v[2:3] op_sel_hi:[1,0] neg_lo:[0,1] neg_hi:[0,1]
    v_pk_fma_f32 v[4:5], v[6:7], v[6:7], v[4:5]
    v_pk_add_f32 v[6:7], v[76:77], v[2:3] op_sel_hi:[1,0] neg_lo:[0,1] neg_hi:[0,1]
    v_pk_fma_f32 v[4:5], v[6:7], v[6:7], v[4:5]
    v_pk_add_f32 v[6:7], v[78:79], v[2:3] op_sel_hi:[1,0] neg_lo:[0,1] neg_hi:[0,1]
    v_pk_fma_f32 v[4:5], v[6:7], v[6:7], v[4:5]
    v_pk_add_f32 v[6:7], v[80:81], v[2:3] op_sel_hi:[1,0] neg_lo:[0,1] neg_hi:[0,1]
    v_pk_fma_f32 v[4:5], v[6:7], v[6:7], v[4:5]
    v_pk_add_f32 v[6:7], v[82:83], v[2:3] op_sel_hi:[1,0] neg_lo:[0,1] neg_hi:[0,1]
    v_pk_fma_f32 v[4:5], v[6:7], v[6:7], v[4:5]
    v_add_f32 v4, v4, v5
    s_nop 1
    v_add_f32_dpp v4, v4, v4 quad_perm:[1,0,3,2] row_mask:0xf bank_mask:0xf
    s_nop 1
    v_add_f32_dpp v4, v4, v4 quad_perm:[2,3,0,1] row_mask:0xf bank_mask:0xf
    s_nop 1
    v_add_f32_dpp v4, v4, v4 row_half_mirror row_mask:0xf bank_mask:0xf
    s_nop 1
    v_add_f32_dpp v4, v4, v4 row_mirror row_mask:0xf bank_mask:0xf
    v_mov_b32 v8, v4
    s_nop 1
    v_permlane16_swap_b32 v4, v8
    s_nop 1
    v_add_f32 v4, v4, v8
    v_mul_f32 v4, s7, v4
    v_cvt_pk_bf16_f32 v2, v2, v2
    v_lshlrev_b32 v2, 16, v2
    v_cvt_pk_bf16_f32 v4, v4, v4
    v_lshlrev_b32 v4, 16, v4
    v_add_f32 v4, 0x3727c5ac, v4
    v_cvt_pk_bf16_f32 v4, v4, v4
    v_lshlrev_b32 v4, 16, v4
    v_sqrt_f32 v4, v4
    s_nop 0
    v_cvt_pk_bf16_f32 v4, v4, v4
    v_lshlrev_b32 v4, 16, v4
    v_rcp_f32 v6, v4
    s_nop 0
    v_fma_f32 v5, -v4, v6, 1.0
    v_fmac_f32 v6, v5, v6
    v_mov_b32 v9, 0
    v_pk_add_f32 v[64:65], v[64:65], v[2:3] op_sel_hi:[1,0] neg_lo:[0,1] neg_hi:[0,1]
    v_cvt_pk_bf16_f32 v5, v64, v65
    v_lshlrev_b32 v64, 16, v5
    v_and_b32 v65, 0xffff0000, v5
    v_pk_mul_f32 v[64:65], v[64:65], v[6:7] op_sel_hi:[1,0]
    v_cvt_pk_bf16_f32 v16, v64, v65
    v_pk_add_f32 v[66:67], v[66:67], v[2:3] op_sel_hi:[1,0] neg_lo:[0,1] neg_hi:[0,1]
    v_cvt_pk_bf16_f32 v5, v66, v67
    v_lshlrev_b32 v66, 16, v5
    v_and_b32 v67, 0xffff0000, v5
    v_pk_mul_f32 v[66:67], v[66:67], v[6:7] op_sel_hi:[1,0]
    v_cvt_pk_bf16_f32 v17, v66, v67
    v_pk_add_f32 v[68:69], v[68:69], v[2:3] op_sel_hi:[1,0] neg_lo:[0,1] neg_hi:[0,1]
    v_cvt_pk_bf16_f32 v5, v68, v69
    v_lshlrev_b32 v68, 16, v5
    v_and_b32 v69, 0xffff0000, v5
    v_pk_mul_f32 v[68:69], v[68:69], v[6:7] op_sel_hi:[1,0]
    v_cvt_pk_bf16_f32 v18, v68, v69
    v_pk_add_f32 v[70:71], v[70:71], v[2:3] op_sel_hi:[1,0] neg_lo:[0,1] neg_hi:[0,1]
    v_cvt_pk_bf16_f32 v5, v70, v71
    v_lshlrev_b32 v70, 16, v5
    v_and_b32 v71, 0xffff0000, v5
    v_pk_mul_f32 v[70:71], v[70:71], v[6:7] op_sel_hi:[1,0]
    v_cvt_pk_bf16_f32 v19, v70, v71
    v_pk_add_f32 v[72:73], v[72:73], v[2:3] op_sel_hi:[1,0] neg_lo:[0,1] neg_hi:[0,1]
    v_cvt_pk_bf16_f32 v5, v72, v73
    v_lshlrev_b32 v72, 16, v5
    v_and_b32 v73, 0xffff0000, v5
    v_pk_mul_f32 v[72:73], v[72:73], v[6:7] op_sel_hi:[1,0]
    v_cvt_pk_bf16_f32 v20, v72, v73
    v_pk_add_f32 v[74:75], v[74:75], v[2:3] op_sel_hi:[1,0] neg_lo:[0,1] neg_hi:[0,1]
    v_cvt_pk_bf16_f32 v5, v74, v75
    v_lshlrev_b32 v74, 16, v5
    v_and_b32 v75, 0xffff0000, v5
    v_pk_mul_f32 v[74:75], v[74:75], v[6:7] op_sel_hi:[1,0]
    v_cvt_pk_bf16_f32 v21, v74, v75
    v_pk_add_f32 v[76:77], v[76:77], v[2:3] op_sel_hi:[1,0] neg_lo:[0,1] neg_hi:[0,1]
    v_cvt_pk_bf16_f32 v5, v76, v77
    v_lshlrev_b32 v76, 16, v5
    v_and_b32 v77, 0xffff0000, v5
    v_pk_mul_f32 v[76:77], v[76:77], v[6:7] op_sel_hi:[1,0]
    v_cvt_pk_bf16_f32 v22, v76, v77
    v_pk_add_f32 v[78:79], v[78:79], v[2:3] op_sel_hi:[1,0] neg_lo:[0,1] neg_hi:[0,1]
    v_cvt_pk_bf16_f32 v5, v78, v79
    v_lshlrev_b32 v78, 16, v5
    v_and_b32 v79, 0xffff0000, v5
    v_pk_mul_f32 v[78:79], v[78:79], v[6:7] op_sel_hi:[1,0]
    v_cvt_pk_bf16_f32 v23, v78, v79
    v_pk_add_f32 v[80:81], v[80:81], v[2:3] op_sel_hi:[1,0] neg_lo:[0,1] neg_hi:[0,1]
    v_cvt_pk_bf16_f32 v5, v80, v81
    v_lshlrev_b32 v80, 16, v5
    v_and_b32 v81, 0xffff0000, v5
    v_pk_mul_f32 v[80:81], v[80:81], v[6:7] op_sel_hi:[1,0]
    v_cvt_pk_bf16_f32 v24, v80, v81
    v_pk_add_f32 v[82:83], v[82:83], v[2:3] op_sel_hi:[1,0] neg_lo:[0,1] neg_hi:[0,1]
    v_cvt_pk_bf16_f32 v5, v82, v83
    v_lshlrev_b32 v82, 16, v5
    v_and_b32 v83, 0xffff0000, v5
    v_pk_mul_f32 v[82:83], v[82:83], v[6:7] op_sel_hi:[1,0]
    v_cvt_pk_bf16_f32 v25, v82, v83
    v_add_u32 v10, 131072, v63
    ds_write_b64 v10, v[16:17] offset:0
    ds_write_b64 v10, v[18:19] offset:256
    ds_write_b64 v10, v[20:21] offset:512
    ds_write_b64 v10, v[22:23] offset:768
    ds_write_b64 v10, v[24:25] offset:1024
    s_waitcnt lgkmcnt(0)
    v_mov_b32 v2, 0
    v_lshlrev_b32 v4, 16, v16
    v_lshlrev_b32 v5, 16, v26
    v_fmac_f32 v2, v4, v5
    v_and_b32 v4, 0xffff0000, v16
    v_and_b32 v5, 0xffff0000, v26
    v_fmac_f32 v2, v4, v5
    v_lshlrev_b32 v4, 16, v17
    v_lshlrev_b32 v5, 16, v27
    v_fmac_f32 v2, v4, v5
    v_and_b32 v4, 0xffff0000, v17
    v_and_b32 v5, 0xffff0000, v27
    v_fmac_f32 v2, v4, v5
    v_lshlrev_b32 v4, 16, v18
    v_lshlrev_b32 v5, 16, v28
    v_fmac_f32 v2, v4, v5
    v_and_b32 v4, 0xffff0000, v18
    v_and_b32 v5, 0xffff0000, v28
    v_fmac_f32 v2, v4, v5
    v_lshlrev_b32 v4, 16, v19
    v_lshlrev_b32 v5, 16, v29
    v_fmac_f32 v2, v4, v5
    v_and_b32 v4, 0xffff0000, v19
    v_and_b32 v5, 0xffff0000, v29
    v_fmac_f32 v2, v4, v5
    v_lshlrev_b32 v4, 16, v20
    v_lshlrev_b32 v5, 16, v30
    v_fmac_f32 v2, v4, v5
    v_and_b32 v4, 0xffff0000, v20
    v_and_b32 v5, 0xffff0000, v30
    v_fmac_f32 v2, v4, v5
    v_lshlrev_b32 v4, 16, v21
    v_lshlrev_b32 v5, 16, v31
    v_fmac_f32 v2, v4, v5
    v_and_b32 v4, 0xffff0000, v21
    v_and_b32 v5, 0xffff0000, v31
    v_fmac_f32 v2, v4, v5
    v_lshlrev_b32 v4, 16, v22
    v_lshlrev_b32 v5, 16, v32
    v_fmac_f32 v2, v4, v5
    v_and_b32 v4, 0xffff0000, v22
    v_and_b32 v5, 0xffff0000, v32
    v_fmac_f32 v2, v4, v5
    v_lshlrev_b32 v4, 16, v23
    v_lshlrev_b32 v5, 16, v33
    v_fmac_f32 v2, v4, v5
    v_and_b32 v4, 0xffff0000, v23
    v_and_b32 v5, 0xffff0000, v33
    v_fmac_f32 v2, v4, v5
    v_lshlrev_b32 v4, 16, v24
    v_lshlrev_b32 v5, 16, v34
    v_fmac_f32 v2, v4, v5
    v_and_b32 v4, 0xffff0000, v24
    v_and_b32 v5, 0xffff0000, v34
    v_fmac_f32 v2, v4, v5
    v_lshlrev_b32 v4, 16, v25
    v_lshlrev_b32 v5, 16, v35
    v_fmac_f32 v2, v4, v5
    v_and_b32 v4, 0xffff0000, v25
    v_and_b32 v5, 0xffff0000, v35
    v_fmac_f32 v2, v4, v5
    s_nop 1
    v_add_f32_dpp v2, v2, v2 quad_perm:[1,0,3,2] row_mask:0xf bank_mask:0xf
    s_nop 1
    v_add_f32_dpp v2, v2, v2 quad_perm:[2,3,0,1] row_mask:0xf bank_mask:0xf
    s_nop 1
    v_add_f32_dpp v2, v2, v2 row_half_mirror row_mask:0xf bank_mask:0xf
    s_nop 1
    v_add_f32_dpp v2, v2, v2 row_mirror row_mask:0xf bank_mask:0xf
    v_mov_b32 v8, v2
    s_nop 1
    v_permlane16_swap_b32 v2, v8
    s_nop 1
    v_add_f32 v2, v2, v8
    v_cvt_pk_bf16_f32 v2, v2, v2
    v_and_b32 v2, 0xffff, v2
    v_bfe_i32 v3, v2, 15, 1
    v_and_b32 v3, 0x7fff, v3
    v_or_b32 v3, 0x8000, v3
    v_xor_b32 v2, v2, v3
    s_lshl_b32 s7, s2, 3
    s_sub_u32 s6, 2047, s7
    v_sub_u32 v3, s6, v62
    v_lshl_or_b32 v2, v2, 11, v3
    v_lshlrev_b32 v3, 2, v62
    v_add_u32 v3, 161792, v3
    ds_write_b32 v3, v2
    s_waitcnt lgkmcnt(0)
L_st_j1:
    s_barrier
    s_cmp_ge_u32 s3, 4
    s_cbranch_scc1 L_kv_v
    ds_read_b128 v[64:67], v48 offset:0
    ds_read_b128 v[68:71], v48 offset:2048
    ds_read_b64_tr_b16 v[96:97], v50 offset:0
    ds_read_b64_tr_b16 v[98:99], v50 offset:1024
    ds_read_b64_tr_b16 v[100:101], v51 offset:0
    ds_read_b64_tr_b16 v[102:103], v51 offset:1024
    ds_read_b128 v[72:75], v48 offset:4096
    ds_read_b64_tr_b16 v[104:105], v52 offset:0
    ds_read_b64_tr_b16 v[106:107], v52 offset:1024
    ds_read_b64_tr_b16 v[108:109], v53 offset:0
    ds_read_b64_tr_b16 v[110:111], v53 offset:1024
    ds_read_b128 v[76:79], v48 offset:6144
    ds_read_b128 v[80:83], v48 offset:8192
    ds_read_b128 v[84:87], v48 offset:10240
    ds_read_b128 v[88:91], v48 offset:12288
    ds_read_b128 v[92:95], v48 offset:14336
    s_mov_b32 m0, s73
    s_xor_b32 s64, s64, 0x10000
    buffer_load_dwordx4 v44, s[16:19], s63 offen offset:0 lds
    buffer_load_dwordx4 v45, s[16:19], s63 offen offset:1024 lds
    buffer_load_dwordx4 v46, s[16:19], s63 offen offset:2048 lds
    buffer_load_dwordx4 v47, s[16:19], s63 offen offset:3072 lds
    s_add_u32 m0, s73, 16384
    s_xor_b32 s73, s73, 0x10000
    buffer_load_dwordx4 v44, s[20:23], s63 offen offset:0 lds
    buffer_load_dwordx4 v45, s[20:23], s63 offen offset:1024 lds
    buffer_load_dwordx4 v46, s[20:23], s63 offen offset:2048 lds
    buffer_load_dwordx4 v47, s[20:23], s63 offen offset:3072 lds
    s_add_u32 s63, s63, 524288
    s_bitset0_b32 s63, 22
.p2align 4
L_kloopA:
    s_waitcnt lgkmcnt(12)
    v_mfma_f32_16x16x32_bf16 v[128:131], v[96:99], v[64:67], v[128:131]
    ds_read_b64_tr_b16 v[112:113], v50 offset:8192
    s_waitcnt lgkmcnt(11)
    v_mfma_f32_16x16x32_bf16 v[132:135], v[100:103], v[64:67], v[132:135]
    ds_read_b64_tr_b16 v[114:115], v50 offset:9216
    s_waitcnt lgkmcnt(9)
    v_mfma_f32_16x16x32_bf16 v[136:139], v[104:107], v[64:67], v[136:139]
    ds_read_b64_tr_b16 v[116:117], v51 offset:8192
    s_waitcnt lgkmcnt(8)
    v_mfma_f32_16x16x32_bf16 v[140:143], v[108:111], v[64:67], v[140:143]
    ds_read_b64_tr_b16 v[118:119], v51 offset:9216
    ds_read_b128 v[64:67], v49 offset:0
    v_mfma_f32_16x16x32_bf16 v[144:147], v[96:99], v[68:71], v[144:147]
    ds_read_b64_tr_b16 v[120:121], v52 offset:8192
    v_mfma_f32_16x16x32_bf16 v[148:151], v[100:103], v[68:71], v[148:151]
    ds_read_b64_tr_b16 v[122:123], v52 offset:9216
    v_mfma_f32_16x16x32_bf16 v[152:155], v[104:107], v[68:71], v[152:155]
    ds_read_b64_tr_b16 v[124:125], v53 offset:8192
    v_mfma_f32_16x16x32_bf16 v[156:159], v[108:111], v[68:71], v[156:159]
    ds_read_b64_tr_b16 v[126:127], v53 offset:9216
    ds_read_b128 v[68:71], v49 offset:2048
    v_mfma_f32_16x16x32_bf16 v[160:163], v[96:99], v[72:75], v[160:163]
    v_mfma_f32_16x16x32_bf16 v[164:167], v[100:103], v[72:75], v[164:167]
    v_mfma_f32_16x16x32_bf16 v[168:171], v[104:107], v[72:75], v[168:171]
    v_mfma_f32_16x16x32_bf16 v[172:175], v[108:111], v[72:75], v[172:175]
    ds_read_b128 v[72:75], v49 offset:4096
    s_waitcnt lgkmcnt(15)
    v_mfma_f32_16x16x32_bf16 v[176:179], v[96:99], v[76:79], v[176:179]
    v_mfma_f32_16x16x32_bf16 v[180:183], v[100:103], v[76:79], v[180:183]
    v_mfma_f32_16x16x32_bf16 v[184:187], v[104:107], v[76:79], v[184:187]
    v_mfma_f32_16x16x32_bf16 v[188:191], v[108:111], v[76:79], v[188:191]
    ds_read_b128 v[76:79], v49 offset:6144
    s_waitcnt lgkmcnt(15)
    v_mfma_f32_16x16x32_bf16 v[192:195], v[96:99], v[80:83], v[192:195]
    v_mfma_f32_16x16x32_bf16 v[196:199], v[100:103], v[80:83], v[196:199]
    v_mfma_f32_16x16x32_bf16 v[200:203], v[104:107], v[80:83], v[200:203]
    v_mfma_f32_16x16x32_bf16 v[204:207], v[108:111], v[80:83], v[204:207]
    ds_read_b128 v[80:83], v49 offset:8192
    s_waitcnt lgkmcnt(15)
    v_mfma_f32_16x16x32_bf16 v[208:211], v[96:99], v[84:87], v[208:211]
    v_mfma_f32_16x16x32_bf16 v[212:215], v[100:103], v[84:87], v[212:215]
    v_mfma_f32_16x16x32_bf16 v[216:219], v[104:107], v[84:87], v[216:219]
    v_mfma_f32_16x16x32_bf16 v[220:223], v[108:111], v[84:87], v[220:223]
    ds_read_b128 v[84:87], v49 offset:10240
    s_waitcnt lgkmcnt(15)
    v_mfma_f32_16x16x32_bf16 v[224:227], v[96:99], v[88:91], v[224:227]
    v_mfma_f32_16x16x32_bf16 v[228:231], v[100:103], v[88:91], v[228:231]
    v_mfma_f32_16x16x32_bf16 v[232:235], v[104:107], v[88:91], v[232:235]
    v_mfma_f32_16x16x32_bf16 v[236:239], v[108:111], v[88:91], v[236:239]
    ds_read_b128 v[88:91], v49 offset:12288
    s_waitcnt lgkmcnt(15)
    v_mfma_f32_16x16x32_bf16 v[240:243], v[96:99], v[92:95], v[240:243]
    v_mfma_f32_16x16x32_bf16 v[244:247], v[100:103], v[92:95], v[244:247]
    v_mfma_f32_16x16x32_bf16 v[248:251], v[104:107], v[92:95], v[248:251]
    v_mfma_f32_16x16x32_bf16 v[252:255], v[108:111], v[92:95], v[252:255]
    ds_read_b128 v[92:95], v49 offset:14336
    s_waitcnt lgkmcnt(11)
    v_mfma_f32_16x16x32_bf16 v[128:131], v[112:115], v[64:67], v[128:131]
    v_mfma_f32_16x16x32_bf16 v[132:135], v[116:119], v[64:67], v[132:135]
    s_waitcnt lgkmcnt(9)
    v_mfma_f32_16x16x32_bf16 v[136:139], v[120:123], v[64:67], v[136:139]
    s_waitcnt lgkmcnt(7)
    v_mfma_f32_16x16x32_bf16 v[140:143], v[124:127], v[64:67], v[140:143]
    s_waitcnt lgkmcnt(6)
    v_mfma_f32_16x16x32_bf16 v[144:147], v[112:115], v[68:71], v[144:147]
    v_mfma_f32_16x16x32_bf16 v[148:151], v[116:119], v[68:71], v[148:151]
    v_mfma_f32_16x16x32_bf16 v[152:155], v[120:123], v[68:71], v[152:155]
    v_mfma_f32_16x16x32_bf16 v[156:159], v[124:127], v[68:71], v[156:159]
    v_xor_b32 v48, 0x10000, v48
    v_xor_b32 v49, 0x10000, v49
    v_xor_b32 v50, 0x10000, v50
    v_xor_b32 v51, 0x10000, v51
    v_xor_b32 v52, 0x10000, v52
    v_xor_b32 v53, 0x10000, v53
    s_waitcnt vmcnt(0) lgkmcnt(0)
    s_barrier
    ds_read_b128 v[64:67], v48 offset:0
    ds_read_b128 v[68:71], v48 offset:2048
    v_mfma_f32_16x16x32_bf16 v[160:163], v[112:115], v[72:75], v[160:163]
    ds_read_b64_tr_b16 v[96:97], v50 offset:0
    s_mov_b32 m0, s64
    s_add_u32 s72, s62, 524288
    v_mfma_f32_16x16x32_bf16 v[164:167], v[116:119], v[72:75], v[164:167]
    ds_read_b64_tr_b16 v[98:99], v50 offset:1024
    buffer_load_dwordx4 v40, s[12:15], s62 offen offset:0 lds
    v_mfma_f32_16x16x32_bf16 v[168:171], v[120:123], v[72:75], v[168:171]
    ds_read_b64_tr_b16 v[100:101], v51 offset:0
    buffer_load_dwordx4 v41, s[12:15], s62 offen offset:1024 lds
    v_mfma_f32_16x16x32_bf16 v[172:175], v[124:127], v[72:75], v[172:175]
    ds_read_b64_tr_b16 v[102:103], v51 offset:1024
    buffer_load_dwordx4 v42, s[12:15], s62 offen offset:2048 lds
    ds_read_b128 v[72:75], v48 offset:4096
    v_mfma_f32_16x16x32_bf16 v[176:179], v[112:115], v[76:79], v[176:179]
    ds_read_b64_tr_b16 v[104:105], v52 offset:0
    buffer_load_dwordx4 v43, s[12:15], s62 offen offset:3072 lds
    v_mfma_f32_16x16x32_bf16 v[180:183], v[116:119], v[76:79], v[180:183]
    ds_read_b64_tr_b16 v[106:107], v52 offset:1024
    s_add_u32 m0, s64, 4096
    s_add_u32 s62, s62, 128
    s_bitset0_b32 s62, 10
    v_mfma_f32_16x16x32_bf16 v[184:187], v[120:123], v[76:79], v[184:187]
    ds_read_b64_tr_b16 v[108:109], v53 offset:0
    buffer_load_dwordx4 v40, s[12:15], s72 offen offset:0 lds
    v_mfma_f32_16x16x32_bf16 v[188:191], v[124:127], v[76:79], v[188:191]
    ds_read_b64_tr_b16 v[110:111], v53 offset:1024
    buffer_load_dwordx4 v41, s[12:15], s72 offen offset:1024 lds
    ds_read_b128 v[76:79], v48 offset:6144
    v_mfma_f32_16x16x32_bf16 v[192:195], v[112:115], v[80:83], v[192:195]
    buffer_load_dwordx4 v42, s[12:15], s72 offen offset:2048 lds
    v_mfma_f32_16x16x32_bf16 v[196:199], v[116:119], v[80:83], v[196:199]
    buffer_load_dwordx4 v43, s[12:15], s72 offen offset:3072 lds
    v_mfma_f32_16x16x32_bf16 v[200:203], v[120:123], v[80:83], v[200:203]
    s_mov_b32 m0, s73
    s_xor_b32 s64, s64, 0x10000
    v_mfma_f32_16x16x32_bf16 v[204:207], v[124:127], v[80:83], v[204:207]
    buffer_load_dwordx4 v44, s[16:19], s63 offen offset:0 lds
    ds_read_b128 v[80:83], v48 offset:8192
    v_mfma_f32_16x16x32_bf16 v[208:211], v[112:115], v[84:87], v[208:211]
    buffer_load_dwordx4 v45, s[16:19], s63 offen offset:1024 lds
    v_mfma_f32_16x16x32_bf16 v[212:215], v[116:119], v[84:87], v[212:215]
    buffer_load_dwordx4 v46, s[16:19], s63 offen offset:2048 lds
    v_mfma_f32_16x16x32_bf16 v[216:219], v[120:123], v[84:87], v[216:219]
    buffer_load_dwordx4 v47, s[16:19], s63 offen offset:3072 lds
    v_mfma_f32_16x16x32_bf16 v[220:223], v[124:127], v[84:87], v[220:223]
    s_add_u32 m0, s73, 16384
    s_xor_b32 s73, s73, 0x10000
    ds_read_b128 v[84:87], v48 offset:10240
    v_mfma_f32_16x16x32_bf16 v[224:227], v[112:115], v[88:91], v[224:227]
    buffer_load_dwordx4 v44, s[20:23], s63 offen offset:0 lds
    v_mfma_f32_16x16x32_bf16 v[228:231], v[116:119], v[88:91], v[228:231]
    buffer_load_dwordx4 v45, s[20:23], s63 offen offset:1024 lds
    v_mfma_f32_16x16x32_bf16 v[232:235], v[120:123], v[88:91], v[232:235]
    buffer_load_dwordx4 v46, s[20:23], s63 offen offset:2048 lds
    v_mfma_f32_16x16x32_bf16 v[236:239], v[124:127], v[88:91], v[236:239]
    buffer_load_dwordx4 v47, s[20:23], s63 offen offset:3072 lds
    ds_read_b128 v[88:91], v48 offset:12288
    v_mfma_f32_16x16x32_bf16 v[240:243], v[112:115], v[92:95], v[240:243]
    s_add_u32 s63, s63, 524288
    s_bitset0_b32 s63, 22
    v_mfma_f32_16x16x32_bf16 v[244:247], v[116:119], v[92:95], v[244:247]
    v_mfma_f32_16x16x32_bf16 v[248:251], v[120:123], v[92:95], v[248:251]
    v_mfma_f32_16x16x32_bf16 v[252:255], v[124:127], v[92:95], v[252:255]
    ds_read_b128 v[92:95], v48 offset:14336
    s_add_u32 s65, s65, 1
    s_cmp_lt_u32 s65, 6
    s_cbranch_scc1 L_kloopA
.p2align 4
L_kloopB:
    s_bitcmp1_b32 128, s65
    s_cbranch_scc1 L_khook
L_khook_back:
    s_waitcnt lgkmcnt(12)
    v_mfma_f32_16x16x32_bf16 v[128:131], v[96:99], v[64:67], v[128:131]
    ds_read_b64_tr_b16 v[112:113], v50 offset:8192
    s_waitcnt lgkmcnt(11)
    v_mfma_f32_16x16x32_bf16 v[132:135], v[100:103], v[64:67], v[132:135]
    ds_read_b64_tr_b16 v[114:115], v50 offset:9216
    s_waitcnt lgkmcnt(9)
    v_mfma_f32_16x16x32_bf16 v[136:139], v[104:107], v[64:67], v[136:139]
    ds_read_b64_tr_b16 v[116:117], v51 offset:8192
    s_waitcnt lgkmcnt(8)
    v_mfma_f32_16x16x32_bf16 v[140:143], v[108:111], v[64:67], v[140:143]
    ds_read_b64_tr_b16 v[118:119], v51 offset:9216
    ds_read_b128 v[64:67], v49 offset:0
    v_mfma_f32_16x16x32_bf16 v[144:147], v[96:99], v[68:71], v[144:147]
    ds_read_b64_tr_b16 v[120:121], v52 offset:8192
    v_mfma_f32_16x16x32_bf16 v[148:151], v[100:103], v[68:71], v[148:151]
    ds_read_b64_tr_b16 v[122:123], v52 offset:9216
    v_mfma_f32_16x16x32_bf16 v[152:155], v[104:107], v[68:71], v[152:155]
    ds_read_b64_tr_b16 v[124:125], v53 offset:8192
    v_mfma_f32_16x16x32_bf16 v[156:159], v[108:111], v[68:71], v[156:159]
    ds_read_b64_tr_b16 v[126:127], v53 offset:9216
    ds_read_b128 v[68:71], v49 offset:2048
    v_mfma_f32_16x16x32_bf16 v[160:163], v[96:99], v[72:75], v[160:163]
    v_mfma_f32_16x16x32_bf16 v[164:167], v[100:103], v[72:75], v[164:167]
    v_mfma_f32_16x16x32_bf16 v[168:171], v[104:107], v[72:75], v[168:171]
    v_mfma_f32_16x16x32_bf16 v[172:175], v[108:111], v[72:75], v[172:175]
    ds_read_b128 v[72:75], v49 offset:4096
    s_waitcnt lgkmcnt(15)
    v_mfma_f32_16x16x32_bf16 v[176:179], v[96:99], v[76:79], v[176:179]
    v_mfma_f32_16x16x32_bf16 v[180:183], v[100:103], v[76:79], v[180:183]
    v_mfma_f32_16x16x32_bf16 v[184:187], v[104:107], v[76:79], v[184:187]
    v_mfma_f32_16x16x32_bf16 v[188:191], v[108:111], v[76:79], v[188:191]
    ds_read_b128 v[76:79], v49 offset:6144
    s_waitcnt lgkmcnt(15)
    v_mfma_f32_16x16x32_bf16 v[192:195], v[96:99], v[80:83], v[192:195]
    v_mfma_f32_16x16x32_bf16 v[196:199], v[100:103], v[80:83], v[196:199]
    v_mfma_f32_16x16x32_bf16 v[200:203], v[104:107], v[80:83], v[200:203]
    v_mfma_f32_16x16x32_bf16 v[204:207], v[108:111], v[80:83], v[204:207]
    ds_read_b128 v[80:83], v49 offset:8192
    s_waitcnt lgkmcnt(15)
    v_mfma_f32_16x16x32_bf16 v[208:211], v[96:99], v[84:87], v[208:211]
    v_mfma_f32_16x16x32_bf16 v[212:215], v[100:103], v[84:87], v[212:215]
    v_mfma_f32_16x16x32_bf16 v[216:219], v[104:107], v[84:87], v[216:219]
    v_mfma_f32_16x16x32_bf16 v[220:223], v[108:111], v[84:87], v[220:223]
    ds_read_b128 v[84:87], v49 offset:10240
    s_waitcnt lgkmcnt(15)
    v_mfma_f32_16x16x32_bf16 v[224:227], v[96:99], v[88:91], v[224:227]
    v_mfma_f32_16x16x32_bf16 v[228:231], v[100:103], v[88:91], v[228:231]
    v_mfma_f32_16x16x32_bf16 v[232:235], v[104:107], v[88:91], v[232:235]
    v_mfma_f32_16x16x32_bf16 v[236:239], v[108:111], v[88:91], v[236:239]
    ds_read_b128 v[88:91], v49 offset:12288
    s_waitcnt lgkmcnt(15)
    v_mfma_f32_16x16x32_bf16 v[240:243], v[96:99], v[92:95], v[240:243]
    v_mfma_f32_16x16x32_bf16 v[244:247], v[100:103], v[92:95], v[244:247]
    v_mfma_f32_16x16x32_bf16 v[248:251], v[104:107], v[92:95], v[248:251]
    v_mfma_f32_16x16x32_bf16 v[252:255], v[108:111], v[92:95], v[252:255]
    ds_read_b128 v[92:95], v49 offset:14336
    s_waitcnt lgkmcnt(11)
    v_mfma_f32_16x16x32_bf16 v[128:131], v[112:115], v[64:67], v[128:131]
    v_mfma_f32_16x16x32_bf16 v[132:135], v[116:119], v[64:67], v[132:135]
    s_waitcnt lgkmcnt(9)
    v_mfma_f32_16x16x32_bf16 v[136:139], v[120:123], v[64:67], v[136:139]
    s_waitcnt lgkmcnt(7)
    v_mfma_f32_16x16x32_bf16 v[140:143], v[124:127], v[64:67], v[140:143]
    s_waitcnt lgkmcnt(6)
    v_mfma_f32_16x16x32_bf16 v[144:147], v[112:115], v[68:71], v[144:147]
    v_mfma_f32_16x16x32_bf16 v[148:151], v[116:119], v[68:71], v[148:151]
    v_mfma_f32_16x16x32_bf16 v[152:155], v[120:123], v[68:71], v[152:155]
    v_mfma_f32_16x16x32_bf16 v[156:159], v[124:127], v[68:71], v[156:159]
    v_xor_b32 v48, 0x10000, v48
    v_xor_b32 v49, 0x10000, v49
    v_xor_b32 v50, 0x10000, v50
    v_xor_b32 v51, 0x10000, v51
    v_xor_b32 v52, 0x10000, v52
    v_xor_b32 v53, 0x10000, v53
    s_waitcnt vmcnt(0) lgkmcnt(0)
    s_barrier
    ds_read_b128 v[64:67], v48 offset:0
    ds_read_b128 v[68:71], v48 offset:2048
    v_mfma_f32_16x16x32_bf16 v[160:163], v[112:115], v[72:75], v[160:163]
    ds_read_b64_tr_b16 v[96:97], v50 offset:0
    s_mov_b32 m0, s74
    s_add_u32 s74, s74, 16384
    s_bitset0_b32 s74, 17
    v_mfma_f32_16x16x32_bf16 v[164:167], v[116:119], v[72:75], v[164:167]
    ds_read_b64_tr_b16 v[98:99], v50 offset:1024
    buffer_load_dwordx4 v44, s[24:27], s71 offen offset:0 lds
    v_mfma_f32_16x16x32_bf16 v[168:171], v[120:123], v[72:75], v[168:171]
    ds_read_b64_tr_b16 v[100:101], v51 offset:0
    buffer_load_dwordx4 v45, s[24:27], s71 offen offset:1024 lds
    v_mfma_f32_16x16x32_bf16 v[172:175], v[124:127], v[72:75], v[172:175]
    ds_read_b64_tr_b16 v[102:103], v51 offset:1024
    buffer_load_dwordx4 v46, s[24:27], s71 offen offset:2048 lds
    ds_read_b128 v[72:75], v48 offset:4096
    v_mfma_f32_16x16x32_bf16 v[176:179], v[112:115], v[76:79], v[176:179]
    ds_read_b64_tr_b16 v[104:105], v52 offset:0
    buffer_load_dwordx4 v47, s[24:27], s71 offen offset:3072 lds
    v_mfma_f32_16x16x32_bf16 v[180:183], v[116:119], v[76:79], v[180:183]
    ds_read_b64_tr_b16 v[106:107], v52 offset:1024
    s_add_u32 s71, s71, 524288
    s_sub_u32 s75, s71, 5242880
    s_cselect_b32 s71, s71, s75
    v_mfma_f32_16x16x32_bf16 v[184:187], v[120:123], v[76:79], v[184:187]
    ds_read_b64_tr_b16 v[108:109], v53 offset:0
    s_mov_b32 m0, s74
    s_add_u32 s74, s74, 16384
    s_bitset0_b32 s74, 17
    v_mfma_f32_16x16x32_bf16 v[188:191], v[124:127], v[76:79], v[188:191]
    ds_read_b64_tr_b16 v[110:111], v53 offset:1024
    buffer_load_dwordx4 v44, s[24:27], s71 offen offset:0 lds
    ds_read_b128 v[76:79], v48 offset:6144
    v_mfma_f32_16x16x32_bf16 v[192:195], v[112:115], v[80:83], v[192:195]
    buffer_load_dwordx4 v45, s[24:27], s71 offen offset:1024 lds
    v_mfma_f32_16x16x32_bf16 v[196:199], v[116:119], v[80:83], v[196:199]
    buffer_load_dwordx4 v46, s[24:27], s71 offen offset:2048 lds
    v_mfma_f32_16x16x32_bf16 v[200:203], v[120:123], v[80:83], v[200:203]
    buffer_load_dwordx4 v47, s[24:27], s71 offen offset:3072 lds
    v_mfma_f32_16x16x32_bf16 v[204:207], v[124:127], v[80:83], v[204:207]
    s_add_u32 s71, s71, 524288
    s_sub_u32 s75, s71, 5242880
    s_cselect_b32 s71, s71, s75
    ds_read_b128 v[80:83], v48 offset:8192
    v_mfma_f32_16x16x32_bf16 v[208:211], v[112:115], v[84:87], v[208:211]
    s_mov_b32 m0, s74
    s_add_u32 s74, s74, 16384
    s_bitset0_b32 s74, 17
    v_mfma_f32_16x16x32_bf16 v[212:215], v[116:119], v[84:87], v[212:215]
    buffer_load_dwordx4 v44, s[24:27], s71 offen offset:0 lds
    v_mfma_f32_16x16x32_bf16 v[216:219], v[120:123], v[84:87], v[216:219]
    buffer_load_dwordx4 v45, s[24:27], s71 offen offset:1024 lds
    v_mfma_f32_16x16x32_bf16 v[220:223], v[124:127], v[84:87], v[220:223]
    buffer_load_dwordx4 v46, s[24:27], s71 offen offset:2048 lds
    ds_read_b128 v[84:87], v48 offset:10240
    v_mfma_f32_16x16x32_bf16 v[224:227], v[112:115], v[88:91], v[224:227]
    buffer_load_dwordx4 v47, s[24:27], s71 offen offset:3072 lds
    v_mfma_f32_16x16x32_bf16 v[228:231], v[116:119], v[88:91], v[228:231]
    s_add_u32 s71, s71, 524288
    s_sub_u32 s75, s71, 5242880
    s_cselect_b32 s71, s71, s75
    v_mfma_f32_16x16x32_bf16 v[232:235], v[120:123], v[88:91], v[232:235]
    s_mov_b32 m0, s74
    s_add_u32 s74, s74, 16384
    s_bitset0_b32 s74, 17
    v_mfma_f32_16x16x32_bf16 v[236:239], v[124:127], v[88:91], v[236:239]
    buffer_load_dwordx4 v44, s[24:27], s71 offen offset:0 lds
    ds_read_b128 v[88:91], v48 offset:12288
    v_mfma_f32_16x16x32_bf16 v[240:243], v[112:115], v[92:95], v[240:243]
    buffer_load_dwordx4 v45, s[24:27], s71 offen offset:1024 lds
    v_mfma_f32_16x16x32_bf16 v[244:247], v[116:119], v[92:95], v[244:247]
    buffer_load_dwordx4 v46, s[24:27], s71 offen offset:2048 lds
    v_mfma_f32_16x16x32_bf16 v[248:251], v[120:123], v[92:95], v[248:251]
    buffer_load_dwordx4 v47, s[24:27], s71 offen offset:3072 lds
    v_mfma_f32_16x16x32_bf16 v[252:255], v[124:127], v[92:95], v[252:255]
    s_add_u32 s71, s71, 524288
    s_sub_u32 s75, s71, 5242880
    s_cselect_b32 s71, s71, s75
    ds_read_b128 v[92:95], v48 offset:14336
    s_add_u32 s65, s65, 1
    s_cmp_lt_u32 s65, 8
    s_cbranch_scc1 L_kloopB
    s_waitcnt lgkmcnt(0)
    s_nop 7
    v_cvt_pk_bf16_f32 v128, v128, v129
    v_cvt_pk_bf16_f32 v129, v130, v131
    v_cvt_pk_bf16_f32 v130, v132, v133
    v_cvt_pk_bf16_f32 v131, v134, v135
    v_cvt_pk_bf16_f32 v132, v136, v137
    v_cvt_pk_bf16_f32 v133, v138, v139
    v_cvt_pk_bf16_f32 v134, v140, v141
    v_cvt_pk_bf16_f32 v135, v142, v143
    v_cvt_pk_bf16_f32 v136, v144, v145
    v_cvt_pk_bf16_f32 v137, v146, v147
    v_cvt_pk_bf16_f32 v138, v148, v149
    v_cvt_pk_bf16_f32 v139, v150, v151
    v_cvt_pk_bf16_f32 v140, v152, v153
    v_cvt_pk_bf16_f32 v141, v154, v155
    v_cvt_pk_bf16_f32 v142, v156, v157
    v_cvt_pk_bf16_f32 v143, v158, v159
    v_cvt_pk_bf16_f32 v144, v160, v161
    v_cvt_pk_bf16_f32 v145, v162, v163
    v_cvt_pk_bf16_f32 v146, v164, v165
    v_cvt_pk_bf16_f32 v147, v166, v167
    v_cvt_pk_bf16_f32 v148, v168, v169
    v_cvt_pk_bf16_f32 v149, v170, v171
    v_cvt_pk_bf16_f32 v150, v172, v173
    v_cvt_pk_bf16_f32 v151, v174, v175
    v_cvt_pk_bf16_f32 v152, v176, v177
    v_cvt_pk_bf16_f32 v153, v178, v179
    v_cvt_pk_bf16_f32 v154, v180, v181
    v_cvt_pk_bf16_f32 v155, v182, v183
    v_cvt_pk_bf16_f32 v156, v184, v185
    v_cvt_pk_bf16_f32 v157, v186, v187
    v_cvt_pk_bf16_f32 v158, v188, v189
    v_cvt_pk_bf16_f32 v159, v190, v191
    v_cvt_pk_bf16_f32 v160, v192, v193
    v_cvt_pk_bf16_f32 v161, v194, v195
    v_cvt_pk_bf16_f32 v162, v196, v197
    v_cvt_pk_bf16_f32 v163, v198, v199
    v_cvt_pk_bf16_f32 v164, v200, v201
    v_cvt_pk_bf16_f32 v165, v202, v203
    v_cvt_pk_bf16_f32 v166, v204, v205
    v_cvt_pk_bf16_f32 v167, v206, v207
    v_cvt_pk_bf16_f32 v168, v208, v209
    v_cvt_pk_bf16_f32 v169, v210, v211
    v_cvt_pk_bf16_f32 v170, v212, v213
    v_cvt_pk_bf16_f32 v171, v214, v215
    v_cvt_pk_bf16_f32 v172, v216, v217
    v_cvt_pk_bf16_f32 v173, v218, v219
    v_cvt_pk_bf16_f32 v174, v220, v221
    v_cvt_pk_bf16_f32 v175, v222, v223
    v_cvt_pk_bf16_f32 v176, v224, v225
    v_cvt_pk_bf16_f32 v177, v226, v227
    v_cvt_pk_bf16_f32 v178, v228, v229
    v_cvt_pk_bf16_f32 v179, v230, v231
    v_cvt_pk_bf16_f32 v180, v232, v233
    v_cvt_pk_bf16_f32 v181, v234, v235
    v_cvt_pk_bf16_f32 v182, v236, v237
    v_cvt_pk_bf16_f32 v183, v238, v239
    v_cvt_pk_bf16_f32 v184, v240, v241
    v_cvt_pk_bf16_f32 v185, v242, v243
    v_cvt_pk_bf16_f32 v186, v244, v245
    v_cvt_pk_bf16_f32 v187, v246, v247
    v_cvt_pk_bf16_f32 v188, v248, v249
    v_cvt_pk_bf16_f32 v189, v250, v251
    v_cvt_pk_bf16_f32 v190, v252, v253
    v_cvt_pk_bf16_f32 v191, v254, v255
    s_branch L_q
L_hook:
    s_cmp_eq_u32 s65, 1
    s_cbranch_scc1 L_hook1
    s_cmp_eq_u32 s65, 2
    s_cbranch_scc1 L_hook2
    s_cmp_eq_u32 s65, 4
    s_cbranch_scc1 L_hook4
    s_cmp_eq_u32 s65, 6
    s_cbranch_scc1 L_hook6
    s_cmp_lg_u32 s65, 7
    s_cbranch_scc1 L_hook_back
    buffer_load_dwordx4 v[16:19], v13, s[8:11], s84 offen offset:0 sc1
    buffer_load_dwordx4 v[20:23], v12, s[8:11], s84 offen offset:0 sc1
    buffer_load_dwordx4 v[24:27], v13, s[8:11], s84 offen offset:1024 sc1
    buffer_load_dwordx4 v[28:31], v12, s[8:11], s84 offen offset:1024 sc1
    buffer_load_dwordx4 v[32:35], v13, s[8:11], s84 offen offset:2048 sc1
    buffer_load_dwordx4 v[36:39], v12, s[8:11], s84 offen offset:2048 sc1
    s_branch L_hook_back
L_hook1:
    s_cmp_ge_u32 s76, 2
    s_cbranch_scc1 L_tch_1a
    s_and_b32 s6, s4, 3
    s_lshl_b32 s6, s6, 19
    s_lshl_b32 s7, s5, 15
    s_add_u32 s6, s6, s7
    s_lshl_b32 s7, s76, 7
    s_add_u32 s6, s6, s7
    s_add_u32 s6, s6, 512
    v_lshrrev_b32 v6, 1, v1
    v_lshlrev_b32 v6, 10, v6
    v_and_b32 v7, 1, v1
    v_lshl_add_u32 v6, v7, 6, v6
    buffer_load_dword v11, v6, s[12:15], s6 offen
    s_add_u32 s6, s6, 262144
    buffer_load_dword v11, v6, s[12:15], s6 offen
    s_branch L_tch_1c
L_tch_1a:
    v_lshrrev_b32 v6, 5, v1
    v_lshlrev_b32 v6, 6, v6
    v_bfe_u32 v7, v1, 2, 3
    v_add_u32 v6, v6, v7
    v_lshlrev_b32 v6, 13, v6
    v_and_b32 v7, 3, v1
    v_lshl_add_u32 v6, v7, 6, v6
    s_lshl_b32 s6, s4, 8
    s_lshl_b32 s7, s5, 16
    s_add_u32 s6, s6, s7
    s_add_u32 s6, s6, 2097152
    s_cmp_lg_u32 s76, 2
    s_cbranch_scc1 L_tch_1b
    buffer_load_dword v11, v6, s[16:19], s6 offen
    s_branch L_tch_1c
L_tch_1b:
    buffer_load_dword v11, v6, s[20:23], s6 offen
L_tch_1c:
    s_branch L_hook_back
L_hook2:
    s_lshr_b32 s72, s2, 1
    s_mul_i32 s72, s72, 20480
    s_and_b32 s7, s2, 1
    s_lshl_b32 s7, s7, 7
    s_add_u32 s72, s72, s7
    v_add_u32 v2, -256, v0
    v_lshrrev_b32 v3, 3, v2
    v_and_b32 v4, 7, v2
    v_mul_u32_u24 v5, 1280, v4
    v_lshl_add_u32 v5, v3, 4, v5
    v_add_u32 v5, 131072, v5
    ds_read_b128 v[16:19], v5
    v_lshlrev_b32 v5, 8, v3
    v_lshl_add_u32 v6, v4, 4, v5
    v_add_u32 v2, 0, v0
    v_lshrrev_b32 v3, 3, v2
    v_and_b32 v4, 7, v2
    v_mul_u32_u24 v5, 1280, v4
    v_lshl_add_u32 v5, v3, 4, v5
    v_add_u32 v5, 131072, v5
    ds_read_b128 v[24:27], v5
    v_lshlrev_b32 v5, 8, v3
    v_lshl_add_u32 v7, v4, 4, v5
    v_add_u32 v2, 256, v0
    v_lshrrev_b32 v3, 3, v2
    v_and_b32 v4, 7, v2
    v_mul_u32_u24 v5, 1280, v4
    v_lshl_add_u32 v5, v3, 4, v5
    v_add_u32 v5, 131072, v5
    ds_read_b128 v[32:35], v5
    v_lshlrev_b32 v5, 8, v3
    v_lshl_add_u32 v8, v4, 4, v5
    s_waitcnt lgkmcnt(0)
    buffer_store_dwordx4 v[16:19], v6, s[8:11], s72 offen sc1
    buffer_store_dwordx4 v[24:27], v7, s[8:11], s72 offen sc1
    s_cmp_ge_u32 s3, 6
    s_cbranch_scc1 L_lns
    buffer_store_dwordx4 v[32:35], v8, s[8:11], s72 offen sc1
L_lns:
    s_cmp_lt_u32 s3, 6
    s_cbranch_scc1 L_zd
    v_mov_b64 v[36:37], 0
    v_mov_b64 v[38:39], 0
    v_lshrrev_b32 v2, 3, v1
    s_cmp_eq_u32 s3, 6
    s_cbranch_scc1 L_z6
    s_lshl_b32 s6, s5, 2
    s_sub_u32 s7, 56, s6
    v_mov_b32 v3, s6
    v_mov_b32 v4, s7
    v_cmp_gt_u32 vcc, 4, v2
    s_lshl_b32 s6, s4, 7
    s_add_u32 s6, s6, 3932160
    v_cndmask_b32 v3, v4, v3, vcc
    v_add_u32 v3, v3, v2
    v_lshl_add_u32 v3, v3, 12, s6
    s_branch L_z7
L_z6:
    v_mov_b32 v3, 0x5000000
    s_lshl_b32 s6, s4, 3
    s_add_u32 s6, s6, s5
    s_lshl_b32 s6, s6, 5
    s_add_u32 s6, s6, s3
    s_lshl_b32 s6, s6, 2
    s_add_u32 s6, s6, 3866624
    s_andn2_b32 s6, s6, 127
    v_cmp_eq_u32 vcc, 0, v2
    v_mov_b32 v4, s6
    s_nop 0
    v_cndmask_b32 v3, v3, v4, vcc
    s_lshl_b32 s6, s61, 5
    s_add_u32 s6, s6, s3
    s_lshl_b32 s6, s6, 2
    s_add_u32 s6, s6, 15859712
    s_andn2_b32 s6, s6, 127
    v_cmp_eq_u32 vcc, 1, v2
    v_mov_b32 v4, s6
    s_nop 0
    v_cndmask_b32 v3, v3, v4, vcc
    s_lshl_b32 s6, s5, 5
    s_add_u32 s6, s6, s4
    s_lshl_b32 s6, s6, 5
    s_add_u32 s6, s6, s3
    s_lshl_b32 s6, s6, 2
    s_add_u32 s6, s6, 3899392
    s_andn2_b32 s6, s6, 127
    v_cmp_eq_u32 vcc, 2, v2
    v_mov_b32 v4, s6
    s_nop 0
    v_cndmask_b32 v3, v3, v4, vcc
    s_and_b32 s6, s4, 7
    s_lshl_b32 s7, s5, 3
    s_add_u32 s6, s6, s7
    s_lshr_b32 s7, s4, 3
    s_add_u32 s7, s7, 0
    s_add_u32 s7, s7, 1
    s_and_b32 s7, s7, 3
    s_lshl_b32 s6, s6, 2
    s_add_u32 s6, s6, s7
    s_mul_i32 s6, s6, 3
    s_add_u32 s6, s6, 0
    s_lshl_b32 s6, s6, 5
    s_add_u32 s6, s6, s3
    s_lshl_b32 s6, s6, 2
    s_add_u32 s6, s6, 15728640
    s_andn2_b32 s6, s6, 127
    v_cmp_eq_u32 vcc, 3, v2
    v_mov_b32 v4, s6
    s_nop 0
    v_cndmask_b32 v3, v3, v4, vcc
    s_and_b32 s6, s4, 7
    s_lshl_b32 s7, s5, 3
    s_add_u32 s6, s6, s7
    s_lshr_b32 s7, s4, 3
    s_add_u32 s7, s7, 1
    s_add_u32 s7, s7, 1
    s_and_b32 s7, s7, 3
    s_lshl_b32 s6, s6, 2
    s_add_u32 s6, s6, s7
    s_mul_i32 s6, s6, 3
    s_add_u32 s6, s6, 1
    s_lshl_b32 s6, s6, 5
    s_add_u32 s6, s6, s3
    s_lshl_b32 s6, s6, 2
    s_add_u32 s6, s6, 15728640
    s_andn2_b32 s6, s6, 127
    v_cmp_eq_u32 vcc, 4, v2
    v_mov_b32 v4, s6
    s_nop 0
    v_cndmask_b32 v3, v3, v4, vcc
    s_and_b32 s6, s4, 7
    s_lshl_b32 s7, s5, 3
    s_add_u32 s6, s6, s7
    s_lshr_b32 s7, s4, 3
    s_add_u32 s7, s7, 2
    s_add_u32 s7, s7, 1
    s_and_b32 s7, s7, 3
    s_lshl_b32 s6, s6, 2
    s_add_u32 s6, s6, s7
    s_mul_i32 s6, s6, 3
    s_add_u32 s6, s6, 2
    s_lshl_b32 s6, s6, 5
    s_add_u32 s6, s6, s3
    s_lshl_b32 s6, s6, 2
    s_add_u32 s6, s6, 15728640
    s_andn2_b32 s6, s6, 127
    v_cmp_eq_u32 vcc, 5, v2
    v_mov_b32 v4, s6
    s_nop 0
    v_cndmask_b32 v3, v3, v4, vcc
    s_mov_b32 s6, 0x5000000
    s_cmp_eq_u32 s2, 31
    s_cmov_b32 s6, 3801088
    s_andn2_b32 s6, s6, 127
    v_cmp_eq_u32 vcc, 6, v2
    v_mov_b32 v4, s6
    s_nop 0
    v_cndmask_b32 v3, v3, v4, vcc
    s_lshl_b32 s6, s2, 7
    s_add_u32 s6, s6, 2621440
    s_andn2_b32 s6, s6, 127
    v_cmp_eq_u32 vcc, 7, v2
    v_mov_b32 v4, s6
    s_nop 0
    v_cndmask_b32 v3, v3, v4, vcc
    v_add_u32 v4, 160896, v13
    s_mov_b32 exec_lo, 0
    s_mov_b32 exec_hi, 0x03000000
    ds_read_b128 v[36:39], v4
    s_mov_b64 exec, -1
    s_waitcnt lgkmcnt(0)
L_z7:
    v_and_b32 v2, 7, v1
    v_lshl_add_u32 v3, v2, 4, v3
    buffer_store_dwordx4 v[36:39], v3, s[8:11], 0 offen sc1
L_zd:
    s_cmp_ge_u32 s76, 2
    s_cbranch_scc1 L_tch_2a
    s_and_b32 s6, s4, 3
    s_lshl_b32 s6, s6, 19
    s_lshl_b32 s7, s5, 15
    s_add_u32 s6, s6, s7
    s_lshl_b32 s7, s76, 7
    s_add_u32 s6, s6, s7
    s_add_u32 s6, s6, 768
    v_lshrrev_b32 v6, 1, v1
    v_lshlrev_b32 v6, 10, v6
    v_and_b32 v7, 1, v1
    v_lshl_add_u32 v6, v7, 6, v6
    buffer_load_dword v11, v6, s[12:15], s6 offen
    s_add_u32 s6, s6, 262144
    buffer_load_dword v11, v6, s[12:15], s6 offen
    s_branch L_tch_2c
L_tch_2a:
    v_lshrrev_b32 v6, 5, v1
    v_lshlrev_b32 v6, 6, v6
    v_bfe_u32 v7, v1, 2, 3
    v_add_u32 v6, v6, v7
    v_lshlrev_b32 v6, 13, v6
    v_and_b32 v7, 3, v1
    v_lshl_add_u32 v6, v7, 6, v6
    s_lshl_b32 s6, s4, 8
    s_lshl_b32 s7, s5, 16
    s_add_u32 s6, s6, s7
    s_add_u32 s6, s6, 3145728
    s_cmp_lg_u32 s76, 2
    s_cbranch_scc1 L_tch_2b
    buffer_load_dword v11, v6, s[16:19], s6 offen
    s_branch L_tch_2c
L_tch_2b:
    buffer_load_dword v11, v6, s[20:23], s6 offen
L_tch_2c:
    s_branch L_hook_back
L_hook4:
    s_cmp_lg_u32 s3, 4
    s_cbranch_scc1 L_hook4b
    s_mov_b32 s28, s56
    s_mov_b32 s29, s57
    s_mov_b32 s30, 0x100
    s_mov_b32 s31, 0x20000
    v_mov_b32 v2, 1
    v_lshlrev_b32 v3, 8, v1
    s_and_b32 s6, s2, 31
    s_lshl_b32 s6, s6, 2
    buffer_atomic_add v2, v3, s[28:31], s6 offen offset:0 sc1
L_hook4b:
    s_lshl_b32 s74, s76, 12
    s_add_u32 s74, s74, 131072
    s_mov_b32 m0, s74
    s_add_u32 s74, s74, 16384
    buffer_load_dwordx4 v44, s[24:27], s71 offen offset:0 lds
    buffer_load_dwordx4 v45, s[24:27], s71 offen offset:1024 lds
    buffer_load_dwordx4 v46, s[24:27], s71 offen offset:2048 lds
    buffer_load_dwordx4 v47, s[24:27], s71 offen offset:3072 lds
    s_add_u32 s71, s71, 524288
    s_sub_u32 s75, s71, 5242880
    s_cselect_b32 s71, s71, s75
    s_mov_b32 m0, s74
    s_add_u32 s74, s74, 16384
    buffer_load_dwordx4 v44, s[24:27], s71 offen offset:0 lds
    buffer_load_dwordx4 v45, s[24:27], s71 offen offset:1024 lds
    buffer_load_dwordx4 v46, s[24:27], s71 offen offset:2048 lds
    buffer_load_dwordx4 v47, s[24:27], s71 offen offset:3072 lds
    s_add_u32 s71, s71, 524288
    s_sub_u32 s75, s71, 5242880
    s_cselect_b32 s71, s71, s75
    s_branch L_hook_back
L_hook6:
    s_cmp_lg_u32 s3, 5
    s_cbranch_scc1 L_hook_back
    s_mov_b32 s28, s56
    s_mov_b32 s29, s57
    s_mov_b32 s30, 0x100
    s_mov_b32 s31, 0x20000
    v_and_b32 v3, 31, v1
    v_lshlrev_b32 v3, 2, v3
    buffer_load_dword v62, v3, s[28:31], 0 offen offset:0 sc1
    s_branch L_hook_back
L_vpre:
    s_waitcnt vmcnt(0)
    s_lshl_b32 s6, s65, 4
    s_add_u32 s6, s6, s3
    s_cmp_lg_u32 s6, 0x65
    s_cbranch_scc1 L_vnow
    v_cmp_gt_u32 vcc, 8, v62
    s_cbranch_vccz L_cntok_3
    s_mov_b32 s28, s56
    s_mov_b32 s29, s57
    s_mov_b32 s30, 0x100
    s_mov_b32 s31, 0x20000
    v_and_b32 v3, 31, v1
    v_lshlrev_b32 v3, 2, v3
    s_mov_b32 s79, 262144
L_poll_4:
    buffer_load_dword v2, v3, s[28:31], 0 offen offset:0 sc1
    s_waitcnt vmcnt(0)
    v_cmp_gt_u32 vcc, 8, v2
    s_cbranch_vccz L_polldone_5
    s_sleep 8
    s_sub_u32 s79, s79, 1
    s_cmp_lg_u32 s79, 0
    s_cbranch_scc1 L_poll_4
L_polldone_5:
L_cntok_3:
    s_branch L_vnow
L_khook:
    s_cmp_lg_u32 s65, 7
    s_cbranch_scc1 L_khook_back
    buffer_load_dwordx4 v[16:19], v13, s[8:11], s84 offen offset:0 sc1
    buffer_load_dwordx4 v[20:23], v12, s[8:11], s84 offen offset:0 sc1
    buffer_load_dwordx4 v[24:27], v13, s[8:11], s84 offen offset:1024 sc1
    buffer_load_dwordx4 v[28:31], v12, s[8:11], s84 offen offset:1024 sc1
    buffer_load_dwordx4 v[32:35], v13, s[8:11], s84 offen offset:2048 sc1
    buffer_load_dwordx4 v[36:39], v12, s[8:11], s84 offen offset:2048 sc1
    s_branch L_khook_back
L_kv_v:
    ds_read_b128 v[64:67], v48 offset:0
    ds_read_b128 v[68:71], v48 offset:2048
    ds_read_b64_tr_b16 v[96:97], v50 offset:0
    ds_read_b64_tr_b16 v[98:99], v50 offset:1024
    ds_read_b64_tr_b16 v[100:101], v51 offset:0
    ds_read_b64_tr_b16 v[102:103], v51 offset:1024
    ds_read_b128 v[72:75], v48 offset:4096
    ds_read_b64_tr_b16 v[104:105], v52 offset:0
    ds_read_b64_tr_b16 v[106:107], v52 offset:1024
    ds_read_b64_tr_b16 v[108:109], v53 offset:0
    ds_read_b64_tr_b16 v[110:111], v53 offset:1024
    ds_read_b128 v[76:79], v48 offset:6144
    ds_read_b128 v[80:83], v48 offset:8192
    ds_read_b128 v[84:87], v48 offset:10240
    ds_read_b128 v[88:91], v48 offset:12288
    ds_read_b128 v[92:95], v48 offset:14336
    s_cmp_ge_u32 s76, 2
    s_cbranch_scc1 L_tch_6a
    s_and_b32 s6, s4, 3
    s_lshl_b32 s6, s6, 19
    s_lshl_b32 s7, s5, 15
    s_add_u32 s6, s6, s7
    s_lshl_b32 s7, s76, 7
    s_add_u32 s6, s6, s7
    s_add_u32 s6, s6, 256
    v_lshrrev_b32 v6, 1, v1
    v_lshlrev_b32 v6, 10, v6
    v_and_b32 v7, 1, v1
    v_lshl_add_u32 v6, v7, 6, v6
    buffer_load_dword v11, v6, s[12:15], s6 offen
    s_add_u32 s6, s6, 262144
    buffer_load_dword v11, v6, s[12:15], s6 offen
    s_branch L_tch_6c
L_tch_6a:
    v_lshrrev_b32 v6, 5, v1
    v_lshlrev_b32 v6, 6, v6
    v_bfe_u32 v7, v1, 2, 3
    v_add_u32 v6, v6, v7
    v_lshlrev_b32 v6, 13, v6
    v_and_b32 v7, 3, v1
    v_lshl_add_u32 v6, v7, 6, v6
    s_lshl_b32 s6, s4, 8
    s_lshl_b32 s7, s5, 16
    s_add_u32 s6, s6, s7
    s_add_u32 s6, s6, 1048576
    s_cmp_lg_u32 s76, 2
    s_cbranch_scc1 L_tch_6b
    buffer_load_dword v11, v6, s[16:19], s6 offen
    s_branch L_tch_6c
L_tch_6b:
    buffer_load_dword v11, v6, s[20:23], s6 offen
L_tch_6c:
.p2align 4
L_vloop:
    s_bitcmp1_b32 214, s65
    s_cbranch_scc1 L_hook
L_hook_back:
    s_waitcnt lgkmcnt(12)
    v_mfma_f32_16x16x32_bf16 v[128:131], v[64:67], v[96:99], v[128:131]
    ds_read_b64_tr_b16 v[112:113], v50 offset:8192
    s_waitcnt lgkmcnt(11)
    v_mfma_f32_16x16x32_bf16 v[132:135], v[64:67], v[100:103], v[132:135]
    ds_read_b64_tr_b16 v[114:115], v50 offset:9216
    s_waitcnt lgkmcnt(9)
    v_mfma_f32_16x16x32_bf16 v[136:139], v[64:67], v[104:107], v[136:139]
    ds_read_b64_tr_b16 v[116:117], v51 offset:8192
    s_waitcnt lgkmcnt(8)
    v_mfma_f32_16x16x32_bf16 v[140:143], v[64:67], v[108:111], v[140:143]
    ds_read_b64_tr_b16 v[118:119], v51 offset:9216
    ds_read_b128 v[64:67], v49 offset:0
    v_mfma_f32_16x16x32_bf16 v[144:147], v[68:71], v[96:99], v[144:147]
    ds_read_b64_tr_b16 v[120:121], v52 offset:8192
    v_mfma_f32_16x16x32_bf16 v[148:151], v[68:71], v[100:103], v[148:151]
    ds_read_b64_tr_b16 v[122:123], v52 offset:9216
    v_mfma_f32_16x16x32_bf16 v[152:155], v[68:71], v[104:107], v[152:155]
    ds_read_b64_tr_b16 v[124:125], v53 offset:8192
    v_mfma_f32_16x16x32_bf16 v[156:159], v[68:71], v[108:111], v[156:159]
    ds_read_b64_tr_b16 v[126:127], v53 offset:9216
    ds_read_b128 v[68:71], v49 offset:2048
    v_mfma_f32_16x16x32_bf16 v[160:163], v[72:75], v[96:99], v[160:163]
    v_mfma_f32_16x16x32_bf16 v[164:167], v[72:75], v[100:103], v[164:167]
    v_mfma_f32_16x16x32_bf16 v[168:171], v[72:75], v[104:107], v[168:171]
    v_mfma_f32_16x16x32_bf16 v[172:175], v[72:75], v[108:111], v[172:175]
    ds_read_b128 v[72:75], v49 offset:4096
    s_waitcnt lgkmcnt(15)
    v_mfma_f32_16x16x32_bf16 v[176:179], v[76:79], v[96:99], v[176:179]
    v_mfma_f32_16x16x32_bf16 v[180:183], v[76:79], v[100:103], v[180:183]
    v_mfma_f32_16x16x32_bf16 v[184:187], v[76:79], v[104:107], v[184:187]
    v_mfma_f32_16x16x32_bf16 v[188:191], v[76:79], v[108:111], v[188:191]
    ds_read_b128 v[76:79], v49 offset:6144
    s_waitcnt lgkmcnt(15)
    v_mfma_f32_16x16x32_bf16 v[192:195], v[80:83], v[96:99], v[192:195]
    v_mfma_f32_16x16x32_bf16 v[196:199], v[80:83], v[100:103], v[196:199]
    v_mfma_f32_16x16x32_bf16 v[200:203], v[80:83], v[104:107], v[200:203]
    v_mfma_f32_16x16x32_bf16 v[204:207], v[80:83], v[108:111], v[204:207]
    ds_read_b128 v[80:83], v49 offset:8192
    s_waitcnt lgkmcnt(15)
    v_mfma_f32_16x16x32_bf16 v[208:211], v[84:87], v[96:99], v[208:211]
    v_mfma_f32_16x16x32_bf16 v[212:215], v[84:87], v[100:103], v[212:215]
    v_mfma_f32_16x16x32_bf16 v[216:219], v[84:87], v[104:107], v[216:219]
    v_mfma_f32_16x16x32_bf16 v[220:223], v[84:87], v[108:111], v[220:223]
    ds_read_b128 v[84:87], v49 offset:10240
    s_waitcnt lgkmcnt(15)
    v_mfma_f32_16x16x32_bf16 v[224:227], v[88:91], v[96:99], v[224:227]
    v_mfma_f32_16x16x32_bf16 v[228:231], v[88:91], v[100:103], v[228:231]
    v_mfma_f32_16x16x32_bf16 v[232:235], v[88:91], v[104:107], v[232:235]
    v_mfma_f32_16x16x32_bf16 v[236:239], v[88:91], v[108:111], v[236:239]
    ds_read_b128 v[88:91], v49 offset:12288
    s_waitcnt lgkmcnt(15)
    v_mfma_f32_16x16x32_bf16 v[240:243], v[92:95], v[96:99], v[240:243]
    v_mfma_f32_16x16x32_bf16 v[244:247], v[92:95], v[100:103], v[244:247]
    v_mfma_f32_16x16x32_bf16 v[248:251], v[92:95], v[104:107], v[248:251]
    v_mfma_f32_16x16x32_bf16 v[252:255], v[92:95], v[108:111], v[252:255]
    ds_read_b128 v[92:95], v49 offset:14336
    s_waitcnt lgkmcnt(11)
    v_mfma_f32_16x16x32_bf16 v[128:131], v[64:67], v[112:115], v[128:131]
    v_mfma_f32_16x16x32_bf16 v[132:135], v[64:67], v[116:119], v[132:135]
    s_waitcnt lgkmcnt(9)
    v_mfma_f32_16x16x32_bf16 v[136:139], v[64:67], v[120:123], v[136:139]
    s_waitcnt lgkmcnt(7)
    v_mfma_f32_16x16x32_bf16 v[140:143], v[64:67], v[124:127], v[140:143]
    s_waitcnt lgkmcnt(6)
    v_mfma_f32_16x16x32_bf16 v[144:147], v[68:71], v[112:115], v[144:147]
    v_mfma_f32_16x16x32_bf16 v[148:151], v[68:71], v[116:119], v[148:151]
    v_mfma_f32_16x16x32_bf16 v[152:155], v[68:71], v[120:123], v[152:155]
    v_mfma_f32_16x16x32_bf16 v[156:159], v[68:71], v[124:127], v[156:159]
    v_xor_b32 v48, 0x10000, v48
    v_xor_b32 v49, 0x10000, v49
    v_xor_b32 v50, 0x10000, v50
    v_xor_b32 v51, 0x10000, v51
    v_xor_b32 v52, 0x10000, v52
    v_xor_b32 v53, 0x10000, v53
    s_bitcmp1_b32 0x48, s65
    s_cbranch_scc1 L_vpre
L_vnow:
    s_waitcnt lgkmcnt(0)
    s_barrier
    ds_read_b128 v[64:67], v48 offset:0
    ds_read_b128 v[68:71], v48 offset:2048
    v_mfma_f32_16x16x32_bf16 v[160:163], v[72:75], v[112:115], v[160:163]
    ds_read_b64_tr_b16 v[96:97], v50 offset:0
    v_mfma_f32_16x16x32_bf16 v[164:167], v[72:75], v[116:119], v[164:167]
    ds_read_b64_tr_b16 v[98:99], v50 offset:1024
    v_mfma_f32_16x16x32_bf16 v[168:171], v[72:75], v[120:123], v[168:171]
    ds_read_b64_tr_b16 v[100:101], v51 offset:0
    v_mfma_f32_16x16x32_bf16 v[172:175], v[72:75], v[124:127], v[172:175]
    ds_read_b64_tr_b16 v[102:103], v51 offset:1024
    ds_read_b128 v[72:75], v48 offset:4096
    v_mfma_f32_16x16x32_bf16 v[176:179], v[76:79], v[112:115], v[176:179]
    ds_read_b64_tr_b16 v[104:105], v52 offset:0
    v_mfma_f32_16x16x32_bf16 v[180:183], v[76:79], v[116:119], v[180:183]
    ds_read_b64_tr_b16 v[106:107], v52 offset:1024
    v_mfma_f32_16x16x32_bf16 v[184:187], v[76:79], v[120:123], v[184:187]
    ds_read_b64_tr_b16 v[108:109], v53 offset:0
    v_mfma_f32_16x16x32_bf16 v[188:191], v[76:79], v[124:127], v[188:191]
    ds_read_b64_tr_b16 v[110:111], v53 offset:1024
    ds_read_b128 v[76:79], v48 offset:6144
    v_mfma_f32_16x16x32_bf16 v[192:195], v[80:83], v[112:115], v[192:195]
    v_mfma_f32_16x16x32_bf16 v[196:199], v[80:83], v[116:119], v[196:199]
    v_mfma_f32_16x16x32_bf16 v[200:203], v[80:83], v[120:123], v[200:203]
    v_mfma_f32_16x16x32_bf16 v[204:207], v[80:83], v[124:127], v[204:207]
    ds_read_b128 v[80:83], v48 offset:8192
    v_mfma_f32_16x16x32_bf16 v[208:211], v[84:87], v[112:115], v[208:211]
    v_mfma_f32_16x16x32_bf16 v[212:215], v[84:87], v[116:119], v[212:215]
    v_mfma_f32_16x16x32_bf16 v[216:219], v[84:87], v[120:123], v[216:219]
    v_mfma_f32_16x16x32_bf16 v[220:223], v[84:87], v[124:127], v[220:223]
    ds_read_b128 v[84:87], v48 offset:10240
    v_mfma_f32_16x16x32_bf16 v[224:227], v[88:91], v[112:115], v[224:227]
    v_mfma_f32_16x16x32_bf16 v[228:231], v[88:91], v[116:119], v[228:231]
    v_mfma_f32_16x16x32_bf16 v[232:235], v[88:91], v[120:123], v[232:235]
    v_mfma_f32_16x16x32_bf16 v[236:239], v[88:91], v[124:127], v[236:239]
    ds_read_b128 v[88:91], v48 offset:12288
    v_mfma_f32_16x16x32_bf16 v[240:243], v[92:95], v[112:115], v[240:243]
    v_mfma_f32_16x16x32_bf16 v[244:247], v[92:95], v[116:119], v[244:247]
    v_mfma_f32_16x16x32_bf16 v[248:251], v[92:95], v[120:123], v[248:251]
    v_mfma_f32_16x16x32_bf16 v[252:255], v[92:95], v[124:127], v[252:255]
    ds_read_b128 v[92:95], v48 offset:14336
    s_add_u32 s65, s65, 1
    s_cmp_lt_u32 s65, 8
    s_cbranch_scc1 L_vloop
    s_waitcnt lgkmcnt(0)
    s_nop 7
    v_cvt_pk_bf16_f32 v128, v128, v129
    v_cvt_pk_bf16_f32 v129, v130, v131
    v_cvt_pk_bf16_f32 v130, v144, v145
    v_cvt_pk_bf16_f32 v131, v146, v147
    v_cvt_pk_bf16_f32 v132, v132, v133
    v_cvt_pk_bf16_f32 v133, v134, v135
    v_cvt_pk_bf16_f32 v134, v148, v149
    v_cvt_pk_bf16_f32 v135, v150, v151
    v_cvt_pk_bf16_f32 v136, v136, v137
    v_cvt_pk_bf16_f32 v137, v138, v139
    v_cvt_pk_bf16_f32 v138, v152, v153
    v_cvt_pk_bf16_f32 v139, v154, v155
    v_cvt_pk_bf16_f32 v140, v140, v141
    v_cvt_pk_bf16_f32 v141, v142, v143
    v_cvt_pk_bf16_f32 v142, v156, v157
    v_cvt_pk_bf16_f32 v143, v158, v159
    v_cvt_pk_bf16_f32 v144, v160, v161
    v_cvt_pk_bf16_f32 v145, v162, v163
    v_cvt_pk_bf16_f32 v146, v176, v177
    v_cvt_pk_bf16_f32 v147, v178, v179
    v_cvt_pk_bf16_f32 v148, v164, v165
    v_cvt_pk_bf16_f32 v149, v166, v167
    v_cvt_pk_bf16_f32 v150, v180, v181
    v_cvt_pk_bf16_f32 v151, v182, v183
    v_cvt_pk_bf16_f32 v152, v168, v169
    v_cvt_pk_bf16_f32 v153, v170, v171
    v_cvt_pk_bf16_f32 v154, v184, v185
    v_cvt_pk_bf16_f32 v155, v186, v187
    v_cvt_pk_bf16_f32 v156, v172, v173
    v_cvt_pk_bf16_f32 v157, v174, v175
    v_cvt_pk_bf16_f32 v158, v188, v189
    v_cvt_pk_bf16_f32 v159, v190, v191
    v_cvt_pk_bf16_f32 v160, v192, v193
    v_cvt_pk_bf16_f32 v161, v194, v195
    v_cvt_pk_bf16_f32 v162, v208, v209
    v_cvt_pk_bf16_f32 v163, v210, v211
    v_cvt_pk_bf16_f32 v164, v196, v197
    v_cvt_pk_bf16_f32 v165, v198, v199
    v_cvt_pk_bf16_f32 v166, v212, v213
    v_cvt_pk_bf16_f32 v167, v214, v215
    v_cvt_pk_bf16_f32 v168, v200, v201
    v_cvt_pk_bf16_f32 v169, v202, v203
    v_cvt_pk_bf16_f32 v170, v216, v217
    v_cvt_pk_bf16_f32 v171, v218, v219
    v_cvt_pk_bf16_f32 v172, v204, v205
    v_cvt_pk_bf16_f32 v173, v206, v207
    v_cvt_pk_bf16_f32 v174, v220, v221
    v_cvt_pk_bf16_f32 v175, v222, v223
    v_cvt_pk_bf16_f32 v176, v224, v225
    v_cvt_pk_bf16_f32 v177, v226, v227
    v_cvt_pk_bf16_f32 v178, v240, v241
    v_cvt_pk_bf16_f32 v179, v242, v243
    v_cvt_pk_bf16_f32 v180, v228, v229
    v_cvt_pk_bf16_f32 v181, v230, v231
    v_cvt_pk_bf16_f32 v182, v244, v245
    v_cvt_pk_bf16_f32 v183, v246, v247
    v_cvt_pk_bf16_f32 v184, v232, v233
    v_cvt_pk_bf16_f32 v185, v234, v235
    v_cvt_pk_bf16_f32 v186, v248, v249
    v_cvt_pk_bf16_f32 v187, v250, v251
    v_cvt_pk_bf16_f32 v188, v236, v237
    v_cvt_pk_bf16_f32 v189, v238, v239
    v_cvt_pk_bf16_f32 v190, v252, v253
    v_cvt_pk_bf16_f32 v191, v254, v255
    s_waitcnt vmcnt(0)
L_q:
    s_mov_b32 s28, s56
    s_mov_b32 s29, s57
    s_mov_b32 s30, 0x100
    s_mov_b32 s31, 0x20000
    s_lshl_b32 s6, s76, 13
    v_add_u32 v49, s6, v13
    s_lshl_b32 s6, s76, 12
    v_add_u32 v50, s6, v13
    s_lshl_b32 s77, s4, 20
    s_add_u32 s77, s77, 16777216
    s_mov_b32 s78, s100
    s_sub_u32 s101, s100, 131072
    s_mov_b32 s90, 0
    s_cmp_lt_u32 s3, 4
    s_cselect_b32 s89, 3, 2
    ds_read_b64_tr_b16 v[96:97], v54 offset:0
    ds_read_b64_tr_b16 v[98:99], v54 offset:1024
    ds_read_b64_tr_b16 v[100:101], v55 offset:0
    ds_read_b64_tr_b16 v[102:103], v55 offset:1024
    ds_read_b64_tr_b16 v[104:105], v56 offset:0
    ds_read_b64_tr_b16 v[106:107], v56 offset:1024
    ds_read_b64_tr_b16 v[108:109], v57 offset:0
    ds_read_b64_tr_b16 v[110:111], v57 offset:1024
    ds_read_b64_tr_b16 v[112:113], v58 offset:0
    ds_read_b64_tr_b16 v[114:115], v58 offset:1024
    ds_read_b64_tr_b16 v[116:117], v59 offset:0
    ds_read_b64_tr_b16 v[118:119], v59 offset:1024
    ds_read_b64_tr_b16 v[120:121], v60 offset:0
    ds_read_b64_tr_b16 v[122:123], v60 offset:1024
    ds_read_b64_tr_b16 v[124:125], v61 offset:0
    ds_read_b64_tr_b16 v[126:127], v61 offset:1024
    buffer_load_dwordx4 v[64:67], v13, s[8:11], s84 offen offset:3072 sc1
    buffer_load_dwordx4 v[68:71], v12, s[8:11], s84 offen offset:3072 sc1
    buffer_load_dwordx4 v[72:75], v13, s[8:11], s85 offen offset:0 sc1
    buffer_load_dwordx4 v[76:79], v12, s[8:11], s85 offen offset:0 sc1
    buffer_load_dwordx4 v[80:83], v13, s[8:11], s85 offen offset:1024 sc1
    buffer_load_dwordx4 v[84:87], v12, s[8:11], s85 offen offset:1024 sc1
    buffer_load_dwordx4 v[88:91], v13, s[8:11], s85 offen offset:2048 sc1
    buffer_load_dwordx4 v[92:95], v12, s[8:11], s85 offen offset:2048 sc1
    s_waitcnt lgkmcnt(14)
    v_mfma_f32_16x16x32_bf16 v[192:195], v[96:99], v[16:19], 0
    v_mfma_f32_16x16x32_bf16 v[196:199], v[96:99], v[20:23], 0
    ds_read_b64_tr_b16 v[96:97], v54 offset:8192
    s_waitcnt lgkmcnt(13)
    v_mfma_f32_16x16x32_bf16 v[200:203], v[100:103], v[16:19], 0
    ds_read_b64_tr_b16 v[98:99], v54 offset:9216
    v_mfma_f32_16x16x32_bf16 v[204:207], v[100:103], v[20:23], 0
    ds_read_b64_tr_b16 v[100:101], v55 offset:8192
    s_waitcnt lgkmcnt(13)
    v_mfma_f32_16x16x32_bf16 v[208:211], v[104:107], v[16:19], 0
    ds_read_b64_tr_b16 v[102:103], v55 offset:9216
    v_mfma_f32_16x16x32_bf16 v[212:215], v[104:107], v[20:23], 0
    ds_read_b64_tr_b16 v[104:105], v56 offset:8192
    s_waitcnt lgkmcnt(13)
    v_mfma_f32_16x16x32_bf16 v[216:219], v[108:111], v[16:19], 0
    ds_read_b64_tr_b16 v[106:107], v56 offset:9216
    buffer_store_dwordx4 v[128:131], v13, s[8:11], s67 offen sc1
    s_add_u32 s67, s67, 1024
    v_mfma_f32_16x16x32_bf16 v[220:223], v[108:111], v[20:23], 0
    ds_read_b64_tr_b16 v[108:109], v57 offset:8192
    s_waitcnt lgkmcnt(13)
    v_mfma_f32_16x16x32_bf16 v[224:227], v[112:115], v[16:19], 0
    ds_read_b64_tr_b16 v[110:111], v57 offset:9216
    v_mfma_f32_16x16x32_bf16 v[228:231], v[112:115], v[20:23], 0
    ds_read_b64_tr_b16 v[112:113], v58 offset:8192
    s_waitcnt lgkmcnt(13)
    v_mfma_f32_16x16x32_bf16 v[232:235], v[116:119], v[16:19], 0
    ds_read_b64_tr_b16 v[114:115], v58 offset:9216
    v_mfma_f32_16x16x32_bf16 v[236:239], v[116:119], v[20:23], 0
    ds_read_b64_tr_b16 v[116:117], v59 offset:8192
    s_waitcnt lgkmcnt(13)
    v_mfma_f32_16x16x32_bf16 v[240:243], v[120:123], v[16:19], 0
    ds_read_b64_tr_b16 v[118:119], v59 offset:9216
    v_mfma_f32_16x16x32_bf16 v[244:247], v[120:123], v[20:23], 0
    ds_read_b64_tr_b16 v[120:121], v60 offset:8192
    s_waitcnt lgkmcnt(13)
    v_mfma_f32_16x16x32_bf16 v[248:251], v[124:127], v[16:19], 0
    ds_read_b64_tr_b16 v[122:123], v60 offset:9216
    v_mfma_f32_16x16x32_bf16 v[252:255], v[124:127], v[20:23], 0
    ds_read_b64_tr_b16 v[124:125], v61 offset:8192
    ds_read_b64_tr_b16 v[126:127], v61 offset:9216
    buffer_load_dwordx4 v[16:19], v13, s[8:11], s85 offen offset:3072 sc1
    buffer_load_dwordx4 v[20:23], v12, s[8:11], s85 offen offset:3072 sc1
    s_waitcnt lgkmcnt(14)
    v_mfma_f32_16x16x32_bf16 v[192:195], v[96:99], v[24:27], v[192:195]
    v_mfma_f32_16x16x32_bf16 v[196:199], v[96:99], v[28:31], v[196:199]
    ds_read_b64_tr_b16 v[96:97], v54 offset:16384
    s_waitcnt lgkmcnt(13)
    v_mfma_f32_16x16x32_bf16 v[200:203], v[100:103], v[24:27], v[200:203]
    ds_read_b64_tr_b16 v[98:99], v54 offset:17408
    v_mfma_f32_16x16x32_bf16 v[204:207], v[100:103], v[28:31], v[204:207]
    ds_read_b64_tr_b16 v[100:101], v55 offset:16384
    s_waitcnt lgkmcnt(13)
    v_mfma_f32_16x16x32_bf16 v[208:211], v[104:107], v[24:27], v[208:211]
    ds_read_b64_tr_b16 v[102:103], v55 offset:17408
    v_mfma_f32_16x16x32_bf16 v[212:215], v[104:107], v[28:31], v[212:215]
    ds_read_b64_tr_b16 v[104:105], v56 offset:16384
    s_waitcnt lgkmcnt(13)
    v_mfma_f32_16x16x32_bf16 v[216:219], v[108:111], v[24:27], v[216:219]
    ds_read_b64_tr_b16 v[106:107], v56 offset:17408
    buffer_store_dwordx4 v[132:135], v13, s[8:11], s67 offen sc1
    s_add_u32 s67, s67, s68
    v_mfma_f32_16x16x32_bf16 v[220:223], v[108:111], v[28:31], v[220:223]
    ds_read_b64_tr_b16 v[108:109], v57 offset:16384
    s_waitcnt lgkmcnt(13)
    v_mfma_f32_16x16x32_bf16 v[224:227], v[112:115], v[24:27], v[224:227]
    ds_read_b64_tr_b16 v[110:111], v57 offset:17408
    v_mfma_f32_16x16x32_bf16 v[228:231], v[112:115], v[28:31], v[228:231]
    ds_read_b64_tr_b16 v[112:113], v58 offset:16384
    s_waitcnt lgkmcnt(13)
    v_mfma_f32_16x16x32_bf16 v[232:235], v[116:119], v[24:27], v[232:235]
    ds_read_b64_tr_b16 v[114:115], v58 offset:17408
    v_mfma_f32_16x16x32_bf16 v[236:239], v[116:119], v[28:31], v[236:239]
    ds_read_b64_tr_b16 v[116:117], v59 offset:16384
    s_waitcnt lgkmcnt(13)
    v_mfma_f32_16x16x32_bf16 v[240:243], v[120:123], v[24:27], v[240:243]
    ds_read_b64_tr_b16 v[118:119], v59 offset:17408
    v_mfma_f32_16x16x32_bf16 v[244:247], v[120:123], v[28:31], v[244:247]
    ds_read_b64_tr_b16 v[120:121], v60 offset:16384
    s_waitcnt lgkmcnt(13)
    v_mfma_f32_16x16x32_bf16 v[248:251], v[124:127], v[24:27], v[248:251]
    ds_read_b64_tr_b16 v[122:123], v60 offset:17408
    v_mfma_f32_16x16x32_bf16 v[252:255], v[124:127], v[28:31], v[252:255]
    ds_read_b64_tr_b16 v[124:125], v61 offset:16384
    ds_read_b64_tr_b16 v[126:127], v61 offset:17408
    buffer_load_dwordx4 v[24:27], v13, s[8:11], s86 offen offset:0 sc1
    buffer_load_dwordx4 v[28:31], v12, s[8:11], s86 offen offset:0 sc1
    s_waitcnt lgkmcnt(14)
    v_mfma_f32_16x16x32_bf16 v[192:195], v[96:99], v[32:35], v[192:195]
    v_mfma_f32_16x16x32_bf16 v[196:199], v[96:99], v[36:39], v[196:199]
    ds_read_b64_tr_b16 v[96:97], v54 offset:24576
    s_waitcnt lgkmcnt(13)
    v_mfma_f32_16x16x32_bf16 v[200:203], v[100:103], v[32:35], v[200:203]
    ds_read_b64_tr_b16 v[98:99], v54 offset:25600
    v_mfma_f32_16x16x32_bf16 v[204:207], v[100:103], v[36:39], v[204:207]
    ds_read_b64_tr_b16 v[100:101], v55 offset:24576
    s_waitcnt lgkmcnt(13)
    v_mfma_f32_16x16x32_bf16 v[208:211], v[104:107], v[32:35], v[208:211]
    ds_read_b64_tr_b16 v[102:103], v55 offset:25600
    v_mfma_f32_16x16x32_bf16 v[212:215], v[104:107], v[36:39], v[212:215]
    ds_read_b64_tr_b16 v[104:105], v56 offset:24576
    s_waitcnt lgkmcnt(13)
    v_mfma_f32_16x16x32_bf16 v[216:219], v[108:111], v[32:35], v[216:219]
    ds_read_b64_tr_b16 v[106:107], v56 offset:25600
    buffer_store_dwordx4 v[136:139], v13, s[8:11], s67 offen sc1
    s_add_u32 s67, s67, 1024
    v_mfma_f32_16x16x32_bf16 v[220:223], v[108:111], v[36:39], v[220:223]
    ds_read_b64_tr_b16 v[108:109], v57 offset:24576
    s_waitcnt lgkmcnt(13)
    v_mfma_f32_16x16x32_bf16 v[224:227], v[112:115], v[32:35], v[224:227]
    ds_read_b64_tr_b16 v[110:111], v57 offset:25600
    v_mfma_f32_16x16x32_bf16 v[228:231], v[112:115], v[36:39], v[228:231]
    ds_read_b64_tr_b16 v[112:113], v58 offset:24576
    s_waitcnt lgkmcnt(13)
    v_mfma_f32_16x16x32_bf16 v[232:235], v[116:119], v[32:35], v[232:235]
    ds_read_b64_tr_b16 v[114:115], v58 offset:25600
    v_mfma_f32_16x16x32_bf16 v[236:239], v[116:119], v[36:39], v[236:239]
    ds_read_b64_tr_b16 v[116:117], v59 offset:24576
    s_waitcnt lgkmcnt(13)
    v_mfma_f32_16x16x32_bf16 v[240:243], v[120:123], v[32:35], v[240:243]
    ds_read_b64_tr_b16 v[118:119], v59 offset:25600
    v_mfma_f32_16x16x32_bf16 v[244:247], v[120:123], v[36:39], v[244:247]
    ds_read_b64_tr_b16 v[120:121], v60 offset:24576
    s_waitcnt lgkmcnt(13)
    v_mfma_f32_16x16x32_bf16 v[248:251], v[124:127], v[32:35], v[248:251]
    ds_read_b64_tr_b16 v[122:123], v60 offset:25600
    v_mfma_f32_16x16x32_bf16 v[252:255], v[124:127], v[36:39], v[252:255]
    ds_read_b64_tr_b16 v[124:125], v61 offset:24576
    ds_read_b64_tr_b16 v[126:127], v61 offset:25600
    buffer_load_dwordx4 v[32:35], v13, s[8:11], s86 offen offset:1024 sc1
    buffer_load_dwordx4 v[36:39], v12, s[8:11], s86 offen offset:1024 sc1
    s_waitcnt vmcnt(15)
    s_waitcnt lgkmcnt(14)
    v_mfma_f32_16x16x32_bf16 v[192:195], v[96:99], v[64:67], v[192:195]
    v_add_u32 v54, s101, v54
    v_mfma_f32_16x16x32_bf16 v[196:199], v[96:99], v[68:71], v[196:199]
    ds_read_b64_tr_b16 v[96:97], v54 offset:0
    s_waitcnt lgkmcnt(13)
    v_mfma_f32_16x16x32_bf16 v[200:203], v[100:103], v[64:67], v[200:203]
    ds_read_b64_tr_b16 v[98:99], v54 offset:1024
    v_add_u32 v55, s101, v55
    v_mfma_f32_16x16x32_bf16 v[204:207], v[100:103], v[68:71], v[204:207]
    ds_read_b64_tr_b16 v[100:101], v55 offset:0
    s_waitcnt lgkmcnt(13)
    v_mfma_f32_16x16x32_bf16 v[208:211], v[104:107], v[64:67], v[208:211]
    ds_read_b64_tr_b16 v[102:103], v55 offset:1024
    v_add_u32 v56, s101, v56
    v_mfma_f32_16x16x32_bf16 v[212:215], v[104:107], v[68:71], v[212:215]
    ds_read_b64_tr_b16 v[104:105], v56 offset:0
    s_waitcnt lgkmcnt(13)
    v_mfma_f32_16x16x32_bf16 v[216:219], v[108:111], v[64:67], v[216:219]
    ds_read_b64_tr_b16 v[106:107], v56 offset:1024
    v_add_u32 v57, s101, v57
    buffer_store_dwordx4 v[140:143], v13, s[8:11], s67 offen sc1
    s_add_u32 s67, s67, s69
    v_mfma_f32_16x16x32_bf16 v[220:223], v[108:111], v[68:71], v[220:223]
    ds_read_b64_tr_b16 v[108:109], v57 offset:0
    s_waitcnt lgkmcnt(13)
    v_mfma_f32_16x16x32_bf16 v[224:227], v[112:115], v[64:67], v[224:227]
    ds_read_b64_tr_b16 v[110:111], v57 offset:1024
    v_add_u32 v58, s101, v58
    v_mfma_f32_16x16x32_bf16 v[228:231], v[112:115], v[68:71], v[228:231]
    ds_read_b64_tr_b16 v[112:113], v58 offset:0
    s_waitcnt lgkmcnt(13)
    v_mfma_f32_16x16x32_bf16 v[232:235], v[116:119], v[64:67], v[232:235]
    ds_read_b64_tr_b16 v[114:115], v58 offset:1024
    v_add_u32 v59, s101, v59
    v_mfma_f32_16x16x32_bf16 v[236:239], v[116:119], v[68:71], v[236:239]
    ds_read_b64_tr_b16 v[116:117], v59 offset:0
    s_waitcnt lgkmcnt(13)
    v_mfma_f32_16x16x32_bf16 v[240:243], v[120:123], v[64:67], v[240:243]
    ds_read_b64_tr_b16 v[118:119], v59 offset:1024
    v_add_u32 v60, s101, v60
    v_mfma_f32_16x16x32_bf16 v[244:247], v[120:123], v[68:71], v[244:247]
    ds_read_b64_tr_b16 v[120:121], v60 offset:0
    s_waitcnt lgkmcnt(13)
    v_mfma_f32_16x16x32_bf16 v[248:251], v[124:127], v[64:67], v[248:251]
    ds_read_b64_tr_b16 v[122:123], v60 offset:1024
    v_add_u32 v61, s101, v61
    v_mfma_f32_16x16x32_bf16 v[252:255], v[124:127], v[68:71], v[252:255]
    ds_read_b64_tr_b16 v[124:125], v61 offset:0
    ds_read_b64_tr_b16 v[126:127], v61 offset:1024
    buffer_load_dwordx4 v[64:67], v13, s[8:11], s86 offen offset:2048 sc1
    buffer_load_dwordx4 v[68:71], v12, s[8:11], s86 offen offset:2048 sc1
    s_waitcnt vmcnt(16)
    s_waitcnt lgkmcnt(14)
    v_mfma_f32_16x16x32_bf16 v[192:195], v[96:99], v[72:75], v[192:195]
    v_mfma_f32_16x16x32_bf16 v[196:199], v[96:99], v[76:79], v[196:199]
    ds_read_b64_tr_b16 v[96:97], v54 offset:8192
    s_waitcnt lgkmcnt(13)
    v_mfma_f32_16x16x32_bf16 v[200:203], v[100:103], v[72:75], v[200:203]
    ds_read_b64_tr_b16 v[98:99], v54 offset:9216
    v_mfma_f32_16x16x32_bf16 v[204:207], v[100:103], v[76:79], v[204:207]
    ds_read_b64_tr_b16 v[100:101], v55 offset:8192
    s_waitcnt lgkmcnt(13)
    v_mfma_f32_16x16x32_bf16 v[208:211], v[104:107], v[72:75], v[208:211]
    ds_read_b64_tr_b16 v[102:103], v55 offset:9216
    v_mfma_f32_16x16x32_bf16 v[212:215], v[104:107], v[76:79], v[212:215]
    ds_read_b64_tr_b16 v[104:105], v56 offset:8192
    s_waitcnt lgkmcnt(13)
    v_mfma_f32_16x16x32_bf16 v[216:219], v[108:111], v[72:75], v[216:219]
    ds_read_b64_tr_b16 v[106:107], v56 offset:9216
    v_mfma_f32_16x16x32_bf16 v[220:223], v[108:111], v[76:79], v[220:223]
    ds_read_b64_tr_b16 v[108:109], v57 offset:8192
    s_waitcnt lgkmcnt(13)
    v_mfma_f32_16x16x32_bf16 v[224:227], v[112:115], v[72:75], v[224:227]
    ds_read_b64_tr_b16 v[110:111], v57 offset:9216
    v_mfma_f32_16x16x32_bf16 v[228:231], v[112:115], v[76:79], v[228:231]
    ds_read_b64_tr_b16 v[112:113], v58 offset:8192
    s_waitcnt lgkmcnt(13)
    v_mfma_f32_16x16x32_bf16 v[232:235], v[116:119], v[72:75], v[232:235]
    ds_read_b64_tr_b16 v[114:115], v58 offset:9216
    v_mfma_f32_16x16x32_bf16 v[236:239], v[116:119], v[76:79], v[236:239]
    ds_read_b64_tr_b16 v[116:117], v59 offset:8192
    s_waitcnt lgkmcnt(13)
    v_mfma_f32_16x16x32_bf16 v[240:243], v[120:123], v[72:75], v[240:243]
    ds_read_b64_tr_b16 v[118:119], v59 offset:9216
    v_mfma_f32_16x16x32_bf16 v[244:247], v[120:123], v[76:79], v[244:247]
    ds_read_b64_tr_b16 v[120:121], v60 offset:8192
    s_waitcnt lgkmcnt(13)
    v_mfma_f32_16x16x32_bf16 v[248:251], v[124:127], v[72:75], v[248:251]
    ds_read_b64_tr_b16 v[122:123], v60 offset:9216
    v_mfma_f32_16x16x32_bf16 v[252:255], v[124:127], v[76:79], v[252:255]
    ds_read_b64_tr_b16 v[124:125], v61 offset:8192
    ds_read_b64_tr_b16 v[126:127], v61 offset:9216
    buffer_load_dwordx4 v[72:75], v13, s[8:11], s86 offen offset:3072 sc1
    buffer_load_dwordx4 v[76:79], v12, s[8:11], s86 offen offset:3072 sc1
    s_waitcnt vmcnt(16)
    s_waitcnt lgkmcnt(14)
    v_mfma_f32_16x16x32_bf16 v[192:195], v[96:99], v[80:83], v[192:195]
    v_mfma_f32_16x16x32_bf16 v[196:199], v[96:99], v[84:87], v[196:199]
    ds_read_b64_tr_b16 v[96:97], v54 offset:16384
    s_waitcnt lgkmcnt(13)
    v_mfma_f32_16x16x32_bf16 v[200:203], v[100:103], v[80:83], v[200:203]
    ds_read_b64_tr_b16 v[98:99], v54 offset:17408
    v_mfma_f32_16x16x32_bf16 v[204:207], v[100:103], v[84:87], v[204:207]
    ds_read_b64_tr_b16 v[100:101], v55 offset:16384
    s_waitcnt lgkmcnt(13)
    v_mfma_f32_16x16x32_bf16 v[208:211], v[104:107], v[80:83], v[208:211]
    ds_read_b64_tr_b16 v[102:103], v55 offset:17408
    v_mfma_f32_16x16x32_bf16 v[212:215], v[104:107], v[84:87], v[212:215]
    ds_read_b64_tr_b16 v[104:105], v56 offset:16384
    s_waitcnt lgkmcnt(13)
    v_mfma_f32_16x16x32_bf16 v[216:219], v[108:111], v[80:83], v[216:219]
    ds_read_b64_tr_b16 v[106:107], v56 offset:17408
    v_mfma_f32_16x16x32_bf16 v[220:223], v[108:111], v[84:87], v[220:223]
    ds_read_b64_tr_b16 v[108:109], v57 offset:16384
    s_waitcnt lgkmcnt(13)
    v_mfma_f32_16x16x32_bf16 v[224:227], v[112:115], v[80:83], v[224:227]
    ds_read_b64_tr_b16 v[110:111], v57 offset:17408
    v_mfma_f32_16x16x32_bf16 v[228:231], v[112:115], v[84:87], v[228:231]
    ds_read_b64_tr_b16 v[112:113], v58 offset:16384
    s_waitcnt lgkmcnt(13)
    v_mfma_f32_16x16x32_bf16 v[232:235], v[116:119], v[80:83], v[232:235]
    ds_read_b64_tr_b16 v[114:115], v58 offset:17408
    v_mfma_f32_16x16x32_bf16 v[236:239], v[116:119], v[84:87], v[236:239]
    ds_read_b64_tr_b16 v[116:117], v59 offset:16384
    s_waitcnt lgkmcnt(13)
    v_mfma_f32_16x16x32_bf16 v[240:243], v[120:123], v[80:83], v[240:243]
    ds_read_b64_tr_b16 v[118:119], v59 offset:17408
    v_mfma_f32_16x16x32_bf16 v[244:247], v[120:123], v[84:87], v[244:247]
    ds_read_b64_tr_b16 v[120:121], v60 offset:16384
    s_waitcnt lgkmcnt(13)
    v_mfma_f32_16x16x32_bf16 v[248:251], v[124:127], v[80:83], v[248:251]
    ds_read_b64_tr_b16 v[122:123], v60 offset:17408
    v_mfma_f32_16x16x32_bf16 v[252:255], v[124:127], v[84:87], v[252:255]
    ds_read_b64_tr_b16 v[124:125], v61 offset:16384
    ds_read_b64_tr_b16 v[126:127], v61 offset:17408
    buffer_load_dwordx4 v[80:83], v13, s[8:11], s87 offen offset:0 sc1
    buffer_load_dwordx4 v[84:87], v12, s[8:11], s87 offen offset:0 sc1
    s_waitcnt vmcnt(16)
    s_waitcnt lgkmcnt(14)
    v_mfma_f32_16x16x32_bf16 v[192:195], v[96:99], v[88:91], v[192:195]
    v_mfma_f32_16x16x32_bf16 v[196:199], v[96:99], v[92:95], v[196:199]
    ds_read_b64_tr_b16 v[96:97], v54 offset:24576
    s_waitcnt lgkmcnt(13)
    v_mfma_f32_16x16x32_bf16 v[200:203], v[100:103], v[88:91], v[200:203]
    ds_read_b64_tr_b16 v[98:99], v54 offset:25600
    v_mfma_f32_16x16x32_bf16 v[204:207], v[100:103], v[92:95], v[204:207]
    ds_read_b64_tr_b16 v[100:101], v55 offset:24576
    s_waitcnt lgkmcnt(13)
    v_mfma_f32_16x16x32_bf16 v[208:211], v[104:107], v[88:91], v[208:211]
    ds_read_b64_tr_b16 v[102:103], v55 offset:25600
    v_mfma_f32_16x16x32_bf16 v[212:215], v[104:107], v[92:95], v[212:215]
    ds_read_b64_tr_b16 v[104:105], v56 offset:24576
    s_waitcnt lgkmcnt(13)
    v_mfma_f32_16x16x32_bf16 v[216:219], v[108:111], v[88:91], v[216:219]
    ds_read_b64_tr_b16 v[106:107], v56 offset:25600
    v_mfma_f32_16x16x32_bf16 v[220:223], v[108:111], v[92:95], v[220:223]
    ds_read_b64_tr_b16 v[108:109], v57 offset:24576
    s_waitcnt lgkmcnt(13)
    v_mfma_f32_16x16x32_bf16 v[224:227], v[112:115], v[88:91], v[224:227]
    ds_read_b64_tr_b16 v[110:111], v57 offset:25600
    v_mfma_f32_16x16x32_bf16 v[228:231], v[112:115], v[92:95], v[228:231]
    ds_read_b64_tr_b16 v[112:113], v58 offset:24576
    s_waitcnt lgkmcnt(13)
    v_mfma_f32_16x16x32_bf16 v[232:235], v[116:119], v[88:91], v[232:235]
    ds_read_b64_tr_b16 v[114:115], v58 offset:25600
    v_mfma_f32_16x16x32_bf16 v[236:239], v[116:119], v[92:95], v[236:239]
    ds_read_b64_tr_b16 v[116:117], v59 offset:24576
    s_waitcnt lgkmcnt(13)
    v_mfma_f32_16x16x32_bf16 v[240:243], v[120:123], v[88:91], v[240:243]
    ds_read_b64_tr_b16 v[118:119], v59 offset:25600
    v_mfma_f32_16x16x32_bf16 v[244:247], v[120:123], v[92:95], v[244:247]
    ds_read_b64_tr_b16 v[120:121], v60 offset:24576
    s_waitcnt lgkmcnt(13)
    v_mfma_f32_16x16x32_bf16 v[248:251], v[124:127], v[88:91], v[248:251]
    ds_read_b64_tr_b16 v[122:123], v60 offset:25600
    v_mfma_f32_16x16x32_bf16 v[252:255], v[124:127], v[92:95], v[252:255]
    ds_read_b64_tr_b16 v[124:125], v61 offset:24576
    ds_read_b64_tr_b16 v[126:127], v61 offset:25600
    buffer_load_dwordx4 v[88:91], v13, s[8:11], s87 offen offset:1024 sc1
    buffer_load_dwordx4 v[92:95], v12, s[8:11], s87 offen offset:1024 sc1
    s_waitcnt vmcnt(8)
    s_lshl_b32 s6, s4, 3
    s_add_u32 s6, s6, s5
    s_lshl_b32 s6, s6, 5
    s_add_u32 s6, s6, s3
    s_lshl_b32 s6, s6, 2
    s_add_u32 s6, s6, 3866624
    v_mov_b32 v2, 1
    v_mov_b32 v3, 0x5000000
    v_writelane_b32 v3, s6, 0
    buffer_store_dword v2, v3, s[8:11], 0 offen sc1
    s_waitcnt lgkmcnt(14)
    v_mfma_f32_16x16x32_bf16 v[192:195], v[96:99], v[16:19], v[192:195]
    v_mfma_f32_16x16x32_bf16 v[196:199], v[96:99], v[20:23], v[196:199]
    ds_read_b64_tr_b16 v[96:97], v54 offset:32768
    s_waitcnt lgkmcnt(13)
    v_mfma_f32_16x16x32_bf16 v[200:203], v[100:103], v[16:19], v[200:203]
    ds_read_b64_tr_b16 v[98:99], v54 offset:33792
    v_mfma_f32_16x16x32_bf16 v[204:207], v[100:103], v[20:23], v[204:207]
    ds_read_b64_tr_b16 v[100:101], v55 offset:32768
    s_waitcnt lgkmcnt(13)
    v_mfma_f32_16x16x32_bf16 v[208:211], v[104:107], v[16:19], v[208:211]
    ds_read_b64_tr_b16 v[102:103], v55 offset:33792
    v_mfma_f32_16x16x32_bf16 v[212:215], v[104:107], v[20:23], v[212:215]
    ds_read_b64_tr_b16 v[104:105], v56 offset:32768
    s_waitcnt lgkmcnt(13)
    v_mfma_f32_16x16x32_bf16 v[216:219], v[108:111], v[16:19], v[216:219]
    ds_read_b64_tr_b16 v[106:107], v56 offset:33792
    v_mfma_f32_16x16x32_bf16 v[220:223], v[108:111], v[20:23], v[220:223]
    ds_read_b64_tr_b16 v[108:109], v57 offset:32768
    s_waitcnt lgkmcnt(13)
    v_mfma_f32_16x16x32_bf16 v[224:227], v[112:115], v[16:19], v[224:227]
    ds_read_b64_tr_b16 v[110:111], v57 offset:33792
    v_mfma_f32_16x16x32_bf16 v[228:231], v[112:115], v[20:23], v[228:231]
    ds_read_b64_tr_b16 v[112:113], v58 offset:32768
    s_waitcnt lgkmcnt(13)
    v_mfma_f32_16x16x32_bf16 v[232:235], v[116:119], v[16:19], v[232:235]
    ds_read_b64_tr_b16 v[114:115], v58 offset:33792
    v_mfma_f32_16x16x32_bf16 v[236:239], v[116:119], v[20:23], v[236:239]
    ds_read_b64_tr_b16 v[116:117], v59 offset:32768
    s_waitcnt lgkmcnt(13)
    v_mfma_f32_16x16x32_bf16 v[240:243], v[120:123], v[16:19], v[240:243]
    ds_read_b64_tr_b16 v[118:119], v59 offset:33792
    v_mfma_f32_16x16x32_bf16 v[244:247], v[120:123], v[20:23], v[244:247]
    ds_read_b64_tr_b16 v[120:121], v60 offset:32768
    s_waitcnt lgkmcnt(13)
    v_mfma_f32_16x16x32_bf16 v[248:251], v[124:127], v[16:19], v[248:251]
    ds_read_b64_tr_b16 v[122:123], v60 offset:33792
    v_mfma_f32_16x16x32_bf16 v[252:255], v[124:127], v[20:23], v[252:255]
    ds_read_b64_tr_b16 v[124:125], v61 offset:32768
    ds_read_b64_tr_b16 v[126:127], v61 offset:33792
    buffer_load_dwordx4 v[16:19], v13, s[8:11], s87 offen offset:2048 sc1
    buffer_load_dwordx4 v[20:23], v12, s[8:11], s87 offen offset:2048 sc1
    s_waitcnt lgkmcnt(14)
    v_mfma_f32_16x16x32_bf16 v[192:195], v[96:99], v[24:27], v[192:195]
    v_mfma_f32_16x16x32_bf16 v[196:199], v[96:99], v[28:31], v[196:199]
    ds_read_b64_tr_b16 v[96:97], v54 offset:40960
    s_waitcnt lgkmcnt(13)
    v_mfma_f32_16x16x32_bf16 v[200:203], v[100:103], v[24:27], v[200:203]
    ds_read_b64_tr_b16 v[98:99], v54 offset:41984
    v_mfma_f32_16x16x32_bf16 v[204:207], v[100:103], v[28:31], v[204:207]
    ds_read_b64_tr_b16 v[100:101], v55 offset:40960
    s_waitcnt lgkmcnt(13)
    v_mfma_f32_16x16x32_bf16 v[208:211], v[104:107], v[24:27], v[208:211]
    ds_read_b64_tr_b16 v[102:103], v55 offset:41984
    v_mfma_f32_16x16x32_bf16 v[212:215], v[104:107], v[28:31], v[212:215]
    ds_read_b64_tr_b16 v[104:105], v56 offset:40960
    s_waitcnt lgkmcnt(13)
    v_mfma_f32_16x16x32_bf16 v[216:219], v[108:111], v[24:27], v[216:219]
    ds_read_b64_tr_b16 v[106:107], v56 offset:41984
    v_mfma_f32_16x16x32_bf16 v[220:223], v[108:111], v[28:31], v[220:223]
    ds_read_b64_tr_b16 v[108:109], v57 offset:40960
    s_waitcnt lgkmcnt(13)
    v_mfma_f32_16x16x32_bf16 v[224:227], v[112:115], v[24:27], v[224:227]
    ds_read_b64_tr_b16 v[110:111], v57 offset:41984
    v_mfma_f32_16x16x32_bf16 v[228:231], v[112:115], v[28:31], v[228:231]
    ds_read_b64_tr_b16 v[112:113], v58 offset:40960
    s_waitcnt lgkmcnt(13)
    v_mfma_f32_16x16x32_bf16 v[232:235], v[116:119], v[24:27], v[232:235]
    ds_read_b64_tr_b16 v[114:115], v58 offset:41984
    v_mfma_f32_16x16x32_bf16 v[236:239], v[116:119], v[28:31], v[236:239]
    ds_read_b64_tr_b16 v[116:117], v59 offset:40960
    s_waitcnt lgkmcnt(13)
    v_mfma_f32_16x16x32_bf16 v[240:243], v[120:123], v[24:27], v[240:243]
    ds_read_b64_tr_b16 v[118:119], v59 offset:41984
    v_mfma_f32_16x16x32_bf16 v[244:247], v[120:123], v[28:31], v[244:247]
    ds_read_b64_tr_b16 v[120:121], v60 offset:40960
    s_waitcnt lgkmcnt(13)
    v_mfma_f32_16x16x32_bf16 v[248:251], v[124:127], v[24:27], v[248:251]
    ds_read_b64_tr_b16 v[122:123], v60 offset:41984
    v_mfma_f32_16x16x32_bf16 v[252:255], v[124:127], v[28:31], v[252:255]
    ds_read_b64_tr_b16 v[124:125], v61 offset:40960
    ds_read_b64_tr_b16 v[126:127], v61 offset:41984
    buffer_load_dwordx4 v[24:27], v13, s[8:11], s87 offen offset:3072 sc1
    buffer_load_dwordx4 v[28:31], v12, s[8:11], s87 offen offset:3072 sc1
    s_waitcnt lgkmcnt(14)
    v_mfma_f32_16x16x32_bf16 v[192:195], v[96:99], v[32:35], v[192:195]
    v_mfma_f32_16x16x32_bf16 v[196:199], v[96:99], v[36:39], v[196:199]
    ds_read_b64_tr_b16 v[96:97], v54 offset:49152
    s_waitcnt lgkmcnt(13)
    v_mfma_f32_16x16x32_bf16 v[200:203], v[100:103], v[32:35], v[200:203]
    ds_read_b64_tr_b16 v[98:99], v54 offset:50176
    v_mfma_f32_16x16x32_bf16 v[204:207], v[100:103], v[36:39], v[204:207]
    ds_read_b64_tr_b16 v[100:101], v55 offset:49152
    s_waitcnt lgkmcnt(13)
    v_mfma_f32_16x16x32_bf16 v[208:211], v[104:107], v[32:35], v[208:211]
    ds_read_b64_tr_b16 v[102:103], v55 offset:50176
    v_mfma_f32_16x16x32_bf16 v[212:215], v[104:107], v[36:39], v[212:215]
    ds_read_b64_tr_b16 v[104:105], v56 offset:49152
    s_waitcnt lgkmcnt(13)
    v_mfma_f32_16x16x32_bf16 v[216:219], v[108:111], v[32:35], v[216:219]
    ds_read_b64_tr_b16 v[106:107], v56 offset:50176
    v_mfma_f32_16x16x32_bf16 v[220:223], v[108:111], v[36:39], v[220:223]
    ds_read_b64_tr_b16 v[108:109], v57 offset:49152
    s_waitcnt lgkmcnt(13)
    v_mfma_f32_16x16x32_bf16 v[224:227], v[112:115], v[32:35], v[224:227]
    ds_read_b64_tr_b16 v[110:111], v57 offset:50176
    v_mfma_f32_16x16x32_bf16 v[228:231], v[112:115], v[36:39], v[228:231]
    ds_read_b64_tr_b16 v[112:113], v58 offset:49152
    s_waitcnt lgkmcnt(13)
    v_mfma_f32_16x16x32_bf16 v[232:235], v[116:119], v[32:35], v[232:235]
    ds_read_b64_tr_b16 v[114:115], v58 offset:50176
    v_mfma_f32_16x16x32_bf16 v[236:239], v[116:119], v[36:39], v[236:239]
    ds_read_b64_tr_b16 v[116:117], v59 offset:49152
    s_waitcnt lgkmcnt(13)
    v_mfma_f32_16x16x32_bf16 v[240:243], v[120:123], v[32:35], v[240:243]
    ds_read_b64_tr_b16 v[118:119], v59 offset:50176
    v_mfma_f32_16x16x32_bf16 v[244:247], v[120:123], v[36:39], v[244:247]
    ds_read_b64_tr_b16 v[120:121], v60 offset:49152
    s_waitcnt lgkmcnt(13)
    v_mfma_f32_16x16x32_bf16 v[248:251], v[124:127], v[32:35], v[248:251]
    ds_read_b64_tr_b16 v[122:123], v60 offset:50176
    v_mfma_f32_16x16x32_bf16 v[252:255], v[124:127], v[36:39], v[252:255]
    ds_read_b64_tr_b16 v[124:125], v61 offset:49152
    ds_read_b64_tr_b16 v[126:127], v61 offset:50176
    buffer_load_dwordx4 v[32:35], v13, s[8:11], s88 offen offset:0 sc1
    buffer_load_dwordx4 v[36:39], v12, s[8:11], s88 offen offset:0 sc1
    s_waitcnt vmcnt(13)
    s_waitcnt lgkmcnt(14)
    v_mfma_f32_16x16x32_bf16 v[192:195], v[96:99], v[64:67], v[192:195]
    v_mfma_f32_16x16x32_bf16 v[196:199], v[96:99], v[68:71], v[196:199]
    ds_read_b64_tr_b16 v[96:97], v54 offset:57344
    s_waitcnt lgkmcnt(13)
    v_mfma_f32_16x16x32_bf16 v[200:203], v[100:103], v[64:67], v[200:203]
    ds_read_b64_tr_b16 v[98:99], v54 offset:58368
    v_mfma_f32_16x16x32_bf16 v[204:207], v[100:103], v[68:71], v[204:207]
    ds_read_b64_tr_b16 v[100:101], v55 offset:57344
    s_waitcnt lgkmcnt(13)
    v_mfma_f32_16x16x32_bf16 v[208:211], v[104:107], v[64:67], v[208:211]
    ds_read_b64_tr_b16 v[102:103], v55 offset:58368
    v_mfma_f32_16x16x32_bf16 v[212:215], v[104:107], v[68:71], v[212:215]
    ds_read_b64_tr_b16 v[104:105], v56 offset:57344
    s_waitcnt lgkmcnt(13)
    v_mfma_f32_16x16x32_bf16 v[216:219], v[108:111], v[64:67], v[216:219]
    ds_read_b64_tr_b16 v[106:107], v56 offset:58368
    v_mfma_f32_16x16x32_bf16 v[220:223], v[108:111], v[68:71], v[220:223]
    ds_read_b64_tr_b16 v[108:109], v57 offset:57344
    s_waitcnt lgkmcnt(13)
    v_mfma_f32_16x16x32_bf16 v[224:227], v[112:115], v[64:67], v[224:227]
    ds_read_b64_tr_b16 v[110:111], v57 offset:58368
    v_mfma_f32_16x16x32_bf16 v[228:231], v[112:115], v[68:71], v[228:231]
    ds_read_b64_tr_b16 v[112:113], v58 offset:57344
    s_waitcnt lgkmcnt(13)
    v_mfma_f32_16x16x32_bf16 v[232:235], v[116:119], v[64:67], v[232:235]
    ds_read_b64_tr_b16 v[114:115], v58 offset:58368
    v_mfma_f32_16x16x32_bf16 v[236:239], v[116:119], v[68:71], v[236:239]
    ds_read_b64_tr_b16 v[116:117], v59 offset:57344
    s_waitcnt lgkmcnt(13)
    v_mfma_f32_16x16x32_bf16 v[240:243], v[120:123], v[64:67], v[240:243]
    ds_read_b64_tr_b16 v[118:119], v59 offset:58368
    v_mfma_f32_16x16x32_bf16 v[244:247], v[120:123], v[68:71], v[244:247]
    ds_read_b64_tr_b16 v[120:121], v60 offset:57344
    s_waitcnt lgkmcnt(13)
    v_mfma_f32_16x16x32_bf16 v[248:251], v[124:127], v[64:67], v[248:251]
    ds_read_b64_tr_b16 v[122:123], v60 offset:58368
    v_mfma_f32_16x16x32_bf16 v[252:255], v[124:127], v[68:71], v[252:255]
    ds_read_b64_tr_b16 v[124:125], v61 offset:57344
    ds_read_b64_tr_b16 v[126:127], v61 offset:58368
    buffer_load_dwordx4 v[64:67], v13, s[8:11], s88 offen offset:1024 sc1
    buffer_load_dwordx4 v[68:71], v12, s[8:11], s88 offen offset:1024 sc1
    s_waitcnt vmcnt(13)
    s_waitcnt lgkmcnt(14)
    v_mfma_f32_16x16x32_bf16 v[192:195], v[96:99], v[72:75], v[192:195]
    v_xor_b32 v54, 0x10000, v54
    v_mfma_f32_16x16x32_bf16 v[196:199], v[96:99], v[76:79], v[196:199]
    s_waitcnt lgkmcnt(12)
    v_mfma_f32_16x16x32_bf16 v[200:203], v[100:103], v[72:75], v[200:203]
    v_xor_b32 v55, 0x10000, v55
    v_mfma_f32_16x16x32_bf16 v[204:207], v[100:103], v[76:79], v[204:207]
    s_waitcnt lgkmcnt(0)
    s_barrier
    ds_read_b64_tr_b16 v[96:97], v54 offset:0
    ds_read_b64_tr_b16 v[98:99], v54 offset:1024
    ds_read_b64_tr_b16 v[100:101], v55 offset:0
    v_mfma_f32_16x16x32_bf16 v[208:211], v[104:107], v[72:75], v[208:211]
    ds_read_b64_tr_b16 v[102:103], v55 offset:1024
    v_xor_b32 v56, 0x10000, v56
    v_mfma_f32_16x16x32_bf16 v[212:215], v[104:107], v[76:79], v[212:215]
    ds_read_b64_tr_b16 v[104:105], v56 offset:0
    v_mfma_f32_16x16x32_bf16 v[216:219], v[108:111], v[72:75], v[216:219]
    ds_read_b64_tr_b16 v[106:107], v56 offset:1024
    v_xor_b32 v57, 0x10000, v57
    v_mfma_f32_16x16x32_bf16 v[220:223], v[108:111], v[76:79], v[220:223]
    ds_read_b64_tr_b16 v[108:109], v57 offset:0
    v_mfma_f32_16x16x32_bf16 v[224:227], v[112:115], v[72:75], v[224:227]
    ds_read_b64_tr_b16 v[110:111], v57 offset:1024
    v_xor_b32 v58, 0x10000, v58
    v_mfma_f32_16x16x32_bf16 v[228:231], v[112:115], v[76:79], v[228:231]
    ds_read_b64_tr_b16 v[112:113], v58 offset:0
    v_mfma_f32_16x16x32_bf16 v[232:235], v[116:119], v[72:75], v[232:235]
    ds_read_b64_tr_b16 v[114:115], v58 offset:1024
    v_xor_b32 v59, 0x10000, v59
    v_mfma_f32_16x16x32_bf16 v[236:239], v[116:119], v[76:79], v[236:239]
    ds_read_b64_tr_b16 v[116:117], v59 offset:0
    v_mfma_f32_16x16x32_bf16 v[240:243], v[120:123], v[72:75], v[240:243]
    ds_read_b64_tr_b16 v[118:119], v59 offset:1024
    v_xor_b32 v60, 0x10000, v60
    v_mfma_f32_16x16x32_bf16 v[244:247], v[120:123], v[76:79], v[244:247]
    ds_read_b64_tr_b16 v[120:121], v60 offset:0
    v_mfma_f32_16x16x32_bf16 v[248:251], v[124:127], v[72:75], v[248:251]
    ds_read_b64_tr_b16 v[122:123], v60 offset:1024
    v_xor_b32 v61, 0x10000, v61
    v_mfma_f32_16x16x32_bf16 v[252:255], v[124:127], v[76:79], v[252:255]
    ds_read_b64_tr_b16 v[124:125], v61 offset:0
    ds_read_b64_tr_b16 v[126:127], v61 offset:1024
    buffer_load_dwordx4 v[72:75], v13, s[8:11], s88 offen offset:2048 sc1
    buffer_load_dwordx4 v[76:79], v12, s[8:11], s88 offen offset:2048 sc1
    s_waitcnt vmcnt(13)
    s_waitcnt lgkmcnt(14)
    v_mfma_f32_16x16x32_bf16 v[192:195], v[96:99], v[80:83], v[192:195]
    v_mfma_f32_16x16x32_bf16 v[196:199], v[96:99], v[84:87], v[196:199]
    ds_read_b64_tr_b16 v[96:97], v54 offset:8192
    s_waitcnt lgkmcnt(13)
    v_mfma_f32_16x16x32_bf16 v[200:203], v[100:103], v[80:83], v[200:203]
    ds_read_b64_tr_b16 v[98:99], v54 offset:9216
    v_mfma_f32_16x16x32_bf16 v[204:207], v[100:103], v[84:87], v[204:207]
    ds_read_b64_tr_b16 v[100:101], v55 offset:8192
    s_waitcnt lgkmcnt(13)
    v_mfma_f32_16x16x32_bf16 v[208:211], v[104:107], v[80:83], v[208:211]
    ds_read_b64_tr_b16 v[102:103], v55 offset:9216
    v_mfma_f32_16x16x32_bf16 v[212:215], v[104:107], v[84:87], v[212:215]
    ds_read_b64_tr_b16 v[104:105], v56 offset:8192
    s_waitcnt lgkmcnt(13)
    v_mfma_f32_16x16x32_bf16 v[216:219], v[108:111], v[80:83], v[216:219]
    ds_read_b64_tr_b16 v[106:107], v56 offset:9216
    v_mfma_f32_16x16x32_bf16 v[220:223], v[108:111], v[84:87], v[220:223]
    ds_read_b64_tr_b16 v[108:109], v57 offset:8192
    s_waitcnt lgkmcnt(13)
    v_mfma_f32_16x16x32_bf16 v[224:227], v[112:115], v[80:83], v[224:227]
    ds_read_b64_tr_b16 v[110:111], v57 offset:9216
    v_mfma_f32_16x16x32_bf16 v[228:231], v[112:115], v[84:87], v[228:231]
    ds_read_b64_tr_b16 v[112:113], v58 offset:8192
    s_waitcnt lgkmcnt(13)
    v_mfma_f32_16x16x32_bf16 v[232:235], v[116:119], v[80:83], v[232:235]
    ds_read_b64_tr_b16 v[114:115], v58 offset:9216
    v_mfma_f32_16x16x32_bf16 v[236:239], v[116:119], v[84:87], v[236:239]
    ds_read_b64_tr_b16 v[116:117], v59 offset:8192
    s_waitcnt lgkmcnt(13)
    v_mfma_f32_16x16x32_bf16 v[240:243], v[120:123], v[80:83], v[240:243]
    ds_read_b64_tr_b16 v[118:119], v59 offset:9216
    v_mfma_f32_16x16x32_bf16 v[244:247], v[120:123], v[84:87], v[244:247]
    ds_read_b64_tr_b16 v[120:121], v60 offset:8192
    s_waitcnt lgkmcnt(13)
    v_mfma_f32_16x16x32_bf16 v[248:251], v[124:127], v[80:83], v[248:251]
    ds_read_b64_tr_b16 v[122:123], v60 offset:9216
    v_mfma_f32_16x16x32_bf16 v[252:255], v[124:127], v[84:87], v[252:255]
    ds_read_b64_tr_b16 v[124:125], v61 offset:8192
    ds_read_b64_tr_b16 v[126:127], v61 offset:9216
    buffer_load_dwordx4 v[80:83], v13, s[8:11], s88 offen offset:3072 sc1
    buffer_load_dwordx4 v[84:87], v12, s[8:11], s88 offen offset:3072 sc1
    s_waitcnt vmcnt(13)
    s_waitcnt lgkmcnt(14)
    v_mfma_f32_16x16x32_bf16 v[192:195], v[96:99], v[88:91], v[192:195]
    v_mfma_f32_16x16x32_bf16 v[196:199], v[96:99], v[92:95], v[196:199]
    ds_read_b64_tr_b16 v[96:97], v54 offset:16384
    s_waitcnt lgkmcnt(13)
    v_mfma_f32_16x16x32_bf16 v[200:203], v[100:103], v[88:91], v[200:203]
    ds_read_b64_tr_b16 v[98:99], v54 offset:17408
    v_mfma_f32_16x16x32_bf16 v[204:207], v[100:103], v[92:95], v[204:207]
    ds_read_b64_tr_b16 v[100:101], v55 offset:16384
    s_waitcnt lgkmcnt(13)
    v_mfma_f32_16x16x32_bf16 v[208:211], v[104:107], v[88:91], v[208:211]
    ds_read_b64_tr_b16 v[102:103], v55 offset:17408
    v_mfma_f32_16x16x32_bf16 v[212:215], v[104:107], v[92:95], v[212:215]
    ds_read_b64_tr_b16 v[104:105], v56 offset:16384
    s_waitcnt lgkmcnt(13)
    v_mfma_f32_16x16x32_bf16 v[216:219], v[108:111], v[88:91], v[216:219]
    ds_read_b64_tr_b16 v[106:107], v56 offset:17408
    v_mfma_f32_16x16x32_bf16 v[220:223], v[108:111], v[92:95], v[220:223]
    ds_read_b64_tr_b16 v[108:109], v57 offset:16384
    s_waitcnt lgkmcnt(13)
    v_mfma_f32_16x16x32_bf16 v[224:227], v[112:115], v[88:91], v[224:227]
    ds_read_b64_tr_b16 v[110:111], v57 offset:17408
    v_mfma_f32_16x16x32_bf16 v[228:231], v[112:115], v[92:95], v[228:231]
    ds_read_b64_tr_b16 v[112:113], v58 offset:16384
    s_waitcnt lgkmcnt(13)
    v_mfma_f32_16x16x32_bf16 v[232:235], v[116:119], v[88:91], v[232:235]
    ds_read_b64_tr_b16 v[114:115], v58 offset:17408
    v_mfma_f32_16x16x32_bf16 v[236:239], v[116:119], v[92:95], v[236:239]
    ds_read_b64_tr_b16 v[116:117], v59 offset:16384
    s_waitcnt lgkmcnt(13)
    v_mfma_f32_16x16x32_bf16 v[240:243], v[120:123], v[88:91], v[240:243]
    ds_read_b64_tr_b16 v[118:119], v59 offset:17408
    v_mfma_f32_16x16x32_bf16 v[244:247], v[120:123], v[92:95], v[244:247]
    ds_read_b64_tr_b16 v[120:121], v60 offset:16384
    s_waitcnt lgkmcnt(13)
    v_mfma_f32_16x16x32_bf16 v[248:251], v[124:127], v[88:91], v[248:251]
    ds_read_b64_tr_b16 v[122:123], v60 offset:17408
    v_mfma_f32_16x16x32_bf16 v[252:255], v[124:127], v[92:95], v[252:255]
    ds_read_b64_tr_b16 v[124:125], v61 offset:16384
    ds_read_b64_tr_b16 v[126:127], v61 offset:17408
    s_waitcnt vmcnt(10)
    s_waitcnt lgkmcnt(14)
    v_mfma_f32_16x16x32_bf16 v[192:195], v[96:99], v[16:19], v[192:195]
    v_mfma_f32_16x16x32_bf16 v[196:199], v[96:99], v[20:23], v[196:199]
    ds_read_b64_tr_b16 v[96:97], v54 offset:24576
    s_waitcnt lgkmcnt(13)
    v_mfma_f32_16x16x32_bf16 v[200:203], v[100:103], v[16:19], v[200:203]
    ds_read_b64_tr_b16 v[98:99], v54 offset:25600
    v_mfma_f32_16x16x32_bf16 v[204:207], v[100:103], v[20:23], v[204:207]
    ds_read_b64_tr_b16 v[100:101], v55 offset:24576
    s_waitcnt lgkmcnt(13)
    v_mfma_f32_16x16x32_bf16 v[208:211], v[104:107], v[16:19], v[208:211]
    ds_read_b64_tr_b16 v[102:103], v55 offset:25600
    v_mfma_f32_16x16x32_bf16 v[212:215], v[104:107], v[20:23], v[212:215]
    ds_read_b64_tr_b16 v[104:105], v56 offset:24576
    s_waitcnt lgkmcnt(13)
    v_mfma_f32_16x16x32_bf16 v[216:219], v[108:111], v[16:19], v[216:219]
    ds_read_b64_tr_b16 v[106:107], v56 offset:25600
    v_mfma_f32_16x16x32_bf16 v[220:223], v[108:111], v[20:23], v[220:223]
    ds_read_b64_tr_b16 v[108:109], v57 offset:24576
    s_waitcnt lgkmcnt(13)
    v_mfma_f32_16x16x32_bf16 v[224:227], v[112:115], v[16:19], v[224:227]
    ds_read_b64_tr_b16 v[110:111], v57 offset:25600
    v_mfma_f32_16x16x32_bf16 v[228:231], v[112:115], v[20:23], v[228:231]
    ds_read_b64_tr_b16 v[112:113], v58 offset:24576
    s_waitcnt lgkmcnt(13)
    v_mfma_f32_16x16x32_bf16 v[232:235], v[116:119], v[16:19], v[232:235]
    ds_read_b64_tr_b16 v[114:115], v58 offset:25600
    v_mfma_f32_16x16x32_bf16 v[236:239], v[116:119], v[20:23], v[236:239]
    ds_read_b64_tr_b16 v[116:117], v59 offset:24576
    s_waitcnt lgkmcnt(13)
    v_mfma_f32_16x16x32_bf16 v[240:243], v[120:123], v[16:19], v[240:243]
    ds_read_b64_tr_b16 v[118:119], v59 offset:25600
    v_mfma_f32_16x16x32_bf16 v[244:247], v[120:123], v[20:23], v[244:247]
    ds_read_b64_tr_b16 v[120:121], v60 offset:24576
    s_waitcnt lgkmcnt(13)
    v_mfma_f32_16x16x32_bf16 v[248:251], v[124:127], v[16:19], v[248:251]
    ds_read_b64_tr_b16 v[122:123], v60 offset:25600
    v_mfma_f32_16x16x32_bf16 v[252:255], v[124:127], v[20:23], v[252:255]
    ds_read_b64_tr_b16 v[124:125], v61 offset:24576
    ds_read_b64_tr_b16 v[126:127], v61 offset:25600
    s_waitcnt vmcnt(8)
    s_waitcnt lgkmcnt(14)
    v_mfma_f32_16x16x32_bf16 v[192:195], v[96:99], v[24:27], v[192:195]
    v_mfma_f32_16x16x32_bf16 v[196:199], v[96:99], v[28:31], v[196:199]
    ds_read_b64_tr_b16 v[96:97], v54 offset:32768
    s_waitcnt lgkmcnt(13)
    v_mfma_f32_16x16x32_bf16 v[200:203], v[100:103], v[24:27], v[200:203]
    ds_read_b64_tr_b16 v[98:99], v54 offset:33792
    v_mfma_f32_16x16x32_bf16 v[204:207], v[100:103], v[28:31], v[204:207]
    ds_read_b64_tr_b16 v[100:101], v55 offset:32768
    s_waitcnt lgkmcnt(13)
    v_mfma_f32_16x16x32_bf16 v[208:211], v[104:107], v[24:27], v[208:211]
    ds_read_b64_tr_b16 v[102:103], v55 offset:33792
    v_mfma_f32_16x16x32_bf16 v[212:215], v[104:107], v[28:31], v[212:215]
    ds_read_b64_tr_b16 v[104:105], v56 offset:32768
    s_waitcnt lgkmcnt(13)
    v_mfma_f32_16x16x32_bf16 v[216:219], v[108:111], v[24:27], v[216:219]
    ds_read_b64_tr_b16 v[106:107], v56 offset:33792
    v_mfma_f32_16x16x32_bf16 v[220:223], v[108:111], v[28:31], v[220:223]
    ds_read_b64_tr_b16 v[108:109], v57 offset:32768
    s_waitcnt lgkmcnt(13)
    v_mfma_f32_16x16x32_bf16 v[224:227], v[112:115], v[24:27], v[224:227]
    ds_read_b64_tr_b16 v[110:111], v57 offset:33792
    v_mfma_f32_16x16x32_bf16 v[228:231], v[112:115], v[28:31], v[228:231]
    ds_read_b64_tr_b16 v[112:113], v58 offset:32768
    s_waitcnt lgkmcnt(13)
    v_mfma_f32_16x16x32_bf16 v[232:235], v[116:119], v[24:27], v[232:235]
    ds_read_b64_tr_b16 v[114:115], v58 offset:33792
    v_mfma_f32_16x16x32_bf16 v[236:239], v[116:119], v[28:31], v[236:239]
    ds_read_b64_tr_b16 v[116:117], v59 offset:32768
    s_waitcnt lgkmcnt(13)
    v_mfma_f32_16x16x32_bf16 v[240:243], v[120:123], v[24:27], v[240:243]
    ds_read_b64_tr_b16 v[118:119], v59 offset:33792
    v_mfma_f32_16x16x32_bf16 v[244:247], v[120:123], v[28:31], v[244:247]
    ds_read_b64_tr_b16 v[120:121], v60 offset:32768
    s_waitcnt lgkmcnt(13)
    v_mfma_f32_16x16x32_bf16 v[248:251], v[124:127], v[24:27], v[248:251]
    ds_read_b64_tr_b16 v[122:123], v60 offset:33792
    v_mfma_f32_16x16x32_bf16 v[252:255], v[124:127], v[28:31], v[252:255]
    ds_read_b64_tr_b16 v[124:125], v61 offset:32768
    ds_read_b64_tr_b16 v[126:127], v61 offset:33792
    s_waitcnt vmcnt(0)
    s_cmp_ge_u32 s3, 4
    s_cbranch_scc1 L_q_nold
    s_lshl_b32 s7, s4, 10
    s_add_u32 s7, s7, 3866624
    v_lshrrev_b32 v2, 3, v1
    v_and_b32 v3, 7, v1
    v_lshlrev_b32 v3, 2, v3
    v_lshl_add_u32 v3, v2, 7, v3
    s_mov_b32 s79, 262144
L_poll_7:
    buffer_load_dword v2, v3, s[8:11], s7 offen sc1
    s_waitcnt vmcnt(0)
    v_cmp_gt_u32 vcc, 1, v2
    s_cbranch_vccz L_polldone_8
    s_sleep 2
    s_sub_u32 s79, s79, 1
    s_cmp_lg_u32 s79, 0
    s_cbranch_scc1 L_poll_7
L_polldone_8:
    s_lshl_b32 s6, s76, 13
    s_add_u32 s6, s6, s78
    s_add_u32 m0, s6, 0
    s_add_u32 s7, s77, 0
    buffer_load_dwordx4 v49, s[8:11], s7 offen offset:0 sc1 lds
    buffer_load_dwordx4 v49, s[8:11], s7 offen offset:1024 sc1 lds
    buffer_load_dwordx4 v49, s[8:11], s7 offen offset:2048 sc1 lds
    buffer_load_dwordx4 v49, s[8:11], s7 offen offset:3072 sc1 lds
    s_lshl_b32 s6, s76, 13
    s_add_u32 s6, s6, s78
    s_add_u32 m0, s6, 4096
    s_add_u32 s7, s77, 4096
    buffer_load_dwordx4 v49, s[8:11], s7 offen offset:0 sc1 lds
    buffer_load_dwordx4 v49, s[8:11], s7 offen offset:1024 sc1 lds
    buffer_load_dwordx4 v49, s[8:11], s7 offen offset:2048 sc1 lds
    buffer_load_dwordx4 v49, s[8:11], s7 offen offset:3072 sc1 lds
    s_lshl_b32 s6, s76, 12
    s_add_u32 s6, s6, s78
    s_add_u32 m0, s6, 49152
    s_add_u32 s7, s77, 524288
    buffer_load_dwordx4 v50, s[8:11], s7 offen offset:0 sc1 lds
    buffer_load_dwordx4 v50, s[8:11], s7 offen offset:1024 sc1 lds
    buffer_load_dwordx4 v50, s[8:11], s7 offen offset:2048 sc1 lds
    buffer_load_dwordx4 v50, s[8:11], s7 offen offset:3072 sc1 lds
L_q_nold:
    s_waitcnt lgkmcnt(14)
    v_mfma_f32_16x16x32_bf16 v[192:195], v[96:99], v[32:35], v[192:195]
    v_mfma_f32_16x16x32_bf16 v[196:199], v[96:99], v[36:39], v[196:199]
    ds_read_b64_tr_b16 v[96:97], v54 offset:40960
    s_waitcnt lgkmcnt(13)
    v_mfma_f32_16x16x32_bf16 v[200:203], v[100:103], v[32:35], v[200:203]
    ds_read_b64_tr_b16 v[98:99], v54 offset:41984
    v_mfma_f32_16x16x32_bf16 v[204:207], v[100:103], v[36:39], v[204:207]
    ds_read_b64_tr_b16 v[100:101], v55 offset:40960
    s_waitcnt lgkmcnt(13)
    v_mfma_f32_16x16x32_bf16 v[208:211], v[104:107], v[32:35], v[208:211]
    ds_read_b64_tr_b16 v[102:103], v55 offset:41984
    v_mfma_f32_16x16x32_bf16 v[212:215], v[104:107], v[36:39], v[212:215]
    ds_read_b64_tr_b16 v[104:105], v56 offset:40960
    s_waitcnt lgkmcnt(13)
    v_mfma_f32_16x16x32_bf16 v[216:219], v[108:111], v[32:35], v[216:219]
    ds_read_b64_tr_b16 v[106:107], v56 offset:41984
    buffer_store_dwordx4 v[144:147], v13, s[8:11], s67 offen sc1
    s_add_u32 s67, s67, 1024
    v_mfma_f32_16x16x32_bf16 v[220:223], v[108:111], v[36:39], v[220:223]
    ds_read_b64_tr_b16 v[108:109], v57 offset:40960
    s_waitcnt lgkmcnt(13)
    v_mfma_f32_16x16x32_bf16 v[224:227], v[112:115], v[32:35], v[224:227]
    ds_read_b64_tr_b16 v[110:111], v57 offset:41984
    v_mfma_f32_16x16x32_bf16 v[228:231], v[112:115], v[36:39], v[228:231]
    ds_read_b64_tr_b16 v[112:113], v58 offset:40960
    s_waitcnt lgkmcnt(13)
    v_mfma_f32_16x16x32_bf16 v[232:235], v[116:119], v[32:35], v[232:235]
    ds_read_b64_tr_b16 v[114:115], v58 offset:41984
    v_mfma_f32_16x16x32_bf16 v[236:239], v[116:119], v[36:39], v[236:239]
    ds_read_b64_tr_b16 v[116:117], v59 offset:40960
    s_waitcnt lgkmcnt(13)
    v_mfma_f32_16x16x32_bf16 v[240:243], v[120:123], v[32:35], v[240:243]
    ds_read_b64_tr_b16 v[118:119], v59 offset:41984
    v_mfma_f32_16x16x32_bf16 v[244:247], v[120:123], v[36:39], v[244:247]
    ds_read_b64_tr_b16 v[120:121], v60 offset:40960
    s_waitcnt lgkmcnt(13)
    v_mfma_f32_16x16x32_bf16 v[248:251], v[124:127], v[32:35], v[248:251]
    ds_read_b64_tr_b16 v[122:123], v60 offset:41984
    v_mfma_f32_16x16x32_bf16 v[252:255], v[124:127], v[36:39], v[252:255]
    ds_read_b64_tr_b16 v[124:125], v61 offset:40960
    ds_read_b64_tr_b16 v[126:127], v61 offset:41984
    s_waitcnt lgkmcnt(14)
    v_mfma_f32_16x16x32_bf16 v[192:195], v[96:99], v[64:67], v[192:195]
    v_mfma_f32_16x16x32_bf16 v[196:199], v[96:99], v[68:71], v[196:199]
    ds_read_b64_tr_b16 v[96:97], v54 offset:49152
    s_waitcnt lgkmcnt(13)
    v_mfma_f32_16x16x32_bf16 v[200:203], v[100:103], v[64:67], v[200:203]
    ds_read_b64_tr_b16 v[98:99], v54 offset:50176
    v_mfma_f32_16x16x32_bf16 v[204:207], v[100:103], v[68:71], v[204:207]
    ds_read_b64_tr_b16 v[100:101], v55 offset:49152
    s_waitcnt lgkmcnt(13)
    v_mfma_f32_16x16x32_bf16 v[208:211], v[104:107], v[64:67], v[208:211]
    ds_read_b64_tr_b16 v[102:103], v55 offset:50176
    v_mfma_f32_16x16x32_bf16 v[212:215], v[104:107], v[68:71], v[212:215]
    ds_read_b64_tr_b16 v[104:105], v56 offset:49152
    s_waitcnt lgkmcnt(13)
    v_mfma_f32_16x16x32_bf16 v[216:219], v[108:111], v[64:67], v[216:219]
    ds_read_b64_tr_b16 v[106:107], v56 offset:50176
    buffer_store_dwordx4 v[148:151], v13, s[8:11], s67 offen sc1
    s_add_u32 s67, s67, s68
    v_mfma_f32_16x16x32_bf16 v[220:223], v[108:111], v[68:71], v[220:223]
    ds_read_b64_tr_b16 v[108:109], v57 offset:49152
    s_waitcnt lgkmcnt(13)
    v_mfma_f32_16x16x32_bf16 v[224:227], v[112:115], v[64:67], v[224:227]
    ds_read_b64_tr_b16 v[110:111], v57 offset:50176
    v_mfma_f32_16x16x32_bf16 v[228:231], v[112:115], v[68:71], v[228:231]
    ds_read_b64_tr_b16 v[112:113], v58 offset:49152
    s_waitcnt lgkmcnt(13)
    v_mfma_f32_16x16x32_bf16 v[232:235], v[116:119], v[64:67], v[232:235]
    ds_read_b64_tr_b16 v[114:115], v58 offset:50176
    v_mfma_f32_16x16x32_bf16 v[236:239], v[116:119], v[68:71], v[236:239]
    ds_read_b64_tr_b16 v[116:117], v59 offset:49152
    s_waitcnt lgkmcnt(13)
    v_mfma_f32_16x16x32_bf16 v[240:243], v[120:123], v[64:67], v[240:243]
    ds_read_b64_tr_b16 v[118:119], v59 offset:50176
    v_mfma_f32_16x16x32_bf16 v[244:247], v[120:123], v[68:71], v[244:247]
    ds_read_b64_tr_b16 v[120:121], v60 offset:49152
    s_waitcnt lgkmcnt(13)
    v_mfma_f32_16x16x32_bf16 v[248:251], v[124:127], v[64:67], v[248:251]
    ds_read_b64_tr_b16 v[122:123], v60 offset:50176
    v_mfma_f32_16x16x32_bf16 v[252:255], v[124:127], v[68:71], v[252:255]
    ds_read_b64_tr_b16 v[124:125], v61 offset:49152
    ds_read_b64_tr_b16 v[126:127], v61 offset:50176
    s_waitcnt lgkmcnt(14)
    v_mfma_f32_16x16x32_bf16 v[192:195], v[96:99], v[72:75], v[192:195]
    v_mfma_f32_16x16x32_bf16 v[196:199], v[96:99], v[76:79], v[196:199]
    ds_read_b64_tr_b16 v[96:97], v54 offset:57344
    s_waitcnt lgkmcnt(13)
    v_mfma_f32_16x16x32_bf16 v[200:203], v[100:103], v[72:75], v[200:203]
    ds_read_b64_tr_b16 v[98:99], v54 offset:58368
    v_mfma_f32_16x16x32_bf16 v[204:207], v[100:103], v[76:79], v[204:207]
    ds_read_b64_tr_b16 v[100:101], v55 offset:57344
    s_waitcnt lgkmcnt(13)
    v_mfma_f32_16x16x32_bf16 v[208:211], v[104:107], v[72:75], v[208:211]
    ds_read_b64_tr_b16 v[102:103], v55 offset:58368
    v_mfma_f32_16x16x32_bf16 v[212:215], v[104:107], v[76:79], v[212:215]
    ds_read_b64_tr_b16 v[104:105], v56 offset:57344
    s_waitcnt lgkmcnt(13)
    v_mfma_f32_16x16x32_bf16 v[216:219], v[108:111], v[72:75], v[216:219]
    ds_read_b64_tr_b16 v[106:107], v56 offset:58368
    buffer_store_dwordx4 v[152:155], v13, s[8:11], s67 offen sc1
    s_add_u32 s67, s67, 1024
    v_mfma_f32_16x16x32_bf16 v[220:223], v[108:111], v[76:79], v[220:223]
    ds_read_b64_tr_b16 v[108:109], v57 offset:57344
    s_waitcnt lgkmcnt(13)
    v_mfma_f32_16x16x32_bf16 v[224:227], v[112:115], v[72:75], v[224:227]
    ds_read_b64_tr_b16 v[110:111], v57 offset:58368
    v_mfma_f32_16x16x32_bf16 v[228:231], v[112:115], v[76:79], v[228:231]
    ds_read_b64_tr_b16 v[112:113], v58 offset:57344
    s_waitcnt lgkmcnt(13)
    v_mfma_f32_16x16x32_bf16 v[232:235], v[116:119], v[72:75], v[232:235]
    ds_read_b64_tr_b16 v[114:115], v58 offset:58368
    v_mfma_f32_16x16x32_bf16 v[236:239], v[116:119], v[76:79], v[236:239]
    ds_read_b64_tr_b16 v[116:117], v59 offset:57344
    s_waitcnt lgkmcnt(13)
    v_mfma_f32_16x16x32_bf16 v[240:243], v[120:123], v[72:75], v[240:243]
    ds_read_b64_tr_b16 v[118:119], v59 offset:58368
    v_mfma_f32_16x16x32_bf16 v[244:247], v[120:123], v[76:79], v[244:247]
    ds_read_b64_tr_b16 v[120:121], v60 offset:57344
    s_waitcnt lgkmcnt(13)
    v_mfma_f32_16x16x32_bf16 v[248:251], v[124:127], v[72:75], v[248:251]
    ds_read_b64_tr_b16 v[122:123], v60 offset:58368
    v_mfma_f32_16x16x32_bf16 v[252:255], v[124:127], v[76:79], v[252:255]
    ds_read_b64_tr_b16 v[124:125], v61 offset:57344
    ds_read_b64_tr_b16 v[126:127], v61 offset:58368
    s_waitcnt lgkmcnt(14)
    v_mfma_f32_16x16x32_bf16 v[192:195], v[96:99], v[80:83], v[192:195]
    v_mfma_f32_16x16x32_bf16 v[196:199], v[96:99], v[84:87], v[196:199]
    s_waitcnt lgkmcnt(12)
    v_mfma_f32_16x16x32_bf16 v[200:203], v[100:103], v[80:83], v[200:203]
    v_mfma_f32_16x16x32_bf16 v[204:207], v[100:103], v[84:87], v[204:207]
    s_waitcnt lgkmcnt(10)
    v_mfma_f32_16x16x32_bf16 v[208:211], v[104:107], v[80:83], v[208:211]
    v_mfma_f32_16x16x32_bf16 v[212:215], v[104:107], v[84:87], v[212:215]
    s_waitcnt lgkmcnt(8)
    v_mfma_f32_16x16x32_bf16 v[216:219], v[108:111], v[80:83], v[216:219]
    buffer_store_dwordx4 v[156:159], v13, s[8:11], s67 offen sc1
    s_add_u32 s67, s67, s69
    v_mfma_f32_16x16x32_bf16 v[220:223], v[108:111], v[84:87], v[220:223]
    s_waitcnt lgkmcnt(6)
    v_mfma_f32_16x16x32_bf16 v[224:227], v[112:115], v[80:83], v[224:227]
    v_mfma_f32_16x16x32_bf16 v[228:231], v[112:115], v[84:87], v[228:231]
    s_waitcnt lgkmcnt(4)
    v_mfma_f32_16x16x32_bf16 v[232:235], v[116:119], v[80:83], v[232:235]
    v_mfma_f32_16x16x32_bf16 v[236:239], v[116:119], v[84:87], v[236:239]
    s_waitcnt lgkmcnt(2)
    v_mfma_f32_16x16x32_bf16 v[240:243], v[120:123], v[80:83], v[240:243]
    v_mfma_f32_16x16x32_bf16 v[244:247], v[120:123], v[84:87], v[244:247]
    s_waitcnt lgkmcnt(0)
    v_mfma_f32_16x16x32_bf16 v[248:251], v[124:127], v[80:83], v[248:251]
    v_mfma_f32_16x16x32_bf16 v[252:255], v[124:127], v[84:87], v[252:255]
    s_cmp_lt_u32 s3, 4
    s_cbranch_scc1 L_qb
    s_barrier
L_qb:
    s_mov_b32 s6, 0x3e0293ee
    s_nop 7
    buffer_store_dwordx4 v[160:163], v13, s[8:11], s67 offen sc1
    s_add_u32 s67, s67, 1024
    buffer_store_dwordx4 v[164:167], v13, s[8:11], s67 offen sc1
    s_add_u32 s67, s67, s68
    buffer_store_dwordx4 v[168:171], v13, s[8:11], s67 offen sc1
    s_add_u32 s67, s67, 1024
    buffer_store_dwordx4 v[172:175], v13, s[8:11], s67 offen sc1
    s_add_u32 s67, s67, s69
    v_mul_f32 v192, s6, v192
    v_mul_f32 v193, s6, v193
    v_mul_f32 v194, s6, v194
    v_mul_f32 v195, s6, v195
    v_cvt_pk_bf16_f32 v16, v192, v193
    v_cvt_pk_bf16_f32 v17, v194, v195
    v_mul_f32 v200, s6, v200
    v_mul_f32 v201, s6, v201
    v_mul_f32 v202, s6, v202
    v_mul_f32 v203, s6, v203
    v_cvt_pk_bf16_f32 v18, v200, v201
    v_cvt_pk_bf16_f32 v19, v202, v203
    v_mul_f32 v208, s6, v208
    v_mul_f32 v209, s6, v209
    v_mul_f32 v210, s6, v210
    v_mul_f32 v211, s6, v211
    v_cvt_pk_bf16_f32 v20, v208, v209
    v_cvt_pk_bf16_f32 v21, v210, v211
    v_mul_f32 v216, s6, v216
    v_mul_f32 v217, s6, v217
    v_mul_f32 v218, s6, v218
    v_mul_f32 v219, s6, v219
    v_cvt_pk_bf16_f32 v22, v216, v217
    v_cvt_pk_bf16_f32 v23, v218, v219
    v_mul_f32 v224, s6, v224
    v_mul_f32 v225, s6, v225
    v_mul_f32 v226, s6, v226
    v_mul_f32 v227, s6, v227
    v_cvt_pk_bf16_f32 v24, v224, v225
    v_cvt_pk_bf16_f32 v25, v226, v227
    v_mul_f32 v232, s6, v232
    v_mul_f32 v233, s6, v233
    v_mul_f32 v234, s6, v234
    v_mul_f32 v235, s6, v235
    v_cvt_pk_bf16_f32 v26, v232, v233
    v_cvt_pk_bf16_f32 v27, v234, v235
    v_mul_f32 v240, s6, v240
    v_mul_f32 v241, s6, v241
    v_mul_f32 v242, s6, v242
    v_mul_f32 v243, s6, v243
    v_cvt_pk_bf16_f32 v28, v240, v241
    v_cvt_pk_bf16_f32 v29, v242, v243
    v_mul_f32 v248, s6, v248
    v_mul_f32 v249, s6, v249
    v_mul_f32 v250, s6, v250
    v_mul_f32 v251, s6, v251
    v_cvt_pk_bf16_f32 v30, v248, v249
    v_cvt_pk_bf16_f32 v31, v250, v251
    v_mul_f32 v196, s6, v196
    v_mul_f32 v197, s6, v197
    v_mul_f32 v198, s6, v198
    v_mul_f32 v199, s6, v199
    v_cvt_pk_bf16_f32 v32, v196, v197
    v_cvt_pk_bf16_f32 v33, v198, v199
    v_mul_f32 v204, s6, v204
    v_mul_f32 v205, s6, v205
    v_mul_f32 v206, s6, v206
    v_mul_f32 v207, s6, v207
    v_cvt_pk_bf16_f32 v34, v204, v205
    v_cvt_pk_bf16_f32 v35, v206, v207
    v_mul_f32 v212, s6, v212
    v_mul_f32 v213, s6, v213
    v_mul_f32 v214, s6, v214
    v_mul_f32 v215, s6, v215
    v_cvt_pk_bf16_f32 v36, v212, v213
    v_cvt_pk_bf16_f32 v37, v214, v215
    v_mul_f32 v220, s6, v220
    v_mul_f32 v221, s6, v221
    v_mul_f32 v222, s6, v222
    v_mul_f32 v223, s6, v223
    v_cvt_pk_bf16_f32 v38, v220, v221
    v_cvt_pk_bf16_f32 v39, v222, v223
    v_mul_f32 v228, s6, v228
    v_mul_f32 v229, s6, v229
    v_mul_f32 v230, s6, v230
    v_mul_f32 v231, s6, v231
    v_cvt_pk_bf16_f32 v40, v228, v229
    v_cvt_pk_bf16_f32 v41, v230, v231
    v_mul_f32 v236, s6, v236
    v_mul_f32 v237, s6, v237
    v_mul_f32 v238, s6, v238
    v_mul_f32 v239, s6, v239
    v_cvt_pk_bf16_f32 v42, v236, v237
    v_cvt_pk_bf16_f32 v43, v238, v239
    v_mul_f32 v244, s6, v244
    v_mul_f32 v245, s6, v245
    v_mul_f32 v246, s6, v246
    v_mul_f32 v247, s6, v247
    v_cvt_pk_bf16_f32 v44, v244, v245
    v_cvt_pk_bf16_f32 v45, v246, v247
    v_mul_f32 v252, s6, v252
    v_mul_f32 v253, s6, v253
    v_mul_f32 v254, s6, v254
    v_mul_f32 v255, s6, v255
    v_cvt_pk_bf16_f32 v46, v252, v253
    v_cvt_pk_bf16_f32 v47, v254, v255
    v_mov_b64 v[192:193], 0
    v_mov_b64 v[194:195], 0
    v_mov_b64 v[196:197], 0
    v_mov_b64 v[198:199], 0
    v_mov_b64 v[200:201], 0
    v_mov_b64 v[202:203], 0
    v_mov_b64 v[204:205], 0
    v_mov_b64 v[206:207], 0
    v_mov_b64 v[208:209], 0
    v_mov_b64 v[210:211], 0
    v_mov_b64 v[212:213], 0
    v_mov_b64 v[214:215], 0
    v_mov_b64 v[216:217], 0
    v_mov_b64 v[218:219], 0
    v_mov_b64 v[220:221], 0
    v_mov_b64 v[222:223], 0
    v_mov_b64 v[224:225], 0
    v_mov_b64 v[226:227], 0
    v_mov_b64 v[228:229], 0
    v_mov_b64 v[230:231], 0
    v_mov_b64 v[232:233], 0
    v_mov_b64 v[234:235], 0
    v_mov_b64 v[236:237], 0
    v_mov_b64 v[238:239], 0
    v_mov_b64 v[240:241], 0
    v_mov_b64 v[242:243], 0
    v_mov_b64 v[244:245], 0
    v_mov_b64 v[246:247], 0
    v_mov_b64 v[248:249], 0
    v_mov_b64 v[250:251], 0
    v_mov_b64 v[252:253], 0
    v_mov_b64 v[254:255], 0
    v_mov_b64 v[144:145], 0
    v_mov_b64 v[146:147], 0
    v_mov_b64 v[148:149], 0
    v_mov_b64 v[150:151], 0
    v_mov_b64 v[152:153], 0
    v_mov_b64 v[154:155], 0
    v_mov_b64 v[156:157], 0
    v_mov_b64 v[158:159], 0
    v_mov_b64 v[160:161], 0
    v_mov_b64 v[162:163], 0
    v_mov_b64 v[164:165], 0
    v_mov_b64 v[166:167], 0
    v_mov_b32 v168, 0x3f803f80
    v_mov_b32 v169, 0x3f803f80
    v_mov_b32 v170, 0x3f803f80
    v_mov_b32 v171, 0x3f803f80
    v_add_u32 v48, s100, v13
    s_waitcnt vmcnt(8)
    s_mov_b32 s72, 0x40004000
    s_mov_b32 s65, 0
    s_sub_u32 s63, 15, s5
    s_mov_b32 s62, -1
    s_cmp_ge_u32 s3, 4
    s_cbranch_scc1 L_qb2
    s_barrier
L_qb2:
    ds_read_b128 v[96:99], v48 offset:0
    ds_read_b128 v[100:103], v48 offset:1024
    ds_read_b128 v[104:107], v48 offset:2048
    ds_read_b128 v[108:111], v48 offset:3072
    ds_read_b128 v[112:115], v48 offset:4096
    ds_read_b128 v[116:119], v48 offset:5120
    ds_read_b128 v[120:123], v48 offset:6144
    ds_read_b128 v[124:127], v48 offset:7168
    s_cmp_lg_u32 s60, 0
    s_cbranch_scc1 L_nm0
    s_call_b64 s[82:83], L_mask
L_nm0:
    s_waitcnt lgkmcnt(7)
    v_mfma_f32_16x16x32_bf16 v[64:67], v[96:99], v[16:19], v[144:147]
    v_mfma_f32_16x16x32_bf16 v[68:71], v[96:99], v[32:35], v[148:151]
    ds_read_b128 v[96:99], v48 offset:8192
    s_waitcnt lgkmcnt(7)
    v_mfma_f32_16x16x32_bf16 v[64:67], v[100:103], v[20:23], v[64:67]
    v_mfma_f32_16x16x32_bf16 v[68:71], v[100:103], v[36:39], v[68:71]
    ds_read_b128 v[100:103], v48 offset:9216
    s_waitcnt lgkmcnt(7)
    v_mfma_f32_16x16x32_bf16 v[64:67], v[104:107], v[24:27], v[64:67]
    v_mfma_f32_16x16x32_bf16 v[68:71], v[104:107], v[40:43], v[68:71]
    ds_read_b128 v[104:107], v48 offset:10240
    s_waitcnt lgkmcnt(7)
    v_mfma_f32_16x16x32_bf16 v[64:67], v[108:111], v[28:31], v[64:67]
    v_mfma_f32_16x16x32_bf16 v[68:71], v[108:111], v[44:47], v[68:71]
    ds_read_b128 v[108:111], v48 offset:11264
    s_waitcnt lgkmcnt(7)
    v_mfma_f32_16x16x32_bf16 v[72:75], v[112:115], v[16:19], v[152:155]
    v_mfma_f32_16x16x32_bf16 v[76:79], v[112:115], v[32:35], v[156:159]
    ds_read_b128 v[112:115], v48 offset:12288
    s_waitcnt lgkmcnt(7)
    v_mfma_f32_16x16x32_bf16 v[72:75], v[116:119], v[20:23], v[72:75]
    v_mfma_f32_16x16x32_bf16 v[76:79], v[116:119], v[36:39], v[76:79]
    ds_read_b128 v[116:119], v48 offset:13312
    s_waitcnt lgkmcnt(7)
    v_mfma_f32_16x16x32_bf16 v[72:75], v[120:123], v[24:27], v[72:75]
    v_mfma_f32_16x16x32_bf16 v[76:79], v[120:123], v[40:43], v[76:79]
    ds_read_b128 v[120:123], v48 offset:14336
    s_waitcnt lgkmcnt(7)
    v_mfma_f32_16x16x32_bf16 v[72:75], v[124:127], v[28:31], v[72:75]
    v_mfma_f32_16x16x32_bf16 v[76:79], v[124:127], v[44:47], v[76:79]
    ds_read_b128 v[124:127], v48 offset:15360
    s_nop 7
    v_max3_f32 v58, v64, v65, v66
    v_max3_f32 v58, v58, v67, v72
    v_max3_f32 v58, v58, v73, v74
    v_max_f32 v58, v58, v75
    v_mov_b32 v60, v58
    s_nop 1
    v_permlane16_swap_b32 v58, v60
    s_nop 1
    v_max_f32 v58, v58, v60
    v_mov_b32 v60, v58
    s_nop 1
    v_permlane32_swap_b32 v58, v60
    s_nop 1
    v_max_f32 v58, v58, v60
    v_add_f32 v58, 0x41c00000, v58
    v_sub_f32 v64, v64, v58
    v_sub_f32 v144, 0, v58
    v_sub_f32 v65, v65, v58
    v_sub_f32 v145, 0, v58
    v_sub_f32 v66, v66, v58
    v_sub_f32 v146, 0, v58
    v_sub_f32 v67, v67, v58
    v_sub_f32 v147, 0, v58
    v_sub_f32 v72, v72, v58
    v_sub_f32 v152, 0, v58
    v_sub_f32 v73, v73, v58
    v_sub_f32 v153, 0, v58
    v_sub_f32 v74, v74, v58
    v_sub_f32 v154, 0, v58
    v_sub_f32 v75, v75, v58
    v_sub_f32 v155, 0, v58
    v_max3_f32 v59, v68, v69, v70
    v_max3_f32 v59, v59, v71, v76
    v_max3_f32 v59, v59, v77, v78
    v_max_f32 v59, v59, v79
    v_mov_b32 v60, v59
    s_nop 1
    v_permlane16_swap_b32 v59, v60
    s_nop 1
    v_max_f32 v59, v59, v60
    v_mov_b32 v60, v59
    s_nop 1
    v_permlane32_swap_b32 v59, v60
    s_nop 1
    v_max_f32 v59, v59, v60
    v_add_f32 v59, 0x41c00000, v59
    v_sub_f32 v68, v68, v59
    v_sub_f32 v148, 0, v59
    v_sub_f32 v69, v69, v59
    v_sub_f32 v149, 0, v59
    v_sub_f32 v70, v70, v59
    v_sub_f32 v150, 0, v59
    v_sub_f32 v71, v71, v59
    v_sub_f32 v151, 0, v59
    v_sub_f32 v76, v76, v59
    v_sub_f32 v156, 0, v59
    v_sub_f32 v77, v77, v59
    v_sub_f32 v157, 0, v59
    v_sub_f32 v78, v78, v59
    v_sub_f32 v158, 0, v59
    v_sub_f32 v79, v79, v59
    v_sub_f32 v159, 0, v59
    s_cmp_lg_u32 s60, 1
    s_cbranch_scc1 L_nm1
    s_call_b64 s[82:83], L_mask
L_nm1:
    v_exp_f32 v58, v64
    v_exp_f32 v59, v65
    s_waitcnt lgkmcnt(7)
    v_mfma_f32_16x16x32_bf16 v[80:83], v[96:99], v[16:19], v[144:147]
    s_waitcnt lgkmcnt(6)
    v_exp_f32 v60, v66
    v_exp_f32 v61, v67
    v_mfma_f32_16x16x32_bf16 v[84:87], v[96:99], v[32:35], v[148:151]
    ds_read_b128 v[96:99], v48 offset:49152
    v_cvt_pk_bf16_f32 v128, v58, v59
    v_cvt_pk_bf16_f32 v129, v60, v61
    v_mfma_f32_16x16x32_bf16 v[80:83], v[100:103], v[20:23], v[80:83]
    s_waitcnt lgkmcnt(6)
    v_exp_f32 v58, v68
    v_exp_f32 v59, v69
    v_mfma_f32_16x16x32_bf16 v[84:87], v[100:103], v[36:39], v[84:87]
    ds_read_b128 v[100:103], v48 offset:50176
    v_cvt_pk_bf16_f32 v132, v58, v59
    v_mfma_f32_16x16x32_bf16 v[80:83], v[104:107], v[24:27], v[80:83]
    s_waitcnt lgkmcnt(6)
    v_exp_f32 v60, v70
    v_exp_f32 v61, v71
    v_mfma_f32_16x16x32_bf16 v[84:87], v[104:107], v[40:43], v[84:87]
    ds_read_b128 v[104:107], v48 offset:51200
    v_cvt_pk_bf16_f32 v133, v60, v61
    v_mfma_f32_16x16x32_bf16 v[80:83], v[108:111], v[28:31], v[80:83]
    s_waitcnt lgkmcnt(6)
    v_exp_f32 v58, v72
    v_exp_f32 v59, v73
    v_mfma_f32_16x16x32_bf16 v[84:87], v[108:111], v[44:47], v[84:87]
    ds_read_b128 v[108:111], v48 offset:52224
    v_cvt_pk_bf16_f32 v130, v58, v59
    v_mfma_f32_16x16x32_bf16 v[88:91], v[112:115], v[16:19], v[152:155]
    s_waitcnt lgkmcnt(6)
    v_exp_f32 v60, v74
    v_exp_f32 v61, v75
    v_mfma_f32_16x16x32_bf16 v[92:95], v[112:115], v[32:35], v[156:159]
    ds_read_b128 v[112:115], v48 offset:53248
    v_cvt_pk_bf16_f32 v131, v60, v61
    v_mfma_f32_16x16x32_bf16 v[88:91], v[116:119], v[20:23], v[88:91]
    s_waitcnt lgkmcnt(6)
    v_exp_f32 v58, v76
    v_exp_f32 v59, v77
    v_mfma_f32_16x16x32_bf16 v[92:95], v[116:119], v[36:39], v[92:95]
    ds_read_b128 v[116:119], v48 offset:54272
    v_cvt_pk_bf16_f32 v134, v58, v59
    v_mfma_f32_16x16x32_bf16 v[88:91], v[120:123], v[24:27], v[88:91]
    s_waitcnt lgkmcnt(6)
    v_exp_f32 v60, v78
    v_exp_f32 v61, v79
    v_mfma_f32_16x16x32_bf16 v[92:95], v[120:123], v[40:43], v[92:95]
    ds_read_b128 v[120:123], v48 offset:55296
    v_cvt_pk_bf16_f32 v135, v60, v61
    v_mfma_f32_16x16x32_bf16 v[88:91], v[124:127], v[28:31], v[88:91]
    s_waitcnt lgkmcnt(6)
    v_or3_b32 v62, v128, v129, v132
    v_or3_b32 v62, v62, v133, v130
    v_or3_b32 v62, v62, v131, v134
    v_bitop3_b32 v62, v62, v135, s72 bitop3:0xa8
    v_cmp_ne_u32 vcc, s65, v62
    v_mfma_f32_16x16x32_bf16 v[92:95], v[124:127], v[44:47], v[92:95]
    ds_read_b128 v[124:127], v48 offset:56320
    s_cbranch_vccnz L_back_9_h
L_back_9:
    s_nop 7
    v_exp_f32 v58, v80
    v_exp_f32 v59, v81
    s_call_b64 s[82:83], L_load
    s_mov_b32 s62, 0
    buffer_store_dwordx4 v[176:179], v13, s[8:11], s67 offen sc1
    s_add_u32 s67, s67, 1024
    buffer_store_dwordx4 v[180:183], v13, s[8:11], s67 offen sc1
    s_add_u32 s67, s67, s68
    buffer_store_dwordx4 v[184:187], v13, s[8:11], s67 offen sc1
    s_add_u32 s67, s67, 1024
    buffer_store_dwordx4 v[188:191], v13, s[8:11], s67 offen sc1
    s_add_u32 s67, s67, s69
    s_sub_i32 s64, s60, 2
    s_cmp_eq_u32 s60, 0
    s_cbranch_scc1 L_pv2
    s_cmp_eq_u32 s60, 1
    s_cbranch_scc1 L_tail2
    s_cmp_lg_u32 s60, 2
    s_cbranch_scc1 L_st2
    s_call_b64 s[82:83], L_mask
    s_branch L_st2
.p2align 6
L_st0:
    v_mfma_f32_16x16x32_bf16 v[192:195], v[96:99], v[128:131], v[192:195]
    s_waitcnt lgkmcnt(6)
    v_exp_f32 v60, v82
    v_mfma_f32_16x16x32_bf16 v[196:199], v[96:99], v[132:135], v[196:199]
    ds_read_b128 v[96:99], v48 offset:0
    v_cvt_pk_bf16_f32 v136, v58, v59
    v_mfma_f32_16x16x32_bf16 v[200:203], v[100:103], v[128:131], v[200:203]
    s_waitcnt lgkmcnt(6)
    v_exp_f32 v61, v83
    v_mfma_f32_16x16x32_bf16 v[204:207], v[100:103], v[132:135], v[204:207]
    s_sub_i32 s64, s64, 1
    ds_read_b128 v[100:103], v48 offset:1024
    v_cvt_pk_bf16_f32 v137, v60, v61
    v_mfma_f32_16x16x32_bf16 v[208:211], v[104:107], v[128:131], v[208:211]
    s_waitcnt lgkmcnt(6)
    v_exp_f32 v58, v84
    v_mfma_f32_16x16x32_bf16 v[212:215], v[104:107], v[132:135], v[212:215]
    ds_read_b128 v[104:107], v48 offset:2048
    v_mfma_f32_16x16x32_bf16 v[216:219], v[108:111], v[128:131], v[216:219]
    s_waitcnt lgkmcnt(6)
    v_exp_f32 v59, v85
    v_mfma_f32_16x16x32_bf16 v[220:223], v[108:111], v[132:135], v[220:223]
    s_cmp_gt_i32 s64, 0
    ds_read_b128 v[108:111], v48 offset:3072
    v_cvt_pk_bf16_f32 v140, v58, v59
    v_mfma_f32_16x16x32_bf16 v[224:227], v[112:115], v[128:131], v[224:227]
    s_waitcnt lgkmcnt(6)
    v_exp_f32 v60, v86
    v_mfma_f32_16x16x32_bf16 v[228:231], v[112:115], v[132:135], v[228:231]
    ds_read_b128 v[112:115], v48 offset:4096
    v_or3_b32 v62, v136, v137, v140
    v_mfma_f32_16x16x32_bf16 v[232:235], v[116:119], v[128:131], v[232:235]
    s_waitcnt lgkmcnt(6)
    v_exp_f32 v61, v87
    v_mfma_f32_16x16x32_bf16 v[236:239], v[116:119], v[132:135], v[236:239]
    s_cselect_b32 s65, 0, 1
    ds_read_b128 v[116:119], v48 offset:5120
    v_cvt_pk_bf16_f32 v141, v60, v61
    v_mfma_f32_16x16x32_bf16 v[240:243], v[120:123], v[128:131], v[240:243]
    s_waitcnt lgkmcnt(6)
    v_exp_f32 v58, v88
    v_mfma_f32_16x16x32_bf16 v[244:247], v[120:123], v[132:135], v[244:247]
    ds_read_b128 v[120:123], v48 offset:6144
    v_mfma_f32_16x16x32_bf16 v[248:251], v[124:127], v[128:131], v[248:251]
    s_waitcnt lgkmcnt(6)
    v_exp_f32 v59, v89
    v_mfma_f32_16x16x32_bf16 v[252:255], v[124:127], v[132:135], v[252:255]
    ds_read_b128 v[124:127], v48 offset:7168
    v_cvt_pk_bf16_f32 v138, v58, v59
    v_mfma_f32_16x16x32_bf16 v[64:67], v[96:99], v[16:19], v[144:147]
    s_waitcnt lgkmcnt(6)
    v_exp_f32 v60, v90
    v_mfma_f32_16x16x32_bf16 v[68:71], v[96:99], v[32:35], v[148:151]
    ds_read_b128 v[96:99], v48 offset:40960
    v_or3_b32 v62, v62, v141, v138
    v_mfma_f32_16x16x32_bf16 v[64:67], v[100:103], v[20:23], v[64:67]
    v_exp_f32 v61, v91
    v_mfma_f32_16x16x32_bf16 v[68:71], v[100:103], v[36:39], v[68:71]
    ds_read_b128 v[100:103], v48 offset:41984
    v_cvt_pk_bf16_f32 v139, v60, v61
    v_mfma_f32_16x16x32_bf16 v[160:163], v[168:171], v[128:131], v[160:163]
    s_waitcnt lgkmcnt(7)
    v_exp_f32 v58, v92
    v_mfma_f32_16x16x32_bf16 v[164:167], v[168:171], v[132:135], v[164:167]
    v_mfma_f32_16x16x32_bf16 v[64:67], v[104:107], v[24:27], v[64:67]
    s_waitcnt lgkmcnt(6)
    v_exp_f32 v59, v93
    v_mfma_f32_16x16x32_bf16 v[68:71], v[104:107], v[40:43], v[68:71]
    ds_read_b128 v[104:107], v48 offset:43008
    v_cvt_pk_bf16_f32 v142, v58, v59
    v_mfma_f32_16x16x32_bf16 v[64:67], v[108:111], v[28:31], v[64:67]
    s_waitcnt lgkmcnt(6)
    v_exp_f32 v60, v94
    v_mfma_f32_16x16x32_bf16 v[68:71], v[108:111], v[44:47], v[68:71]
    ds_read_b128 v[108:111], v48 offset:44032
    v_or3_b32 v62, v62, v139, v142
    v_mfma_f32_16x16x32_bf16 v[72:75], v[112:115], v[16:19], v[152:155]
    s_waitcnt lgkmcnt(6)
    v_exp_f32 v61, v95
    v_mfma_f32_16x16x32_bf16 v[76:79], v[112:115], v[32:35], v[156:159]
    ds_read_b128 v[112:115], v48 offset:45056
    v_cvt_pk_bf16_f32 v143, v60, v61
    v_mfma_f32_16x16x32_bf16 v[72:75], v[116:119], v[20:23], v[72:75]
    s_waitcnt lgkmcnt(6)
    v_bitop3_b32 v62, v62, v143, s72 bitop3:0xa8
    v_cmp_ne_u32 vcc, s65, v62
    v_mfma_f32_16x16x32_bf16 v[76:79], v[116:119], v[36:39], v[76:79]
    ds_read_b128 v[116:119], v48 offset:46080
    v_mfma_f32_16x16x32_bf16 v[72:75], v[120:123], v[24:27], v[72:75]
    s_waitcnt lgkmcnt(6)
    v_exp_f32 v58, v64
    v_mfma_f32_16x16x32_bf16 v[76:79], v[120:123], v[40:43], v[76:79]
    ds_read_b128 v[120:123], v48 offset:47104
    v_mfma_f32_16x16x32_bf16 v[72:75], v[124:127], v[28:31], v[72:75]
    s_waitcnt lgkmcnt(6)
    v_exp_f32 v59, v65
    v_mfma_f32_16x16x32_bf16 v[76:79], v[124:127], v[44:47], v[76:79]
    ds_read_b128 v[124:127], v48 offset:48128
    s_cbranch_vccnz L_back_10_h
L_back_10:
    v_mfma_f32_16x16x32_bf16 v[192:195], v[96:99], v[136:139], v[192:195]
    s_waitcnt lgkmcnt(6)
    v_exp_f32 v60, v66
    v_mfma_f32_16x16x32_bf16 v[196:199], v[96:99], v[140:143], v[196:199]
    ds_read_b128 v[96:99], v48 offset:8192
    v_cvt_pk_bf16_f32 v128, v58, v59
    v_mfma_f32_16x16x32_bf16 v[200:203], v[100:103], v[136:139], v[200:203]
    s_waitcnt lgkmcnt(6)
    v_exp_f32 v61, v67
    v_mfma_f32_16x16x32_bf16 v[204:207], v[100:103], v[140:143], v[204:207]
    s_sub_i32 s64, s64, 1
    ds_read_b128 v[100:103], v48 offset:9216
    v_cvt_pk_bf16_f32 v129, v60, v61
    v_mfma_f32_16x16x32_bf16 v[208:211], v[104:107], v[136:139], v[208:211]
    s_waitcnt lgkmcnt(6)
    v_exp_f32 v58, v68
    v_mfma_f32_16x16x32_bf16 v[212:215], v[104:107], v[140:143], v[212:215]
    ds_read_b128 v[104:107], v48 offset:10240
    v_mfma_f32_16x16x32_bf16 v[216:219], v[108:111], v[136:139], v[216:219]
    s_waitcnt lgkmcnt(6)
    v_exp_f32 v59, v69
    v_mfma_f32_16x16x32_bf16 v[220:223], v[108:111], v[140:143], v[220:223]
    s_cmp_gt_i32 s64, 0
    ds_read_b128 v[108:111], v48 offset:11264
    v_cvt_pk_bf16_f32 v132, v58, v59
    v_mfma_f32_16x16x32_bf16 v[224:227], v[112:115], v[136:139], v[224:227]
    s_waitcnt lgkmcnt(6)
    v_exp_f32 v60, v70
    v_mfma_f32_16x16x32_bf16 v[228:231], v[112:115], v[140:143], v[228:231]
    ds_read_b128 v[112:115], v48 offset:12288
    v_or3_b32 v62, v128, v129, v132
    v_mfma_f32_16x16x32_bf16 v[232:235], v[116:119], v[136:139], v[232:235]
    s_waitcnt lgkmcnt(6)
    v_exp_f32 v61, v71
    v_mfma_f32_16x16x32_bf16 v[236:239], v[116:119], v[140:143], v[236:239]
    s_cselect_b32 s65, 0, 1
    ds_read_b128 v[116:119], v48 offset:13312
    v_cvt_pk_bf16_f32 v133, v60, v61
    v_mfma_f32_16x16x32_bf16 v[240:243], v[120:123], v[136:139], v[240:243]
    s_waitcnt lgkmcnt(6)
    v_exp_f32 v58, v72
    v_mfma_f32_16x16x32_bf16 v[244:247], v[120:123], v[140:143], v[244:247]
    ds_read_b128 v[120:123], v48 offset:14336
    v_mfma_f32_16x16x32_bf16 v[248:251], v[124:127], v[136:139], v[248:251]
    s_waitcnt lgkmcnt(6)
    v_exp_f32 v59, v73
    v_mfma_f32_16x16x32_bf16 v[252:255], v[124:127], v[140:143], v[252:255]
    ds_read_b128 v[124:127], v48 offset:15360
    v_cvt_pk_bf16_f32 v130, v58, v59
    v_mfma_f32_16x16x32_bf16 v[80:83], v[96:99], v[16:19], v[144:147]
    s_waitcnt lgkmcnt(6)
    v_exp_f32 v60, v74
    v_mfma_f32_16x16x32_bf16 v[84:87], v[96:99], v[32:35], v[148:151]
    ds_read_b128 v[96:99], v48 offset:49152
    v_or3_b32 v62, v62, v133, v130
    v_mfma_f32_16x16x32_bf16 v[80:83], v[100:103], v[20:23], v[80:83]
    v_exp_f32 v61, v75
    v_mfma_f32_16x16x32_bf16 v[84:87], v[100:103], v[36:39], v[84:87]
    ds_read_b128 v[100:103], v48 offset:50176
    v_cvt_pk_bf16_f32 v131, v60, v61
    v_mfma_f32_16x16x32_bf16 v[160:163], v[168:171], v[136:139], v[160:163]
    s_waitcnt lgkmcnt(7)
    v_exp_f32 v58, v76
    v_mfma_f32_16x16x32_bf16 v[164:167], v[168:171], v[140:143], v[164:167]
    v_mfma_f32_16x16x32_bf16 v[80:83], v[104:107], v[24:27], v[80:83]
    s_waitcnt lgkmcnt(6)
    v_exp_f32 v59, v77
    v_mfma_f32_16x16x32_bf16 v[84:87], v[104:107], v[40:43], v[84:87]
    ds_read_b128 v[104:107], v48 offset:51200
    v_cvt_pk_bf16_f32 v134, v58, v59
    v_mfma_f32_16x16x32_bf16 v[80:83], v[108:111], v[28:31], v[80:83]
    s_waitcnt lgkmcnt(6)
    v_exp_f32 v60, v78
    v_mfma_f32_16x16x32_bf16 v[84:87], v[108:111], v[44:47], v[84:87]
    ds_read_b128 v[108:111], v48 offset:52224
    v_or3_b32 v62, v62, v131, v134
    v_mfma_f32_16x16x32_bf16 v[88:91], v[112:115], v[16:19], v[152:155]
    s_waitcnt lgkmcnt(6)
    v_exp_f32 v61, v79
    v_mfma_f32_16x16x32_bf16 v[92:95], v[112:115], v[32:35], v[156:159]
    ds_read_b128 v[112:115], v48 offset:53248
    v_cvt_pk_bf16_f32 v135, v60, v61
    v_mfma_f32_16x16x32_bf16 v[88:91], v[116:119], v[20:23], v[88:91]
    s_waitcnt lgkmcnt(6)
    v_bitop3_b32 v62, v62, v135, s72 bitop3:0xa8
    v_cmp_ne_u32 vcc, s65, v62
    v_mfma_f32_16x16x32_bf16 v[92:95], v[116:119], v[36:39], v[92:95]
    ds_read_b128 v[116:119], v48 offset:54272
    v_mfma_f32_16x16x32_bf16 v[88:91], v[120:123], v[24:27], v[88:91]
    s_waitcnt lgkmcnt(6)
    v_exp_f32 v58, v80
    v_mfma_f32_16x16x32_bf16 v[92:95], v[120:123], v[40:43], v[92:95]
    ds_read_b128 v[120:123], v48 offset:55296
    v_mfma_f32_16x16x32_bf16 v[88:91], v[124:127], v[28:31], v[88:91]
    s_waitcnt lgkmcnt(6)
    v_exp_f32 v59, v81
    v_mfma_f32_16x16x32_bf16 v[92:95], v[124:127], v[44:47], v[92:95]
    ds_read_b128 v[124:127], v48 offset:56320
    s_cbranch_vccnz L_back_11_h
L_back_11:
L_st2:
    v_mfma_f32_16x16x32_bf16 v[192:195], v[96:99], v[128:131], v[192:195]
    s_waitcnt lgkmcnt(6)
    v_exp_f32 v60, v82
    v_mfma_f32_16x16x32_bf16 v[196:199], v[96:99], v[132:135], v[196:199]
    ds_read_b128 v[96:99], v48 offset:16384
    v_cvt_pk_bf16_f32 v136, v58, v59
    v_mfma_f32_16x16x32_bf16 v[200:203], v[100:103], v[128:131], v[200:203]
    s_waitcnt lgkmcnt(6)
    v_exp_f32 v61, v83
    v_mfma_f32_16x16x32_bf16 v[204:207], v[100:103], v[132:135], v[204:207]
    s_sub_i32 s64, s64, 1
    ds_read_b128 v[100:103], v48 offset:17408
    v_cvt_pk_bf16_f32 v137, v60, v61
    v_mfma_f32_16x16x32_bf16 v[208:211], v[104:107], v[128:131], v[208:211]
    s_waitcnt lgkmcnt(6)
    v_exp_f32 v58, v84
    v_mfma_f32_16x16x32_bf16 v[212:215], v[104:107], v[132:135], v[212:215]
    ds_read_b128 v[104:107], v48 offset:18432
    v_mfma_f32_16x16x32_bf16 v[216:219], v[108:111], v[128:131], v[216:219]
    s_waitcnt lgkmcnt(6)
    v_exp_f32 v59, v85
    v_mfma_f32_16x16x32_bf16 v[220:223], v[108:111], v[132:135], v[220:223]
    s_cmp_gt_i32 s64, 0
    ds_read_b128 v[108:111], v48 offset:19456
    v_cvt_pk_bf16_f32 v140, v58, v59
    v_mfma_f32_16x16x32_bf16 v[224:227], v[112:115], v[128:131], v[224:227]
    s_waitcnt lgkmcnt(6)
    v_exp_f32 v60, v86
    v_mfma_f32_16x16x32_bf16 v[228:231], v[112:115], v[132:135], v[228:231]
    ds_read_b128 v[112:115], v48 offset:20480
    v_or3_b32 v62, v136, v137, v140
    v_mfma_f32_16x16x32_bf16 v[232:235], v[116:119], v[128:131], v[232:235]
    s_waitcnt lgkmcnt(6)
    v_exp_f32 v61, v87
    v_mfma_f32_16x16x32_bf16 v[236:239], v[116:119], v[132:135], v[236:239]
    s_cselect_b32 s65, 0, 1
    ds_read_b128 v[116:119], v48 offset:21504
    v_cvt_pk_bf16_f32 v141, v60, v61
    v_mfma_f32_16x16x32_bf16 v[240:243], v[120:123], v[128:131], v[240:243]
    s_waitcnt lgkmcnt(6)
    v_exp_f32 v58, v88
    v_mfma_f32_16x16x32_bf16 v[244:247], v[120:123], v[132:135], v[244:247]
    ds_read_b128 v[120:123], v48 offset:22528
    v_mfma_f32_16x16x32_bf16 v[248:251], v[124:127], v[128:131], v[248:251]
    s_waitcnt lgkmcnt(6)
    v_exp_f32 v59, v89
    v_mfma_f32_16x16x32_bf16 v[252:255], v[124:127], v[132:135], v[252:255]
    ds_read_b128 v[124:127], v48 offset:23552
    v_cvt_pk_bf16_f32 v138, v58, v59
    v_mfma_f32_16x16x32_bf16 v[64:67], v[96:99], v[16:19], v[144:147]
    s_waitcnt lgkmcnt(6)
    v_exp_f32 v60, v90
    v_mfma_f32_16x16x32_bf16 v[68:71], v[96:99], v[32:35], v[148:151]
    ds_read_b128 v[96:99], v48 offset:57344
    v_or3_b32 v62, v62, v141, v138
    v_mfma_f32_16x16x32_bf16 v[64:67], v[100:103], v[20:23], v[64:67]
    v_exp_f32 v61, v91
    v_mfma_f32_16x16x32_bf16 v[68:71], v[100:103], v[36:39], v[68:71]
    ds_read_b128 v[100:103], v48 offset:58368
    v_cvt_pk_bf16_f32 v139, v60, v61
    v_mfma_f32_16x16x32_bf16 v[160:163], v[168:171], v[128:131], v[160:163]
    s_waitcnt lgkmcnt(7)
    v_exp_f32 v58, v92
    v_mfma_f32_16x16x32_bf16 v[164:167], v[168:171], v[132:135], v[164:167]
    v_mfma_f32_16x16x32_bf16 v[64:67], v[104:107], v[24:27], v[64:67]
    s_waitcnt lgkmcnt(6)
    v_exp_f32 v59, v93
    v_mfma_f32_16x16x32_bf16 v[68:71], v[104:107], v[40:43], v[68:71]
    ds_read_b128 v[104:107], v48 offset:59392
    v_cvt_pk_bf16_f32 v142, v58, v59
    v_mfma_f32_16x16x32_bf16 v[64:67], v[108:111], v[28:31], v[64:67]
    s_waitcnt lgkmcnt(6)
    v_exp_f32 v60, v94
    v_mfma_f32_16x16x32_bf16 v[68:71], v[108:111], v[44:47], v[68:71]
    ds_read_b128 v[108:111], v48 offset:60416
    v_or3_b32 v62, v62, v139, v142
    v_mfma_f32_16x16x32_bf16 v[72:75], v[112:115], v[16:19], v[152:155]
    s_waitcnt lgkmcnt(6)
    v_exp_f32 v61, v95
    v_mfma_f32_16x16x32_bf16 v[76:79], v[112:115], v[32:35], v[156:159]
    ds_read_b128 v[112:115], v48 offset:61440
    v_cvt_pk_bf16_f32 v143, v60, v61
    v_mfma_f32_16x16x32_bf16 v[72:75], v[116:119], v[20:23], v[72:75]
    s_waitcnt lgkmcnt(6)
    v_bitop3_b32 v62, v62, v143, s72 bitop3:0xa8
    v_cmp_ne_u32 vcc, s65, v62
    v_mfma_f32_16x16x32_bf16 v[76:79], v[116:119], v[36:39], v[76:79]
    ds_read_b128 v[116:119], v48 offset:62464
    v_mfma_f32_16x16x32_bf16 v[72:75], v[120:123], v[24:27], v[72:75]
    s_waitcnt lgkmcnt(6)
    v_exp_f32 v58, v64
    v_mfma_f32_16x16x32_bf16 v[76:79], v[120:123], v[40:43], v[76:79]
    ds_read_b128 v[120:123], v48 offset:63488
    v_mfma_f32_16x16x32_bf16 v[72:75], v[124:127], v[28:31], v[72:75]
    s_waitcnt lgkmcnt(6)
    v_exp_f32 v59, v65
    v_mfma_f32_16x16x32_bf16 v[76:79], v[124:127], v[44:47], v[76:79]
    ds_read_b128 v[124:127], v48 offset:64512
    s_cbranch_vccnz L_back_12_h
L_back_12:
    v_mfma_f32_16x16x32_bf16 v[192:195], v[96:99], v[136:139], v[192:195]
    s_waitcnt lgkmcnt(6)
    v_exp_f32 v60, v66
    v_mfma_f32_16x16x32_bf16 v[196:199], v[96:99], v[140:143], v[196:199]
    ds_read_b128 v[96:99], v48 offset:24576
    v_cvt_pk_bf16_f32 v128, v58, v59
    v_mfma_f32_16x16x32_bf16 v[200:203], v[100:103], v[136:139], v[200:203]
    s_waitcnt lgkmcnt(6)
    v_exp_f32 v61, v67
    v_mfma_f32_16x16x32_bf16 v[204:207], v[100:103], v[140:143], v[204:207]
    s_sub_i32 s64, s64, 1
    ds_read_b128 v[100:103], v48 offset:25600
    v_cvt_pk_bf16_f32 v129, v60, v61
    v_mfma_f32_16x16x32_bf16 v[208:211], v[104:107], v[136:139], v[208:211]
    s_waitcnt lgkmcnt(6)
    v_exp_f32 v58, v68
    v_mfma_f32_16x16x32_bf16 v[212:215], v[104:107], v[140:143], v[212:215]
    ds_read_b128 v[104:107], v48 offset:26624
    v_mfma_f32_16x16x32_bf16 v[216:219], v[108:111], v[136:139], v[216:219]
    s_waitcnt lgkmcnt(6)
    v_exp_f32 v59, v69
    v_mfma_f32_16x16x32_bf16 v[220:223], v[108:111], v[140:143], v[220:223]
    s_cmp_gt_i32 s64, 0
    ds_read_b128 v[108:111], v48 offset:27648
    v_cvt_pk_bf16_f32 v132, v58, v59
    v_mfma_f32_16x16x32_bf16 v[224:227], v[112:115], v[136:139], v[224:227]
    s_waitcnt lgkmcnt(6)
    v_exp_f32 v60, v70
    v_mfma_f32_16x16x32_bf16 v[228:231], v[112:115], v[140:143], v[228:231]
    ds_read_b128 v[112:115], v48 offset:28672
    v_or3_b32 v62, v128, v129, v132
    v_mfma_f32_16x16x32_bf16 v[232:235], v[116:119], v[136:139], v[232:235]
    s_waitcnt lgkmcnt(6)
    v_exp_f32 v61, v71
    v_mfma_f32_16x16x32_bf16 v[236:239], v[116:119], v[140:143], v[236:239]
    s_cselect_b32 s65, 0, 1
    ds_read_b128 v[116:119], v48 offset:29696
    v_cvt_pk_bf16_f32 v133, v60, v61
    v_mfma_f32_16x16x32_bf16 v[240:243], v[120:123], v[136:139], v[240:243]
    s_waitcnt lgkmcnt(6)
    v_exp_f32 v58, v72
    v_mfma_f32_16x16x32_bf16 v[244:247], v[120:123], v[140:143], v[244:247]
    ds_read_b128 v[120:123], v48 offset:30720
    v_mfma_f32_16x16x32_bf16 v[248:251], v[124:127], v[136:139], v[248:251]
    s_waitcnt lgkmcnt(6)
    v_exp_f32 v59, v73
    v_mfma_f32_16x16x32_bf16 v[252:255], v[124:127], v[140:143], v[252:255]
    ds_read_b128 v[124:127], v48 offset:31744
    v_cvt_pk_bf16_f32 v130, v58, v59
    v_mfma_f32_16x16x32_bf16 v[80:83], v[96:99], v[16:19], v[144:147]
    s_waitcnt lgkmcnt(6)
    v_exp_f32 v60, v74
    v_mfma_f32_16x16x32_bf16 v[84:87], v[96:99], v[32:35], v[148:151]
    v_or3_b32 v62, v62, v133, v130
    v_xor_b32 v48, 0x10000, v48
    v_mfma_f32_16x16x32_bf16 v[80:83], v[100:103], v[20:23], v[80:83]
    v_exp_f32 v61, v75
    v_mfma_f32_16x16x32_bf16 v[84:87], v[100:103], v[36:39], v[84:87]
    s_cmp_lg_u32 s89, 0
    v_cvt_pk_bf16_f32 v131, v60, v61
    v_mfma_f32_16x16x32_bf16 v[160:163], v[168:171], v[136:139], v[160:163]
    s_waitcnt lgkmcnt(0)
    v_exp_f32 v58, v76
    v_mfma_f32_16x16x32_bf16 v[164:167], v[168:171], v[140:143], v[164:167]
    s_cbranch_scc1 L_ldback_13_c
    s_barrier
L_ldback_13:
    s_add_i32 s62, s62, 1
    ds_read_b128 v[96:99], v48 offset:32768
    ds_read_b128 v[100:103], v48 offset:33792
    v_mfma_f32_16x16x32_bf16 v[80:83], v[104:107], v[24:27], v[80:83]
    v_exp_f32 v59, v77
    v_mfma_f32_16x16x32_bf16 v[84:87], v[104:107], v[40:43], v[84:87]
    ds_read_b128 v[104:107], v48 offset:34816
    v_cvt_pk_bf16_f32 v134, v58, v59
    v_mfma_f32_16x16x32_bf16 v[80:83], v[108:111], v[28:31], v[80:83]
    v_exp_f32 v60, v78
    v_mfma_f32_16x16x32_bf16 v[84:87], v[108:111], v[44:47], v[84:87]
    ds_read_b128 v[108:111], v48 offset:35840
    v_or3_b32 v62, v62, v131, v134
    v_mfma_f32_16x16x32_bf16 v[88:91], v[112:115], v[16:19], v[152:155]
    v_exp_f32 v61, v79
    v_mfma_f32_16x16x32_bf16 v[92:95], v[112:115], v[32:35], v[156:159]
    ds_read_b128 v[112:115], v48 offset:36864
    v_cvt_pk_bf16_f32 v135, v60, v61
    v_mfma_f32_16x16x32_bf16 v[88:91], v[116:119], v[20:23], v[88:91]
    v_bitop3_b32 v62, v62, v135, s72 bitop3:0xa8
    v_cmp_ne_u32 vcc, s65, v62
    v_mfma_f32_16x16x32_bf16 v[92:95], v[116:119], v[36:39], v[92:95]
    ds_read_b128 v[116:119], v48 offset:37888
    v_mfma_f32_16x16x32_bf16 v[88:91], v[120:123], v[24:27], v[88:91]
    v_exp_f32 v58, v80
    v_mfma_f32_16x16x32_bf16 v[92:95], v[120:123], v[40:43], v[92:95]
    ds_read_b128 v[120:123], v48 offset:38912
    v_mfma_f32_16x16x32_bf16 v[88:91], v[124:127], v[28:31], v[88:91]
    s_waitcnt lgkmcnt(6)
    v_exp_f32 v59, v81
    v_mfma_f32_16x16x32_bf16 v[92:95], v[124:127], v[44:47], v[92:95]
    ds_read_b128 v[124:127], v48 offset:39936
    s_cbranch_vccz L_st0
    s_branch L_back_14_h
L_tail0:
    s_mov_b32 s65, 0
    v_mfma_f32_16x16x32_bf16 v[192:195], v[96:99], v[128:131], v[192:195]
    s_waitcnt lgkmcnt(6)
    v_exp_f32 v60, v82
    v_exp_f32 v61, v83
    v_mfma_f32_16x16x32_bf16 v[196:199], v[96:99], v[132:135], v[196:199]
    ds_read_b128 v[96:99], v48 offset:40960
    v_cvt_pk_bf16_f32 v136, v58, v59
    v_cvt_pk_bf16_f32 v137, v60, v61
    v_mfma_f32_16x16x32_bf16 v[200:203], v[100:103], v[128:131], v[200:203]
    v_exp_f32 v58, v84
    v_exp_f32 v59, v85
    v_mfma_f32_16x16x32_bf16 v[204:207], v[100:103], v[132:135], v[204:207]
    ds_read_b128 v[100:103], v48 offset:41984
    v_cvt_pk_bf16_f32 v140, v58, v59
    v_mfma_f32_16x16x32_bf16 v[160:163], v[168:171], v[128:131], v[160:163]
    s_waitcnt lgkmcnt(7)
    v_exp_f32 v60, v86
    v_exp_f32 v61, v87
    v_mfma_f32_16x16x32_bf16 v[164:167], v[168:171], v[132:135], v[164:167]
    v_cvt_pk_bf16_f32 v141, v60, v61
    v_mfma_f32_16x16x32_bf16 v[208:211], v[104:107], v[128:131], v[208:211]
    s_waitcnt lgkmcnt(6)
    v_exp_f32 v58, v88
    v_exp_f32 v59, v89
    v_mfma_f32_16x16x32_bf16 v[212:215], v[104:107], v[132:135], v[212:215]
    ds_read_b128 v[104:107], v48 offset:43008
    v_cvt_pk_bf16_f32 v138, v58, v59
    v_mfma_f32_16x16x32_bf16 v[216:219], v[108:111], v[128:131], v[216:219]
    s_waitcnt lgkmcnt(6)
    v_exp_f32 v60, v90
    v_exp_f32 v61, v91
    v_mfma_f32_16x16x32_bf16 v[220:223], v[108:111], v[132:135], v[220:223]
    ds_read_b128 v[108:111], v48 offset:44032
    v_cvt_pk_bf16_f32 v139, v60, v61
    v_mfma_f32_16x16x32_bf16 v[224:227], v[112:115], v[128:131], v[224:227]
    s_waitcnt lgkmcnt(6)
    v_exp_f32 v58, v92
    v_exp_f32 v59, v93
    v_mfma_f32_16x16x32_bf16 v[228:231], v[112:115], v[132:135], v[228:231]
    ds_read_b128 v[112:115], v48 offset:45056
    v_cvt_pk_bf16_f32 v142, v58, v59
    v_mfma_f32_16x16x32_bf16 v[232:235], v[116:119], v[128:131], v[232:235]
    s_waitcnt lgkmcnt(6)
    v_exp_f32 v60, v94
    v_exp_f32 v61, v95
    v_mfma_f32_16x16x32_bf16 v[236:239], v[116:119], v[132:135], v[236:239]
    ds_read_b128 v[116:119], v48 offset:46080
    v_cvt_pk_bf16_f32 v143, v60, v61
    v_mfma_f32_16x16x32_bf16 v[240:243], v[120:123], v[128:131], v[240:243]
    s_waitcnt lgkmcnt(6)
    v_or3_b32 v62, v136, v137, v140
    v_or3_b32 v62, v62, v141, v138
    v_or3_b32 v62, v62, v139, v142
    v_bitop3_b32 v62, v62, v143, s72 bitop3:0xa8
    v_cmp_ne_u32 vcc, s65, v62
    v_mfma_f32_16x16x32_bf16 v[244:247], v[120:123], v[132:135], v[244:247]
    ds_read_b128 v[120:123], v48 offset:47104
    v_mfma_f32_16x16x32_bf16 v[248:251], v[124:127], v[128:131], v[248:251]
    s_waitcnt lgkmcnt(6)
    v_mfma_f32_16x16x32_bf16 v[252:255], v[124:127], v[132:135], v[252:255]
    ds_read_b128 v[124:127], v48 offset:48128
    s_cbranch_vccnz L_back_15_h
L_back_15:
L_pv1:
    v_mfma_f32_16x16x32_bf16 v[192:195], v[96:99], v[136:139], v[192:195]
    s_waitcnt lgkmcnt(6)
    v_mfma_f32_16x16x32_bf16 v[196:199], v[96:99], v[140:143], v[196:199]
    v_mfma_f32_16x16x32_bf16 v[200:203], v[100:103], v[136:139], v[200:203]
    v_mfma_f32_16x16x32_bf16 v[204:207], v[100:103], v[140:143], v[204:207]
    v_mfma_f32_16x16x32_bf16 v[160:163], v[168:171], v[136:139], v[160:163]
    s_waitcnt lgkmcnt(5)
    v_mfma_f32_16x16x32_bf16 v[164:167], v[168:171], v[140:143], v[164:167]
    v_mfma_f32_16x16x32_bf16 v[208:211], v[104:107], v[136:139], v[208:211]
    s_waitcnt lgkmcnt(4)
    v_mfma_f32_16x16x32_bf16 v[212:215], v[104:107], v[140:143], v[212:215]
    v_mfma_f32_16x16x32_bf16 v[216:219], v[108:111], v[136:139], v[216:219]
    s_waitcnt lgkmcnt(3)
    v_mfma_f32_16x16x32_bf16 v[220:223], v[108:111], v[140:143], v[220:223]
    v_mfma_f32_16x16x32_bf16 v[224:227], v[112:115], v[136:139], v[224:227]
    s_waitcnt lgkmcnt(2)
    v_mfma_f32_16x16x32_bf16 v[228:231], v[112:115], v[140:143], v[228:231]
    v_mfma_f32_16x16x32_bf16 v[232:235], v[116:119], v[136:139], v[232:235]
    s_waitcnt lgkmcnt(1)
    v_mfma_f32_16x16x32_bf16 v[236:239], v[116:119], v[140:143], v[236:239]
    v_mfma_f32_16x16x32_bf16 v[240:243], v[120:123], v[136:139], v[240:243]
    s_waitcnt lgkmcnt(0)
    v_mfma_f32_16x16x32_bf16 v[244:247], v[120:123], v[140:143], v[244:247]
    v_mfma_f32_16x16x32_bf16 v[248:251], v[124:127], v[136:139], v[248:251]
    v_mfma_f32_16x16x32_bf16 v[252:255], v[124:127], v[140:143], v[252:255]
    s_branch L_fin
L_tail1:
    s_mov_b32 s65, 0
    v_mfma_f32_16x16x32_bf16 v[192:195], v[96:99], v[136:139], v[192:195]
    s_waitcnt lgkmcnt(6)
    v_exp_f32 v60, v66
    v_exp_f32 v61, v67
    v_mfma_f32_16x16x32_bf16 v[196:199], v[96:99], v[140:143], v[196:199]
    ds_read_b128 v[96:99], v48 offset:49152
    v_cvt_pk_bf16_f32 v128, v58, v59
    v_cvt_pk_bf16_f32 v129, v60, v61
    v_mfma_f32_16x16x32_bf16 v[200:203], v[100:103], v[136:139], v[200:203]
    v_exp_f32 v58, v68
    v_exp_f32 v59, v69
    v_mfma_f32_16x16x32_bf16 v[204:207], v[100:103], v[140:143], v[204:207]
    ds_read_b128 v[100:103], v48 offset:50176
    v_cvt_pk_bf16_f32 v132, v58, v59
    v_mfma_f32_16x16x32_bf16 v[160:163], v[168:171], v[136:139], v[160:163]
    s_waitcnt lgkmcnt(7)
    v_exp_f32 v60, v70
    v_exp_f32 v61, v71
    v_mfma_f32_16x16x32_bf16 v[164:167], v[168:171], v[140:143], v[164:167]
    v_cvt_pk_bf16_f32 v133, v60, v61
    v_mfma_f32_16x16x32_bf16 v[208:211], v[104:107], v[136:139], v[208:211]
    s_waitcnt lgkmcnt(6)
    v_exp_f32 v58, v72
    v_exp_f32 v59, v73
    v_mfma_f32_16x16x32_bf16 v[212:215], v[104:107], v[140:143], v[212:215]
    ds_read_b128 v[104:107], v48 offset:51200
    v_cvt_pk_bf16_f32 v130, v58, v59
    v_mfma_f32_16x16x32_bf16 v[216:219], v[108:111], v[136:139], v[216:219]
    s_waitcnt lgkmcnt(6)
    v_exp_f32 v60, v74
    v_exp_f32 v61, v75
    v_mfma_f32_16x16x32_bf16 v[220:223], v[108:111], v[140:143], v[220:223]
    ds_read_b128 v[108:111], v48 offset:52224
    v_cvt_pk_bf16_f32 v131, v60, v61
    v_mfma_f32_16x16x32_bf16 v[224:227], v[112:115], v[136:139], v[224:227]
    s_waitcnt lgkmcnt(6)
    v_exp_f32 v58, v76
    v_exp_f32 v59, v77
    v_mfma_f32_16x16x32_bf16 v[228:231], v[112:115], v[140:143], v[228:231]
    ds_read_b128 v[112:115], v48 offset:53248
    v_cvt_pk_bf16_f32 v134, v58, v59
    v_mfma_f32_16x16x32_bf16 v[232:235], v[116:119], v[136:139], v[232:235]
    s_waitcnt lgkmcnt(6)
    v_exp_f32 v60, v78
    v_exp_f32 v61, v79
    v_mfma_f32_16x16x32_bf16 v[236:239], v[116:119], v[140:143], v[236:239]
    ds_read_b128 v[116:119], v48 offset:54272
    v_cvt_pk_bf16_f32 v135, v60, v61
    v_mfma_f32_16x16x32_bf16 v[240:243], v[120:123], v[136:139], v[240:243]
    s_waitcnt lgkmcnt(6)
    v_or3_b32 v62, v128, v129, v132
    v_or3_b32 v62, v62, v133, v130
    v_or3_b32 v62, v62, v131, v134
    v_bitop3_b32 v62, v62, v135, s72 bitop3:0xa8
    v_cmp_ne_u32 vcc, s65, v62
    v_mfma_f32_16x16x32_bf16 v[244:247], v[120:123], v[140:143], v[244:247]
    ds_read_b128 v[120:123], v48 offset:55296
    v_mfma_f32_16x16x32_bf16 v[248:251], v[124:127], v[136:139], v[248:251]
    s_waitcnt lgkmcnt(6)
    v_mfma_f32_16x16x32_bf16 v[252:255], v[124:127], v[140:143], v[252:255]
    ds_read_b128 v[124:127], v48 offset:56320
    s_cbranch_vccnz L_back_16_h
L_back_16:
L_pv2:
    v_mfma_f32_16x16x32_bf16 v[192:195], v[96:99], v[128:131], v[192:195]
    s_waitcnt lgkmcnt(6)
    v_mfma_f32_16x16x32_bf16 v[196:199], v[96:99], v[132:135], v[196:199]
    v_mfma_f32_16x16x32_bf16 v[200:203], v[100:103], v[128:131], v[200:203]
    v_mfma_f32_16x16x32_bf16 v[204:207], v[100:103], v[132:135], v[204:207]
    v_mfma_f32_16x16x32_bf16 v[160:163], v[168:171], v[128:131], v[160:163]
    s_waitcnt lgkmcnt(5)
    v_mfma_f32_16x16x32_bf16 v[164:167], v[168:171], v[132:135], v[164:167]
    v_mfma_f32_16x16x32_bf16 v[208:211], v[104:107], v[128:131], v[208:211]
    s_waitcnt lgkmcnt(4)
    v_mfma_f32_16x16x32_bf16 v[212:215], v[104:107], v[132:135], v[212:215]
    v_mfma_f32_16x16x32_bf16 v[216:219], v[108:111], v[128:131], v[216:219]
    s_waitcnt lgkmcnt(3)
    v_mfma_f32_16x16x32_bf16 v[220:223], v[108:111], v[132:135], v[220:223]
    v_mfma_f32_16x16x32_bf16 v[224:227], v[112:115], v[128:131], v[224:227]
    s_waitcnt lgkmcnt(2)
    v_mfma_f32_16x16x32_bf16 v[228:231], v[112:115], v[132:135], v[228:231]
    v_mfma_f32_16x16x32_bf16 v[232:235], v[116:119], v[128:131], v[232:235]
    s_waitcnt lgkmcnt(1)
    v_mfma_f32_16x16x32_bf16 v[236:239], v[116:119], v[132:135], v[236:239]
    v_mfma_f32_16x16x32_bf16 v[240:243], v[120:123], v[128:131], v[240:243]
    s_waitcnt lgkmcnt(0)
    v_mfma_f32_16x16x32_bf16 v[244:247], v[120:123], v[132:135], v[244:247]
    v_mfma_f32_16x16x32_bf16 v[248:251], v[124:127], v[128:131], v[248:251]
    v_mfma_f32_16x16x32_bf16 v[252:255], v[124:127], v[132:135], v[252:255]
    s_branch L_fin
L_tail2:
    s_mov_b32 s65, 0
    v_mfma_f32_16x16x32_bf16 v[192:195], v[96:99], v[128:131], v[192:195]
    s_waitcnt lgkmcnt(6)
    v_exp_f32 v60, v82
    v_exp_f32 v61, v83
    v_mfma_f32_16x16x32_bf16 v[196:199], v[96:99], v[132:135], v[196:199]
    ds_read_b128 v[96:99], v48 offset:57344
    v_cvt_pk_bf16_f32 v136, v58, v59
    v_cvt_pk_bf16_f32 v137, v60, v61
    v_mfma_f32_16x16x32_bf16 v[200:203], v[100:103], v[128:131], v[200:203]
    v_exp_f32 v58, v84
    v_exp_f32 v59, v85
    v_mfma_f32_16x16x32_bf16 v[204:207], v[100:103], v[132:135], v[204:207]
    ds_read_b128 v[100:103], v48 offset:58368
    v_cvt_pk_bf16_f32 v140, v58, v59
    v_mfma_f32_16x16x32_bf16 v[160:163], v[168:171], v[128:131], v[160:163]
    s_waitcnt lgkmcnt(7)
    v_exp_f32 v60, v86
    v_exp_f32 v61, v87
    v_mfma_f32_16x16x32_bf16 v[164:167], v[168:171], v[132:135], v[164:167]
    v_cvt_pk_bf16_f32 v141, v60, v61
    v_mfma_f32_16x16x32_bf16 v[208:211], v[104:107], v[128:131], v[208:211]
    s_waitcnt lgkmcnt(6)
    v_exp_f32 v58, v88
    v_exp_f32 v59, v89
    v_mfma_f32_16x16x32_bf16 v[212:215], v[104:107], v[132:135], v[212:215]
    ds_read_b128 v[104:107], v48 offset:59392
    v_cvt_pk_bf16_f32 v138, v58, v59
    v_mfma_f32_16x16x32_bf16 v[216:219], v[108:111], v[128:131], v[216:219]
    s_waitcnt lgkmcnt(6)
    v_exp_f32 v60, v90
    v_exp_f32 v61, v91
    v_mfma_f32_16x16x32_bf16 v[220:223], v[108:111], v[132:135], v[220:223]
    ds_read_b128 v[108:111], v48 offset:60416
    v_cvt_pk_bf16_f32 v139, v60, v61
    v_mfma_f32_16x16x32_bf16 v[224:227], v[112:115], v[128:131], v[224:227]
    s_waitcnt lgkmcnt(6)
    v_exp_f32 v58, v92
    v_exp_f32 v59, v93
    v_mfma_f32_16x16x32_bf16 v[228:231], v[112:115], v[132:135], v[228:231]
    ds_read_b128 v[112:115], v48 offset:61440
    v_cvt_pk_bf16_f32 v142, v58, v59
    v_mfma_f32_16x16x32_bf16 v[232:235], v[116:119], v[128:131], v[232:235]
    s_waitcnt lgkmcnt(6)
    v_exp_f32 v60, v94
    v_exp_f32 v61, v95
    v_mfma_f32_16x16x32_bf16 v[236:239], v[116:119], v[132:135], v[236:239]
    ds_read_b128 v[116:119], v48 offset:62464
    v_cvt_pk_bf16_f32 v143, v60, v61
    v_mfma_f32_16x16x32_bf16 v[240:243], v[120:123], v[128:131], v[240:243]
    s_waitcnt lgkmcnt(6)
    v_or3_b32 v62, v136, v137, v140
    v_or3_b32 v62, v62, v141, v138
    v_or3_b32 v62, v62, v139, v142
    v_bitop3_b32 v62, v62, v143, s72 bitop3:0xa8
    v_cmp_ne_u32 vcc, s65, v62
    v_mfma_f32_16x16x32_bf16 v[244:247], v[120:123], v[132:135], v[244:247]
    ds_read_b128 v[120:123], v48 offset:63488
    v_mfma_f32_16x16x32_bf16 v[248:251], v[124:127], v[128:131], v[248:251]
    s_waitcnt lgkmcnt(6)
    v_mfma_f32_16x16x32_bf16 v[252:255], v[124:127], v[132:135], v[252:255]
    ds_read_b128 v[124:127], v48 offset:64512
    s_cbranch_vccnz L_back_17_h
L_back_17:
L_pv3:
    v_mfma_f32_16x16x32_bf16 v[192:195], v[96:99], v[136:139], v[192:195]
    s_waitcnt lgkmcnt(6)
    v_mfma_f32_16x16x32_bf16 v[196:199], v[96:99], v[140:143], v[196:199]
    v_xor_b32 v48, 0x10000, v48
    v_mfma_f32_16x16x32_bf16 v[200:203], v[100:103], v[136:139], v[200:203]
    v_mfma_f32_16x16x32_bf16 v[204:207], v[100:103], v[140:143], v[204:207]
    v_mfma_f32_16x16x32_bf16 v[160:163], v[168:171], v[136:139], v[160:163]
    s_waitcnt lgkmcnt(5)
    v_mfma_f32_16x16x32_bf16 v[164:167], v[168:171], v[140:143], v[164:167]
    s_waitcnt vmcnt(0) lgkmcnt(0)
    s_call_b64 s[82:83], L_pend
    s_barrier
    s_call_b64 s[82:83], L_load
    s_add_i32 s62, s62, 1
    v_mfma_f32_16x16x32_bf16 v[208:211], v[104:107], v[136:139], v[208:211]
    v_mfma_f32_16x16x32_bf16 v[212:215], v[104:107], v[140:143], v[212:215]
    v_mfma_f32_16x16x32_bf16 v[216:219], v[108:111], v[136:139], v[216:219]
    v_mfma_f32_16x16x32_bf16 v[220:223], v[108:111], v[140:143], v[220:223]
    v_mfma_f32_16x16x32_bf16 v[224:227], v[112:115], v[136:139], v[224:227]
    v_mfma_f32_16x16x32_bf16 v[228:231], v[112:115], v[140:143], v[228:231]
    v_mfma_f32_16x16x32_bf16 v[232:235], v[116:119], v[136:139], v[232:235]
    v_mfma_f32_16x16x32_bf16 v[236:239], v[116:119], v[140:143], v[236:239]
    v_mfma_f32_16x16x32_bf16 v[240:243], v[120:123], v[136:139], v[240:243]
    v_mfma_f32_16x16x32_bf16 v[244:247], v[120:123], v[140:143], v[244:247]
    v_mfma_f32_16x16x32_bf16 v[248:251], v[124:127], v[136:139], v[248:251]
    v_mfma_f32_16x16x32_bf16 v[252:255], v[124:127], v[140:143], v[252:255]
    s_branch L_fin
L_tail3:
    s_mov_b32 s65, 0
    v_mfma_f32_16x16x32_bf16 v[192:195], v[96:99], v[136:139], v[192:195]
    s_waitcnt lgkmcnt(6)
    v_exp_f32 v60, v66
    v_exp_f32 v61, v67
    v_mfma_f32_16x16x32_bf16 v[196:199], v[96:99], v[140:143], v[196:199]
    v_cvt_pk_bf16_f32 v128, v58, v59
    v_cvt_pk_bf16_f32 v129, v60, v61
    v_xor_b32 v48, 0x10000, v48
    v_mfma_f32_16x16x32_bf16 v[200:203], v[100:103], v[136:139], v[200:203]
    v_exp_f32 v58, v68
    v_exp_f32 v59, v69
    v_mfma_f32_16x16x32_bf16 v[204:207], v[100:103], v[140:143], v[204:207]
    v_cvt_pk_bf16_f32 v132, v58, v59
    v_mfma_f32_16x16x32_bf16 v[160:163], v[168:171], v[136:139], v[160:163]
    s_waitcnt lgkmcnt(5)
    v_exp_f32 v60, v70
    v_exp_f32 v61, v71
    v_mfma_f32_16x16x32_bf16 v[164:167], v[168:171], v[140:143], v[164:167]
    s_waitcnt vmcnt(0) lgkmcnt(0)
    s_call_b64 s[82:83], L_pend
    s_barrier
    s_call_b64 s[82:83], L_load
    s_add_i32 s62, s62, 1
    ds_read_b128 v[96:99], v48 offset:32768
    ds_read_b128 v[100:103], v48 offset:33792
    v_cvt_pk_bf16_f32 v133, v60, v61
    v_mfma_f32_16x16x32_bf16 v[208:211], v[104:107], v[136:139], v[208:211]
    v_exp_f32 v58, v72
    v_exp_f32 v59, v73
    v_mfma_f32_16x16x32_bf16 v[212:215], v[104:107], v[140:143], v[212:215]
    ds_read_b128 v[104:107], v48 offset:34816
    v_cvt_pk_bf16_f32 v130, v58, v59
    v_mfma_f32_16x16x32_bf16 v[216:219], v[108:111], v[136:139], v[216:219]
    v_exp_f32 v60, v74
    v_exp_f32 v61, v75
    v_mfma_f32_16x16x32_bf16 v[220:223], v[108:111], v[140:143], v[220:223]
    ds_read_b128 v[108:111], v48 offset:35840
    v_cvt_pk_bf16_f32 v131, v60, v61
    v_mfma_f32_16x16x32_bf16 v[224:227], v[112:115], v[136:139], v[224:227]
    v_exp_f32 v58, v76
    v_exp_f32 v59, v77
    v_mfma_f32_16x16x32_bf16 v[228:231], v[112:115], v[140:143], v[228:231]
    ds_read_b128 v[112:115], v48 offset:36864
    v_cvt_pk_bf16_f32 v134, v58, v59
    v_mfma_f32_16x16x32_bf16 v[232:235], v[116:119], v[136:139], v[232:235]
    v_exp_f32 v60, v78
    v_exp_f32 v61, v79
    v_mfma_f32_16x16x32_bf16 v[236:239], v[116:119], v[140:143], v[236:239]
    ds_read_b128 v[116:119], v48 offset:37888
    v_cvt_pk_bf16_f32 v135, v60, v61
    v_mfma_f32_16x16x32_bf16 v[240:243], v[120:123], v[136:139], v[240:243]
    v_or3_b32 v62, v128, v129, v132
    v_or3_b32 v62, v62, v133, v130
    v_or3_b32 v62, v62, v131, v134
    v_bitop3_b32 v62, v62, v135, s72 bitop3:0xa8
    v_cmp_ne_u32 vcc, s65, v62
    v_mfma_f32_16x16x32_bf16 v[244:247], v[120:123], v[140:143], v[244:247]
    ds_read_b128 v[120:123], v48 offset:38912
    v_mfma_f32_16x16x32_bf16 v[248:251], v[124:127], v[136:139], v[248:251]
    s_waitcnt lgkmcnt(6)
    v_mfma_f32_16x16x32_bf16 v[252:255], v[124:127], v[140:143], v[252:255]
    ds_read_b128 v[124:127], v48 offset:39936
    s_cbranch_vccnz L_back_20_h
L_back_20:
L_pv0:
    v_mfma_f32_16x16x32_bf16 v[192:195], v[96:99], v[128:131], v[192:195]
    s_waitcnt lgkmcnt(6)
    v_mfma_f32_16x16x32_bf16 v[196:199], v[96:99], v[132:135], v[196:199]
    v_mfma_f32_16x16x32_bf16 v[200:203], v[100:103], v[128:131], v[200:203]
    v_mfma_f32_16x16x32_bf16 v[204:207], v[100:103], v[132:135], v[204:207]
    v_mfma_f32_16x16x32_bf16 v[160:163], v[168:171], v[128:131], v[160:163]
    s_waitcnt lgkmcnt(5)
    v_mfma_f32_16x16x32_bf16 v[164:167], v[168:171], v[132:135], v[164:167]
    v_mfma_f32_16x16x32_bf16 v[208:211], v[104:107], v[128:131], v[208:211]
    s_waitcnt lgkmcnt(4)
    v_mfma_f32_16x16x32_bf16 v[212:215], v[104:107], v[132:135], v[212:215]
    v_mfma_f32_16x16x32_bf16 v[216:219], v[108:111], v[128:131], v[216:219]
    s_waitcnt lgkmcnt(3)
    v_mfma_f32_16x16x32_bf16 v[220:223], v[108:111], v[132:135], v[220:223]
    v_mfma_f32_16x16x32_bf16 v[224:227], v[112:115], v[128:131], v[224:227]
    s_waitcnt lgkmcnt(2)
    v_mfma_f32_16x16x32_bf16 v[228:231], v[112:115], v[132:135], v[228:231]
    v_mfma_f32_16x16x32_bf16 v[232:235], v[116:119], v[128:131], v[232:235]
    s_waitcnt lgkmcnt(1)
    v_mfma_f32_16x16x32_bf16 v[236:239], v[116:119], v[132:135], v[236:239]
    v_mfma_f32_16x16x32_bf16 v[240:243], v[120:123], v[128:131], v[240:243]
    s_waitcnt lgkmcnt(0)
    v_mfma_f32_16x16x32_bf16 v[244:247], v[120:123], v[132:135], v[244:247]
    v_mfma_f32_16x16x32_bf16 v[248:251], v[124:127], v[128:131], v[248:251]
    v_mfma_f32_16x16x32_bf16 v[252:255], v[124:127], v[132:135], v[252:255]
L_fin:
    v_and_b32 v3, 7, v1
    v_lshlrev_b32 v3, 2, v3
    s_mov_b32 s72, 0x3a0000
    buffer_load_dword v51, v3, s[8:11], s72 offen sc1
    v_rcp_f32 v56, v160
    v_rcp_f32 v57, v164
    s_lshl_b32 s6, s60, 18
    s_lshl_b32 s7, s4, 12
    s_add_u32 s6, s6, s7
    s_add_u32 s6, s6, 50331648
    s_nop 4
    v_mul_f32 v192, v56, v192
    v_mul_f32 v193, v56, v193
    v_mul_f32 v194, v56, v194
    v_mul_f32 v195, v56, v195
    v_cvt_pk_bf16_f32 v16, v192, v193
    v_cvt_pk_bf16_f32 v17, v194, v195
    v_mul_f32 v200, v56, v200
    v_mul_f32 v201, v56, v201
    v_mul_f32 v202, v56, v202
    v_mul_f32 v203, v56, v203
    v_cvt_pk_bf16_f32 v18, v200, v201
    v_cvt_pk_bf16_f32 v19, v202, v203
    buffer_store_dwordx4 v[16:19], v13, s[8:11], s6 offen offset:0 sc1
    v_mul_f32 v208, v56, v208
    v_mul_f32 v209, v56, v209
    v_mul_f32 v210, v56, v210
    v_mul_f32 v211, v56, v211
    v_cvt_pk_bf16_f32 v20, v208, v209
    v_cvt_pk_bf16_f32 v21, v210, v211
    v_mul_f32 v216, v56, v216
    v_mul_f32 v217, v56, v217
    v_mul_f32 v218, v56, v218
    v_mul_f32 v219, v56, v219
    v_cvt_pk_bf16_f32 v22, v216, v217
    v_cvt_pk_bf16_f32 v23, v218, v219
    buffer_store_dwordx4 v[20:23], v13, s[8:11], s6 offen offset:1024 sc1
    v_mul_f32 v224, v56, v224
    v_mul_f32 v225, v56, v225
    v_mul_f32 v226, v56, v226
    v_mul_f32 v227, v56, v227
    v_cvt_pk_bf16_f32 v24, v224, v225
    v_cvt_pk_bf16_f32 v25, v226, v227
    v_mul_f32 v232, v56, v232
    v_mul_f32 v233, v56, v233
    v_mul_f32 v234, v56, v234
    v_mul_f32 v235, v56, v235
    v_cvt_pk_bf16_f32 v26, v232, v233
    v_cvt_pk_bf16_f32 v27, v234, v235
    buffer_store_dwordx4 v[24:27], v13, s[8:11], s6 offen offset:2048 sc1
    v_mul_f32 v240, v56, v240
    v_mul_f32 v241, v56, v241
    v_mul_f32 v242, v56, v242
    v_mul_f32 v243, v56, v243
    v_cvt_pk_bf16_f32 v28, v240, v241
    v_cvt_pk_bf16_f32 v29, v242, v243
    v_mul_f32 v248, v56, v248
    v_mul_f32 v249, v56, v249
    v_mul_f32 v250, v56, v250
    v_mul_f32 v251, v56, v251
    v_cvt_pk_bf16_f32 v30, v248, v249
    v_cvt_pk_bf16_f32 v31, v250, v251
    buffer_store_dwordx4 v[28:31], v13, s[8:11], s6 offen offset:3072 sc1
    s_add_u32 s6, s6, 0x20000
    v_mul_f32 v196, v57, v196
    v_mul_f32 v197, v57, v197
    v_mul_f32 v198, v57, v198
    v_mul_f32 v199, v57, v199
    v_cvt_pk_bf16_f32 v32, v196, v197
    v_cvt_pk_bf16_f32 v33, v198, v199
    v_mul_f32 v204, v57, v204
    v_mul_f32 v205, v57, v205
    v_mul_f32 v206, v57, v206
    v_mul_f32 v207, v57, v207
    v_cvt_pk_bf16_f32 v34, v204, v205
    v_cvt_pk_bf16_f32 v35, v206, v207
    buffer_store_dwordx4 v[32:35], v13, s[8:11], s6 offen offset:0 sc1
    v_mul_f32 v212, v57, v212
    v_mul_f32 v213, v57, v213
    v_mul_f32 v214, v57, v214
    v_mul_f32 v215, v57, v215
    v_cvt_pk_bf16_f32 v36, v212, v213
    v_cvt_pk_bf16_f32 v37, v214, v215
    v_mul_f32 v220, v57, v220
    v_mul_f32 v221, v57, v221
    v_mul_f32 v222, v57, v222
    v_mul_f32 v223, v57, v223
    v_cvt_pk_bf16_f32 v38, v220, v221
    v_cvt_pk_bf16_f32 v39, v222, v223
    buffer_store_dwordx4 v[36:39], v13, s[8:11], s6 offen offset:1024 sc1
    v_mul_f32 v228, v57, v228
    v_mul_f32 v229, v57, v229
    v_mul_f32 v230, v57, v230
    v_mul_f32 v231, v57, v231
    v_cvt_pk_bf16_f32 v40, v228, v229
    v_cvt_pk_bf16_f32 v41, v230, v231
    v_mul_f32 v236, v57, v236
    v_mul_f32 v237, v57, v237
    v_mul_f32 v238, v57, v238
    v_mul_f32 v239, v57, v239
    v_cvt_pk_bf16_f32 v42, v236, v237
    v_cvt_pk_bf16_f32 v43, v238, v239
    buffer_store_dwordx4 v[40:43], v13, s[8:11], s6 offen offset:2048 sc1
    v_mul_f32 v244, v57, v244
    v_mul_f32 v245, v57, v245
    v_mul_f32 v246, v57, v246
    v_mul_f32 v247, v57, v247
    v_cvt_pk_bf16_f32 v44, v244, v245
    v_cvt_pk_bf16_f32 v45, v246, v247
    v_mul_f32 v252, v57, v252
    v_mul_f32 v253, v57, v253
    v_mul_f32 v254, v57, v254
    v_mul_f32 v255, v57, v255
    v_cvt_pk_bf16_f32 v46, v252, v253
    v_cvt_pk_bf16_f32 v47, v254, v255
    buffer_store_dwordx4 v[44:47], v13, s[8:11], s6 offen offset:3072 sc1
    s_cmp_gt_i32 s62, s63
    s_cbranch_scc1 L_pre
    s_waitcnt vmcnt(8)
    s_call_b64 s[82:83], L_pend
    s_barrier
    s_waitcnt vmcnt(0)
    s_lshl_b32 s6, s60, 5
    s_add_u32 s6, s6, s4
    s_lshl_b32 s6, s6, 7
    s_add_u32 s6, s6, 3932160
    v_mov_b32 v2, 1
    v_mov_b32 v3, 0x5000000
    v_writelane_b32 v3, s6, 0
    buffer_store_dword v2, v3, s[8:11], 0 offen sc1
    s_call_b64 s[82:83], L_load
    s_add_i32 s62, s62, 1
    s_lshl_b32 s6, s3, 8
    s_add_u32 s6, s6, s2
    s_cmp_eq_u32 s6, 31
    s_cbranch_scc1 L_top
L_idle:
    s_sub_i32 s6, s63, 5
    s_cmp_gt_i32 s62, s6
    s_cbranch_scc1 L_pre
    s_waitcnt vmcnt(0) lgkmcnt(0)
    s_call_b64 s[82:83], L_pend
    s_barrier
    s_call_b64 s[82:83], L_load
    s_add_i32 s62, s62, 1
    s_cmp_lt_u32 s61, 54
    s_cbranch_scc1 L_moe
    s_branch L_idle
L_pre:
    s_cmp_lt_u32 s3, 4
    s_cbranch_scc1 L_pre1
    s_add_u32 s6, s76, 0
    s_and_b32 s6, s6, 3
    s_lshl_b32 s6, s6, 10
    v_add_u32 v44, s6, v13
    s_add_u32 s6, s76, 1
    s_and_b32 s6, s6, 3
    s_lshl_b32 s6, s6, 10
    v_add_u32 v45, s6, v13
    s_add_u32 s6, s76, 2
    s_and_b32 s6, s6, 3
    s_lshl_b32 s6, s6, 10
    v_add_u32 v46, s6, v13
    s_add_u32 s6, s76, 3
    s_and_b32 s6, s6, 3
    s_lshl_b32 s6, s6, 10
    v_add_u32 v47, s6, v13
    v_add_u32 v52, 4096, v13
    s_lshr_b32 s69, s4, 3
    s_lshl_b32 s69, s69, 2
    s_add_u32 s69, s69, s76
    s_mul_i32 s69, s69, 327680
    s_and_b32 s7, s4, 3
    s_mul_i32 s7, s7, 10240
    s_add_u32 s69, s69, s7
    s_add_u32 s69, s69, 4199424
    s_and_b32 s6, s4, 4
    s_lshr_b32 s7, s4, 3
    s_add_u32 s6, s6, s7
    s_lshl_b32 s7, s5, 3
    s_add_u32 s68, s6, s7
    s_sub_u32 s7, 120, s7
    s_add_u32 s61, s6, s7
    s_waitcnt vmcnt(8)
    v_cmp_le_i32 vcc, 0, v51
    s_cbranch_vccz L_idx_okb
    v_and_b32 v3, 7, v1
    v_lshlrev_b32 v3, 2, v3
    s_mov_b32 s72, 0x3a0000
    s_mov_b32 s79, 262144
L_poll_23:
    buffer_load_dword v51, v3, s[8:11], s72 offen sc1
    s_waitcnt vmcnt(0)
    v_cmp_le_i32 vcc, 0, v51
    s_cbranch_vccz L_polldone_24
    s_sleep 2
    s_sub_u32 s79, s79, 1
    s_cmp_lg_u32 s79, 0
    s_cbranch_scc1 L_poll_23
L_polldone_24:
L_idx_okb:
    s_call_b64 s[80:81], L_oprep
    s_mov_b32 s6, 0x10000
    s_lshl_b32 s7, s76, 12
    s_add_u32 s7, s7, s6
    v_add_u32 v12, s7, v13
    s_lshl_b32 s7, s76, 13
    s_add_u32 s6, s6, s7
    v_add_u32 v3, s6, v13
    s_add_u32 s7, s7, 131072
    v_add_u32 v2, s7, v13
    s_barrier
    s_add_u32 s75, s69, 163840
    buffer_load_dwordx4 v[176:179], v44, s[8:11], s75 offen sc1
    buffer_load_dwordx4 v[180:183], v45, s[8:11], s75 offen sc1
    buffer_load_dwordx4 v[184:187], v46, s[8:11], s75 offen sc1
    buffer_load_dwordx4 v[188:191], v47, s[8:11], s75 offen sc1
    buffer_load_dwordx4 v[192:195], v52, s[8:11], s75 offen sc1
    ds_read_b128 v[96:99], v2 offset:0
    ds_read_b128 v[100:103], v2 offset:1024
    ds_read_b128 v[104:107], v2 offset:2048
    ds_read_b128 v[108:111], v2 offset:3072
    ds_read_b128 v[112:115], v2 offset:4096
    ds_read_b128 v[116:119], v2 offset:5120
    ds_read_b128 v[120:123], v2 offset:6144
    ds_read_b128 v[124:127], v2 offset:7168
    s_waitcnt lgkmcnt(6)
    ds_read_b128 v[128:131], v3 offset:0
    ds_read_b128 v[132:135], v3 offset:1024
    ds_read_b128 v[136:139], v3 offset:2048
    ds_read_b128 v[140:143], v3 offset:3072
    ds_read_b128 v[144:147], v3 offset:4096
    ds_read_b128 v[148:151], v3 offset:5120
    ds_read_b128 v[152:155], v3 offset:6144
    ds_read_b128 v[156:159], v3 offset:7168
    s_waitcnt lgkmcnt(6)
    ds_read_b128 v[160:163], v12 offset:49152
    ds_read_b128 v[164:167], v12 offset:50176
    ds_read_b128 v[168:171], v12 offset:51200
    ds_read_b128 v[172:175], v12 offset:52224
    s_waitcnt vmcnt(5)
    s_lshl_b32 s6, s60, 5
    s_add_u32 s6, s6, s4
    s_lshl_b32 s6, s6, 7
    s_add_u32 s6, s6, 3932160
    v_mov_b32 v2, 1
    v_mov_b32 v3, 0x5000000
    v_writelane_b32 v3, s6, 0
    buffer_store_dword v2, v3, s[8:11], 0 offen sc1
    s_waitcnt lgkmcnt(0)
    s_branch L_adone
L_oprep:
    s_add_u32 s6, s76, 0
    s_and_b32 s6, s6, 3
    s_lshl_b32 s6, s6, 10
    v_add_u32 v44, s6, v13
    s_add_u32 s6, s76, 1
    s_and_b32 s6, s6, 3
    s_lshl_b32 s6, s6, 10
    v_add_u32 v45, s6, v13
    s_add_u32 s6, s76, 2
    s_and_b32 s6, s6, 3
    s_lshl_b32 s6, s6, 10
    v_add_u32 v46, s6, v13
    s_add_u32 s6, s76, 3
    s_and_b32 s6, s6, 3
    s_lshl_b32 s6, s6, 10
    v_add_u32 v47, s6, v13
    v_add_u32 v52, 4096, v13
    s_lshr_b32 s6, s3, 2
    s_lshl_b32 s6, s6, 1
    s_sub_u32 s71, s76, s6
    s_and_b32 s71, s71, 3
    s_lshr_b32 s6, s4, 3
    s_lshl_b32 s6, s6, 15
    s_lshl_b32 s99, s3, 12
    s_add_u32 s66, s6, s99
    s_add_u32 s66, s66, 50331648
    s_lshl_b32 s6, s76, 13
    v_add_u32 v4, s6, v13
    v_add_u32 v7, 65536, v4
    s_lshr_b32 s6, s3, 2
    s_mul_i32 s67, s6, 15360
    s_add_u32 s67, s67, 98304
    v_add_u32 v6, s67, v44
    v_mov_b32 v11, 0x5000000
    s_and_b32 s63, s4, 7
    s_lshl_b32 s7, s5, 3
    s_add_u32 s63, s63, s7
    s_lshl_b32 s63, s63, 2
    s_lshr_b32 s7, s4, 3
    s_add_u32 s63, s63, s7
    s_mul_i32 s62, s63, 61440
    s_add_u32 s62, s62, 67108864
    s_mul_i32 s63, s63, 384
    s_add_u32 s63, s63, 15728640
    s_and_b32 s96, s4, 7
    s_lshl_b32 s7, s5, 3
    s_add_u32 s96, s96, s7
    s_lshr_b32 s7, s4, 3
    s_add_u32 s7, s7, 0
    s_add_u32 s7, s7, 1
    s_and_b32 s7, s7, 3
    s_lshl_b32 s96, s96, 2
    s_add_u32 s96, s96, s7
    s_mul_i32 s96, s96, 3
    s_add_u32 s96, s96, 0
    s_lshl_b32 s6, s96, 5
    s_add_u32 s6, s6, s3
    s_lshl_b32 s6, s6, 2
    s_add_u32 s6, s6, 15728640
    v_writelane_b32 v11, s6, 0
    s_mul_i32 s96, s96, 20480
    s_lshr_b32 s6, s3, 2
    s_mul_i32 s6, s6, 5120
    s_add_u32 s96, s96, s6
    s_add_u32 s96, s96, 67108864
    s_and_b32 s97, s4, 7
    s_lshl_b32 s7, s5, 3
    s_add_u32 s97, s97, s7
    s_lshr_b32 s7, s4, 3
    s_add_u32 s7, s7, 1
    s_add_u32 s7, s7, 1
    s_and_b32 s7, s7, 3
    s_lshl_b32 s97, s97, 2
    s_add_u32 s97, s97, s7
    s_mul_i32 s97, s97, 3
    s_add_u32 s97, s97, 1
    s_lshl_b32 s6, s97, 5
    s_add_u32 s6, s6, s3
    s_lshl_b32 s6, s6, 2
    s_add_u32 s6, s6, 15728640
    v_writelane_b32 v11, s6, 1
    s_mul_i32 s97, s97, 20480
    s_lshr_b32 s6, s3, 2
    s_mul_i32 s6, s6, 5120
    s_add_u32 s97, s97, s6
    s_add_u32 s97, s97, 67108864
    s_and_b32 s98, s4, 7
    s_lshl_b32 s7, s5, 3
    s_add_u32 s98, s98, s7
    s_lshr_b32 s7, s4, 3
    s_add_u32 s7, s7, 2
    s_add_u32 s7, s7, 1
    s_and_b32 s7, s7, 3
    s_lshl_b32 s98, s98, 2
    s_add_u32 s98, s98, s7
    s_mul_i32 s98, s98, 3
    s_add_u32 s98, s98, 2
    s_lshl_b32 s6, s98, 5
    s_add_u32 s6, s6, s3
    s_lshl_b32 s6, s6, 2
    s_add_u32 s6, s6, 15728640
    v_writelane_b32 v11, s6, 2
    s_mul_i32 s98, s98, 20480
    s_lshr_b32 s6, s3, 2
    s_mul_i32 s6, s6, 5120
    s_add_u32 s98, s98, s6
    s_add_u32 s98, s98, 67108864
    s_mov_b32 s12, s32
    s_mov_b32 s13, s33
    s_mov_b32 s14, 0x280000
    s_mov_b32 s15, 0x20000
    s_and_b32 s75, s4, 3
    s_mul_i32 s70, s75, 320
    s_add_u32 s73, s70, 3837952
    s_mul_i32 s72, s75, 5120
    v_lshrrev_b32 v2, 4, v1
    v_and_b32 v3, 15, v1
    v_mul_u32_u24 v54, 1280, v3
    v_lshl_add_u32 v54, v2, 4, v54
    v_lshlrev_b32 v3, 4, v3
    v_lshl_add_u32 v9, v2, 9, v3
    s_lshr_b32 s100, s3, 2
    s_cselect_b32 s6, s61, s68
    s_mul_i32 s6, s6, 20480
    s_lshl_b32 s7, s76, 6
    s_add_u32 s7, s7, s6
    v_add_u32 v53, s7, v54
    s_lshl_b32 s7, s76, 10
    s_add_u32 s7, s7, s6
    s_add_u32 s7, s7, s72
    v_add_u32 v48, s7, v13
    s_mul_i32 s6, s100, 10240
    s_lshl_b32 s7, s76, 11
    s_add_u32 s6, s6, s7
    v_add_u32 v8, s6, v9
    s_mul_i32 s6, s100, 75776
    s_sub_u32 s6, 65536, s6
    v_add_u32 v10, s6, v8
    s_lshl_b32 s7, s76, 2
    v_add_u32 v2, s7, v2
    v_cmp_lt_u32 vcc, 9, v2
    s_mul_i32 s6, s100, 86016
    s_add_u32 s6, s6, 15360
    v_add_u32 v3, s6, v10
    v_cndmask_b32 v10, v10, v3, vcc
    s_and_b32 s100, s3, 1
    s_cselect_b32 s6, s61, s68
    s_mul_i32 s6, s6, 20480
    s_add_u32 s7, s6, 256
    v_add_u32 v54, s7, v54
    s_add_u32 s7, s6, s72
    s_add_u32 s7, s7, 4096
    v_add_u32 v49, s7, v13
    s_mul_i32 s6, s100, 10240
    s_add_u32 s6, s6, 8192
    v_add_u32 v9, s6, v9
    s_mul_i32 s6, s100, 10240
    s_add_u32 s6, s6, 80896
    v_add_u32 v55, s6, v9
    s_mov_b32 s64, 0
    v_and_b32 v2, 0x7ff, v51
    v_sub_u32 v2, 0x7ff, v2
    v_lshrrev_b32 v3, 4, v2
    v_cmp_eq_u32 vcc, s68, v3
    v_cmp_eq_u32 s[74:75], s61, v3
    s_nop 3
    s_or_b64 vcc, vcc, s[74:75]
    s_cbranch_scc0 L_notok_25
    v_readlane_b32 s84, v2, 0
    v_readlane_b32 s85, v2, 1
    v_readlane_b32 s86, v2, 2
    v_readlane_b32 s87, v2, 3
    v_readlane_b32 s88, v2, 4
    v_readlane_b32 s65, v2, 5
    v_readlane_b32 s91, v2, 6
    v_readlane_b32 s101, v2, 7
    s_lshl_b32 s7, s76, 6
    s_lshr_b32 s100, s3, 2
    s_cselect_b32 s6, s61, s68
    s_lshl_b32 s6, s6, 4
    v_and_b32 v2, 15, v1
    v_add_u32 v2, s6, v2
    s_add_u32 s7, s7, s73
    v_and_b32 v3, 48, v1
    v_add_u32 v3, s7, v3
    v_cmp_eq_u32 vcc, s84, v2
    s_nop 1
    v_cndmask_b32 v48, v48, v3, vcc
    v_add_u32 v3, 1280, v3
    v_cmp_eq_u32 vcc, s85, v2
    s_nop 1
    v_cndmask_b32 v48, v48, v3, vcc
    v_add_u32 v3, 1280, v3
    v_cmp_eq_u32 vcc, s86, v2
    s_nop 1
    v_cndmask_b32 v48, v48, v3, vcc
    v_add_u32 v3, 1280, v3
    v_cmp_eq_u32 vcc, s87, v2
    s_nop 1
    v_cndmask_b32 v48, v48, v3, vcc
    v_add_u32 v3, 1280, v3
    v_cmp_eq_u32 vcc, s88, v2
    s_nop 1
    v_cndmask_b32 v48, v48, v3, vcc
    v_add_u32 v3, 1280, v3
    v_cmp_eq_u32 vcc, s65, v2
    s_nop 1
    v_cndmask_b32 v48, v48, v3, vcc
    v_add_u32 v3, 1280, v3
    v_cmp_eq_u32 vcc, s91, v2
    s_nop 1
    v_cndmask_b32 v48, v48, v3, vcc
    v_add_u32 v3, 1280, v3
    v_cmp_eq_u32 vcc, s101, v2
    s_nop 1
    v_cndmask_b32 v48, v48, v3, vcc
    s_movk_i32 s7, 256
    s_and_b32 s100, s3, 1
    s_cselect_b32 s6, s61, s68
    s_lshl_b32 s6, s6, 4
    v_and_b32 v2, 15, v1
    v_add_u32 v2, s6, v2
    s_add_u32 s7, s7, s73
    v_and_b32 v3, 48, v1
    v_add_u32 v3, s7, v3
    v_cmp_eq_u32 vcc, s84, v2
    s_nop 1
    v_cndmask_b32 v49, v49, v3, vcc
    v_add_u32 v3, 1280, v3
    v_cmp_eq_u32 vcc, s85, v2
    s_nop 1
    v_cndmask_b32 v49, v49, v3, vcc
    v_add_u32 v3, 1280, v3
    v_cmp_eq_u32 vcc, s86, v2
    s_nop 1
    v_cndmask_b32 v49, v49, v3, vcc
    v_add_u32 v3, 1280, v3
    v_cmp_eq_u32 vcc, s87, v2
    s_nop 1
    v_cndmask_b32 v49, v49, v3, vcc
    v_add_u32 v3, 1280, v3
    v_cmp_eq_u32 vcc, s88, v2
    s_nop 1
    v_cndmask_b32 v49, v49, v3, vcc
    v_add_u32 v3, 1280, v3
    v_cmp_eq_u32 vcc, s65, v2
    s_nop 1
    v_cndmask_b32 v49, v49, v3, vcc
    v_add_u32 v3, 1280, v3
    v_cmp_eq_u32 vcc, s91, v2
    s_nop 1
    v_cndmask_b32 v49, v49, v3, vcc
    v_add_u32 v3, 1280, v3
    v_cmp_eq_u32 vcc, s101, v2
    s_nop 1
    v_cndmask_b32 v49, v49, v3, vcc
    s_mov_b32 s64, 1
L_notok_25:
    s_setpc_b64 s[80:81]
L_pre1:
    s_mov_b32 s28, s56
    s_mov_b32 s29, s57
    s_mov_b32 s30, 0x100
    s_mov_b32 s31, 0x20000
    v_and_b32 v3, 31, v1
    v_lshlrev_b32 v3, 2, v3
    s_mov_b32 s79, 262144
L_poll_26:
    buffer_load_dword v2, v3, s[28:31], 0 offen offset:128 sc1
    s_waitcnt vmcnt(0)
    v_cmp_gt_u32 vcc, 4, v2
    s_cbranch_vccz L_polldone_27
    s_sleep 8
    s_sub_u32 s79, s79, 1
    s_cmp_lg_u32 s79, 0
    s_cbranch_scc1 L_poll_26
L_polldone_27:
    s_mov_b32 s90, 1
    v_and_b32 v3, 7, v1
    v_lshlrev_b32 v3, 2, v3
    s_mov_b32 s72, 0x3a0000
    buffer_load_dword v51, v3, s[8:11], s72 offen sc1
    s_add_u32 s6, s76, 0
    s_and_b32 s6, s6, 3
    s_lshl_b32 s6, s6, 10
    v_add_u32 v44, s6, v13
    s_add_u32 s6, s76, 1
    s_and_b32 s6, s6, 3
    s_lshl_b32 s6, s6, 10
    v_add_u32 v45, s6, v13
    s_add_u32 s6, s76, 2
    s_and_b32 s6, s6, 3
    s_lshl_b32 s6, s6, 10
    v_add_u32 v46, s6, v13
    s_add_u32 s6, s76, 3
    s_and_b32 s6, s6, 3
    s_lshl_b32 s6, s6, 10
    v_add_u32 v47, s6, v13
    v_add_u32 v52, 4096, v13
    s_lshr_b32 s69, s4, 3
    s_lshl_b32 s69, s69, 2
    s_add_u32 s69, s69, s76
    s_mul_i32 s69, s69, 327680
    s_and_b32 s7, s4, 3
    s_mul_i32 s7, s7, 10240
    s_add_u32 s69, s69, s7
    s_add_u32 s69, s69, 4194304
    s_and_b32 s6, s4, 4
    s_lshr_b32 s7, s4, 3
    s_add_u32 s6, s6, s7
    s_lshl_b32 s7, s5, 3
    s_add_u32 s68, s6, s7
    s_sub_u32 s7, 120, s7
    s_add_u32 s61, s6, s7
    s_add_u32 s75, s69, 0
    buffer_load_dwordx4 v[96:99], v44, s[8:11], s75 offen sc1
    buffer_load_dwordx4 v[100:103], v45, s[8:11], s75 offen sc1
    buffer_load_dwordx4 v[104:107], v46, s[8:11], s75 offen sc1
    buffer_load_dwordx4 v[108:111], v47, s[8:11], s75 offen sc1
    buffer_load_dwordx4 v[112:115], v52, s[8:11], s75 offen sc1
    s_add_u32 s75, s69, 40960
    buffer_load_dwordx4 v[116:119], v44, s[8:11], s75 offen sc1
    buffer_load_dwordx4 v[120:123], v45, s[8:11], s75 offen sc1
    buffer_load_dwordx4 v[124:127], v46, s[8:11], s75 offen sc1
    buffer_load_dwordx4 v[128:131], v47, s[8:11], s75 offen sc1
    buffer_load_dwordx4 v[132:135], v52, s[8:11], s75 offen sc1
    s_cmp_gt_i32 s62, s63
    s_cbranch_scc1 L_e2
    s_cmp_eq_i32 s62, s63
    s_cbranch_scc1 L_lw0
    s_waitcnt vmcnt(11)
L_lw0:
    s_waitcnt vmcnt(21)
    s_call_b64 s[82:83], L_pend
    s_barrier
    s_call_b64 s[82:83], L_load
    s_add_i32 s62, s62, 1
L_e2:
    s_add_u32 s75, s69, 81920
    buffer_load_dwordx4 v[136:139], v44, s[8:11], s75 offen sc1
    buffer_load_dwordx4 v[140:143], v45, s[8:11], s75 offen sc1
    buffer_load_dwordx4 v[144:147], v46, s[8:11], s75 offen sc1
    buffer_load_dwordx4 v[148:151], v47, s[8:11], s75 offen sc1
    buffer_load_dwordx4 v[152:155], v52, s[8:11], s75 offen sc1
    s_add_u32 s75, s69, 122880
    buffer_load_dwordx4 v[156:159], v44, s[8:11], s75 offen sc1
    buffer_load_dwordx4 v[160:163], v45, s[8:11], s75 offen sc1
    buffer_load_dwordx4 v[164:167], v46, s[8:11], s75 offen sc1
    buffer_load_dwordx4 v[168:171], v47, s[8:11], s75 offen sc1
    buffer_load_dwordx4 v[172:175], v52, s[8:11], s75 offen sc1
    s_cmp_gt_i32 s62, s63
    s_cbranch_scc1 L_e3
    s_cmp_eq_i32 s62, s63
    s_cbranch_scc1 L_lw1
    s_waitcnt vmcnt(10)
L_lw1:
    s_waitcnt vmcnt(21)
    s_call_b64 s[82:83], L_pend
    s_barrier
    s_call_b64 s[82:83], L_load
    s_add_i32 s62, s62, 1
L_e3:
    s_add_u32 s75, s69, 163840
    buffer_load_dwordx4 v[176:179], v44, s[8:11], s75 offen sc1
    buffer_load_dwordx4 v[180:183], v45, s[8:11], s75 offen sc1
    buffer_load_dwordx4 v[184:187], v46, s[8:11], s75 offen sc1
    buffer_load_dwordx4 v[188:191], v47, s[8:11], s75 offen sc1
    buffer_load_dwordx4 v[192:195], v52, s[8:11], s75 offen sc1
    s_add_u32 s75, s69, 204800
    buffer_load_dwordx4 v[196:199], v44, s[8:11], s75 offen sc1
    buffer_load_dwordx4 v[200:203], v45, s[8:11], s75 offen sc1
    buffer_load_dwordx4 v[204:207], v46, s[8:11], s75 offen sc1
    buffer_load_dwordx4 v[208:211], v47, s[8:11], s75 offen sc1
    buffer_load_dwordx4 v[212:215], v52, s[8:11], s75 offen sc1
    s_cmp_gt_i32 s62, s63
    s_cbranch_scc1 L_e4
    s_cmp_eq_i32 s62, s63
    s_cbranch_scc1 L_lw2
    s_waitcnt vmcnt(10)
L_lw2:
    s_waitcnt vmcnt(21)
    s_call_b64 s[82:83], L_pend
    s_barrier
    s_call_b64 s[82:83], L_load
    s_add_i32 s62, s62, 1
L_e4:
    s_add_u32 s75, s69, 245760
    buffer_load_dwordx4 v[216:219], v44, s[8:11], s75 offen sc1
    buffer_load_dwordx4 v[220:223], v45, s[8:11], s75 offen sc1
    buffer_load_dwordx4 v[224:227], v46, s[8:11], s75 offen sc1
    buffer_load_dwordx4 v[228:231], v47, s[8:11], s75 offen sc1
    buffer_load_dwordx4 v[232:235], v52, s[8:11], s75 offen sc1
    s_add_u32 s75, s69, 286720
    buffer_load_dwordx4 v[236:239], v44, s[8:11], s75 offen sc1
    buffer_load_dwordx4 v[240:243], v45, s[8:11], s75 offen sc1
    buffer_load_dwordx4 v[244:247], v46, s[8:11], s75 offen sc1
    buffer_load_dwordx4 v[248:251], v47, s[8:11], s75 offen sc1
    buffer_load_dwordx4 v[252:255], v52, s[8:11], s75 offen sc1
    s_cmp_gt_i32 s62, s63
    s_cbranch_scc1 L_e5
    s_cmp_eq_i32 s62, s63
    s_cbranch_scc1 L_lw3
    s_waitcnt vmcnt(10)
L_lw3:
    s_waitcnt vmcnt(21)
    s_call_b64 s[82:83], L_pend
    s_barrier
    s_call_b64 s[82:83], L_load
    s_add_i32 s62, s62, 1
L_e5:
    v_and_b32 v3, 1, v1
    v_lshlrev_b32 v3, 12, v3
    v_and_b32 v2, 2, v1
    v_lshl_add_u32 v3, v2, 8, v3
    s_lshr_b32 s72, s68, 2
    s_lshl_b32 s72, s72, 6
    s_andn2_b32 s6, s4, 7
    s_add_u32 s72, s72, s6
    s_add_u32 s72, s72, s3
    s_lshl_b32 s72, s72, 7
    s_add_u32 s72, s72, 3932160
    buffer_load_dword v50, v3, s[8:11], s72 offen sc1
    s_cmp_gt_i32 s62, s63
    s_cbranch_scc1 L_e6
    s_waitcnt vmcnt(21)
    s_call_b64 s[82:83], L_pend
    s_barrier
    s_call_b64 s[82:83], L_load
    s_add_i32 s62, s62, 1
L_e6:
    s_waitcnt vmcnt(20)
    v_cmp_le_i32 vcc, 0, v51
    s_cbranch_vccz L_idx_oka
    v_and_b32 v3, 7, v1
    v_lshlrev_b32 v3, 2, v3
    s_mov_b32 s72, 0x3a0000
    s_mov_b32 s79, 262144
L_poll_33:
    buffer_load_dword v51, v3, s[8:11], s72 offen sc1
    s_waitcnt vmcnt(0)
    v_cmp_le_i32 vcc, 0, v51
    s_cbranch_vccz L_polldone_34
    s_sleep 2
    s_sub_u32 s79, s79, 1
    s_cmp_lg_u32 s79, 0
    s_cbranch_scc1 L_poll_33
L_polldone_34:
L_idx_oka:
    s_lshr_b32 s7, s3, 1
    s_lshl_b32 s7, s7, 4
    s_add_u32 s6, s5, s7
    s_cmp_lg_u32 s6, 3
    s_cbranch_scc1 L_yd
    s_lshr_b32 s87, s4, 2
    s_and_b32 s88, s4, 3
    s_lshl_b32 s88, s88, 1
    s_add_u32 s88, s88, s3
    s_mov_b32 m0, s87
    s_nop 3
    v_readlane_b32 s85, v51, m0
    s_nop 3
    s_and_b32 s86, s85, 0x7ff
    s_sub_u32 s86, 0x7ff, s86
    v_min_u32 v3, 53, v1
    v_lshlrev_b32 v3, 7, v3
    s_mov_b32 s72, 0xf20000
    s_mov_b32 s79, 262144
L_poll_35:
    buffer_load_dwordx4 v[16:19], v3, s[8:11], s72 offen sc1
    s_waitcnt vmcnt(0)
    v_and_b32 v16, v16, v17
    v_and_b32 v16, v16, v18
    v_and_b32 v16, v16, v19
    v_cmp_ne_u32 vcc, 1, v16
    s_cbranch_vccz L_polldone_36
    s_sleep 16
    s_sub_u32 s79, s79, 1
    s_cmp_lg_u32 s79, 0
    s_cbranch_scc1 L_poll_35
L_polldone_36:
    v_mul_u32_u24 v2, 13, v1
    v_lshrrev_b32 v2, 8, v2
    v_mul_u32_u24 v3, 20, v2
    v_sub_u32 v4, v1, v3
    s_mov_b32 s6, 368640
    v_mul_lo_u32 v2, v2, s6
    v_lshl_add_u32 v2, v4, 4, v2
    v_cmp_lt_u32 vcc, 59, v1
    v_mov_b32 v3, 0x5000000
    s_nop 0
    v_cndmask_b32 v2, v2, v3, vcc
    s_mul_i32 s6, s87, 2560
    s_mul_i32 s7, s88, 320
    s_add_u32 s6, s6, s7
    s_add_u32 s6, s6, 2686976
    buffer_load_dwordx4 v[16:19], v2, s[8:11], s6 offen sc1
    s_add_u32 s6, s6, 20480
    buffer_load_dwordx4 v[20:23], v2, s[8:11], s6 offen sc1
    s_add_u32 s6, s6, 20480
    buffer_load_dwordx4 v[24:27], v2, s[8:11], s6 offen sc1
    s_add_u32 s6, s6, 20480
    buffer_load_dwordx4 v[28:31], v2, s[8:11], s6 offen sc1
    s_add_u32 s6, s6, 20480
    buffer_load_dwordx4 v[32:35], v2, s[8:11], s6 offen sc1
    s_add_u32 s6, s6, 20480
    buffer_load_dwordx4 v[36:39], v2, s[8:11], s6 offen sc1
    s_add_u32 s6, s6, 20480
    buffer_load_dwordx4 v[40:43], v2, s[8:11], s6 offen sc1
    s_add_u32 s6, s6, 20480
    buffer_load_dwordx4 v[44:47], v2, s[8:11], s6 offen sc1
    s_add_u32 s6, s6, 20480
    buffer_load_dwordx4 v[56:59], v2, s[8:11], s6 offen sc1
    s_add_u32 s6, s6, 20480
    buffer_load_dwordx4 v[60:63], v2, s[8:11], s6 offen sc1
    s_add_u32 s6, s6, 20480
    buffer_load_dwordx4 v[64:67], v2, s[8:11], s6 offen sc1
    s_add_u32 s6, s6, 20480
    buffer_load_dwordx4 v[68:71], v2, s[8:11], s6 offen sc1
    s_add_u32 s6, s6, 20480
    buffer_load_dwordx4 v[72:75], v2, s[8:11], s6 offen sc1
    s_add_u32 s6, s6, 20480
    buffer_load_dwordx4 v[76:79], v2, s[8:11], s6 offen sc1
    s_add_u32 s6, s6, 20480
    buffer_load_dwordx4 v[80:83], v2, s[8:11], s6 offen sc1
    s_add_u32 s6, s6, 20480
    buffer_load_dwordx4 v[84:87], v2, s[8:11], s6 offen sc1
    s_add_u32 s6, s6, 20480
    buffer_load_dwordx4 v[88:91], v2, s[8:11], s6 offen sc1
    s_add_u32 s6, s6, 20480
    buffer_load_dwordx4 v[92:95], v2, s[8:11], s6 offen sc1
    s_add_u32 s6, s6, 20480
    s_lshr_b32 s6, s86, 4
    s_mul_i32 s6, s6, 20480
    s_and_b32 s7, s86, 15
    s_lshl_b32 s7, s7, 4
    s_add_u32 s6, s6, s7
    s_mul_i32 s7, s88, 2560
    s_add_u32 s6, s6, s7
    v_lshrrev_b32 v5, 1, v4
    v_lshlrev_b32 v5, 8, v5
    v_and_b32 v6, 1, v4
    v_lshl_add_u32 v5, v6, 3, v5
    buffer_load_dwordx2 v[54:55], v5, s[8:11], s6 offen sc1
    s_bfe_u32 s6, s85, 0x10000b
    s_xor_b32 s7, s6, 0xffff
    s_bitcmp1_b32 s6, 15
    s_bitset0_b32 s6, 15
    s_cselect_b32 s6, s6, s7
    s_lshl_b32 s6, s6, 16
    v_mov_b32 v5, s6
    v_mul_f32 v5, 0xbfb8aa3b, v5
    v_exp_f32 v5, v5
    s_nop 0
    v_add_f32 v5, 1.0, v5
    v_rcp_f32 v5, v5
    s_nop 0
    v_cvt_pk_bf16_f32 v5, v5, v5
    v_lshlrev_b32 v5, 16, v5
    v_lshlrev_b32 v6, 2, v1
    s_waitcnt vmcnt(0)
    v_pk_add_f32 v[16:17], v[16:17], v[20:21]
    v_pk_add_f32 v[18:19], v[18:19], v[22:23]
    v_pk_add_f32 v[16:17], v[16:17], v[24:25]
    v_pk_add_f32 v[18:19], v[18:19], v[26:27]
    v_pk_add_f32 v[16:17], v[16:17], v[28:29]
    v_pk_add_f32 v[18:19], v[18:19], v[30:31]
    v_pk_add_f32 v[16:17], v[16:17], v[32:33]
    v_pk_add_f32 v[18:19], v[18:19], v[34:35]
    v_pk_add_f32 v[16:17], v[16:17], v[36:37]
    v_pk_add_f32 v[18:19], v[18:19], v[38:39]
    v_pk_add_f32 v[16:17], v[16:17], v[40:41]
    v_pk_add_f32 v[18:19], v[18:19], v[42:43]
    v_pk_add_f32 v[16:17], v[16:17], v[44:45]
    v_pk_add_f32 v[18:19], v[18:19], v[46:47]
    v_pk_add_f32 v[16:17], v[16:17], v[56:57]
    v_pk_add_f32 v[18:19], v[18:19], v[58:59]
    v_pk_add_f32 v[16:17], v[16:17], v[60:61]
    v_pk_add_f32 v[18:19], v[18:19], v[62:63]
    v_pk_add_f32 v[16:17], v[16:17], v[64:65]
    v_pk_add_f32 v[18:19], v[18:19], v[66:67]
    v_pk_add_f32 v[16:17], v[16:17], v[68:69]
    v_pk_add_f32 v[18:19], v[18:19], v[70:71]
    v_pk_add_f32 v[16:17], v[16:17], v[72:73]
    v_pk_add_f32 v[18:19], v[18:19], v[74:75]
    v_pk_add_f32 v[16:17], v[16:17], v[76:77]
    v_pk_add_f32 v[18:19], v[18:19], v[78:79]
    v_pk_add_f32 v[16:17], v[16:17], v[80:81]
    v_pk_add_f32 v[18:19], v[18:19], v[82:83]
    v_pk_add_f32 v[16:17], v[16:17], v[84:85]
    v_pk_add_f32 v[18:19], v[18:19], v[86:87]
    v_pk_add_f32 v[16:17], v[16:17], v[88:89]
    v_pk_add_f32 v[18:19], v[18:19], v[90:91]
    v_pk_add_f32 v[16:17], v[16:17], v[92:93]
    v_pk_add_f32 v[18:19], v[18:19], v[94:95]
    ds_bpermute_b32 v20, v6, v16 offset:80
    ds_bpermute_b32 v21, v6, v17 offset:80
    ds_bpermute_b32 v22, v6, v18 offset:80
    ds_bpermute_b32 v23, v6, v19 offset:80
    ds_bpermute_b32 v24, v6, v16 offset:160
    ds_bpermute_b32 v25, v6, v17 offset:160
    ds_bpermute_b32 v26, v6, v18 offset:160
    ds_bpermute_b32 v27, v6, v19 offset:160
    s_waitcnt lgkmcnt(0)
    v_add_f32 v16, v16, v20
    v_add_f32 v16, v16, v24
    v_cvt_pk_bf16_f32 v16, v16, v16
    v_lshlrev_b32 v16, 16, v16
    v_mul_f32 v16, v16, v5
    v_cvt_pk_bf16_f32 v16, v16, v16
    v_lshlrev_b32 v16, 16, v16
    v_lshlrev_b32 v7, 16, v54
    v_add_f32 v16, v16, v7
    v_add_f32 v17, v17, v21
    v_add_f32 v17, v17, v25
    v_cvt_pk_bf16_f32 v17, v17, v17
    v_lshlrev_b32 v17, 16, v17
    v_mul_f32 v17, v17, v5
    v_cvt_pk_bf16_f32 v17, v17, v17
    v_lshlrev_b32 v17, 16, v17
    v_and_b32 v7, 0xffff0000, v54
    v_add_f32 v17, v17, v7
    v_add_f32 v18, v18, v22
    v_add_f32 v18, v18, v26
    v_cvt_pk_bf16_f32 v18, v18, v18
    v_lshlrev_b32 v18, 16, v18
    v_mul_f32 v18, v18, v5
    v_cvt_pk_bf16_f32 v18, v18, v18
    v_lshlrev_b32 v18, 16, v18
    v_lshlrev_b32 v7, 16, v55
    v_add_f32 v18, v18, v7
    v_add_f32 v19, v19, v23
    v_add_f32 v19, v19, v27
    v_cvt_pk_bf16_f32 v19, v19, v19
    v_lshlrev_b32 v19, 16, v19
    v_mul_f32 v19, v19, v5
    v_cvt_pk_bf16_f32 v19, v19, v19
    v_lshlrev_b32 v19, 16, v19
    v_and_b32 v7, 0xffff0000, v55
    v_add_f32 v19, v19, v7
    v_cvt_pk_bf16_f32 v20, v16, v17
    v_cvt_pk_bf16_f32 v21, v18, v19
    v_lshlrev_b32 v2, 3, v1
    v_cmp_lt_u32 vcc, 19, v1
    s_mul_i32 s6, s87, 1280
    s_mul_i32 s7, s88, 160
    v_cndmask_b32 v2, v2, v3, vcc
    s_add_u32 s6, s6, s7
    s_add_u32 s6, s6, 3837952
    buffer_store_dwordx2 v[20:21], v2, s[8:11], s6 offen sc1
    s_call_b64 s[80:81], L_oprep
    s_waitcnt vmcnt(0)
    s_lshl_b32 s6, s5, 5
    s_add_u32 s6, s6, s4
    s_lshl_b32 s6, s6, 5
    s_add_u32 s6, s6, s3
    s_lshl_b32 s6, s6, 2
    s_add_u32 s6, s6, 3899392
    v_mov_b32 v2, 1
    v_mov_b32 v3, 0x5000000
    v_writelane_b32 v3, s6, 0
    buffer_store_dword v2, v3, s[8:11], 0 offen sc1
    s_branch L_ye
L_yd:
    s_call_b64 s[80:81], L_oprep
    s_waitcnt vmcnt(0)
L_ye:
    v_cmp_ne_u32 vcc, 1, v50
    s_cbranch_vccz L_ce
    v_and_b32 v3, 1, v1
    v_lshlrev_b32 v3, 12, v3
    v_and_b32 v2, 2, v1
    v_lshl_add_u32 v3, v2, 8, v3
    s_lshr_b32 s72, s68, 2
    s_lshl_b32 s72, s72, 6
    s_andn2_b32 s6, s4, 7
    s_add_u32 s72, s72, s6
    s_add_u32 s72, s72, s3
    s_lshl_b32 s72, s72, 7
    s_add_u32 s72, s72, 3932160
    s_mov_b32 s79, 262144
L_poll_37:
    buffer_load_dword v2, v3, s[8:11], s72 offen sc1
    s_waitcnt vmcnt(0)
    v_cmp_ne_u32 vcc, 1, v2
    s_cbranch_vccz L_polldone_38
    s_sleep 4
    s_sub_u32 s79, s79, 1
    s_cmp_lg_u32 s79, 0
    s_cbranch_scc1 L_poll_37
L_polldone_38:
L_ce:
    s_add_u32 s65, s68, 1
    s_and_b32 s65, s65, 3
    s_andn2_b32 s7, s68, 3
    s_add_u32 s65, s65, s7
    s_lshl_b32 s65, s65, 17
    s_add_u32 s65, s65, s66
    s_add_u32 m0, s99, 0
    s_add_u32 s65, s65, 0
    buffer_load_dwordx4 v13, s[8:11], s65 offen offset:0 sc1 lds
    buffer_load_dwordx4 v13, s[8:11], s65 offen offset:1024 sc1 lds
    buffer_load_dwordx4 v13, s[8:11], s65 offen offset:2048 sc1 lds
    buffer_load_dwordx4 v13, s[8:11], s65 offen offset:3072 sc1 lds
    s_add_u32 s65, s68, 1
    s_and_b32 s65, s65, 3
    s_andn2_b32 s7, s68, 3
    s_add_u32 s65, s65, s7
    s_lshl_b32 s65, s65, 17
    s_add_u32 s65, s65, s66
    s_add_u32 m0, s99, 16384
    s_add_u32 s65, s65, 16384
    buffer_load_dwordx4 v13, s[8:11], s65 offen offset:0 sc1 lds
    buffer_load_dwordx4 v13, s[8:11], s65 offen offset:1024 sc1 lds
    buffer_load_dwordx4 v13, s[8:11], s65 offen offset:2048 sc1 lds
    buffer_load_dwordx4 v13, s[8:11], s65 offen offset:3072 sc1 lds
    s_setprio 0
    s_barrier
    s_add_u32 s65, s68, 2
    s_and_b32 s65, s65, 3
    s_andn2_b32 s7, s68, 3
    s_add_u32 s65, s65, s7
    s_lshl_b32 s65, s65, 17
    s_add_u32 s65, s65, s66
    s_add_u32 m0, s99, 32768
    s_add_u32 s65, s65, 0
    buffer_load_dwordx4 v13, s[8:11], s65 offen offset:0 sc1 lds
    buffer_load_dwordx4 v13, s[8:11], s65 offen offset:1024 sc1 lds
    buffer_load_dwordx4 v13, s[8:11], s65 offen offset:2048 sc1 lds
    buffer_load_dwordx4 v13, s[8:11], s65 offen offset:3072 sc1 lds
    s_add_u32 s65, s68, 2
    s_and_b32 s65, s65, 3
    s_andn2_b32 s7, s68, 3
    s_add_u32 s65, s65, s7
    s_lshl_b32 s65, s65, 17
    s_add_u32 s65, s65, s66
    s_add_u32 m0, s99, 49152
    s_add_u32 s65, s65, 16384
    buffer_load_dwordx4 v13, s[8:11], s65 offen offset:0 sc1 lds
    buffer_load_dwordx4 v13, s[8:11], s65 offen offset:1024 sc1 lds
    buffer_load_dwordx4 v13, s[8:11], s65 offen offset:2048 sc1 lds
    buffer_load_dwordx4 v13, s[8:11], s65 offen offset:3072 sc1 lds
    s_waitcnt vmcnt(8)
    s_branch L_adone
L_moe:
    s_sub_u32 s6, s62, s5
    s_cmp_lg_u32 s6, 3
    s_cbranch_scc1 L_idle
    s_mov_b32 s12, s48
    s_mov_b32 s13, s49
    s_mov_b32 s14, 0x21c000
    s_mov_b32 s15, 0x20000
    s_cmp_ge_u32 s3, 2
    s_cselect_b32 s12, s50, s12
    s_cselect_b32 s13, s51, s13
    s_mov_b32 s16, s52
    s_mov_b32 s17, s53
    s_mov_b32 s18, 0x21c000
    s_mov_b32 s19, 0x20000
    v_lshrrev_b32 v3, 2, v1
    v_mul_u32_u24 v3, 3456, v3
    v_and_b32 v4, 3, v1
    v_lshl_add_u32 v16, v4, 4, v3
    v_lshrrev_b32 v3, 3, v1
    v_mul_u32_u24 v3, 1280, v3
    v_and_b32 v4, 7, v1
    v_lshl_add_u32 v18, v4, 4, v3
    s_and_b32 s7, s3, 1
    s_mul_i32 s84, s7, 1105920
    s_lshl_b32 s6, s61, 6
    s_add_u32 s84, s84, s6
    s_lshl_b32 s85, s3, 13
    s_add_u32 s85, s85, 131072
    s_mul_i32 s86, s61, 40960
    s_lshl_b32 s6, s3, 7
    s_add_u32 s86, s86, s6
    s_add_u32 m0, s85, 0
    s_nop 0
    buffer_load_dwordx4 v16, s[12:15], s84 offen lds
    s_add_u32 s84, s84, 55296
    s_add_u32 m0, s85, 1024
    s_nop 0
    buffer_load_dwordx4 v16, s[12:15], s84 offen lds
    s_add_u32 s84, s84, 55296
    s_add_u32 m0, s85, 2048
    s_nop 0
    buffer_load_dwordx4 v16, s[12:15], s84 offen lds
    s_add_u32 s84, s84, 55296
    s_add_u32 m0, s85, 3072
    s_nop 0
    buffer_load_dwordx4 v16, s[12:15], s84 offen lds
    s_add_u32 s84, s84, 55296
    s_add_u32 m0, s85, 4096
    s_nop 0
    buffer_load_dwordx4 v16, s[12:15], s84 offen lds
    s_add_u32 s84, s84, 55296
    s_add_u32 m0, s85, 5120
    s_nop 0
    buffer_load_dwordx4 v16, s[12:15], s84 offen lds
    s_add_u32 s84, s84, 55296
    s_add_u32 m0, s85, 6144
    s_nop 0
    buffer_load_dwordx4 v16, s[12:15], s84 offen lds
    s_add_u32 s84, s84, 55296
    s_add_u32 m0, s85, 7168
    s_nop 0
    buffer_load_dwordx4 v16, s[12:15], s84 offen lds
    s_add_u32 s84, s84, 55296
    v_lshrrev_b32 v7, 4, v1
    v_and_b32 v2, 15, v1
    v_lshrrev_b32 v3, 2, v2
    v_lshl_add_u32 v8, v7, 3, v3
    v_lshlrev_b32 v8, 6, v8
    v_and_b32 v4, 3, v2
    v_lshl_add_u32 v8, v4, 3, v8
    v_add_u32 v17, s85, v8
    v_lshl_add_u32 v8, v7, 2, v3
    v_lshlrev_b32 v8, 7, v8
    v_lshl_add_u32 v8, v4, 3, v8
    s_add_u32 s6, s85, 4096
    v_add_u32 v19, s6, v8
    v_mul_u32_u24 v3, 2560, v2
    v_lshl_add_u32 v3, v7, 4, v3
    v_mov_b32 v4, 0x5000000
    v_cmp_gt_u32 vcc, 8, v2
    s_mul_i32 s87, s61, 20480
    s_lshl_b32 s7, s3, 8
    s_add_u32 s87, s87, s7
    s_add_u32 s87, s87, 2686976
    v_cndmask_b32 v20, v4, v3, vcc
    s_and_b32 s7, s3, 1
    s_mul_i32 s88, s7, 10240
    s_add_u32 s88, s88, 12582912
    s_waitcnt vmcnt(0) lgkmcnt(0)
    s_call_b64 s[82:83], L_pend
    s_barrier
    ds_read_b64_tr_b16 v[104:105], v17 offset:0
    ds_read_b64_tr_b16 v[106:107], v17 offset:256
    ds_read_b64_tr_b16 v[108:109], v17 offset:32
    ds_read_b64_tr_b16 v[110:111], v17 offset:288
    ds_read_b64_tr_b16 v[112:113], v17 offset:2048
    ds_read_b64_tr_b16 v[114:115], v17 offset:2304
    ds_read_b64_tr_b16 v[116:117], v17 offset:2080
    ds_read_b64_tr_b16 v[118:119], v17 offset:2336
    s_waitcnt lgkmcnt(0)
    ds_read_b64_tr_b16 v[120:121], v17 offset:4096
    ds_read_b64_tr_b16 v[122:123], v17 offset:4352
    ds_read_b64_tr_b16 v[124:125], v17 offset:4128
    ds_read_b64_tr_b16 v[126:127], v17 offset:4384
    ds_read_b64_tr_b16 v[128:129], v17 offset:6144
    ds_read_b64_tr_b16 v[130:131], v17 offset:6400
    ds_read_b64_tr_b16 v[132:133], v17 offset:6176
    ds_read_b64_tr_b16 v[134:135], v17 offset:6432
    s_waitcnt lgkmcnt(0)
    s_add_u32 m0, s85, 0
    s_nop 0
    buffer_load_dwordx4 v16, s[12:15], s84 offen lds
    s_add_u32 s84, s84, 55296
    s_add_u32 m0, s85, 1024
    s_nop 0
    buffer_load_dwordx4 v16, s[12:15], s84 offen lds
    s_add_u32 s84, s84, 55296
    s_add_u32 m0, s85, 2048
    s_nop 0
    buffer_load_dwordx4 v16, s[12:15], s84 offen lds
    s_add_u32 s84, s84, 55296
    s_add_u32 m0, s85, 3072
    s_nop 0
    buffer_load_dwordx4 v16, s[12:15], s84 offen lds
    s_add_u32 s84, s84, 55296
    s_add_u32 m0, s85, 4096
    s_nop 0
    buffer_load_dwordx4 v16, s[12:15], s84 offen lds
    s_add_u32 s84, s84, 55296
    s_add_u32 m0, s85, 5120
    s_nop 0
    buffer_load_dwordx4 v16, s[12:15], s84 offen lds
    s_add_u32 s84, s84, 55296
    s_add_u32 m0, s85, 6144
    s_nop 0
    buffer_load_dwordx4 v16, s[12:15], s84 offen lds
    s_add_u32 s84, s84, 55296
    s_add_u32 m0, s85, 7168
    s_nop 0
    buffer_load_dwordx4 v16, s[12:15], s84 offen lds
    s_add_u32 s84, s84, 55296
    s_call_b64 s[82:83], L_load
    s_add_i32 s62, s62, 1
    v_and_b32 v3, 7, v1
    v_lshlrev_b32 v3, 2, v3
    s_mov_b32 s72, 0x3a0000
    buffer_load_dword v51, v3, s[8:11], s72 offen sc1
    s_waitcnt vmcnt(0) lgkmcnt(0)
    s_call_b64 s[82:83], L_pend
    s_barrier
    ds_read_b64_tr_b16 v[136:137], v17 offset:0
    ds_read_b64_tr_b16 v[138:139], v17 offset:256
    ds_read_b64_tr_b16 v[140:141], v17 offset:32
    ds_read_b64_tr_b16 v[142:143], v17 offset:288
    ds_read_b64_tr_b16 v[144:145], v17 offset:2048
    ds_read_b64_tr_b16 v[146:147], v17 offset:2304
    ds_read_b64_tr_b16 v[148:149], v17 offset:2080
    ds_read_b64_tr_b16 v[150:151], v17 offset:2336
    s_waitcnt lgkmcnt(0)
    ds_read_b64_tr_b16 v[152:153], v17 offset:4096
    ds_read_b64_tr_b16 v[154:155], v17 offset:4352
    ds_read_b64_tr_b16 v[156:157], v17 offset:4128
    ds_read_b64_tr_b16 v[158:159], v17 offset:4384
    ds_read_b64_tr_b16 v[160:161], v17 offset:6144
    ds_read_b64_tr_b16 v[162:163], v17 offset:6400
    ds_read_b64_tr_b16 v[164:165], v17 offset:6176
    ds_read_b64_tr_b16 v[166:167], v17 offset:6432
    s_waitcnt lgkmcnt(0)
    s_add_u32 m0, s85, 0
    s_nop 0
    buffer_load_dwordx4 v16, s[12:15], s84 offen lds
    s_add_u32 s84, s84, 55296
    s_add_u32 m0, s85, 1024
    s_nop 0
    buffer_load_dwordx4 v16, s[12:15], s84 offen lds
    s_add_u32 s84, s84, 55296
    s_add_u32 m0, s85, 2048
    s_nop 0
    buffer_load_dwordx4 v16, s[12:15], s84 offen lds
    s_add_u32 s84, s84, 55296
    s_add_u32 m0, s85, 3072
    s_nop 0
    buffer_load_dwordx4 v16, s[12:15], s84 offen lds
    s_add_u32 s84, s84, 55296
    s_add_u32 m0, s85, 4096
    s_add_u32 s6, s86, 0
    buffer_load_dwordx4 v18, s[16:19], s6 offen lds
    s_add_u32 m0, s85, 5120
    s_add_u32 s6, s86, 10240
    buffer_load_dwordx4 v18, s[16:19], s6 offen lds
    s_add_u32 m0, s85, 6144
    s_add_u32 s6, s86, 20480
    buffer_load_dwordx4 v18, s[16:19], s6 offen lds
    s_add_u32 m0, s85, 7168
    s_add_u32 s6, s86, 30720
    buffer_load_dwordx4 v18, s[16:19], s6 offen lds
    s_add_u32 s86, s86, 512
    s_call_b64 s[82:83], L_load
    s_add_i32 s62, s62, 1
    v_cmp_le_i32 vcc, 0, v51
    s_cbranch_vccz L_idx_okm
    v_and_b32 v3, 7, v1
    v_lshlrev_b32 v3, 2, v3
    s_mov_b32 s72, 0x3a0000
    s_mov_b32 s79, 262144
L_poll_41:
    buffer_load_dword v51, v3, s[8:11], s72 offen sc1
    s_waitcnt vmcnt(0)
    v_cmp_le_i32 vcc, 0, v51
    s_cbranch_vccz L_polldone_42
    s_sleep 2
    s_sub_u32 s79, s79, 1
    s_cmp_lg_u32 s79, 0
    s_cbranch_scc1 L_poll_41
L_polldone_42:
L_idx_okm:
    buffer_load_dwordx4 v[64:67], v13, s[8:11], s88 offen sc1
    s_add_u32 s88, s88, 1024
    buffer_load_dwordx4 v[68:71], v13, s[8:11], s88 offen sc1
    s_add_u32 s88, s88, 1024
    buffer_load_dwordx4 v[72:75], v13, s[8:11], s88 offen sc1
    s_add_u32 s88, s88, 1024
    buffer_load_dwordx4 v[76:79], v13, s[8:11], s88 offen sc1
    s_add_u32 s88, s88, 1024
    buffer_load_dwordx4 v[80:83], v13, s[8:11], s88 offen sc1
    s_add_u32 s88, s88, 1024
    buffer_load_dwordx4 v[84:87], v13, s[8:11], s88 offen sc1
    s_add_u32 s88, s88, 1024
    buffer_load_dwordx4 v[88:91], v13, s[8:11], s88 offen sc1
    s_add_u32 s88, s88, 1024
    buffer_load_dwordx4 v[92:95], v13, s[8:11], s88 offen sc1
    s_add_u32 s88, s88, 1024
    buffer_load_dwordx4 v[96:99], v13, s[8:11], s88 offen sc1
    s_add_u32 s88, s88, 1024
    buffer_load_dwordx4 v[100:103], v13, s[8:11], s88 offen sc1
    s_add_u32 s88, s88, 1024
    s_waitcnt vmcnt(10) lgkmcnt(0)
    s_call_b64 s[82:83], L_pend
    s_barrier
    ds_read_b64_tr_b16 v[168:169], v17 offset:0
    ds_read_b64_tr_b16 v[170:171], v17 offset:256
    ds_read_b64_tr_b16 v[172:173], v17 offset:32
    ds_read_b64_tr_b16 v[174:175], v17 offset:288
    ds_read_b64_tr_b16 v[176:177], v17 offset:2048
    ds_read_b64_tr_b16 v[178:179], v17 offset:2304
    ds_read_b64_tr_b16 v[180:181], v17 offset:2080
    ds_read_b64_tr_b16 v[182:183], v17 offset:2336
    s_waitcnt lgkmcnt(0)
    ds_read_b64_tr_b16 v[32:33], v19 offset:0
    ds_read_b64_tr_b16 v[34:35], v19 offset:2048
    ds_read_b64_tr_b16 v[36:37], v19 offset:32
    ds_read_b64_tr_b16 v[38:39], v19 offset:2080
    ds_read_b64_tr_b16 v[40:41], v19 offset:64
    ds_read_b64_tr_b16 v[42:43], v19 offset:2112
    ds_read_b64_tr_b16 v[44:45], v19 offset:96
    ds_read_b64_tr_b16 v[46:47], v19 offset:2144
    s_waitcnt lgkmcnt(0)
    s_add_u32 m0, s85, 4096
    s_add_u32 s6, s86, 0
    buffer_load_dwordx4 v18, s[16:19], s6 offen lds
    s_add_u32 m0, s85, 5120
    s_add_u32 s6, s86, 10240
    buffer_load_dwordx4 v18, s[16:19], s6 offen lds
    s_add_u32 m0, s85, 6144
    s_add_u32 s6, s86, 20480
    buffer_load_dwordx4 v18, s[16:19], s6 offen lds
    s_add_u32 m0, s85, 7168
    s_add_u32 s6, s86, 30720
    buffer_load_dwordx4 v18, s[16:19], s6 offen lds
    s_add_u32 s86, s86, 512
    s_call_b64 s[82:83], L_load
    s_add_i32 s62, s62, 1
    s_waitcnt vmcnt(20)
    v_mfma_f32_16x16x32_bf16 v[24:27], v[104:107], v[64:67], 0
    v_mfma_f32_16x16x32_bf16 v[28:31], v[108:111], v[64:67], 0
    v_mfma_f32_16x16x32_bf16 v[24:27], v[112:115], v[68:71], v[24:27]
    v_mfma_f32_16x16x32_bf16 v[28:31], v[116:119], v[68:71], v[28:31]
    v_mfma_f32_16x16x32_bf16 v[24:27], v[120:123], v[72:75], v[24:27]
    v_mfma_f32_16x16x32_bf16 v[28:31], v[124:127], v[72:75], v[28:31]
    v_mfma_f32_16x16x32_bf16 v[24:27], v[128:131], v[76:79], v[24:27]
    v_mfma_f32_16x16x32_bf16 v[28:31], v[132:135], v[76:79], v[28:31]
    v_mfma_f32_16x16x32_bf16 v[24:27], v[136:139], v[80:83], v[24:27]
    v_mfma_f32_16x16x32_bf16 v[28:31], v[140:143], v[80:83], v[28:31]
    v_mfma_f32_16x16x32_bf16 v[24:27], v[144:147], v[84:87], v[24:27]
    v_mfma_f32_16x16x32_bf16 v[28:31], v[148:151], v[84:87], v[28:31]
    v_mfma_f32_16x16x32_bf16 v[24:27], v[152:155], v[88:91], v[24:27]
    v_mfma_f32_16x16x32_bf16 v[28:31], v[156:159], v[88:91], v[28:31]
    v_mfma_f32_16x16x32_bf16 v[24:27], v[160:163], v[92:95], v[24:27]
    v_mfma_f32_16x16x32_bf16 v[28:31], v[164:167], v[92:95], v[28:31]
    v_mfma_f32_16x16x32_bf16 v[24:27], v[168:171], v[96:99], v[24:27]
    v_mfma_f32_16x16x32_bf16 v[28:31], v[172:175], v[96:99], v[28:31]
    v_mfma_f32_16x16x32_bf16 v[24:27], v[176:179], v[100:103], v[24:27]
    v_mfma_f32_16x16x32_bf16 v[28:31], v[180:183], v[100:103], v[28:31]
    v_add_u32 v10, s85, v13
    s_nop 7
    ds_write_b128 v10, v[24:27]
    ds_write_b128 v10, v[28:31] offset:1024
    s_waitcnt vmcnt(0) lgkmcnt(0)
    s_call_b64 s[82:83], L_pend
    s_barrier
    ds_read_b64_tr_b16 v[240:241], v19 offset:0
    ds_read_b64_tr_b16 v[242:243], v19 offset:2048
    ds_read_b64_tr_b16 v[244:245], v19 offset:32
    ds_read_b64_tr_b16 v[246:247], v19 offset:2080
    ds_read_b64_tr_b16 v[248:249], v19 offset:64
    ds_read_b64_tr_b16 v[250:251], v19 offset:2112
    ds_read_b64_tr_b16 v[252:253], v19 offset:96
    ds_read_b64_tr_b16 v[254:255], v19 offset:2144
    v_add_u32 v10, 131072, v13
    s_waitcnt lgkmcnt(0)
    ds_read_b128 v[184:187], v10 offset:0
    ds_read_b128 v[188:191], v10 offset:1024
    ds_read_b128 v[192:195], v10 offset:8192
    ds_read_b128 v[196:199], v10 offset:9216
    ds_read_b128 v[200:203], v10 offset:16384
    ds_read_b128 v[204:207], v10 offset:17408
    ds_read_b128 v[208:211], v10 offset:24576
    ds_read_b128 v[212:215], v10 offset:25600
    s_cmp_ge_u32 s3, 2
    s_cbranch_scc1 L_moe4b
    s_add_u32 m0, s85, 4096
    s_add_u32 s6, s86, 0
    buffer_load_dwordx4 v18, s[16:19], s6 offen lds
    s_add_u32 m0, s85, 5120
    s_add_u32 s6, s86, 10240
    buffer_load_dwordx4 v18, s[16:19], s6 offen lds
    s_add_u32 m0, s85, 6144
    s_add_u32 s6, s86, 20480
    buffer_load_dwordx4 v18, s[16:19], s6 offen lds
    s_add_u32 m0, s85, 7168
    s_add_u32 s6, s86, 30720
    buffer_load_dwordx4 v18, s[16:19], s6 offen lds
    s_add_u32 s86, s86, 512
L_moe4b:
    s_call_b64 s[82:83], L_load
    s_add_i32 s62, s62, 1
    s_waitcnt lgkmcnt(0)
    s_mov_b32 s6, 0xbfb8aa3b
    v_add_f32 v184, v184, v192
    v_add_f32 v200, v200, v208
    v_add_f32 v185, v185, v193
    v_add_f32 v201, v201, v209
    v_cvt_pk_bf16_f32 v185, v184, v185
    v_lshlrev_b32 v184, 16, v185
    v_and_b32 v185, 0xffff0000, v185
    v_cvt_pk_bf16_f32 v201, v200, v201
    v_lshlrev_b32 v200, 16, v201
    v_and_b32 v201, 0xffff0000, v201
    v_mul_f32 v2, s6, v184
    v_mul_f32 v3, s6, v185
    v_exp_f32 v2, v2
    v_exp_f32 v3, v3
    s_nop 0
    v_add_f32 v2, 1.0, v2
    v_add_f32 v3, 1.0, v3
    v_rcp_f32 v2, v2
    v_rcp_f32 v3, v3
    s_nop 0
    v_mul_f32 v184, v184, v2
    v_mul_f32 v185, v185, v3
    v_cvt_pk_bf16_f32 v185, v184, v185
    v_lshlrev_b32 v184, 16, v185
    v_and_b32 v185, 0xffff0000, v185
    v_mul_f32 v184, v184, v200
    v_mul_f32 v185, v185, v201
    v_cvt_pk_bf16_f32 v24, v184, v185
    v_add_f32 v186, v186, v194
    v_add_f32 v202, v202, v210
    v_add_f32 v187, v187, v195
    v_add_f32 v203, v203, v211
    v_cvt_pk_bf16_f32 v187, v186, v187
    v_lshlrev_b32 v186, 16, v187
    v_and_b32 v187, 0xffff0000, v187
    v_cvt_pk_bf16_f32 v203, v202, v203
    v_lshlrev_b32 v202, 16, v203
    v_and_b32 v203, 0xffff0000, v203
    v_mul_f32 v2, s6, v186
    v_mul_f32 v3, s6, v187
    v_exp_f32 v2, v2
    v_exp_f32 v3, v3
    s_nop 0
    v_add_f32 v2, 1.0, v2
    v_add_f32 v3, 1.0, v3
    v_rcp_f32 v2, v2
    v_rcp_f32 v3, v3
    s_nop 0
    v_mul_f32 v186, v186, v2
    v_mul_f32 v187, v187, v3
    v_cvt_pk_bf16_f32 v187, v186, v187
    v_lshlrev_b32 v186, 16, v187
    v_and_b32 v187, 0xffff0000, v187
    v_mul_f32 v186, v186, v202
    v_mul_f32 v187, v187, v203
    v_cvt_pk_bf16_f32 v25, v186, v187
    v_add_f32 v188, v188, v196
    v_add_f32 v204, v204, v212
    v_add_f32 v189, v189, v197
    v_add_f32 v205, v205, v213
    v_cvt_pk_bf16_f32 v189, v188, v189
    v_lshlrev_b32 v188, 16, v189
    v_and_b32 v189, 0xffff0000, v189
    v_cvt_pk_bf16_f32 v205, v204, v205
    v_lshlrev_b32 v204, 16, v205
    v_and_b32 v205, 0xffff0000, v205
    v_mul_f32 v2, s6, v188
    v_mul_f32 v3, s6, v189
    v_exp_f32 v2, v2
    v_exp_f32 v3, v3
    s_nop 0
    v_add_f32 v2, 1.0, v2
    v_add_f32 v3, 1.0, v3
    v_rcp_f32 v2, v2
    v_rcp_f32 v3, v3
    s_nop 0
    v_mul_f32 v188, v188, v2
    v_mul_f32 v189, v189, v3
    v_cvt_pk_bf16_f32 v189, v188, v189
    v_lshlrev_b32 v188, 16, v189
    v_and_b32 v189, 0xffff0000, v189
    v_mul_f32 v188, v188, v204
    v_mul_f32 v189, v189, v205
    v_cvt_pk_bf16_f32 v26, v188, v189
    v_add_f32 v190, v190, v198
    v_add_f32 v206, v206, v214
    v_add_f32 v191, v191, v199
    v_add_f32 v207, v207, v215
    v_cvt_pk_bf16_f32 v191, v190, v191
    v_lshlrev_b32 v190, 16, v191
    v_and_b32 v191, 0xffff0000, v191
    v_cvt_pk_bf16_f32 v207, v206, v207
    v_lshlrev_b32 v206, 16, v207
    v_and_b32 v207, 0xffff0000, v207
    v_mul_f32 v2, s6, v190
    v_mul_f32 v3, s6, v191
    v_exp_f32 v2, v2
    v_exp_f32 v3, v3
    s_nop 0
    v_add_f32 v2, 1.0, v2
    v_add_f32 v3, 1.0, v3
    v_rcp_f32 v2, v2
    v_rcp_f32 v3, v3
    s_nop 0
    v_mul_f32 v190, v190, v2
    v_mul_f32 v191, v191, v3
    v_cvt_pk_bf16_f32 v191, v190, v191
    v_lshlrev_b32 v190, 16, v191
    v_and_b32 v191, 0xffff0000, v191
    v_mul_f32 v190, v190, v206
    v_mul_f32 v191, v191, v207
    v_cvt_pk_bf16_f32 v27, v190, v191
    s_nop 1
    v_mfma_f32_16x16x32_bf16 v[216:219], v[32:35], v[24:27], 0
    v_mfma_f32_16x16x32_bf16 v[220:223], v[36:39], v[24:27], 0
    v_mfma_f32_16x16x32_bf16 v[224:227], v[40:43], v[24:27], 0
    v_mfma_f32_16x16x32_bf16 v[228:231], v[44:47], v[24:27], 0
    s_nop 7
    buffer_store_dwordx4 v[216:219], v20, s[8:11], s87 offen offset:0 sc1
    buffer_store_dwordx4 v[220:223], v20, s[8:11], s87 offen offset:64 sc1
    buffer_store_dwordx4 v[224:227], v20, s[8:11], s87 offen offset:128 sc1
    buffer_store_dwordx4 v[228:231], v20, s[8:11], s87 offen offset:192 sc1
    s_nop 1
    s_waitcnt vmcnt(4) lgkmcnt(0)
    s_call_b64 s[82:83], L_pend
    s_barrier
    s_call_b64 s[82:83], L_load
    s_add_i32 s62, s62, 1
    v_mfma_f32_16x16x32_bf16 v[216:219], v[240:243], v[24:27], 0
    v_mfma_f32_16x16x32_bf16 v[220:223], v[244:247], v[24:27], 0
    v_mfma_f32_16x16x32_bf16 v[224:227], v[248:251], v[24:27], 0
    v_mfma_f32_16x16x32_bf16 v[228:231], v[252:255], v[24:27], 0
    s_nop 7
    buffer_store_dwordx4 v[216:219], v20, s[8:11], s87 offen offset:1024 sc1
    buffer_store_dwordx4 v[220:223], v20, s[8:11], s87 offen offset:1088 sc1
    buffer_store_dwordx4 v[224:227], v20, s[8:11], s87 offen offset:1152 sc1
    buffer_store_dwordx4 v[228:231], v20, s[8:11], s87 offen offset:1216 sc1
    s_nop 1
    s_cmp_ge_u32 s3, 2
    s_cbranch_scc1 L_moe5b
    ds_read_b64_tr_b16 v[32:33], v19 offset:0
    ds_read_b64_tr_b16 v[34:35], v19 offset:2048
    ds_read_b64_tr_b16 v[36:37], v19 offset:32
    ds_read_b64_tr_b16 v[38:39], v19 offset:2080
    ds_read_b64_tr_b16 v[40:41], v19 offset:64
    ds_read_b64_tr_b16 v[42:43], v19 offset:2112
    ds_read_b64_tr_b16 v[44:45], v19 offset:96
    ds_read_b64_tr_b16 v[46:47], v19 offset:2144
    s_waitcnt lgkmcnt(0)
    v_mfma_f32_16x16x32_bf16 v[216:219], v[32:35], v[24:27], 0
    v_mfma_f32_16x16x32_bf16 v[220:223], v[36:39], v[24:27], 0
    v_mfma_f32_16x16x32_bf16 v[224:227], v[40:43], v[24:27], 0
    v_mfma_f32_16x16x32_bf16 v[228:231], v[44:47], v[24:27], 0
    s_nop 7
    buffer_store_dwordx4 v[216:219], v20, s[8:11], s87 offen offset:2048 sc1
    buffer_store_dwordx4 v[220:223], v20, s[8:11], s87 offen offset:2112 sc1
    buffer_store_dwordx4 v[224:227], v20, s[8:11], s87 offen offset:2176 sc1
    buffer_store_dwordx4 v[228:231], v20, s[8:11], s87 offen offset:2240 sc1
    s_nop 1
L_moe5b:
    s_waitcnt vmcnt(4) lgkmcnt(0)
    s_call_b64 s[82:83], L_pend
    s_barrier
    s_waitcnt vmcnt(0)
    s_lshl_b32 s6, s61, 5
    s_add_u32 s6, s6, s3
    s_lshl_b32 s6, s6, 2
    s_add_u32 s6, s6, 15859712
    v_mov_b32 v2, 1
    v_mov_b32 v3, 0x5000000
    v_writelane_b32 v3, s6, 0
    buffer_store_dword v2, v3, s[8:11], 0 offen sc1
    s_call_b64 s[82:83], L_load
    s_add_i32 s62, s62, 1
    s_branch L_idle
L_top:
    s_mov_b32 s6, 0x280000
    v_lshrrev_b32 v2, 1, v1
    v_and_b32 v3, 1, v1
    v_lshlrev_b32 v3, 4, v3
    v_lshl_add_u32 v2, v2, 7, v3
    buffer_load_dwordx4 v[64:67], v2, s[8:11], s6 offen sc1
    s_add_u32 s6, s6, 4096
    buffer_load_dwordx4 v[68:71], v2, s[8:11], s6 offen sc1
    s_add_u32 s6, s6, 4096
    buffer_load_dwordx4 v[72:75], v2, s[8:11], s6 offen sc1
    s_add_u32 s6, s6, 4096
    buffer_load_dwordx4 v[76:79], v2, s[8:11], s6 offen sc1
    s_add_u32 s6, s6, 4096
    buffer_load_dwordx4 v[80:83], v2, s[8:11], s6 offen sc1
    s_add_u32 s6, s6, 4096
    buffer_load_dwordx4 v[84:87], v2, s[8:11], s6 offen sc1
    s_add_u32 s6, s6, 4096
    buffer_load_dwordx4 v[88:91], v2, s[8:11], s6 offen sc1
    s_add_u32 s6, s6, 4096
    buffer_load_dwordx4 v[92:95], v2, s[8:11], s6 offen sc1
    s_add_u32 s6, s6, 4096
    s_waitcnt vmcnt(0)
    v_mov_b32 v24, 0
    s_mov_b32 s7, 0
    s_mov_b32 s84, 0
L_top_l:
    v_max3_u32 v4, v64, v65, v66
    v_max3_u32 v5, v67, v68, v69
    v_max3_u32 v4, v4, v70, v71
    v_max3_u32 v5, v5, v72, v73
    v_max3_u32 v4, v4, v74, v75
    v_max3_u32 v5, v5, v76, v77
    v_max3_u32 v4, v4, v78, v79
    v_max3_u32 v5, v5, v80, v81
    v_max3_u32 v4, v4, v82, v83
    v_max3_u32 v5, v5, v84, v85
    v_max3_u32 v4, v4, v86, v87
    v_max3_u32 v5, v5, v88, v89
    v_max3_u32 v4, v4, v90, v91
    v_max3_u32 v5, v5, v92, v93
    v_max3_u32 v4, v4, v94, v95
    v_max_u32 v4, v4, v5
    s_nop 1
    v_max_u32_dpp v4, v4, v4 quad_perm:[1,0,3,2] row_mask:0xf bank_mask:0xf
    s_nop 1
    v_max_u32_dpp v4, v4, v4 quad_perm:[2,3,0,1] row_mask:0xf bank_mask:0xf
    s_nop 1
    v_max_u32_dpp v4, v4, v4 row_half_mirror row_mask:0xf bank_mask:0xf
    s_nop 1
    v_max_u32_dpp v4, v4, v4 row_mirror row_mask:0xf bank_mask:0xf
    s_nop 1
    v_max_u32_dpp v4, v4, v4 row_bcast:15 row_mask:0xa bank_mask:0xf
    s_nop 1
    v_max_u32_dpp v4, v4, v4 row_bcast:31 row_mask:0xc bank_mask:0xf
    s_nop 1
    v_readlane_b32 s6, v4, 63
    s_mov_b32 m0, s7
    s_nop 3
    s_add_u32 s84, s84, s6
    v_writelane_b32 v24, s84, m0
    v_subrev_u32 v64, s6, v64
    v_subrev_u32 v65, s6, v65
    v_subrev_u32 v66, s6, v66
    v_subrev_u32 v67, s6, v67
    v_subrev_u32 v68, s6, v68
    v_subrev_u32 v69, s6, v69
    v_subrev_u32 v70, s6, v70
    v_subrev_u32 v71, s6, v71
    v_subrev_u32 v72, s6, v72
    v_subrev_u32 v73, s6, v73
    v_subrev_u32 v74, s6, v74
    v_subrev_u32 v75, s6, v75
    v_subrev_u32 v76, s6, v76
    v_subrev_u32 v77, s6, v77
    v_subrev_u32 v78, s6, v78
    v_subrev_u32 v79, s6, v79
    v_subrev_u32 v80, s6, v80
    v_subrev_u32 v81, s6, v81
    v_subrev_u32 v82, s6, v82
    v_subrev_u32 v83, s6, v83
    v_subrev_u32 v84, s6, v84
    v_subrev_u32 v85, s6, v85
    v_subrev_u32 v86, s6, v86
    v_subrev_u32 v87, s6, v87
    v_subrev_u32 v88, s6, v88
    v_subrev_u32 v89, s6, v89
    v_subrev_u32 v90, s6, v90
    v_subrev_u32 v91, s6, v91
    v_subrev_u32 v92, s6, v92
    v_subrev_u32 v93, s6, v93
    v_subrev_u32 v94, s6, v94
    v_subrev_u32 v95, s6, v95
    s_add_u32 s7, s7, 1
    s_cmp_lt_u32 s7, 8
    s_cbranch_scc1 L_top_l
    v_and_b32 v2, 7, v1
    v_lshlrev_b32 v2, 2, v2
    ds_bpermute_b32 v4, v2, v24
    s_waitcnt lgkmcnt(0)
    v_and_b32 v4, 0x7ff, v4
    v_sub_u32 v4, 0x7ff, v4
    v_lshrrev_b32 v5, 4, v4
    v_mul_u32_u24 v5, 20480, v5
    v_and_b32 v4, 15, v4
    v_lshl_add_u32 v5, v4, 4, v5
    v_lshrrev_b32 v7, 4, v1
    v_lshl_add_u32 v5, v7, 8, v5
    v_mov_b32 v6, 0x5000000
    v_and_b32 v2, 8, v1
    v_cmp_eq_u32 vcc, 0, v2
    s_mov_b32 s6, 0
    s_nop 0
    v_cndmask_b32 v5, v6, v5, vcc
    buffer_load_dwordx4 v[64:67], v5, s[8:11], s6 offen offset:0 sc1
    buffer_load_dwordx4 v[68:71], v5, s[8:11], s6 offen offset:1024 sc1
    buffer_load_dwordx4 v[72:75], v5, s[8:11], s6 offen offset:2048 sc1
    buffer_load_dwordx4 v[76:79], v5, s[8:11], s6 offen offset:3072 sc1
    s_add_u32 s6, s6, 4096
    buffer_load_dwordx4 v[80:83], v5, s[8:11], s6 offen offset:0 sc1
    buffer_load_dwordx4 v[84:87], v5, s[8:11], s6 offen offset:1024 sc1
    buffer_load_dwordx4 v[88:91], v5, s[8:11], s6 offen offset:2048 sc1
    buffer_load_dwordx4 v[92:95], v5, s[8:11], s6 offen offset:3072 sc1
    s_add_u32 s6, s6, 4096
    buffer_load_dwordx4 v[96:99], v5, s[8:11], s6 offen offset:0 sc1
    buffer_load_dwordx4 v[100:103], v5, s[8:11], s6 offen offset:1024 sc1
    buffer_load_dwordx4 v[104:107], v5, s[8:11], s6 offen offset:2048 sc1
    buffer_load_dwordx4 v[108:111], v5, s[8:11], s6 offen offset:3072 sc1
    s_add_u32 s6, s6, 4096
    buffer_load_dwordx4 v[112:115], v5, s[8:11], s6 offen offset:0 sc1
    buffer_load_dwordx4 v[116:119], v5, s[8:11], s6 offen offset:1024 sc1
    buffer_load_dwordx4 v[120:123], v5, s[8:11], s6 offen offset:2048 sc1
    buffer_load_dwordx4 v[124:127], v5, s[8:11], s6 offen offset:3072 sc1
    s_add_u32 s6, s6, 4096
    buffer_load_dwordx4 v[128:131], v5, s[8:11], s6 offen offset:0 sc1
    buffer_load_dwordx4 v[132:135], v5, s[8:11], s6 offen offset:1024 sc1
    buffer_load_dwordx4 v[136:139], v5, s[8:11], s6 offen offset:2048 sc1
    buffer_load_dwordx4 v[140:143], v5, s[8:11], s6 offen offset:3072 sc1
    s_waitcnt vmcnt(20)
    s_call_b64 s[82:83], L_pend
    s_barrier
    s_waitcnt vmcnt(0)
    s_mov_b32 s6, 0xc00000
    buffer_store_dwordx4 v[64:67], v13, s[8:11], s6 offen offset:0 sc1
    buffer_store_dwordx4 v[68:71], v13, s[8:11], s6 offen offset:1024 sc1
    buffer_store_dwordx4 v[72:75], v13, s[8:11], s6 offen offset:2048 sc1
    buffer_store_dwordx4 v[76:79], v13, s[8:11], s6 offen offset:3072 sc1
    s_add_u32 s6, s6, 4096
    buffer_store_dwordx4 v[80:83], v13, s[8:11], s6 offen offset:0 sc1
    buffer_store_dwordx4 v[84:87], v13, s[8:11], s6 offen offset:1024 sc1
    buffer_store_dwordx4 v[88:91], v13, s[8:11], s6 offen offset:2048 sc1
    buffer_store_dwordx4 v[92:95], v13, s[8:11], s6 offen offset:3072 sc1
    s_add_u32 s6, s6, 4096
    buffer_store_dwordx4 v[96:99], v13, s[8:11], s6 offen offset:0 sc1
    buffer_store_dwordx4 v[100:103], v13, s[8:11], s6 offen offset:1024 sc1
    buffer_store_dwordx4 v[104:107], v13, s[8:11], s6 offen offset:2048 sc1
    buffer_store_dwordx4 v[108:111], v13, s[8:11], s6 offen offset:3072 sc1
    s_add_u32 s6, s6, 4096
    buffer_store_dwordx4 v[112:115], v13, s[8:11], s6 offen offset:0 sc1
    buffer_store_dwordx4 v[116:119], v13, s[8:11], s6 offen offset:1024 sc1
    buffer_store_dwordx4 v[120:123], v13, s[8:11], s6 offen offset:2048 sc1
    buffer_store_dwordx4 v[124:127], v13, s[8:11], s6 offen offset:3072 sc1
    s_add_u32 s6, s6, 4096
    buffer_store_dwordx4 v[128:131], v13, s[8:11], s6 offen offset:0 sc1
    buffer_store_dwordx4 v[132:135], v13, s[8:11], s6 offen offset:1024 sc1
    buffer_store_dwordx4 v[136:139], v13, s[8:11], s6 offen offset:2048 sc1
    buffer_store_dwordx4 v[140:143], v13, s[8:11], s6 offen offset:3072 sc1
    s_call_b64 s[82:83], L_load
    s_add_i32 s62, s62, 1
    s_waitcnt vmcnt(16)
    v_or_b32 v24, 0x80000000, v24
    v_lshlrev_b32 v5, 2, v1
    v_mov_b32 v6, 0x5000000
    v_cmp_gt_u32 vcc, 8, v1
    s_mov_b32 s6, 0x3a0000
    s_nop 0
    v_cndmask_b32 v5, v6, v5, vcc
    buffer_store_dword v24, v5, s[8:11], s6 offen sc1
    s_branch L_idle
L_back_9_h:
    v_cmp_ne_u32 vcc, 0, v62
    s_cbranch_vccz L_back_9_n
    s_call_b64 s[80:81], L_rare0
L_back_9_n:
    s_branch L_back_9
L_back_10_h:
    v_cmp_ne_u32 vcc, 0, v62
    s_cbranch_vccz L_back_10_n
    s_call_b64 s[80:81], L_rare1
    v_exp_f32 v58, v64
    v_exp_f32 v59, v65
L_back_10_n:
    s_cmp_lt_i32 s64, 0
    s_cbranch_scc1 L_tail1
    s_cmp_gt_i32 s64, 0
    s_cbranch_scc1 L_back_10
    s_call_b64 s[82:83], L_mask
    s_branch L_back_10
L_back_11_h:
    v_cmp_ne_u32 vcc, 0, v62
    s_cbranch_vccz L_back_11_n
    s_call_b64 s[80:81], L_rare0
    v_exp_f32 v58, v80
    v_exp_f32 v59, v81
L_back_11_n:
    s_cmp_lt_i32 s64, 0
    s_cbranch_scc1 L_tail2
    s_cmp_gt_i32 s64, 0
    s_cbranch_scc1 L_back_11
    s_call_b64 s[82:83], L_mask
    s_branch L_back_11
L_back_12_h:
    v_cmp_ne_u32 vcc, 0, v62
    s_cbranch_vccz L_back_12_n
    s_call_b64 s[80:81], L_rare1
    v_exp_f32 v58, v64
    v_exp_f32 v59, v65
L_back_12_n:
    s_cmp_lt_i32 s64, 0
    s_cbranch_scc1 L_tail3
    s_cmp_gt_i32 s64, 0
    s_cbranch_scc1 L_back_12
    s_call_b64 s[82:83], L_mask
    s_branch L_back_12
L_ldback_13_c:
    s_waitcnt vmcnt(0) lgkmcnt(0)
    s_call_b64 s[82:83], L_pend
    s_barrier
    s_call_b64 s[82:83], L_load
    s_branch L_ldback_13
L_back_14_h:
    v_cmp_ne_u32 vcc, 0, v62
    s_cbranch_vccz L_back_14_n
    s_call_b64 s[80:81], L_rare0
    v_exp_f32 v58, v80
    v_exp_f32 v59, v81
L_back_14_n:
    s_cmp_lt_i32 s64, 0
    s_cbranch_scc1 L_tail0
    s_cmp_gt_i32 s64, 0
    s_cbranch_scc1 L_st0
    s_call_b64 s[82:83], L_mask
    s_branch L_st0
L_back_15_h:
    v_cmp_ne_u32 vcc, 0, v62
    s_cbranch_vccz L_back_15_n
    s_call_b64 s[80:81], L_rare1
L_back_15_n:
    s_branch L_back_15
L_back_16_h:
    v_cmp_ne_u32 vcc, 0, v62
    s_cbranch_vccz L_back_16_n
    s_call_b64 s[80:81], L_rare0
L_back_16_n:
    s_branch L_back_16
L_back_17_h:
    v_cmp_ne_u32 vcc, 0, v62
    s_cbranch_vccz L_back_17_n
    s_call_b64 s[80:81], L_rare1
L_back_17_n:
    s_branch L_back_17
L_back_20_h:
    v_cmp_ne_u32 vcc, 0, v62
    s_cbranch_vccz L_back_20_n
    s_call_b64 s[80:81], L_rare0
L_back_20_n:
    s_branch L_back_20
L_load:
    s_bitcmp1_b32 s89, 0
    s_cbranch_scc0 L_load_r
    s_add_u32 s77, s77, 32768
    s_xor_b32 s78, s78, 0x10000
    s_add_i32 s73, s62, 1
    s_cmp_gt_i32 s73, s63
    s_cbranch_scc1 L_load_r
    s_cmp_eq_i32 s73, s63
    s_cbranch_scc1 L_load_v
    s_cmp_lg_i32 s73, 3
    s_cbranch_scc1 L_load_k
    v_cmp_gt_u32 vcc, 2, v12
    s_cbranch_vccz L_load_k
    s_lshl_b32 s7, s4, 10
    s_add_u32 s7, s7, 3866624
    v_lshrrev_b32 v2, 3, v1
    v_and_b32 v3, 7, v1
    v_lshlrev_b32 v3, 2, v3
    v_lshl_add_u32 v3, v2, 7, v3
    s_mov_b32 s79, 262144
L_poll_48:
    buffer_load_dword v2, v3, s[8:11], s7 offen sc1
    s_waitcnt vmcnt(0)
    v_cmp_gt_u32 vcc, 2, v2
    s_cbranch_vccz L_polldone_49
    s_sleep 2
    s_sub_u32 s79, s79, 1
    s_cmp_lg_u32 s79, 0
    s_cbranch_scc1 L_poll_48
L_polldone_49:
L_load_k:
    s_lshl_b32 s6, s76, 13
    s_add_u32 s6, s6, s78
    s_add_u32 m0, s6, 0
    s_add_u32 s7, s77, 0
    buffer_load_dwordx4 v49, s[8:11], s7 offen offset:0 sc1 lds
    buffer_load_dwordx4 v49, s[8:11], s7 offen offset:1024 sc1 lds
    buffer_load_dwordx4 v49, s[8:11], s7 offen offset:2048 sc1 lds
    buffer_load_dwordx4 v49, s[8:11], s7 offen offset:3072 sc1 lds
    s_lshl_b32 s6, s76, 13
    s_add_u32 s6, s6, s78
    s_add_u32 m0, s6, 4096
    s_add_u32 s7, s77, 4096
    buffer_load_dwordx4 v49, s[8:11], s7 offen offset:0 sc1 lds
    buffer_load_dwordx4 v49, s[8:11], s7 offen offset:1024 sc1 lds
    buffer_load_dwordx4 v49, s[8:11], s7 offen offset:2048 sc1 lds
    buffer_load_dwordx4 v49, s[8:11], s7 offen offset:3072 sc1 lds
    s_lshl_b32 s6, s76, 12
    s_add_u32 s6, s6, s78
    s_add_u32 m0, s6, 49152
    s_add_u32 s7, s77, 524288
    buffer_load_dwordx4 v50, s[8:11], s7 offen offset:0 sc1 lds
    buffer_load_dwordx4 v50, s[8:11], s7 offen offset:1024 sc1 lds
    buffer_load_dwordx4 v50, s[8:11], s7 offen offset:2048 sc1 lds
    buffer_load_dwordx4 v50, s[8:11], s7 offen offset:3072 sc1 lds
L_load_v:
    s_lshl_b32 s6, s76, 12
    s_add_u32 s6, s6, s78
    s_add_u32 m0, s6, 32768
    s_add_u32 s7, s77, 507904
    buffer_load_dwordx4 v50, s[8:11], s7 offen offset:0 sc1 lds
    buffer_load_dwordx4 v50, s[8:11], s7 offen offset:1024 sc1 lds
    buffer_load_dwordx4 v50, s[8:11], s7 offen offset:2048 sc1 lds
    buffer_load_dwordx4 v50, s[8:11], s7 offen offset:3072 sc1 lds
    s_cmp_eq_i32 s73, s63
    s_cbranch_scc1 L_xa
    s_cmp_lg_i32 s73, 2
    s_cbranch_scc1 L_nolook
    s_lshl_b32 s7, s4, 10
    s_add_u32 s7, s7, 3866624
    v_lshrrev_b32 v2, 3, v1
    v_and_b32 v3, 7, v1
    v_lshlrev_b32 v3, 2, v3
    v_lshl_add_u32 v3, v2, 7, v3
    buffer_load_dword v12, v3, s[8:11], s7 offen sc1
L_nolook:
    s_cmp_lt_u32 s5, 4
    s_cbranch_scc1 L_load_r
    s_sub_i32 s6, s62, 0
    s_cmp_gt_u32 s6, 4
    s_cbranch_scc1 L_wb
    s_cbranch_scc0 L_wsel
L_wb:
    s_sub_i32 s79, s73, 1
    s_cmp_lt_u32 s79, 2
    s_cbranch_scc1 L_x3
L_load_r:
    s_setpc_b64 s[82:83]
L_pend:
    s_bitcmp1_b32 s89, 1
    s_cbranch_scc0 L_load_a
    s_cmp_lt_i32 s62, 0
    s_cbranch_scc1 L_load_a
    s_lshl_b32 s6, s4, 3
    s_add_u32 s6, s6, s5
    s_lshl_b32 s6, s6, 5
    s_add_u32 s6, s6, s3
    s_lshl_b32 s6, s6, 2
    s_add_u32 s6, s6, 3866624
    v_mov_b32 v2, 2
    v_mov_b32 v3, 0x5000000
    v_writelane_b32 v3, s6, 0
    buffer_store_dword v2, v3, s[8:11], 0 offen sc1
    s_and_b32 s89, s89, 1
L_load_a:
    s_setpc_b64 s[82:83]
L_wsel:
    s_lshr_b32 s7, s6, 1
    s_lshl_b32 s91, s2, 1
    s_add_u32 s91, s91, s7
    s_sub_u32 s91, s91, 256
    s_cmp_eq_u32 s6, 4
    s_cbranch_scc1 L_w2
    s_bitcmp1_b32 s6, 0
    s_cbranch_scc1 L_w1
L_w0:
    s_mov_b32 s28, s42
    s_mov_b32 s29, s43
    s_mov_b32 s30, 0x500000
    s_mov_b32 s31, 0x20000
    s_lshr_b32 s75, s91, 1
    s_mul_i32 s75, s75, 40960
    s_and_b32 s6, s91, 1
    s_mul_i32 s6, s6, 640
    s_add_u32 s75, s75, s6
    s_movk_i32 s7, 1639
    s_mul_i32 s74, s76, 5120
    s_add_u32 s74, s74, 141312
    s_mul_i32 s6, s76, 320
    v_add_u32 v9, s6, v1
    v_add_u32 v2, 0, v9
    v_mul_lo_u32 v3, v2, s7
    v_lshrrev_b32 v3, 16, v3
    v_mul_u32_u24 v4, 40, v3
    v_sub_u32 v4, v2, v4
    v_mul_u32_u24 v3, 1280, v3
    v_lshl_add_u32 v3, v4, 4, v3
    s_add_u32 m0, s74, 0
    s_nop 0
    buffer_load_dwordx4 v3, s[28:31], s75 offen nt lds
    v_add_u32 v2, 64, v9
    v_mul_lo_u32 v3, v2, s7
    v_lshrrev_b32 v3, 16, v3
    v_mul_u32_u24 v4, 40, v3
    v_sub_u32 v4, v2, v4
    v_mul_u32_u24 v3, 1280, v3
    v_lshl_add_u32 v3, v4, 4, v3
    s_add_u32 m0, s74, 1024
    s_nop 0
    buffer_load_dwordx4 v3, s[28:31], s75 offen nt lds
    v_add_u32 v2, 128, v9
    v_mul_lo_u32 v3, v2, s7
    v_lshrrev_b32 v3, 16, v3
    v_mul_u32_u24 v4, 40, v3
    v_sub_u32 v4, v2, v4
    v_mul_u32_u24 v3, 1280, v3
    v_lshl_add_u32 v3, v4, 4, v3
    s_add_u32 m0, s74, 2048
    s_nop 0
    buffer_load_dwordx4 v3, s[28:31], s75 offen nt lds
    v_add_u32 v2, 192, v9
    v_mul_lo_u32 v3, v2, s7
    v_lshrrev_b32 v3, 16, v3
    v_mul_u32_u24 v4, 40, v3
    v_sub_u32 v4, v2, v4
    v_mul_u32_u24 v3, 1280, v3
    v_lshl_add_u32 v3, v4, 4, v3
    s_add_u32 m0, s74, 3072
    s_nop 0
    buffer_load_dwordx4 v3, s[28:31], s75 offen nt lds
    v_add_u32 v2, 256, v9
    v_mul_lo_u32 v3, v2, s7
    v_lshrrev_b32 v3, 16, v3
    v_mul_u32_u24 v4, 40, v3
    v_sub_u32 v4, v2, v4
    v_mul_u32_u24 v3, 1280, v3
    v_lshl_add_u32 v3, v4, 4, v3
    s_add_u32 m0, s74, 4096
    s_nop 0
    buffer_load_dwordx4 v3, s[28:31], s75 offen nt lds
    s_branch L_wb
L_w1:
    v_and_b32 v2, 15, v1
    v_lshrrev_b32 v3, 4, v1
    v_lshrrev_b32 v4, 2, v2
    v_lshl_add_u32 v4, v3, 2, v4
    v_mul_u32_u24 v4, 640, v4
    v_and_b32 v2, 3, v2
    v_lshl_add_u32 v4, v2, 3, v4
    s_mul_i32 s6, s76, 160
    s_add_u32 s6, s6, 141312
    v_add_u32 v4, s6, v4
    s_mul_i32 s6, s91, 20480
    s_mul_i32 s7, s76, 5120
    s_add_u32 s6, s6, s7
    s_add_u32 s6, s6, 4194304
    s_add_u32 s7, s6, 4096
    ds_read_b64_tr_b16 v[172:173], v4 offset:0
    ds_read_b64_tr_b16 v[174:175], v4 offset:10240
    ds_read_b64_tr_b16 v[176:177], v4 offset:32
    ds_read_b64_tr_b16 v[178:179], v4 offset:10272
    ds_read_b64_tr_b16 v[180:181], v4 offset:64
    ds_read_b64_tr_b16 v[182:183], v4 offset:10304
    ds_read_b64_tr_b16 v[184:185], v4 offset:96
    ds_read_b64_tr_b16 v[186:187], v4 offset:10336
    ds_read_b64_tr_b16 v[188:189], v4 offset:128
    ds_read_b64_tr_b16 v[190:191], v4 offset:10368
    s_waitcnt lgkmcnt(0)
    buffer_store_dwordx4 v[172:175], v13, s[8:11], s6 offen offset:0 sc1
    buffer_store_dwordx4 v[176:179], v13, s[8:11], s6 offen offset:1024 sc1
    buffer_store_dwordx4 v[180:183], v13, s[8:11], s6 offen offset:2048 sc1
    buffer_store_dwordx4 v[184:187], v13, s[8:11], s6 offen offset:3072 sc1
    buffer_store_dwordx4 v[188:191], v13, s[8:11], s7 offen offset:0 sc1
    s_branch L_wb
L_w2:
    s_cmp_lg_u32 s3, 0
    s_cbranch_scc1 L_wb
    s_mov_b32 s28, s56
    s_mov_b32 s29, s57
    s_mov_b32 s30, 0x100
    s_mov_b32 s31, 0x20000
    v_mov_b32 v2, 1
    v_lshlrev_b32 v3, 8, v1
    s_and_b32 s6, s2, 31
    s_lshl_b32 s6, s6, 2
    buffer_atomic_add v2, v3, s[28:31], s6 offen offset:128 sc1
    s_branch L_wb
L_xa:
    s_cmp_lg_u32 s90, 0
    s_cbranch_scc1 L_xa1
    s_mov_b32 s28, s56
    s_mov_b32 s29, s57
    s_mov_b32 s30, 0x100
    s_mov_b32 s31, 0x20000
    v_and_b32 v3, 31, v1
    v_lshlrev_b32 v3, 2, v3
    s_mov_b32 s79, 262144
L_poll_50:
    buffer_load_dword v2, v3, s[28:31], 0 offen offset:128 sc1
    s_waitcnt vmcnt(0)
    v_cmp_gt_u32 vcc, 4, v2
    s_cbranch_vccz L_polldone_51
    s_sleep 8
    s_sub_u32 s79, s79, 1
    s_cmp_lg_u32 s79, 0
    s_cbranch_scc1 L_poll_50
L_polldone_51:
L_xa1:
    s_getpc_b64 s[80:81]
L_pc2:
    s_sub_u32 s80, s80, L_pc2-L_fin
    s_subb_u32 s81, s81, 0
    s_and_b32 s6, s4, 1
    s_lshl_b32 s6, s6, 14
    v_lshl_add_u32 v3, v0, 6, s6
    v_min_u32 v3, L_exit-L_fin, v3
    global_load_dword v11, v3, s[80:81]
    s_lshr_b32 s74, s4, 3
    s_lshl_b32 s74, s74, 2
    s_add_u32 s74, s74, s76
    s_mul_i32 s74, s74, 327680
    s_and_b32 s7, s4, 3
    s_mul_i32 s7, s7, 10240
    s_add_u32 s74, s74, s7
    s_add_u32 s74, s74, 4199424
    s_add_u32 s6, s76, 0
    s_and_b32 s6, s6, 3
    s_lshl_b32 s6, s6, 10
    s_add_u32 s84, s6, s74
    s_add_u32 s6, s76, 1
    s_and_b32 s6, s6, 3
    s_lshl_b32 s6, s6, 10
    s_add_u32 s85, s6, s74
    s_add_u32 s6, s76, 2
    s_and_b32 s6, s6, 3
    s_lshl_b32 s6, s6, 10
    s_add_u32 s86, s6, s74
    s_add_u32 s6, s76, 3
    s_and_b32 s6, s6, 3
    s_lshl_b32 s6, s6, 10
    s_add_u32 s87, s6, s74
    s_add_u32 s88, s74, 4096
    s_lshl_b32 s73, s3, 13
    s_add_u32 s75, s73, s78
    s_add_u32 m0, s73, 131072
    s_add_u32 s7, s84, 0
    buffer_load_dwordx4 v13, s[8:11], s7 offen sc1 lds
    s_add_u32 m0, s73, 132096
    s_add_u32 s7, s85, 0
    buffer_load_dwordx4 v13, s[8:11], s7 offen sc1 lds
    s_add_u32 m0, s73, 133120
    s_add_u32 s7, s86, 0
    buffer_load_dwordx4 v13, s[8:11], s7 offen sc1 lds
    s_add_u32 m0, s73, 134144
    s_add_u32 s7, s87, 0
    buffer_load_dwordx4 v13, s[8:11], s7 offen sc1 lds
    s_add_u32 m0, s73, 135168
    s_add_u32 s7, s88, 0
    buffer_load_dwordx4 v13, s[8:11], s7 offen sc1 lds
    s_add_u32 m0, s73, 136192
    s_add_u32 s7, s84, 40960
    buffer_load_dwordx4 v13, s[8:11], s7 offen sc1 lds
    s_add_u32 m0, s73, 137216
    s_add_u32 s7, s85, 40960
    buffer_load_dwordx4 v13, s[8:11], s7 offen sc1 lds
    s_add_u32 m0, s73, 138240
    s_add_u32 s7, s86, 40960
    buffer_load_dwordx4 v13, s[8:11], s7 offen sc1 lds
    s_add_u32 m0, s75, 0
    s_add_u32 s7, s87, 40960
    buffer_load_dwordx4 v13, s[8:11], s7 offen sc1 lds
    s_add_u32 m0, s75, 1024
    s_add_u32 s7, s88, 40960
    buffer_load_dwordx4 v13, s[8:11], s7 offen sc1 lds
    s_add_u32 m0, s75, 2048
    s_add_u32 s7, s84, 81920
    buffer_load_dwordx4 v13, s[8:11], s7 offen sc1 lds
    s_add_u32 m0, s75, 3072
    s_add_u32 s7, s85, 81920
    buffer_load_dwordx4 v13, s[8:11], s7 offen sc1 lds
    s_add_u32 m0, s75, 4096
    s_add_u32 s7, s86, 81920
    buffer_load_dwordx4 v13, s[8:11], s7 offen sc1 lds
    s_add_u32 m0, s75, 5120
    s_add_u32 s7, s87, 81920
    buffer_load_dwordx4 v13, s[8:11], s7 offen sc1 lds
    s_add_u32 m0, s75, 6144
    s_add_u32 s7, s88, 81920
    buffer_load_dwordx4 v13, s[8:11], s7 offen sc1 lds
    s_add_u32 m0, s75, 7168
    s_add_u32 s7, s84, 122880
    buffer_load_dwordx4 v13, s[8:11], s7 offen sc1 lds
    s_lshl_b32 s75, s3, 12
    s_add_u32 s75, s75, s78
    s_add_u32 m0, s75, 49152
    s_add_u32 s7, s85, 122880
    buffer_load_dwordx4 v13, s[8:11], s7 offen sc1 lds
    s_add_u32 m0, s75, 50176
    s_add_u32 s7, s86, 122880
    buffer_load_dwordx4 v13, s[8:11], s7 offen sc1 lds
    s_add_u32 m0, s75, 51200
    s_add_u32 s7, s87, 122880
    buffer_load_dwordx4 v13, s[8:11], s7 offen sc1 lds
    s_add_u32 m0, s75, 52224
    s_add_u32 s7, s88, 122880
    buffer_load_dwordx4 v13, s[8:11], s7 offen sc1 lds
    s_setpc_b64 s[82:83]
L_x3:
    s_mov_b32 s12, s48
    s_mov_b32 s13, s49
    s_mov_b32 s14, 0x21c000
    s_mov_b32 s15, 0x20000
    s_cmp_eq_u32 s3, 3
    s_cbranch_scc1 L_load_r
    s_cmp_eq_u32 s3, 1
    s_cselect_b32 s12, s50, s12
    s_cselect_b32 s13, s51, s13
    s_cmp_eq_u32 s3, 2
    s_cselect_b32 s12, s52, s12
    s_cselect_b32 s13, s53, s13
    s_mov_b32 s73, 3456
    s_cmov_b32 s73, 256
    s_mov_b32 s75, 256
    s_cmov_b32 s75, 163840
    s_lshr_b32 s6, s2, 3
    s_sub_u32 s6, s6, 16
    s_mul_i32 s6, s6, 40
    v_lshrrev_b32 v2, 2, v1
    v_add_u32 v2, s6, v2
    v_mul_lo_u32 v2, v2, s73
    v_and_b32 v3, 3, v1
    v_lshl_add_u32 v2, v3, 6, v2
    s_xor_b32 s79, s79, 1
    s_lshl_b32 s6, s79, 3
    s_lshr_b32 s7, s4, 2
    s_add_u32 s6, s6, s7
    s_mul_i32 s6, s6, s75
    v_mov_b32 v3, 0x5000000
    v_cmp_gt_u32 vcc, 32, v1
    s_lshl_b32 s73, s73, 4
    s_nop 0
    v_cndmask_b32 v3, v3, v2, vcc
    buffer_load_dword v11, v2, s[12:15], s6 offen
    s_add_u32 s7, s6, s73
    buffer_load_dword v11, v2, s[12:15], s7 offen
    s_add_u32 s7, s7, s73
    buffer_load_dword v11, v3, s[12:15], s7 offen
    s_setpc_b64 s[82:83]
L_mask:
    v_and_b32 v2, 15, v1
    v_lshrrev_b32 v3, 4, v1
    v_lshlrev_b32 v3, 2, v3
    v_sub_u32 v2, v2, v3
    v_mov_b32 v3, 0xff800000
    v_cmp_gt_i32 vcc, 0, v2
    v_mov_b32 v152, v3
    s_nop 0
    v_cndmask_b32 v144, v144, v3, vcc
    v_cndmask_b32 v156, v156, v3, vcc
    v_cmp_gt_i32 vcc, 1, v2
    v_mov_b32 v153, v3
    s_nop 0
    v_cndmask_b32 v145, v145, v3, vcc
    v_cndmask_b32 v157, v157, v3, vcc
    v_cmp_gt_i32 vcc, 2, v2
    v_mov_b32 v154, v3
    s_nop 0
    v_cndmask_b32 v146, v146, v3, vcc
    v_cndmask_b32 v158, v158, v3, vcc
    v_cmp_gt_i32 vcc, 3, v2
    v_mov_b32 v155, v3
    s_nop 0
    v_cndmask_b32 v147, v147, v3, vcc
    v_cndmask_b32 v159, v159, v3, vcc
    s_nop 1
    s_setpc_b64 s[82:83]
L_rare0:
    s_nop 15
    v_max_f32 v62, v64, v65
    v_max3_f32 v62, v62, v66, v67
    v_max3_f32 v62, v62, v72, v73
    v_max3_f32 v62, v62, v74, v75
    v_mov_b32 v58, v62
    s_nop 1
    v_permlane16_swap_b32 v62, v58
    s_nop 1
    v_max_f32 v62, v62, v58
    v_mov_b32 v58, v62
    s_nop 1
    v_permlane32_swap_b32 v62, v58
    s_nop 1
    v_max_f32 v62, v62, v58
    v_add_f32 v62, 0x41c00000, v62
    v_max_f32 v62, 0, v62
    v_exp_f32 v58, -v62
    v_sub_f32 v64, v64, v62
    v_sub_f32 v80, v80, v62
    v_sub_f32 v144, v144, v62
    v_sub_f32 v65, v65, v62
    v_sub_f32 v81, v81, v62
    v_sub_f32 v145, v145, v62
    v_sub_f32 v66, v66, v62
    v_sub_f32 v82, v82, v62
    v_sub_f32 v146, v146, v62
    v_sub_f32 v67, v67, v62
    v_sub_f32 v83, v83, v62
    v_sub_f32 v147, v147, v62
    v_sub_f32 v72, v72, v62
    v_sub_f32 v88, v88, v62
    v_sub_f32 v152, v152, v62
    v_sub_f32 v73, v73, v62
    v_sub_f32 v89, v89, v62
    v_sub_f32 v153, v153, v62
    v_sub_f32 v74, v74, v62
    v_sub_f32 v90, v90, v62
    v_sub_f32 v154, v154, v62
    v_sub_f32 v75, v75, v62
    v_sub_f32 v91, v91, v62
    v_sub_f32 v155, v155, v62
    v_mul_f32 v160, v58, v160
    v_mul_f32 v161, v58, v161
    v_mul_f32 v162, v58, v162
    v_mul_f32 v163, v58, v163
    v_mul_f32 v192, v58, v192
    v_mul_f32 v193, v58, v193
    v_mul_f32 v194, v58, v194
    v_mul_f32 v195, v58, v195
    v_mul_f32 v200, v58, v200
    v_mul_f32 v201, v58, v201
    v_mul_f32 v202, v58, v202
    v_mul_f32 v203, v58, v203
    v_mul_f32 v208, v58, v208
    v_mul_f32 v209, v58, v209
    v_mul_f32 v210, v58, v210
    v_mul_f32 v211, v58, v211
    v_mul_f32 v216, v58, v216
    v_mul_f32 v217, v58, v217
    v_mul_f32 v218, v58, v218
    v_mul_f32 v219, v58, v219
    v_mul_f32 v224, v58, v224
    v_mul_f32 v225, v58, v225
    v_mul_f32 v226, v58, v226
    v_mul_f32 v227, v58, v227
    v_mul_f32 v232, v58, v232
    v_mul_f32 v233, v58, v233
    v_mul_f32 v234, v58, v234
    v_mul_f32 v235, v58, v235
    v_mul_f32 v240, v58, v240
    v_mul_f32 v241, v58, v241
    v_mul_f32 v242, v58, v242
    v_mul_f32 v243, v58, v243
    v_mul_f32 v248, v58, v248
    v_mul_f32 v249, v58, v249
    v_mul_f32 v250, v58, v250
    v_mul_f32 v251, v58, v251
    v_max_f32 v62, v68, v69
    v_max3_f32 v62, v62, v70, v71
    v_max3_f32 v62, v62, v76, v77
    v_max3_f32 v62, v62, v78, v79
    v_mov_b32 v58, v62
    s_nop 1
    v_permlane16_swap_b32 v62, v58
    s_nop 1
    v_max_f32 v62, v62, v58
    v_mov_b32 v58, v62
    s_nop 1
    v_permlane32_swap_b32 v62, v58
    s_nop 1
    v_max_f32 v62, v62, v58
    v_add_f32 v62, 0x41c00000, v62
    v_max_f32 v62, 0, v62
    v_exp_f32 v58, -v62
    v_sub_f32 v68, v68, v62
    v_sub_f32 v84, v84, v62
    v_sub_f32 v148, v148, v62
    v_sub_f32 v69, v69, v62
    v_sub_f32 v85, v85, v62
    v_sub_f32 v149, v149, v62
    v_sub_f32 v70, v70, v62
    v_sub_f32 v86, v86, v62
    v_sub_f32 v150, v150, v62
    v_sub_f32 v71, v71, v62
    v_sub_f32 v87, v87, v62
    v_sub_f32 v151, v151, v62
    v_sub_f32 v76, v76, v62
    v_sub_f32 v92, v92, v62
    v_sub_f32 v156, v156, v62
    v_sub_f32 v77, v77, v62
    v_sub_f32 v93, v93, v62
    v_sub_f32 v157, v157, v62
    v_sub_f32 v78, v78, v62
    v_sub_f32 v94, v94, v62
    v_sub_f32 v158, v158, v62
    v_sub_f32 v79, v79, v62
    v_sub_f32 v95, v95, v62
    v_sub_f32 v159, v159, v62
    v_mul_f32 v164, v58, v164
    v_mul_f32 v165, v58, v165
    v_mul_f32 v166, v58, v166
    v_mul_f32 v167, v58, v167
    v_mul_f32 v196, v58, v196
    v_mul_f32 v197, v58, v197
    v_mul_f32 v198, v58, v198
    v_mul_f32 v199, v58, v199
    v_mul_f32 v204, v58, v204
    v_mul_f32 v205, v58, v205
    v_mul_f32 v206, v58, v206
    v_mul_f32 v207, v58, v207
    v_mul_f32 v212, v58, v212
    v_mul_f32 v213, v58, v213
    v_mul_f32 v214, v58, v214
    v_mul_f32 v215, v58, v215
    v_mul_f32 v220, v58, v220
    v_mul_f32 v221, v58, v221
    v_mul_f32 v222, v58, v222
    v_mul_f32 v223, v58, v223
    v_mul_f32 v228, v58, v228
    v_mul_f32 v229, v58, v229
    v_mul_f32 v230, v58, v230
    v_mul_f32 v231, v58, v231
    v_mul_f32 v236, v58, v236
    v_mul_f32 v237, v58, v237
    v_mul_f32 v238, v58, v238
    v_mul_f32 v239, v58, v239
    v_mul_f32 v244, v58, v244
    v_mul_f32 v245, v58, v245
    v_mul_f32 v246, v58, v246
    v_mul_f32 v247, v58, v247
    v_mul_f32 v252, v58, v252
    v_mul_f32 v253, v58, v253
    v_mul_f32 v254, v58, v254
    v_mul_f32 v255, v58, v255
    v_exp_f32 v58, v64
    s_nop 0
    v_exp_f32 v59, v65
    s_nop 0
    v_cvt_pk_bf16_f32 v128, v58, v59
    v_exp_f32 v60, v66
    s_nop 0
    v_exp_f32 v61, v67
    s_nop 0
    v_cvt_pk_bf16_f32 v129, v60, v61
    v_exp_f32 v58, v68
    s_nop 0
    v_exp_f32 v59, v69
    s_nop 0
    v_cvt_pk_bf16_f32 v132, v58, v59
    v_exp_f32 v60, v70
    s_nop 0
    v_exp_f32 v61, v71
    s_nop 0
    v_cvt_pk_bf16_f32 v133, v60, v61
    v_exp_f32 v58, v72
    s_nop 0
    v_exp_f32 v59, v73
    s_nop 0
    v_cvt_pk_bf16_f32 v130, v58, v59
    v_exp_f32 v60, v74
    s_nop 0
    v_exp_f32 v61, v75
    s_nop 0
    v_cvt_pk_bf16_f32 v131, v60, v61
    v_exp_f32 v58, v76
    s_nop 0
    v_exp_f32 v59, v77
    s_nop 0
    v_cvt_pk_bf16_f32 v134, v58, v59
    v_exp_f32 v60, v78
    s_nop 0
    v_exp_f32 v61, v79
    s_nop 0
    v_cvt_pk_bf16_f32 v135, v60, v61
    s_nop 1
    s_setpc_b64 s[80:81]
L_rare1:
    s_nop 15
    v_max_f32 v62, v80, v81
    v_max3_f32 v62, v62, v82, v83
    v_max3_f32 v62, v62, v88, v89
    v_max3_f32 v62, v62, v90, v91
    v_mov_b32 v58, v62
    s_nop 1
    v_permlane16_swap_b32 v62, v58
    s_nop 1
    v_max_f32 v62, v62, v58
    v_mov_b32 v58, v62
    s_nop 1
    v_permlane32_swap_b32 v62, v58
    s_nop 1
    v_max_f32 v62, v62, v58
    v_add_f32 v62, 0x41c00000, v62
    v_max_f32 v62, 0, v62
    v_exp_f32 v58, -v62
    v_sub_f32 v64, v64, v62
    v_sub_f32 v80, v80, v62
    v_sub_f32 v144, v144, v62
    v_sub_f32 v65, v65, v62
    v_sub_f32 v81, v81, v62
    v_sub_f32 v145, v145, v62
    v_sub_f32 v66, v66, v62
    v_sub_f32 v82, v82, v62
    v_sub_f32 v146, v146, v62
    v_sub_f32 v67, v67, v62
    v_sub_f32 v83, v83, v62
    v_sub_f32 v147, v147, v62
    v_sub_f32 v72, v72, v62
    v_sub_f32 v88, v88, v62
    v_sub_f32 v152, v152, v62
    v_sub_f32 v73, v73, v62
    v_sub_f32 v89, v89, v62
    v_sub_f32 v153, v153, v62
    v_sub_f32 v74, v74, v62
    v_sub_f32 v90, v90, v62
    v_sub_f32 v154, v154, v62
    v_sub_f32 v75, v75, v62
    v_sub_f32 v91, v91, v62
    v_sub_f32 v155, v155, v62
    v_mul_f32 v160, v58, v160
    v_mul_f32 v161, v58, v161
    v_mul_f32 v162, v58, v162
    v_mul_f32 v163, v58, v163
    v_mul_f32 v192, v58, v192
    v_mul_f32 v193, v58, v193
    v_mul_f32 v194, v58, v194
    v_mul_f32 v195, v58, v195
    v_mul_f32 v200, v58, v200
    v_mul_f32 v201, v58, v201
    v_mul_f32 v202, v58, v202
    v_mul_f32 v203, v58, v203
    v_mul_f32 v208, v58, v208
    v_mul_f32 v209, v58, v209
    v_mul_f32 v210, v58, v210
    v_mul_f32 v211, v58, v211
    v_mul_f32 v216, v58, v216
    v_mul_f32 v217, v58, v217
    v_mul_f32 v218, v58, v218
    v_mul_f32 v219, v58, v219
    v_mul_f32 v224, v58, v224
    v_mul_f32 v225, v58, v225
    v_mul_f32 v226, v58, v226
    v_mul_f32 v227, v58, v227
    v_mul_f32 v232, v58, v232
    v_mul_f32 v233, v58, v233
    v_mul_f32 v234, v58, v234
    v_mul_f32 v235, v58, v235
    v_mul_f32 v240, v58, v240
    v_mul_f32 v241, v58, v241
    v_mul_f32 v242, v58, v242
    v_mul_f32 v243, v58, v243
    v_mul_f32 v248, v58, v248
    v_mul_f32 v249, v58, v249
    v_mul_f32 v250, v58, v250
    v_mul_f32 v251, v58, v251
    v_max_f32 v62, v84, v85
    v_max3_f32 v62, v62, v86, v87
    v_max3_f32 v62, v62, v92, v93
    v_max3_f32 v62, v62, v94, v95
    v_mov_b32 v58, v62
    s_nop 1
    v_permlane16_swap_b32 v62, v58
    s_nop 1
    v_max_f32 v62, v62, v58
    v_mov_b32 v58, v62
    s_nop 1
    v_permlane32_swap_b32 v62, v58
    s_nop 1
    v_max_f32 v62, v62, v58
    v_add_f32 v62, 0x41c00000, v62
    v_max_f32 v62, 0, v62
    v_exp_f32 v58, -v62
    v_sub_f32 v68, v68, v62
    v_sub_f32 v84, v84, v62
    v_sub_f32 v148, v148, v62
    v_sub_f32 v69, v69, v62
    v_sub_f32 v85, v85, v62
    v_sub_f32 v149, v149, v62
    v_sub_f32 v70, v70, v62
    v_sub_f32 v86, v86, v62
    v_sub_f32 v150, v150, v62
    v_sub_f32 v71, v71, v62
    v_sub_f32 v87, v87, v62
    v_sub_f32 v151, v151, v62
    v_sub_f32 v76, v76, v62
    v_sub_f32 v92, v92, v62
    v_sub_f32 v156, v156, v62
    v_sub_f32 v77, v77, v62
    v_sub_f32 v93, v93, v62
    v_sub_f32 v157, v157, v62
    v_sub_f32 v78, v78, v62
    v_sub_f32 v94, v94, v62
    v_sub_f32 v158, v158, v62
    v_sub_f32 v79, v79, v62
    v_sub_f32 v95, v95, v62
    v_sub_f32 v159, v159, v62
    v_mul_f32 v164, v58, v164
    v_mul_f32 v165, v58, v165
    v_mul_f32 v166, v58, v166
    v_mul_f32 v167, v58, v167
    v_mul_f32 v196, v58, v196
    v_mul_f32 v197, v58, v197
    v_mul_f32 v198, v58, v198
    v_mul_f32 v199, v58, v199
    v_mul_f32 v204, v58, v204
    v_mul_f32 v205, v58, v205
    v_mul_f32 v206, v58, v206
    v_mul_f32 v207, v58, v207
    v_mul_f32 v212, v58, v212
    v_mul_f32 v213, v58, v213
    v_mul_f32 v214, v58, v214
    v_mul_f32 v215, v58, v215
    v_mul_f32 v220, v58, v220
    v_mul_f32 v221, v58, v221
    v_mul_f32 v222, v58, v222
    v_mul_f32 v223, v58, v223
    v_mul_f32 v228, v58, v228
    v_mul_f32 v229, v58, v229
    v_mul_f32 v230, v58, v230
    v_mul_f32 v231, v58, v231
    v_mul_f32 v236, v58, v236
    v_mul_f32 v237, v58, v237
    v_mul_f32 v238, v58, v238
    v_mul_f32 v239, v58, v239
    v_mul_f32 v244, v58, v244
    v_mul_f32 v245, v58, v245
    v_mul_f32 v246, v58, v246
    v_mul_f32 v247, v58, v247
    v_mul_f32 v252, v58, v252
    v_mul_f32 v253, v58, v253
    v_mul_f32 v254, v58, v254
    v_mul_f32 v255, v58, v255
    v_exp_f32 v58, v80
    s_nop 0
    v_exp_f32 v59, v81
    s_nop 0
    v_cvt_pk_bf16_f32 v136, v58, v59
    v_exp_f32 v60, v82
    s_nop 0
    v_exp_f32 v61, v83
    s_nop 0
    v_cvt_pk_bf16_f32 v137, v60, v61
    v_exp_f32 v58, v84
    s_nop 0
    v_exp_f32 v59, v85
    s_nop 0
    v_cvt_pk_bf16_f32 v140, v58, v59
    v_exp_f32 v60, v86
    s_nop 0
    v_exp_f32 v61, v87
    s_nop 0
    v_cvt_pk_bf16_f32 v141, v60, v61
    v_exp_f32 v58, v88
    s_nop 0
    v_exp_f32 v59, v89
    s_nop 0
    v_cvt_pk_bf16_f32 v138, v58, v59
    v_exp_f32 v60, v90
    s_nop 0
    v_exp_f32 v61, v91
    s_nop 0
    v_cvt_pk_bf16_f32 v139, v60, v61
    v_exp_f32 v58, v92
    s_nop 0
    v_exp_f32 v59, v93
    s_nop 0
    v_cvt_pk_bf16_f32 v142, v58, v59
    v_exp_f32 v60, v94
    s_nop 0
    v_exp_f32 v61, v95
    s_nop 0
    v_cvt_pk_bf16_f32 v143, v60, v61
    s_nop 1
    s_setpc_b64 s[80:81]
L_adone:
    s_barrier
    ds_read_b128 v[16:19], v4 offset:0
    ds_read_b128 v[20:23], v4 offset:1024
    ds_read_b128 v[24:27], v4 offset:2048
    ds_read_b128 v[28:31], v4 offset:3072
    s_waitcnt lgkmcnt(3)
    v_mfma_f32_16x16x32_bf16 v[56:59], v[96:99], v[16:19], 0
    v_mfma_f32_16x16x32_bf16 v[60:63], v[100:103], v[16:19], 0
    v_mfma_f32_16x16x32_bf16 v[64:67], v[104:107], v[16:19], 0
    v_mfma_f32_16x16x32_bf16 v[68:71], v[108:111], v[16:19], 0
    s_waitcnt lgkmcnt(2)
    v_mfma_f32_16x16x32_bf16 v[72:75], v[112:115], v[16:19], 0
    ds_read_b128 v[16:19], v4 offset:4096
    s_cmp_lt_u32 s3, 4
    s_cbranch_scc1 L_nowl_52
    s_add_u32 s75, s69, 204800
    buffer_load_dwordx4 v[196:199], v44, s[8:11], s75 offen sc1
    buffer_load_dwordx4 v[200:203], v45, s[8:11], s75 offen sc1
    buffer_load_dwordx4 v[204:207], v46, s[8:11], s75 offen sc1
    buffer_load_dwordx4 v[208:211], v47, s[8:11], s75 offen sc1
    buffer_load_dwordx4 v[212:215], v52, s[8:11], s75 offen sc1
L_nowl_52:
    v_mfma_f32_16x16x32_bf16 v[56:59], v[116:119], v[20:23], v[56:59]
    v_mfma_f32_16x16x32_bf16 v[60:63], v[120:123], v[20:23], v[60:63]
    v_mfma_f32_16x16x32_bf16 v[64:67], v[124:127], v[20:23], v[64:67]
    v_mfma_f32_16x16x32_bf16 v[68:71], v[128:131], v[20:23], v[68:71]
    s_waitcnt lgkmcnt(2)
    v_mfma_f32_16x16x32_bf16 v[72:75], v[132:135], v[20:23], v[72:75]
    ds_read_b128 v[20:23], v4 offset:5120
    s_cmp_lt_u32 s3, 4
    s_cbranch_scc1 L_nowl_53
    s_add_u32 s75, s69, 245760
    buffer_load_dwordx4 v[216:219], v44, s[8:11], s75 offen sc1
    buffer_load_dwordx4 v[220:223], v45, s[8:11], s75 offen sc1
    buffer_load_dwordx4 v[224:227], v46, s[8:11], s75 offen sc1
    buffer_load_dwordx4 v[228:231], v47, s[8:11], s75 offen sc1
    buffer_load_dwordx4 v[232:235], v52, s[8:11], s75 offen sc1
L_nowl_53:
    v_mfma_f32_16x16x32_bf16 v[56:59], v[136:139], v[24:27], v[56:59]
    v_mfma_f32_16x16x32_bf16 v[60:63], v[140:143], v[24:27], v[60:63]
    s_add_u32 s65, s68, 3
    s_and_b32 s65, s65, 3
    s_andn2_b32 s7, s68, 3
    v_mfma_f32_16x16x32_bf16 v[64:67], v[144:147], v[24:27], v[64:67]
    s_add_u32 s65, s65, s7
    s_lshl_b32 s65, s65, 17
    s_add_u32 s65, s65, s66
    v_mfma_f32_16x16x32_bf16 v[68:71], v[148:151], v[24:27], v[68:71]
    s_waitcnt lgkmcnt(2)
    s_add_u32 m0, s99, 65536
    v_mfma_f32_16x16x32_bf16 v[72:75], v[152:155], v[24:27], v[72:75]
    ds_read_b128 v[24:27], v4 offset:6144
    s_cmp_lt_u32 s3, 4
    s_cbranch_scc1 L_nowl_54
    s_add_u32 s75, s69, 286720
    buffer_load_dwordx4 v[236:239], v44, s[8:11], s75 offen sc1
    buffer_load_dwordx4 v[240:243], v45, s[8:11], s75 offen sc1
    buffer_load_dwordx4 v[244:247], v46, s[8:11], s75 offen sc1
    buffer_load_dwordx4 v[248:251], v47, s[8:11], s75 offen sc1
    buffer_load_dwordx4 v[252:255], v52, s[8:11], s75 offen sc1
L_nowl_54:
    v_mfma_f32_16x16x32_bf16 v[56:59], v[156:159], v[28:31], v[56:59]
    buffer_load_dwordx4 v13, s[8:11], s65 offen offset:0 sc1 lds
    v_mfma_f32_16x16x32_bf16 v[60:63], v[160:163], v[28:31], v[60:63]
    buffer_load_dwordx4 v13, s[8:11], s65 offen offset:1024 sc1 lds
    v_mfma_f32_16x16x32_bf16 v[64:67], v[164:167], v[28:31], v[64:67]
    buffer_load_dwordx4 v13, s[8:11], s65 offen offset:2048 sc1 lds
    v_mfma_f32_16x16x32_bf16 v[68:71], v[168:171], v[28:31], v[68:71]
    buffer_load_dwordx4 v13, s[8:11], s65 offen offset:3072 sc1 lds
    s_waitcnt lgkmcnt(2)
    v_mfma_f32_16x16x32_bf16 v[72:75], v[172:175], v[28:31], v[72:75]
    ds_read_b128 v[28:31], v4 offset:7168
    s_waitcnt vmcnt(20)
    v_mfma_f32_16x16x32_bf16 v[56:59], v[176:179], v[16:19], v[56:59]
    v_mfma_f32_16x16x32_bf16 v[60:63], v[180:183], v[16:19], v[60:63]
    v_mfma_f32_16x16x32_bf16 v[64:67], v[184:187], v[16:19], v[64:67]
    v_mfma_f32_16x16x32_bf16 v[68:71], v[188:191], v[16:19], v[68:71]
    s_waitcnt lgkmcnt(2)
    v_mfma_f32_16x16x32_bf16 v[72:75], v[192:195], v[16:19], v[72:75]
    s_cmp_ge_u32 s3, 4
    s_cbranch_scc1 L_o0
    s_waitcnt vmcnt(4)
L_o0:
    s_waitcnt lgkmcnt(0)
    s_barrier
    ds_read_b128 v[16:19], v4 offset:32768
    s_waitcnt vmcnt(14)
    v_mfma_f32_16x16x32_bf16 v[56:59], v[196:199], v[20:23], v[56:59]
    v_mfma_f32_16x16x32_bf16 v[60:63], v[200:203], v[20:23], v[60:63]
    v_mfma_f32_16x16x32_bf16 v[64:67], v[204:207], v[20:23], v[64:67]
    v_mfma_f32_16x16x32_bf16 v[68:71], v[208:211], v[20:23], v[68:71]
    v_mfma_f32_16x16x32_bf16 v[72:75], v[212:215], v[20:23], v[72:75]
    ds_read_b128 v[20:23], v4 offset:33792
    s_waitcnt vmcnt(9)
    v_mfma_f32_16x16x32_bf16 v[56:59], v[216:219], v[24:27], v[56:59]
    v_mfma_f32_16x16x32_bf16 v[60:63], v[220:223], v[24:27], v[60:63]
    v_mfma_f32_16x16x32_bf16 v[64:67], v[224:227], v[24:27], v[64:67]
    v_mfma_f32_16x16x32_bf16 v[68:71], v[228:231], v[24:27], v[68:71]
    v_mfma_f32_16x16x32_bf16 v[72:75], v[232:235], v[24:27], v[72:75]
    ds_read_b128 v[24:27], v4 offset:34816
    s_waitcnt vmcnt(4)
    v_mfma_f32_16x16x32_bf16 v[56:59], v[236:239], v[28:31], v[56:59]
    v_mfma_f32_16x16x32_bf16 v[60:63], v[240:243], v[28:31], v[60:63]
    v_mfma_f32_16x16x32_bf16 v[64:67], v[244:247], v[28:31], v[64:67]
    v_mfma_f32_16x16x32_bf16 v[68:71], v[248:251], v[28:31], v[68:71]
    s_waitcnt lgkmcnt(2)
    v_mfma_f32_16x16x32_bf16 v[72:75], v[252:255], v[28:31], v[72:75]
    ds_read_b128 v[28:31], v4 offset:35840
    v_mfma_f32_16x16x32_bf16 v[76:79], v[96:99], v[16:19], 0
    s_sub_u32 s6, s71, 1
    s_and_b32 s6, s6, 3
    s_mul_i32 s7, s6, 5120
    v_mfma_f32_16x16x32_bf16 v[80:83], v[100:103], v[16:19], 0
    s_add_u32 s7, s7, s67
    s_cmp_eq_u32 s6, 3
    s_cselect_b32 s7, 155648, s7
    v_mfma_f32_16x16x32_bf16 v[84:87], v[104:107], v[16:19], 0
    v_add_u32 v12, s7, v52
    v_add_u32 v5, s67, v45
    v_mfma_f32_16x16x32_bf16 v[88:91], v[108:111], v[16:19], 0
    s_waitcnt lgkmcnt(2)
    v_mfma_f32_16x16x32_bf16 v[92:95], v[112:115], v[16:19], 0
    ds_read_b128 v[16:19], v4 offset:36864
    v_mfma_f32_16x16x32_bf16 v[76:79], v[116:119], v[20:23], v[76:79]
    ds_write_b128 v5, v[60:63] offset:0
    v_add_u32 v5, s67, v46
    v_mfma_f32_16x16x32_bf16 v[80:83], v[120:123], v[20:23], v[80:83]
    v_mfma_f32_16x16x32_bf16 v[84:87], v[124:127], v[20:23], v[84:87]
    v_mfma_f32_16x16x32_bf16 v[88:91], v[128:131], v[20:23], v[88:91]
    s_waitcnt lgkmcnt(3)
    v_mfma_f32_16x16x32_bf16 v[92:95], v[132:135], v[20:23], v[92:95]
    ds_read_b128 v[20:23], v4 offset:37888
    v_mfma_f32_16x16x32_bf16 v[76:79], v[136:139], v[24:27], v[76:79]
    ds_write_b128 v5, v[64:67] offset:5120
    v_add_u32 v5, s67, v47
    v_mfma_f32_16x16x32_bf16 v[80:83], v[140:143], v[24:27], v[80:83]
    v_mfma_f32_16x16x32_bf16 v[84:87], v[144:147], v[24:27], v[84:87]
    v_mfma_f32_16x16x32_bf16 v[88:91], v[148:151], v[24:27], v[88:91]
    s_waitcnt lgkmcnt(4)
    v_mfma_f32_16x16x32_bf16 v[92:95], v[152:155], v[24:27], v[92:95]
    ds_read_b128 v[24:27], v4 offset:38912
    v_mfma_f32_16x16x32_bf16 v[76:79], v[156:159], v[28:31], v[76:79]
    ds_write_b128 v5, v[68:71] offset:10240
    v_add_u32 v5, s67, v52
    v_mfma_f32_16x16x32_bf16 v[80:83], v[160:163], v[28:31], v[80:83]
    v_mfma_f32_16x16x32_bf16 v[84:87], v[164:167], v[28:31], v[84:87]
    v_mfma_f32_16x16x32_bf16 v[88:91], v[168:171], v[28:31], v[88:91]
    s_waitcnt lgkmcnt(5)
    v_mfma_f32_16x16x32_bf16 v[92:95], v[172:175], v[28:31], v[92:95]
    ds_read_b128 v[28:31], v4 offset:39936
    v_mfma_f32_16x16x32_bf16 v[76:79], v[176:179], v[16:19], v[76:79]
    ds_write_b128 v12, v[72:75] offset:0
    v_mfma_f32_16x16x32_bf16 v[80:83], v[180:183], v[16:19], v[80:83]
    v_mfma_f32_16x16x32_bf16 v[84:87], v[184:187], v[16:19], v[84:87]
    v_and_b32 v3, 1, v1
    v_lshlrev_b32 v3, 12, v3
    s_lshr_b32 s72, s61, 2
    s_lshl_b32 s72, s72, 6
    s_andn2_b32 s6, s4, 7
    s_add_u32 s72, s72, s6
    s_add_u32 s72, s72, s3
    s_lshl_b32 s72, s72, 7
    s_add_u32 s72, s72, 3932160
    v_mfma_f32_16x16x32_bf16 v[88:91], v[188:191], v[16:19], v[88:91]
    s_waitcnt lgkmcnt(5)
    v_mfma_f32_16x16x32_bf16 v[92:95], v[192:195], v[16:19], v[92:95]
    s_waitcnt vmcnt(0)
    s_waitcnt lgkmcnt(0)
    s_barrier
    ds_read_b128 v[32:35], v6 offset:0
    ds_read_b128 v[36:39], v6 offset:5120
    ds_read_b128 v[40:43], v6 offset:10240
    ds_read_b128 v[16:19], v7 offset:0
    v_mfma_f32_16x16x32_bf16 v[76:79], v[196:199], v[20:23], v[76:79]
    v_mfma_f32_16x16x32_bf16 v[80:83], v[200:203], v[20:23], v[80:83]
    v_mfma_f32_16x16x32_bf16 v[84:87], v[204:207], v[20:23], v[84:87]
    s_waitcnt lgkmcnt(3)
    v_add_f32 v56, v56, v32
    v_add_f32 v57, v57, v33
    v_mfma_f32_16x16x32_bf16 v[88:91], v[208:211], v[20:23], v[88:91]
    v_add_f32 v58, v58, v34
    v_add_f32 v59, v59, v35
    v_mfma_f32_16x16x32_bf16 v[92:95], v[212:215], v[20:23], v[92:95]
    s_waitcnt lgkmcnt(2)
    ds_read_b128 v[32:35], v5 offset:0
    ds_read_b128 v[20:23], v7 offset:1024
    v_add_f32 v56, v56, v36
    v_add_f32 v57, v57, v37
    v_mfma_f32_16x16x32_bf16 v[76:79], v[216:219], v[24:27], v[76:79]
    buffer_load_dword v50, v3, s[8:11], s72 offen sc1
    v_add_f32 v58, v58, v38
    v_add_f32 v59, v59, v39
    v_mfma_f32_16x16x32_bf16 v[80:83], v[220:223], v[24:27], v[80:83]
    s_waitcnt lgkmcnt(3)
    ds_read_b128 v[36:39], v5 offset:5120
    v_add_f32 v56, v56, v40
    v_add_f32 v57, v57, v41
    v_mfma_f32_16x16x32_bf16 v[84:87], v[224:227], v[24:27], v[84:87]
    v_add_f32 v58, v58, v42
    v_add_f32 v59, v59, v43
    v_mfma_f32_16x16x32_bf16 v[88:91], v[228:231], v[24:27], v[88:91]
    ds_read_b128 v[40:43], v5 offset:10240
    s_waitcnt lgkmcnt(3)
    v_add_f32 v72, v72, v32
    v_add_f32 v73, v73, v33
    s_add_u32 s6, s96, 0
    v_mfma_f32_16x16x32_bf16 v[92:95], v[232:235], v[24:27], v[92:95]
    ds_read_b128 v[24:27], v7 offset:2048
    v_add_f32 v74, v74, v34
    v_add_f32 v75, v75, v35
    v_mfma_f32_16x16x32_bf16 v[76:79], v[236:239], v[28:31], v[76:79]
    buffer_store_dwordx4 v[56:59], v44, s[8:11], s6 offen sc1
    s_waitcnt lgkmcnt(2)
    v_add_f32 v72, v72, v36
    v_add_f32 v73, v73, v37
    v_mfma_f32_16x16x32_bf16 v[80:83], v[240:243], v[28:31], v[80:83]
    v_add_f32 v74, v74, v38
    v_add_f32 v75, v75, v39
    v_mfma_f32_16x16x32_bf16 v[84:87], v[244:247], v[28:31], v[84:87]
    s_waitcnt lgkmcnt(1)
    v_add_f32 v72, v72, v40
    v_add_f32 v73, v73, v41
    v_mfma_f32_16x16x32_bf16 v[88:91], v[248:251], v[28:31], v[88:91]
    v_add_f32 v74, v74, v42
    v_add_f32 v75, v75, v43
    s_cmp_lg_u32 s71, 0
    v_mfma_f32_16x16x32_bf16 v[92:95], v[252:255], v[28:31], v[92:95]
    s_cbranch_scc1 L_nost_55
    buffer_store_dwordx4 v[72:75], v52, s[8:11], s6 offen sc1
L_nost_55:
    ds_read_b128 v[28:31], v7 offset:3072
    v_mfma_f32_16x16x32_bf16 v[56:59], v[96:99], v[16:19], 0
    s_sub_u32 s6, s71, 2
    s_and_b32 s6, s6, 3
    s_mul_i32 s7, s6, 5120
    v_mfma_f32_16x16x32_bf16 v[60:63], v[100:103], v[16:19], 0
    s_add_u32 s7, s7, s67
    s_cmp_eq_u32 s6, 3
    s_cselect_b32 s7, 124928, s7
    v_mfma_f32_16x16x32_bf16 v[64:67], v[104:107], v[16:19], 0
    v_add_u32 v12, s7, v52
    v_add_u32 v5, s67, v45
    s_waitcnt vmcnt(1)
    v_cmp_ne_u32 vcc, 1, v50
    s_cbranch_vccz L_o1
    s_mov_b32 s79, 262144
L_poll_57:
    buffer_load_dword v2, v3, s[8:11], s72 offen sc1
    s_waitcnt vmcnt(0)
    v_cmp_ne_u32 vcc, 1, v2
    s_cbranch_vccz L_polldone_58
    s_sleep 1
    s_sub_u32 s79, s79, 1
    s_cmp_lg_u32 s79, 0
    s_cbranch_scc1 L_poll_57
L_polldone_58:
L_o1:
    v_mfma_f32_16x16x32_bf16 v[68:71], v[108:111], v[16:19], 0
    s_add_u32 s65, s61, 1
    s_and_b32 s65, s65, 3
    s_andn2_b32 s7, s61, 3
    v_mfma_f32_16x16x32_bf16 v[72:75], v[112:115], v[16:19], 0
    ds_read_b128 v[16:19], v7 offset:4096
    s_add_u32 s65, s65, s7
    s_lshl_b32 s65, s65, 17
    s_add_u32 s65, s65, s66
    v_mfma_f32_16x16x32_bf16 v[56:59], v[116:119], v[20:23], v[56:59]
    ds_write_b128 v5, v[80:83] offset:30720
    v_add_u32 v5, s67, v46
    s_add_u32 m0, s99, 0
    v_mfma_f32_16x16x32_bf16 v[60:63], v[120:123], v[20:23], v[60:63]
    buffer_load_dwordx4 v13, s[8:11], s65 offen offset:1024 sc1 lds
    buffer_load_dwordx4 v13, s[8:11], s65 offen offset:0 sc1 lds
    v_mfma_f32_16x16x32_bf16 v[64:67], v[124:127], v[20:23], v[64:67]
    buffer_load_dwordx4 v13, s[8:11], s65 offen offset:3072 sc1 lds
    buffer_load_dwordx4 v13, s[8:11], s65 offen offset:2048 sc1 lds
    v_mfma_f32_16x16x32_bf16 v[68:71], v[128:131], v[20:23], v[68:71]
    s_waitcnt lgkmcnt(3)
    s_add_u32 s65, s61, 2
    s_and_b32 s65, s65, 3
    s_andn2_b32 s7, s61, 3
    v_mfma_f32_16x16x32_bf16 v[72:75], v[132:135], v[20:23], v[72:75]
    ds_read_b128 v[20:23], v7 offset:5120
    s_add_u32 s65, s65, s7
    s_lshl_b32 s65, s65, 17
    s_add_u32 s65, s65, s66
    v_mfma_f32_16x16x32_bf16 v[56:59], v[136:139], v[24:27], v[56:59]
    ds_write_b128 v5, v[84:87] offset:35840
    v_add_u32 v5, s67, v47
    s_add_u32 m0, s99, 32768
    v_mfma_f32_16x16x32_bf16 v[60:63], v[140:143], v[24:27], v[60:63]
    buffer_load_dwordx4 v13, s[8:11], s65 offen offset:0 sc1 lds
    v_mfma_f32_16x16x32_bf16 v[64:67], v[144:147], v[24:27], v[64:67]
    buffer_load_dwordx4 v13, s[8:11], s65 offen offset:1024 sc1 lds
    v_mfma_f32_16x16x32_bf16 v[68:71], v[148:151], v[24:27], v[68:71]
    buffer_load_dwordx4 v13, s[8:11], s65 offen offset:2048 sc1 lds
    s_waitcnt lgkmcnt(4)
    v_mfma_f32_16x16x32_bf16 v[72:75], v[152:155], v[24:27], v[72:75]
    ds_read_b128 v[24:27], v7 offset:6144
    v_mfma_f32_16x16x32_bf16 v[56:59], v[156:159], v[28:31], v[56:59]
    ds_write_b128 v5, v[88:91] offset:40960
    v_add_u32 v5, s67, v52
    v_mfma_f32_16x16x32_bf16 v[60:63], v[160:163], v[28:31], v[60:63]
    buffer_load_dwordx4 v13, s[8:11], s65 offen offset:3072 sc1 lds
    v_mfma_f32_16x16x32_bf16 v[64:67], v[164:167], v[28:31], v[64:67]
    v_mfma_f32_16x16x32_bf16 v[68:71], v[168:171], v[28:31], v[68:71]
    s_waitcnt lgkmcnt(5)
    v_mfma_f32_16x16x32_bf16 v[72:75], v[172:175], v[28:31], v[72:75]
    ds_read_b128 v[28:31], v7 offset:7168
    v_mfma_f32_16x16x32_bf16 v[56:59], v[176:179], v[16:19], v[56:59]
    ds_write_b128 v12, v[92:95] offset:30720
    v_mfma_f32_16x16x32_bf16 v[60:63], v[180:183], v[16:19], v[60:63]
    s_add_u32 s65, s61, 3
    s_and_b32 s65, s65, 3
    s_andn2_b32 s7, s61, 3
    v_mfma_f32_16x16x32_bf16 v[64:67], v[184:187], v[16:19], v[64:67]
    s_add_u32 s65, s65, s7
    s_lshl_b32 s65, s65, 17
    s_add_u32 s65, s65, s66
    v_mfma_f32_16x16x32_bf16 v[68:71], v[188:191], v[16:19], v[68:71]
    s_waitcnt lgkmcnt(5)
    s_add_u32 m0, s99, 65536
    v_mfma_f32_16x16x32_bf16 v[72:75], v[192:195], v[16:19], v[72:75]
    s_waitcnt vmcnt(4)
    s_waitcnt lgkmcnt(0)
    s_barrier
    ds_read_b128 v[32:35], v6 offset:30720
    ds_read_b128 v[36:39], v6 offset:35840
    ds_read_b128 v[40:43], v6 offset:40960
    ds_read_b128 v[16:19], v4 offset:0
    v_mfma_f32_16x16x32_bf16 v[56:59], v[196:199], v[20:23], v[56:59]
    buffer_load_dwordx4 v13, s[8:11], s65 offen offset:0 sc1 lds
    v_mfma_f32_16x16x32_bf16 v[60:63], v[200:203], v[20:23], v[60:63]
    buffer_load_dwordx4 v13, s[8:11], s65 offen offset:1024 sc1 lds
    v_mfma_f32_16x16x32_bf16 v[64:67], v[204:207], v[20:23], v[64:67]
    s_waitcnt lgkmcnt(3)
    v_add_f32 v76, v76, v32
    v_add_f32 v77, v77, v33
    v_mfma_f32_16x16x32_bf16 v[68:71], v[208:211], v[20:23], v[68:71]
    buffer_load_dwordx4 v13, s[8:11], s65 offen offset:2048 sc1 lds
    v_add_f32 v78, v78, v34
    v_add_f32 v79, v79, v35
    v_mfma_f32_16x16x32_bf16 v[72:75], v[212:215], v[20:23], v[72:75]
    s_waitcnt lgkmcnt(2)
    ds_read_b128 v[32:35], v5 offset:30720
    ds_read_b128 v[20:23], v4 offset:1024
    v_add_f32 v76, v76, v36
    v_add_f32 v77, v77, v37
    v_mfma_f32_16x16x32_bf16 v[56:59], v[216:219], v[24:27], v[56:59]
    buffer_load_dwordx4 v13, s[8:11], s65 offen offset:3072 sc1 lds
    v_add_f32 v78, v78, v38
    v_add_f32 v79, v79, v39
    v_mfma_f32_16x16x32_bf16 v[60:63], v[220:223], v[24:27], v[60:63]
    s_waitcnt lgkmcnt(3)
    ds_read_b128 v[36:39], v5 offset:35840
    v_add_f32 v76, v76, v40
    v_add_f32 v77, v77, v41
    v_mfma_f32_16x16x32_bf16 v[64:67], v[224:227], v[24:27], v[64:67]
    v_add_f32 v78, v78, v42
    v_add_f32 v79, v79, v43
    v_mfma_f32_16x16x32_bf16 v[68:71], v[228:231], v[24:27], v[68:71]
    ds_read_b128 v[40:43], v5 offset:40960
    s_waitcnt lgkmcnt(3)
    v_add_f32 v92, v92, v32
    v_add_f32 v93, v93, v33
    s_add_u32 s6, s97, 0
    v_mfma_f32_16x16x32_bf16 v[72:75], v[232:235], v[24:27], v[72:75]
    ds_read_b128 v[24:27], v4 offset:2048
    v_add_f32 v94, v94, v34
    v_add_f32 v95, v95, v35
    v_mfma_f32_16x16x32_bf16 v[56:59], v[236:239], v[28:31], v[56:59]
    buffer_store_dwordx4 v[76:79], v44, s[8:11], s6 offen sc1
    s_waitcnt lgkmcnt(2)
    v_add_f32 v92, v92, v36
    v_add_f32 v93, v93, v37
    v_mfma_f32_16x16x32_bf16 v[60:63], v[240:243], v[28:31], v[60:63]
    v_add_f32 v94, v94, v38
    v_add_f32 v95, v95, v39
    v_mfma_f32_16x16x32_bf16 v[64:67], v[244:247], v[28:31], v[64:67]
    s_waitcnt lgkmcnt(1)
    v_add_f32 v92, v92, v40
    v_add_f32 v93, v93, v41
    v_mfma_f32_16x16x32_bf16 v[68:71], v[248:251], v[28:31], v[68:71]
    v_add_f32 v94, v94, v42
    v_add_f32 v95, v95, v43
    s_cmp_lg_u32 s71, 1
    v_mfma_f32_16x16x32_bf16 v[72:75], v[252:255], v[28:31], v[72:75]
    s_cbranch_scc1 L_nost_56
    buffer_store_dwordx4 v[92:95], v52, s[8:11], s6 offen sc1
L_nost_56:
    ds_read_b128 v[28:31], v4 offset:3072
    v_mfma_f32_16x16x32_bf16 v[76:79], v[96:99], v[16:19], 0
    s_sub_u32 s6, s71, 3
    s_and_b32 s6, s6, 3
    s_mul_i32 s7, s6, 5120
    v_mfma_f32_16x16x32_bf16 v[80:83], v[100:103], v[16:19], 0
    s_add_u32 s7, s7, s67
    s_cmp_eq_u32 s6, 3
    s_cselect_b32 s7, 155648, s7
    v_mfma_f32_16x16x32_bf16 v[84:87], v[104:107], v[16:19], 0
    v_add_u32 v12, s7, v52
    v_add_u32 v5, s67, v45
    v_mfma_f32_16x16x32_bf16 v[88:91], v[108:111], v[16:19], 0
    v_mfma_f32_16x16x32_bf16 v[92:95], v[112:115], v[16:19], 0
    ds_read_b128 v[16:19], v4 offset:4096
    v_mfma_f32_16x16x32_bf16 v[76:79], v[116:119], v[20:23], v[76:79]
    ds_write_b128 v5, v[60:63] offset:0
    v_add_u32 v5, s67, v46
    v_mfma_f32_16x16x32_bf16 v[80:83], v[120:123], v[20:23], v[80:83]
    v_mfma_f32_16x16x32_bf16 v[84:87], v[124:127], v[20:23], v[84:87]
    v_mfma_f32_16x16x32_bf16 v[88:91], v[128:131], v[20:23], v[88:91]
    s_waitcnt lgkmcnt(3)
    v_mfma_f32_16x16x32_bf16 v[92:95], v[132:135], v[20:23], v[92:95]
    ds_read_b128 v[20:23], v4 offset:5120
    v_mfma_f32_16x16x32_bf16 v[76:79], v[136:139], v[24:27], v[76:79]
    ds_write_b128 v5, v[64:67] offset:5120
    v_add_u32 v5, s67, v47
    v_mfma_f32_16x16x32_bf16 v[80:83], v[140:143], v[24:27], v[80:83]
    v_mfma_f32_16x16x32_bf16 v[84:87], v[144:147], v[24:27], v[84:87]
    v_mfma_f32_16x16x32_bf16 v[88:91], v[148:151], v[24:27], v[88:91]
    s_waitcnt lgkmcnt(4)
    v_mfma_f32_16x16x32_bf16 v[92:95], v[152:155], v[24:27], v[92:95]
    ds_read_b128 v[24:27], v4 offset:6144
    v_mfma_f32_16x16x32_bf16 v[76:79], v[156:159], v[28:31], v[76:79]
    ds_write_b128 v5, v[68:71] offset:10240
    v_add_u32 v5, s67, v52
    v_mfma_f32_16x16x32_bf16 v[80:83], v[160:163], v[28:31], v[80:83]
    v_mfma_f32_16x16x32_bf16 v[84:87], v[164:167], v[28:31], v[84:87]
    v_mfma_f32_16x16x32_bf16 v[88:91], v[168:171], v[28:31], v[88:91]
    s_waitcnt lgkmcnt(5)
    v_mfma_f32_16x16x32_bf16 v[92:95], v[172:175], v[28:31], v[92:95]
    ds_read_b128 v[28:31], v4 offset:7168
    v_mfma_f32_16x16x32_bf16 v[76:79], v[176:179], v[16:19], v[76:79]
    ds_write_b128 v12, v[72:75] offset:0
    v_mfma_f32_16x16x32_bf16 v[80:83], v[180:183], v[16:19], v[80:83]
    s_add_u32 s65, s68, 0
    s_and_b32 s65, s65, 3
    s_andn2_b32 s7, s68, 3
    v_mfma_f32_16x16x32_bf16 v[84:87], v[184:187], v[16:19], v[84:87]
    s_add_u32 s65, s65, s7
    s_lshl_b32 s65, s65, 17
    s_add_u32 s65, s65, s66
    v_mfma_f32_16x16x32_bf16 v[88:91], v[188:191], v[16:19], v[88:91]
    s_waitcnt lgkmcnt(5)
    s_add_u32 m0, s99, 0
    v_mfma_f32_16x16x32_bf16 v[92:95], v[192:195], v[16:19], v[92:95]
    s_waitcnt vmcnt(5)
    s_waitcnt lgkmcnt(0)
    s_barrier
    ds_read_b128 v[32:35], v6 offset:0
    ds_read_b128 v[36:39], v6 offset:5120
    ds_read_b128 v[40:43], v6 offset:10240
    ds_read_b128 v[16:19], v4 offset:32768
    v_mfma_f32_16x16x32_bf16 v[76:79], v[196:199], v[20:23], v[76:79]
    buffer_load_dwordx4 v13, s[8:11], s65 offen offset:0 sc1 lds
    v_mfma_f32_16x16x32_bf16 v[80:83], v[200:203], v[20:23], v[80:83]
    buffer_load_dwordx4 v13, s[8:11], s65 offen offset:1024 sc1 lds
    v_mfma_f32_16x16x32_bf16 v[84:87], v[204:207], v[20:23], v[84:87]
    s_waitcnt lgkmcnt(3)
    v_add_f32 v56, v56, v32
    v_add_f32 v57, v57, v33
    v_mfma_f32_16x16x32_bf16 v[88:91], v[208:211], v[20:23], v[88:91]
    buffer_load_dwordx4 v13, s[8:11], s65 offen offset:2048 sc1 lds
    v_add_f32 v58, v58, v34
    v_add_f32 v59, v59, v35
    v_mfma_f32_16x16x32_bf16 v[92:95], v[212:215], v[20:23], v[92:95]
    s_waitcnt lgkmcnt(2)
    ds_read_b128 v[32:35], v5 offset:0
    ds_read_b128 v[20:23], v4 offset:33792
    v_add_f32 v56, v56, v36
    v_add_f32 v57, v57, v37
    v_mfma_f32_16x16x32_bf16 v[76:79], v[216:219], v[24:27], v[76:79]
    buffer_load_dwordx4 v13, s[8:11], s65 offen offset:3072 sc1 lds
    v_add_f32 v58, v58, v38
    v_add_f32 v59, v59, v39
    v_mfma_f32_16x16x32_bf16 v[80:83], v[220:223], v[24:27], v[80:83]
    s_waitcnt lgkmcnt(3)
    ds_read_b128 v[36:39], v5 offset:5120
    v_add_f32 v56, v56, v40
    v_add_f32 v57, v57, v41
    v_mfma_f32_16x16x32_bf16 v[84:87], v[224:227], v[24:27], v[84:87]
    v_add_f32 v58, v58, v42
    v_add_f32 v59, v59, v43
    v_mfma_f32_16x16x32_bf16 v[88:91], v[228:231], v[24:27], v[88:91]
    ds_read_b128 v[40:43], v5 offset:10240
    s_waitcnt lgkmcnt(3)
    v_add_f32 v72, v72, v32
    v_add_f32 v73, v73, v33
    s_add_u32 s6, s98, 0
    v_mfma_f32_16x16x32_bf16 v[92:95], v[232:235], v[24:27], v[92:95]
    ds_read_b128 v[24:27], v4 offset:34816
    v_add_f32 v74, v74, v34
    v_add_f32 v75, v75, v35
    v_mfma_f32_16x16x32_bf16 v[76:79], v[236:239], v[28:31], v[76:79]
    buffer_store_dwordx4 v[56:59], v44, s[8:11], s6 offen sc1
    s_waitcnt lgkmcnt(2)
    v_add_f32 v72, v72, v36
    v_add_f32 v73, v73, v37
    v_mfma_f32_16x16x32_bf16 v[80:83], v[240:243], v[28:31], v[80:83]
    v_add_f32 v74, v74, v38
    v_add_f32 v75, v75, v39
    v_mfma_f32_16x16x32_bf16 v[84:87], v[244:247], v[28:31], v[84:87]
    s_waitcnt lgkmcnt(1)
    v_add_f32 v72, v72, v40
    v_add_f32 v73, v73, v41
    v_mfma_f32_16x16x32_bf16 v[88:91], v[248:251], v[28:31], v[88:91]
    v_add_f32 v74, v74, v42
    v_add_f32 v75, v75, v43
    s_cmp_lg_u32 s71, 2
    v_mfma_f32_16x16x32_bf16 v[92:95], v[252:255], v[28:31], v[92:95]
    s_cbranch_scc1 L_nost_59
    buffer_store_dwordx4 v[72:75], v52, s[8:11], s6 offen sc1
L_nost_59:
    ds_read_b128 v[28:31], v4 offset:35840
    v_mfma_f32_16x16x32_bf16 v[56:59], v[96:99], v[16:19], 0
    s_sub_u32 s6, s71, 4
    s_and_b32 s6, s6, 3
    s_mul_i32 s7, s6, 5120
    v_mfma_f32_16x16x32_bf16 v[60:63], v[100:103], v[16:19], 0
    s_add_u32 s7, s7, s67
    s_cmp_eq_u32 s6, 3
    s_cselect_b32 s7, 124928, s7
    v_mfma_f32_16x16x32_bf16 v[64:67], v[104:107], v[16:19], 0
    v_add_u32 v12, s7, v52
    v_add_u32 v5, s67, v45
    v_mfma_f32_16x16x32_bf16 v[68:71], v[108:111], v[16:19], 0
    v_mfma_f32_16x16x32_bf16 v[72:75], v[112:115], v[16:19], 0
    ds_read_b128 v[16:19], v4 offset:36864
    v_mfma_f32_16x16x32_bf16 v[56:59], v[116:119], v[20:23], v[56:59]
    ds_write_b128 v5, v[80:83] offset:30720
    v_add_u32 v5, s67, v46
    v_mfma_f32_16x16x32_bf16 v[60:63], v[120:123], v[20:23], v[60:63]
    v_mfma_f32_16x16x32_bf16 v[64:67], v[124:127], v[20:23], v[64:67]
    v_mfma_f32_16x16x32_bf16 v[68:71], v[128:131], v[20:23], v[68:71]
    s_waitcnt lgkmcnt(3)
    v_mfma_f32_16x16x32_bf16 v[72:75], v[132:135], v[20:23], v[72:75]
    ds_read_b128 v[20:23], v4 offset:37888
    v_mfma_f32_16x16x32_bf16 v[56:59], v[136:139], v[24:27], v[56:59]
    ds_write_b128 v5, v[84:87] offset:35840
    v_add_u32 v5, s67, v47
    v_mfma_f32_16x16x32_bf16 v[60:63], v[140:143], v[24:27], v[60:63]
    v_mfma_f32_16x16x32_bf16 v[64:67], v[144:147], v[24:27], v[64:67]
    v_mfma_f32_16x16x32_bf16 v[68:71], v[148:151], v[24:27], v[68:71]
    s_waitcnt lgkmcnt(4)
    v_mfma_f32_16x16x32_bf16 v[72:75], v[152:155], v[24:27], v[72:75]
    ds_read_b128 v[24:27], v4 offset:38912
    v_mfma_f32_16x16x32_bf16 v[56:59], v[156:159], v[28:31], v[56:59]
    ds_write_b128 v5, v[88:91] offset:40960
    v_add_u32 v5, s67, v52
    v_mfma_f32_16x16x32_bf16 v[60:63], v[160:163], v[28:31], v[60:63]
    v_mfma_f32_16x16x32_bf16 v[64:67], v[164:167], v[28:31], v[64:67]
    v_mfma_f32_16x16x32_bf16 v[68:71], v[168:171], v[28:31], v[68:71]
    s_waitcnt lgkmcnt(5)
    v_mfma_f32_16x16x32_bf16 v[72:75], v[172:175], v[28:31], v[72:75]
    ds_read_b128 v[28:31], v4 offset:39936
    v_mfma_f32_16x16x32_bf16 v[56:59], v[176:179], v[16:19], v[56:59]
    ds_write_b128 v12, v[92:95] offset:30720
    v_mfma_f32_16x16x32_bf16 v[60:63], v[180:183], v[16:19], v[60:63]
    s_add_u32 s65, s61, 0
    s_and_b32 s65, s65, 3
    s_andn2_b32 s7, s61, 3
    v_mfma_f32_16x16x32_bf16 v[64:67], v[184:187], v[16:19], v[64:67]
    s_add_u32 s65, s65, s7
    s_lshl_b32 s65, s65, 17
    s_add_u32 s65, s65, s66
    v_mfma_f32_16x16x32_bf16 v[68:71], v[188:191], v[16:19], v[68:71]
    s_waitcnt lgkmcnt(5)
    s_add_u32 m0, s99, 32768
    v_mfma_f32_16x16x32_bf16 v[72:75], v[192:195], v[16:19], v[72:75]
    s_waitcnt vmcnt(5)
    s_waitcnt lgkmcnt(0)
    s_barrier
    ds_read_b128 v[32:35], v6 offset:30720
    ds_read_b128 v[36:39], v6 offset:35840
    ds_read_b128 v[40:43], v6 offset:40960
    ds_read_b128 v[16:19], v7 offset:0
    v_mfma_f32_16x16x32_bf16 v[56:59], v[196:199], v[20:23], v[56:59]
    buffer_load_dwordx4 v13, s[8:11], s65 offen offset:0 sc1 lds
    v_mfma_f32_16x16x32_bf16 v[60:63], v[200:203], v[20:23], v[60:63]
    buffer_load_dwordx4 v13, s[8:11], s65 offen offset:1024 sc1 lds
    v_mfma_f32_16x16x32_bf16 v[64:67], v[204:207], v[20:23], v[64:67]
    s_waitcnt lgkmcnt(3)
    v_add_f32 v76, v76, v32
    v_add_f32 v77, v77, v33
    v_mfma_f32_16x16x32_bf16 v[68:71], v[208:211], v[20:23], v[68:71]
    buffer_load_dwordx4 v13, s[8:11], s65 offen offset:2048 sc1 lds
    v_add_f32 v78, v78, v34
    v_add_f32 v79, v79, v35
    v_mfma_f32_16x16x32_bf16 v[72:75], v[212:215], v[20:23], v[72:75]
    s_waitcnt lgkmcnt(2)
    ds_read_b128 v[32:35], v5 offset:30720
    ds_read_b128 v[20:23], v7 offset:1024
    v_add_f32 v76, v76, v36
    v_add_f32 v77, v77, v37
    v_mfma_f32_16x16x32_bf16 v[56:59], v[216:219], v[24:27], v[56:59]
    buffer_load_dwordx4 v13, s[8:11], s65 offen offset:3072 sc1 lds
    v_add_f32 v78, v78, v38
    v_add_f32 v79, v79, v39
    v_mfma_f32_16x16x32_bf16 v[60:63], v[220:223], v[24:27], v[60:63]
    s_waitcnt lgkmcnt(3)
    ds_read_b128 v[36:39], v5 offset:35840
    v_add_f32 v76, v76, v40
    v_add_f32 v77, v77, v41
    v_mfma_f32_16x16x32_bf16 v[64:67], v[224:227], v[24:27], v[64:67]
    v_add_f32 v78, v78, v42
    v_add_f32 v79, v79, v43
    v_mfma_f32_16x16x32_bf16 v[68:71], v[228:231], v[24:27], v[68:71]
    ds_read_b128 v[40:43], v5 offset:40960
    s_waitcnt lgkmcnt(3)
    v_add_f32 v92, v92, v32
    v_add_f32 v93, v93, v33
    s_add_u32 s6, s96, 10240
    v_mfma_f32_16x16x32_bf16 v[72:75], v[232:235], v[24:27], v[72:75]
    ds_read_b128 v[24:27], v7 offset:2048
    v_add_f32 v94, v94, v34
    v_add_f32 v95, v95, v35
    v_mfma_f32_16x16x32_bf16 v[56:59], v[236:239], v[28:31], v[56:59]
    buffer_store_dwordx4 v[76:79], v44, s[8:11], s6 offen sc1
    s_waitcnt lgkmcnt(2)
    v_add_f32 v92, v92, v36
    v_add_f32 v93, v93, v37
    v_mfma_f32_16x16x32_bf16 v[60:63], v[240:243], v[28:31], v[60:63]
    v_add_f32 v94, v94, v38
    v_add_f32 v95, v95, v39
    v_mfma_f32_16x16x32_bf16 v[64:67], v[244:247], v[28:31], v[64:67]
    s_waitcnt lgkmcnt(1)
    v_add_f32 v92, v92, v40
    v_add_f32 v93, v93, v41
    v_mfma_f32_16x16x32_bf16 v[68:71], v[248:251], v[28:31], v[68:71]
    v_add_f32 v94, v94, v42
    v_add_f32 v95, v95, v43
    s_cmp_lg_u32 s71, 3
    v_mfma_f32_16x16x32_bf16 v[72:75], v[252:255], v[28:31], v[72:75]
    s_cbranch_scc1 L_nost_60
    buffer_store_dwordx4 v[92:95], v52, s[8:11], s6 offen sc1
L_nost_60:
    ds_read_b128 v[28:31], v7 offset:3072
    v_mfma_f32_16x16x32_bf16 v[76:79], v[96:99], v[16:19], 0
    s_sub_u32 s6, s71, 5
    s_and_b32 s6, s6, 3
    s_mul_i32 s7, s6, 5120
    v_mfma_f32_16x16x32_bf16 v[80:83], v[100:103], v[16:19], 0
    s_add_u32 s7, s7, s67
    s_cmp_eq_u32 s6, 3
    s_cselect_b32 s7, 155648, s7
    v_mfma_f32_16x16x32_bf16 v[84:87], v[104:107], v[16:19], 0
    v_add_u32 v12, s7, v52
    v_add_u32 v5, s67, v45
    v_mfma_f32_16x16x32_bf16 v[88:91], v[108:111], v[16:19], 0
    v_mfma_f32_16x16x32_bf16 v[92:95], v[112:115], v[16:19], 0
    ds_read_b128 v[16:19], v7 offset:4096
    v_mfma_f32_16x16x32_bf16 v[76:79], v[116:119], v[20:23], v[76:79]
    ds_write_b128 v5, v[60:63] offset:0
    v_add_u32 v5, s67, v46
    v_mfma_f32_16x16x32_bf16 v[80:83], v[120:123], v[20:23], v[80:83]
    v_mfma_f32_16x16x32_bf16 v[84:87], v[124:127], v[20:23], v[84:87]
    v_mfma_f32_16x16x32_bf16 v[88:91], v[128:131], v[20:23], v[88:91]
    s_waitcnt lgkmcnt(3)
    v_mfma_f32_16x16x32_bf16 v[92:95], v[132:135], v[20:23], v[92:95]
    ds_read_b128 v[20:23], v7 offset:5120
    v_mfma_f32_16x16x32_bf16 v[76:79], v[136:139], v[24:27], v[76:79]
    ds_write_b128 v5, v[64:67] offset:5120
    v_add_u32 v5, s67, v47
    v_mfma_f32_16x16x32_bf16 v[80:83], v[140:143], v[24:27], v[80:83]
    v_mfma_f32_16x16x32_bf16 v[84:87], v[144:147], v[24:27], v[84:87]
    v_mfma_f32_16x16x32_bf16 v[88:91], v[148:151], v[24:27], v[88:91]
    s_waitcnt lgkmcnt(4)
    v_mfma_f32_16x16x32_bf16 v[92:95], v[152:155], v[24:27], v[92:95]
    ds_read_b128 v[24:27], v7 offset:6144
    v_mfma_f32_16x16x32_bf16 v[76:79], v[156:159], v[28:31], v[76:79]
    ds_write_b128 v5, v[68:71] offset:10240
    v_add_u32 v5, s67, v52
    v_mfma_f32_16x16x32_bf16 v[80:83], v[160:163], v[28:31], v[80:83]
    v_mfma_f32_16x16x32_bf16 v[84:87], v[164:167], v[28:31], v[84:87]
    v_mfma_f32_16x16x32_bf16 v[88:91], v[168:171], v[28:31], v[88:91]
    s_waitcnt lgkmcnt(5)
    v_mfma_f32_16x16x32_bf16 v[92:95], v[172:175], v[28:31], v[92:95]
    ds_read_b128 v[28:31], v7 offset:7168
    v_mfma_f32_16x16x32_bf16 v[76:79], v[176:179], v[16:19], v[76:79]
    ds_write_b128 v12, v[72:75] offset:0
    v_mfma_f32_16x16x32_bf16 v[80:83], v[180:183], v[16:19], v[80:83]
    v_mfma_f32_16x16x32_bf16 v[84:87], v[184:187], v[16:19], v[84:87]
    v_mfma_f32_16x16x32_bf16 v[88:91], v[188:191], v[16:19], v[88:91]
    s_waitcnt lgkmcnt(5)
    v_mfma_f32_16x16x32_bf16 v[92:95], v[192:195], v[16:19], v[92:95]
    s_waitcnt vmcnt(5)
    s_waitcnt lgkmcnt(0)
    s_barrier
    ds_read_b128 v[32:35], v6 offset:0
    ds_read_b128 v[36:39], v6 offset:5120
    ds_read_b128 v[40:43], v6 offset:10240
    ds_read_b128 v[16:19], v4 offset:0
    v_mfma_f32_16x16x32_bf16 v[76:79], v[196:199], v[20:23], v[76:79]
    v_mfma_f32_16x16x32_bf16 v[80:83], v[200:203], v[20:23], v[80:83]
    v_mfma_f32_16x16x32_bf16 v[84:87], v[204:207], v[20:23], v[84:87]
    s_waitcnt lgkmcnt(3)
    v_add_f32 v56, v56, v32
    v_add_f32 v57, v57, v33
    v_mfma_f32_16x16x32_bf16 v[88:91], v[208:211], v[20:23], v[88:91]
    v_add_f32 v58, v58, v34
    v_add_f32 v59, v59, v35
    v_mfma_f32_16x16x32_bf16 v[92:95], v[212:215], v[20:23], v[92:95]
    s_waitcnt lgkmcnt(2)
    ds_read_b128 v[32:35], v5 offset:0
    ds_read_b128 v[20:23], v4 offset:1024
    v_add_f32 v56, v56, v36
    v_add_f32 v57, v57, v37
    v_mfma_f32_16x16x32_bf16 v[76:79], v[216:219], v[24:27], v[76:79]
    v_add_f32 v58, v58, v38
    v_add_f32 v59, v59, v39
    v_mfma_f32_16x16x32_bf16 v[80:83], v[220:223], v[24:27], v[80:83]
    s_waitcnt lgkmcnt(3)
    ds_read_b128 v[36:39], v5 offset:5120
    v_add_f32 v56, v56, v40
    v_add_f32 v57, v57, v41
    v_mfma_f32_16x16x32_bf16 v[84:87], v[224:227], v[24:27], v[84:87]
    v_add_f32 v58, v58, v42
    v_add_f32 v59, v59, v43
    v_mfma_f32_16x16x32_bf16 v[88:91], v[228:231], v[24:27], v[88:91]
    ds_read_b128 v[40:43], v5 offset:10240
    s_waitcnt lgkmcnt(3)
    v_add_f32 v72, v72, v32
    v_add_f32 v73, v73, v33
    s_add_u32 s6, s97, 10240
    v_mfma_f32_16x16x32_bf16 v[92:95], v[232:235], v[24:27], v[92:95]
    ds_read_b128 v[24:27], v4 offset:2048
    v_add_f32 v74, v74, v34
    v_add_f32 v75, v75, v35
    v_mfma_f32_16x16x32_bf16 v[76:79], v[236:239], v[28:31], v[76:79]
    buffer_store_dwordx4 v[56:59], v44, s[8:11], s6 offen sc1
    s_waitcnt lgkmcnt(2)
    v_add_f32 v72, v72, v36
    v_add_f32 v73, v73, v37
    v_mfma_f32_16x16x32_bf16 v[80:83], v[240:243], v[28:31], v[80:83]
    v_add_f32 v74, v74, v38
    v_add_f32 v75, v75, v39
    v_mfma_f32_16x16x32_bf16 v[84:87], v[244:247], v[28:31], v[84:87]
    s_waitcnt lgkmcnt(1)
    v_add_f32 v72, v72, v40
    v_add_f32 v73, v73, v41
    v_mfma_f32_16x16x32_bf16 v[88:91], v[248:251], v[28:31], v[88:91]
    v_add_f32 v74, v74, v42
    v_add_f32 v75, v75, v43
    s_cmp_lg_u32 s71, 0
    v_mfma_f32_16x16x32_bf16 v[92:95], v[252:255], v[28:31], v[92:95]
    s_cbranch_scc1 L_nost_61
    buffer_store_dwordx4 v[72:75], v52, s[8:11], s6 offen sc1
L_nost_61:
    ds_read_b128 v[28:31], v4 offset:3072
    v_mfma_f32_16x16x32_bf16 v[56:59], v[96:99], v[16:19], 0
    s_sub_u32 s6, s71, 6
    s_and_b32 s6, s6, 3
    s_mul_i32 s7, s6, 5120
    v_mfma_f32_16x16x32_bf16 v[60:63], v[100:103], v[16:19], 0
    s_add_u32 s7, s7, s67
    s_cmp_eq_u32 s6, 3
    s_cselect_b32 s7, 124928, s7
    v_mfma_f32_16x16x32_bf16 v[64:67], v[104:107], v[16:19], 0
    v_add_u32 v12, s7, v52
    v_add_u32 v5, s67, v45
    v_mfma_f32_16x16x32_bf16 v[68:71], v[108:111], v[16:19], 0
    v_mfma_f32_16x16x32_bf16 v[72:75], v[112:115], v[16:19], 0
    ds_read_b128 v[16:19], v4 offset:4096
    v_mfma_f32_16x16x32_bf16 v[56:59], v[116:119], v[20:23], v[56:59]
    ds_write_b128 v5, v[80:83] offset:30720
    v_add_u32 v5, s67, v46
    v_mfma_f32_16x16x32_bf16 v[60:63], v[120:123], v[20:23], v[60:63]
    v_mfma_f32_16x16x32_bf16 v[64:67], v[124:127], v[20:23], v[64:67]
    v_mfma_f32_16x16x32_bf16 v[68:71], v[128:131], v[20:23], v[68:71]
    s_waitcnt lgkmcnt(3)
    v_mfma_f32_16x16x32_bf16 v[72:75], v[132:135], v[20:23], v[72:75]
    ds_read_b128 v[20:23], v4 offset:5120
    v_mfma_f32_16x16x32_bf16 v[56:59], v[136:139], v[24:27], v[56:59]
    ds_write_b128 v5, v[84:87] offset:35840
    v_add_u32 v5, s67, v47
    v_mfma_f32_16x16x32_bf16 v[60:63], v[140:143], v[24:27], v[60:63]
    v_mfma_f32_16x16x32_bf16 v[64:67], v[144:147], v[24:27], v[64:67]
    v_mfma_f32_16x16x32_bf16 v[68:71], v[148:151], v[24:27], v[68:71]
    s_waitcnt lgkmcnt(4)
    v_mfma_f32_16x16x32_bf16 v[72:75], v[152:155], v[24:27], v[72:75]
    ds_read_b128 v[24:27], v4 offset:6144
    v_mfma_f32_16x16x32_bf16 v[56:59], v[156:159], v[28:31], v[56:59]
    ds_write_b128 v5, v[88:91] offset:40960
    v_add_u32 v5, s67, v52
    v_mfma_f32_16x16x32_bf16 v[60:63], v[160:163], v[28:31], v[60:63]
    v_mfma_f32_16x16x32_bf16 v[64:67], v[164:167], v[28:31], v[64:67]
    v_mfma_f32_16x16x32_bf16 v[68:71], v[168:171], v[28:31], v[68:71]
    s_waitcnt lgkmcnt(5)
    v_mfma_f32_16x16x32_bf16 v[72:75], v[172:175], v[28:31], v[72:75]
    ds_read_b128 v[28:31], v4 offset:7168
    v_mfma_f32_16x16x32_bf16 v[56:59], v[176:179], v[16:19], v[56:59]
    ds_write_b128 v12, v[92:95] offset:30720
    v_mfma_f32_16x16x32_bf16 v[60:63], v[180:183], v[16:19], v[60:63]
    v_mfma_f32_16x16x32_bf16 v[64:67], v[184:187], v[16:19], v[64:67]
    v_mov_b32 v2, 1
    v_writelane_b32 v2, 2, 0
    v_mfma_f32_16x16x32_bf16 v[68:71], v[188:191], v[16:19], v[68:71]
    s_waitcnt lgkmcnt(5)
    v_mfma_f32_16x16x32_bf16 v[72:75], v[192:195], v[16:19], v[72:75]
    s_waitcnt vmcnt(1)
    buffer_store_dword v2, v11, s[8:11], 0 offen sc1
    s_waitcnt lgkmcnt(0)
    s_barrier
    ds_read_b128 v[32:35], v6 offset:30720
    ds_read_b128 v[36:39], v6 offset:35840
    ds_read_b128 v[40:43], v6 offset:40960
    ds_read_b128 v[16:19], v4 offset:32768
    v_mfma_f32_16x16x32_bf16 v[56:59], v[196:199], v[20:23], v[56:59]
    v_mfma_f32_16x16x32_bf16 v[60:63], v[200:203], v[20:23], v[60:63]
    v_mfma_f32_16x16x32_bf16 v[64:67], v[204:207], v[20:23], v[64:67]
    s_waitcnt lgkmcnt(3)
    v_add_f32 v76, v76, v32
    v_add_f32 v77, v77, v33
    v_mfma_f32_16x16x32_bf16 v[68:71], v[208:211], v[20:23], v[68:71]
    v_add_f32 v78, v78, v34
    v_add_f32 v79, v79, v35
    v_mfma_f32_16x16x32_bf16 v[72:75], v[212:215], v[20:23], v[72:75]
    s_waitcnt lgkmcnt(2)
    ds_read_b128 v[32:35], v5 offset:30720
    ds_read_b128 v[20:23], v4 offset:33792
    v_add_f32 v76, v76, v36
    v_add_f32 v77, v77, v37
    v_mfma_f32_16x16x32_bf16 v[56:59], v[216:219], v[24:27], v[56:59]
    v_add_f32 v78, v78, v38
    v_add_f32 v79, v79, v39
    v_mfma_f32_16x16x32_bf16 v[60:63], v[220:223], v[24:27], v[60:63]
    s_waitcnt lgkmcnt(3)
    ds_read_b128 v[36:39], v5 offset:35840
    v_add_f32 v76, v76, v40
    v_add_f32 v77, v77, v41
    v_mfma_f32_16x16x32_bf16 v[64:67], v[224:227], v[24:27], v[64:67]
    v_add_f32 v78, v78, v42
    v_add_f32 v79, v79, v43
    v_mfma_f32_16x16x32_bf16 v[68:71], v[228:231], v[24:27], v[68:71]
    ds_read_b128 v[40:43], v5 offset:40960
    s_waitcnt lgkmcnt(3)
    v_add_f32 v92, v92, v32
    v_add_f32 v93, v93, v33
    s_add_u32 s6, s98, 10240
    v_mfma_f32_16x16x32_bf16 v[72:75], v[232:235], v[24:27], v[72:75]
    ds_read_b128 v[24:27], v4 offset:34816
    v_add_f32 v94, v94, v34
    v_add_f32 v95, v95, v35
    v_mfma_f32_16x16x32_bf16 v[56:59], v[236:239], v[28:31], v[56:59]
    buffer_store_dwordx4 v[76:79], v44, s[8:11], s6 offen sc1
    s_waitcnt lgkmcnt(2)
    v_add_f32 v92, v92, v36
    v_add_f32 v93, v93, v37
    v_mfma_f32_16x16x32_bf16 v[60:63], v[240:243], v[28:31], v[60:63]
    v_add_f32 v94, v94, v38
    v_add_f32 v95, v95, v39
    v_mfma_f32_16x16x32_bf16 v[64:67], v[244:247], v[28:31], v[64:67]
    s_waitcnt lgkmcnt(1)
    v_add_f32 v92, v92, v40
    v_add_f32 v93, v93, v41
    v_mfma_f32_16x16x32_bf16 v[68:71], v[248:251], v[28:31], v[68:71]
    v_add_f32 v94, v94, v42
    v_add_f32 v95, v95, v43
    s_cmp_lg_u32 s71, 1
    v_mfma_f32_16x16x32_bf16 v[72:75], v[252:255], v[28:31], v[72:75]
    s_cbranch_scc1 L_nost_62
    buffer_store_dwordx4 v[92:95], v52, s[8:11], s6 offen sc1
L_nost_62:
    ds_read_b128 v[28:31], v4 offset:35840
    v_mfma_f32_16x16x32_bf16 v[76:79], v[96:99], v[16:19], 0
    v_mfma_f32_16x16x32_bf16 v[80:83], v[100:103], v[16:19], 0
    v_mfma_f32_16x16x32_bf16 v[84:87], v[104:107], v[16:19], 0
    s_mul_i32 s73, s3, 5120
    s_add_u32 s6, s73, 65536
    v_mfma_f32_16x16x32_bf16 v[88:91], v[108:111], v[16:19], 0
    v_add_u32 v5, s6, v44
    v_mfma_f32_16x16x32_bf16 v[92:95], v[112:115], v[16:19], 0
    ds_read_b128 v[16:19], v4 offset:36864
    v_mfma_f32_16x16x32_bf16 v[76:79], v[116:119], v[20:23], v[76:79]
    ds_write_b128 v5, v[56:59]
    s_add_u32 s6, s73, 65536
    v_add_u32 v5, s6, v45
    v_mfma_f32_16x16x32_bf16 v[80:83], v[120:123], v[20:23], v[80:83]
    v_mfma_f32_16x16x32_bf16 v[84:87], v[124:127], v[20:23], v[84:87]
    v_mfma_f32_16x16x32_bf16 v[88:91], v[128:131], v[20:23], v[88:91]
    s_waitcnt lgkmcnt(3)
    v_mfma_f32_16x16x32_bf16 v[92:95], v[132:135], v[20:23], v[92:95]
    ds_read_b128 v[20:23], v4 offset:37888
    v_mfma_f32_16x16x32_bf16 v[76:79], v[136:139], v[24:27], v[76:79]
    ds_write_b128 v5, v[60:63]
    s_add_u32 s6, s73, 65536
    v_add_u32 v5, s6, v46
    v_mfma_f32_16x16x32_bf16 v[80:83], v[140:143], v[24:27], v[80:83]
    v_mfma_f32_16x16x32_bf16 v[84:87], v[144:147], v[24:27], v[84:87]
    v_mfma_f32_16x16x32_bf16 v[88:91], v[148:151], v[24:27], v[88:91]
    s_waitcnt lgkmcnt(4)
    v_mfma_f32_16x16x32_bf16 v[92:95], v[152:155], v[24:27], v[92:95]
    ds_read_b128 v[24:27], v4 offset:38912
    v_mfma_f32_16x16x32_bf16 v[76:79], v[156:159], v[28:31], v[76:79]
    ds_write_b128 v5, v[64:67]
    s_add_u32 s6, s73, 65536
    v_add_u32 v5, s6, v47
    v_mfma_f32_16x16x32_bf16 v[80:83], v[160:163], v[28:31], v[80:83]
    v_mov_b32 v2, 2
    s_waitcnt vmcnt(0)
    buffer_store_dword v2, v11, s[8:11], 0 offen sc1
    v_mfma_f32_16x16x32_bf16 v[84:87], v[164:167], v[28:31], v[84:87]
    v_mfma_f32_16x16x32_bf16 v[88:91], v[168:171], v[28:31], v[88:91]
    s_waitcnt lgkmcnt(5)
    s_cmp_eq_u32 s64, 0
    s_cbranch_scc1 L_nb
    v_bfe_u32 v2, v1, 1, 3
    v_and_b32 v3, 1, v1
    v_lshl_add_u32 v3, v2, 7, v3
    v_lshlrev_b32 v3, 2, v3
    s_and_b32 s6, s4, 3
    s_lshl_b32 s6, s6, 7
    s_add_u32 s6, s6, 3911680
    s_mov_b32 s79, 262144
L_poll_63:
    buffer_load_dword v2, v3, s[8:11], s6 offen sc1
    s_waitcnt vmcnt(0)
    v_cmp_ne_u32 vcc, 1, v2
    s_cbranch_vccz L_polldone_64
    s_sleep 2
    s_sub_u32 s79, s79, 1
    s_cmp_lg_u32 s79, 0
    s_cbranch_scc1 L_poll_63
L_polldone_64:
L_nb:
    buffer_load_dwordx4 v[96:99], v53, s[12:15], s70 offen
    buffer_load_dwordx4 v[100:103], v48, s[8:11], 0 offen sc1
    s_cmp_ge_u32 s3, 2
    s_cbranch_scc1 L_itskip_65
    buffer_load_dwordx4 v[104:107], v54, s[12:15], s70 offen
    buffer_load_dwordx4 v[108:111], v49, s[8:11], 0 offen sc1
L_itskip_65:
    v_mfma_f32_16x16x32_bf16 v[92:95], v[172:175], v[28:31], v[92:95]
    ds_read_b128 v[28:31], v4 offset:39936
    v_mfma_f32_16x16x32_bf16 v[76:79], v[176:179], v[16:19], v[76:79]
    ds_write_b128 v5, v[68:71]
    s_add_u32 s6, s73, 65536
    v_add_u32 v5, s6, v52
    v_mfma_f32_16x16x32_bf16 v[80:83], v[180:183], v[16:19], v[80:83]
    v_mfma_f32_16x16x32_bf16 v[84:87], v[184:187], v[16:19], v[84:87]
    v_mfma_f32_16x16x32_bf16 v[88:91], v[188:191], v[16:19], v[88:91]
    s_waitcnt lgkmcnt(5)
    v_mfma_f32_16x16x32_bf16 v[92:95], v[192:195], v[16:19], v[92:95]
    v_mfma_f32_16x16x32_bf16 v[76:79], v[196:199], v[20:23], v[76:79]
    ds_write_b128 v5, v[72:75]
    v_mfma_f32_16x16x32_bf16 v[80:83], v[200:203], v[20:23], v[80:83]
    v_mfma_f32_16x16x32_bf16 v[84:87], v[204:207], v[20:23], v[84:87]
    v_mfma_f32_16x16x32_bf16 v[88:91], v[208:211], v[20:23], v[88:91]
    s_waitcnt lgkmcnt(4)
    v_mfma_f32_16x16x32_bf16 v[92:95], v[212:215], v[20:23], v[92:95]
    v_mfma_f32_16x16x32_bf16 v[76:79], v[216:219], v[24:27], v[76:79]
    v_bfe_u32 v2, v1, 3, 2
    v_min_u32 v2, 2, v2
    v_and_b32 v3, 7, v1
    v_lshlrev_b32 v3, 2, v3
    v_lshl_add_u32 v3, v2, 7, v3
    v_mfma_f32_16x16x32_bf16 v[80:83], v[220:223], v[24:27], v[80:83]
    s_bitcmp1_b32 13, s3
    s_cselect_b32 s77, 1, 2
    buffer_load_dword v50, v3, s[8:11], s63 offen sc1
    v_mfma_f32_16x16x32_bf16 v[84:87], v[224:227], v[24:27], v[84:87]
    v_mfma_f32_16x16x32_bf16 v[88:91], v[228:231], v[24:27], v[88:91]
    s_waitcnt lgkmcnt(2)
    s_add_u32 s6, s73, 86016
    s_cmp_lt_u32 s3, 4
    s_cselect_b32 s73, s73, s6
    v_mfma_f32_16x16x32_bf16 v[92:95], v[232:235], v[24:27], v[92:95]
    v_mfma_f32_16x16x32_bf16 v[76:79], v[236:239], v[28:31], v[76:79]
    v_mfma_f32_16x16x32_bf16 v[80:83], v[240:243], v[28:31], v[80:83]
    v_mfma_f32_16x16x32_bf16 v[84:87], v[244:247], v[28:31], v[84:87]
    v_mfma_f32_16x16x32_bf16 v[88:91], v[248:251], v[28:31], v[88:91]
    v_mfma_f32_16x16x32_bf16 v[92:95], v[252:255], v[28:31], v[92:95]
    s_nop 4
    v_add_u32 v5, s73, v44
    ds_write_b128 v5, v[76:79]
    v_add_u32 v5, s73, v45
    ds_write_b128 v5, v[80:83]
    v_add_u32 v5, s73, v46
    ds_write_b128 v5, v[84:87]
    v_add_u32 v5, s73, v47
    ds_write_b128 v5, v[88:91]
    v_add_u32 v5, s73, v52
    ds_write_b128 v5, v[92:95]
    s_waitcnt vmcnt(0)
    v_cmp_gt_u32 s[78:79], s77, v50
    s_nop 3
    s_cmp_lg_u64 s[78:79], 0
    s_cbranch_scc1 L_x2a
    s_add_u32 s6, s62, 0
    buffer_load_dwordx4 v[112:115], v8, s[8:11], s6 offen offset:0 sc1
    buffer_load_dwordx4 v[116:119], v8, s[8:11], s6 offen offset:256 sc1
    s_add_u32 s6, s62, 20480
    buffer_load_dwordx4 v[120:123], v8, s[8:11], s6 offen offset:0 sc1
    buffer_load_dwordx4 v[124:127], v8, s[8:11], s6 offen offset:256 sc1
    s_add_u32 s6, s62, 40960
    buffer_load_dwordx4 v[128:131], v8, s[8:11], s6 offen offset:0 sc1
    buffer_load_dwordx4 v[132:135], v8, s[8:11], s6 offen offset:256 sc1
    s_cmp_ge_u32 s3, 2
    s_cbranch_scc1 L_xi_66
    s_add_u32 s6, s62, 0
    buffer_load_dwordx4 v[136:139], v9, s[8:11], s6 offen offset:0 sc1
    buffer_load_dwordx4 v[140:143], v9, s[8:11], s6 offen offset:256 sc1
    s_add_u32 s6, s62, 20480
    buffer_load_dwordx4 v[144:147], v9, s[8:11], s6 offen offset:0 sc1
    buffer_load_dwordx4 v[148:151], v9, s[8:11], s6 offen offset:256 sc1
    s_add_u32 s6, s62, 40960
    buffer_load_dwordx4 v[152:155], v9, s[8:11], s6 offen offset:0 sc1
    buffer_load_dwordx4 v[156:159], v9, s[8:11], s6 offen offset:256 sc1
L_xi_66:
L_x2a:
    s_waitcnt lgkmcnt(0)
    s_barrier
    ds_read_b128 v[160:163], v10 offset:0
    ds_read_b128 v[164:167], v10 offset:256
    ds_read_b128 v[168:171], v10 offset:5120
    ds_read_b128 v[172:175], v10 offset:5376
    ds_read_b128 v[176:179], v10 offset:10240
    ds_read_b128 v[180:183], v10 offset:10496
    ds_read_b128 v[184:187], v10 offset:15360
    ds_read_b128 v[188:191], v10 offset:15616
    ds_read_b128 v[192:195], v55 offset:0
    ds_read_b128 v[196:199], v55 offset:256
    ds_read_b128 v[200:203], v55 offset:5120
    ds_read_b128 v[204:207], v55 offset:5376
    ds_read_b128 v[208:211], v55 offset:10240
    ds_read_b128 v[212:215], v55 offset:10496
    ds_read_b128 v[216:219], v55 offset:15360
    ds_read_b128 v[220:223], v55 offset:15616
    s_cmp_eq_u64 s[78:79], 0
    s_cbranch_scc1 L_x2b
    s_mov_b32 s79, 262144
L_poll_67:
    buffer_load_dword v2, v3, s[8:11], s63 offen sc1
    s_waitcnt vmcnt(0)
    v_cmp_gt_u32 vcc, s77, v2
    s_cbranch_vccz L_polldone_68
    s_sleep 1
    s_sub_u32 s79, s79, 1
    s_cmp_lg_u32 s79, 0
    s_cbranch_scc1 L_poll_67
L_polldone_68:
    s_add_u32 s6, s62, 0
    buffer_load_dwordx4 v[112:115], v8, s[8:11], s6 offen offset:0 sc1
    buffer_load_dwordx4 v[116:119], v8, s[8:11], s6 offen offset:256 sc1
    s_add_u32 s6, s62, 20480
    buffer_load_dwordx4 v[120:123], v8, s[8:11], s6 offen offset:0 sc1
    buffer_load_dwordx4 v[124:127], v8, s[8:11], s6 offen offset:256 sc1
    s_add_u32 s6, s62, 40960
    buffer_load_dwordx4 v[128:131], v8, s[8:11], s6 offen offset:0 sc1
    buffer_load_dwordx4 v[132:135], v8, s[8:11], s6 offen offset:256 sc1
    s_cmp_ge_u32 s3, 2
    s_cbranch_scc1 L_xi_69
    s_add_u32 s6, s62, 0
    buffer_load_dwordx4 v[136:139], v9, s[8:11], s6 offen offset:0 sc1
    buffer_load_dwordx4 v[140:143], v9, s[8:11], s6 offen offset:256 sc1
    s_add_u32 s6, s62, 20480
    buffer_load_dwordx4 v[144:147], v9, s[8:11], s6 offen offset:0 sc1
    buffer_load_dwordx4 v[148:151], v9, s[8:11], s6 offen offset:256 sc1
    s_add_u32 s6, s62, 40960
    buffer_load_dwordx4 v[152:155], v9, s[8:11], s6 offen offset:0 sc1
    buffer_load_dwordx4 v[156:159], v9, s[8:11], s6 offen offset:256 sc1
L_xi_69:
L_x2b:
    s_mov_b32 s16, s54
    s_mov_b32 s17, s55
    s_mov_b32 s18, 0x280000
    s_mov_b32 s19, 0x20000
    s_waitcnt lgkmcnt(8)
    v_pk_add_f32 v[160:161], v[160:161], v[168:169]
    v_pk_add_f32 v[162:163], v[162:163], v[170:171]
    v_pk_add_f32 v[164:165], v[164:165], v[172:173]
    v_pk_add_f32 v[166:167], v[166:167], v[174:175]
    v_pk_add_f32 v[160:161], v[160:161], v[176:177]
    v_pk_add_f32 v[162:163], v[162:163], v[178:179]
    v_pk_add_f32 v[164:165], v[164:165], v[180:181]
    v_pk_add_f32 v[166:167], v[166:167], v[182:183]
    v_pk_add_f32 v[160:161], v[160:161], v[184:185]
    v_pk_add_f32 v[162:163], v[162:163], v[186:187]
    v_pk_add_f32 v[164:165], v[164:165], v[188:189]
    v_pk_add_f32 v[166:167], v[166:167], v[190:191]
    s_waitcnt vmcnt(0)
    v_pk_add_f32 v[160:161], v[160:161], v[112:113]
    v_pk_add_f32 v[162:163], v[162:163], v[114:115]
    v_pk_add_f32 v[164:165], v[164:165], v[116:117]
    v_pk_add_f32 v[166:167], v[166:167], v[118:119]
    v_pk_add_f32 v[160:161], v[160:161], v[120:121]
    v_pk_add_f32 v[162:163], v[162:163], v[122:123]
    v_pk_add_f32 v[164:165], v[164:165], v[124:125]
    v_pk_add_f32 v[166:167], v[166:167], v[126:127]
    v_pk_add_f32 v[160:161], v[160:161], v[128:129]
    v_pk_add_f32 v[162:163], v[162:163], v[130:131]
    v_pk_add_f32 v[164:165], v[164:165], v[132:133]
    v_pk_add_f32 v[166:167], v[166:167], v[134:135]
    v_cvt_pk_bf16_f32 v2, v160, v161
    v_lshlrev_b32 v160, 16, v2
    v_and_b32 v161, 0xffff0000, v2
    v_lshlrev_b32 v2, 16, v96
    v_and_b32 v3, 0xffff0000, v96
    v_pk_add_f32 v[160:161], v[160:161], v[2:3]
    v_cvt_pk_bf16_f32 v2, v160, v161
    v_lshlrev_b32 v160, 16, v2
    v_and_b32 v161, 0xffff0000, v2
    v_lshlrev_b32 v2, 16, v100
    v_and_b32 v3, 0xffff0000, v100
    v_pk_add_f32 v[160:161], v[160:161], v[2:3]
    v_cvt_pk_bf16_f32 v224, v160, v161
    v_cvt_pk_bf16_f32 v2, v162, v163
    v_lshlrev_b32 v162, 16, v2
    v_and_b32 v163, 0xffff0000, v2
    v_lshlrev_b32 v2, 16, v97
    v_and_b32 v3, 0xffff0000, v97
    v_pk_add_f32 v[162:163], v[162:163], v[2:3]
    v_cvt_pk_bf16_f32 v2, v162, v163
    v_lshlrev_b32 v162, 16, v2
    v_and_b32 v163, 0xffff0000, v2
    v_lshlrev_b32 v2, 16, v101
    v_and_b32 v3, 0xffff0000, v101
    v_pk_add_f32 v[162:163], v[162:163], v[2:3]
    v_cvt_pk_bf16_f32 v225, v162, v163
    v_cvt_pk_bf16_f32 v2, v164, v165
    v_lshlrev_b32 v164, 16, v2
    v_and_b32 v165, 0xffff0000, v2
    v_lshlrev_b32 v2, 16, v98
    v_and_b32 v3, 0xffff0000, v98
    v_pk_add_f32 v[164:165], v[164:165], v[2:3]
    v_cvt_pk_bf16_f32 v2, v164, v165
    v_lshlrev_b32 v164, 16, v2
    v_and_b32 v165, 0xffff0000, v2
    v_lshlrev_b32 v2, 16, v102
    v_and_b32 v3, 0xffff0000, v102
    v_pk_add_f32 v[164:165], v[164:165], v[2:3]
    v_cvt_pk_bf16_f32 v226, v164, v165
    v_cvt_pk_bf16_f32 v2, v166, v167
    v_lshlrev_b32 v166, 16, v2
    v_and_b32 v167, 0xffff0000, v2
    v_lshlrev_b32 v2, 16, v99
    v_and_b32 v3, 0xffff0000, v99
    v_pk_add_f32 v[166:167], v[166:167], v[2:3]
    v_cvt_pk_bf16_f32 v2, v166, v167
    v_lshlrev_b32 v166, 16, v2
    v_and_b32 v167, 0xffff0000, v2
    v_lshlrev_b32 v2, 16, v103
    v_and_b32 v3, 0xffff0000, v103
    v_pk_add_f32 v[166:167], v[166:167], v[2:3]
    v_cvt_pk_bf16_f32 v227, v166, v167
    buffer_store_dwordx4 v[224:227], v53, s[16:19], s70 offen
    s_cmp_ge_u32 s3, 2
    s_cbranch_scc1 L_end
    s_waitcnt lgkmcnt(0)
    v_pk_add_f32 v[192:193], v[192:193], v[200:201]
    v_pk_add_f32 v[194:195], v[194:195], v[202:203]
    v_pk_add_f32 v[196:197], v[196:197], v[204:205]
    v_pk_add_f32 v[198:199], v[198:199], v[206:207]
    v_pk_add_f32 v[192:193], v[192:193], v[208:209]
    v_pk_add_f32 v[194:195], v[194:195], v[210:211]
    v_pk_add_f32 v[196:197], v[196:197], v[212:213]
    v_pk_add_f32 v[198:199], v[198:199], v[214:215]
    v_pk_add_f32 v[192:193], v[192:193], v[216:217]
    v_pk_add_f32 v[194:195], v[194:195], v[218:219]
    v_pk_add_f32 v[196:197], v[196:197], v[220:221]
    v_pk_add_f32 v[198:199], v[198:199], v[222:223]
    s_nop 0
    v_pk_add_f32 v[192:193], v[192:193], v[136:137]
    v_pk_add_f32 v[194:195], v[194:195], v[138:139]
    v_pk_add_f32 v[196:197], v[196:197], v[140:141]
    v_pk_add_f32 v[198:199], v[198:199], v[142:143]
    v_pk_add_f32 v[192:193], v[192:193], v[144:145]
    v_pk_add_f32 v[194:195], v[194:195], v[146:147]
    v_pk_add_f32 v[196:197], v[196:197], v[148:149]
    v_pk_add_f32 v[198:199], v[198:199], v[150:151]
    v_pk_add_f32 v[192:193], v[192:193], v[152:153]
    v_pk_add_f32 v[194:195], v[194:195], v[154:155]
    v_pk_add_f32 v[196:197], v[196:197], v[156:157]
    v_pk_add_f32 v[198:199], v[198:199], v[158:159]
    v_cvt_pk_bf16_f32 v2, v192, v193
    v_lshlrev_b32 v192, 16, v2
    v_and_b32 v193, 0xffff0000, v2
    v_lshlrev_b32 v2, 16, v104
    v_and_b32 v3, 0xffff0000, v104
    v_pk_add_f32 v[192:193], v[192:193], v[2:3]
    v_cvt_pk_bf16_f32 v2, v192, v193
    v_lshlrev_b32 v192, 16, v2
    v_and_b32 v193, 0xffff0000, v2
    v_lshlrev_b32 v2, 16, v108
    v_and_b32 v3, 0xffff0000, v108
    v_pk_add_f32 v[192:193], v[192:193], v[2:3]
    v_cvt_pk_bf16_f32 v228, v192, v193
    v_cvt_pk_bf16_f32 v2, v194, v195
    v_lshlrev_b32 v194, 16, v2
    v_and_b32 v195, 0xffff0000, v2
    v_lshlrev_b32 v2, 16, v105
    v_and_b32 v3, 0xffff0000, v105
    v_pk_add_f32 v[194:195], v[194:195], v[2:3]
    v_cvt_pk_bf16_f32 v2, v194, v195
    v_lshlrev_b32 v194, 16, v2
    v_and_b32 v195, 0xffff0000, v2
    v_lshlrev_b32 v2, 16, v109
    v_and_b32 v3, 0xffff0000, v109
    v_pk_add_f32 v[194:195], v[194:195], v[2:3]
    v_cvt_pk_bf16_f32 v229, v194, v195
    v_cvt_pk_bf16_f32 v2, v196, v197
    v_lshlrev_b32 v196, 16, v2
    v_and_b32 v197, 0xffff0000, v2
    v_lshlrev_b32 v2, 16, v106
    v_and_b32 v3, 0xffff0000, v106
    v_pk_add_f32 v[196:197], v[196:197], v[2:3]
    v_cvt_pk_bf16_f32 v2, v196, v197
    v_lshlrev_b32 v196, 16, v2
    v_and_b32 v197, 0xffff0000, v2
    v_lshlrev_b32 v2, 16, v110
    v_and_b32 v3, 0xffff0000, v110
    v_pk_add_f32 v[196:197], v[196:197], v[2:3]
    v_cvt_pk_bf16_f32 v230, v196, v197
    v_cvt_pk_bf16_f32 v2, v198, v199
    v_lshlrev_b32 v198, 16, v2
    v_and_b32 v199, 0xffff0000, v2
    v_lshlrev_b32 v2, 16, v107
    v_and_b32 v3, 0xffff0000, v107
    v_pk_add_f32 v[198:199], v[198:199], v[2:3]
    v_cvt_pk_bf16_f32 v2, v198, v199
    v_lshlrev_b32 v198, 16, v2
    v_and_b32 v199, 0xffff0000, v2
    v_lshlrev_b32 v2, 16, v111
    v_and_b32 v3, 0xffff0000, v111
    v_pk_add_f32 v[198:199], v[198:199], v[2:3]
    v_cvt_pk_bf16_f32 v231, v198, v199
    buffer_store_dwordx4 v[228:231], v54, s[16:19], s70 offen
L_end:
L_exit:
    s_endpgm
.section .rodata,"a"
.p2align 6
.amdhsa_kernel parallel_sum__compressed_kv_cla__moe_arch_mod__prompt_kernel
  .amdhsa_next_free_vgpr 256
  .amdhsa_next_free_sgpr 102
  .amdhsa_accum_offset 256
  .amdhsa_group_segment_fixed_size 0
  .amdhsa_kernarg_size 112
  .amdhsa_user_sgpr_count 2
  .amdhsa_user_sgpr_kernarg_segment_ptr 1
  .amdhsa_system_sgpr_workgroup_id_x 1
  .amdhsa_float_denorm_mode_32 3
.end_amdhsa_kernel
```

```asm
; @launch grid=(256,1,1) block=(512,1,1) lds=163840
.amdgcn_target "amdgcn-amd-amdhsa--gfx950"
.text
.globl parallel_sum__compressed_kv_cla__moe_arch_mod__prompt_kernel
.p2align 8
.type parallel_sum__compressed_kv_cla__moe_arch_mod__prompt_kernel,@function
parallel_sum__compressed_kv_cla__moe_arch_mod__prompt_kernel:
    s_cmp_ge_u32 s2, 256
    s_cbranch_scc1 L_exit
    s_load_dwordx16 s[32:47], s[0:1], 0
    s_load_dwordx8 s[48:55], s[0:1], 64
    s_load_dwordx4 s[56:59], s[0:1], 96
    v_lshrrev_b32 v2, 6, v0
    v_and_b32 v1, 63, v0
    v_readfirstlane_b32 s3, v2
    s_getpc_b64 s[80:81]
L_pc:
    s_lshr_b32 s6, s2, 3
    s_and_b32 s6, s6, 15
    s_lshl_b32 s6, s6, 12
    s_cmp_lt_u32 s3, 2
    s_cselect_b32 s6, 0, s6
    v_lshl_add_u32 v3, v0, 6, s6
    v_min_u32 v3, L_exit-L_pc, v3
    s_cmp_ge_u32 s3, 3
    s_cbranch_scc1 L_noct
    global_load_dword v11, v3, s[80:81]
L_noct:
    v_lshrrev_b32 v62, 5, v0
    v_and_b32 v62, 7, v62
    v_and_b32 v2, 31, v0
    v_lshlrev_b32 v2, 3, v2
    v_mul_u32_u24 v63, 1280, v62
    v_add_u32 v63, v63, v2
    s_mul_i32 s6, s2, 10240
    v_add_u32 v10, s6, v63
    s_cmp_lt_u32 s3, 4
    s_cbranch_scc1 L_st_k0
    s_waitcnt lgkmcnt(0)
    global_load_dwordx2 v[16:17], v10, s[32:33] offset:0
    global_load_dwordx2 v[18:19], v10, s[32:33] offset:256
    global_load_dwordx2 v[20:21], v10, s[32:33] offset:512
    global_load_dwordx2 v[22:23], v10, s[32:33] offset:768
    global_load_dwordx2 v[24:25], v10, s[32:33] offset:1024
    global_load_dwordx2 v[26:27], v2, s[46:47] offset:0
    global_load_dwordx2 v[28:29], v2, s[46:47] offset:256
    global_load_dwordx2 v[30:31], v2, s[46:47] offset:512
    global_load_dwordx2 v[32:33], v2, s[46:47] offset:768
    global_load_dwordx2 v[34:35], v2, s[46:47] offset:1024
    s_barrier
L_st_k0:
    s_and_b32 s6, s2, 7
    s_lshl_b32 s6, s6, 2
    s_lshr_b32 s7, s2, 3
    s_and_b32 s7, s7, 3
    s_add_u32 s4, s6, s7
    s_lshr_b32 s5, s2, 5
    s_and_b32 s76, s3, 3
    v_lshrrev_b32 v2, 3, v1
    v_and_b32 v3, 7, v1
    v_lshrrev_b32 v4, 4, v1
    v_xor_b32 v5, v3, v4
    v_lshlrev_b32 v5, 4, v5
    v_lshl_add_u32 v40, v2, 10, v5
    v_xor_b32 v5, 64, v40
    v_add_u32 v41, 7168, v5
    v_add_u32 v42, 14336, v40
    v_add_u32 v43, 14336, v41
    v_and_b32 v6, 15, v1
    s_lshl_b32 s6, s76, 4
    v_add_u32 v7, s6, v4
    v_lshlrev_b32 v5, 1, v4
    v_xor_b32 v5, v6, v5
    v_lshlrev_b32 v5, 4, v5
    v_lshl_add_u32 v44, v7, 13, v5
    v_add_u32 v45, 31744, v44
    v_xor_b32 v5, 0x80, v44
    v_add_u32 v46, 63488, v5
    v_add_u32 v47, 31744, v46
    s_and_b32 s6, s76, 1
    s_lshl_b32 s6, s6, 20
    s_lshr_b32 s7, s76, 1
    s_lshl_b32 s7, s7, 18
    s_add_u32 s6, s6, s7
    s_lshl_b32 s62, s5, 15
    s_add_u32 s62, s62, s6
    s_lshl_b32 s63, s4, 8
    s_lshl_b32 s64, s76, 13
    s_lshl_b32 s73, s76, 12
    s_add_u32 s73, s73, 32768
    s_andn2_b32 s100, 1, s5
    s_lshl_b32 s100, s100, 16
    s_add_u32 s64, s64, s100
    s_add_u32 s73, s73, s100
    s_waitcnt lgkmcnt(0)
    s_mov_b32 s12, s34
    s_mov_b32 s13, s35
    s_mov_b32 s14, 0x200000
    s_mov_b32 s15, 0x20000
    s_mov_b32 s16, s38
    s_mov_b32 s17, s39
    s_mov_b32 s18, 0x400000
    s_mov_b32 s19, 0x20000
    s_mov_b32 s20, s40
    s_mov_b32 s21, s41
    s_mov_b32 s22, 0x400000
    s_mov_b32 s23, 0x20000
    s_cmp_ge_u32 s3, 4
    s_cbranch_scc1 L_st_v0
    s_barrier
    s_mov_b32 m0, s64
    s_add_u32 s72, s62, 524288
    buffer_load_dwordx4 v40, s[12:15], s62 offen offset:0 lds
    buffer_load_dwordx4 v41, s[12:15], s62 offen offset:1024 lds
    buffer_load_dwordx4 v42, s[12:15], s62 offen offset:2048 lds
    buffer_load_dwordx4 v43, s[12:15], s62 offen offset:3072 lds
    s_add_u32 m0, s64, 4096
    s_add_u32 s62, s62, 128
    s_bitset0_b32 s62, 10
    buffer_load_dwordx4 v40, s[12:15], s72 offen offset:0 lds
    buffer_load_dwordx4 v41, s[12:15], s72 offen offset:1024 lds
    buffer_load_dwordx4 v42, s[12:15], s72 offen offset:2048 lds
    buffer_load_dwordx4 v43, s[12:15], s72 offen offset:3072 lds
    s_mov_b32 m0, s73
    s_xor_b32 s64, s64, 0x10000
    buffer_load_dwordx4 v44, s[16:19], s63 offen offset:0 lds
    buffer_load_dwordx4 v45, s[16:19], s63 offen offset:1024 lds
    buffer_load_dwordx4 v46, s[16:19], s63 offen offset:2048 lds
    buffer_load_dwordx4 v47, s[16:19], s63 offen offset:3072 lds
    s_add_u32 m0, s73, 16384
    s_xor_b32 s73, s73, 0x10000
    buffer_load_dwordx4 v44, s[20:23], s63 offen offset:0 lds
    buffer_load_dwordx4 v45, s[20:23], s63 offen offset:1024 lds
    buffer_load_dwordx4 v46, s[20:23], s63 offen offset:2048 lds
    buffer_load_dwordx4 v47, s[20:23], s63 offen offset:3072 lds
    s_add_u32 s63, s63, 524288
    s_bitset0_b32 s63, 22
    s_setprio 1
L_st_v0:
    s_mov_b32 s8, s58
    s_mov_b32 s9, s59
    s_mov_b32 s10, 0x5000000
    s_mov_b32 s11, 0x20000
    s_mov_b32 s24, s36
    s_mov_b32 s25, s37
    s_mov_b32 s26, 0x500000
    s_mov_b32 s27, 0x20000
    v_lshlrev_b32 v13, 4, v1
    s_lshl_b32 s6, s5, 2
    s_add_u32 s7, s6, s3
    s_sub_u32 s6, 56, s6
    s_add_u32 s6, s6, s3
    s_cmp_lt_u32 s3, 4
    s_cselect_b32 s60, s7, s6
    s_sub_u32 s6, 2, s5
    s_and_b32 s6, s6, 7
    s_lshl_b32 s6, s6, 5
    s_add_u32 s61, s6, s4
    v_and_b32 v2, 15, v1
    v_lshrrev_b32 v3, 4, v1
    s_and_b32 s6, s3, 1
    s_lshl_b32 s6, s6, 7
    v_add_u32 v4, s6, v2
    v_lshlrev_b32 v4, 7, v4
    v_add_u32 v4, s100, v4
    v_lshrrev_b32 v5, 1, v2
    v_add_u32 v6, 0, v3
    v_xor_b32 v6, v6, v5
    v_lshl_add_u32 v48, v6, 4, v4
    v_add_u32 v6, 4, v3
    v_xor_b32 v6, v6, v5
    v_lshl_add_u32 v49, v6, 4, v4
    v_lshrrev_b32 v4, 2, v2
    v_lshl_add_u32 v5, v3, 3, v4
    v_lshlrev_b32 v5, 8, v5
    v_and_b32 v6, 1, v2
    v_lshl_add_u32 v5, v6, 3, v5
    v_and_b32 v6, 1, v3
    v_lshl_or_b32 v4, v6, 2, v4
    v_lshlrev_b32 v4, 1, v4
    v_bfe_u32 v6, v2, 1, 1
    v_add_u32 v8, 131072, v5
    v_add_u32 v7, 0, v6
    v_xor_b32 v7, v7, v4
    v_lshl_add_u32 v54, v7, 4, v8
    v_add_u32 v7, 2, v6
    v_xor_b32 v7, v7, v4
    v_lshl_add_u32 v55, v7, 4, v8
    v_add_u32 v7, 4, v6
    v_xor_b32 v7, v7, v4
    v_lshl_add_u32 v56, v7, 4, v8
    v_add_u32 v7, 6, v6
    v_xor_b32 v7, v7, v4
    v_lshl_add_u32 v57, v7, 4, v8
    v_add_u32 v7, 8, v6
    v_xor_b32 v7, v7, v4
    v_lshl_add_u32 v58, v7, 4, v8
    v_add_u32 v7, 10, v6
    v_xor_b32 v7, v7, v4
    v_lshl_add_u32 v59, v7, 4, v8
    v_add_u32 v7, 12, v6
    v_xor_b32 v7, v7, v4
    v_lshl_add_u32 v60, v7, 4, v8
    v_add_u32 v7, 14, v6
    v_xor_b32 v7, v7, v4
    v_lshl_add_u32 v61, v7, 4, v8
    s_lshr_b32 s6, s3, 2
    s_lshl_b32 s6, s6, 14
    s_add_u32 s6, s6, 32768
    s_add_u32 s6, s6, s100
    v_add_u32 v5, s6, v5
    s_lshr_b32 s7, s3, 1
    s_and_b32 s7, s7, 1
    s_lshl_b32 s7, s7, 3
    s_add_u32 s6, s7, 0
    v_add_u32 v7, s6, v6
    v_xor_b32 v7, v7, v4
    v_lshl_add_u32 v50, v7, 4, v5
    s_add_u32 s6, s7, 2
    v_add_u32 v7, s6, v6
    v_xor_b32 v7, v7, v4
    v_lshl_add_u32 v51, v7, 4, v5
    s_add_u32 s6, s7, 4
    v_add_u32 v7, s6, v6
    v_xor_b32 v7, v7, v4
    v_lshl_add_u32 v52, v7, 4, v5
    s_add_u32 s6, s7, 6
    v_add_u32 v7, s6, v6
    v_xor_b32 v7, v7, v4
    v_lshl_add_u32 v53, v7, 4, v5
    v_mov_b64 v[128:129], 0
    v_mov_b64 v[130:131], 0
    v_mov_b64 v[132:133], 0
    v_mov_b64 v[134:135], 0
    v_mov_b64 v[136:137], 0
    v_mov_b64 v[138:139], 0
    v_mov_b64 v[140:141], 0
    v_mov_b64 v[142:143], 0
    v_mov_b64 v[144:145], 0
    v_mov_b64 v[146:147], 0
    v_mov_b64 v[148:149], 0
    v_mov_b64 v[150:151], 0
    v_mov_b64 v[152:153], 0
    v_mov_b64 v[154:155], 0
    v_mov_b64 v[156:157], 0
    v_mov_b64 v[158:159], 0
    v_mov_b64 v[160:161], 0
    v_mov_b64 v[162:163], 0
    v_mov_b64 v[164:165], 0
    v_mov_b64 v[166:167], 0
    v_mov_b64 v[168:169], 0
    v_mov_b64 v[170:171], 0
    v_mov_b64 v[172:173], 0
    v_mov_b64 v[174:175], 0
    v_mov_b64 v[176:177], 0
    v_mov_b64 v[178:179], 0
    v_mov_b64 v[180:181], 0
    v_mov_b64 v[182:183], 0
    v_mov_b64 v[184:185], 0
    v_mov_b64 v[186:187], 0
    v_mov_b64 v[188:189], 0
    v_mov_b64 v[190:191], 0
    v_mov_b64 v[192:193], 0
    v_mov_b64 v[194:195], 0
    v_mov_b64 v[196:197], 0
    v_mov_b64 v[198:199], 0
    v_mov_b64 v[200:201], 0
    v_mov_b64 v[202:203], 0
    v_mov_b64 v[204:205], 0
    v_mov_b64 v[206:207], 0
    v_mov_b64 v[208:209], 0
    v_mov_b64 v[210:211], 0
    v_mov_b64 v[212:213], 0
    v_mov_b64 v[214:215], 0
    v_mov_b64 v[216:217], 0
    v_mov_b64 v[218:219], 0
    v_mov_b64 v[220:221], 0
    v_mov_b64 v[222:223], 0
    v_mov_b64 v[224:225], 0
    v_mov_b64 v[226:227], 0
    v_mov_b64 v[228:229], 0
    v_mov_b64 v[230:231], 0
    v_mov_b64 v[232:233], 0
    v_mov_b64 v[234:235], 0
    v_mov_b64 v[236:237], 0
    v_mov_b64 v[238:239], 0
    v_mov_b64 v[240:241], 0
    v_mov_b64 v[242:243], 0
    v_mov_b64 v[244:245], 0
    v_mov_b64 v[246:247], 0
    v_mov_b64 v[248:249], 0
    v_mov_b64 v[250:251], 0
    v_mov_b64 v[252:253], 0
    v_mov_b64 v[254:255], 0
    v_add_u32 v12, 20480, v13
    s_mul_i32 s70, s60, 40960
    s_mov_b32 s65, 0
    s_lshl_b32 s6, s4, 20
    s_lshl_b32 s7, s5, 13
    s_add_u32 s6, s6, s7
    s_and_b32 s7, s3, 1
    s_lshl_b32 s7, s7, 16
    s_add_u32 s6, s6, s7
    s_add_u32 s67, s6, 16777216
    s_and_b32 s6, s4, 3
    s_add_u32 s6, s6, s5
    s_sub_u32 s7, s6, 5
    s_cselect_b32 s6, s6, s7
    s_sub_u32 s7, s6, 5
    s_cselect_b32 s6, s6, s7
    s_lshl_b32 s71, s6, 20
    s_lshl_b32 s7, s4, 8
    s_add_u32 s71, s71, s7
    s_lshl_b32 s7, s6, 12
    s_add_u32 s84, s70, s7
    s_add_u32 s6, s6, 1
    s_cmp_eq_u32 s6, 5
    s_cselect_b32 s6, 0, s6
    s_lshl_b32 s7, s6, 12
    s_add_u32 s85, s70, s7
    s_add_u32 s6, s6, 1
    s_cmp_eq_u32 s6, 5
    s_cselect_b32 s6, 0, s6
    s_lshl_b32 s7, s6, 12
    s_add_u32 s86, s70, s7
    s_add_u32 s6, s6, 1
    s_cmp_eq_u32 s6, 5
    s_cselect_b32 s6, 0, s6
    s_lshl_b32 s7, s6, 12
    s_add_u32 s87, s70, s7
    s_add_u32 s6, s6, 1
    s_cmp_eq_u32 s6, 5
    s_cselect_b32 s6, 0, s6
    s_lshl_b32 s7, s6, 12
    s_add_u32 s88, s70, s7
    s_lshr_b32 s7, s3, 1
    s_and_b32 s7, s7, 1
    s_cmp_ge_u32 s3, 4
    s_cbranch_scc1 L_c_v
    s_lshl_b32 s7, s7, 11
    s_add_u32 s67, s67, s7
    s_movk_i32 s68, 3072
    s_mov_b32 s69, 125952
    s_add_u32 s71, s71, 1048576
    s_sub_u32 s75, s71, 5242880
    s_cselect_b32 s71, s71, s75
    s_lshl_b32 s74, s76, 12
    s_add_u32 s74, s74, s100
    s_branch L_c_j
L_c_v:
    s_lshl_b32 s7, s7, 12
    s_add_u32 s67, s67, s7
    s_add_u32 s67, s67, 0x80000
    s_movk_i32 s68, 1024
    s_mov_b32 s69, 128000
L_c_j:
    s_cmp_ge_u32 s3, 4
    s_cbranch_scc1 L_st_v1
    s_mov_b32 m0, s64
    s_add_u32 s72, s62, 524288
    buffer_load_dwordx4 v40, s[12:15], s62 offen offset:0 lds
    buffer_load_dwordx4 v41, s[12:15], s62 offen offset:1024 lds
    buffer_load_dwordx4 v42, s[12:15], s62 offen offset:2048 lds
    buffer_load_dwordx4 v43, s[12:15], s62 offen offset:3072 lds
    s_add_u32 m0, s64, 4096
    s_add_u32 s62, s62, 128
    s_bitset0_b32 s62, 10
    buffer_load_dwordx4 v40, s[12:15], s72 offen offset:0 lds
    buffer_load_dwordx4 v41, s[12:15], s72 offen offset:1024 lds
    buffer_load_dwordx4 v42, s[12:15], s72 offen offset:2048 lds
    buffer_load_dwordx4 v43, s[12:15], s72 offen offset:3072 lds
    s_waitcnt vmcnt(8)
    s_branch L_st_j1
L_st_v1:
    s_waitcnt vmcnt(0)
    v_lshlrev_b32 v64, 16, v16
    v_and_b32 v65, 0xffff0000, v16
    v_lshlrev_b32 v66, 16, v17
    v_and_b32 v67, 0xffff0000, v17
    v_lshlrev_b32 v68, 16, v18
    v_and_b32 v69, 0xffff0000, v18
    v_lshlrev_b32 v70, 16, v19
    v_and_b32 v71, 0xffff0000, v19
    v_lshlrev_b32 v72, 16, v20
    v_and_b32 v73, 0xffff0000, v20
    v_lshlrev_b32 v74, 16, v21
    v_and_b32 v75, 0xffff0000, v21
    v_lshlrev_b32 v76, 16, v22
    v_and_b32 v77, 0xffff0000, v22
    v_lshlrev_b32 v78, 16, v23
    v_and_b32 v79, 0xffff0000, v23
    v_lshlrev_b32 v80, 16, v24
    v_and_b32 v81, 0xffff0000, v24
    v_lshlrev_b32 v82, 16, v25
    v_and_b32 v83, 0xffff0000, v25
    v_pk_add_f32 v[2:3], v[64:65], v[66:67]
    v_pk_add_f32 v[2:3], v[2:3], v[68:69]
    v_pk_add_f32 v[2:3], v[2:3], v[70:71]
    v_pk_add_f32 v[2:3], v[2:3], v[72:73]
    v_pk_add_f32 v[2:3], v[2:3], v[74:75]
    v_pk_add_f32 v[2:3], v[2:3], v[76:77]
    v_pk_add_f32 v[2:3], v[2:3], v[78:79]
    v_pk_add_f32 v[2:3], v[2:3], v[80:81]
    v_pk_add_f32 v[2:3], v[2:3], v[82:83]
    v_add_f32 v2, v2, v3
    s_nop 1
    v_add_f32_dpp v2, v2, v2 quad_perm:[1,0,3,2] row_mask:0xf bank_mask:0xf
    s_nop 1
    v_add_f32_dpp v2, v2, v2 quad_perm:[2,3,0,1] row_mask:0xf bank_mask:0xf
    s_nop 1
    v_add_f32_dpp v2, v2, v2 row_half_mirror row_mask:0xf bank_mask:0xf
    s_nop 1
    v_add_f32_dpp v2, v2, v2 row_mirror row_mask:0xf bank_mask:0xf
    v_mov_b32 v8, v2
    s_nop 1
    v_permlane16_swap_b32 v2, v8
    s_nop 1
    v_add_f32 v2, v2, v8
    s_mov_b32 s7, 0x3acccccd
    v_mul_f32 v2, s7, v2
    v_mov_b64 v[4:5], 0
    v_pk_add_f32 v[6:7], v[64:65], v[2:3] op_sel_hi:[1,0] neg_lo:[0,1] neg_hi:[0,1]
    v_pk_fma_f32 v[4:5], v[6:7], v[6:7], v[4:5]
    v_pk_add_f32 v[6:7], v[66:67], v[2:3] op_sel_hi:[1,0] neg_lo:[0,1] neg_hi:[0,1]
    v_pk_fma_f32 v[4:5], v[6:7], v[6:7], v[4:5]
    v_pk_add_f32 v[6:7], v[68:69], v[2:3] op_sel_hi:[1,0] neg_lo:[0,1] neg_hi:[0,1]
    v_pk_fma_f32 v[4:5], v[6:7], v[6:7], v[4:5]
    v_pk_add_f32 v[6:7], v[70:71], v[2:3] op_sel_hi:[1,0] neg_lo:[0,1] neg_hi:[0,1]
    v_pk_fma_f32 v[4:5], v[6:7], v[6:7], v[4:5]
    v_pk_add_f32 v[6:7], v[72:73], v[2:3] op_sel_hi:[1,0] neg_lo:[0,1] neg_hi:[0,1]
    v_pk_fma_f32 v[4:5], v[6:7], v[6:7], v[4:5]
    v_pk_add_f32 v[6:7], v[74:75], v[2:3] op_sel_hi:[1,0] neg_lo:[0,1] neg_hi:[0,1]
    v_pk_fma_f32 v[4:5], v[6:7], v[6:7], v[4:5]
    v_pk_add_f32 v[6:7], v[76:77], v[2:3] op_sel_hi:[1,0] neg_lo:[0,1] neg_hi:[0,1]
    v_pk_fma_f32 v[4:5], v[6:7], v[6:7], v[4:5]
    v_pk_add_f32 v[6:7], v[78:79], v[2:3] op_sel_hi:[1,0] neg_lo:[0,1] neg_hi:[0,1]
    v_pk_fma_f32 v[4:5], v[6:7], v[6:7], v[4:5]
    v_pk_add_f32 v[6:7], v[80:81], v[2:3] op_sel_hi:[1,0] neg_lo:[0,1] neg_hi:[0,1]
    v_pk_fma_f32 v[4:5], v[6:7], v[6:7], v[4:5]
    v_pk_add_f32 v[6:7], v[82:83], v[2:3] op_sel_hi:[1,0] neg_lo:[0,1] neg_hi:[0,1]
    v_pk_fma_f32 v[4:5], v[6:7], v[6:7], v[4:5]
    v_add_f32 v4, v4, v5
    s_nop 1
    v_add_f32_dpp v4, v4, v4 quad_perm:[1,0,3,2] row_mask:0xf bank_mask:0xf
    s_nop 1
    v_add_f32_dpp v4, v4, v4 quad_perm:[2,3,0,1] row_mask:0xf bank_mask:0xf
    s_nop 1
    v_add_f32_dpp v4, v4, v4 row_half_mirror row_mask:0xf bank_mask:0xf
    s_nop 1
    v_add_f32_dpp v4, v4, v4 row_mirror row_mask:0xf bank_mask:0xf
    v_mov_b32 v8, v4
    s_nop 1
    v_permlane16_swap_b32 v4, v8
    s_nop 1
    v_add_f32 v4, v4, v8
    v_mul_f32 v4, s7, v4
    v_cvt_pk_bf16_f32 v2, v2, v2
    v_lshlrev_b32 v2, 16, v2
    v_cvt_pk_bf16_f32 v4, v4, v4
    v_lshlrev_b32 v4, 16, v4
    v_add_f32 v4, 0x3727c5ac, v4
    v_cvt_pk_bf16_f32 v4, v4, v4
    v_lshlrev_b32 v4, 16, v4
    v_sqrt_f32 v4, v4
    s_nop 0
    v_cvt_pk_bf16_f32 v4, v4, v4
    v_lshlrev_b32 v4, 16, v4
    v_rcp_f32 v6, v4
    s_nop 0
    v_fma_f32 v5, -v4, v6, 1.0
    v_fmac_f32 v6, v5, v6
    v_mov_b32 v9, 0
    v_pk_add_f32 v[64:65], v[64:65], v[2:3] op_sel_hi:[1,0] neg_lo:[0,1] neg_hi:[0,1]
    v_cvt_pk_bf16_f32 v5, v64, v65
    v_lshlrev_b32 v64, 16, v5
    v_and_b32 v65, 0xffff0000, v5
    v_pk_mul_f32 v[64:65], v[64:65], v[6:7] op_sel_hi:[1,0]
    v_cvt_pk_bf16_f32 v16, v64, v65
    v_pk_add_f32 v[66:67], v[66:67], v[2:3] op_sel_hi:[1,0] neg_lo:[0,1] neg_hi:[0,1]
    v_cvt_pk_bf16_f32 v5, v66, v67
    v_lshlrev_b32 v66, 16, v5
    v_and_b32 v67, 0xffff0000, v5
    v_pk_mul_f32 v[66:67], v[66:67], v[6:7] op_sel_hi:[1,0]
    v_cvt_pk_bf16_f32 v17, v66, v67
    v_pk_add_f32 v[68:69], v[68:69], v[2:3] op_sel_hi:[1,0] neg_lo:[0,1] neg_hi:[0,1]
    v_cvt_pk_bf16_f32 v5, v68, v69
    v_lshlrev_b32 v68, 16, v5
    v_and_b32 v69, 0xffff0000, v5
    v_pk_mul_f32 v[68:69], v[68:69], v[6:7] op_sel_hi:[1,0]
    v_cvt_pk_bf16_f32 v18, v68, v69
    v_pk_add_f32 v[70:71], v[70:71], v[2:3] op_sel_hi:[1,0] neg_lo:[0,1] neg_hi:[0,1]
    v_cvt_pk_bf16_f32 v5, v70, v71
    v_lshlrev_b32 v70, 16, v5
    v_and_b32 v71, 0xffff0000, v5
    v_pk_mul_f32 v[70:71], v[70:71], v[6:7] op_sel_hi:[1,0]
    v_cvt_pk_bf16_f32 v19, v70, v71
    v_pk_add_f32 v[72:73], v[72:73], v[2:3] op_sel_hi:[1,0] neg_lo:[0,1] neg_hi:[0,1]
    v_cvt_pk_bf16_f32 v5, v72, v73
    v_lshlrev_b32 v72, 16, v5
    v_and_b32 v73, 0xffff0000, v5
    v_pk_mul_f32 v[72:73], v[72:73], v[6:7] op_sel_hi:[1,0]
    v_cvt_pk_bf16_f32 v20, v72, v73
    v_pk_add_f32 v[74:75], v[74:75], v[2:3] op_sel_hi:[1,0] neg_lo:[0,1] neg_hi:[0,1]
    v_cvt_pk_bf16_f32 v5, v74, v75
    v_lshlrev_b32 v74, 16, v5
    v_and_b32 v75, 0xffff0000, v5
    v_pk_mul_f32 v[74:75], v[74:75], v[6:7] op_sel_hi:[1,0]
    v_cvt_pk_bf16_f32 v21, v74, v75
    v_pk_add_f32 v[76:77], v[76:77], v[2:3] op_sel_hi:[1,0] neg_lo:[0,1] neg_hi:[0,1]
    v_cvt_pk_bf16_f32 v5, v76, v77
    v_lshlrev_b32 v76, 16, v5
    v_and_b32 v77, 0xffff0000, v5
    v_pk_mul_f32 v[76:77], v[76:77], v[6:7] op_sel_hi:[1,0]
    v_cvt_pk_bf16_f32 v22, v76, v77
    v_pk_add_f32 v[78:79], v[78:79], v[2:3] op_sel_hi:[1,0] neg_lo:[0,1] neg_hi:[0,1]
    v_cvt_pk_bf16_f32 v5, v78, v79
    v_lshlrev_b32 v78, 16, v5
    v_and_b32 v79, 0xffff0000, v5
    v_pk_mul_f32 v[78:79], v[78:79], v[6:7] op_sel_hi:[1,0]
    v_cvt_pk_bf16_f32 v23, v78, v79
    v_pk_add_f32 v[80:81], v[80:81], v[2:3] op_sel_hi:[1,0] neg_lo:[0,1] neg_hi:[0,1]
    v_cvt_pk_bf16_f32 v5, v80, v81
    v_lshlrev_b32 v80, 16, v5
    v_and_b32 v81, 0xffff0000, v5
    v_pk_mul_f32 v[80:81], v[80:81], v[6:7] op_sel_hi:[1,0]
    v_cvt_pk_bf16_f32 v24, v80, v81
    v_pk_add_f32 v[82:83], v[82:83], v[2:3] op_sel_hi:[1,0] neg_lo:[0,1] neg_hi:[0,1]
    v_cvt_pk_bf16_f32 v5, v82, v83
    v_lshlrev_b32 v82, 16, v5
    v_and_b32 v83, 0xffff0000, v5
    v_pk_mul_f32 v[82:83], v[82:83], v[6:7] op_sel_hi:[1,0]
    v_cvt_pk_bf16_f32 v25, v82, v83
    v_add_u32 v10, 131072, v63
    ds_write_b64 v10, v[16:17] offset:0
    ds_write_b64 v10, v[18:19] offset:256
    ds_write_b64 v10, v[20:21] offset:512
    ds_write_b64 v10, v[22:23] offset:768
    ds_write_b64 v10, v[24:25] offset:1024
    s_waitcnt lgkmcnt(0)
    v_mov_b32 v2, 0
    v_lshlrev_b32 v4, 16, v16
    v_lshlrev_b32 v5, 16, v26
    v_fmac_f32 v2, v4, v5
    v_and_b32 v4, 0xffff0000, v16
    v_and_b32 v5, 0xffff0000, v26
    v_fmac_f32 v2, v4, v5
    v_lshlrev_b32 v4, 16, v17
    v_lshlrev_b32 v5, 16, v27
    v_fmac_f32 v2, v4, v5
    v_and_b32 v4, 0xffff0000, v17
    v_and_b32 v5, 0xffff0000, v27
    v_fmac_f32 v2, v4, v5
    v_lshlrev_b32 v4, 16, v18
    v_lshlrev_b32 v5, 16, v28
    v_fmac_f32 v2, v4, v5
    v_and_b32 v4, 0xffff0000, v18
    v_and_b32 v5, 0xffff0000, v28
    v_fmac_f32 v2, v4, v5
    v_lshlrev_b32 v4, 16, v19
    v_lshlrev_b32 v5, 16, v29
    v_fmac_f32 v2, v4, v5
    v_and_b32 v4, 0xffff0000, v19
    v_and_b32 v5, 0xffff0000, v29
    v_fmac_f32 v2, v4, v5
    v_lshlrev_b32 v4, 16, v20
    v_lshlrev_b32 v5, 16, v30
    v_fmac_f32 v2, v4, v5
    v_and_b32 v4, 0xffff0000, v20
    v_and_b32 v5, 0xffff0000, v30
    v_fmac_f32 v2, v4, v5
    v_lshlrev_b32 v4, 16, v21
    v_lshlrev_b32 v5, 16, v31
    v_fmac_f32 v2, v4, v5
    v_and_b32 v4, 0xffff0000, v21
    v_and_b32 v5, 0xffff0000, v31
    v_fmac_f32 v2, v4, v5
    v_lshlrev_b32 v4, 16, v22
    v_lshlrev_b32 v5, 16, v32
    v_fmac_f32 v2, v4, v5
    v_and_b32 v4, 0xffff0000, v22
    v_and_b32 v5, 0xffff0000, v32
    v_fmac_f32 v2, v4, v5
    v_lshlrev_b32 v4, 16, v23
    v_lshlrev_b32 v5, 16, v33
    v_fmac_f32 v2, v4, v5
    v_and_b32 v4, 0xffff0000, v23
    v_and_b32 v5, 0xffff0000, v33
    v_fmac_f32 v2, v4, v5
    v_lshlrev_b32 v4, 16, v24
    v_lshlrev_b32 v5, 16, v34
    v_fmac_f32 v2, v4, v5
    v_and_b32 v4, 0xffff0000, v24
    v_and_b32 v5, 0xffff0000, v34
    v_fmac_f32 v2, v4, v5
    v_lshlrev_b32 v4, 16, v25
    v_lshlrev_b32 v5, 16, v35
    v_fmac_f32 v2, v4, v5
    v_and_b32 v4, 0xffff0000, v25
    v_and_b32 v5, 0xffff0000, v35
    v_fmac_f32 v2, v4, v5
    s_nop 1
    v_add_f32_dpp v2, v2, v2 quad_perm:[1,0,3,2] row_mask:0xf bank_mask:0xf
    s_nop 1
    v_add_f32_dpp v2, v2, v2 quad_perm:[2,3,0,1] row_mask:0xf bank_mask:0xf
    s_nop 1
    v_add_f32_dpp v2, v2, v2 row_half_mirror row_mask:0xf bank_mask:0xf
    s_nop 1
    v_add_f32_dpp v2, v2, v2 row_mirror row_mask:0xf bank_mask:0xf
    v_mov_b32 v8, v2
    s_nop 1
    v_permlane16_swap_b32 v2, v8
    s_nop 1
    v_add_f32 v2, v2, v8
    v_cvt_pk_bf16_f32 v2, v2, v2
    v_and_b32 v2, 0xffff, v2
    v_bfe_i32 v3, v2, 15, 1
    v_and_b32 v3, 0x7fff, v3
    v_or_b32 v3, 0x8000, v3
    v_xor_b32 v2, v2, v3
    s_lshl_b32 s7, s2, 3
    s_sub_u32 s6, 2047, s7
    v_sub_u32 v3, s6, v62
    v_lshl_or_b32 v2, v2, 11, v3
    v_lshlrev_b32 v3, 2, v62
    v_add_u32 v3, 161792, v3
    ds_write_b32 v3, v2
    s_waitcnt lgkmcnt(0)
L_st_j1:
    s_barrier
    s_cmp_ge_u32 s3, 4
    s_cbranch_scc1 L_kv_v
    ds_read_b128 v[64:67], v48 offset:0
    ds_read_b128 v[68:71], v48 offset:2048
    ds_read_b64_tr_b16 v[96:97], v50 offset:0
    ds_read_b64_tr_b16 v[98:99], v50 offset:1024
    ds_read_b64_tr_b16 v[100:101], v51 offset:0
    ds_read_b64_tr_b16 v[102:103], v51 offset:1024
    ds_read_b128 v[72:75], v48 offset:4096
    ds_read_b64_tr_b16 v[104:105], v52 offset:0
    ds_read_b64_tr_b16 v[106:107], v52 offset:1024
    ds_read_b64_tr_b16 v[108:109], v53 offset:0
    ds_read_b64_tr_b16 v[110:111], v53 offset:1024
    ds_read_b128 v[76:79], v48 offset:6144
    ds_read_b128 v[80:83], v48 offset:8192
    ds_read_b128 v[84:87], v48 offset:10240
    ds_read_b128 v[88:91], v48 offset:12288
    ds_read_b128 v[92:95], v48 offset:14336
    s_mov_b32 m0, s73
    s_xor_b32 s64, s64, 0x10000
    buffer_load_dwordx4 v44, s[16:19], s63 offen offset:0 lds
    buffer_load_dwordx4 v45, s[16:19], s63 offen offset:1024 lds
    buffer_load_dwordx4 v46, s[16:19], s63 offen offset:2048 lds
    buffer_load_dwordx4 v47, s[16:19], s63 offen offset:3072 lds
    s_add_u32 m0, s73, 16384
    s_xor_b32 s73, s73, 0x10000
    buffer_load_dwordx4 v44, s[20:23], s63 offen offset:0 lds
    buffer_load_dwordx4 v45, s[20:23], s63 offen offset:1024 lds
    buffer_load_dwordx4 v46, s[20:23], s63 offen offset:2048 lds
    buffer_load_dwordx4 v47, s[20:23], s63 offen offset:3072 lds
    s_add_u32 s63, s63, 524288
    s_bitset0_b32 s63, 22
.p2align 4
L_kloopA:
    s_waitcnt lgkmcnt(12)
    v_mfma_f32_16x16x32_bf16 v[128:131], v[96:99], v[64:67], v[128:131]
    ds_read_b64_tr_b16 v[112:113], v50 offset:8192
    s_waitcnt lgkmcnt(11)
    v_mfma_f32_16x16x32_bf16 v[132:135], v[100:103], v[64:67], v[132:135]
    ds_read_b64_tr_b16 v[114:115], v50 offset:9216
    s_waitcnt lgkmcnt(9)
    v_mfma_f32_16x16x32_bf16 v[136:139], v[104:107], v[64:67], v[136:139]
    ds_read_b64_tr_b16 v[116:117], v51 offset:8192
    s_waitcnt lgkmcnt(8)
    v_mfma_f32_16x16x32_bf16 v[140:143], v[108:111], v[64:67], v[140:143]
    ds_read_b64_tr_b16 v[118:119], v51 offset:9216
    ds_read_b128 v[64:67], v49 offset:0
    v_mfma_f32_16x16x32_bf16 v[144:147], v[96:99], v[68:71], v[144:147]
    ds_read_b64_tr_b16 v[120:121], v52 offset:8192
    v_mfma_f32_16x16x32_bf16 v[148:151], v[100:103], v[68:71], v[148:151]
    ds_read_b64_tr_b16 v[122:123], v52 offset:9216
    v_mfma_f32_16x16x32_bf16 v[152:155], v[104:107], v[68:71], v[152:155]
    ds_read_b64_tr_b16 v[124:125], v53 offset:8192
    v_mfma_f32_16x16x32_bf16 v[156:159], v[108:111], v[68:71], v[156:159]
    ds_read_b64_tr_b16 v[126:127], v53 offset:9216
    ds_read_b128 v[68:71], v49 offset:2048
    v_mfma_f32_16x16x32_bf16 v[160:163], v[96:99], v[72:75], v[160:163]
    v_mfma_f32_16x16x32_bf16 v[164:167], v[100:103], v[72:75], v[164:167]
    v_mfma_f32_16x16x32_bf16 v[168:171], v[104:107], v[72:75], v[168:171]
    v_mfma_f32_16x16x32_bf16 v[172:175], v[108:111], v[72:75], v[172:175]
    ds_read_b128 v[72:75], v49 offset:4096
    s_waitcnt lgkmcnt(15)
    v_mfma_f32_16x16x32_bf16 v[176:179], v[96:99], v[76:79], v[176:179]
    v_mfma_f32_16x16x32_bf16 v[180:183], v[100:103], v[76:79], v[180:183]
    v_mfma_f32_16x16x32_bf16 v[184:187], v[104:107], v[76:79], v[184:187]
    v_mfma_f32_16x16x32_bf16 v[188:191], v[108:111], v[76:79], v[188:191]
    ds_read_b128 v[76:79], v49 offset:6144
    s_waitcnt lgkmcnt(15)
    v_mfma_f32_16x16x32_bf16 v[192:195], v[96:99], v[80:83], v[192:195]
    v_mfma_f32_16x16x32_bf16 v[196:199], v[100:103], v[80:83], v[196:199]
    v_mfma_f32_16x16x32_bf16 v[200:203], v[104:107], v[80:83], v[200:203]
    v_mfma_f32_16x16x32_bf16 v[204:207], v[108:111], v[80:83], v[204:207]
    ds_read_b128 v[80:83], v49 offset:8192
    s_waitcnt lgkmcnt(15)
    v_mfma_f32_16x16x32_bf16 v[208:211], v[96:99], v[84:87], v[208:211]
    v_mfma_f32_16x16x32_bf16 v[212:215], v[100:103], v[84:87], v[212:215]
    v_mfma_f32_16x16x32_bf16 v[216:219], v[104:107], v[84:87], v[216:219]
    v_mfma_f32_16x16x32_bf16 v[220:223], v[108:111], v[84:87], v[220:223]
    ds_read_b128 v[84:87], v49 offset:10240
    s_waitcnt lgkmcnt(15)
    v_mfma_f32_16x16x32_bf16 v[224:227], v[96:99], v[88:91], v[224:227]
    v_mfma_f32_16x16x32_bf16 v[228:231], v[100:103], v[88:91], v[228:231]
    v_mfma_f32_16x16x32_bf16 v[232:235], v[104:107], v[88:91], v[232:235]
    v_mfma_f32_16x16x32_bf16 v[236:239], v[108:111], v[88:91], v[236:239]
    ds_read_b128 v[88:91], v49 offset:12288
    s_waitcnt lgkmcnt(15)
    v_mfma_f32_16x16x32_bf16 v[240:243], v[96:99], v[92:95], v[240:243]
    v_mfma_f32_16x16x32_bf16 v[244:247], v[100:103], v[92:95], v[244:247]
    v_mfma_f32_16x16x32_bf16 v[248:251], v[104:107], v[92:95], v[248:251]
    v_mfma_f32_16x16x32_bf16 v[252:255], v[108:111], v[92:95], v[252:255]
    ds_read_b128 v[92:95], v49 offset:14336
    s_waitcnt lgkmcnt(11)
    v_mfma_f32_16x16x32_bf16 v[128:131], v[112:115], v[64:67], v[128:131]
    v_mfma_f32_16x16x32_bf16 v[132:135], v[116:119], v[64:67], v[132:135]
    s_waitcnt lgkmcnt(9)
    v_mfma_f32_16x16x32_bf16 v[136:139], v[120:123], v[64:67], v[136:139]
    s_waitcnt lgkmcnt(7)
    v_mfma_f32_16x16x32_bf16 v[140:143], v[124:127], v[64:67], v[140:143]
    s_waitcnt lgkmcnt(6)
    v_mfma_f32_16x16x32_bf16 v[144:147], v[112:115], v[68:71], v[144:147]
    v_mfma_f32_16x16x32_bf16 v[148:151], v[116:119], v[68:71], v[148:151]
    v_mfma_f32_16x16x32_bf16 v[152:155], v[120:123], v[68:71], v[152:155]
    v_mfma_f32_16x16x32_bf16 v[156:159], v[124:127], v[68:71], v[156:159]
    v_xor_b32 v48, 0x10000, v48
    v_xor_b32 v49, 0x10000, v49
    v_xor_b32 v50, 0x10000, v50
    v_xor_b32 v51, 0x10000, v51
    v_xor_b32 v52, 0x10000, v52
    v_xor_b32 v53, 0x10000, v53
    s_waitcnt vmcnt(0) lgkmcnt(0)
    s_barrier
    ds_read_b128 v[64:67], v48 offset:0
    ds_read_b128 v[68:71], v48 offset:2048
    v_mfma_f32_16x16x32_bf16 v[160:163], v[112:115], v[72:75], v[160:163]
    ds_read_b64_tr_b16 v[96:97], v50 offset:0
    s_mov_b32 m0, s64
    s_add_u32 s72, s62, 524288
    v_mfma_f32_16x16x32_bf16 v[164:167], v[116:119], v[72:75], v[164:167]
    ds_read_b64_tr_b16 v[98:99], v50 offset:1024
    buffer_load_dwordx4 v40, s[12:15], s62 offen offset:0 lds
    v_mfma_f32_16x16x32_bf16 v[168:171], v[120:123], v[72:75], v[168:171]
    ds_read_b64_tr_b16 v[100:101], v51 offset:0
    buffer_load_dwordx4 v41, s[12:15], s62 offen offset:1024 lds
    v_mfma_f32_16x16x32_bf16 v[172:175], v[124:127], v[72:75], v[172:175]
    ds_read_b64_tr_b16 v[102:103], v51 offset:1024
    buffer_load_dwordx4 v42, s[12:15], s62 offen offset:2048 lds
    ds_read_b128 v[72:75], v48 offset:4096
    v_mfma_f32_16x16x32_bf16 v[176:179], v[112:115], v[76:79], v[176:179]
    ds_read_b64_tr_b16 v[104:105], v52 offset:0
    buffer_load_dwordx4 v43, s[12:15], s62 offen offset:3072 lds
    v_mfma_f32_16x16x32_bf16 v[180:183], v[116:119], v[76:79], v[180:183]
    ds_read_b64_tr_b16 v[106:107], v52 offset:1024
    s_add_u32 m0, s64, 4096
    s_add_u32 s62, s62, 128
    s_bitset0_b32 s62, 10
    v_mfma_f32_16x16x32_bf16 v[184:187], v[120:123], v[76:79], v[184:187]
    ds_read_b64_tr_b16 v[108:109], v53 offset:0
    buffer_load_dwordx4 v40, s[12:15], s72 offen offset:0 lds
    v_mfma_f32_16x16x32_bf16 v[188:191], v[124:127], v[76:79], v[188:191]
    ds_read_b64_tr_b16 v[110:111], v53 offset:1024
    buffer_load_dwordx4 v41, s[12:15], s72 offen offset:1024 lds
    ds_read_b128 v[76:79], v48 offset:6144
    v_mfma_f32_16x16x32_bf16 v[192:195], v[112:115], v[80:83], v[192:195]
    buffer_load_dwordx4 v42, s[12:15], s72 offen offset:2048 lds
    v_mfma_f32_16x16x32_bf16 v[196:199], v[116:119], v[80:83], v[196:199]
    buffer_load_dwordx4 v43, s[12:15], s72 offen offset:3072 lds
    v_mfma_f32_16x16x32_bf16 v[200:203], v[120:123], v[80:83], v[200:203]
    s_mov_b32 m0, s73
    s_xor_b32 s64, s64, 0x10000
    v_mfma_f32_16x16x32_bf16 v[204:207], v[124:127], v[80:83], v[204:207]
    buffer_load_dwordx4 v44, s[16:19], s63 offen offset:0 lds
    ds_read_b128 v[80:83], v48 offset:8192
    v_mfma_f32_16x16x32_bf16 v[208:211], v[112:115], v[84:87], v[208:211]
    buffer_load_dwordx4 v45, s[16:19], s63 offen offset:1024 lds
    v_mfma_f32_16x16x32_bf16 v[212:215], v[116:119], v[84:87], v[212:215]
    buffer_load_dwordx4 v46, s[16:19], s63 offen offset:2048 lds
    v_mfma_f32_16x16x32_bf16 v[216:219], v[120:123], v[84:87], v[216:219]
    buffer_load_dwordx4 v47, s[16:19], s63 offen offset:3072 lds
    v_mfma_f32_16x16x32_bf16 v[220:223], v[124:127], v[84:87], v[220:223]
    s_add_u32 m0, s73, 16384
    s_xor_b32 s73, s73, 0x10000
    ds_read_b128 v[84:87], v48 offset:10240
    v_mfma_f32_16x16x32_bf16 v[224:227], v[112:115], v[88:91], v[224:227]
    buffer_load_dwordx4 v44, s[20:23], s63 offen offset:0 lds
    v_mfma_f32_16x16x32_bf16 v[228:231], v[116:119], v[88:91], v[228:231]
    buffer_load_dwordx4 v45, s[20:23], s63 offen offset:1024 lds
    v_mfma_f32_16x16x32_bf16 v[232:235], v[120:123], v[88:91], v[232:235]
    buffer_load_dwordx4 v46, s[20:23], s63 offen offset:2048 lds
    v_mfma_f32_16x16x32_bf16 v[236:239], v[124:127], v[88:91], v[236:239]
    buffer_load_dwordx4 v47, s[20:23], s63 offen offset:3072 lds
    ds_read_b128 v[88:91], v48 offset:12288
    v_mfma_f32_16x16x32_bf16 v[240:243], v[112:115], v[92:95], v[240:243]
    s_add_u32 s63, s63, 524288
    s_bitset0_b32 s63, 22
    v_mfma_f32_16x16x32_bf16 v[244:247], v[116:119], v[92:95], v[244:247]
    v_mfma_f32_16x16x32_bf16 v[248:251], v[120:123], v[92:95], v[248:251]
    v_mfma_f32_16x16x32_bf16 v[252:255], v[124:127], v[92:95], v[252:255]
    ds_read_b128 v[92:95], v48 offset:14336
    s_add_u32 s65, s65, 1
    s_cmp_lt_u32 s65, 6
    s_cbranch_scc1 L_kloopA
.p2align 4
L_kloopB:
    s_bitcmp1_b32 128, s65
    s_cbranch_scc1 L_khook
L_khook_back:
    s_waitcnt lgkmcnt(12)
    v_mfma_f32_16x16x32_bf16 v[128:131], v[96:99], v[64:67], v[128:131]
    ds_read_b64_tr_b16 v[112:113], v50 offset:8192
    s_waitcnt lgkmcnt(11)
    v_mfma_f32_16x16x32_bf16 v[132:135], v[100:103], v[64:67], v[132:135]
    ds_read_b64_tr_b16 v[114:115], v50 offset:9216
    s_waitcnt lgkmcnt(9)
    v_mfma_f32_16x16x32_bf16 v[136:139], v[104:107], v[64:67], v[136:139]
    ds_read_b64_tr_b16 v[116:117], v51 offset:8192
    s_waitcnt lgkmcnt(8)
    v_mfma_f32_16x16x32_bf16 v[140:143], v[108:111], v[64:67], v[140:143]
    ds_read_b64_tr_b16 v[118:119], v51 offset:9216
    ds_read_b128 v[64:67], v49 offset:0
    v_mfma_f32_16x16x32_bf16 v[144:147], v[96:99], v[68:71], v[144:147]
    ds_read_b64_tr_b16 v[120:121], v52 offset:8192
    v_mfma_f32_16x16x32_bf16 v[148:151], v[100:103], v[68:71], v[148:151]
    ds_read_b64_tr_b16 v[122:123], v52 offset:9216
    v_mfma_f32_16x16x32_bf16 v[152:155], v[104:107], v[68:71], v[152:155]
    ds_read_b64_tr_b16 v[124:125], v53 offset:8192
    v_mfma_f32_16x16x32_bf16 v[156:159], v[108:111], v[68:71], v[156:159]
    ds_read_b64_tr_b16 v[126:127], v53 offset:9216
    ds_read_b128 v[68:71], v49 offset:2048
    v_mfma_f32_16x16x32_bf16 v[160:163], v[96:99], v[72:75], v[160:163]
    v_mfma_f32_16x16x32_bf16 v[164:167], v[100:103], v[72:75], v[164:167]
    v_mfma_f32_16x16x32_bf16 v[168:171], v[104:107], v[72:75], v[168:171]
    v_mfma_f32_16x16x32_bf16 v[172:175], v[108:111], v[72:75], v[172:175]
    ds_read_b128 v[72:75], v49 offset:4096
    s_waitcnt lgkmcnt(15)
    v_mfma_f32_16x16x32_bf16 v[176:179], v[96:99], v[76:79], v[176:179]
    v_mfma_f32_16x16x32_bf16 v[180:183], v[100:103], v[76:79], v[180:183]
    v_mfma_f32_16x16x32_bf16 v[184:187], v[104:107], v[76:79], v[184:187]
    v_mfma_f32_16x16x32_bf16 v[188:191], v[108:111], v[76:79], v[188:191]
    ds_read_b128 v[76:79], v49 offset:6144
    s_waitcnt lgkmcnt(15)
    v_mfma_f32_16x16x32_bf16 v[192:195], v[96:99], v[80:83], v[192:195]
    v_mfma_f32_16x16x32_bf16 v[196:199], v[100:103], v[80:83], v[196:199]
    v_mfma_f32_16x16x32_bf16 v[200:203], v[104:107], v[80:83], v[200:203]
    v_mfma_f32_16x16x32_bf16 v[204:207], v[108:111], v[80:83], v[204:207]
    ds_read_b128 v[80:83], v49 offset:8192
    s_waitcnt lgkmcnt(15)
    v_mfma_f32_16x16x32_bf16 v[208:211], v[96:99], v[84:87], v[208:211]
    v_mfma_f32_16x16x32_bf16 v[212:215], v[100:103], v[84:87], v[212:215]
    v_mfma_f32_16x16x32_bf16 v[216:219], v[104:107], v[84:87], v[216:219]
    v_mfma_f32_16x16x32_bf16 v[220:223], v[108:111], v[84:87], v[220:223]
    ds_read_b128 v[84:87], v49 offset:10240
    s_waitcnt lgkmcnt(15)
    v_mfma_f32_16x16x32_bf16 v[224:227], v[96:99], v[88:91], v[224:227]
    v_mfma_f32_16x16x32_bf16 v[228:231], v[100:103], v[88:91], v[228:231]
    v_mfma_f32_16x16x32_bf16 v[232:235], v[104:107], v[88:91], v[232:235]
    v_mfma_f32_16x16x32_bf16 v[236:239], v[108:111], v[88:91], v[236:239]
    ds_read_b128 v[88:91], v49 offset:12288
    s_waitcnt lgkmcnt(15)
    v_mfma_f32_16x16x32_bf16 v[240:243], v[96:99], v[92:95], v[240:243]
    v_mfma_f32_16x16x32_bf16 v[244:247], v[100:103], v[92:95], v[244:247]
    v_mfma_f32_16x16x32_bf16 v[248:251], v[104:107], v[92:95], v[248:251]
    v_mfma_f32_16x16x32_bf16 v[252:255], v[108:111], v[92:95], v[252:255]
    ds_read_b128 v[92:95], v49 offset:14336
    s_waitcnt lgkmcnt(11)
    v_mfma_f32_16x16x32_bf16 v[128:131], v[112:115], v[64:67], v[128:131]
    v_mfma_f32_16x16x32_bf16 v[132:135], v[116:119], v[64:67], v[132:135]
    s_waitcnt lgkmcnt(9)
    v_mfma_f32_16x16x32_bf16 v[136:139], v[120:123], v[64:67], v[136:139]
    s_waitcnt lgkmcnt(7)
    v_mfma_f32_16x16x32_bf16 v[140:143], v[124:127], v[64:67], v[140:143]
    s_waitcnt lgkmcnt(6)
    v_mfma_f32_16x16x32_bf16 v[144:147], v[112:115], v[68:71], v[144:147]
    v_mfma_f32_16x16x32_bf16 v[148:151], v[116:119], v[68:71], v[148:151]
    v_mfma_f32_16x16x32_bf16 v[152:155], v[120:123], v[68:71], v[152:155]
    v_mfma_f32_16x16x32_bf16 v[156:159], v[124:127], v[68:71], v[156:159]
    v_xor_b32 v48, 0x10000, v48
    v_xor_b32 v49, 0x10000, v49
    v_xor_b32 v50, 0x10000, v50
    v_xor_b32 v51, 0x10000, v51
    v_xor_b32 v52, 0x10000, v52
    v_xor_b32 v53, 0x10000, v53
    s_waitcnt vmcnt(0) lgkmcnt(0)
    s_barrier
    ds_read_b128 v[64:67], v48 offset:0
    ds_read_b128 v[68:71], v48 offset:2048
    v_mfma_f32_16x16x32_bf16 v[160:163], v[112:115], v[72:75], v[160:163]
    ds_read_b64_tr_b16 v[96:97], v50 offset:0
    s_mov_b32 m0, s74
    s_add_u32 s74, s74, 16384
    s_bitset0_b32 s74, 17
    v_mfma_f32_16x16x32_bf16 v[164:167], v[116:119], v[72:75], v[164:167]
    ds_read_b64_tr_b16 v[98:99], v50 offset:1024
    buffer_load_dwordx4 v44, s[24:27], s71 offen offset:0 lds
    v_mfma_f32_16x16x32_bf16 v[168:171], v[120:123], v[72:75], v[168:171]
    ds_read_b64_tr_b16 v[100:101], v51 offset:0
    buffer_load_dwordx4 v45, s[24:27], s71 offen offset:1024 lds
    v_mfma_f32_16x16x32_bf16 v[172:175], v[124:127], v[72:75], v[172:175]
    ds_read_b64_tr_b16 v[102:103], v51 offset:1024
    buffer_load_dwordx4 v46, s[24:27], s71 offen offset:2048 lds
    ds_read_b128 v[72:75], v48 offset:4096
    v_mfma_f32_16x16x32_bf16 v[176:179], v[112:115], v[76:79], v[176:179]
    ds_read_b64_tr_b16 v[104:105], v52 offset:0
    buffer_load_dwordx4 v47, s[24:27], s71 offen offset:3072 lds
    v_mfma_f32_16x16x32_bf16 v[180:183], v[116:119], v[76:79], v[180:183]
    ds_read_b64_tr_b16 v[106:107], v52 offset:1024
    s_add_u32 s71, s71, 524288
    s_sub_u32 s75, s71, 5242880
    s_cselect_b32 s71, s71, s75
    v_mfma_f32_16x16x32_bf16 v[184:187], v[120:123], v[76:79], v[184:187]
    ds_read_b64_tr_b16 v[108:109], v53 offset:0
    s_mov_b32 m0, s74
    s_add_u32 s74, s74, 16384
    s_bitset0_b32 s74, 17
    v_mfma_f32_16x16x32_bf16 v[188:191], v[124:127], v[76:79], v[188:191]
    ds_read_b64_tr_b16 v[110:111], v53 offset:1024
    buffer_load_dwordx4 v44, s[24:27], s71 offen offset:0 lds
    ds_read_b128 v[76:79], v48 offset:6144
    v_mfma_f32_16x16x32_bf16 v[192:195], v[112:115], v[80:83], v[192:195]
    buffer_load_dwordx4 v45, s[24:27], s71 offen offset:1024 lds
    v_mfma_f32_16x16x32_bf16 v[196:199], v[116:119], v[80:83], v[196:199]
    buffer_load_dwordx4 v46, s[24:27], s71 offen offset:2048 lds
    v_mfma_f32_16x16x32_bf16 v[200:203], v[120:123], v[80:83], v[200:203]
    buffer_load_dwordx4 v47, s[24:27], s71 offen offset:3072 lds
    v_mfma_f32_16x16x32_bf16 v[204:207], v[124:127], v[80:83], v[204:207]
    s_add_u32 s71, s71, 524288
    s_sub_u32 s75, s71, 5242880
    s_cselect_b32 s71, s71, s75
    ds_read_b128 v[80:83], v48 offset:8192
    v_mfma_f32_16x16x32_bf16 v[208:211], v[112:115], v[84:87], v[208:211]
    s_mov_b32 m0, s74
    s_add_u32 s74, s74, 16384
    s_bitset0_b32 s74, 17
    v_mfma_f32_16x16x32_bf16 v[212:215], v[116:119], v[84:87], v[212:215]
    buffer_load_dwordx4 v44, s[24:27], s71 offen offset:0 lds
    v_mfma_f32_16x16x32_bf16 v[216:219], v[120:123], v[84:87], v[216:219]
    buffer_load_dwordx4 v45, s[24:27], s71 offen offset:1024 lds
    v_mfma_f32_16x16x32_bf16 v[220:223], v[124:127], v[84:87], v[220:223]
    buffer_load_dwordx4 v46, s[24:27], s71 offen offset:2048 lds
    ds_read_b128 v[84:87], v48 offset:10240
    v_mfma_f32_16x16x32_bf16 v[224:227], v[112:115], v[88:91], v[224:227]
    buffer_load_dwordx4 v47, s[24:27], s71 offen offset:3072 lds
    v_mfma_f32_16x16x32_bf16 v[228:231], v[116:119], v[88:91], v[228:231]
    s_add_u32 s71, s71, 524288
    s_sub_u32 s75, s71, 5242880
    s_cselect_b32 s71, s71, s75
    v_mfma_f32_16x16x32_bf16 v[232:235], v[120:123], v[88:91], v[232:235]
    s_mov_b32 m0, s74
    s_add_u32 s74, s74, 16384
    s_bitset0_b32 s74, 17
    v_mfma_f32_16x16x32_bf16 v[236:239], v[124:127], v[88:91], v[236:239]
    buffer_load_dwordx4 v44, s[24:27], s71 offen offset:0 lds
    ds_read_b128 v[88:91], v48 offset:12288
    v_mfma_f32_16x16x32_bf16 v[240:243], v[112:115], v[92:95], v[240:243]
    buffer_load_dwordx4 v45, s[24:27], s71 offen offset:1024 lds
    v_mfma_f32_16x16x32_bf16 v[244:247], v[116:119], v[92:95], v[244:247]
    buffer_load_dwordx4 v46, s[24:27], s71 offen offset:2048 lds
    v_mfma_f32_16x16x32_bf16 v[248:251], v[120:123], v[92:95], v[248:251]
    buffer_load_dwordx4 v47, s[24:27], s71 offen offset:3072 lds
    v_mfma_f32_16x16x32_bf16 v[252:255], v[124:127], v[92:95], v[252:255]
    s_add_u32 s71, s71, 524288
    s_sub_u32 s75, s71, 5242880
    s_cselect_b32 s71, s71, s75
    ds_read_b128 v[92:95], v48 offset:14336
    s_add_u32 s65, s65, 1
    s_cmp_lt_u32 s65, 8
    s_cbranch_scc1 L_kloopB
    s_waitcnt lgkmcnt(0)
    s_nop 7
    v_cvt_pk_bf16_f32 v128, v128, v129
    v_cvt_pk_bf16_f32 v129, v130, v131
    v_cvt_pk_bf16_f32 v130, v132, v133
    v_cvt_pk_bf16_f32 v131, v134, v135
    v_cvt_pk_bf16_f32 v132, v136, v137
    v_cvt_pk_bf16_f32 v133, v138, v139
    v_cvt_pk_bf16_f32 v134, v140, v141
    v_cvt_pk_bf16_f32 v135, v142, v143
    v_cvt_pk_bf16_f32 v136, v144, v145
    v_cvt_pk_bf16_f32 v137, v146, v147
    v_cvt_pk_bf16_f32 v138, v148, v149
    v_cvt_pk_bf16_f32 v139, v150, v151
    v_cvt_pk_bf16_f32 v140, v152, v153
    v_cvt_pk_bf16_f32 v141, v154, v155
    v_cvt_pk_bf16_f32 v142, v156, v157
    v_cvt_pk_bf16_f32 v143, v158, v159
    v_cvt_pk_bf16_f32 v144, v160, v161
    v_cvt_pk_bf16_f32 v145, v162, v163
    v_cvt_pk_bf16_f32 v146, v164, v165
    v_cvt_pk_bf16_f32 v147, v166, v167
    v_cvt_pk_bf16_f32 v148, v168, v169
    v_cvt_pk_bf16_f32 v149, v170, v171
    v_cvt_pk_bf16_f32 v150, v172, v173
    v_cvt_pk_bf16_f32 v151, v174, v175
    v_cvt_pk_bf16_f32 v152, v176, v177
    v_cvt_pk_bf16_f32 v153, v178, v179
    v_cvt_pk_bf16_f32 v154, v180, v181
    v_cvt_pk_bf16_f32 v155, v182, v183
    v_cvt_pk_bf16_f32 v156, v184, v185
    v_cvt_pk_bf16_f32 v157, v186, v187
    v_cvt_pk_bf16_f32 v158, v188, v189
    v_cvt_pk_bf16_f32 v159, v190, v191
    v_cvt_pk_bf16_f32 v160, v192, v193
    v_cvt_pk_bf16_f32 v161, v194, v195
    v_cvt_pk_bf16_f32 v162, v196, v197
    v_cvt_pk_bf16_f32 v163, v198, v199
    v_cvt_pk_bf16_f32 v164, v200, v201
    v_cvt_pk_bf16_f32 v165, v202, v203
    v_cvt_pk_bf16_f32 v166, v204, v205
    v_cvt_pk_bf16_f32 v167, v206, v207
    v_cvt_pk_bf16_f32 v168, v208, v209
    v_cvt_pk_bf16_f32 v169, v210, v211
    v_cvt_pk_bf16_f32 v170, v212, v213
    v_cvt_pk_bf16_f32 v171, v214, v215
    v_cvt_pk_bf16_f32 v172, v216, v217
    v_cvt_pk_bf16_f32 v173, v218, v219
    v_cvt_pk_bf16_f32 v174, v220, v221
    v_cvt_pk_bf16_f32 v175, v222, v223
    v_cvt_pk_bf16_f32 v176, v224, v225
    v_cvt_pk_bf16_f32 v177, v226, v227
    v_cvt_pk_bf16_f32 v178, v228, v229
    v_cvt_pk_bf16_f32 v179, v230, v231
    v_cvt_pk_bf16_f32 v180, v232, v233
    v_cvt_pk_bf16_f32 v181, v234, v235
    v_cvt_pk_bf16_f32 v182, v236, v237
    v_cvt_pk_bf16_f32 v183, v238, v239
    v_cvt_pk_bf16_f32 v184, v240, v241
    v_cvt_pk_bf16_f32 v185, v242, v243
    v_cvt_pk_bf16_f32 v186, v244, v245
    v_cvt_pk_bf16_f32 v187, v246, v247
    v_cvt_pk_bf16_f32 v188, v248, v249
    v_cvt_pk_bf16_f32 v189, v250, v251
    v_cvt_pk_bf16_f32 v190, v252, v253
    v_cvt_pk_bf16_f32 v191, v254, v255
    s_waitcnt vmcnt(16)
    s_branch L_q
L_hook:
    s_cmp_eq_u32 s65, 1
    s_cbranch_scc1 L_hook1
    s_cmp_eq_u32 s65, 2
    s_cbranch_scc1 L_hook2
    s_cmp_eq_u32 s65, 4
    s_cbranch_scc1 L_hook4
    s_cmp_eq_u32 s65, 6
    s_cbranch_scc1 L_hook6
    s_cmp_lg_u32 s65, 7
    s_cbranch_scc1 L_hook_back
    buffer_load_dwordx4 v[16:19], v13, s[8:11], s84 offen offset:0 sc1
    buffer_load_dwordx4 v[20:23], v12, s[8:11], s84 offen offset:0 sc1
    buffer_load_dwordx4 v[24:27], v13, s[8:11], s84 offen offset:1024 sc1
    buffer_load_dwordx4 v[28:31], v12, s[8:11], s84 offen offset:1024 sc1
    buffer_load_dwordx4 v[32:35], v13, s[8:11], s84 offen offset:2048 sc1
    buffer_load_dwordx4 v[36:39], v12, s[8:11], s84 offen offset:2048 sc1
    s_branch L_hook_back
L_hook1:
    s_cmp_ge_u32 s76, 2
    s_cbranch_scc1 L_tch_1a
    s_and_b32 s6, s4, 3
    s_lshl_b32 s6, s6, 19
    s_lshl_b32 s7, s5, 15
    s_add_u32 s6, s6, s7
    s_lshl_b32 s7, s76, 7
    s_add_u32 s6, s6, s7
    s_add_u32 s6, s6, 512
    v_lshrrev_b32 v6, 1, v1
    v_lshlrev_b32 v6, 10, v6
    v_and_b32 v7, 1, v1
    v_lshl_add_u32 v6, v7, 6, v6
    buffer_load_dword v11, v6, s[12:15], s6 offen
    s_add_u32 s6, s6, 262144
    buffer_load_dword v11, v6, s[12:15], s6 offen
    s_branch L_tch_1c
L_tch_1a:
    v_lshrrev_b32 v6, 5, v1
    v_lshlrev_b32 v6, 6, v6
    v_bfe_u32 v7, v1, 2, 3
    v_add_u32 v6, v6, v7
    v_lshlrev_b32 v6, 13, v6
    v_and_b32 v7, 3, v1
    v_lshl_add_u32 v6, v7, 6, v6
    s_lshl_b32 s6, s4, 8
    s_lshl_b32 s7, s5, 16
    s_add_u32 s6, s6, s7
    s_add_u32 s6, s6, 2097152
    s_cmp_lg_u32 s76, 2
    s_cbranch_scc1 L_tch_1b
    buffer_load_dword v11, v6, s[16:19], s6 offen
    s_branch L_tch_1c
L_tch_1b:
    buffer_load_dword v11, v6, s[20:23], s6 offen
L_tch_1c:
    s_branch L_hook_back
L_hook2:
    s_lshr_b32 s72, s2, 1
    s_mul_i32 s72, s72, 20480
    s_and_b32 s7, s2, 1
    s_lshl_b32 s7, s7, 7
    s_add_u32 s72, s72, s7
    v_add_u32 v2, -256, v0
    v_lshrrev_b32 v3, 3, v2
    v_and_b32 v4, 7, v2
    v_mul_u32_u24 v5, 1280, v4
    v_lshl_add_u32 v5, v3, 4, v5
    v_add_u32 v5, 131072, v5
    ds_read_b128 v[16:19], v5
    v_lshlrev_b32 v5, 8, v3
    v_lshl_add_u32 v6, v4, 4, v5
    v_add_u32 v2, 0, v0
    v_lshrrev_b32 v3, 3, v2
    v_and_b32 v4, 7, v2
    v_mul_u32_u24 v5, 1280, v4
    v_lshl_add_u32 v5, v3, 4, v5
    v_add_u32 v5, 131072, v5
    ds_read_b128 v[24:27], v5
    v_lshlrev_b32 v5, 8, v3
    v_lshl_add_u32 v7, v4, 4, v5
    v_add_u32 v2, 256, v0
    v_lshrrev_b32 v3, 3, v2
    v_and_b32 v4, 7, v2
    v_mul_u32_u24 v5, 1280, v4
    v_lshl_add_u32 v5, v3, 4, v5
    v_add_u32 v5, 131072, v5
    ds_read_b128 v[32:35], v5
    v_lshlrev_b32 v5, 8, v3
    v_lshl_add_u32 v8, v4, 4, v5
    s_waitcnt lgkmcnt(0)
    buffer_store_dwordx4 v[16:19], v6, s[8:11], s72 offen sc1
    buffer_store_dwordx4 v[24:27], v7, s[8:11], s72 offen sc1
    s_cmp_ge_u32 s3, 6
    s_cbranch_scc1 L_lns
    buffer_store_dwordx4 v[32:35], v8, s[8:11], s72 offen sc1
L_lns:
    s_cmp_lt_u32 s3, 6
    s_cbranch_scc1 L_zd
    v_mov_b64 v[36:37], 0
    v_mov_b64 v[38:39], 0
    v_lshrrev_b32 v2, 3, v1
    s_cmp_eq_u32 s3, 6
    s_cbranch_scc1 L_z6
    s_lshl_b32 s6, s5, 2
    s_sub_u32 s7, 56, s6
    v_mov_b32 v3, s6
    v_mov_b32 v4, s7
    v_cmp_gt_u32 vcc, 4, v2
    s_lshl_b32 s6, s4, 7
    s_add_u32 s6, s6, 3932160
    v_cndmask_b32 v3, v4, v3, vcc
    v_add_u32 v3, v3, v2
    v_lshl_add_u32 v3, v3, 12, s6
    s_branch L_z7
L_z6:
    v_mov_b32 v3, 0x5000000
    s_lshl_b32 s6, s4, 3
    s_add_u32 s6, s6, s5
    s_lshl_b32 s6, s6, 5
    s_add_u32 s6, s6, s3
    s_lshl_b32 s6, s6, 2
    s_add_u32 s6, s6, 3866624
    s_andn2_b32 s6, s6, 127
    v_cmp_eq_u32 vcc, 0, v2
    v_mov_b32 v4, s6
    s_nop 0
    v_cndmask_b32 v3, v3, v4, vcc
    s_lshl_b32 s6, s61, 5
    s_add_u32 s6, s6, s3
    s_lshl_b32 s6, s6, 2
    s_add_u32 s6, s6, 15859712
    s_andn2_b32 s6, s6, 127
    v_cmp_eq_u32 vcc, 1, v2
    v_mov_b32 v4, s6
    s_nop 0
    v_cndmask_b32 v3, v3, v4, vcc
    s_lshl_b32 s6, s5, 5
    s_add_u32 s6, s6, s4
    s_lshl_b32 s6, s6, 5
    s_add_u32 s6, s6, s3
    s_lshl_b32 s6, s6, 2
    s_add_u32 s6, s6, 3899392
    s_andn2_b32 s6, s6, 127
    v_cmp_eq_u32 vcc, 2, v2
    v_mov_b32 v4, s6
    s_nop 0
    v_cndmask_b32 v3, v3, v4, vcc
    s_and_b32 s6, s4, 7
    s_lshl_b32 s7, s5, 3
    s_add_u32 s6, s6, s7
    s_lshr_b32 s7, s4, 3
    s_add_u32 s7, s7, 0
    s_add_u32 s7, s7, 1
    s_and_b32 s7, s7, 3
    s_lshl_b32 s6, s6, 2
    s_add_u32 s6, s6, s7
    s_mul_i32 s6, s6, 3
    s_add_u32 s6, s6, 0
    s_lshl_b32 s6, s6, 5
    s_add_u32 s6, s6, s3
    s_lshl_b32 s6, s6, 2
    s_add_u32 s6, s6, 15728640
    s_andn2_b32 s6, s6, 127
    v_cmp_eq_u32 vcc, 3, v2
    v_mov_b32 v4, s6
    s_nop 0
    v_cndmask_b32 v3, v3, v4, vcc
    s_and_b32 s6, s4, 7
    s_lshl_b32 s7, s5, 3
    s_add_u32 s6, s6, s7
    s_lshr_b32 s7, s4, 3
    s_add_u32 s7, s7, 1
    s_add_u32 s7, s7, 1
    s_and_b32 s7, s7, 3
    s_lshl_b32 s6, s6, 2
    s_add_u32 s6, s6, s7
    s_mul_i32 s6, s6, 3
    s_add_u32 s6, s6, 1
    s_lshl_b32 s6, s6, 5
    s_add_u32 s6, s6, s3
    s_lshl_b32 s6, s6, 2
    s_add_u32 s6, s6, 15728640
    s_andn2_b32 s6, s6, 127
    v_cmp_eq_u32 vcc, 4, v2
    v_mov_b32 v4, s6
    s_nop 0
    v_cndmask_b32 v3, v3, v4, vcc
    s_and_b32 s6, s4, 7
    s_lshl_b32 s7, s5, 3
    s_add_u32 s6, s6, s7
    s_lshr_b32 s7, s4, 3
    s_add_u32 s7, s7, 2
    s_add_u32 s7, s7, 1
    s_and_b32 s7, s7, 3
    s_lshl_b32 s6, s6, 2
    s_add_u32 s6, s6, s7
    s_mul_i32 s6, s6, 3
    s_add_u32 s6, s6, 2
    s_lshl_b32 s6, s6, 5
    s_add_u32 s6, s6, s3
    s_lshl_b32 s6, s6, 2
    s_add_u32 s6, s6, 15728640
    s_andn2_b32 s6, s6, 127
    v_cmp_eq_u32 vcc, 5, v2
    v_mov_b32 v4, s6
    s_nop 0
    v_cndmask_b32 v3, v3, v4, vcc
    s_mov_b32 s6, 0x5000000
    s_cmp_eq_u32 s2, 31
    s_cmov_b32 s6, 3801088
    s_andn2_b32 s6, s6, 127
    v_cmp_eq_u32 vcc, 6, v2
    v_mov_b32 v4, s6
    s_nop 0
    v_cndmask_b32 v3, v3, v4, vcc
    s_lshl_b32 s6, s2, 7
    s_add_u32 s6, s6, 2621440
    s_andn2_b32 s6, s6, 127
    v_cmp_eq_u32 vcc, 7, v2
    v_mov_b32 v4, s6
    s_nop 0
    v_cndmask_b32 v3, v3, v4, vcc
    v_add_u32 v4, 160896, v13
    s_mov_b32 exec_lo, 0
    s_mov_b32 exec_hi, 0x03000000
    ds_read_b128 v[36:39], v4
    s_mov_b64 exec, -1
    s_waitcnt lgkmcnt(0)
L_z7:
    v_and_b32 v2, 7, v1
    v_lshl_add_u32 v3, v2, 4, v3
    buffer_store_dwordx4 v[36:39], v3, s[8:11], 0 offen sc1
L_zd:
    s_cmp_ge_u32 s76, 2
    s_cbranch_scc1 L_tch_2a
    s_and_b32 s6, s4, 3
    s_lshl_b32 s6, s6, 19
    s_lshl_b32 s7, s5, 15
    s_add_u32 s6, s6, s7
    s_lshl_b32 s7, s76, 7
    s_add_u32 s6, s6, s7
    s_add_u32 s6, s6, 768
    v_lshrrev_b32 v6, 1, v1
    v_lshlrev_b32 v6, 10, v6
    v_and_b32 v7, 1, v1
    v_lshl_add_u32 v6, v7, 6, v6
    buffer_load_dword v11, v6, s[12:15], s6 offen
    s_add_u32 s6, s6, 262144
    buffer_load_dword v11, v6, s[12:15], s6 offen
    s_branch L_tch_2c
L_tch_2a:
    v_lshrrev_b32 v6, 5, v1
    v_lshlrev_b32 v6, 6, v6
    v_bfe_u32 v7, v1, 2, 3
    v_add_u32 v6, v6, v7
    v_lshlrev_b32 v6, 13, v6
    v_and_b32 v7, 3, v1
    v_lshl_add_u32 v6, v7, 6, v6
    s_lshl_b32 s6, s4, 8
    s_lshl_b32 s7, s5, 16
    s_add_u32 s6, s6, s7
    s_add_u32 s6, s6, 3145728
    s_cmp_lg_u32 s76, 2
    s_cbranch_scc1 L_tch_2b
    buffer_load_dword v11, v6, s[16:19], s6 offen
    s_branch L_tch_2c
L_tch_2b:
    buffer_load_dword v11, v6, s[20:23], s6 offen
L_tch_2c:
    s_branch L_hook_back
L_hook4:
    s_cmp_lg_u32 s3, 4
    s_cbranch_scc1 L_hook4b
    s_mov_b32 s28, s56
    s_mov_b32 s29, s57
    s_mov_b32 s30, 0x100
    s_mov_b32 s31, 0x20000
    v_mov_b32 v2, 1
    v_lshlrev_b32 v3, 8, v1
    s_and_b32 s6, s2, 31
    s_lshl_b32 s6, s6, 2
    buffer_atomic_add v2, v3, s[28:31], s6 offen offset:0 sc1
L_hook4b:
    s_lshl_b32 s74, s76, 12
    s_add_u32 s74, s74, 131072
    s_mov_b32 m0, s74
    s_add_u32 s74, s74, 16384
    buffer_load_dwordx4 v44, s[24:27], s71 offen offset:0 lds
    buffer_load_dwordx4 v45, s[24:27], s71 offen offset:1024 lds
    buffer_load_dwordx4 v46, s[24:27], s71 offen offset:2048 lds
    buffer_load_dwordx4 v47, s[24:27], s71 offen offset:3072 lds
    s_add_u32 s71, s71, 524288
    s_sub_u32 s75, s71, 5242880
    s_cselect_b32 s71, s71, s75
    s_mov_b32 m0, s74
    s_add_u32 s74, s74, 16384
    buffer_load_dwordx4 v44, s[24:27], s71 offen offset:0 lds
    buffer_load_dwordx4 v45, s[24:27], s71 offen offset:1024 lds
    buffer_load_dwordx4 v46, s[24:27], s71 offen offset:2048 lds
    buffer_load_dwordx4 v47, s[24:27], s71 offen offset:3072 lds
    s_add_u32 s71, s71, 524288
    s_sub_u32 s75, s71, 5242880
    s_cselect_b32 s71, s71, s75
    s_branch L_hook_back
L_hook6:
    s_cmp_lg_u32 s3, 5
    s_cbranch_scc1 L_hook_back
    s_mov_b32 s28, s56
    s_mov_b32 s29, s57
    s_mov_b32 s30, 0x100
    s_mov_b32 s31, 0x20000
    v_and_b32 v3, 31, v1
    v_lshlrev_b32 v3, 2, v3
    buffer_load_dword v62, v3, s[28:31], 0 offen offset:0 sc1
    s_branch L_hook_back
L_vpre:
    s_waitcnt vmcnt(0)
    s_lshl_b32 s6, s65, 4
    s_add_u32 s6, s6, s3
    s_cmp_lg_u32 s6, 0x65
    s_cbranch_scc1 L_vnow
    v_cmp_gt_u32 vcc, 8, v62
    s_cbranch_vccz L_cntok_3
    s_mov_b32 s28, s56
    s_mov_b32 s29, s57
    s_mov_b32 s30, 0x100
    s_mov_b32 s31, 0x20000
    v_and_b32 v3, 31, v1
    v_lshlrev_b32 v3, 2, v3
    s_mov_b32 s79, 262144
L_poll_4:
    buffer_load_dword v2, v3, s[28:31], 0 offen offset:0 sc1
    s_waitcnt vmcnt(0)
    v_cmp_gt_u32 vcc, 8, v2
    s_cbranch_vccz L_polldone_5
    s_sleep 8
    s_sub_u32 s79, s79, 1
    s_cmp_lg_u32 s79, 0
    s_cbranch_scc1 L_poll_4
L_polldone_5:
L_cntok_3:
    s_branch L_vnow
L_khook:
    s_cmp_lg_u32 s65, 7
    s_cbranch_scc1 L_khook_back
    buffer_load_dwordx4 v[16:19], v13, s[8:11], s84 offen offset:0 sc1
    buffer_load_dwordx4 v[20:23], v12, s[8:11], s84 offen offset:0 sc1
    buffer_load_dwordx4 v[24:27], v13, s[8:11], s84 offen offset:1024 sc1
    buffer_load_dwordx4 v[28:31], v12, s[8:11], s84 offen offset:1024 sc1
    buffer_load_dwordx4 v[32:35], v13, s[8:11], s84 offen offset:2048 sc1
    buffer_load_dwordx4 v[36:39], v12, s[8:11], s84 offen offset:2048 sc1
    s_branch L_khook_back
L_kv_v:
    ds_read_b128 v[64:67], v48 offset:0
    ds_read_b128 v[68:71], v48 offset:2048
    ds_read_b64_tr_b16 v[96:97], v50 offset:0
    ds_read_b64_tr_b16 v[98:99], v50 offset:1024
    ds_read_b64_tr_b16 v[100:101], v51 offset:0
    ds_read_b64_tr_b16 v[102:103], v51 offset:1024
    ds_read_b128 v[72:75], v48 offset:4096
    ds_read_b64_tr_b16 v[104:105], v52 offset:0
    ds_read_b64_tr_b16 v[106:107], v52 offset:1024
    ds_read_b64_tr_b16 v[108:109], v53 offset:0
    ds_read_b64_tr_b16 v[110:111], v53 offset:1024
    ds_read_b128 v[76:79], v48 offset:6144
    ds_read_b128 v[80:83], v48 offset:8192
    ds_read_b128 v[84:87], v48 offset:10240
    ds_read_b128 v[88:91], v48 offset:12288
    ds_read_b128 v[92:95], v48 offset:14336
    s_cmp_ge_u32 s76, 2
    s_cbranch_scc1 L_tch_6a
    s_and_b32 s6, s4, 3
    s_lshl_b32 s6, s6, 19
    s_lshl_b32 s7, s5, 15
    s_add_u32 s6, s6, s7
    s_lshl_b32 s7, s76, 7
    s_add_u32 s6, s6, s7
    s_add_u32 s6, s6, 256
    v_lshrrev_b32 v6, 1, v1
    v_lshlrev_b32 v6, 10, v6
    v_and_b32 v7, 1, v1
    v_lshl_add_u32 v6, v7, 6, v6
    buffer_load_dword v11, v6, s[12:15], s6 offen
    s_add_u32 s6, s6, 262144
    buffer_load_dword v11, v6, s[12:15], s6 offen
    s_branch L_tch_6c
L_tch_6a:
    v_lshrrev_b32 v6, 5, v1
    v_lshlrev_b32 v6, 6, v6
    v_bfe_u32 v7, v1, 2, 3
    v_add_u32 v6, v6, v7
    v_lshlrev_b32 v6, 13, v6
    v_and_b32 v7, 3, v1
    v_lshl_add_u32 v6, v7, 6, v6
    s_lshl_b32 s6, s4, 8
    s_lshl_b32 s7, s5, 16
    s_add_u32 s6, s6, s7
    s_add_u32 s6, s6, 1048576
    s_cmp_lg_u32 s76, 2
    s_cbranch_scc1 L_tch_6b
    buffer_load_dword v11, v6, s[16:19], s6 offen
    s_branch L_tch_6c
L_tch_6b:
    buffer_load_dword v11, v6, s[20:23], s6 offen
L_tch_6c:
.p2align 4
L_vloop:
    s_bitcmp1_b32 214, s65
    s_cbranch_scc1 L_hook
L_hook_back:
    s_waitcnt lgkmcnt(12)
    v_mfma_f32_16x16x32_bf16 v[128:131], v[64:67], v[96:99], v[128:131]
    ds_read_b64_tr_b16 v[112:113], v50 offset:8192
    s_waitcnt lgkmcnt(11)
    v_mfma_f32_16x16x32_bf16 v[132:135], v[64:67], v[100:103], v[132:135]
    ds_read_b64_tr_b16 v[114:115], v50 offset:9216
    s_waitcnt lgkmcnt(9)
    v_mfma_f32_16x16x32_bf16 v[136:139], v[64:67], v[104:107], v[136:139]
    ds_read_b64_tr_b16 v[116:117], v51 offset:8192
    s_waitcnt lgkmcnt(8)
    v_mfma_f32_16x16x32_bf16 v[140:143], v[64:67], v[108:111], v[140:143]
    ds_read_b64_tr_b16 v[118:119], v51 offset:9216
    ds_read_b128 v[64:67], v49 offset:0
    v_mfma_f32_16x16x32_bf16 v[144:147], v[68:71], v[96:99], v[144:147]
    ds_read_b64_tr_b16 v[120:121], v52 offset:8192
    v_mfma_f32_16x16x32_bf16 v[148:151], v[68:71], v[100:103], v[148:151]
    ds_read_b64_tr_b16 v[122:123], v52 offset:9216
    v_mfma_f32_16x16x32_bf16 v[152:155], v[68:71], v[104:107], v[152:155]
    ds_read_b64_tr_b16 v[124:125], v53 offset:8192
    v_mfma_f32_16x16x32_bf16 v[156:159], v[68:71], v[108:111], v[156:159]
    ds_read_b64_tr_b16 v[126:127], v53 offset:9216
    ds_read_b128 v[68:71], v49 offset:2048
    v_mfma_f32_16x16x32_bf16 v[160:163], v[72:75], v[96:99], v[160:163]
    v_mfma_f32_16x16x32_bf16 v[164:167], v[72:75], v[100:103], v[164:167]
    v_mfma_f32_16x16x32_bf16 v[168:171], v[72:75], v[104:107], v[168:171]
    v_mfma_f32_16x16x32_bf16 v[172:175], v[72:75], v[108:111], v[172:175]
    ds_read_b128 v[72:75], v49 offset:4096
    s_waitcnt lgkmcnt(15)
    v_mfma_f32_16x16x32_bf16 v[176:179], v[76:79], v[96:99], v[176:179]
    v_mfma_f32_16x16x32_bf16 v[180:183], v[76:79], v[100:103], v[180:183]
    v_mfma_f32_16x16x32_bf16 v[184:187], v[76:79], v[104:107], v[184:187]
    v_mfma_f32_16x16x32_bf16 v[188:191], v[76:79], v[108:111], v[188:191]
    ds_read_b128 v[76:79], v49 offset:6144
    s_waitcnt lgkmcnt(15)
    v_mfma_f32_16x16x32_bf16 v[192:195], v[80:83], v[96:99], v[192:195]
    v_mfma_f32_16x16x32_bf16 v[196:199], v[80:83], v[100:103], v[196:199]
    v_mfma_f32_16x16x32_bf16 v[200:203], v[80:83], v[104:107], v[200:203]
    v_mfma_f32_16x16x32_bf16 v[204:207], v[80:83], v[108:111], v[204:207]
    ds_read_b128 v[80:83], v49 offset:8192
    s_waitcnt lgkmcnt(15)
    v_mfma_f32_16x16x32_bf16 v[208:211], v[84:87], v[96:99], v[208:211]
    v_mfma_f32_16x16x32_bf16 v[212:215], v[84:87], v[100:103], v[212:215]
    v_mfma_f32_16x16x32_bf16 v[216:219], v[84:87], v[104:107], v[216:219]
    v_mfma_f32_16x16x32_bf16 v[220:223], v[84:87], v[108:111], v[220:223]
    ds_read_b128 v[84:87], v49 offset:10240
    s_waitcnt lgkmcnt(15)
    v_mfma_f32_16x16x32_bf16 v[224:227], v[88:91], v[96:99], v[224:227]
    v_mfma_f32_16x16x32_bf16 v[228:231], v[88:91], v[100:103], v[228:231]
    v_mfma_f32_16x16x32_bf16 v[232:235], v[88:91], v[104:107], v[232:235]
    v_mfma_f32_16x16x32_bf16 v[236:239], v[88:91], v[108:111], v[236:239]
    ds_read_b128 v[88:91], v49 offset:12288
    s_waitcnt lgkmcnt(15)
    v_mfma_f32_16x16x32_bf16 v[240:243], v[92:95], v[96:99], v[240:243]
    v_mfma_f32_16x16x32_bf16 v[244:247], v[92:95], v[100:103], v[244:247]
    v_mfma_f32_16x16x32_bf16 v[248:251], v[92:95], v[104:107], v[248:251]
    v_mfma_f32_16x16x32_bf16 v[252:255], v[92:95], v[108:111], v[252:255]
    ds_read_b128 v[92:95], v49 offset:14336
    s_waitcnt lgkmcnt(11)
    v_mfma_f32_16x16x32_bf16 v[128:131], v[64:67], v[112:115], v[128:131]
    v_mfma_f32_16x16x32_bf16 v[132:135], v[64:67], v[116:119], v[132:135]
    s_waitcnt lgkmcnt(9)
    v_mfma_f32_16x16x32_bf16 v[136:139], v[64:67], v[120:123], v[136:139]
    s_waitcnt lgkmcnt(7)
    v_mfma_f32_16x16x32_bf16 v[140:143], v[64:67], v[124:127], v[140:143]
    s_waitcnt lgkmcnt(6)
    v_mfma_f32_16x16x32_bf16 v[144:147], v[68:71], v[112:115], v[144:147]
    v_mfma_f32_16x16x32_bf16 v[148:151], v[68:71], v[116:119], v[148:151]
    v_mfma_f32_16x16x32_bf16 v[152:155], v[68:71], v[120:123], v[152:155]
    v_mfma_f32_16x16x32_bf16 v[156:159], v[68:71], v[124:127], v[156:159]
    v_xor_b32 v48, 0x10000, v48
    v_xor_b32 v49, 0x10000, v49
    v_xor_b32 v50, 0x10000, v50
    v_xor_b32 v51, 0x10000, v51
    v_xor_b32 v52, 0x10000, v52
    v_xor_b32 v53, 0x10000, v53
    s_bitcmp1_b32 0x48, s65
    s_cbranch_scc1 L_vpre
L_vnow:
    s_waitcnt lgkmcnt(0)
    s_barrier
    ds_read_b128 v[64:67], v48 offset:0
    ds_read_b128 v[68:71], v48 offset:2048
    v_mfma_f32_16x16x32_bf16 v[160:163], v[72:75], v[112:115], v[160:163]
    ds_read_b64_tr_b16 v[96:97], v50 offset:0
    v_mfma_f32_16x16x32_bf16 v[164:167], v[72:75], v[116:119], v[164:167]
    ds_read_b64_tr_b16 v[98:99], v50 offset:1024
    v_mfma_f32_16x16x32_bf16 v[168:171], v[72:75], v[120:123], v[168:171]
    ds_read_b64_tr_b16 v[100:101], v51 offset:0
    v_mfma_f32_16x16x32_bf16 v[172:175], v[72:75], v[124:127], v[172:175]
    ds_read_b64_tr_b16 v[102:103], v51 offset:1024
    ds_read_b128 v[72:75], v48 offset:4096
    v_mfma_f32_16x16x32_bf16 v[176:179], v[76:79], v[112:115], v[176:179]
    ds_read_b64_tr_b16 v[104:105], v52 offset:0
    v_mfma_f32_16x16x32_bf16 v[180:183], v[76:79], v[116:119], v[180:183]
    ds_read_b64_tr_b16 v[106:107], v52 offset:1024
    v_mfma_f32_16x16x32_bf16 v[184:187], v[76:79], v[120:123], v[184:187]
    ds_read_b64_tr_b16 v[108:109], v53 offset:0
    v_mfma_f32_16x16x32_bf16 v[188:191], v[76:79], v[124:127], v[188:191]
    ds_read_b64_tr_b16 v[110:111], v53 offset:1024
    ds_read_b128 v[76:79], v48 offset:6144
    v_mfma_f32_16x16x32_bf16 v[192:195], v[80:83], v[112:115], v[192:195]
    v_mfma_f32_16x16x32_bf16 v[196:199], v[80:83], v[116:119], v[196:199]
    v_mfma_f32_16x16x32_bf16 v[200:203], v[80:83], v[120:123], v[200:203]
    v_mfma_f32_16x16x32_bf16 v[204:207], v[80:83], v[124:127], v[204:207]
    ds_read_b128 v[80:83], v48 offset:8192
    v_mfma_f32_16x16x32_bf16 v[208:211], v[84:87], v[112:115], v[208:211]
    v_mfma_f32_16x16x32_bf16 v[212:215], v[84:87], v[116:119], v[212:215]
    v_mfma_f32_16x16x32_bf16 v[216:219], v[84:87], v[120:123], v[216:219]
    v_mfma_f32_16x16x32_bf16 v[220:223], v[84:87], v[124:127], v[220:223]
    ds_read_b128 v[84:87], v48 offset:10240
    v_mfma_f32_16x16x32_bf16 v[224:227], v[88:91], v[112:115], v[224:227]
    v_mfma_f32_16x16x32_bf16 v[228:231], v[88:91], v[116:119], v[228:231]
    v_mfma_f32_16x16x32_bf16 v[232:235], v[88:91], v[120:123], v[232:235]
    v_mfma_f32_16x16x32_bf16 v[236:239], v[88:91], v[124:127], v[236:239]
    ds_read_b128 v[88:91], v48 offset:12288
    v_mfma_f32_16x16x32_bf16 v[240:243], v[92:95], v[112:115], v[240:243]
    v_mfma_f32_16x16x32_bf16 v[244:247], v[92:95], v[116:119], v[244:247]
    v_mfma_f32_16x16x32_bf16 v[248:251], v[92:95], v[120:123], v[248:251]
    v_mfma_f32_16x16x32_bf16 v[252:255], v[92:95], v[124:127], v[252:255]
    ds_read_b128 v[92:95], v48 offset:14336
    s_add_u32 s65, s65, 1
    s_cmp_lt_u32 s65, 8
    s_cbranch_scc1 L_vloop
    s_waitcnt lgkmcnt(0)
    s_nop 7
    v_cvt_pk_bf16_f32 v128, v128, v129
    v_cvt_pk_bf16_f32 v129, v130, v131
    v_cvt_pk_bf16_f32 v130, v144, v145
    v_cvt_pk_bf16_f32 v131, v146, v147
    v_cvt_pk_bf16_f32 v132, v132, v133
    v_cvt_pk_bf16_f32 v133, v134, v135
    v_cvt_pk_bf16_f32 v134, v148, v149
    v_cvt_pk_bf16_f32 v135, v150, v151
    v_cvt_pk_bf16_f32 v136, v136, v137
    v_cvt_pk_bf16_f32 v137, v138, v139
    v_cvt_pk_bf16_f32 v138, v152, v153
    v_cvt_pk_bf16_f32 v139, v154, v155
    v_cvt_pk_bf16_f32 v140, v140, v141
    v_cvt_pk_bf16_f32 v141, v142, v143
    v_cvt_pk_bf16_f32 v142, v156, v157
    v_cvt_pk_bf16_f32 v143, v158, v159
    v_cvt_pk_bf16_f32 v144, v160, v161
    v_cvt_pk_bf16_f32 v145, v162, v163
    v_cvt_pk_bf16_f32 v146, v176, v177
    v_cvt_pk_bf16_f32 v147, v178, v179
    v_cvt_pk_bf16_f32 v148, v164, v165
    v_cvt_pk_bf16_f32 v149, v166, v167
    v_cvt_pk_bf16_f32 v150, v180, v181
    v_cvt_pk_bf16_f32 v151, v182, v183
    v_cvt_pk_bf16_f32 v152, v168, v169
    v_cvt_pk_bf16_f32 v153, v170, v171
    v_cvt_pk_bf16_f32 v154, v184, v185
    v_cvt_pk_bf16_f32 v155, v186, v187
    v_cvt_pk_bf16_f32 v156, v172, v173
    v_cvt_pk_bf16_f32 v157, v174, v175
    v_cvt_pk_bf16_f32 v158, v188, v189
    v_cvt_pk_bf16_f32 v159, v190, v191
    v_cvt_pk_bf16_f32 v160, v192, v193
    v_cvt_pk_bf16_f32 v161, v194, v195
    v_cvt_pk_bf16_f32 v162, v208, v209
    v_cvt_pk_bf16_f32 v163, v210, v211
    v_cvt_pk_bf16_f32 v164, v196, v197
    v_cvt_pk_bf16_f32 v165, v198, v199
    v_cvt_pk_bf16_f32 v166, v212, v213
    v_cvt_pk_bf16_f32 v167, v214, v215
    v_cvt_pk_bf16_f32 v168, v200, v201
    v_cvt_pk_bf16_f32 v169, v202, v203
    v_cvt_pk_bf16_f32 v170, v216, v217
    v_cvt_pk_bf16_f32 v171, v218, v219
    v_cvt_pk_bf16_f32 v172, v204, v205
    v_cvt_pk_bf16_f32 v173, v206, v207
    v_cvt_pk_bf16_f32 v174, v220, v221
    v_cvt_pk_bf16_f32 v175, v222, v223
    v_cvt_pk_bf16_f32 v176, v224, v225
    v_cvt_pk_bf16_f32 v177, v226, v227
    v_cvt_pk_bf16_f32 v178, v240, v241
    v_cvt_pk_bf16_f32 v179, v242, v243
    v_cvt_pk_bf16_f32 v180, v228, v229
    v_cvt_pk_bf16_f32 v181, v230, v231
    v_cvt_pk_bf16_f32 v182, v244, v245
    v_cvt_pk_bf16_f32 v183, v246, v247
    v_cvt_pk_bf16_f32 v184, v232, v233
    v_cvt_pk_bf16_f32 v185, v234, v235
    v_cvt_pk_bf16_f32 v186, v248, v249
    v_cvt_pk_bf16_f32 v187, v250, v251
    v_cvt_pk_bf16_f32 v188, v236, v237
    v_cvt_pk_bf16_f32 v189, v238, v239
    v_cvt_pk_bf16_f32 v190, v252, v253
    v_cvt_pk_bf16_f32 v191, v254, v255
    s_waitcnt vmcnt(0)
L_q:
    s_mov_b32 s28, s56
    s_mov_b32 s29, s57
    s_mov_b32 s30, 0x100
    s_mov_b32 s31, 0x20000
    s_lshl_b32 s6, s76, 13
    v_add_u32 v49, s6, v13
    s_lshl_b32 s6, s76, 12
    v_add_u32 v50, s6, v13
    s_lshl_b32 s77, s4, 20
    s_add_u32 s77, s77, 16777216
    s_mov_b32 s78, s100
    s_sub_u32 s101, s100, 131072
    s_mov_b32 s90, 0
    s_cmp_lt_u32 s3, 4
    s_cselect_b32 s89, 3, 2
    ds_read_b64_tr_b16 v[96:97], v54 offset:0
    ds_read_b64_tr_b16 v[98:99], v54 offset:1024
    ds_read_b64_tr_b16 v[100:101], v55 offset:0
    ds_read_b64_tr_b16 v[102:103], v55 offset:1024
    ds_read_b64_tr_b16 v[104:105], v56 offset:0
    ds_read_b64_tr_b16 v[106:107], v56 offset:1024
    ds_read_b64_tr_b16 v[108:109], v57 offset:0
    ds_read_b64_tr_b16 v[110:111], v57 offset:1024
    ds_read_b64_tr_b16 v[112:113], v58 offset:0
    ds_read_b64_tr_b16 v[114:115], v58 offset:1024
    ds_read_b64_tr_b16 v[116:117], v59 offset:0
    ds_read_b64_tr_b16 v[118:119], v59 offset:1024
    ds_read_b64_tr_b16 v[120:121], v60 offset:0
    ds_read_b64_tr_b16 v[122:123], v60 offset:1024
    ds_read_b64_tr_b16 v[124:125], v61 offset:0
    ds_read_b64_tr_b16 v[126:127], v61 offset:1024
    buffer_load_dwordx4 v[64:67], v13, s[8:11], s84 offen offset:3072 sc1
    buffer_load_dwordx4 v[68:71], v12, s[8:11], s84 offen offset:3072 sc1
    buffer_load_dwordx4 v[72:75], v13, s[8:11], s85 offen offset:0 sc1
    buffer_load_dwordx4 v[76:79], v12, s[8:11], s85 offen offset:0 sc1
    buffer_load_dwordx4 v[80:83], v13, s[8:11], s85 offen offset:1024 sc1
    buffer_load_dwordx4 v[84:87], v12, s[8:11], s85 offen offset:1024 sc1
    buffer_load_dwordx4 v[88:91], v13, s[8:11], s85 offen offset:2048 sc1
    buffer_load_dwordx4 v[92:95], v12, s[8:11], s85 offen offset:2048 sc1
    s_waitcnt lgkmcnt(14)
    v_mfma_f32_16x16x32_bf16 v[192:195], v[96:99], v[16:19], 0
    v_mfma_f32_16x16x32_bf16 v[196:199], v[96:99], v[20:23], 0
    ds_read_b64_tr_b16 v[96:97], v54 offset:8192
    s_waitcnt lgkmcnt(13)
    v_mfma_f32_16x16x32_bf16 v[200:203], v[100:103], v[16:19], 0
    ds_read_b64_tr_b16 v[98:99], v54 offset:9216
    v_mfma_f32_16x16x32_bf16 v[204:207], v[100:103], v[20:23], 0
    ds_read_b64_tr_b16 v[100:101], v55 offset:8192
    s_waitcnt lgkmcnt(13)
    v_mfma_f32_16x16x32_bf16 v[208:211], v[104:107], v[16:19], 0
    ds_read_b64_tr_b16 v[102:103], v55 offset:9216
    v_mfma_f32_16x16x32_bf16 v[212:215], v[104:107], v[20:23], 0
    ds_read_b64_tr_b16 v[104:105], v56 offset:8192
    s_waitcnt lgkmcnt(13)
    v_mfma_f32_16x16x32_bf16 v[216:219], v[108:111], v[16:19], 0
    ds_read_b64_tr_b16 v[106:107], v56 offset:9216
    buffer_store_dwordx4 v[128:131], v13, s[8:11], s67 offen sc1
    s_add_u32 s67, s67, 1024
    v_mfma_f32_16x16x32_bf16 v[220:223], v[108:111], v[20:23], 0
    ds_read_b64_tr_b16 v[108:109], v57 offset:8192
    s_waitcnt lgkmcnt(13)
    v_mfma_f32_16x16x32_bf16 v[224:227], v[112:115], v[16:19], 0
    ds_read_b64_tr_b16 v[110:111], v57 offset:9216
    v_mfma_f32_16x16x32_bf16 v[228:231], v[112:115], v[20:23], 0
    ds_read_b64_tr_b16 v[112:113], v58 offset:8192
    s_waitcnt lgkmcnt(13)
    v_mfma_f32_16x16x32_bf16 v[232:235], v[116:119], v[16:19], 0
    ds_read_b64_tr_b16 v[114:115], v58 offset:9216
    v_mfma_f32_16x16x32_bf16 v[236:239], v[116:119], v[20:23], 0
    ds_read_b64_tr_b16 v[116:117], v59 offset:8192
    s_waitcnt lgkmcnt(13)
    v_mfma_f32_16x16x32_bf16 v[240:243], v[120:123], v[16:19], 0
    ds_read_b64_tr_b16 v[118:119], v59 offset:9216
    v_mfma_f32_16x16x32_bf16 v[244:247], v[120:123], v[20:23], 0
    ds_read_b64_tr_b16 v[120:121], v60 offset:8192
    s_waitcnt lgkmcnt(13)
    v_mfma_f32_16x16x32_bf16 v[248:251], v[124:127], v[16:19], 0
    ds_read_b64_tr_b16 v[122:123], v60 offset:9216
    v_mfma_f32_16x16x32_bf16 v[252:255], v[124:127], v[20:23], 0
    ds_read_b64_tr_b16 v[124:125], v61 offset:8192
    ds_read_b64_tr_b16 v[126:127], v61 offset:9216
    buffer_load_dwordx4 v[16:19], v13, s[8:11], s85 offen offset:3072 sc1
    buffer_load_dwordx4 v[20:23], v12, s[8:11], s85 offen offset:3072 sc1
    s_waitcnt lgkmcnt(14)
    v_mfma_f32_16x16x32_bf16 v[192:195], v[96:99], v[24:27], v[192:195]
    v_mfma_f32_16x16x32_bf16 v[196:199], v[96:99], v[28:31], v[196:199]
    ds_read_b64_tr_b16 v[96:97], v54 offset:16384
    s_waitcnt lgkmcnt(13)
    v_mfma_f32_16x16x32_bf16 v[200:203], v[100:103], v[24:27], v[200:203]
    ds_read_b64_tr_b16 v[98:99], v54 offset:17408
    v_mfma_f32_16x16x32_bf16 v[204:207], v[100:103], v[28:31], v[204:207]
    ds_read_b64_tr_b16 v[100:101], v55 offset:16384
    s_waitcnt lgkmcnt(13)
    v_mfma_f32_16x16x32_bf16 v[208:211], v[104:107], v[24:27], v[208:211]
    ds_read_b64_tr_b16 v[102:103], v55 offset:17408
    v_mfma_f32_16x16x32_bf16 v[212:215], v[104:107], v[28:31], v[212:215]
    ds_read_b64_tr_b16 v[104:105], v56 offset:16384
    s_waitcnt lgkmcnt(13)
    v_mfma_f32_16x16x32_bf16 v[216:219], v[108:111], v[24:27], v[216:219]
    ds_read_b64_tr_b16 v[106:107], v56 offset:17408
    buffer_store_dwordx4 v[132:135], v13, s[8:11], s67 offen sc1
    s_add_u32 s67, s67, s68
    v_mfma_f32_16x16x32_bf16 v[220:223], v[108:111], v[28:31], v[220:223]
    ds_read_b64_tr_b16 v[108:109], v57 offset:16384
    s_waitcnt lgkmcnt(13)
    v_mfma_f32_16x16x32_bf16 v[224:227], v[112:115], v[24:27], v[224:227]
    ds_read_b64_tr_b16 v[110:111], v57 offset:17408
    v_mfma_f32_16x16x32_bf16 v[228:231], v[112:115], v[28:31], v[228:231]
    ds_read_b64_tr_b16 v[112:113], v58 offset:16384
    s_waitcnt lgkmcnt(13)
    v_mfma_f32_16x16x32_bf16 v[232:235], v[116:119], v[24:27], v[232:235]
    ds_read_b64_tr_b16 v[114:115], v58 offset:17408
    v_mfma_f32_16x16x32_bf16 v[236:239], v[116:119], v[28:31], v[236:239]
    ds_read_b64_tr_b16 v[116:117], v59 offset:16384
    s_waitcnt lgkmcnt(13)
    v_mfma_f32_16x16x32_bf16 v[240:243], v[120:123], v[24:27], v[240:243]
    ds_read_b64_tr_b16 v[118:119], v59 offset:17408
    v_mfma_f32_16x16x32_bf16 v[244:247], v[120:123], v[28:31], v[244:247]
    ds_read_b64_tr_b16 v[120:121], v60 offset:16384
    s_waitcnt lgkmcnt(13)
    v_mfma_f32_16x16x32_bf16 v[248:251], v[124:127], v[24:27], v[248:251]
    ds_read_b64_tr_b16 v[122:123], v60 offset:17408
    v_mfma_f32_16x16x32_bf16 v[252:255], v[124:127], v[28:31], v[252:255]
    ds_read_b64_tr_b16 v[124:125], v61 offset:16384
    ds_read_b64_tr_b16 v[126:127], v61 offset:17408
    buffer_load_dwordx4 v[24:27], v13, s[8:11], s86 offen offset:0 sc1
    buffer_load_dwordx4 v[28:31], v12, s[8:11], s86 offen offset:0 sc1
    s_waitcnt lgkmcnt(14)
    v_mfma_f32_16x16x32_bf16 v[192:195], v[96:99], v[32:35], v[192:195]
    v_mfma_f32_16x16x32_bf16 v[196:199], v[96:99], v[36:39], v[196:199]
    ds_read_b64_tr_b16 v[96:97], v54 offset:24576
    s_waitcnt lgkmcnt(13)
    v_mfma_f32_16x16x32_bf16 v[200:203], v[100:103], v[32:35], v[200:203]
    ds_read_b64_tr_b16 v[98:99], v54 offset:25600
    v_mfma_f32_16x16x32_bf16 v[204:207], v[100:103], v[36:39], v[204:207]
    ds_read_b64_tr_b16 v[100:101], v55 offset:24576
    s_waitcnt lgkmcnt(13)
    v_mfma_f32_16x16x32_bf16 v[208:211], v[104:107], v[32:35], v[208:211]
    ds_read_b64_tr_b16 v[102:103], v55 offset:25600
    v_mfma_f32_16x16x32_bf16 v[212:215], v[104:107], v[36:39], v[212:215]
    ds_read_b64_tr_b16 v[104:105], v56 offset:24576
    s_waitcnt lgkmcnt(13)
    v_mfma_f32_16x16x32_bf16 v[216:219], v[108:111], v[32:35], v[216:219]
    ds_read_b64_tr_b16 v[106:107], v56 offset:25600
    buffer_store_dwordx4 v[136:139], v13, s[8:11], s67 offen sc1
    s_add_u32 s67, s67, 1024
    v_mfma_f32_16x16x32_bf16 v[220:223], v[108:111], v[36:39], v[220:223]
    ds_read_b64_tr_b16 v[108:109], v57 offset:24576
    s_waitcnt lgkmcnt(13)
    v_mfma_f32_16x16x32_bf16 v[224:227], v[112:115], v[32:35], v[224:227]
    ds_read_b64_tr_b16 v[110:111], v57 offset:25600
    v_mfma_f32_16x16x32_bf16 v[228:231], v[112:115], v[36:39], v[228:231]
    ds_read_b64_tr_b16 v[112:113], v58 offset:24576
    s_waitcnt lgkmcnt(13)
    v_mfma_f32_16x16x32_bf16 v[232:235], v[116:119], v[32:35], v[232:235]
    ds_read_b64_tr_b16 v[114:115], v58 offset:25600
    v_mfma_f32_16x16x32_bf16 v[236:239], v[116:119], v[36:39], v[236:239]
    ds_read_b64_tr_b16 v[116:117], v59 offset:24576
    s_waitcnt lgkmcnt(13)
    v_mfma_f32_16x16x32_bf16 v[240:243], v[120:123], v[32:35], v[240:243]
    ds_read_b64_tr_b16 v[118:119], v59 offset:25600
    v_mfma_f32_16x16x32_bf16 v[244:247], v[120:123], v[36:39], v[244:247]
    ds_read_b64_tr_b16 v[120:121], v60 offset:24576
    s_waitcnt lgkmcnt(13)
    v_mfma_f32_16x16x32_bf16 v[248:251], v[124:127], v[32:35], v[248:251]
    ds_read_b64_tr_b16 v[122:123], v60 offset:25600
    v_mfma_f32_16x16x32_bf16 v[252:255], v[124:127], v[36:39], v[252:255]
    ds_read_b64_tr_b16 v[124:125], v61 offset:24576
    ds_read_b64_tr_b16 v[126:127], v61 offset:25600
    buffer_load_dwordx4 v[32:35], v13, s[8:11], s86 offen offset:1024 sc1
    buffer_load_dwordx4 v[36:39], v12, s[8:11], s86 offen offset:1024 sc1
    s_waitcnt vmcnt(15)
    s_waitcnt lgkmcnt(14)
    v_mfma_f32_16x16x32_bf16 v[192:195], v[96:99], v[64:67], v[192:195]
    v_add_u32 v54, s101, v54
    v_mfma_f32_16x16x32_bf16 v[196:199], v[96:99], v[68:71], v[196:199]
    ds_read_b64_tr_b16 v[96:97], v54 offset:0
    s_waitcnt lgkmcnt(13)
    v_mfma_f32_16x16x32_bf16 v[200:203], v[100:103], v[64:67], v[200:203]
    ds_read_b64_tr_b16 v[98:99], v54 offset:1024
    v_add_u32 v55, s101, v55
    v_mfma_f32_16x16x32_bf16 v[204:207], v[100:103], v[68:71], v[204:207]
    ds_read_b64_tr_b16 v[100:101], v55 offset:0
    s_waitcnt lgkmcnt(13)
    v_mfma_f32_16x16x32_bf16 v[208:211], v[104:107], v[64:67], v[208:211]
    ds_read_b64_tr_b16 v[102:103], v55 offset:1024
    v_add_u32 v56, s101, v56
    v_mfma_f32_16x16x32_bf16 v[212:215], v[104:107], v[68:71], v[212:215]
    ds_read_b64_tr_b16 v[104:105], v56 offset:0
    s_waitcnt lgkmcnt(13)
    v_mfma_f32_16x16x32_bf16 v[216:219], v[108:111], v[64:67], v[216:219]
    ds_read_b64_tr_b16 v[106:107], v56 offset:1024
    v_add_u32 v57, s101, v57
    buffer_store_dwordx4 v[140:143], v13, s[8:11], s67 offen sc1
    s_add_u32 s67, s67, s69
    v_mfma_f32_16x16x32_bf16 v[220:223], v[108:111], v[68:71], v[220:223]
    ds_read_b64_tr_b16 v[108:109], v57 offset:0
    s_waitcnt lgkmcnt(13)
    v_mfma_f32_16x16x32_bf16 v[224:227], v[112:115], v[64:67], v[224:227]
    ds_read_b64_tr_b16 v[110:111], v57 offset:1024
    v_add_u32 v58, s101, v58
    v_mfma_f32_16x16x32_bf16 v[228:231], v[112:115], v[68:71], v[228:231]
    ds_read_b64_tr_b16 v[112:113], v58 offset:0
    s_waitcnt lgkmcnt(13)
    v_mfma_f32_16x16x32_bf16 v[232:235], v[116:119], v[64:67], v[232:235]
    ds_read_b64_tr_b16 v[114:115], v58 offset:1024
    v_add_u32 v59, s101, v59
    v_mfma_f32_16x16x32_bf16 v[236:239], v[116:119], v[68:71], v[236:239]
    ds_read_b64_tr_b16 v[116:117], v59 offset:0
    s_waitcnt lgkmcnt(13)
    v_mfma_f32_16x16x32_bf16 v[240:243], v[120:123], v[64:67], v[240:243]
    ds_read_b64_tr_b16 v[118:119], v59 offset:1024
    v_add_u32 v60, s101, v60
    v_mfma_f32_16x16x32_bf16 v[244:247], v[120:123], v[68:71], v[244:247]
    ds_read_b64_tr_b16 v[120:121], v60 offset:0
    s_waitcnt lgkmcnt(13)
    v_mfma_f32_16x16x32_bf16 v[248:251], v[124:127], v[64:67], v[248:251]
    ds_read_b64_tr_b16 v[122:123], v60 offset:1024
    v_add_u32 v61, s101, v61
    v_mfma_f32_16x16x32_bf16 v[252:255], v[124:127], v[68:71], v[252:255]
    ds_read_b64_tr_b16 v[124:125], v61 offset:0
    ds_read_b64_tr_b16 v[126:127], v61 offset:1024
    buffer_load_dwordx4 v[64:67], v13, s[8:11], s86 offen offset:2048 sc1
    buffer_load_dwordx4 v[68:71], v12, s[8:11], s86 offen offset:2048 sc1
    s_waitcnt vmcnt(16)
    s_waitcnt lgkmcnt(14)
    v_mfma_f32_16x16x32_bf16 v[192:195], v[96:99], v[72:75], v[192:195]
    v_mfma_f32_16x16x32_bf16 v[196:199], v[96:99], v[76:79], v[196:199]
    ds_read_b64_tr_b16 v[96:97], v54 offset:8192
    s_waitcnt lgkmcnt(13)
    v_mfma_f32_16x16x32_bf16 v[200:203], v[100:103], v[72:75], v[200:203]
    ds_read_b64_tr_b16 v[98:99], v54 offset:9216
    v_mfma_f32_16x16x32_bf16 v[204:207], v[100:103], v[76:79], v[204:207]
    ds_read_b64_tr_b16 v[100:101], v55 offset:8192
    s_waitcnt lgkmcnt(13)
    v_mfma_f32_16x16x32_bf16 v[208:211], v[104:107], v[72:75], v[208:211]
    ds_read_b64_tr_b16 v[102:103], v55 offset:9216
    v_mfma_f32_16x16x32_bf16 v[212:215], v[104:107], v[76:79], v[212:215]
    ds_read_b64_tr_b16 v[104:105], v56 offset:8192
    s_waitcnt lgkmcnt(13)
    v_mfma_f32_16x16x32_bf16 v[216:219], v[108:111], v[72:75], v[216:219]
    ds_read_b64_tr_b16 v[106:107], v56 offset:9216
    v_mfma_f32_16x16x32_bf16 v[220:223], v[108:111], v[76:79], v[220:223]
    ds_read_b64_tr_b16 v[108:109], v57 offset:8192
    s_waitcnt lgkmcnt(13)
    v_mfma_f32_16x16x32_bf16 v[224:227], v[112:115], v[72:75], v[224:227]
    ds_read_b64_tr_b16 v[110:111], v57 offset:9216
    v_mfma_f32_16x16x32_bf16 v[228:231], v[112:115], v[76:79], v[228:231]
    ds_read_b64_tr_b16 v[112:113], v58 offset:8192
    s_waitcnt lgkmcnt(13)
    v_mfma_f32_16x16x32_bf16 v[232:235], v[116:119], v[72:75], v[232:235]
    ds_read_b64_tr_b16 v[114:115], v58 offset:9216
    v_mfma_f32_16x16x32_bf16 v[236:239], v[116:119], v[76:79], v[236:239]
    ds_read_b64_tr_b16 v[116:117], v59 offset:8192
    s_waitcnt lgkmcnt(13)
    v_mfma_f32_16x16x32_bf16 v[240:243], v[120:123], v[72:75], v[240:243]
    ds_read_b64_tr_b16 v[118:119], v59 offset:9216
    v_mfma_f32_16x16x32_bf16 v[244:247], v[120:123], v[76:79], v[244:247]
    ds_read_b64_tr_b16 v[120:121], v60 offset:8192
    s_waitcnt lgkmcnt(13)
    v_mfma_f32_16x16x32_bf16 v[248:251], v[124:127], v[72:75], v[248:251]
    ds_read_b64_tr_b16 v[122:123], v60 offset:9216
    v_mfma_f32_16x16x32_bf16 v[252:255], v[124:127], v[76:79], v[252:255]
    ds_read_b64_tr_b16 v[124:125], v61 offset:8192
    ds_read_b64_tr_b16 v[126:127], v61 offset:9216
    buffer_load_dwordx4 v[72:75], v13, s[8:11], s86 offen offset:3072 sc1
    buffer_load_dwordx4 v[76:79], v12, s[8:11], s86 offen offset:3072 sc1
    s_waitcnt vmcnt(16)
    s_waitcnt lgkmcnt(14)
    v_mfma_f32_16x16x32_bf16 v[192:195], v[96:99], v[80:83], v[192:195]
    v_mfma_f32_16x16x32_bf16 v[196:199], v[96:99], v[84:87], v[196:199]
    ds_read_b64_tr_b16 v[96:97], v54 offset:16384
    s_waitcnt lgkmcnt(13)
    v_mfma_f32_16x16x32_bf16 v[200:203], v[100:103], v[80:83], v[200:203]
    ds_read_b64_tr_b16 v[98:99], v54 offset:17408
    v_mfma_f32_16x16x32_bf16 v[204:207], v[100:103], v[84:87], v[204:207]
    ds_read_b64_tr_b16 v[100:101], v55 offset:16384
    s_waitcnt lgkmcnt(13)
    v_mfma_f32_16x16x32_bf16 v[208:211], v[104:107], v[80:83], v[208:211]
    ds_read_b64_tr_b16 v[102:103], v55 offset:17408
    v_mfma_f32_16x16x32_bf16 v[212:215], v[104:107], v[84:87], v[212:215]
    ds_read_b64_tr_b16 v[104:105], v56 offset:16384
    s_waitcnt lgkmcnt(13)
    v_mfma_f32_16x16x32_bf16 v[216:219], v[108:111], v[80:83], v[216:219]
    ds_read_b64_tr_b16 v[106:107], v56 offset:17408
    v_mfma_f32_16x16x32_bf16 v[220:223], v[108:111], v[84:87], v[220:223]
    ds_read_b64_tr_b16 v[108:109], v57 offset:16384
    s_waitcnt lgkmcnt(13)
    v_mfma_f32_16x16x32_bf16 v[224:227], v[112:115], v[80:83], v[224:227]
    ds_read_b64_tr_b16 v[110:111], v57 offset:17408
    v_mfma_f32_16x16x32_bf16 v[228:231], v[112:115], v[84:87], v[228:231]
    ds_read_b64_tr_b16 v[112:113], v58 offset:16384
    s_waitcnt lgkmcnt(13)
    v_mfma_f32_16x16x32_bf16 v[232:235], v[116:119], v[80:83], v[232:235]
    ds_read_b64_tr_b16 v[114:115], v58 offset:17408
    v_mfma_f32_16x16x32_bf16 v[236:239], v[116:119], v[84:87], v[236:239]
    ds_read_b64_tr_b16 v[116:117], v59 offset:16384
    s_waitcnt lgkmcnt(13)
    v_mfma_f32_16x16x32_bf16 v[240:243], v[120:123], v[80:83], v[240:243]
    ds_read_b64_tr_b16 v[118:119], v59 offset:17408
    v_mfma_f32_16x16x32_bf16 v[244:247], v[120:123], v[84:87], v[244:247]
    ds_read_b64_tr_b16 v[120:121], v60 offset:16384
    s_waitcnt lgkmcnt(13)
    v_mfma_f32_16x16x32_bf16 v[248:251], v[124:127], v[80:83], v[248:251]
    ds_read_b64_tr_b16 v[122:123], v60 offset:17408
    v_mfma_f32_16x16x32_bf16 v[252:255], v[124:127], v[84:87], v[252:255]
    ds_read_b64_tr_b16 v[124:125], v61 offset:16384
    ds_read_b64_tr_b16 v[126:127], v61 offset:17408
    buffer_load_dwordx4 v[80:83], v13, s[8:11], s87 offen offset:0 sc1
    buffer_load_dwordx4 v[84:87], v12, s[8:11], s87 offen offset:0 sc1
    s_waitcnt vmcnt(16)
    s_waitcnt lgkmcnt(14)
    v_mfma_f32_16x16x32_bf16 v[192:195], v[96:99], v[88:91], v[192:195]
    v_mfma_f32_16x16x32_bf16 v[196:199], v[96:99], v[92:95], v[196:199]
    ds_read_b64_tr_b16 v[96:97], v54 offset:24576
    s_waitcnt lgkmcnt(13)
    v_mfma_f32_16x16x32_bf16 v[200:203], v[100:103], v[88:91], v[200:203]
    ds_read_b64_tr_b16 v[98:99], v54 offset:25600
    v_mfma_f32_16x16x32_bf16 v[204:207], v[100:103], v[92:95], v[204:207]
    ds_read_b64_tr_b16 v[100:101], v55 offset:24576
    s_waitcnt lgkmcnt(13)
    v_mfma_f32_16x16x32_bf16 v[208:211], v[104:107], v[88:91], v[208:211]
    ds_read_b64_tr_b16 v[102:103], v55 offset:25600
    v_mfma_f32_16x16x32_bf16 v[212:215], v[104:107], v[92:95], v[212:215]
    ds_read_b64_tr_b16 v[104:105], v56 offset:24576
    s_waitcnt lgkmcnt(13)
    v_mfma_f32_16x16x32_bf16 v[216:219], v[108:111], v[88:91], v[216:219]
    ds_read_b64_tr_b16 v[106:107], v56 offset:25600
    v_mfma_f32_16x16x32_bf16 v[220:223], v[108:111], v[92:95], v[220:223]
    ds_read_b64_tr_b16 v[108:109], v57 offset:24576
    s_waitcnt lgkmcnt(13)
    v_mfma_f32_16x16x32_bf16 v[224:227], v[112:115], v[88:91], v[224:227]
    ds_read_b64_tr_b16 v[110:111], v57 offset:25600
    v_mfma_f32_16x16x32_bf16 v[228:231], v[112:115], v[92:95], v[228:231]
    ds_read_b64_tr_b16 v[112:113], v58 offset:24576
    s_waitcnt lgkmcnt(13)
    v_mfma_f32_16x16x32_bf16 v[232:235], v[116:119], v[88:91], v[232:235]
    ds_read_b64_tr_b16 v[114:115], v58 offset:25600
    v_mfma_f32_16x16x32_bf16 v[236:239], v[116:119], v[92:95], v[236:239]
    ds_read_b64_tr_b16 v[116:117], v59 offset:24576
    s_waitcnt lgkmcnt(13)
    v_mfma_f32_16x16x32_bf16 v[240:243], v[120:123], v[88:91], v[240:243]
    ds_read_b64_tr_b16 v[118:119], v59 offset:25600
    v_mfma_f32_16x16x32_bf16 v[244:247], v[120:123], v[92:95], v[244:247]
    ds_read_b64_tr_b16 v[120:121], v60 offset:24576
    s_waitcnt lgkmcnt(13)
    v_mfma_f32_16x16x32_bf16 v[248:251], v[124:127], v[88:91], v[248:251]
    ds_read_b64_tr_b16 v[122:123], v60 offset:25600
    v_mfma_f32_16x16x32_bf16 v[252:255], v[124:127], v[92:95], v[252:255]
    ds_read_b64_tr_b16 v[124:125], v61 offset:24576
    ds_read_b64_tr_b16 v[126:127], v61 offset:25600
    buffer_load_dwordx4 v[88:91], v13, s[8:11], s87 offen offset:1024 sc1
    buffer_load_dwordx4 v[92:95], v12, s[8:11], s87 offen offset:1024 sc1
    s_waitcnt vmcnt(8)
    s_lshl_b32 s6, s4, 3
    s_add_u32 s6, s6, s5
    s_lshl_b32 s6, s6, 5
    s_add_u32 s6, s6, s3
    s_lshl_b32 s6, s6, 2
    s_add_u32 s6, s6, 3866624
    v_mov_b32 v2, 1
    v_mov_b32 v3, 0x5000000
    v_writelane_b32 v3, s6, 0
    buffer_store_dword v2, v3, s[8:11], 0 offen sc1
    s_waitcnt lgkmcnt(14)
    v_mfma_f32_16x16x32_bf16 v[192:195], v[96:99], v[16:19], v[192:195]
    v_mfma_f32_16x16x32_bf16 v[196:199], v[96:99], v[20:23], v[196:199]
    ds_read_b64_tr_b16 v[96:97], v54 offset:32768
    s_waitcnt lgkmcnt(13)
    v_mfma_f32_16x16x32_bf16 v[200:203], v[100:103], v[16:19], v[200:203]
    ds_read_b64_tr_b16 v[98:99], v54 offset:33792
    v_mfma_f32_16x16x32_bf16 v[204:207], v[100:103], v[20:23], v[204:207]
    ds_read_b64_tr_b16 v[100:101], v55 offset:32768
    s_waitcnt lgkmcnt(13)
    v_mfma_f32_16x16x32_bf16 v[208:211], v[104:107], v[16:19], v[208:211]
    ds_read_b64_tr_b16 v[102:103], v55 offset:33792
    v_mfma_f32_16x16x32_bf16 v[212:215], v[104:107], v[20:23], v[212:215]
    ds_read_b64_tr_b16 v[104:105], v56 offset:32768
    s_waitcnt lgkmcnt(13)
    v_mfma_f32_16x16x32_bf16 v[216:219], v[108:111], v[16:19], v[216:219]
    ds_read_b64_tr_b16 v[106:107], v56 offset:33792
    v_mfma_f32_16x16x32_bf16 v[220:223], v[108:111], v[20:23], v[220:223]
    ds_read_b64_tr_b16 v[108:109], v57 offset:32768
    s_waitcnt lgkmcnt(13)
    v_mfma_f32_16x16x32_bf16 v[224:227], v[112:115], v[16:19], v[224:227]
    ds_read_b64_tr_b16 v[110:111], v57 offset:33792
    v_mfma_f32_16x16x32_bf16 v[228:231], v[112:115], v[20:23], v[228:231]
    ds_read_b64_tr_b16 v[112:113], v58 offset:32768
    s_waitcnt lgkmcnt(13)
    v_mfma_f32_16x16x32_bf16 v[232:235], v[116:119], v[16:19], v[232:235]
    ds_read_b64_tr_b16 v[114:115], v58 offset:33792
    v_mfma_f32_16x16x32_bf16 v[236:239], v[116:119], v[20:23], v[236:239]
    ds_read_b64_tr_b16 v[116:117], v59 offset:32768
    s_waitcnt lgkmcnt(13)
    v_mfma_f32_16x16x32_bf16 v[240:243], v[120:123], v[16:19], v[240:243]
    ds_read_b64_tr_b16 v[118:119], v59 offset:33792
    v_mfma_f32_16x16x32_bf16 v[244:247], v[120:123], v[20:23], v[244:247]
    ds_read_b64_tr_b16 v[120:121], v60 offset:32768
    s_waitcnt lgkmcnt(13)
    v_mfma_f32_16x16x32_bf16 v[248:251], v[124:127], v[16:19], v[248:251]
    ds_read_b64_tr_b16 v[122:123], v60 offset:33792
    v_mfma_f32_16x16x32_bf16 v[252:255], v[124:127], v[20:23], v[252:255]
    ds_read_b64_tr_b16 v[124:125], v61 offset:32768
    ds_read_b64_tr_b16 v[126:127], v61 offset:33792
    buffer_load_dwordx4 v[16:19], v13, s[8:11], s87 offen offset:2048 sc1
    buffer_load_dwordx4 v[20:23], v12, s[8:11], s87 offen offset:2048 sc1
    s_waitcnt lgkmcnt(14)
    v_mfma_f32_16x16x32_bf16 v[192:195], v[96:99], v[24:27], v[192:195]
    v_mfma_f32_16x16x32_bf16 v[196:199], v[96:99], v[28:31], v[196:199]
    ds_read_b64_tr_b16 v[96:97], v54 offset:40960
    s_waitcnt lgkmcnt(13)
    v_mfma_f32_16x16x32_bf16 v[200:203], v[100:103], v[24:27], v[200:203]
    ds_read_b64_tr_b16 v[98:99], v54 offset:41984
    v_mfma_f32_16x16x32_bf16 v[204:207], v[100:103], v[28:31], v[204:207]
    ds_read_b64_tr_b16 v[100:101], v55 offset:40960
    s_waitcnt lgkmcnt(13)
    v_mfma_f32_16x16x32_bf16 v[208:211], v[104:107], v[24:27], v[208:211]
    ds_read_b64_tr_b16 v[102:103], v55 offset:41984
    v_mfma_f32_16x16x32_bf16 v[212:215], v[104:107], v[28:31], v[212:215]
    ds_read_b64_tr_b16 v[104:105], v56 offset:40960
    s_waitcnt lgkmcnt(13)
    v_mfma_f32_16x16x32_bf16 v[216:219], v[108:111], v[24:27], v[216:219]
    ds_read_b64_tr_b16 v[106:107], v56 offset:41984
    v_mfma_f32_16x16x32_bf16 v[220:223], v[108:111], v[28:31], v[220:223]
    ds_read_b64_tr_b16 v[108:109], v57 offset:40960
    s_waitcnt lgkmcnt(13)
    v_mfma_f32_16x16x32_bf16 v[224:227], v[112:115], v[24:27], v[224:227]
    ds_read_b64_tr_b16 v[110:111], v57 offset:41984
    v_mfma_f32_16x16x32_bf16 v[228:231], v[112:115], v[28:31], v[228:231]
    ds_read_b64_tr_b16 v[112:113], v58 offset:40960
    s_waitcnt lgkmcnt(13)
    v_mfma_f32_16x16x32_bf16 v[232:235], v[116:119], v[24:27], v[232:235]
    ds_read_b64_tr_b16 v[114:115], v58 offset:41984
    v_mfma_f32_16x16x32_bf16 v[236:239], v[116:119], v[28:31], v[236:239]
    ds_read_b64_tr_b16 v[116:117], v59 offset:40960
    s_waitcnt lgkmcnt(13)
    v_mfma_f32_16x16x32_bf16 v[240:243], v[120:123], v[24:27], v[240:243]
    ds_read_b64_tr_b16 v[118:119], v59 offset:41984
    v_mfma_f32_16x16x32_bf16 v[244:247], v[120:123], v[28:31], v[244:247]
    ds_read_b64_tr_b16 v[120:121], v60 offset:40960
    s_waitcnt lgkmcnt(13)
    v_mfma_f32_16x16x32_bf16 v[248:251], v[124:127], v[24:27], v[248:251]
    ds_read_b64_tr_b16 v[122:123], v60 offset:41984
    v_mfma_f32_16x16x32_bf16 v[252:255], v[124:127], v[28:31], v[252:255]
    ds_read_b64_tr_b16 v[124:125], v61 offset:40960
    ds_read_b64_tr_b16 v[126:127], v61 offset:41984
    buffer_load_dwordx4 v[24:27], v13, s[8:11], s87 offen offset:3072 sc1
    buffer_load_dwordx4 v[28:31], v12, s[8:11], s87 offen offset:3072 sc1
    s_waitcnt lgkmcnt(14)
    v_mfma_f32_16x16x32_bf16 v[192:195], v[96:99], v[32:35], v[192:195]
    v_mfma_f32_16x16x32_bf16 v[196:199], v[96:99], v[36:39], v[196:199]
    ds_read_b64_tr_b16 v[96:97], v54 offset:49152
    s_waitcnt lgkmcnt(13)
    v_mfma_f32_16x16x32_bf16 v[200:203], v[100:103], v[32:35], v[200:203]
    ds_read_b64_tr_b16 v[98:99], v54 offset:50176
    v_mfma_f32_16x16x32_bf16 v[204:207], v[100:103], v[36:39], v[204:207]
    ds_read_b64_tr_b16 v[100:101], v55 offset:49152
    s_waitcnt lgkmcnt(13)
    v_mfma_f32_16x16x32_bf16 v[208:211], v[104:107], v[32:35], v[208:211]
    ds_read_b64_tr_b16 v[102:103], v55 offset:50176
    v_mfma_f32_16x16x32_bf16 v[212:215], v[104:107], v[36:39], v[212:215]
    ds_read_b64_tr_b16 v[104:105], v56 offset:49152
    s_waitcnt lgkmcnt(13)
    v_mfma_f32_16x16x32_bf16 v[216:219], v[108:111], v[32:35], v[216:219]
    ds_read_b64_tr_b16 v[106:107], v56 offset:50176
    v_mfma_f32_16x16x32_bf16 v[220:223], v[108:111], v[36:39], v[220:223]
    ds_read_b64_tr_b16 v[108:109], v57 offset:49152
    s_waitcnt lgkmcnt(13)
    v_mfma_f32_16x16x32_bf16 v[224:227], v[112:115], v[32:35], v[224:227]
    ds_read_b64_tr_b16 v[110:111], v57 offset:50176
    v_mfma_f32_16x16x32_bf16 v[228:231], v[112:115], v[36:39], v[228:231]
    ds_read_b64_tr_b16 v[112:113], v58 offset:49152
    s_waitcnt lgkmcnt(13)
    v_mfma_f32_16x16x32_bf16 v[232:235], v[116:119], v[32:35], v[232:235]
    ds_read_b64_tr_b16 v[114:115], v58 offset:50176
    v_mfma_f32_16x16x32_bf16 v[236:239], v[116:119], v[36:39], v[236:239]
    ds_read_b64_tr_b16 v[116:117], v59 offset:49152
    s_waitcnt lgkmcnt(13)
    v_mfma_f32_16x16x32_bf16 v[240:243], v[120:123], v[32:35], v[240:243]
    ds_read_b64_tr_b16 v[118:119], v59 offset:50176
    v_mfma_f32_16x16x32_bf16 v[244:247], v[120:123], v[36:39], v[244:247]
    ds_read_b64_tr_b16 v[120:121], v60 offset:49152
    s_waitcnt lgkmcnt(13)
    v_mfma_f32_16x16x32_bf16 v[248:251], v[124:127], v[32:35], v[248:251]
    ds_read_b64_tr_b16 v[122:123], v60 offset:50176
    v_mfma_f32_16x16x32_bf16 v[252:255], v[124:127], v[36:39], v[252:255]
    ds_read_b64_tr_b16 v[124:125], v61 offset:49152
    ds_read_b64_tr_b16 v[126:127], v61 offset:50176
    buffer_load_dwordx4 v[32:35], v13, s[8:11], s88 offen offset:0 sc1
    buffer_load_dwordx4 v[36:39], v12, s[8:11], s88 offen offset:0 sc1
    s_waitcnt vmcnt(13)
    s_waitcnt lgkmcnt(14)
    v_mfma_f32_16x16x32_bf16 v[192:195], v[96:99], v[64:67], v[192:195]
    v_mfma_f32_16x16x32_bf16 v[196:199], v[96:99], v[68:71], v[196:199]
    ds_read_b64_tr_b16 v[96:97], v54 offset:57344
    s_waitcnt lgkmcnt(13)
    v_mfma_f32_16x16x32_bf16 v[200:203], v[100:103], v[64:67], v[200:203]
    ds_read_b64_tr_b16 v[98:99], v54 offset:58368
    v_mfma_f32_16x16x32_bf16 v[204:207], v[100:103], v[68:71], v[204:207]
    ds_read_b64_tr_b16 v[100:101], v55 offset:57344
    s_waitcnt lgkmcnt(13)
    v_mfma_f32_16x16x32_bf16 v[208:211], v[104:107], v[64:67], v[208:211]
    ds_read_b64_tr_b16 v[102:103], v55 offset:58368
    v_mfma_f32_16x16x32_bf16 v[212:215], v[104:107], v[68:71], v[212:215]
    ds_read_b64_tr_b16 v[104:105], v56 offset:57344
    s_waitcnt lgkmcnt(13)
    v_mfma_f32_16x16x32_bf16 v[216:219], v[108:111], v[64:67], v[216:219]
    ds_read_b64_tr_b16 v[106:107], v56 offset:58368
    v_mfma_f32_16x16x32_bf16 v[220:223], v[108:111], v[68:71], v[220:223]
    ds_read_b64_tr_b16 v[108:109], v57 offset:57344
    s_waitcnt lgkmcnt(13)
    v_mfma_f32_16x16x32_bf16 v[224:227], v[112:115], v[64:67], v[224:227]
    ds_read_b64_tr_b16 v[110:111], v57 offset:58368
    v_mfma_f32_16x16x32_bf16 v[228:231], v[112:115], v[68:71], v[228:231]
    ds_read_b64_tr_b16 v[112:113], v58 offset:57344
    s_waitcnt lgkmcnt(13)
    v_mfma_f32_16x16x32_bf16 v[232:235], v[116:119], v[64:67], v[232:235]
    ds_read_b64_tr_b16 v[114:115], v58 offset:58368
    v_mfma_f32_16x16x32_bf16 v[236:239], v[116:119], v[68:71], v[236:239]
    ds_read_b64_tr_b16 v[116:117], v59 offset:57344
    s_waitcnt lgkmcnt(13)
    v_mfma_f32_16x16x32_bf16 v[240:243], v[120:123], v[64:67], v[240:243]
    ds_read_b64_tr_b16 v[118:119], v59 offset:58368
    v_mfma_f32_16x16x32_bf16 v[244:247], v[120:123], v[68:71], v[244:247]
    ds_read_b64_tr_b16 v[120:121], v60 offset:57344
    s_waitcnt lgkmcnt(13)
    v_mfma_f32_16x16x32_bf16 v[248:251], v[124:127], v[64:67], v[248:251]
    ds_read_b64_tr_b16 v[122:123], v60 offset:58368
    v_mfma_f32_16x16x32_bf16 v[252:255], v[124:127], v[68:71], v[252:255]
    ds_read_b64_tr_b16 v[124:125], v61 offset:57344
    ds_read_b64_tr_b16 v[126:127], v61 offset:58368
    buffer_load_dwordx4 v[64:67], v13, s[8:11], s88 offen offset:1024 sc1
    buffer_load_dwordx4 v[68:71], v12, s[8:11], s88 offen offset:1024 sc1
    s_waitcnt vmcnt(13)
    s_waitcnt lgkmcnt(14)
    v_mfma_f32_16x16x32_bf16 v[192:195], v[96:99], v[72:75], v[192:195]
    v_xor_b32 v54, 0x10000, v54
    v_mfma_f32_16x16x32_bf16 v[196:199], v[96:99], v[76:79], v[196:199]
    s_waitcnt lgkmcnt(12)
    v_mfma_f32_16x16x32_bf16 v[200:203], v[100:103], v[72:75], v[200:203]
    v_xor_b32 v55, 0x10000, v55
    v_mfma_f32_16x16x32_bf16 v[204:207], v[100:103], v[76:79], v[204:207]
    s_waitcnt lgkmcnt(0)
    s_barrier
    ds_read_b64_tr_b16 v[96:97], v54 offset:0
    ds_read_b64_tr_b16 v[98:99], v54 offset:1024
    ds_read_b64_tr_b16 v[100:101], v55 offset:0
    v_mfma_f32_16x16x32_bf16 v[208:211], v[104:107], v[72:75], v[208:211]
    ds_read_b64_tr_b16 v[102:103], v55 offset:1024
    v_xor_b32 v56, 0x10000, v56
    v_mfma_f32_16x16x32_bf16 v[212:215], v[104:107], v[76:79], v[212:215]
    ds_read_b64_tr_b16 v[104:105], v56 offset:0
    v_mfma_f32_16x16x32_bf16 v[216:219], v[108:111], v[72:75], v[216:219]
    ds_read_b64_tr_b16 v[106:107], v56 offset:1024
    v_xor_b32 v57, 0x10000, v57
    v_mfma_f32_16x16x32_bf16 v[220:223], v[108:111], v[76:79], v[220:223]
    ds_read_b64_tr_b16 v[108:109], v57 offset:0
    v_mfma_f32_16x16x32_bf16 v[224:227], v[112:115], v[72:75], v[224:227]
    ds_read_b64_tr_b16 v[110:111], v57 offset:1024
    v_xor_b32 v58, 0x10000, v58
    v_mfma_f32_16x16x32_bf16 v[228:231], v[112:115], v[76:79], v[228:231]
    ds_read_b64_tr_b16 v[112:113], v58 offset:0
    v_mfma_f32_16x16x32_bf16 v[232:235], v[116:119], v[72:75], v[232:235]
    ds_read_b64_tr_b16 v[114:115], v58 offset:1024
    v_xor_b32 v59, 0x10000, v59
    v_mfma_f32_16x16x32_bf16 v[236:239], v[116:119], v[76:79], v[236:239]
    ds_read_b64_tr_b16 v[116:117], v59 offset:0
    v_mfma_f32_16x16x32_bf16 v[240:243], v[120:123], v[72:75], v[240:243]
    ds_read_b64_tr_b16 v[118:119], v59 offset:1024
    v_xor_b32 v60, 0x10000, v60
    v_mfma_f32_16x16x32_bf16 v[244:247], v[120:123], v[76:79], v[244:247]
    ds_read_b64_tr_b16 v[120:121], v60 offset:0
    v_mfma_f32_16x16x32_bf16 v[248:251], v[124:127], v[72:75], v[248:251]
    ds_read_b64_tr_b16 v[122:123], v60 offset:1024
    v_xor_b32 v61, 0x10000, v61
    v_mfma_f32_16x16x32_bf16 v[252:255], v[124:127], v[76:79], v[252:255]
    ds_read_b64_tr_b16 v[124:125], v61 offset:0
    ds_read_b64_tr_b16 v[126:127], v61 offset:1024
    buffer_load_dwordx4 v[72:75], v13, s[8:11], s88 offen offset:2048 sc1
    buffer_load_dwordx4 v[76:79], v12, s[8:11], s88 offen offset:2048 sc1
    s_waitcnt vmcnt(13)
    s_waitcnt lgkmcnt(14)
    v_mfma_f32_16x16x32_bf16 v[192:195], v[96:99], v[80:83], v[192:195]
    v_mfma_f32_16x16x32_bf16 v[196:199], v[96:99], v[84:87], v[196:199]
    ds_read_b64_tr_b16 v[96:97], v54 offset:8192
    s_waitcnt lgkmcnt(13)
    v_mfma_f32_16x16x32_bf16 v[200:203], v[100:103], v[80:83], v[200:203]
    ds_read_b64_tr_b16 v[98:99], v54 offset:9216
    v_mfma_f32_16x16x32_bf16 v[204:207], v[100:103], v[84:87], v[204:207]
    ds_read_b64_tr_b16 v[100:101], v55 offset:8192
    s_waitcnt lgkmcnt(13)
    v_mfma_f32_16x16x32_bf16 v[208:211], v[104:107], v[80:83], v[208:211]
    ds_read_b64_tr_b16 v[102:103], v55 offset:9216
    v_mfma_f32_16x16x32_bf16 v[212:215], v[104:107], v[84:87], v[212:215]
    ds_read_b64_tr_b16 v[104:105], v56 offset:8192
    s_waitcnt lgkmcnt(13)
    v_mfma_f32_16x16x32_bf16 v[216:219], v[108:111], v[80:83], v[216:219]
    ds_read_b64_tr_b16 v[106:107], v56 offset:9216
    v_mfma_f32_16x16x32_bf16 v[220:223], v[108:111], v[84:87], v[220:223]
    ds_read_b64_tr_b16 v[108:109], v57 offset:8192
    s_waitcnt lgkmcnt(13)
    v_mfma_f32_16x16x32_bf16 v[224:227], v[112:115], v[80:83], v[224:227]
    ds_read_b64_tr_b16 v[110:111], v57 offset:9216
    v_mfma_f32_16x16x32_bf16 v[228:231], v[112:115], v[84:87], v[228:231]
    ds_read_b64_tr_b16 v[112:113], v58 offset:8192
    s_waitcnt lgkmcnt(13)
    v_mfma_f32_16x16x32_bf16 v[232:235], v[116:119], v[80:83], v[232:235]
    ds_read_b64_tr_b16 v[114:115], v58 offset:9216
    v_mfma_f32_16x16x32_bf16 v[236:239], v[116:119], v[84:87], v[236:239]
    ds_read_b64_tr_b16 v[116:117], v59 offset:8192
    s_waitcnt lgkmcnt(13)
    v_mfma_f32_16x16x32_bf16 v[240:243], v[120:123], v[80:83], v[240:243]
    ds_read_b64_tr_b16 v[118:119], v59 offset:9216
    v_mfma_f32_16x16x32_bf16 v[244:247], v[120:123], v[84:87], v[244:247]
    ds_read_b64_tr_b16 v[120:121], v60 offset:8192
    s_waitcnt lgkmcnt(13)
    v_mfma_f32_16x16x32_bf16 v[248:251], v[124:127], v[80:83], v[248:251]
    ds_read_b64_tr_b16 v[122:123], v60 offset:9216
    v_mfma_f32_16x16x32_bf16 v[252:255], v[124:127], v[84:87], v[252:255]
    ds_read_b64_tr_b16 v[124:125], v61 offset:8192
    ds_read_b64_tr_b16 v[126:127], v61 offset:9216
    buffer_load_dwordx4 v[80:83], v13, s[8:11], s88 offen offset:3072 sc1
    buffer_load_dwordx4 v[84:87], v12, s[8:11], s88 offen offset:3072 sc1
    s_waitcnt vmcnt(13)
    s_waitcnt lgkmcnt(14)
    v_mfma_f32_16x16x32_bf16 v[192:195], v[96:99], v[88:91], v[192:195]
    v_mfma_f32_16x16x32_bf16 v[196:199], v[96:99], v[92:95], v[196:199]
    ds_read_b64_tr_b16 v[96:97], v54 offset:16384
    s_waitcnt lgkmcnt(13)
    v_mfma_f32_16x16x32_bf16 v[200:203], v[100:103], v[88:91], v[200:203]
    ds_read_b64_tr_b16 v[98:99], v54 offset:17408
    v_mfma_f32_16x16x32_bf16 v[204:207], v[100:103], v[92:95], v[204:207]
    ds_read_b64_tr_b16 v[100:101], v55 offset:16384
    s_waitcnt lgkmcnt(13)
    v_mfma_f32_16x16x32_bf16 v[208:211], v[104:107], v[88:91], v[208:211]
    ds_read_b64_tr_b16 v[102:103], v55 offset:17408
    v_mfma_f32_16x16x32_bf16 v[212:215], v[104:107], v[92:95], v[212:215]
    ds_read_b64_tr_b16 v[104:105], v56 offset:16384
    s_waitcnt lgkmcnt(13)
    v_mfma_f32_16x16x32_bf16 v[216:219], v[108:111], v[88:91], v[216:219]
    ds_read_b64_tr_b16 v[106:107], v56 offset:17408
    v_mfma_f32_16x16x32_bf16 v[220:223], v[108:111], v[92:95], v[220:223]
    ds_read_b64_tr_b16 v[108:109], v57 offset:16384
    s_waitcnt lgkmcnt(13)
    v_mfma_f32_16x16x32_bf16 v[224:227], v[112:115], v[88:91], v[224:227]
    ds_read_b64_tr_b16 v[110:111], v57 offset:17408
    v_mfma_f32_16x16x32_bf16 v[228:231], v[112:115], v[92:95], v[228:231]
    ds_read_b64_tr_b16 v[112:113], v58 offset:16384
    s_waitcnt lgkmcnt(13)
    v_mfma_f32_16x16x32_bf16 v[232:235], v[116:119], v[88:91], v[232:235]
    ds_read_b64_tr_b16 v[114:115], v58 offset:17408
    v_mfma_f32_16x16x32_bf16 v[236:239], v[116:119], v[92:95], v[236:239]
    ds_read_b64_tr_b16 v[116:117], v59 offset:16384
    s_waitcnt lgkmcnt(13)
    v_mfma_f32_16x16x32_bf16 v[240:243], v[120:123], v[88:91], v[240:243]
    ds_read_b64_tr_b16 v[118:119], v59 offset:17408
    v_mfma_f32_16x16x32_bf16 v[244:247], v[120:123], v[92:95], v[244:247]
    ds_read_b64_tr_b16 v[120:121], v60 offset:16384
    s_waitcnt lgkmcnt(13)
    v_mfma_f32_16x16x32_bf16 v[248:251], v[124:127], v[88:91], v[248:251]
    ds_read_b64_tr_b16 v[122:123], v60 offset:17408
    v_mfma_f32_16x16x32_bf16 v[252:255], v[124:127], v[92:95], v[252:255]
    ds_read_b64_tr_b16 v[124:125], v61 offset:16384
    ds_read_b64_tr_b16 v[126:127], v61 offset:17408
    s_waitcnt vmcnt(10)
    s_waitcnt lgkmcnt(14)
    v_mfma_f32_16x16x32_bf16 v[192:195], v[96:99], v[16:19], v[192:195]
    v_mfma_f32_16x16x32_bf16 v[196:199], v[96:99], v[20:23], v[196:199]
    ds_read_b64_tr_b16 v[96:97], v54 offset:24576
    s_waitcnt lgkmcnt(13)
    v_mfma_f32_16x16x32_bf16 v[200:203], v[100:103], v[16:19], v[200:203]
    ds_read_b64_tr_b16 v[98:99], v54 offset:25600
    v_mfma_f32_16x16x32_bf16 v[204:207], v[100:103], v[20:23], v[204:207]
    ds_read_b64_tr_b16 v[100:101], v55 offset:24576
    s_waitcnt lgkmcnt(13)
    v_mfma_f32_16x16x32_bf16 v[208:211], v[104:107], v[16:19], v[208:211]
    ds_read_b64_tr_b16 v[102:103], v55 offset:25600
    v_mfma_f32_16x16x32_bf16 v[212:215], v[104:107], v[20:23], v[212:215]
    ds_read_b64_tr_b16 v[104:105], v56 offset:24576
    s_waitcnt lgkmcnt(13)
    v_mfma_f32_16x16x32_bf16 v[216:219], v[108:111], v[16:19], v[216:219]
    ds_read_b64_tr_b16 v[106:107], v56 offset:25600
    v_mfma_f32_16x16x32_bf16 v[220:223], v[108:111], v[20:23], v[220:223]
    ds_read_b64_tr_b16 v[108:109], v57 offset:24576
    s_waitcnt lgkmcnt(13)
    v_mfma_f32_16x16x32_bf16 v[224:227], v[112:115], v[16:19], v[224:227]
    ds_read_b64_tr_b16 v[110:111], v57 offset:25600
    v_mfma_f32_16x16x32_bf16 v[228:231], v[112:115], v[20:23], v[228:231]
    ds_read_b64_tr_b16 v[112:113], v58 offset:24576
    s_waitcnt lgkmcnt(13)
    v_mfma_f32_16x16x32_bf16 v[232:235], v[116:119], v[16:19], v[232:235]
    ds_read_b64_tr_b16 v[114:115], v58 offset:25600
    v_mfma_f32_16x16x32_bf16 v[236:239], v[116:119], v[20:23], v[236:239]
    ds_read_b64_tr_b16 v[116:117], v59 offset:24576
    s_waitcnt lgkmcnt(13)
    v_mfma_f32_16x16x32_bf16 v[240:243], v[120:123], v[16:19], v[240:243]
    ds_read_b64_tr_b16 v[118:119], v59 offset:25600
    v_mfma_f32_16x16x32_bf16 v[244:247], v[120:123], v[20:23], v[244:247]
    ds_read_b64_tr_b16 v[120:121], v60 offset:24576
    s_waitcnt lgkmcnt(13)
    v_mfma_f32_16x16x32_bf16 v[248:251], v[124:127], v[16:19], v[248:251]
    ds_read_b64_tr_b16 v[122:123], v60 offset:25600
    v_mfma_f32_16x16x32_bf16 v[252:255], v[124:127], v[20:23], v[252:255]
    ds_read_b64_tr_b16 v[124:125], v61 offset:24576
    ds_read_b64_tr_b16 v[126:127], v61 offset:25600
    s_waitcnt vmcnt(8)
    s_waitcnt lgkmcnt(14)
    v_mfma_f32_16x16x32_bf16 v[192:195], v[96:99], v[24:27], v[192:195]
    v_mfma_f32_16x16x32_bf16 v[196:199], v[96:99], v[28:31], v[196:199]
    ds_read_b64_tr_b16 v[96:97], v54 offset:32768
    s_waitcnt lgkmcnt(13)
    v_mfma_f32_16x16x32_bf16 v[200:203], v[100:103], v[24:27], v[200:203]
    ds_read_b64_tr_b16 v[98:99], v54 offset:33792
    v_mfma_f32_16x16x32_bf16 v[204:207], v[100:103], v[28:31], v[204:207]
    ds_read_b64_tr_b16 v[100:101], v55 offset:32768
    s_waitcnt lgkmcnt(13)
    v_mfma_f32_16x16x32_bf16 v[208:211], v[104:107], v[24:27], v[208:211]
    ds_read_b64_tr_b16 v[102:103], v55 offset:33792
    v_mfma_f32_16x16x32_bf16 v[212:215], v[104:107], v[28:31], v[212:215]
    ds_read_b64_tr_b16 v[104:105], v56 offset:32768
    s_waitcnt lgkmcnt(13)
    v_mfma_f32_16x16x32_bf16 v[216:219], v[108:111], v[24:27], v[216:219]
    ds_read_b64_tr_b16 v[106:107], v56 offset:33792
    v_mfma_f32_16x16x32_bf16 v[220:223], v[108:111], v[28:31], v[220:223]
    ds_read_b64_tr_b16 v[108:109], v57 offset:32768
    s_waitcnt lgkmcnt(13)
    v_mfma_f32_16x16x32_bf16 v[224:227], v[112:115], v[24:27], v[224:227]
    ds_read_b64_tr_b16 v[110:111], v57 offset:33792
    v_mfma_f32_16x16x32_bf16 v[228:231], v[112:115], v[28:31], v[228:231]
    ds_read_b64_tr_b16 v[112:113], v58 offset:32768
    s_waitcnt lgkmcnt(13)
    v_mfma_f32_16x16x32_bf16 v[232:235], v[116:119], v[24:27], v[232:235]
    ds_read_b64_tr_b16 v[114:115], v58 offset:33792
    v_mfma_f32_16x16x32_bf16 v[236:239], v[116:119], v[28:31], v[236:239]
    ds_read_b64_tr_b16 v[116:117], v59 offset:32768
    s_waitcnt lgkmcnt(13)
    v_mfma_f32_16x16x32_bf16 v[240:243], v[120:123], v[24:27], v[240:243]
    ds_read_b64_tr_b16 v[118:119], v59 offset:33792
    v_mfma_f32_16x16x32_bf16 v[244:247], v[120:123], v[28:31], v[244:247]
    ds_read_b64_tr_b16 v[120:121], v60 offset:32768
    s_waitcnt lgkmcnt(13)
    v_mfma_f32_16x16x32_bf16 v[248:251], v[124:127], v[24:27], v[248:251]
    ds_read_b64_tr_b16 v[122:123], v60 offset:33792
    v_mfma_f32_16x16x32_bf16 v[252:255], v[124:127], v[28:31], v[252:255]
    ds_read_b64_tr_b16 v[124:125], v61 offset:32768
    ds_read_b64_tr_b16 v[126:127], v61 offset:33792
    s_waitcnt vmcnt(0)
    s_cmp_ge_u32 s3, 4
    s_cbranch_scc1 L_q_nold
    s_lshl_b32 s7, s4, 10
    s_add_u32 s7, s7, 3866624
    v_lshrrev_b32 v2, 3, v1
    v_and_b32 v3, 7, v1
    v_lshlrev_b32 v3, 2, v3
    v_lshl_add_u32 v3, v2, 7, v3
    s_mov_b32 s79, 262144
L_poll_7:
    buffer_load_dword v2, v3, s[8:11], s7 offen sc1
    s_waitcnt vmcnt(0)
    v_cmp_gt_u32 vcc, 1, v2
    s_cbranch_vccz L_polldone_8
    s_sleep 2
    s_sub_u32 s79, s79, 1
    s_cmp_lg_u32 s79, 0
    s_cbranch_scc1 L_poll_7
L_polldone_8:
    s_lshl_b32 s6, s76, 13
    s_add_u32 s6, s6, s78
    s_add_u32 m0, s6, 0
    s_add_u32 s7, s77, 0
    buffer_load_dwordx4 v49, s[8:11], s7 offen offset:0 sc1 lds
    buffer_load_dwordx4 v49, s[8:11], s7 offen offset:1024 sc1 lds
    buffer_load_dwordx4 v49, s[8:11], s7 offen offset:2048 sc1 lds
    buffer_load_dwordx4 v49, s[8:11], s7 offen offset:3072 sc1 lds
    s_lshl_b32 s6, s76, 13
    s_add_u32 s6, s6, s78
    s_add_u32 m0, s6, 4096
    s_add_u32 s7, s77, 4096
    buffer_load_dwordx4 v49, s[8:11], s7 offen offset:0 sc1 lds
    buffer_load_dwordx4 v49, s[8:11], s7 offen offset:1024 sc1 lds
    buffer_load_dwordx4 v49, s[8:11], s7 offen offset:2048 sc1 lds
    buffer_load_dwordx4 v49, s[8:11], s7 offen offset:3072 sc1 lds
    s_lshl_b32 s6, s76, 12
    s_add_u32 s6, s6, s78
    s_add_u32 m0, s6, 49152
    s_add_u32 s7, s77, 524288
    buffer_load_dwordx4 v50, s[8:11], s7 offen offset:0 sc1 lds
    buffer_load_dwordx4 v50, s[8:11], s7 offen offset:1024 sc1 lds
    buffer_load_dwordx4 v50, s[8:11], s7 offen offset:2048 sc1 lds
    buffer_load_dwordx4 v50, s[8:11], s7 offen offset:3072 sc1 lds
L_q_nold:
    s_waitcnt lgkmcnt(14)
    v_mfma_f32_16x16x32_bf16 v[192:195], v[96:99], v[32:35], v[192:195]
    v_mfma_f32_16x16x32_bf16 v[196:199], v[96:99], v[36:39], v[196:199]
    ds_read_b64_tr_b16 v[96:97], v54 offset:40960
    s_waitcnt lgkmcnt(13)
    v_mfma_f32_16x16x32_bf16 v[200:203], v[100:103], v[32:35], v[200:203]
    ds_read_b64_tr_b16 v[98:99], v54 offset:41984
    v_mfma_f32_16x16x32_bf16 v[204:207], v[100:103], v[36:39], v[204:207]
    ds_read_b64_tr_b16 v[100:101], v55 offset:40960
    s_waitcnt lgkmcnt(13)
    v_mfma_f32_16x16x32_bf16 v[208:211], v[104:107], v[32:35], v[208:211]
    ds_read_b64_tr_b16 v[102:103], v55 offset:41984
    v_mfma_f32_16x16x32_bf16 v[212:215], v[104:107], v[36:39], v[212:215]
    ds_read_b64_tr_b16 v[104:105], v56 offset:40960
    s_waitcnt lgkmcnt(13)
    v_mfma_f32_16x16x32_bf16 v[216:219], v[108:111], v[32:35], v[216:219]
    ds_read_b64_tr_b16 v[106:107], v56 offset:41984
    buffer_store_dwordx4 v[144:147], v13, s[8:11], s67 offen sc1
    s_add_u32 s67, s67, 1024
    v_mfma_f32_16x16x32_bf16 v[220:223], v[108:111], v[36:39], v[220:223]
    ds_read_b64_tr_b16 v[108:109], v57 offset:40960
    s_waitcnt lgkmcnt(13)
    v_mfma_f32_16x16x32_bf16 v[224:227], v[112:115], v[32:35], v[224:227]
    ds_read_b64_tr_b16 v[110:111], v57 offset:41984
    v_mfma_f32_16x16x32_bf16 v[228:231], v[112:115], v[36:39], v[228:231]
    ds_read_b64_tr_b16 v[112:113], v58 offset:40960
    s_waitcnt lgkmcnt(13)
    v_mfma_f32_16x16x32_bf16 v[232:235], v[116:119], v[32:35], v[232:235]
    ds_read_b64_tr_b16 v[114:115], v58 offset:41984
    v_mfma_f32_16x16x32_bf16 v[236:239], v[116:119], v[36:39], v[236:239]
    ds_read_b64_tr_b16 v[116:117], v59 offset:40960
    s_waitcnt lgkmcnt(13)
    v_mfma_f32_16x16x32_bf16 v[240:243], v[120:123], v[32:35], v[240:243]
    ds_read_b64_tr_b16 v[118:119], v59 offset:41984
    v_mfma_f32_16x16x32_bf16 v[244:247], v[120:123], v[36:39], v[244:247]
    ds_read_b64_tr_b16 v[120:121], v60 offset:40960
    s_waitcnt lgkmcnt(13)
    v_mfma_f32_16x16x32_bf16 v[248:251], v[124:127], v[32:35], v[248:251]
    ds_read_b64_tr_b16 v[122:123], v60 offset:41984
    v_mfma_f32_16x16x32_bf16 v[252:255], v[124:127], v[36:39], v[252:255]
    ds_read_b64_tr_b16 v[124:125], v61 offset:40960
    ds_read_b64_tr_b16 v[126:127], v61 offset:41984
    s_waitcnt lgkmcnt(14)
    v_mfma_f32_16x16x32_bf16 v[192:195], v[96:99], v[64:67], v[192:195]
    v_mfma_f32_16x16x32_bf16 v[196:199], v[96:99], v[68:71], v[196:199]
    ds_read_b64_tr_b16 v[96:97], v54 offset:49152
    s_waitcnt lgkmcnt(13)
    v_mfma_f32_16x16x32_bf16 v[200:203], v[100:103], v[64:67], v[200:203]
    ds_read_b64_tr_b16 v[98:99], v54 offset:50176
    v_mfma_f32_16x16x32_bf16 v[204:207], v[100:103], v[68:71], v[204:207]
    ds_read_b64_tr_b16 v[100:101], v55 offset:49152
    s_waitcnt lgkmcnt(13)
    v_mfma_f32_16x16x32_bf16 v[208:211], v[104:107], v[64:67], v[208:211]
    ds_read_b64_tr_b16 v[102:103], v55 offset:50176
    v_mfma_f32_16x16x32_bf16 v[212:215], v[104:107], v[68:71], v[212:215]
    ds_read_b64_tr_b16 v[104:105], v56 offset:49152
    s_waitcnt lgkmcnt(13)
    v_mfma_f32_16x16x32_bf16 v[216:219], v[108:111], v[64:67], v[216:219]
    ds_read_b64_tr_b16 v[106:107], v56 offset:50176
    buffer_store_dwordx4 v[148:151], v13, s[8:11], s67 offen sc1
    s_add_u32 s67, s67, s68
    v_mfma_f32_16x16x32_bf16 v[220:223], v[108:111], v[68:71], v[220:223]
    ds_read_b64_tr_b16 v[108:109], v57 offset:49152
    s_waitcnt lgkmcnt(13)
    v_mfma_f32_16x16x32_bf16 v[224:227], v[112:115], v[64:67], v[224:227]
    ds_read_b64_tr_b16 v[110:111], v57 offset:50176
    v_mfma_f32_16x16x32_bf16 v[228:231], v[112:115], v[68:71], v[228:231]
    ds_read_b64_tr_b16 v[112:113], v58 offset:49152
    s_waitcnt lgkmcnt(13)
    v_mfma_f32_16x16x32_bf16 v[232:235], v[116:119], v[64:67], v[232:235]
    ds_read_b64_tr_b16 v[114:115], v58 offset:50176
    v_mfma_f32_16x16x32_bf16 v[236:239], v[116:119], v[68:71], v[236:239]
    ds_read_b64_tr_b16 v[116:117], v59 offset:49152
    s_waitcnt lgkmcnt(13)
    v_mfma_f32_16x16x32_bf16 v[240:243], v[120:123], v[64:67], v[240:243]
    ds_read_b64_tr_b16 v[118:119], v59 offset:50176
    v_mfma_f32_16x16x32_bf16 v[244:247], v[120:123], v[68:71], v[244:247]
    ds_read_b64_tr_b16 v[120:121], v60 offset:49152
    s_waitcnt lgkmcnt(13)
    v_mfma_f32_16x16x32_bf16 v[248:251], v[124:127], v[64:67], v[248:251]
    ds_read_b64_tr_b16 v[122:123], v60 offset:50176
    v_mfma_f32_16x16x32_bf16 v[252:255], v[124:127], v[68:71], v[252:255]
    ds_read_b64_tr_b16 v[124:125], v61 offset:49152
    ds_read_b64_tr_b16 v[126:127], v61 offset:50176
    s_waitcnt lgkmcnt(14)
    v_mfma_f32_16x16x32_bf16 v[192:195], v[96:99], v[72:75], v[192:195]
    v_mfma_f32_16x16x32_bf16 v[196:199], v[96:99], v[76:79], v[196:199]
    ds_read_b64_tr_b16 v[96:97], v54 offset:57344
    s_waitcnt lgkmcnt(13)
    v_mfma_f32_16x16x32_bf16 v[200:203], v[100:103], v[72:75], v[200:203]
    ds_read_b64_tr_b16 v[98:99], v54 offset:58368
    v_mfma_f32_16x16x32_bf16 v[204:207], v[100:103], v[76:79], v[204:207]
    ds_read_b64_tr_b16 v[100:101], v55 offset:57344
    s_waitcnt lgkmcnt(13)
    v_mfma_f32_16x16x32_bf16 v[208:211], v[104:107], v[72:75], v[208:211]
    ds_read_b64_tr_b16 v[102:103], v55 offset:58368
    v_mfma_f32_16x16x32_bf16 v[212:215], v[104:107], v[76:79], v[212:215]
    ds_read_b64_tr_b16 v[104:105], v56 offset:57344
    s_waitcnt lgkmcnt(13)
    v_mfma_f32_16x16x32_bf16 v[216:219], v[108:111], v[72:75], v[216:219]
    ds_read_b64_tr_b16 v[106:107], v56 offset:58368
    buffer_store_dwordx4 v[152:155], v13, s[8:11], s67 offen sc1
    s_add_u32 s67, s67, 1024
    v_mfma_f32_16x16x32_bf16 v[220:223], v[108:111], v[76:79], v[220:223]
    ds_read_b64_tr_b16 v[108:109], v57 offset:57344
    s_waitcnt lgkmcnt(13)
    v_mfma_f32_16x16x32_bf16 v[224:227], v[112:115], v[72:75], v[224:227]
    ds_read_b64_tr_b16 v[110:111], v57 offset:58368
    v_mfma_f32_16x16x32_bf16 v[228:231], v[112:115], v[76:79], v[228:231]
    ds_read_b64_tr_b16 v[112:113], v58 offset:57344
    s_waitcnt lgkmcnt(13)
    v_mfma_f32_16x16x32_bf16 v[232:235], v[116:119], v[72:75], v[232:235]
    ds_read_b64_tr_b16 v[114:115], v58 offset:58368
    v_mfma_f32_16x16x32_bf16 v[236:239], v[116:119], v[76:79], v[236:239]
    ds_read_b64_tr_b16 v[116:117], v59 offset:57344
    s_waitcnt lgkmcnt(13)
    v_mfma_f32_16x16x32_bf16 v[240:243], v[120:123], v[72:75], v[240:243]
    ds_read_b64_tr_b16 v[118:119], v59 offset:58368
    v_mfma_f32_16x16x32_bf16 v[244:247], v[120:123], v[76:79], v[244:247]
    ds_read_b64_tr_b16 v[120:121], v60 offset:57344
    s_waitcnt lgkmcnt(13)
    v_mfma_f32_16x16x32_bf16 v[248:251], v[124:127], v[72:75], v[248:251]
    ds_read_b64_tr_b16 v[122:123], v60 offset:58368
    v_mfma_f32_16x16x32_bf16 v[252:255], v[124:127], v[76:79], v[252:255]
    ds_read_b64_tr_b16 v[124:125], v61 offset:57344
    ds_read_b64_tr_b16 v[126:127], v61 offset:58368
    s_waitcnt lgkmcnt(14)
    v_mfma_f32_16x16x32_bf16 v[192:195], v[96:99], v[80:83], v[192:195]
    v_mfma_f32_16x16x32_bf16 v[196:199], v[96:99], v[84:87], v[196:199]
    s_waitcnt lgkmcnt(12)
    v_mfma_f32_16x16x32_bf16 v[200:203], v[100:103], v[80:83], v[200:203]
    v_mfma_f32_16x16x32_bf16 v[204:207], v[100:103], v[84:87], v[204:207]
    s_waitcnt lgkmcnt(10)
    v_mfma_f32_16x16x32_bf16 v[208:211], v[104:107], v[80:83], v[208:211]
    v_mfma_f32_16x16x32_bf16 v[212:215], v[104:107], v[84:87], v[212:215]
    s_waitcnt lgkmcnt(8)
    v_mfma_f32_16x16x32_bf16 v[216:219], v[108:111], v[80:83], v[216:219]
    buffer_store_dwordx4 v[156:159], v13, s[8:11], s67 offen sc1
    s_add_u32 s67, s67, s69
    v_mfma_f32_16x16x32_bf16 v[220:223], v[108:111], v[84:87], v[220:223]
    s_waitcnt lgkmcnt(6)
    v_mfma_f32_16x16x32_bf16 v[224:227], v[112:115], v[80:83], v[224:227]
    v_mfma_f32_16x16x32_bf16 v[228:231], v[112:115], v[84:87], v[228:231]
    s_waitcnt lgkmcnt(4)
    v_mfma_f32_16x16x32_bf16 v[232:235], v[116:119], v[80:83], v[232:235]
    v_mfma_f32_16x16x32_bf16 v[236:239], v[116:119], v[84:87], v[236:239]
    s_waitcnt lgkmcnt(2)
    v_mfma_f32_16x16x32_bf16 v[240:243], v[120:123], v[80:83], v[240:243]
    v_mfma_f32_16x16x32_bf16 v[244:247], v[120:123], v[84:87], v[244:247]
    s_waitcnt lgkmcnt(0)
    v_mfma_f32_16x16x32_bf16 v[248:251], v[124:127], v[80:83], v[248:251]
    v_mfma_f32_16x16x32_bf16 v[252:255], v[124:127], v[84:87], v[252:255]
    s_cmp_lt_u32 s3, 4
    s_cbranch_scc1 L_qb
    s_barrier
L_qb:
    s_mov_b32 s6, 0x3e0293ee
    s_nop 7
    buffer_store_dwordx4 v[160:163], v13, s[8:11], s67 offen sc1
    s_add_u32 s67, s67, 1024
    buffer_store_dwordx4 v[164:167], v13, s[8:11], s67 offen sc1
    s_add_u32 s67, s67, s68
    buffer_store_dwordx4 v[168:171], v13, s[8:11], s67 offen sc1
    s_add_u32 s67, s67, 1024
    buffer_store_dwordx4 v[172:175], v13, s[8:11], s67 offen sc1
    s_add_u32 s67, s67, s69
    v_mul_f32 v192, s6, v192
    v_mul_f32 v193, s6, v193
    v_mul_f32 v194, s6, v194
    v_mul_f32 v195, s6, v195
    v_cvt_pk_bf16_f32 v16, v192, v193
    v_cvt_pk_bf16_f32 v17, v194, v195
    v_mul_f32 v200, s6, v200
    v_mul_f32 v201, s6, v201
    v_mul_f32 v202, s6, v202
    v_mul_f32 v203, s6, v203
    v_cvt_pk_bf16_f32 v18, v200, v201
    v_cvt_pk_bf16_f32 v19, v202, v203
    v_mul_f32 v208, s6, v208
    v_mul_f32 v209, s6, v209
    v_mul_f32 v210, s6, v210
    v_mul_f32 v211, s6, v211
    v_cvt_pk_bf16_f32 v20, v208, v209
    v_cvt_pk_bf16_f32 v21, v210, v211
    v_mul_f32 v216, s6, v216
    v_mul_f32 v217, s6, v217
    v_mul_f32 v218, s6, v218
    v_mul_f32 v219, s6, v219
    v_cvt_pk_bf16_f32 v22, v216, v217
    v_cvt_pk_bf16_f32 v23, v218, v219
    v_mul_f32 v224, s6, v224
    v_mul_f32 v225, s6, v225
    v_mul_f32 v226, s6, v226
    v_mul_f32 v227, s6, v227
    v_cvt_pk_bf16_f32 v24, v224, v225
    v_cvt_pk_bf16_f32 v25, v226, v227
    v_mul_f32 v232, s6, v232
    v_mul_f32 v233, s6, v233
    v_mul_f32 v234, s6, v234
    v_mul_f32 v235, s6, v235
    v_cvt_pk_bf16_f32 v26, v232, v233
    v_cvt_pk_bf16_f32 v27, v234, v235
    v_mul_f32 v240, s6, v240
    v_mul_f32 v241, s6, v241
    v_mul_f32 v242, s6, v242
    v_mul_f32 v243, s6, v243
    v_cvt_pk_bf16_f32 v28, v240, v241
    v_cvt_pk_bf16_f32 v29, v242, v243
    v_mul_f32 v248, s6, v248
    v_mul_f32 v249, s6, v249
    v_mul_f32 v250, s6, v250
    v_mul_f32 v251, s6, v251
    v_cvt_pk_bf16_f32 v30, v248, v249
    v_cvt_pk_bf16_f32 v31, v250, v251
    v_mul_f32 v196, s6, v196
    v_mul_f32 v197, s6, v197
    v_mul_f32 v198, s6, v198
    v_mul_f32 v199, s6, v199
    v_cvt_pk_bf16_f32 v32, v196, v197
    v_cvt_pk_bf16_f32 v33, v198, v199
    v_mul_f32 v204, s6, v204
    v_mul_f32 v205, s6, v205
    v_mul_f32 v206, s6, v206
    v_mul_f32 v207, s6, v207
    v_cvt_pk_bf16_f32 v34, v204, v205
    v_cvt_pk_bf16_f32 v35, v206, v207
    v_mul_f32 v212, s6, v212
    v_mul_f32 v213, s6, v213
    v_mul_f32 v214, s6, v214
    v_mul_f32 v215, s6, v215
    v_cvt_pk_bf16_f32 v36, v212, v213
    v_cvt_pk_bf16_f32 v37, v214, v215
    v_mul_f32 v220, s6, v220
    v_mul_f32 v221, s6, v221
    v_mul_f32 v222, s6, v222
    v_mul_f32 v223, s6, v223
    v_cvt_pk_bf16_f32 v38, v220, v221
    v_cvt_pk_bf16_f32 v39, v222, v223
    v_mul_f32 v228, s6, v228
    v_mul_f32 v229, s6, v229
    v_mul_f32 v230, s6, v230
    v_mul_f32 v231, s6, v231
    v_cvt_pk_bf16_f32 v40, v228, v229
    v_cvt_pk_bf16_f32 v41, v230, v231
    v_mul_f32 v236, s6, v236
    v_mul_f32 v237, s6, v237
    v_mul_f32 v238, s6, v238
    v_mul_f32 v239, s6, v239
    v_cvt_pk_bf16_f32 v42, v236, v237
    v_cvt_pk_bf16_f32 v43, v238, v239
    v_mul_f32 v244, s6, v244
    v_mul_f32 v245, s6, v245
    v_mul_f32 v246, s6, v246
    v_mul_f32 v247, s6, v247
    v_cvt_pk_bf16_f32 v44, v244, v245
    v_cvt_pk_bf16_f32 v45, v246, v247
    v_mul_f32 v252, s6, v252
    v_mul_f32 v253, s6, v253
    v_mul_f32 v254, s6, v254
    v_mul_f32 v255, s6, v255
    v_cvt_pk_bf16_f32 v46, v252, v253
    v_cvt_pk_bf16_f32 v47, v254, v255
    v_mov_b64 v[192:193], 0
    v_mov_b64 v[194:195], 0
    v_mov_b64 v[196:197], 0
    v_mov_b64 v[198:199], 0
    v_mov_b64 v[200:201], 0
    v_mov_b64 v[202:203], 0
    v_mov_b64 v[204:205], 0
    v_mov_b64 v[206:207], 0
    v_mov_b64 v[208:209], 0
    v_mov_b64 v[210:211], 0
    v_mov_b64 v[212:213], 0
    v_mov_b64 v[214:215], 0
    v_mov_b64 v[216:217], 0
    v_mov_b64 v[218:219], 0
    v_mov_b64 v[220:221], 0
    v_mov_b64 v[222:223], 0
    v_mov_b64 v[224:225], 0
    v_mov_b64 v[226:227], 0
    v_mov_b64 v[228:229], 0
    v_mov_b64 v[230:231], 0
    v_mov_b64 v[232:233], 0
    v_mov_b64 v[234:235], 0
    v_mov_b64 v[236:237], 0
    v_mov_b64 v[238:239], 0
    v_mov_b64 v[240:241], 0
    v_mov_b64 v[242:243], 0
    v_mov_b64 v[244:245], 0
    v_mov_b64 v[246:247], 0
    v_mov_b64 v[248:249], 0
    v_mov_b64 v[250:251], 0
    v_mov_b64 v[252:253], 0
    v_mov_b64 v[254:255], 0
    v_mov_b64 v[144:145], 0
    v_mov_b64 v[146:147], 0
    v_mov_b64 v[148:149], 0
    v_mov_b64 v[150:151], 0
    v_mov_b64 v[152:153], 0
    v_mov_b64 v[154:155], 0
    v_mov_b64 v[156:157], 0
    v_mov_b64 v[158:159], 0
    v_mov_b64 v[160:161], 0
    v_mov_b64 v[162:163], 0
    v_mov_b64 v[164:165], 0
    v_mov_b64 v[166:167], 0
    v_mov_b32 v168, 0x3f803f80
    v_mov_b32 v169, 0x3f803f80
    v_mov_b32 v170, 0x3f803f80
    v_mov_b32 v171, 0x3f803f80
    v_add_u32 v48, s100, v13
    s_waitcnt vmcnt(8)
    s_mov_b32 s72, 0x40004000
    s_mov_b32 s65, 0
    s_sub_u32 s63, 15, s5
    s_mov_b32 s62, -1
    s_cmp_ge_u32 s3, 4
    s_cbranch_scc1 L_qb2
    s_barrier
L_qb2:
    ds_read_b128 v[96:99], v48 offset:0
    ds_read_b128 v[100:103], v48 offset:1024
    ds_read_b128 v[104:107], v48 offset:2048
    ds_read_b128 v[108:111], v48 offset:3072
    ds_read_b128 v[112:115], v48 offset:4096
    ds_read_b128 v[116:119], v48 offset:5120
    ds_read_b128 v[120:123], v48 offset:6144
    ds_read_b128 v[124:127], v48 offset:7168
    s_cmp_lg_u32 s60, 0
    s_cbranch_scc1 L_nm0
    s_call_b64 s[82:83], L_mask
L_nm0:
    s_waitcnt lgkmcnt(7)
    v_mfma_f32_16x16x32_bf16 v[64:67], v[96:99], v[16:19], v[144:147]
    v_mfma_f32_16x16x32_bf16 v[68:71], v[96:99], v[32:35], v[148:151]
    ds_read_b128 v[96:99], v48 offset:8192
    s_waitcnt lgkmcnt(7)
    v_mfma_f32_16x16x32_bf16 v[64:67], v[100:103], v[20:23], v[64:67]
    v_mfma_f32_16x16x32_bf16 v[68:71], v[100:103], v[36:39], v[68:71]
    ds_read_b128 v[100:103], v48 offset:9216
    s_waitcnt lgkmcnt(7)
    v_mfma_f32_16x16x32_bf16 v[64:67], v[104:107], v[24:27], v[64:67]
    v_mfma_f32_16x16x32_bf16 v[68:71], v[104:107], v[40:43], v[68:71]
    ds_read_b128 v[104:107], v48 offset:10240
    s_waitcnt lgkmcnt(7)
    v_mfma_f32_16x16x32_bf16 v[64:67], v[108:111], v[28:31], v[64:67]
    v_mfma_f32_16x16x32_bf16 v[68:71], v[108:111], v[44:47], v[68:71]
    ds_read_b128 v[108:111], v48 offset:11264
    s_waitcnt lgkmcnt(7)
    v_mfma_f32_16x16x32_bf16 v[72:75], v[112:115], v[16:19], v[152:155]
    v_mfma_f32_16x16x32_bf16 v[76:79], v[112:115], v[32:35], v[156:159]
    ds_read_b128 v[112:115], v48 offset:12288
    s_waitcnt lgkmcnt(7)
    v_mfma_f32_16x16x32_bf16 v[72:75], v[116:119], v[20:23], v[72:75]
    v_mfma_f32_16x16x32_bf16 v[76:79], v[116:119], v[36:39], v[76:79]
    ds_read_b128 v[116:119], v48 offset:13312
    s_waitcnt lgkmcnt(7)
    v_mfma_f32_16x16x32_bf16 v[72:75], v[120:123], v[24:27], v[72:75]
    v_mfma_f32_16x16x32_bf16 v[76:79], v[120:123], v[40:43], v[76:79]
    ds_read_b128 v[120:123], v48 offset:14336
    s_waitcnt lgkmcnt(7)
    v_mfma_f32_16x16x32_bf16 v[72:75], v[124:127], v[28:31], v[72:75]
    v_mfma_f32_16x16x32_bf16 v[76:79], v[124:127], v[44:47], v[76:79]
    ds_read_b128 v[124:127], v48 offset:15360
    s_nop 7
    v_max3_f32 v58, v64, v65, v66
    v_max3_f32 v58, v58, v67, v72
    v_max3_f32 v58, v58, v73, v74
    v_max_f32 v58, v58, v75
    v_mov_b32 v60, v58
    s_nop 1
    v_permlane16_swap_b32 v58, v60
    s_nop 1
    v_max_f32 v58, v58, v60
    v_mov_b32 v60, v58
    s_nop 1
    v_permlane32_swap_b32 v58, v60
    s_nop 1
    v_max_f32 v58, v58, v60
    v_add_f32 v58, 0x41c00000, v58
    v_sub_f32 v64, v64, v58
    v_sub_f32 v144, 0, v58
    v_sub_f32 v65, v65, v58
    v_sub_f32 v145, 0, v58
    v_sub_f32 v66, v66, v58
    v_sub_f32 v146, 0, v58
    v_sub_f32 v67, v67, v58
    v_sub_f32 v147, 0, v58
    v_sub_f32 v72, v72, v58
    v_sub_f32 v152, 0, v58
    v_sub_f32 v73, v73, v58
    v_sub_f32 v153, 0, v58
    v_sub_f32 v74, v74, v58
    v_sub_f32 v154, 0, v58
    v_sub_f32 v75, v75, v58
    v_sub_f32 v155, 0, v58
    v_max3_f32 v59, v68, v69, v70
    v_max3_f32 v59, v59, v71, v76
    v_max3_f32 v59, v59, v77, v78
    v_max_f32 v59, v59, v79
    v_mov_b32 v60, v59
    s_nop 1
    v_permlane16_swap_b32 v59, v60
    s_nop 1
    v_max_f32 v59, v59, v60
    v_mov_b32 v60, v59
    s_nop 1
    v_permlane32_swap_b32 v59, v60
    s_nop 1
    v_max_f32 v59, v59, v60
    v_add_f32 v59, 0x41c00000, v59
    v_sub_f32 v68, v68, v59
    v_sub_f32 v148, 0, v59
    v_sub_f32 v69, v69, v59
    v_sub_f32 v149, 0, v59
    v_sub_f32 v70, v70, v59
    v_sub_f32 v150, 0, v59
    v_sub_f32 v71, v71, v59
    v_sub_f32 v151, 0, v59
    v_sub_f32 v76, v76, v59
    v_sub_f32 v156, 0, v59
    v_sub_f32 v77, v77, v59
    v_sub_f32 v157, 0, v59
    v_sub_f32 v78, v78, v59
    v_sub_f32 v158, 0, v59
    v_sub_f32 v79, v79, v59
    v_sub_f32 v159, 0, v59
    s_cmp_lg_u32 s60, 1
    s_cbranch_scc1 L_nm1
    s_call_b64 s[82:83], L_mask
L_nm1:
    v_exp_f32 v58, v64
    v_exp_f32 v59, v65
    s_waitcnt lgkmcnt(7)
    v_mfma_f32_16x16x32_bf16 v[80:83], v[96:99], v[16:19], v[144:147]
    s_waitcnt lgkmcnt(6)
    v_exp_f32 v60, v66
    v_exp_f32 v61, v67
    v_mfma_f32_16x16x32_bf16 v[84:87], v[96:99], v[32:35], v[148:151]
    ds_read_b128 v[96:99], v48 offset:49152
    v_cvt_pk_bf16_f32 v128, v58, v59
    v_cvt_pk_bf16_f32 v129, v60, v61
    v_mfma_f32_16x16x32_bf16 v[80:83], v[100:103], v[20:23], v[80:83]
    s_waitcnt lgkmcnt(6)
    v_exp_f32 v58, v68
    v_exp_f32 v59, v69
    v_mfma_f32_16x16x32_bf16 v[84:87], v[100:103], v[36:39], v[84:87]
    ds_read_b128 v[100:103], v48 offset:50176
    v_cvt_pk_bf16_f32 v132, v58, v59
    v_mfma_f32_16x16x32_bf16 v[80:83], v[104:107], v[24:27], v[80:83]
    s_waitcnt lgkmcnt(6)
    v_exp_f32 v60, v70
    v_exp_f32 v61, v71
    v_mfma_f32_16x16x32_bf16 v[84:87], v[104:107], v[40:43], v[84:87]
    ds_read_b128 v[104:107], v48 offset:51200
    v_cvt_pk_bf16_f32 v133, v60, v61
    v_mfma_f32_16x16x32_bf16 v[80:83], v[108:111], v[28:31], v[80:83]
    s_waitcnt lgkmcnt(6)
    v_exp_f32 v58, v72
    v_exp_f32 v59, v73
    v_mfma_f32_16x16x32_bf16 v[84:87], v[108:111], v[44:47], v[84:87]
    ds_read_b128 v[108:111], v48 offset:52224
    v_cvt_pk_bf16_f32 v130, v58, v59
    v_mfma_f32_16x16x32_bf16 v[88:91], v[112:115], v[16:19], v[152:155]
    s_waitcnt lgkmcnt(6)
    v_exp_f32 v60, v74
    v_exp_f32 v61, v75
    v_mfma_f32_16x16x32_bf16 v[92:95], v[112:115], v[32:35], v[156:159]
    ds_read_b128 v[112:115], v48 offset:53248
    v_cvt_pk_bf16_f32 v131, v60, v61
    v_mfma_f32_16x16x32_bf16 v[88:91], v[116:119], v[20:23], v[88:91]
    s_waitcnt lgkmcnt(6)
    v_exp_f32 v58, v76
    v_exp_f32 v59, v77
    v_mfma_f32_16x16x32_bf16 v[92:95], v[116:119], v[36:39], v[92:95]
    ds_read_b128 v[116:119], v48 offset:54272
    v_cvt_pk_bf16_f32 v134, v58, v59
    v_mfma_f32_16x16x32_bf16 v[88:91], v[120:123], v[24:27], v[88:91]
    s_waitcnt lgkmcnt(6)
    v_exp_f32 v60, v78
    v_exp_f32 v61, v79
    v_mfma_f32_16x16x32_bf16 v[92:95], v[120:123], v[40:43], v[92:95]
    ds_read_b128 v[120:123], v48 offset:55296
    v_cvt_pk_bf16_f32 v135, v60, v61
    v_mfma_f32_16x16x32_bf16 v[88:91], v[124:127], v[28:31], v[88:91]
    s_waitcnt lgkmcnt(6)
    v_or3_b32 v62, v128, v129, v132
    v_or3_b32 v62, v62, v133, v130
    v_or3_b32 v62, v62, v131, v134
    v_bitop3_b32 v62, v62, v135, s72 bitop3:0xa8
    v_cmp_ne_u32 vcc, s65, v62
    v_mfma_f32_16x16x32_bf16 v[92:95], v[124:127], v[44:47], v[92:95]
    ds_read_b128 v[124:127], v48 offset:56320
    s_cbranch_vccnz L_back_9_h
L_back_9:
    s_nop 7
    v_exp_f32 v58, v80
    v_exp_f32 v59, v81
    s_call_b64 s[82:83], L_load
    s_mov_b32 s62, 0
    buffer_store_dwordx4 v[176:179], v13, s[8:11], s67 offen sc1
    s_add_u32 s67, s67, 1024
    buffer_store_dwordx4 v[180:183], v13, s[8:11], s67 offen sc1
    s_add_u32 s67, s67, s68
    buffer_store_dwordx4 v[184:187], v13, s[8:11], s67 offen sc1
    s_add_u32 s67, s67, 1024
    buffer_store_dwordx4 v[188:191], v13, s[8:11], s67 offen sc1
    s_add_u32 s67, s67, s69
    s_sub_i32 s64, s60, 2
    s_cmp_eq_u32 s60, 0
    s_cbranch_scc1 L_pv2
    s_cmp_eq_u32 s60, 1
    s_cbranch_scc1 L_tail2
    s_cmp_lg_u32 s60, 2
    s_cbranch_scc1 L_st2
    s_call_b64 s[82:83], L_mask
    s_branch L_st2
.p2align 6
L_st0:
    v_mfma_f32_16x16x32_bf16 v[192:195], v[96:99], v[128:131], v[192:195]
    s_waitcnt lgkmcnt(6)
    v_exp_f32 v60, v82
    v_mfma_f32_16x16x32_bf16 v[196:199], v[96:99], v[132:135], v[196:199]
    ds_read_b128 v[96:99], v48 offset:0
    v_cvt_pk_bf16_f32 v136, v58, v59
    v_mfma_f32_16x16x32_bf16 v[200:203], v[100:103], v[128:131], v[200:203]
    s_waitcnt lgkmcnt(6)
    v_exp_f32 v61, v83
    v_mfma_f32_16x16x32_bf16 v[204:207], v[100:103], v[132:135], v[204:207]
    s_sub_i32 s64, s64, 1
    ds_read_b128 v[100:103], v48 offset:1024
    v_cvt_pk_bf16_f32 v137, v60, v61
    v_mfma_f32_16x16x32_bf16 v[208:211], v[104:107], v[128:131], v[208:211]
    s_waitcnt lgkmcnt(6)
    v_exp_f32 v58, v84
    v_mfma_f32_16x16x32_bf16 v[212:215], v[104:107], v[132:135], v[212:215]
    ds_read_b128 v[104:107], v48 offset:2048
    v_mfma_f32_16x16x32_bf16 v[216:219], v[108:111], v[128:131], v[216:219]
    s_waitcnt lgkmcnt(6)
    v_exp_f32 v59, v85
    v_mfma_f32_16x16x32_bf16 v[220:223], v[108:111], v[132:135], v[220:223]
    s_cmp_gt_i32 s64, 0
    ds_read_b128 v[108:111], v48 offset:3072
    v_cvt_pk_bf16_f32 v140, v58, v59
    v_mfma_f32_16x16x32_bf16 v[224:227], v[112:115], v[128:131], v[224:227]
    s_waitcnt lgkmcnt(6)
    v_exp_f32 v60, v86
    v_mfma_f32_16x16x32_bf16 v[228:231], v[112:115], v[132:135], v[228:231]
    ds_read_b128 v[112:115], v48 offset:4096
    v_or3_b32 v62, v136, v137, v140
    v_mfma_f32_16x16x32_bf16 v[232:235], v[116:119], v[128:131], v[232:235]
    s_waitcnt lgkmcnt(6)
    v_exp_f32 v61, v87
    v_mfma_f32_16x16x32_bf16 v[236:239], v[116:119], v[132:135], v[236:239]
    s_cselect_b32 s65, 0, 1
    ds_read_b128 v[116:119], v48 offset:5120
    v_cvt_pk_bf16_f32 v141, v60, v61
    v_mfma_f32_16x16x32_bf16 v[240:243], v[120:123], v[128:131], v[240:243]
    s_waitcnt lgkmcnt(6)
    v_exp_f32 v58, v88
    v_mfma_f32_16x16x32_bf16 v[244:247], v[120:123], v[132:135], v[244:247]
    ds_read_b128 v[120:123], v48 offset:6144
    v_mfma_f32_16x16x32_bf16 v[248:251], v[124:127], v[128:131], v[248:251]
    s_waitcnt lgkmcnt(6)
    v_exp_f32 v59, v89
    v_mfma_f32_16x16x32_bf16 v[252:255], v[124:127], v[132:135], v[252:255]
    ds_read_b128 v[124:127], v48 offset:7168
    v_cvt_pk_bf16_f32 v138, v58, v59
    v_mfma_f32_16x16x32_bf16 v[64:67], v[96:99], v[16:19], v[144:147]
    s_waitcnt lgkmcnt(6)
    v_exp_f32 v60, v90
    v_mfma_f32_16x16x32_bf16 v[68:71], v[96:99], v[32:35], v[148:151]
    ds_read_b128 v[96:99], v48 offset:40960
    v_or3_b32 v62, v62, v141, v138
    v_mfma_f32_16x16x32_bf16 v[64:67], v[100:103], v[20:23], v[64:67]
    v_exp_f32 v61, v91
    v_mfma_f32_16x16x32_bf16 v[68:71], v[100:103], v[36:39], v[68:71]
    ds_read_b128 v[100:103], v48 offset:41984
    v_cvt_pk_bf16_f32 v139, v60, v61
    v_mfma_f32_16x16x32_bf16 v[160:163], v[168:171], v[128:131], v[160:163]
    s_waitcnt lgkmcnt(7)
    v_exp_f32 v58, v92
    v_mfma_f32_16x16x32_bf16 v[164:167], v[168:171], v[132:135], v[164:167]
    v_mfma_f32_16x16x32_bf16 v[64:67], v[104:107], v[24:27], v[64:67]
    s_waitcnt lgkmcnt(6)
    v_exp_f32 v59, v93
    v_mfma_f32_16x16x32_bf16 v[68:71], v[104:107], v[40:43], v[68:71]
    ds_read_b128 v[104:107], v48 offset:43008
    v_cvt_pk_bf16_f32 v142, v58, v59
    v_mfma_f32_16x16x32_bf16 v[64:67], v[108:111], v[28:31], v[64:67]
    s_waitcnt lgkmcnt(6)
    v_exp_f32 v60, v94
    v_mfma_f32_16x16x32_bf16 v[68:71], v[108:111], v[44:47], v[68:71]
    ds_read_b128 v[108:111], v48 offset:44032
    v_or3_b32 v62, v62, v139, v142
    v_mfma_f32_16x16x32_bf16 v[72:75], v[112:115], v[16:19], v[152:155]
    s_waitcnt lgkmcnt(6)
    v_exp_f32 v61, v95
    v_mfma_f32_16x16x32_bf16 v[76:79], v[112:115], v[32:35], v[156:159]
    ds_read_b128 v[112:115], v48 offset:45056
    v_cvt_pk_bf16_f32 v143, v60, v61
    v_mfma_f32_16x16x32_bf16 v[72:75], v[116:119], v[20:23], v[72:75]
    s_waitcnt lgkmcnt(6)
    v_bitop3_b32 v62, v62, v143, s72 bitop3:0xa8
    v_cmp_ne_u32 vcc, s65, v62
    v_mfma_f32_16x16x32_bf16 v[76:79], v[116:119], v[36:39], v[76:79]
    ds_read_b128 v[116:119], v48 offset:46080
    v_mfma_f32_16x16x32_bf16 v[72:75], v[120:123], v[24:27], v[72:75]
    s_waitcnt lgkmcnt(6)
    v_exp_f32 v58, v64
    v_mfma_f32_16x16x32_bf16 v[76:79], v[120:123], v[40:43], v[76:79]
    ds_read_b128 v[120:123], v48 offset:47104
    v_mfma_f32_16x16x32_bf16 v[72:75], v[124:127], v[28:31], v[72:75]
    s_waitcnt lgkmcnt(6)
    v_exp_f32 v59, v65
    v_mfma_f32_16x16x32_bf16 v[76:79], v[124:127], v[44:47], v[76:79]
    ds_read_b128 v[124:127], v48 offset:48128
    s_cbranch_vccnz L_back_10_h
L_back_10:
    v_mfma_f32_16x16x32_bf16 v[192:195], v[96:99], v[136:139], v[192:195]
    s_waitcnt lgkmcnt(6)
    v_exp_f32 v60, v66
    v_mfma_f32_16x16x32_bf16 v[196:199], v[96:99], v[140:143], v[196:199]
    ds_read_b128 v[96:99], v48 offset:8192
    v_cvt_pk_bf16_f32 v128, v58, v59
    v_mfma_f32_16x16x32_bf16 v[200:203], v[100:103], v[136:139], v[200:203]
    s_waitcnt lgkmcnt(6)
    v_exp_f32 v61, v67
    v_mfma_f32_16x16x32_bf16 v[204:207], v[100:103], v[140:143], v[204:207]
    s_sub_i32 s64, s64, 1
    ds_read_b128 v[100:103], v48 offset:9216
    v_cvt_pk_bf16_f32 v129, v60, v61
    v_mfma_f32_16x16x32_bf16 v[208:211], v[104:107], v[136:139], v[208:211]
    s_waitcnt lgkmcnt(6)
    v_exp_f32 v58, v68
    v_mfma_f32_16x16x32_bf16 v[212:215], v[104:107], v[140:143], v[212:215]
    ds_read_b128 v[104:107], v48 offset:10240
    v_mfma_f32_16x16x32_bf16 v[216:219], v[108:111], v[136:139], v[216:219]
    s_waitcnt lgkmcnt(6)
    v_exp_f32 v59, v69
    v_mfma_f32_16x16x32_bf16 v[220:223], v[108:111], v[140:143], v[220:223]
    s_cmp_gt_i32 s64, 0
    ds_read_b128 v[108:111], v48 offset:11264
    v_cvt_pk_bf16_f32 v132, v58, v59
    v_mfma_f32_16x16x32_bf16 v[224:227], v[112:115], v[136:139], v[224:227]
    s_waitcnt lgkmcnt(6)
    v_exp_f32 v60, v70
    v_mfma_f32_16x16x32_bf16 v[228:231], v[112:115], v[140:143], v[228:231]
    ds_read_b128 v[112:115], v48 offset:12288
    v_or3_b32 v62, v128, v129, v132
    v_mfma_f32_16x16x32_bf16 v[232:235], v[116:119], v[136:139], v[232:235]
    s_waitcnt lgkmcnt(6)
    v_exp_f32 v61, v71
    v_mfma_f32_16x16x32_bf16 v[236:239], v[116:119], v[140:143], v[236:239]
    s_cselect_b32 s65, 0, 1
    ds_read_b128 v[116:119], v48 offset:13312
    v_cvt_pk_bf16_f32 v133, v60, v61
    v_mfma_f32_16x16x32_bf16 v[240:243], v[120:123], v[136:139], v[240:243]
    s_waitcnt lgkmcnt(6)
    v_exp_f32 v58, v72
    v_mfma_f32_16x16x32_bf16 v[244:247], v[120:123], v[140:143], v[244:247]
    ds_read_b128 v[120:123], v48 offset:14336
    v_mfma_f32_16x16x32_bf16 v[248:251], v[124:127], v[136:139], v[248:251]
    s_waitcnt lgkmcnt(6)
    v_exp_f32 v59, v73
    v_mfma_f32_16x16x32_bf16 v[252:255], v[124:127], v[140:143], v[252:255]
    ds_read_b128 v[124:127], v48 offset:15360
    v_cvt_pk_bf16_f32 v130, v58, v59
    v_mfma_f32_16x16x32_bf16 v[80:83], v[96:99], v[16:19], v[144:147]
    s_waitcnt lgkmcnt(6)
    v_exp_f32 v60, v74
    v_mfma_f32_16x16x32_bf16 v[84:87], v[96:99], v[32:35], v[148:151]
    ds_read_b128 v[96:99], v48 offset:49152
    v_or3_b32 v62, v62, v133, v130
    v_mfma_f32_16x16x32_bf16 v[80:83], v[100:103], v[20:23], v[80:83]
    v_exp_f32 v61, v75
    v_mfma_f32_16x16x32_bf16 v[84:87], v[100:103], v[36:39], v[84:87]
    ds_read_b128 v[100:103], v48 offset:50176
    v_cvt_pk_bf16_f32 v131, v60, v61
    v_mfma_f32_16x16x32_bf16 v[160:163], v[168:171], v[136:139], v[160:163]
    s_waitcnt lgkmcnt(7)
    v_exp_f32 v58, v76
    v_mfma_f32_16x16x32_bf16 v[164:167], v[168:171], v[140:143], v[164:167]
    v_mfma_f32_16x16x32_bf16 v[80:83], v[104:107], v[24:27], v[80:83]
    s_waitcnt lgkmcnt(6)
    v_exp_f32 v59, v77
    v_mfma_f32_16x16x32_bf16 v[84:87], v[104:107], v[40:43], v[84:87]
    ds_read_b128 v[104:107], v48 offset:51200
    v_cvt_pk_bf16_f32 v134, v58, v59
    v_mfma_f32_16x16x32_bf16 v[80:83], v[108:111], v[28:31], v[80:83]
    s_waitcnt lgkmcnt(6)
    v_exp_f32 v60, v78
    v_mfma_f32_16x16x32_bf16 v[84:87], v[108:111], v[44:47], v[84:87]
    ds_read_b128 v[108:111], v48 offset:52224
    v_or3_b32 v62, v62, v131, v134
    v_mfma_f32_16x16x32_bf16 v[88:91], v[112:115], v[16:19], v[152:155]
    s_waitcnt lgkmcnt(6)
    v_exp_f32 v61, v79
    v_mfma_f32_16x16x32_bf16 v[92:95], v[112:115], v[32:35], v[156:159]
    ds_read_b128 v[112:115], v48 offset:53248
    v_cvt_pk_bf16_f32 v135, v60, v61
    v_mfma_f32_16x16x32_bf16 v[88:91], v[116:119], v[20:23], v[88:91]
    s_waitcnt lgkmcnt(6)
    v_bitop3_b32 v62, v62, v135, s72 bitop3:0xa8
    v_cmp_ne_u32 vcc, s65, v62
    v_mfma_f32_16x16x32_bf16 v[92:95], v[116:119], v[36:39], v[92:95]
    ds_read_b128 v[116:119], v48 offset:54272
    v_mfma_f32_16x16x32_bf16 v[88:91], v[120:123], v[24:27], v[88:91]
    s_waitcnt lgkmcnt(6)
    v_exp_f32 v58, v80
    v_mfma_f32_16x16x32_bf16 v[92:95], v[120:123], v[40:43], v[92:95]
    ds_read_b128 v[120:123], v48 offset:55296
    v_mfma_f32_16x16x32_bf16 v[88:91], v[124:127], v[28:31], v[88:91]
    s_waitcnt lgkmcnt(6)
    v_exp_f32 v59, v81
    v_mfma_f32_16x16x32_bf16 v[92:95], v[124:127], v[44:47], v[92:95]
    ds_read_b128 v[124:127], v48 offset:56320
    s_cbranch_vccnz L_back_11_h
L_back_11:
L_st2:
    v_mfma_f32_16x16x32_bf16 v[192:195], v[96:99], v[128:131], v[192:195]
    s_waitcnt lgkmcnt(6)
    v_exp_f32 v60, v82
    v_mfma_f32_16x16x32_bf16 v[196:199], v[96:99], v[132:135], v[196:199]
    ds_read_b128 v[96:99], v48 offset:16384
    v_cvt_pk_bf16_f32 v136, v58, v59
    v_mfma_f32_16x16x32_bf16 v[200:203], v[100:103], v[128:131], v[200:203]
    s_waitcnt lgkmcnt(6)
    v_exp_f32 v61, v83
    v_mfma_f32_16x16x32_bf16 v[204:207], v[100:103], v[132:135], v[204:207]
    s_sub_i32 s64, s64, 1
    ds_read_b128 v[100:103], v48 offset:17408
    v_cvt_pk_bf16_f32 v137, v60, v61
    v_mfma_f32_16x16x32_bf16 v[208:211], v[104:107], v[128:131], v[208:211]
    s_waitcnt lgkmcnt(6)
    v_exp_f32 v58, v84
    v_mfma_f32_16x16x32_bf16 v[212:215], v[104:107], v[132:135], v[212:215]
    ds_read_b128 v[104:107], v48 offset:18432
    v_mfma_f32_16x16x32_bf16 v[216:219], v[108:111], v[128:131], v[216:219]
    s_waitcnt lgkmcnt(6)
    v_exp_f32 v59, v85
    v_mfma_f32_16x16x32_bf16 v[220:223], v[108:111], v[132:135], v[220:223]
    s_cmp_gt_i32 s64, 0
    ds_read_b128 v[108:111], v48 offset:19456
    v_cvt_pk_bf16_f32 v140, v58, v59
    v_mfma_f32_16x16x32_bf16 v[224:227], v[112:115], v[128:131], v[224:227]
    s_waitcnt lgkmcnt(6)
    v_exp_f32 v60, v86
    v_mfma_f32_16x16x32_bf16 v[228:231], v[112:115], v[132:135], v[228:231]
    ds_read_b128 v[112:115], v48 offset:20480
    v_or3_b32 v62, v136, v137, v140
    v_mfma_f32_16x16x32_bf16 v[232:235], v[116:119], v[128:131], v[232:235]
    s_waitcnt lgkmcnt(6)
    v_exp_f32 v61, v87
    v_mfma_f32_16x16x32_bf16 v[236:239], v[116:119], v[132:135], v[236:239]
    s_cselect_b32 s65, 0, 1
    ds_read_b128 v[116:119], v48 offset:21504
    v_cvt_pk_bf16_f32 v141, v60, v61
    v_mfma_f32_16x16x32_bf16 v[240:243], v[120:123], v[128:131], v[240:243]
    s_waitcnt lgkmcnt(6)
    v_exp_f32 v58, v88
    v_mfma_f32_16x16x32_bf16 v[244:247], v[120:123], v[132:135], v[244:247]
    ds_read_b128 v[120:123], v48 offset:22528
    v_mfma_f32_16x16x32_bf16 v[248:251], v[124:127], v[128:131], v[248:251]
    s_waitcnt lgkmcnt(6)
    v_exp_f32 v59, v89
    v_mfma_f32_16x16x32_bf16 v[252:255], v[124:127], v[132:135], v[252:255]
    ds_read_b128 v[124:127], v48 offset:23552
    v_cvt_pk_bf16_f32 v138, v58, v59
    v_mfma_f32_16x16x32_bf16 v[64:67], v[96:99], v[16:19], v[144:147]
    s_waitcnt lgkmcnt(6)
    v_exp_f32 v60, v90
    v_mfma_f32_16x16x32_bf16 v[68:71], v[96:99], v[32:35], v[148:151]
    ds_read_b128 v[96:99], v48 offset:57344
    v_or3_b32 v62, v62, v141, v138
    v_mfma_f32_16x16x32_bf16 v[64:67], v[100:103], v[20:23], v[64:67]
    v_exp_f32 v61, v91
    v_mfma_f32_16x16x32_bf16 v[68:71], v[100:103], v[36:39], v[68:71]
    ds_read_b128 v[100:103], v48 offset:58368
    v_cvt_pk_bf16_f32 v139, v60, v61
    v_mfma_f32_16x16x32_bf16 v[160:163], v[168:171], v[128:131], v[160:163]
    s_waitcnt lgkmcnt(7)
    v_exp_f32 v58, v92
    v_mfma_f32_16x16x32_bf16 v[164:167], v[168:171], v[132:135], v[164:167]
    v_mfma_f32_16x16x32_bf16 v[64:67], v[104:107], v[24:27], v[64:67]
    s_waitcnt lgkmcnt(6)
    v_exp_f32 v59, v93
    v_mfma_f32_16x16x32_bf16 v[68:71], v[104:107], v[40:43], v[68:71]
    ds_read_b128 v[104:107], v48 offset:59392
    v_cvt_pk_bf16_f32 v142, v58, v59
    v_mfma_f32_16x16x32_bf16 v[64:67], v[108:111], v[28:31], v[64:67]
    s_waitcnt lgkmcnt(6)
    v_exp_f32 v60, v94
    v_mfma_f32_16x16x32_bf16 v[68:71], v[108:111], v[44:47], v[68:71]
    ds_read_b128 v[108:111], v48 offset:60416
    v_or3_b32 v62, v62, v139, v142
    v_mfma_f32_16x16x32_bf16 v[72:75], v[112:115], v[16:19], v[152:155]
    s_waitcnt lgkmcnt(6)
    v_exp_f32 v61, v95
    v_mfma_f32_16x16x32_bf16 v[76:79], v[112:115], v[32:35], v[156:159]
    ds_read_b128 v[112:115], v48 offset:61440
    v_cvt_pk_bf16_f32 v143, v60, v61
    v_mfma_f32_16x16x32_bf16 v[72:75], v[116:119], v[20:23], v[72:75]
    s_waitcnt lgkmcnt(6)
    v_bitop3_b32 v62, v62, v143, s72 bitop3:0xa8
    v_cmp_ne_u32 vcc, s65, v62
    v_mfma_f32_16x16x32_bf16 v[76:79], v[116:119], v[36:39], v[76:79]
    ds_read_b128 v[116:119], v48 offset:62464
    v_mfma_f32_16x16x32_bf16 v[72:75], v[120:123], v[24:27], v[72:75]
    s_waitcnt lgkmcnt(6)
    v_exp_f32 v58, v64
    v_mfma_f32_16x16x32_bf16 v[76:79], v[120:123], v[40:43], v[76:79]
    ds_read_b128 v[120:123], v48 offset:63488
    v_mfma_f32_16x16x32_bf16 v[72:75], v[124:127], v[28:31], v[72:75]
    s_waitcnt lgkmcnt(6)
    v_exp_f32 v59, v65
    v_mfma_f32_16x16x32_bf16 v[76:79], v[124:127], v[44:47], v[76:79]
    ds_read_b128 v[124:127], v48 offset:64512
    s_cbranch_vccnz L_back_12_h
L_back_12:
    v_mfma_f32_16x16x32_bf16 v[192:195], v[96:99], v[136:139], v[192:195]
    s_waitcnt lgkmcnt(6)
    v_exp_f32 v60, v66
    v_mfma_f32_16x16x32_bf16 v[196:199], v[96:99], v[140:143], v[196:199]
    ds_read_b128 v[96:99], v48 offset:24576
    v_cvt_pk_bf16_f32 v128, v58, v59
    v_mfma_f32_16x16x32_bf16 v[200:203], v[100:103], v[136:139], v[200:203]
    s_waitcnt lgkmcnt(6)
    v_exp_f32 v61, v67
    v_mfma_f32_16x16x32_bf16 v[204:207], v[100:103], v[140:143], v[204:207]
    s_sub_i32 s64, s64, 1
    ds_read_b128 v[100:103], v48 offset:25600
    v_cvt_pk_bf16_f32 v129, v60, v61
    v_mfma_f32_16x16x32_bf16 v[208:211], v[104:107], v[136:139], v[208:211]
    s_waitcnt lgkmcnt(6)
    v_exp_f32 v58, v68
    v_mfma_f32_16x16x32_bf16 v[212:215], v[104:107], v[140:143], v[212:215]
    ds_read_b128 v[104:107], v48 offset:26624
    v_mfma_f32_16x16x32_bf16 v[216:219], v[108:111], v[136:139], v[216:219]
    s_waitcnt lgkmcnt(6)
    v_exp_f32 v59, v69
    v_mfma_f32_16x16x32_bf16 v[220:223], v[108:111], v[140:143], v[220:223]
    s_cmp_gt_i32 s64, 0
    ds_read_b128 v[108:111], v48 offset:27648
    v_cvt_pk_bf16_f32 v132, v58, v59
    v_mfma_f32_16x16x32_bf16 v[224:227], v[112:115], v[136:139], v[224:227]
    s_waitcnt lgkmcnt(6)
    v_exp_f32 v60, v70
    v_mfma_f32_16x16x32_bf16 v[228:231], v[112:115], v[140:143], v[228:231]
    ds_read_b128 v[112:115], v48 offset:28672
    v_or3_b32 v62, v128, v129, v132
    v_mfma_f32_16x16x32_bf16 v[232:235], v[116:119], v[136:139], v[232:235]
    s_waitcnt lgkmcnt(6)
    v_exp_f32 v61, v71
    v_mfma_f32_16x16x32_bf16 v[236:239], v[116:119], v[140:143], v[236:239]
    s_cselect_b32 s65, 0, 1
    ds_read_b128 v[116:119], v48 offset:29696
    v_cvt_pk_bf16_f32 v133, v60, v61
    v_mfma_f32_16x16x32_bf16 v[240:243], v[120:123], v[136:139], v[240:243]
    s_waitcnt lgkmcnt(6)
    v_exp_f32 v58, v72
    v_mfma_f32_16x16x32_bf16 v[244:247], v[120:123], v[140:143], v[244:247]
    ds_read_b128 v[120:123], v48 offset:30720
    v_mfma_f32_16x16x32_bf16 v[248:251], v[124:127], v[136:139], v[248:251]
    s_waitcnt lgkmcnt(6)
    v_exp_f32 v59, v73
    v_mfma_f32_16x16x32_bf16 v[252:255], v[124:127], v[140:143], v[252:255]
    ds_read_b128 v[124:127], v48 offset:31744
    v_cvt_pk_bf16_f32 v130, v58, v59
    v_mfma_f32_16x16x32_bf16 v[80:83], v[96:99], v[16:19], v[144:147]
    s_waitcnt lgkmcnt(6)
    v_exp_f32 v60, v74
    v_mfma_f32_16x16x32_bf16 v[84:87], v[96:99], v[32:35], v[148:151]
    v_or3_b32 v62, v62, v133, v130
    v_xor_b32 v48, 0x10000, v48
    v_mfma_f32_16x16x32_bf16 v[80:83], v[100:103], v[20:23], v[80:83]
    v_exp_f32 v61, v75
    v_mfma_f32_16x16x32_bf16 v[84:87], v[100:103], v[36:39], v[84:87]
    s_cmp_lg_u32 s89, 0
    v_cvt_pk_bf16_f32 v131, v60, v61
    v_mfma_f32_16x16x32_bf16 v[160:163], v[168:171], v[136:139], v[160:163]
    s_waitcnt lgkmcnt(0)
    v_exp_f32 v58, v76
    v_mfma_f32_16x16x32_bf16 v[164:167], v[168:171], v[140:143], v[164:167]
    s_cbranch_scc1 L_ldback_13_c
    s_barrier
L_ldback_13:
    s_add_i32 s62, s62, 1
    ds_read_b128 v[96:99], v48 offset:32768
    ds_read_b128 v[100:103], v48 offset:33792
    v_mfma_f32_16x16x32_bf16 v[80:83], v[104:107], v[24:27], v[80:83]
    v_exp_f32 v59, v77
    v_mfma_f32_16x16x32_bf16 v[84:87], v[104:107], v[40:43], v[84:87]
    ds_read_b128 v[104:107], v48 offset:34816
    v_cvt_pk_bf16_f32 v134, v58, v59
    v_mfma_f32_16x16x32_bf16 v[80:83], v[108:111], v[28:31], v[80:83]
    v_exp_f32 v60, v78
    v_mfma_f32_16x16x32_bf16 v[84:87], v[108:111], v[44:47], v[84:87]
    ds_read_b128 v[108:111], v48 offset:35840
    v_or3_b32 v62, v62, v131, v134
    v_mfma_f32_16x16x32_bf16 v[88:91], v[112:115], v[16:19], v[152:155]
    v_exp_f32 v61, v79
    v_mfma_f32_16x16x32_bf16 v[92:95], v[112:115], v[32:35], v[156:159]
    ds_read_b128 v[112:115], v48 offset:36864
    v_cvt_pk_bf16_f32 v135, v60, v61
    v_mfma_f32_16x16x32_bf16 v[88:91], v[116:119], v[20:23], v[88:91]
    v_bitop3_b32 v62, v62, v135, s72 bitop3:0xa8
    v_cmp_ne_u32 vcc, s65, v62
    v_mfma_f32_16x16x32_bf16 v[92:95], v[116:119], v[36:39], v[92:95]
    ds_read_b128 v[116:119], v48 offset:37888
    v_mfma_f32_16x16x32_bf16 v[88:91], v[120:123], v[24:27], v[88:91]
    v_exp_f32 v58, v80
    v_mfma_f32_16x16x32_bf16 v[92:95], v[120:123], v[40:43], v[92:95]
    ds_read_b128 v[120:123], v48 offset:38912
    v_mfma_f32_16x16x32_bf16 v[88:91], v[124:127], v[28:31], v[88:91]
    s_waitcnt lgkmcnt(6)
    v_exp_f32 v59, v81
    v_mfma_f32_16x16x32_bf16 v[92:95], v[124:127], v[44:47], v[92:95]
    ds_read_b128 v[124:127], v48 offset:39936
    s_cbranch_vccz L_st0
    s_branch L_back_14_h
L_tail0:
    s_mov_b32 s65, 0
    v_mfma_f32_16x16x32_bf16 v[192:195], v[96:99], v[128:131], v[192:195]
    s_waitcnt lgkmcnt(6)
    v_exp_f32 v60, v82
    v_exp_f32 v61, v83
    v_mfma_f32_16x16x32_bf16 v[196:199], v[96:99], v[132:135], v[196:199]
    ds_read_b128 v[96:99], v48 offset:40960
    v_cvt_pk_bf16_f32 v136, v58, v59
    v_cvt_pk_bf16_f32 v137, v60, v61
    v_mfma_f32_16x16x32_bf16 v[200:203], v[100:103], v[128:131], v[200:203]
    v_exp_f32 v58, v84
    v_exp_f32 v59, v85
    v_mfma_f32_16x16x32_bf16 v[204:207], v[100:103], v[132:135], v[204:207]
    ds_read_b128 v[100:103], v48 offset:41984
    v_cvt_pk_bf16_f32 v140, v58, v59
    v_mfma_f32_16x16x32_bf16 v[160:163], v[168:171], v[128:131], v[160:163]
    s_waitcnt lgkmcnt(7)
    v_exp_f32 v60, v86
    v_exp_f32 v61, v87
    v_mfma_f32_16x16x32_bf16 v[164:167], v[168:171], v[132:135], v[164:167]
    v_cvt_pk_bf16_f32 v141, v60, v61
    v_mfma_f32_16x16x32_bf16 v[208:211], v[104:107], v[128:131], v[208:211]
    s_waitcnt lgkmcnt(6)
    v_exp_f32 v58, v88
    v_exp_f32 v59, v89
    v_mfma_f32_16x16x32_bf16 v[212:215], v[104:107], v[132:135], v[212:215]
    ds_read_b128 v[104:107], v48 offset:43008
    v_cvt_pk_bf16_f32 v138, v58, v59
    v_mfma_f32_16x16x32_bf16 v[216:219], v[108:111], v[128:131], v[216:219]
    s_waitcnt lgkmcnt(6)
    v_exp_f32 v60, v90
    v_exp_f32 v61, v91
    v_mfma_f32_16x16x32_bf16 v[220:223], v[108:111], v[132:135], v[220:223]
    ds_read_b128 v[108:111], v48 offset:44032
    v_cvt_pk_bf16_f32 v139, v60, v61
    v_mfma_f32_16x16x32_bf16 v[224:227], v[112:115], v[128:131], v[224:227]
    s_waitcnt lgkmcnt(6)
    v_exp_f32 v58, v92
    v_exp_f32 v59, v93
    v_mfma_f32_16x16x32_bf16 v[228:231], v[112:115], v[132:135], v[228:231]
    ds_read_b128 v[112:115], v48 offset:45056
    v_cvt_pk_bf16_f32 v142, v58, v59
    v_mfma_f32_16x16x32_bf16 v[232:235], v[116:119], v[128:131], v[232:235]
    s_waitcnt lgkmcnt(6)
    v_exp_f32 v60, v94
    v_exp_f32 v61, v95
    v_mfma_f32_16x16x32_bf16 v[236:239], v[116:119], v[132:135], v[236:239]
    ds_read_b128 v[116:119], v48 offset:46080
    v_cvt_pk_bf16_f32 v143, v60, v61
    v_mfma_f32_16x16x32_bf16 v[240:243], v[120:123], v[128:131], v[240:243]
    s_waitcnt lgkmcnt(6)
    v_or3_b32 v62, v136, v137, v140
    v_or3_b32 v62, v62, v141, v138
    v_or3_b32 v62, v62, v139, v142
    v_bitop3_b32 v62, v62, v143, s72 bitop3:0xa8
    v_cmp_ne_u32 vcc, s65, v62
    v_mfma_f32_16x16x32_bf16 v[244:247], v[120:123], v[132:135], v[244:247]
    ds_read_b128 v[120:123], v48 offset:47104
    v_mfma_f32_16x16x32_bf16 v[248:251], v[124:127], v[128:131], v[248:251]
    s_waitcnt lgkmcnt(6)
    v_mfma_f32_16x16x32_bf16 v[252:255], v[124:127], v[132:135], v[252:255]
    ds_read_b128 v[124:127], v48 offset:48128
    s_cbranch_vccnz L_back_15_h
L_back_15:
L_pv1:
    v_mfma_f32_16x16x32_bf16 v[192:195], v[96:99], v[136:139], v[192:195]
    s_waitcnt lgkmcnt(6)
    v_mfma_f32_16x16x32_bf16 v[196:199], v[96:99], v[140:143], v[196:199]
    v_mfma_f32_16x16x32_bf16 v[200:203], v[100:103], v[136:139], v[200:203]
    v_mfma_f32_16x16x32_bf16 v[204:207], v[100:103], v[140:143], v[204:207]
    v_mfma_f32_16x16x32_bf16 v[160:163], v[168:171], v[136:139], v[160:163]
    s_waitcnt lgkmcnt(5)
    v_mfma_f32_16x16x32_bf16 v[164:167], v[168:171], v[140:143], v[164:167]
    v_mfma_f32_16x16x32_bf16 v[208:211], v[104:107], v[136:139], v[208:211]
    s_waitcnt lgkmcnt(4)
    v_mfma_f32_16x16x32_bf16 v[212:215], v[104:107], v[140:143], v[212:215]
    v_mfma_f32_16x16x32_bf16 v[216:219], v[108:111], v[136:139], v[216:219]
    s_waitcnt lgkmcnt(3)
    v_mfma_f32_16x16x32_bf16 v[220:223], v[108:111], v[140:143], v[220:223]
    v_mfma_f32_16x16x32_bf16 v[224:227], v[112:115], v[136:139], v[224:227]
    s_waitcnt lgkmcnt(2)
    v_mfma_f32_16x16x32_bf16 v[228:231], v[112:115], v[140:143], v[228:231]
    v_mfma_f32_16x16x32_bf16 v[232:235], v[116:119], v[136:139], v[232:235]
    s_waitcnt lgkmcnt(1)
    v_mfma_f32_16x16x32_bf16 v[236:239], v[116:119], v[140:143], v[236:239]
    v_mfma_f32_16x16x32_bf16 v[240:243], v[120:123], v[136:139], v[240:243]
    s_waitcnt lgkmcnt(0)
    v_mfma_f32_16x16x32_bf16 v[244:247], v[120:123], v[140:143], v[244:247]
    v_mfma_f32_16x16x32_bf16 v[248:251], v[124:127], v[136:139], v[248:251]
    v_mfma_f32_16x16x32_bf16 v[252:255], v[124:127], v[140:143], v[252:255]
    s_branch L_fin
L_tail1:
    s_mov_b32 s65, 0
    v_mfma_f32_16x16x32_bf16 v[192:195], v[96:99], v[136:139], v[192:195]
    s_waitcnt lgkmcnt(6)
    v_exp_f32 v60, v66
    v_exp_f32 v61, v67
    v_mfma_f32_16x16x32_bf16 v[196:199], v[96:99], v[140:143], v[196:199]
    ds_read_b128 v[96:99], v48 offset:49152
    v_cvt_pk_bf16_f32 v128, v58, v59
    v_cvt_pk_bf16_f32 v129, v60, v61
    v_mfma_f32_16x16x32_bf16 v[200:203], v[100:103], v[136:139], v[200:203]
    v_exp_f32 v58, v68
    v_exp_f32 v59, v69
    v_mfma_f32_16x16x32_bf16 v[204:207], v[100:103], v[140:143], v[204:207]
    ds_read_b128 v[100:103], v48 offset:50176
    v_cvt_pk_bf16_f32 v132, v58, v59
    v_mfma_f32_16x16x32_bf16 v[160:163], v[168:171], v[136:139], v[160:163]
    s_waitcnt lgkmcnt(7)
    v_exp_f32 v60, v70
    v_exp_f32 v61, v71
    v_mfma_f32_16x16x32_bf16 v[164:167], v[168:171], v[140:143], v[164:167]
    v_cvt_pk_bf16_f32 v133, v60, v61
    v_mfma_f32_16x16x32_bf16 v[208:211], v[104:107], v[136:139], v[208:211]
    s_waitcnt lgkmcnt(6)
    v_exp_f32 v58, v72
    v_exp_f32 v59, v73
    v_mfma_f32_16x16x32_bf16 v[212:215], v[104:107], v[140:143], v[212:215]
    ds_read_b128 v[104:107], v48 offset:51200
    v_cvt_pk_bf16_f32 v130, v58, v59
    v_mfma_f32_16x16x32_bf16 v[216:219], v[108:111], v[136:139], v[216:219]
    s_waitcnt lgkmcnt(6)
    v_exp_f32 v60, v74
    v_exp_f32 v61, v75
    v_mfma_f32_16x16x32_bf16 v[220:223], v[108:111], v[140:143], v[220:223]
    ds_read_b128 v[108:111], v48 offset:52224
    v_cvt_pk_bf16_f32 v131, v60, v61
    v_mfma_f32_16x16x32_bf16 v[224:227], v[112:115], v[136:139], v[224:227]
    s_waitcnt lgkmcnt(6)
    v_exp_f32 v58, v76
    v_exp_f32 v59, v77
    v_mfma_f32_16x16x32_bf16 v[228:231], v[112:115], v[140:143], v[228:231]
    ds_read_b128 v[112:115], v48 offset:53248
    v_cvt_pk_bf16_f32 v134, v58, v59
    v_mfma_f32_16x16x32_bf16 v[232:235], v[116:119], v[136:139], v[232:235]
    s_waitcnt lgkmcnt(6)
    v_exp_f32 v60, v78
    v_exp_f32 v61, v79
    v_mfma_f32_16x16x32_bf16 v[236:239], v[116:119], v[140:143], v[236:239]
    ds_read_b128 v[116:119], v48 offset:54272
    v_cvt_pk_bf16_f32 v135, v60, v61
    v_mfma_f32_16x16x32_bf16 v[240:243], v[120:123], v[136:139], v[240:243]
    s_waitcnt lgkmcnt(6)
    v_or3_b32 v62, v128, v129, v132
    v_or3_b32 v62, v62, v133, v130
    v_or3_b32 v62, v62, v131, v134
    v_bitop3_b32 v62, v62, v135, s72 bitop3:0xa8
    v_cmp_ne_u32 vcc, s65, v62
    v_mfma_f32_16x16x32_bf16 v[244:247], v[120:123], v[140:143], v[244:247]
    ds_read_b128 v[120:123], v48 offset:55296
    v_mfma_f32_16x16x32_bf16 v[248:251], v[124:127], v[136:139], v[248:251]
    s_waitcnt lgkmcnt(6)
    v_mfma_f32_16x16x32_bf16 v[252:255], v[124:127], v[140:143], v[252:255]
    ds_read_b128 v[124:127], v48 offset:56320
    s_cbranch_vccnz L_back_16_h
L_back_16:
L_pv2:
    v_mfma_f32_16x16x32_bf16 v[192:195], v[96:99], v[128:131], v[192:195]
    s_waitcnt lgkmcnt(6)
    v_mfma_f32_16x16x32_bf16 v[196:199], v[96:99], v[132:135], v[196:199]
    v_mfma_f32_16x16x32_bf16 v[200:203], v[100:103], v[128:131], v[200:203]
    v_mfma_f32_16x16x32_bf16 v[204:207], v[100:103], v[132:135], v[204:207]
    v_mfma_f32_16x16x32_bf16 v[160:163], v[168:171], v[128:131], v[160:163]
    s_waitcnt lgkmcnt(5)
    v_mfma_f32_16x16x32_bf16 v[164:167], v[168:171], v[132:135], v[164:167]
    v_mfma_f32_16x16x32_bf16 v[208:211], v[104:107], v[128:131], v[208:211]
    s_waitcnt lgkmcnt(4)
    v_mfma_f32_16x16x32_bf16 v[212:215], v[104:107], v[132:135], v[212:215]
    v_mfma_f32_16x16x32_bf16 v[216:219], v[108:111], v[128:131], v[216:219]
    s_waitcnt lgkmcnt(3)
    v_mfma_f32_16x16x32_bf16 v[220:223], v[108:111], v[132:135], v[220:223]
    v_mfma_f32_16x16x32_bf16 v[224:227], v[112:115], v[128:131], v[224:227]
    s_waitcnt lgkmcnt(2)
    v_mfma_f32_16x16x32_bf16 v[228:231], v[112:115], v[132:135], v[228:231]
    v_mfma_f32_16x16x32_bf16 v[232:235], v[116:119], v[128:131], v[232:235]
    s_waitcnt lgkmcnt(1)
    v_mfma_f32_16x16x32_bf16 v[236:239], v[116:119], v[132:135], v[236:239]
    v_mfma_f32_16x16x32_bf16 v[240:243], v[120:123], v[128:131], v[240:243]
    s_waitcnt lgkmcnt(0)
    v_mfma_f32_16x16x32_bf16 v[244:247], v[120:123], v[132:135], v[244:247]
    v_mfma_f32_16x16x32_bf16 v[248:251], v[124:127], v[128:131], v[248:251]
    v_mfma_f32_16x16x32_bf16 v[252:255], v[124:127], v[132:135], v[252:255]
    s_branch L_fin
L_tail2:
    s_mov_b32 s65, 0
    v_mfma_f32_16x16x32_bf16 v[192:195], v[96:99], v[128:131], v[192:195]
    s_waitcnt lgkmcnt(6)
    v_exp_f32 v60, v82
    v_exp_f32 v61, v83
    v_mfma_f32_16x16x32_bf16 v[196:199], v[96:99], v[132:135], v[196:199]
    ds_read_b128 v[96:99], v48 offset:57344
    v_cvt_pk_bf16_f32 v136, v58, v59
    v_cvt_pk_bf16_f32 v137, v60, v61
    v_mfma_f32_16x16x32_bf16 v[200:203], v[100:103], v[128:131], v[200:203]
    v_exp_f32 v58, v84
    v_exp_f32 v59, v85
    v_mfma_f32_16x16x32_bf16 v[204:207], v[100:103], v[132:135], v[204:207]
    ds_read_b128 v[100:103], v48 offset:58368
    v_cvt_pk_bf16_f32 v140, v58, v59
    v_mfma_f32_16x16x32_bf16 v[160:163], v[168:171], v[128:131], v[160:163]
    s_waitcnt lgkmcnt(7)
    v_exp_f32 v60, v86
    v_exp_f32 v61, v87
    v_mfma_f32_16x16x32_bf16 v[164:167], v[168:171], v[132:135], v[164:167]
    v_cvt_pk_bf16_f32 v141, v60, v61
    v_mfma_f32_16x16x32_bf16 v[208:211], v[104:107], v[128:131], v[208:211]
    s_waitcnt lgkmcnt(6)
    v_exp_f32 v58, v88
    v_exp_f32 v59, v89
    v_mfma_f32_16x16x32_bf16 v[212:215], v[104:107], v[132:135], v[212:215]
    ds_read_b128 v[104:107], v48 offset:59392
    v_cvt_pk_bf16_f32 v138, v58, v59
    v_mfma_f32_16x16x32_bf16 v[216:219], v[108:111], v[128:131], v[216:219]
    s_waitcnt lgkmcnt(6)
    v_exp_f32 v60, v90
    v_exp_f32 v61, v91
    v_mfma_f32_16x16x32_bf16 v[220:223], v[108:111], v[132:135], v[220:223]
    ds_read_b128 v[108:111], v48 offset:60416
    v_cvt_pk_bf16_f32 v139, v60, v61
    v_mfma_f32_16x16x32_bf16 v[224:227], v[112:115], v[128:131], v[224:227]
    s_waitcnt lgkmcnt(6)
    v_exp_f32 v58, v92
    v_exp_f32 v59, v93
    v_mfma_f32_16x16x32_bf16 v[228:231], v[112:115], v[132:135], v[228:231]
    ds_read_b128 v[112:115], v48 offset:61440
    v_cvt_pk_bf16_f32 v142, v58, v59
    v_mfma_f32_16x16x32_bf16 v[232:235], v[116:119], v[128:131], v[232:235]
    s_waitcnt lgkmcnt(6)
    v_exp_f32 v60, v94
    v_exp_f32 v61, v95
    v_mfma_f32_16x16x32_bf16 v[236:239], v[116:119], v[132:135], v[236:239]
    ds_read_b128 v[116:119], v48 offset:62464
    v_cvt_pk_bf16_f32 v143, v60, v61
    v_mfma_f32_16x16x32_bf16 v[240:243], v[120:123], v[128:131], v[240:243]
    s_waitcnt lgkmcnt(6)
    v_or3_b32 v62, v136, v137, v140
    v_or3_b32 v62, v62, v141, v138
    v_or3_b32 v62, v62, v139, v142
    v_bitop3_b32 v62, v62, v143, s72 bitop3:0xa8
    v_cmp_ne_u32 vcc, s65, v62
    v_mfma_f32_16x16x32_bf16 v[244:247], v[120:123], v[132:135], v[244:247]
    ds_read_b128 v[120:123], v48 offset:63488
    v_mfma_f32_16x16x32_bf16 v[248:251], v[124:127], v[128:131], v[248:251]
    s_waitcnt lgkmcnt(6)
    v_mfma_f32_16x16x32_bf16 v[252:255], v[124:127], v[132:135], v[252:255]
    ds_read_b128 v[124:127], v48 offset:64512
    s_cbranch_vccnz L_back_17_h
L_back_17:
L_pv3:
    v_mfma_f32_16x16x32_bf16 v[192:195], v[96:99], v[136:139], v[192:195]
    s_waitcnt lgkmcnt(6)
    v_mfma_f32_16x16x32_bf16 v[196:199], v[96:99], v[140:143], v[196:199]
    v_xor_b32 v48, 0x10000, v48
    v_mfma_f32_16x16x32_bf16 v[200:203], v[100:103], v[136:139], v[200:203]
    v_mfma_f32_16x16x32_bf16 v[204:207], v[100:103], v[140:143], v[204:207]
    v_mfma_f32_16x16x32_bf16 v[160:163], v[168:171], v[136:139], v[160:163]
    s_waitcnt lgkmcnt(5)
    v_mfma_f32_16x16x32_bf16 v[164:167], v[168:171], v[140:143], v[164:167]
    s_waitcnt vmcnt(0) lgkmcnt(0)
    s_call_b64 s[82:83], L_pend
    s_barrier
    s_call_b64 s[82:83], L_load
    s_add_i32 s62, s62, 1
    v_mfma_f32_16x16x32_bf16 v[208:211], v[104:107], v[136:139], v[208:211]
    v_mfma_f32_16x16x32_bf16 v[212:215], v[104:107], v[140:143], v[212:215]
    v_mfma_f32_16x16x32_bf16 v[216:219], v[108:111], v[136:139], v[216:219]
    v_mfma_f32_16x16x32_bf16 v[220:223], v[108:111], v[140:143], v[220:223]
    v_mfma_f32_16x16x32_bf16 v[224:227], v[112:115], v[136:139], v[224:227]
    v_mfma_f32_16x16x32_bf16 v[228:231], v[112:115], v[140:143], v[228:231]
    v_mfma_f32_16x16x32_bf16 v[232:235], v[116:119], v[136:139], v[232:235]
    v_mfma_f32_16x16x32_bf16 v[236:239], v[116:119], v[140:143], v[236:239]
    v_mfma_f32_16x16x32_bf16 v[240:243], v[120:123], v[136:139], v[240:243]
    v_mfma_f32_16x16x32_bf16 v[244:247], v[120:123], v[140:143], v[244:247]
    v_mfma_f32_16x16x32_bf16 v[248:251], v[124:127], v[136:139], v[248:251]
    v_mfma_f32_16x16x32_bf16 v[252:255], v[124:127], v[140:143], v[252:255]
    s_branch L_fin
L_tail3:
    s_mov_b32 s65, 0
    v_mfma_f32_16x16x32_bf16 v[192:195], v[96:99], v[136:139], v[192:195]
    s_waitcnt lgkmcnt(6)
    v_exp_f32 v60, v66
    v_exp_f32 v61, v67
    v_mfma_f32_16x16x32_bf16 v[196:199], v[96:99], v[140:143], v[196:199]
    v_cvt_pk_bf16_f32 v128, v58, v59
    v_cvt_pk_bf16_f32 v129, v60, v61
    v_xor_b32 v48, 0x10000, v48
    v_mfma_f32_16x16x32_bf16 v[200:203], v[100:103], v[136:139], v[200:203]
    v_exp_f32 v58, v68
    v_exp_f32 v59, v69
    v_mfma_f32_16x16x32_bf16 v[204:207], v[100:103], v[140:143], v[204:207]
    v_cvt_pk_bf16_f32 v132, v58, v59
    v_mfma_f32_16x16x32_bf16 v[160:163], v[168:171], v[136:139], v[160:163]
    s_waitcnt lgkmcnt(5)
    v_exp_f32 v60, v70
    v_exp_f32 v61, v71
    v_mfma_f32_16x16x32_bf16 v[164:167], v[168:171], v[140:143], v[164:167]
    s_waitcnt vmcnt(0) lgkmcnt(0)
    s_call_b64 s[82:83], L_pend
    s_barrier
    s_call_b64 s[82:83], L_load
    s_add_i32 s62, s62, 1
    ds_read_b128 v[96:99], v48 offset:32768
    ds_read_b128 v[100:103], v48 offset:33792
    v_cvt_pk_bf16_f32 v133, v60, v61
    v_mfma_f32_16x16x32_bf16 v[208:211], v[104:107], v[136:139], v[208:211]
    v_exp_f32 v58, v72
    v_exp_f32 v59, v73
    v_mfma_f32_16x16x32_bf16 v[212:215], v[104:107], v[140:143], v[212:215]
    ds_read_b128 v[104:107], v48 offset:34816
    v_cvt_pk_bf16_f32 v130, v58, v59
    v_mfma_f32_16x16x32_bf16 v[216:219], v[108:111], v[136:139], v[216:219]
    v_exp_f32 v60, v74
    v_exp_f32 v61, v75
    v_mfma_f32_16x16x32_bf16 v[220:223], v[108:111], v[140:143], v[220:223]
    ds_read_b128 v[108:111], v48 offset:35840
    v_cvt_pk_bf16_f32 v131, v60, v61
    v_mfma_f32_16x16x32_bf16 v[224:227], v[112:115], v[136:139], v[224:227]
    v_exp_f32 v58, v76
    v_exp_f32 v59, v77
    v_mfma_f32_16x16x32_bf16 v[228:231], v[112:115], v[140:143], v[228:231]
    ds_read_b128 v[112:115], v48 offset:36864
    v_cvt_pk_bf16_f32 v134, v58, v59
    v_mfma_f32_16x16x32_bf16 v[232:235], v[116:119], v[136:139], v[232:235]
    v_exp_f32 v60, v78
    v_exp_f32 v61, v79
    v_mfma_f32_16x16x32_bf16 v[236:239], v[116:119], v[140:143], v[236:239]
    ds_read_b128 v[116:119], v48 offset:37888
    v_cvt_pk_bf16_f32 v135, v60, v61
    v_mfma_f32_16x16x32_bf16 v[240:243], v[120:123], v[136:139], v[240:243]
    v_or3_b32 v62, v128, v129, v132
    v_or3_b32 v62, v62, v133, v130
    v_or3_b32 v62, v62, v131, v134
    v_bitop3_b32 v62, v62, v135, s72 bitop3:0xa8
    v_cmp_ne_u32 vcc, s65, v62
    v_mfma_f32_16x16x32_bf16 v[244:247], v[120:123], v[140:143], v[244:247]
    ds_read_b128 v[120:123], v48 offset:38912
    v_mfma_f32_16x16x32_bf16 v[248:251], v[124:127], v[136:139], v[248:251]
    s_waitcnt lgkmcnt(6)
    v_mfma_f32_16x16x32_bf16 v[252:255], v[124:127], v[140:143], v[252:255]
    ds_read_b128 v[124:127], v48 offset:39936
    s_cbranch_vccnz L_back_20_h
L_back_20:
L_pv0:
    v_mfma_f32_16x16x32_bf16 v[192:195], v[96:99], v[128:131], v[192:195]
    s_waitcnt lgkmcnt(6)
    v_mfma_f32_16x16x32_bf16 v[196:199], v[96:99], v[132:135], v[196:199]
    v_mfma_f32_16x16x32_bf16 v[200:203], v[100:103], v[128:131], v[200:203]
    v_mfma_f32_16x16x32_bf16 v[204:207], v[100:103], v[132:135], v[204:207]
    v_mfma_f32_16x16x32_bf16 v[160:163], v[168:171], v[128:131], v[160:163]
    s_waitcnt lgkmcnt(5)
    v_mfma_f32_16x16x32_bf16 v[164:167], v[168:171], v[132:135], v[164:167]
    v_mfma_f32_16x16x32_bf16 v[208:211], v[104:107], v[128:131], v[208:211]
    s_waitcnt lgkmcnt(4)
    v_mfma_f32_16x16x32_bf16 v[212:215], v[104:107], v[132:135], v[212:215]
    v_mfma_f32_16x16x32_bf16 v[216:219], v[108:111], v[128:131], v[216:219]
    s_waitcnt lgkmcnt(3)
    v_mfma_f32_16x16x32_bf16 v[220:223], v[108:111], v[132:135], v[220:223]
    v_mfma_f32_16x16x32_bf16 v[224:227], v[112:115], v[128:131], v[224:227]
    s_waitcnt lgkmcnt(2)
    v_mfma_f32_16x16x32_bf16 v[228:231], v[112:115], v[132:135], v[228:231]
    v_mfma_f32_16x16x32_bf16 v[232:235], v[116:119], v[128:131], v[232:235]
    s_waitcnt lgkmcnt(1)
    v_mfma_f32_16x16x32_bf16 v[236:239], v[116:119], v[132:135], v[236:239]
    v_mfma_f32_16x16x32_bf16 v[240:243], v[120:123], v[128:131], v[240:243]
    s_waitcnt lgkmcnt(0)
    v_mfma_f32_16x16x32_bf16 v[244:247], v[120:123], v[132:135], v[244:247]
    v_mfma_f32_16x16x32_bf16 v[248:251], v[124:127], v[128:131], v[248:251]
    v_mfma_f32_16x16x32_bf16 v[252:255], v[124:127], v[132:135], v[252:255]
L_fin:
    v_and_b32 v3, 7, v1
    v_lshlrev_b32 v3, 2, v3
    s_mov_b32 s72, 0x3a0000
    buffer_load_dword v51, v3, s[8:11], s72 offen sc1
    v_rcp_f32 v56, v160
    v_rcp_f32 v57, v164
    s_lshl_b32 s6, s60, 18
    s_lshl_b32 s7, s4, 12
    s_add_u32 s6, s6, s7
    s_add_u32 s6, s6, 50331648
    s_nop 4
    v_mul_f32 v192, v56, v192
    v_mul_f32 v193, v56, v193
    v_mul_f32 v194, v56, v194
    v_mul_f32 v195, v56, v195
    v_cvt_pk_bf16_f32 v16, v192, v193
    v_cvt_pk_bf16_f32 v17, v194, v195
    v_mul_f32 v200, v56, v200
    v_mul_f32 v201, v56, v201
    v_mul_f32 v202, v56, v202
    v_mul_f32 v203, v56, v203
    v_cvt_pk_bf16_f32 v18, v200, v201
    v_cvt_pk_bf16_f32 v19, v202, v203
    buffer_store_dwordx4 v[16:19], v13, s[8:11], s6 offen offset:0 sc1
    v_mul_f32 v208, v56, v208
    v_mul_f32 v209, v56, v209
    v_mul_f32 v210, v56, v210
    v_mul_f32 v211, v56, v211
    v_cvt_pk_bf16_f32 v20, v208, v209
    v_cvt_pk_bf16_f32 v21, v210, v211
    v_mul_f32 v216, v56, v216
    v_mul_f32 v217, v56, v217
    v_mul_f32 v218, v56, v218
    v_mul_f32 v219, v56, v219
    v_cvt_pk_bf16_f32 v22, v216, v217
    v_cvt_pk_bf16_f32 v23, v218, v219
    buffer_store_dwordx4 v[20:23], v13, s[8:11], s6 offen offset:1024 sc1
    v_mul_f32 v224, v56, v224
    v_mul_f32 v225, v56, v225
    v_mul_f32 v226, v56, v226
    v_mul_f32 v227, v56, v227
    v_cvt_pk_bf16_f32 v24, v224, v225
    v_cvt_pk_bf16_f32 v25, v226, v227
    v_mul_f32 v232, v56, v232
    v_mul_f32 v233, v56, v233
    v_mul_f32 v234, v56, v234
    v_mul_f32 v235, v56, v235
    v_cvt_pk_bf16_f32 v26, v232, v233
    v_cvt_pk_bf16_f32 v27, v234, v235
    buffer_store_dwordx4 v[24:27], v13, s[8:11], s6 offen offset:2048 sc1
    v_mul_f32 v240, v56, v240
    v_mul_f32 v241, v56, v241
    v_mul_f32 v242, v56, v242
    v_mul_f32 v243, v56, v243
    v_cvt_pk_bf16_f32 v28, v240, v241
    v_cvt_pk_bf16_f32 v29, v242, v243
    v_mul_f32 v248, v56, v248
    v_mul_f32 v249, v56, v249
    v_mul_f32 v250, v56, v250
    v_mul_f32 v251, v56, v251
    v_cvt_pk_bf16_f32 v30, v248, v249
    v_cvt_pk_bf16_f32 v31, v250, v251
    buffer_store_dwordx4 v[28:31], v13, s[8:11], s6 offen offset:3072 sc1
    s_add_u32 s6, s6, 0x20000
    v_mul_f32 v196, v57, v196
    v_mul_f32 v197, v57, v197
    v_mul_f32 v198, v57, v198
    v_mul_f32 v199, v57, v199
    v_cvt_pk_bf16_f32 v32, v196, v197
    v_cvt_pk_bf16_f32 v33, v198, v199
    v_mul_f32 v204, v57, v204
    v_mul_f32 v205, v57, v205
    v_mul_f32 v206, v57, v206
    v_mul_f32 v207, v57, v207
    v_cvt_pk_bf16_f32 v34, v204, v205
    v_cvt_pk_bf16_f32 v35, v206, v207
    buffer_store_dwordx4 v[32:35], v13, s[8:11], s6 offen offset:0 sc1
    v_mul_f32 v212, v57, v212
    v_mul_f32 v213, v57, v213
    v_mul_f32 v214, v57, v214
    v_mul_f32 v215, v57, v215
    v_cvt_pk_bf16_f32 v36, v212, v213
    v_cvt_pk_bf16_f32 v37, v214, v215
    v_mul_f32 v220, v57, v220
    v_mul_f32 v221, v57, v221
    v_mul_f32 v222, v57, v222
    v_mul_f32 v223, v57, v223
    v_cvt_pk_bf16_f32 v38, v220, v221
    v_cvt_pk_bf16_f32 v39, v222, v223
    buffer_store_dwordx4 v[36:39], v13, s[8:11], s6 offen offset:1024 sc1
    v_mul_f32 v228, v57, v228
    v_mul_f32 v229, v57, v229
    v_mul_f32 v230, v57, v230
    v_mul_f32 v231, v57, v231
    v_cvt_pk_bf16_f32 v40, v228, v229
    v_cvt_pk_bf16_f32 v41, v230, v231
    v_mul_f32 v236, v57, v236
    v_mul_f32 v237, v57, v237
    v_mul_f32 v238, v57, v238
    v_mul_f32 v239, v57, v239
    v_cvt_pk_bf16_f32 v42, v236, v237
    v_cvt_pk_bf16_f32 v43, v238, v239
    buffer_store_dwordx4 v[40:43], v13, s[8:11], s6 offen offset:2048 sc1
    v_mul_f32 v244, v57, v244
    v_mul_f32 v245, v57, v245
    v_mul_f32 v246, v57, v246
    v_mul_f32 v247, v57, v247
    v_cvt_pk_bf16_f32 v44, v244, v245
    v_cvt_pk_bf16_f32 v45, v246, v247
    v_mul_f32 v252, v57, v252
    v_mul_f32 v253, v57, v253
    v_mul_f32 v254, v57, v254
    v_mul_f32 v255, v57, v255
    v_cvt_pk_bf16_f32 v46, v252, v253
    v_cvt_pk_bf16_f32 v47, v254, v255
    buffer_store_dwordx4 v[44:47], v13, s[8:11], s6 offen offset:3072 sc1
    s_cmp_gt_i32 s62, s63
    s_cbranch_scc1 L_pre
    s_waitcnt vmcnt(8)
    s_call_b64 s[82:83], L_pend
    s_barrier
    s_waitcnt vmcnt(0)
    s_lshl_b32 s6, s60, 5
    s_add_u32 s6, s6, s4
    s_lshl_b32 s6, s6, 7
    s_add_u32 s6, s6, 3932160
    v_mov_b32 v2, 1
    v_mov_b32 v3, 0x5000000
    v_writelane_b32 v3, s6, 0
    buffer_store_dword v2, v3, s[8:11], 0 offen sc1
    s_call_b64 s[82:83], L_load
    s_add_i32 s62, s62, 1
    s_lshl_b32 s6, s3, 8
    s_add_u32 s6, s6, s2
    s_cmp_eq_u32 s6, 31
    s_cbranch_scc1 L_top
L_idle:
    s_sub_i32 s6, s63, 5
    s_cmp_gt_i32 s62, s6
    s_cbranch_scc1 L_pre
    s_waitcnt vmcnt(0) lgkmcnt(0)
    s_call_b64 s[82:83], L_pend
    s_barrier
    s_call_b64 s[82:83], L_load
    s_add_i32 s62, s62, 1
    s_cmp_lt_u32 s61, 54
    s_cbranch_scc1 L_moe
    s_branch L_idle
L_pre:
    s_cmp_lt_u32 s3, 4
    s_cbranch_scc1 L_pre1
    s_add_u32 s6, s76, 0
    s_and_b32 s6, s6, 3
    s_lshl_b32 s6, s6, 10
    v_add_u32 v44, s6, v13
    s_add_u32 s6, s76, 1
    s_and_b32 s6, s6, 3
    s_lshl_b32 s6, s6, 10
    v_add_u32 v45, s6, v13
    s_add_u32 s6, s76, 2
    s_and_b32 s6, s6, 3
    s_lshl_b32 s6, s6, 10
    v_add_u32 v46, s6, v13
    s_add_u32 s6, s76, 3
    s_and_b32 s6, s6, 3
    s_lshl_b32 s6, s6, 10
    v_add_u32 v47, s6, v13
    v_add_u32 v52, 4096, v13
    s_lshr_b32 s69, s4, 3
    s_lshl_b32 s69, s69, 2
    s_add_u32 s69, s69, s76
    s_mul_i32 s69, s69, 327680
    s_and_b32 s7, s4, 3
    s_mul_i32 s7, s7, 10240
    s_add_u32 s69, s69, s7
    s_add_u32 s69, s69, 4199424
    s_and_b32 s6, s4, 4
    s_lshr_b32 s7, s4, 3
    s_add_u32 s6, s6, s7
    s_lshl_b32 s7, s5, 3
    s_add_u32 s68, s6, s7
    s_sub_u32 s7, 120, s7
    s_add_u32 s61, s6, s7
    s_waitcnt vmcnt(8)
    v_cmp_le_i32 vcc, 0, v51
    s_cbranch_vccz L_idx_okb
    v_and_b32 v3, 7, v1
    v_lshlrev_b32 v3, 2, v3
    s_mov_b32 s72, 0x3a0000
    s_mov_b32 s79, 262144
L_poll_23:
    buffer_load_dword v51, v3, s[8:11], s72 offen sc1
    s_waitcnt vmcnt(0)
    v_cmp_le_i32 vcc, 0, v51
    s_cbranch_vccz L_polldone_24
    s_sleep 2
    s_sub_u32 s79, s79, 1
    s_cmp_lg_u32 s79, 0
    s_cbranch_scc1 L_poll_23
L_polldone_24:
L_idx_okb:
    s_call_b64 s[80:81], L_oprep
    s_mov_b32 s6, 0x10000
    s_lshl_b32 s7, s76, 12
    s_add_u32 s7, s7, s6
    v_add_u32 v12, s7, v13
    s_lshl_b32 s7, s76, 13
    s_add_u32 s6, s6, s7
    v_add_u32 v3, s6, v13
    s_add_u32 s7, s7, 131072
    v_add_u32 v2, s7, v13
    s_barrier
    s_add_u32 s75, s69, 163840
    buffer_load_dwordx4 v[176:179], v44, s[8:11], s75 offen sc1
    buffer_load_dwordx4 v[180:183], v45, s[8:11], s75 offen sc1
    buffer_load_dwordx4 v[184:187], v46, s[8:11], s75 offen sc1
    buffer_load_dwordx4 v[188:191], v47, s[8:11], s75 offen sc1
    buffer_load_dwordx4 v[192:195], v52, s[8:11], s75 offen sc1
    ds_read_b128 v[96:99], v2 offset:0
    ds_read_b128 v[100:103], v2 offset:1024
    ds_read_b128 v[104:107], v2 offset:2048
    ds_read_b128 v[108:111], v2 offset:3072
    ds_read_b128 v[112:115], v2 offset:4096
    ds_read_b128 v[116:119], v2 offset:5120
    ds_read_b128 v[120:123], v2 offset:6144
    ds_read_b128 v[124:127], v2 offset:7168
    s_waitcnt lgkmcnt(6)
    ds_read_b128 v[128:131], v3 offset:0
    ds_read_b128 v[132:135], v3 offset:1024
    ds_read_b128 v[136:139], v3 offset:2048
    ds_read_b128 v[140:143], v3 offset:3072
    ds_read_b128 v[144:147], v3 offset:4096
    ds_read_b128 v[148:151], v3 offset:5120
    ds_read_b128 v[152:155], v3 offset:6144
    ds_read_b128 v[156:159], v3 offset:7168
    s_waitcnt lgkmcnt(6)
    ds_read_b128 v[160:163], v12 offset:49152
    ds_read_b128 v[164:167], v12 offset:50176
    ds_read_b128 v[168:171], v12 offset:51200
    ds_read_b128 v[172:175], v12 offset:52224
    s_waitcnt vmcnt(5)
    s_lshl_b32 s6, s60, 5
    s_add_u32 s6, s6, s4
    s_lshl_b32 s6, s6, 7
    s_add_u32 s6, s6, 3932160
    v_mov_b32 v2, 1
    v_mov_b32 v3, 0x5000000
    v_writelane_b32 v3, s6, 0
    buffer_store_dword v2, v3, s[8:11], 0 offen sc1
    s_waitcnt lgkmcnt(0)
    s_branch L_adone
L_oprep:
    s_add_u32 s6, s76, 0
    s_and_b32 s6, s6, 3
    s_lshl_b32 s6, s6, 10
    v_add_u32 v44, s6, v13
    s_add_u32 s6, s76, 1
    s_and_b32 s6, s6, 3
    s_lshl_b32 s6, s6, 10
    v_add_u32 v45, s6, v13
    s_add_u32 s6, s76, 2
    s_and_b32 s6, s6, 3
    s_lshl_b32 s6, s6, 10
    v_add_u32 v46, s6, v13
    s_add_u32 s6, s76, 3
    s_and_b32 s6, s6, 3
    s_lshl_b32 s6, s6, 10
    v_add_u32 v47, s6, v13
    v_add_u32 v52, 4096, v13
    s_lshr_b32 s6, s3, 2
    s_lshl_b32 s6, s6, 1
    s_sub_u32 s71, s76, s6
    s_and_b32 s71, s71, 3
    s_lshr_b32 s6, s4, 3
    s_lshl_b32 s6, s6, 15
    s_lshl_b32 s99, s3, 12
    s_add_u32 s66, s6, s99
    s_add_u32 s66, s66, 50331648
    s_lshl_b32 s6, s76, 13
    v_add_u32 v4, s6, v13
    v_add_u32 v7, 65536, v4
    s_lshr_b32 s6, s3, 2
    s_mul_i32 s67, s6, 15360
    s_add_u32 s67, s67, 98304
    v_add_u32 v6, s67, v44
    v_mov_b32 v11, 0x5000000
    s_and_b32 s63, s4, 7
    s_lshl_b32 s7, s5, 3
    s_add_u32 s63, s63, s7
    s_lshl_b32 s63, s63, 2
    s_lshr_b32 s7, s4, 3
    s_add_u32 s63, s63, s7
    s_mul_i32 s62, s63, 61440
    s_add_u32 s62, s62, 67108864
    s_mul_i32 s63, s63, 384
    s_add_u32 s63, s63, 15728640
    s_and_b32 s96, s4, 7
    s_lshl_b32 s7, s5, 3
    s_add_u32 s96, s96, s7
    s_lshr_b32 s7, s4, 3
    s_add_u32 s7, s7, 0
    s_add_u32 s7, s7, 1
    s_and_b32 s7, s7, 3
    s_lshl_b32 s96, s96, 2
    s_add_u32 s96, s96, s7
    s_mul_i32 s96, s96, 3
    s_add_u32 s96, s96, 0
    s_lshl_b32 s6, s96, 5
    s_add_u32 s6, s6, s3
    s_lshl_b32 s6, s6, 2
    s_add_u32 s6, s6, 15728640
    v_writelane_b32 v11, s6, 0
    s_mul_i32 s96, s96, 20480
    s_lshr_b32 s6, s3, 2
    s_mul_i32 s6, s6, 5120
    s_add_u32 s96, s96, s6
    s_add_u32 s96, s96, 67108864
    s_and_b32 s97, s4, 7
    s_lshl_b32 s7, s5, 3
    s_add_u32 s97, s97, s7
    s_lshr_b32 s7, s4, 3
    s_add_u32 s7, s7, 1
    s_add_u32 s7, s7, 1
    s_and_b32 s7, s7, 3
    s_lshl_b32 s97, s97, 2
    s_add_u32 s97, s97, s7
    s_mul_i32 s97, s97, 3
    s_add_u32 s97, s97, 1
    s_lshl_b32 s6, s97, 5
    s_add_u32 s6, s6, s3
    s_lshl_b32 s6, s6, 2
    s_add_u32 s6, s6, 15728640
    v_writelane_b32 v11, s6, 1
    s_mul_i32 s97, s97, 20480
    s_lshr_b32 s6, s3, 2
    s_mul_i32 s6, s6, 5120
    s_add_u32 s97, s97, s6
    s_add_u32 s97, s97, 67108864
    s_and_b32 s98, s4, 7
    s_lshl_b32 s7, s5, 3
    s_add_u32 s98, s98, s7
    s_lshr_b32 s7, s4, 3
    s_add_u32 s7, s7, 2
    s_add_u32 s7, s7, 1
    s_and_b32 s7, s7, 3
    s_lshl_b32 s98, s98, 2
    s_add_u32 s98, s98, s7
    s_mul_i32 s98, s98, 3
    s_add_u32 s98, s98, 2
    s_lshl_b32 s6, s98, 5
    s_add_u32 s6, s6, s3
    s_lshl_b32 s6, s6, 2
    s_add_u32 s6, s6, 15728640
    v_writelane_b32 v11, s6, 2
    s_mul_i32 s98, s98, 20480
    s_lshr_b32 s6, s3, 2
    s_mul_i32 s6, s6, 5120
    s_add_u32 s98, s98, s6
    s_add_u32 s98, s98, 67108864
    s_mov_b32 s12, s32
    s_mov_b32 s13, s33
    s_mov_b32 s14, 0x280000
    s_mov_b32 s15, 0x20000
    s_and_b32 s75, s4, 3
    s_mul_i32 s70, s75, 320
    s_add_u32 s73, s70, 3837952
    s_mul_i32 s72, s75, 5120
    v_lshrrev_b32 v2, 4, v1
    v_and_b32 v3, 15, v1
    v_mul_u32_u24 v54, 1280, v3
    v_lshl_add_u32 v54, v2, 4, v54
    v_lshlrev_b32 v3, 4, v3
    v_lshl_add_u32 v9, v2, 9, v3
    s_lshr_b32 s100, s3, 2
    s_cselect_b32 s6, s61, s68
    s_mul_i32 s6, s6, 20480
    s_lshl_b32 s7, s76, 6
    s_add_u32 s7, s7, s6
    v_add_u32 v53, s7, v54
    s_lshl_b32 s7, s76, 10
    s_add_u32 s7, s7, s6
    s_add_u32 s7, s7, s72
    v_add_u32 v48, s7, v13
    s_mul_i32 s6, s100, 10240
    s_lshl_b32 s7, s76, 11
    s_add_u32 s6, s6, s7
    v_add_u32 v8, s6, v9
    s_mul_i32 s6, s100, 75776
    s_sub_u32 s6, 65536, s6
    v_add_u32 v10, s6, v8
    s_lshl_b32 s7, s76, 2
    v_add_u32 v2, s7, v2
    v_cmp_lt_u32 vcc, 9, v2
    s_mul_i32 s6, s100, 86016
    s_add_u32 s6, s6, 15360
    v_add_u32 v3, s6, v10
    v_cndmask_b32 v10, v10, v3, vcc
    s_and_b32 s100, s3, 1
    s_cselect_b32 s6, s61, s68
    s_mul_i32 s6, s6, 20480
    s_add_u32 s7, s6, 256
    v_add_u32 v54, s7, v54
    s_add_u32 s7, s6, s72
    s_add_u32 s7, s7, 4096
    v_add_u32 v49, s7, v13
    s_mul_i32 s6, s100, 10240
    s_add_u32 s6, s6, 8192
    v_add_u32 v9, s6, v9
    s_mul_i32 s6, s100, 10240
    s_add_u32 s6, s6, 80896
    v_add_u32 v55, s6, v9
    s_mov_b32 s64, 0
    v_and_b32 v2, 0x7ff, v51
    v_sub_u32 v2, 0x7ff, v2
    v_lshrrev_b32 v3, 4, v2
    v_cmp_eq_u32 vcc, s68, v3
    v_cmp_eq_u32 s[74:75], s61, v3
    s_nop 3
    s_or_b64 vcc, vcc, s[74:75]
    s_cbranch_scc0 L_notok_25
    v_readlane_b32 s84, v2, 0
    v_readlane_b32 s85, v2, 1
    v_readlane_b32 s86, v2, 2
    v_readlane_b32 s87, v2, 3
    v_readlane_b32 s88, v2, 4
    v_readlane_b32 s65, v2, 5
    v_readlane_b32 s91, v2, 6
    v_readlane_b32 s101, v2, 7
    s_lshl_b32 s7, s76, 6
    s_lshr_b32 s100, s3, 2
    s_cselect_b32 s6, s61, s68
    s_lshl_b32 s6, s6, 4
    v_and_b32 v2, 15, v1
    v_add_u32 v2, s6, v2
    s_add_u32 s7, s7, s73
    v_and_b32 v3, 48, v1
    v_add_u32 v3, s7, v3
    v_cmp_eq_u32 vcc, s84, v2
    s_nop 1
    v_cndmask_b32 v48, v48, v3, vcc
    v_add_u32 v3, 1280, v3
    v_cmp_eq_u32 vcc, s85, v2
    s_nop 1
    v_cndmask_b32 v48, v48, v3, vcc
    v_add_u32 v3, 1280, v3
    v_cmp_eq_u32 vcc, s86, v2
    s_nop 1
    v_cndmask_b32 v48, v48, v3, vcc
    v_add_u32 v3, 1280, v3
    v_cmp_eq_u32 vcc, s87, v2
    s_nop 1
    v_cndmask_b32 v48, v48, v3, vcc
    v_add_u32 v3, 1280, v3
    v_cmp_eq_u32 vcc, s88, v2
    s_nop 1
    v_cndmask_b32 v48, v48, v3, vcc
    v_add_u32 v3, 1280, v3
    v_cmp_eq_u32 vcc, s65, v2
    s_nop 1
    v_cndmask_b32 v48, v48, v3, vcc
    v_add_u32 v3, 1280, v3
    v_cmp_eq_u32 vcc, s91, v2
    s_nop 1
    v_cndmask_b32 v48, v48, v3, vcc
    v_add_u32 v3, 1280, v3
    v_cmp_eq_u32 vcc, s101, v2
    s_nop 1
    v_cndmask_b32 v48, v48, v3, vcc
    s_movk_i32 s7, 256
    s_and_b32 s100, s3, 1
    s_cselect_b32 s6, s61, s68
    s_lshl_b32 s6, s6, 4
    v_and_b32 v2, 15, v1
    v_add_u32 v2, s6, v2
    s_add_u32 s7, s7, s73
    v_and_b32 v3, 48, v1
    v_add_u32 v3, s7, v3
    v_cmp_eq_u32 vcc, s84, v2
    s_nop 1
    v_cndmask_b32 v49, v49, v3, vcc
    v_add_u32 v3, 1280, v3
    v_cmp_eq_u32 vcc, s85, v2
    s_nop 1
    v_cndmask_b32 v49, v49, v3, vcc
    v_add_u32 v3, 1280, v3
    v_cmp_eq_u32 vcc, s86, v2
    s_nop 1
    v_cndmask_b32 v49, v49, v3, vcc
    v_add_u32 v3, 1280, v3
    v_cmp_eq_u32 vcc, s87, v2
    s_nop 1
    v_cndmask_b32 v49, v49, v3, vcc
    v_add_u32 v3, 1280, v3
    v_cmp_eq_u32 vcc, s88, v2
    s_nop 1
    v_cndmask_b32 v49, v49, v3, vcc
    v_add_u32 v3, 1280, v3
    v_cmp_eq_u32 vcc, s65, v2
    s_nop 1
    v_cndmask_b32 v49, v49, v3, vcc
    v_add_u32 v3, 1280, v3
    v_cmp_eq_u32 vcc, s91, v2
    s_nop 1
    v_cndmask_b32 v49, v49, v3, vcc
    v_add_u32 v3, 1280, v3
    v_cmp_eq_u32 vcc, s101, v2
    s_nop 1
    v_cndmask_b32 v49, v49, v3, vcc
    s_mov_b32 s64, 1
L_notok_25:
    s_setpc_b64 s[80:81]
L_pre1:
    s_mov_b32 s28, s56
    s_mov_b32 s29, s57
    s_mov_b32 s30, 0x100
    s_mov_b32 s31, 0x20000
    v_and_b32 v3, 31, v1
    v_lshlrev_b32 v3, 2, v3
    s_mov_b32 s79, 262144
L_poll_26:
    buffer_load_dword v2, v3, s[28:31], 0 offen offset:128 sc1
    s_waitcnt vmcnt(0)
    v_cmp_gt_u32 vcc, 4, v2
    s_cbranch_vccz L_polldone_27
    s_sleep 8
    s_sub_u32 s79, s79, 1
    s_cmp_lg_u32 s79, 0
    s_cbranch_scc1 L_poll_26
L_polldone_27:
    s_mov_b32 s90, 1
    v_and_b32 v3, 7, v1
    v_lshlrev_b32 v3, 2, v3
    s_mov_b32 s72, 0x3a0000
    buffer_load_dword v51, v3, s[8:11], s72 offen sc1
    s_add_u32 s6, s76, 0
    s_and_b32 s6, s6, 3
    s_lshl_b32 s6, s6, 10
    v_add_u32 v44, s6, v13
    s_add_u32 s6, s76, 1
    s_and_b32 s6, s6, 3
    s_lshl_b32 s6, s6, 10
    v_add_u32 v45, s6, v13
    s_add_u32 s6, s76, 2
    s_and_b32 s6, s6, 3
    s_lshl_b32 s6, s6, 10
    v_add_u32 v46, s6, v13
    s_add_u32 s6, s76, 3
    s_and_b32 s6, s6, 3
    s_lshl_b32 s6, s6, 10
    v_add_u32 v47, s6, v13
    v_add_u32 v52, 4096, v13
    s_lshr_b32 s69, s4, 3
    s_lshl_b32 s69, s69, 2
    s_add_u32 s69, s69, s76
    s_mul_i32 s69, s69, 327680
    s_and_b32 s7, s4, 3
    s_mul_i32 s7, s7, 10240
    s_add_u32 s69, s69, s7
    s_add_u32 s69, s69, 4194304
    s_and_b32 s6, s4, 4
    s_lshr_b32 s7, s4, 3
    s_add_u32 s6, s6, s7
    s_lshl_b32 s7, s5, 3
    s_add_u32 s68, s6, s7
    s_sub_u32 s7, 120, s7
    s_add_u32 s61, s6, s7
    s_add_u32 s75, s69, 0
    buffer_load_dwordx4 v[96:99], v44, s[8:11], s75 offen sc1
    buffer_load_dwordx4 v[100:103], v45, s[8:11], s75 offen sc1
    buffer_load_dwordx4 v[104:107], v46, s[8:11], s75 offen sc1
    buffer_load_dwordx4 v[108:111], v47, s[8:11], s75 offen sc1
    buffer_load_dwordx4 v[112:115], v52, s[8:11], s75 offen sc1
    s_add_u32 s75, s69, 40960
    buffer_load_dwordx4 v[116:119], v44, s[8:11], s75 offen sc1
    buffer_load_dwordx4 v[120:123], v45, s[8:11], s75 offen sc1
    buffer_load_dwordx4 v[124:127], v46, s[8:11], s75 offen sc1
    buffer_load_dwordx4 v[128:131], v47, s[8:11], s75 offen sc1
    buffer_load_dwordx4 v[132:135], v52, s[8:11], s75 offen sc1
    s_cmp_gt_i32 s62, s63
    s_cbranch_scc1 L_e2
    s_cmp_eq_i32 s62, s63
    s_cbranch_scc1 L_lw0
    s_waitcnt vmcnt(11)
L_lw0:
    s_waitcnt vmcnt(20)
    s_call_b64 s[82:83], L_pend
    s_barrier
    s_call_b64 s[82:83], L_load
    s_add_i32 s62, s62, 1
L_e2:
    s_add_u32 s75, s69, 81920
    buffer_load_dwordx4 v[136:139], v44, s[8:11], s75 offen sc1
    buffer_load_dwordx4 v[140:143], v45, s[8:11], s75 offen sc1
    buffer_load_dwordx4 v[144:147], v46, s[8:11], s75 offen sc1
    buffer_load_dwordx4 v[148:151], v47, s[8:11], s75 offen sc1
    buffer_load_dwordx4 v[152:155], v52, s[8:11], s75 offen sc1
    s_add_u32 s75, s69, 122880
    buffer_load_dwordx4 v[156:159], v44, s[8:11], s75 offen sc1
    buffer_load_dwordx4 v[160:163], v45, s[8:11], s75 offen sc1
    buffer_load_dwordx4 v[164:167], v46, s[8:11], s75 offen sc1
    buffer_load_dwordx4 v[168:171], v47, s[8:11], s75 offen sc1
    buffer_load_dwordx4 v[172:175], v52, s[8:11], s75 offen sc1
    s_cmp_gt_i32 s62, s63
    s_cbranch_scc1 L_e3
    s_cmp_eq_i32 s62, s63
    s_cbranch_scc1 L_lw1
    s_waitcnt vmcnt(10)
L_lw1:
    s_waitcnt vmcnt(20)
    s_call_b64 s[82:83], L_pend
    s_barrier
    s_call_b64 s[82:83], L_load
    s_add_i32 s62, s62, 1
L_e3:
    s_add_u32 s75, s69, 163840
    buffer_load_dwordx4 v[176:179], v44, s[8:11], s75 offen sc1
    buffer_load_dwordx4 v[180:183], v45, s[8:11], s75 offen sc1
    buffer_load_dwordx4 v[184:187], v46, s[8:11], s75 offen sc1
    buffer_load_dwordx4 v[188:191], v47, s[8:11], s75 offen sc1
    buffer_load_dwordx4 v[192:195], v52, s[8:11], s75 offen sc1
    s_add_u32 s75, s69, 204800
    buffer_load_dwordx4 v[196:199], v44, s[8:11], s75 offen sc1
    buffer_load_dwordx4 v[200:203], v45, s[8:11], s75 offen sc1
    buffer_load_dwordx4 v[204:207], v46, s[8:11], s75 offen sc1
    buffer_load_dwordx4 v[208:211], v47, s[8:11], s75 offen sc1
    buffer_load_dwordx4 v[212:215], v52, s[8:11], s75 offen sc1
    s_cmp_gt_i32 s62, s63
    s_cbranch_scc1 L_e4
    s_cmp_eq_i32 s62, s63
    s_cbranch_scc1 L_lw2
    s_waitcnt vmcnt(10)
L_lw2:
    s_waitcnt vmcnt(20)
    s_call_b64 s[82:83], L_pend
    s_barrier
    s_call_b64 s[82:83], L_load
    s_add_i32 s62, s62, 1
L_e4:
    s_add_u32 s75, s69, 245760
    buffer_load_dwordx4 v[216:219], v44, s[8:11], s75 offen sc1
    buffer_load_dwordx4 v[220:223], v45, s[8:11], s75 offen sc1
    buffer_load_dwordx4 v[224:227], v46, s[8:11], s75 offen sc1
    buffer_load_dwordx4 v[228:231], v47, s[8:11], s75 offen sc1
    buffer_load_dwordx4 v[232:235], v52, s[8:11], s75 offen sc1
    s_add_u32 s75, s69, 286720
    buffer_load_dwordx4 v[236:239], v44, s[8:11], s75 offen sc1
    buffer_load_dwordx4 v[240:243], v45, s[8:11], s75 offen sc1
    buffer_load_dwordx4 v[244:247], v46, s[8:11], s75 offen sc1
    buffer_load_dwordx4 v[248:251], v47, s[8:11], s75 offen sc1
    buffer_load_dwordx4 v[252:255], v52, s[8:11], s75 offen sc1
    s_cmp_gt_i32 s62, s63
    s_cbranch_scc1 L_e5
    s_cmp_eq_i32 s62, s63
    s_cbranch_scc1 L_lw3
    s_waitcnt vmcnt(10)
L_lw3:
    s_waitcnt vmcnt(20)
    s_call_b64 s[82:83], L_pend
    s_barrier
    s_call_b64 s[82:83], L_load
    s_add_i32 s62, s62, 1
L_e5:
    v_and_b32 v3, 1, v1
    v_lshlrev_b32 v3, 12, v3
    v_and_b32 v2, 2, v1
    v_lshl_add_u32 v3, v2, 8, v3
    s_lshr_b32 s72, s68, 2
    s_lshl_b32 s72, s72, 6
    s_andn2_b32 s6, s4, 7
    s_add_u32 s72, s72, s6
    s_add_u32 s72, s72, s3
    s_lshl_b32 s72, s72, 7
    s_add_u32 s72, s72, 3932160
    buffer_load_dword v50, v3, s[8:11], s72 offen sc1
    s_cmp_gt_i32 s62, s63
    s_cbranch_scc1 L_e6
    s_waitcnt vmcnt(20)
    s_call_b64 s[82:83], L_pend
    s_barrier
    s_call_b64 s[82:83], L_load
    s_add_i32 s62, s62, 1
L_e6:
    s_waitcnt vmcnt(20)
    v_cmp_le_i32 vcc, 0, v51
    s_cbranch_vccz L_idx_oka
    v_and_b32 v3, 7, v1
    v_lshlrev_b32 v3, 2, v3
    s_mov_b32 s72, 0x3a0000
    s_mov_b32 s79, 262144
L_poll_33:
    buffer_load_dword v51, v3, s[8:11], s72 offen sc1
    s_waitcnt vmcnt(0)
    v_cmp_le_i32 vcc, 0, v51
    s_cbranch_vccz L_polldone_34
    s_sleep 2
    s_sub_u32 s79, s79, 1
    s_cmp_lg_u32 s79, 0
    s_cbranch_scc1 L_poll_33
L_polldone_34:
L_idx_oka:
    s_lshr_b32 s7, s3, 1
    s_lshl_b32 s7, s7, 4
    s_add_u32 s6, s5, s7
    s_cmp_lg_u32 s6, 3
    s_cbranch_scc1 L_yd
    s_lshr_b32 s87, s4, 2
    s_and_b32 s88, s4, 3
    s_lshl_b32 s88, s88, 1
    s_add_u32 s88, s88, s3
    s_mov_b32 m0, s87
    s_nop 3
    v_readlane_b32 s85, v51, m0
    s_nop 3
    s_and_b32 s86, s85, 0x7ff
    s_sub_u32 s86, 0x7ff, s86
    v_min_u32 v3, 53, v1
    v_lshlrev_b32 v3, 7, v3
    s_mov_b32 s72, 0xf20000
    s_mov_b32 s79, 262144
L_poll_35:
    buffer_load_dwordx4 v[16:19], v3, s[8:11], s72 offen sc1
    s_waitcnt vmcnt(0)
    v_and_b32 v16, v16, v17
    v_and_b32 v16, v16, v18
    v_and_b32 v16, v16, v19
    v_cmp_ne_u32 vcc, 1, v16
    s_cbranch_vccz L_polldone_36
    s_sleep 16
    s_sub_u32 s79, s79, 1
    s_cmp_lg_u32 s79, 0
    s_cbranch_scc1 L_poll_35
L_polldone_36:
    v_mul_u32_u24 v2, 13, v1
    v_lshrrev_b32 v2, 8, v2
    v_mul_u32_u24 v3, 20, v2
    v_sub_u32 v4, v1, v3
    s_mov_b32 s6, 368640
    v_mul_lo_u32 v2, v2, s6
    v_lshl_add_u32 v2, v4, 4, v2
    v_cmp_lt_u32 vcc, 59, v1
    v_mov_b32 v3, 0x5000000
    s_nop 0
    v_cndmask_b32 v2, v2, v3, vcc
    s_mul_i32 s6, s87, 2560
    s_mul_i32 s7, s88, 320
    s_add_u32 s6, s6, s7
    s_add_u32 s6, s6, 2686976
    buffer_load_dwordx4 v[16:19], v2, s[8:11], s6 offen sc1
    s_add_u32 s6, s6, 20480
    buffer_load_dwordx4 v[20:23], v2, s[8:11], s6 offen sc1
    s_add_u32 s6, s6, 20480
    buffer_load_dwordx4 v[24:27], v2, s[8:11], s6 offen sc1
    s_add_u32 s6, s6, 20480
    buffer_load_dwordx4 v[28:31], v2, s[8:11], s6 offen sc1
    s_add_u32 s6, s6, 20480
    buffer_load_dwordx4 v[32:35], v2, s[8:11], s6 offen sc1
    s_add_u32 s6, s6, 20480
    buffer_load_dwordx4 v[36:39], v2, s[8:11], s6 offen sc1
    s_add_u32 s6, s6, 20480
    buffer_load_dwordx4 v[40:43], v2, s[8:11], s6 offen sc1
    s_add_u32 s6, s6, 20480
    buffer_load_dwordx4 v[44:47], v2, s[8:11], s6 offen sc1
    s_add_u32 s6, s6, 20480
    buffer_load_dwordx4 v[56:59], v2, s[8:11], s6 offen sc1
    s_add_u32 s6, s6, 20480
    buffer_load_dwordx4 v[60:63], v2, s[8:11], s6 offen sc1
    s_add_u32 s6, s6, 20480
    buffer_load_dwordx4 v[64:67], v2, s[8:11], s6 offen sc1
    s_add_u32 s6, s6, 20480
    buffer_load_dwordx4 v[68:71], v2, s[8:11], s6 offen sc1
    s_add_u32 s6, s6, 20480
    buffer_load_dwordx4 v[72:75], v2, s[8:11], s6 offen sc1
    s_add_u32 s6, s6, 20480
    buffer_load_dwordx4 v[76:79], v2, s[8:11], s6 offen sc1
    s_add_u32 s6, s6, 20480
    buffer_load_dwordx4 v[80:83], v2, s[8:11], s6 offen sc1
    s_add_u32 s6, s6, 20480
    buffer_load_dwordx4 v[84:87], v2, s[8:11], s6 offen sc1
    s_add_u32 s6, s6, 20480
    buffer_load_dwordx4 v[88:91], v2, s[8:11], s6 offen sc1
    s_add_u32 s6, s6, 20480
    buffer_load_dwordx4 v[92:95], v2, s[8:11], s6 offen sc1
    s_add_u32 s6, s6, 20480
    s_lshr_b32 s6, s86, 4
    s_mul_i32 s6, s6, 20480
    s_and_b32 s7, s86, 15
    s_lshl_b32 s7, s7, 4
    s_add_u32 s6, s6, s7
    s_mul_i32 s7, s88, 2560
    s_add_u32 s6, s6, s7
    v_lshrrev_b32 v5, 1, v4
    v_lshlrev_b32 v5, 8, v5
    v_and_b32 v6, 1, v4
    v_lshl_add_u32 v5, v6, 3, v5
    buffer_load_dwordx2 v[54:55], v5, s[8:11], s6 offen sc1
    s_bfe_u32 s6, s85, 0x10000b
    s_xor_b32 s7, s6, 0xffff
    s_bitcmp1_b32 s6, 15
    s_bitset0_b32 s6, 15
    s_cselect_b32 s6, s6, s7
    s_lshl_b32 s6, s6, 16
    v_mov_b32 v5, s6
    v_mul_f32 v5, 0xbfb8aa3b, v5
    v_exp_f32 v5, v5
    s_nop 0
    v_add_f32 v5, 1.0, v5
    v_rcp_f32 v5, v5
    s_nop 0
    v_cvt_pk_bf16_f32 v5, v5, v5
    v_lshlrev_b32 v5, 16, v5
    v_lshlrev_b32 v6, 2, v1
    s_waitcnt vmcnt(0)
    v_pk_add_f32 v[16:17], v[16:17], v[20:21]
    v_pk_add_f32 v[18:19], v[18:19], v[22:23]
    v_pk_add_f32 v[16:17], v[16:17], v[24:25]
    v_pk_add_f32 v[18:19], v[18:19], v[26:27]
    v_pk_add_f32 v[16:17], v[16:17], v[28:29]
    v_pk_add_f32 v[18:19], v[18:19], v[30:31]
    v_pk_add_f32 v[16:17], v[16:17], v[32:33]
    v_pk_add_f32 v[18:19], v[18:19], v[34:35]
    v_pk_add_f32 v[16:17], v[16:17], v[36:37]
    v_pk_add_f32 v[18:19], v[18:19], v[38:39]
    v_pk_add_f32 v[16:17], v[16:17], v[40:41]
    v_pk_add_f32 v[18:19], v[18:19], v[42:43]
    v_pk_add_f32 v[16:17], v[16:17], v[44:45]
    v_pk_add_f32 v[18:19], v[18:19], v[46:47]
    v_pk_add_f32 v[16:17], v[16:17], v[56:57]
    v_pk_add_f32 v[18:19], v[18:19], v[58:59]
    v_pk_add_f32 v[16:17], v[16:17], v[60:61]
    v_pk_add_f32 v[18:19], v[18:19], v[62:63]
    v_pk_add_f32 v[16:17], v[16:17], v[64:65]
    v_pk_add_f32 v[18:19], v[18:19], v[66:67]
    v_pk_add_f32 v[16:17], v[16:17], v[68:69]
    v_pk_add_f32 v[18:19], v[18:19], v[70:71]
    v_pk_add_f32 v[16:17], v[16:17], v[72:73]
    v_pk_add_f32 v[18:19], v[18:19], v[74:75]
    v_pk_add_f32 v[16:17], v[16:17], v[76:77]
    v_pk_add_f32 v[18:19], v[18:19], v[78:79]
    v_pk_add_f32 v[16:17], v[16:17], v[80:81]
    v_pk_add_f32 v[18:19], v[18:19], v[82:83]
    v_pk_add_f32 v[16:17], v[16:17], v[84:85]
    v_pk_add_f32 v[18:19], v[18:19], v[86:87]
    v_pk_add_f32 v[16:17], v[16:17], v[88:89]
    v_pk_add_f32 v[18:19], v[18:19], v[90:91]
    v_pk_add_f32 v[16:17], v[16:17], v[92:93]
    v_pk_add_f32 v[18:19], v[18:19], v[94:95]
    ds_bpermute_b32 v20, v6, v16 offset:80
    ds_bpermute_b32 v21, v6, v17 offset:80
    ds_bpermute_b32 v22, v6, v18 offset:80
    ds_bpermute_b32 v23, v6, v19 offset:80
    ds_bpermute_b32 v24, v6, v16 offset:160
    ds_bpermute_b32 v25, v6, v17 offset:160
    ds_bpermute_b32 v26, v6, v18 offset:160
    ds_bpermute_b32 v27, v6, v19 offset:160
    s_waitcnt lgkmcnt(0)
    v_add_f32 v16, v16, v20
    v_add_f32 v16, v16, v24
    v_cvt_pk_bf16_f32 v16, v16, v16
    v_lshlrev_b32 v16, 16, v16
    v_mul_f32 v16, v16, v5
    v_cvt_pk_bf16_f32 v16, v16, v16
    v_lshlrev_b32 v16, 16, v16
    v_lshlrev_b32 v7, 16, v54
    v_add_f32 v16, v16, v7
    v_add_f32 v17, v17, v21
    v_add_f32 v17, v17, v25
    v_cvt_pk_bf16_f32 v17, v17, v17
    v_lshlrev_b32 v17, 16, v17
    v_mul_f32 v17, v17, v5
    v_cvt_pk_bf16_f32 v17, v17, v17
    v_lshlrev_b32 v17, 16, v17
    v_and_b32 v7, 0xffff0000, v54
    v_add_f32 v17, v17, v7
    v_add_f32 v18, v18, v22
    v_add_f32 v18, v18, v26
    v_cvt_pk_bf16_f32 v18, v18, v18
    v_lshlrev_b32 v18, 16, v18
    v_mul_f32 v18, v18, v5
    v_cvt_pk_bf16_f32 v18, v18, v18
    v_lshlrev_b32 v18, 16, v18
    v_lshlrev_b32 v7, 16, v55
    v_add_f32 v18, v18, v7
    v_add_f32 v19, v19, v23
    v_add_f32 v19, v19, v27
    v_cvt_pk_bf16_f32 v19, v19, v19
    v_lshlrev_b32 v19, 16, v19
    v_mul_f32 v19, v19, v5
    v_cvt_pk_bf16_f32 v19, v19, v19
    v_lshlrev_b32 v19, 16, v19
    v_and_b32 v7, 0xffff0000, v55
    v_add_f32 v19, v19, v7
    v_cvt_pk_bf16_f32 v20, v16, v17
    v_cvt_pk_bf16_f32 v21, v18, v19
    v_lshlrev_b32 v2, 3, v1
    v_cmp_lt_u32 vcc, 19, v1
    s_mul_i32 s6, s87, 1280
    s_mul_i32 s7, s88, 160
    v_cndmask_b32 v2, v2, v3, vcc
    s_add_u32 s6, s6, s7
    s_add_u32 s6, s6, 3837952
    buffer_store_dwordx2 v[20:21], v2, s[8:11], s6 offen sc1
    s_call_b64 s[80:81], L_oprep
    s_waitcnt vmcnt(0)
    s_lshl_b32 s6, s5, 5
    s_add_u32 s6, s6, s4
    s_lshl_b32 s6, s6, 5
    s_add_u32 s6, s6, s3
    s_lshl_b32 s6, s6, 2
    s_add_u32 s6, s6, 3899392
    v_mov_b32 v2, 1
    v_mov_b32 v3, 0x5000000
    v_writelane_b32 v3, s6, 0
    buffer_store_dword v2, v3, s[8:11], 0 offen sc1
    s_branch L_ye
L_yd:
    s_call_b64 s[80:81], L_oprep
    s_waitcnt vmcnt(0)
L_ye:
    v_cmp_ne_u32 vcc, 1, v50
    s_cbranch_vccz L_ce
    v_and_b32 v3, 1, v1
    v_lshlrev_b32 v3, 12, v3
    v_and_b32 v2, 2, v1
    v_lshl_add_u32 v3, v2, 8, v3
    s_lshr_b32 s72, s68, 2
    s_lshl_b32 s72, s72, 6
    s_andn2_b32 s6, s4, 7
    s_add_u32 s72, s72, s6
    s_add_u32 s72, s72, s3
    s_lshl_b32 s72, s72, 7
    s_add_u32 s72, s72, 3932160
    s_mov_b32 s79, 262144
L_poll_37:
    buffer_load_dword v2, v3, s[8:11], s72 offen sc1
    s_waitcnt vmcnt(0)
    v_cmp_ne_u32 vcc, 1, v2
    s_cbranch_vccz L_polldone_38
    s_sleep 4
    s_sub_u32 s79, s79, 1
    s_cmp_lg_u32 s79, 0
    s_cbranch_scc1 L_poll_37
L_polldone_38:
L_ce:
    s_add_u32 s65, s68, 1
    s_and_b32 s65, s65, 3
    s_andn2_b32 s7, s68, 3
    s_add_u32 s65, s65, s7
    s_lshl_b32 s65, s65, 17
    s_add_u32 s65, s65, s66
    s_add_u32 m0, s99, 0
    s_add_u32 s65, s65, 0
    buffer_load_dwordx4 v13, s[8:11], s65 offen offset:0 sc1 lds
    buffer_load_dwordx4 v13, s[8:11], s65 offen offset:1024 sc1 lds
    buffer_load_dwordx4 v13, s[8:11], s65 offen offset:2048 sc1 lds
    buffer_load_dwordx4 v13, s[8:11], s65 offen offset:3072 sc1 lds
    s_add_u32 s65, s68, 1
    s_and_b32 s65, s65, 3
    s_andn2_b32 s7, s68, 3
    s_add_u32 s65, s65, s7
    s_lshl_b32 s65, s65, 17
    s_add_u32 s65, s65, s66
    s_add_u32 m0, s99, 16384
    s_add_u32 s65, s65, 16384
    buffer_load_dwordx4 v13, s[8:11], s65 offen offset:0 sc1 lds
    buffer_load_dwordx4 v13, s[8:11], s65 offen offset:1024 sc1 lds
    buffer_load_dwordx4 v13, s[8:11], s65 offen offset:2048 sc1 lds
    buffer_load_dwordx4 v13, s[8:11], s65 offen offset:3072 sc1 lds
    s_setprio 0
    s_barrier
    s_add_u32 s65, s68, 2
    s_and_b32 s65, s65, 3
    s_andn2_b32 s7, s68, 3
    s_add_u32 s65, s65, s7
    s_lshl_b32 s65, s65, 17
    s_add_u32 s65, s65, s66
    s_add_u32 m0, s99, 32768
    s_add_u32 s65, s65, 0
    buffer_load_dwordx4 v13, s[8:11], s65 offen offset:0 sc1 lds
    buffer_load_dwordx4 v13, s[8:11], s65 offen offset:1024 sc1 lds
    buffer_load_dwordx4 v13, s[8:11], s65 offen offset:2048 sc1 lds
    buffer_load_dwordx4 v13, s[8:11], s65 offen offset:3072 sc1 lds
    s_add_u32 s65, s68, 2
    s_and_b32 s65, s65, 3
    s_andn2_b32 s7, s68, 3
    s_add_u32 s65, s65, s7
    s_lshl_b32 s65, s65, 17
    s_add_u32 s65, s65, s66
    s_add_u32 m0, s99, 49152
    s_add_u32 s65, s65, 16384
    buffer_load_dwordx4 v13, s[8:11], s65 offen offset:0 sc1 lds
    buffer_load_dwordx4 v13, s[8:11], s65 offen offset:1024 sc1 lds
    buffer_load_dwordx4 v13, s[8:11], s65 offen offset:2048 sc1 lds
    buffer_load_dwordx4 v13, s[8:11], s65 offen offset:3072 sc1 lds
    s_waitcnt vmcnt(8)
    s_branch L_adone
L_moe:
    s_sub_u32 s6, s62, s5
    s_cmp_lg_u32 s6, 3
    s_cbranch_scc1 L_idle
    s_mov_b32 s12, s48
    s_mov_b32 s13, s49
    s_mov_b32 s14, 0x21c000
    s_mov_b32 s15, 0x20000
    s_cmp_ge_u32 s3, 2
    s_cselect_b32 s12, s50, s12
    s_cselect_b32 s13, s51, s13
    s_mov_b32 s16, s52
    s_mov_b32 s17, s53
    s_mov_b32 s18, 0x21c000
    s_mov_b32 s19, 0x20000
    v_lshrrev_b32 v3, 2, v1
    v_mul_u32_u24 v3, 3456, v3
    v_and_b32 v4, 3, v1
    v_lshl_add_u32 v16, v4, 4, v3
    v_lshrrev_b32 v3, 3, v1
    v_mul_u32_u24 v3, 1280, v3
    v_and_b32 v4, 7, v1
    v_lshl_add_u32 v18, v4, 4, v3
    s_and_b32 s7, s3, 1
    s_mul_i32 s84, s7, 1105920
    s_lshl_b32 s6, s61, 6
    s_add_u32 s84, s84, s6
    s_lshl_b32 s85, s3, 13
    s_add_u32 s85, s85, 131072
    s_mul_i32 s86, s61, 40960
    s_lshl_b32 s6, s3, 7
    s_add_u32 s86, s86, s6
    s_add_u32 m0, s85, 0
    s_nop 0
    buffer_load_dwordx4 v16, s[12:15], s84 offen lds
    s_add_u32 s84, s84, 55296
    s_add_u32 m0, s85, 1024
    s_nop 0
    buffer_load_dwordx4 v16, s[12:15], s84 offen lds
    s_add_u32 s84, s84, 55296
    s_add_u32 m0, s85, 2048
    s_nop 0
    buffer_load_dwordx4 v16, s[12:15], s84 offen lds
    s_add_u32 s84, s84, 55296
    s_add_u32 m0, s85, 3072
    s_nop 0
    buffer_load_dwordx4 v16, s[12:15], s84 offen lds
    s_add_u32 s84, s84, 55296
    s_add_u32 m0, s85, 4096
    s_nop 0
    buffer_load_dwordx4 v16, s[12:15], s84 offen lds
    s_add_u32 s84, s84, 55296
    s_add_u32 m0, s85, 5120
    s_nop 0
    buffer_load_dwordx4 v16, s[12:15], s84 offen lds
    s_add_u32 s84, s84, 55296
    s_add_u32 m0, s85, 6144
    s_nop 0
    buffer_load_dwordx4 v16, s[12:15], s84 offen lds
    s_add_u32 s84, s84, 55296
    s_add_u32 m0, s85, 7168
    s_nop 0
    buffer_load_dwordx4 v16, s[12:15], s84 offen lds
    s_add_u32 s84, s84, 55296
    v_lshrrev_b32 v7, 4, v1
    v_and_b32 v2, 15, v1
    v_lshrrev_b32 v3, 2, v2
    v_lshl_add_u32 v8, v7, 3, v3
    v_lshlrev_b32 v8, 6, v8
    v_and_b32 v4, 3, v2
    v_lshl_add_u32 v8, v4, 3, v8
    v_add_u32 v17, s85, v8
    v_lshl_add_u32 v8, v7, 2, v3
    v_lshlrev_b32 v8, 7, v8
    v_lshl_add_u32 v8, v4, 3, v8
    s_add_u32 s6, s85, 4096
    v_add_u32 v19, s6, v8
    v_mul_u32_u24 v3, 2560, v2
    v_lshl_add_u32 v3, v7, 4, v3
    v_mov_b32 v4, 0x5000000
    v_cmp_gt_u32 vcc, 8, v2
    s_mul_i32 s87, s61, 20480
    s_lshl_b32 s7, s3, 8
    s_add_u32 s87, s87, s7
    s_add_u32 s87, s87, 2686976
    v_cndmask_b32 v20, v4, v3, vcc
    s_and_b32 s7, s3, 1
    s_mul_i32 s88, s7, 10240
    s_add_u32 s88, s88, 12582912
    s_waitcnt vmcnt(0) lgkmcnt(0)
    s_call_b64 s[82:83], L_pend
    s_barrier
    ds_read_b64_tr_b16 v[104:105], v17 offset:0
    ds_read_b64_tr_b16 v[106:107], v17 offset:256
    ds_read_b64_tr_b16 v[108:109], v17 offset:32
    ds_read_b64_tr_b16 v[110:111], v17 offset:288
    ds_read_b64_tr_b16 v[112:113], v17 offset:2048
    ds_read_b64_tr_b16 v[114:115], v17 offset:2304
    ds_read_b64_tr_b16 v[116:117], v17 offset:2080
    ds_read_b64_tr_b16 v[118:119], v17 offset:2336
    s_waitcnt lgkmcnt(0)
    ds_read_b64_tr_b16 v[120:121], v17 offset:4096
    ds_read_b64_tr_b16 v[122:123], v17 offset:4352
    ds_read_b64_tr_b16 v[124:125], v17 offset:4128
    ds_read_b64_tr_b16 v[126:127], v17 offset:4384
    ds_read_b64_tr_b16 v[128:129], v17 offset:6144
    ds_read_b64_tr_b16 v[130:131], v17 offset:6400
    ds_read_b64_tr_b16 v[132:133], v17 offset:6176
    ds_read_b64_tr_b16 v[134:135], v17 offset:6432
    s_waitcnt lgkmcnt(0)
    s_add_u32 m0, s85, 0
    s_nop 0
    buffer_load_dwordx4 v16, s[12:15], s84 offen lds
    s_add_u32 s84, s84, 55296
    s_add_u32 m0, s85, 1024
    s_nop 0
    buffer_load_dwordx4 v16, s[12:15], s84 offen lds
    s_add_u32 s84, s84, 55296
    s_add_u32 m0, s85, 2048
    s_nop 0
    buffer_load_dwordx4 v16, s[12:15], s84 offen lds
    s_add_u32 s84, s84, 55296
    s_add_u32 m0, s85, 3072
    s_nop 0
    buffer_load_dwordx4 v16, s[12:15], s84 offen lds
    s_add_u32 s84, s84, 55296
    s_add_u32 m0, s85, 4096
    s_nop 0
    buffer_load_dwordx4 v16, s[12:15], s84 offen lds
    s_add_u32 s84, s84, 55296
    s_add_u32 m0, s85, 5120
    s_nop 0
    buffer_load_dwordx4 v16, s[12:15], s84 offen lds
    s_add_u32 s84, s84, 55296
    s_add_u32 m0, s85, 6144
    s_nop 0
    buffer_load_dwordx4 v16, s[12:15], s84 offen lds
    s_add_u32 s84, s84, 55296
    s_add_u32 m0, s85, 7168
    s_nop 0
    buffer_load_dwordx4 v16, s[12:15], s84 offen lds
    s_add_u32 s84, s84, 55296
    s_call_b64 s[82:83], L_load
    s_add_i32 s62, s62, 1
    v_and_b32 v3, 7, v1
    v_lshlrev_b32 v3, 2, v3
    s_mov_b32 s72, 0x3a0000
    buffer_load_dword v51, v3, s[8:11], s72 offen sc1
    s_waitcnt vmcnt(0) lgkmcnt(0)
    s_call_b64 s[82:83], L_pend
    s_barrier
    ds_read_b64_tr_b16 v[136:137], v17 offset:0
    ds_read_b64_tr_b16 v[138:139], v17 offset:256
    ds_read_b64_tr_b16 v[140:141], v17 offset:32
    ds_read_b64_tr_b16 v[142:143], v17 offset:288
    ds_read_b64_tr_b16 v[144:145], v17 offset:2048
    ds_read_b64_tr_b16 v[146:147], v17 offset:2304
    ds_read_b64_tr_b16 v[148:149], v17 offset:2080
    ds_read_b64_tr_b16 v[150:151], v17 offset:2336
    s_waitcnt lgkmcnt(0)
    ds_read_b64_tr_b16 v[152:153], v17 offset:4096
    ds_read_b64_tr_b16 v[154:155], v17 offset:4352
    ds_read_b64_tr_b16 v[156:157], v17 offset:4128
    ds_read_b64_tr_b16 v[158:159], v17 offset:4384
    ds_read_b64_tr_b16 v[160:161], v17 offset:6144
    ds_read_b64_tr_b16 v[162:163], v17 offset:6400
    ds_read_b64_tr_b16 v[164:165], v17 offset:6176
    ds_read_b64_tr_b16 v[166:167], v17 offset:6432
    s_waitcnt lgkmcnt(0)
    s_add_u32 m0, s85, 0
    s_nop 0
    buffer_load_dwordx4 v16, s[12:15], s84 offen lds
    s_add_u32 s84, s84, 55296
    s_add_u32 m0, s85, 1024
    s_nop 0
    buffer_load_dwordx4 v16, s[12:15], s84 offen lds
    s_add_u32 s84, s84, 55296
    s_add_u32 m0, s85, 2048
    s_nop 0
    buffer_load_dwordx4 v16, s[12:15], s84 offen lds
    s_add_u32 s84, s84, 55296
    s_add_u32 m0, s85, 3072
    s_nop 0
    buffer_load_dwordx4 v16, s[12:15], s84 offen lds
    s_add_u32 s84, s84, 55296
    s_add_u32 m0, s85, 4096
    s_add_u32 s6, s86, 0
    buffer_load_dwordx4 v18, s[16:19], s6 offen lds
    s_add_u32 m0, s85, 5120
    s_add_u32 s6, s86, 10240
    buffer_load_dwordx4 v18, s[16:19], s6 offen lds
    s_add_u32 m0, s85, 6144
    s_add_u32 s6, s86, 20480
    buffer_load_dwordx4 v18, s[16:19], s6 offen lds
    s_add_u32 m0, s85, 7168
    s_add_u32 s6, s86, 30720
    buffer_load_dwordx4 v18, s[16:19], s6 offen lds
    s_add_u32 s86, s86, 512
    s_call_b64 s[82:83], L_load
    s_add_i32 s62, s62, 1
    v_cmp_le_i32 vcc, 0, v51
    s_cbranch_vccz L_idx_okm
    v_and_b32 v3, 7, v1
    v_lshlrev_b32 v3, 2, v3
    s_mov_b32 s72, 0x3a0000
    s_mov_b32 s79, 262144
L_poll_41:
    buffer_load_dword v51, v3, s[8:11], s72 offen sc1
    s_waitcnt vmcnt(0)
    v_cmp_le_i32 vcc, 0, v51
    s_cbranch_vccz L_polldone_42
    s_sleep 2
    s_sub_u32 s79, s79, 1
    s_cmp_lg_u32 s79, 0
    s_cbranch_scc1 L_poll_41
L_polldone_42:
L_idx_okm:
    buffer_load_dwordx4 v[64:67], v13, s[8:11], s88 offen sc1
    s_add_u32 s88, s88, 1024
    buffer_load_dwordx4 v[68:71], v13, s[8:11], s88 offen sc1
    s_add_u32 s88, s88, 1024
    buffer_load_dwordx4 v[72:75], v13, s[8:11], s88 offen sc1
    s_add_u32 s88, s88, 1024
    buffer_load_dwordx4 v[76:79], v13, s[8:11], s88 offen sc1
    s_add_u32 s88, s88, 1024
    buffer_load_dwordx4 v[80:83], v13, s[8:11], s88 offen sc1
    s_add_u32 s88, s88, 1024
    buffer_load_dwordx4 v[84:87], v13, s[8:11], s88 offen sc1
    s_add_u32 s88, s88, 1024
    buffer_load_dwordx4 v[88:91], v13, s[8:11], s88 offen sc1
    s_add_u32 s88, s88, 1024
    buffer_load_dwordx4 v[92:95], v13, s[8:11], s88 offen sc1
    s_add_u32 s88, s88, 1024
    buffer_load_dwordx4 v[96:99], v13, s[8:11], s88 offen sc1
    s_add_u32 s88, s88, 1024
    buffer_load_dwordx4 v[100:103], v13, s[8:11], s88 offen sc1
    s_add_u32 s88, s88, 1024
    s_waitcnt vmcnt(10) lgkmcnt(0)
    s_call_b64 s[82:83], L_pend
    s_barrier
    ds_read_b64_tr_b16 v[168:169], v17 offset:0
    ds_read_b64_tr_b16 v[170:171], v17 offset:256
    ds_read_b64_tr_b16 v[172:173], v17 offset:32
    ds_read_b64_tr_b16 v[174:175], v17 offset:288
    ds_read_b64_tr_b16 v[176:177], v17 offset:2048
    ds_read_b64_tr_b16 v[178:179], v17 offset:2304
    ds_read_b64_tr_b16 v[180:181], v17 offset:2080
    ds_read_b64_tr_b16 v[182:183], v17 offset:2336
    s_waitcnt lgkmcnt(0)
    ds_read_b64_tr_b16 v[32:33], v19 offset:0
    ds_read_b64_tr_b16 v[34:35], v19 offset:2048
    ds_read_b64_tr_b16 v[36:37], v19 offset:32
    ds_read_b64_tr_b16 v[38:39], v19 offset:2080
    ds_read_b64_tr_b16 v[40:41], v19 offset:64
    ds_read_b64_tr_b16 v[42:43], v19 offset:2112
    ds_read_b64_tr_b16 v[44:45], v19 offset:96
    ds_read_b64_tr_b16 v[46:47], v19 offset:2144
    s_waitcnt lgkmcnt(0)
    s_add_u32 m0, s85, 4096
    s_add_u32 s6, s86, 0
    buffer_load_dwordx4 v18, s[16:19], s6 offen lds
    s_add_u32 m0, s85, 5120
    s_add_u32 s6, s86, 10240
    buffer_load_dwordx4 v18, s[16:19], s6 offen lds
    s_add_u32 m0, s85, 6144
    s_add_u32 s6, s86, 20480
    buffer_load_dwordx4 v18, s[16:19], s6 offen lds
    s_add_u32 m0, s85, 7168
    s_add_u32 s6, s86, 30720
    buffer_load_dwordx4 v18, s[16:19], s6 offen lds
    s_add_u32 s86, s86, 512
    s_call_b64 s[82:83], L_load
    s_add_i32 s62, s62, 1
    s_waitcnt vmcnt(20)
    v_mfma_f32_16x16x32_bf16 v[24:27], v[104:107], v[64:67], 0
    v_mfma_f32_16x16x32_bf16 v[28:31], v[108:111], v[64:67], 0
    v_mfma_f32_16x16x32_bf16 v[24:27], v[112:115], v[68:71], v[24:27]
    v_mfma_f32_16x16x32_bf16 v[28:31], v[116:119], v[68:71], v[28:31]
    v_mfma_f32_16x16x32_bf16 v[24:27], v[120:123], v[72:75], v[24:27]
    v_mfma_f32_16x16x32_bf16 v[28:31], v[124:127], v[72:75], v[28:31]
    v_mfma_f32_16x16x32_bf16 v[24:27], v[128:131], v[76:79], v[24:27]
    v_mfma_f32_16x16x32_bf16 v[28:31], v[132:135], v[76:79], v[28:31]
    v_mfma_f32_16x16x32_bf16 v[24:27], v[136:139], v[80:83], v[24:27]
    v_mfma_f32_16x16x32_bf16 v[28:31], v[140:143], v[80:83], v[28:31]
    v_mfma_f32_16x16x32_bf16 v[24:27], v[144:147], v[84:87], v[24:27]
    v_mfma_f32_16x16x32_bf16 v[28:31], v[148:151], v[84:87], v[28:31]
    v_mfma_f32_16x16x32_bf16 v[24:27], v[152:155], v[88:91], v[24:27]
    v_mfma_f32_16x16x32_bf16 v[28:31], v[156:159], v[88:91], v[28:31]
    v_mfma_f32_16x16x32_bf16 v[24:27], v[160:163], v[92:95], v[24:27]
    v_mfma_f32_16x16x32_bf16 v[28:31], v[164:167], v[92:95], v[28:31]
    v_mfma_f32_16x16x32_bf16 v[24:27], v[168:171], v[96:99], v[24:27]
    v_mfma_f32_16x16x32_bf16 v[28:31], v[172:175], v[96:99], v[28:31]
    v_mfma_f32_16x16x32_bf16 v[24:27], v[176:179], v[100:103], v[24:27]
    v_mfma_f32_16x16x32_bf16 v[28:31], v[180:183], v[100:103], v[28:31]
    v_add_u32 v10, s85, v13
    s_nop 7
    ds_write_b128 v10, v[24:27]
    ds_write_b128 v10, v[28:31] offset:1024
    s_waitcnt vmcnt(0) lgkmcnt(0)
    s_call_b64 s[82:83], L_pend
    s_barrier
    ds_read_b64_tr_b16 v[240:241], v19 offset:0
    ds_read_b64_tr_b16 v[242:243], v19 offset:2048
    ds_read_b64_tr_b16 v[244:245], v19 offset:32
    ds_read_b64_tr_b16 v[246:247], v19 offset:2080
    ds_read_b64_tr_b16 v[248:249], v19 offset:64
    ds_read_b64_tr_b16 v[250:251], v19 offset:2112
    ds_read_b64_tr_b16 v[252:253], v19 offset:96
    ds_read_b64_tr_b16 v[254:255], v19 offset:2144
    v_add_u32 v10, 131072, v13
    s_waitcnt lgkmcnt(0)
    ds_read_b128 v[184:187], v10 offset:0
    ds_read_b128 v[188:191], v10 offset:1024
    ds_read_b128 v[192:195], v10 offset:8192
    ds_read_b128 v[196:199], v10 offset:9216
    ds_read_b128 v[200:203], v10 offset:16384
    ds_read_b128 v[204:207], v10 offset:17408
    ds_read_b128 v[208:211], v10 offset:24576
    ds_read_b128 v[212:215], v10 offset:25600
    s_cmp_ge_u32 s3, 2
    s_cbranch_scc1 L_moe4b
    s_add_u32 m0, s85, 4096
    s_add_u32 s6, s86, 0
    buffer_load_dwordx4 v18, s[16:19], s6 offen lds
    s_add_u32 m0, s85, 5120
    s_add_u32 s6, s86, 10240
    buffer_load_dwordx4 v18, s[16:19], s6 offen lds
    s_add_u32 m0, s85, 6144
    s_add_u32 s6, s86, 20480
    buffer_load_dwordx4 v18, s[16:19], s6 offen lds
    s_add_u32 m0, s85, 7168
    s_add_u32 s6, s86, 30720
    buffer_load_dwordx4 v18, s[16:19], s6 offen lds
    s_add_u32 s86, s86, 512
L_moe4b:
    s_call_b64 s[82:83], L_load
    s_add_i32 s62, s62, 1
    s_waitcnt lgkmcnt(0)
    s_mov_b32 s6, 0xbfb8aa3b
    v_add_f32 v184, v184, v192
    v_add_f32 v200, v200, v208
    v_add_f32 v185, v185, v193
    v_add_f32 v201, v201, v209
    v_cvt_pk_bf16_f32 v185, v184, v185
    v_lshlrev_b32 v184, 16, v185
    v_and_b32 v185, 0xffff0000, v185
    v_cvt_pk_bf16_f32 v201, v200, v201
    v_lshlrev_b32 v200, 16, v201
    v_and_b32 v201, 0xffff0000, v201
    v_mul_f32 v2, s6, v184
    v_mul_f32 v3, s6, v185
    v_exp_f32 v2, v2
    v_exp_f32 v3, v3
    s_nop 0
    v_add_f32 v2, 1.0, v2
    v_add_f32 v3, 1.0, v3
    v_rcp_f32 v2, v2
    v_rcp_f32 v3, v3
    s_nop 0
    v_mul_f32 v184, v184, v2
    v_mul_f32 v185, v185, v3
    v_cvt_pk_bf16_f32 v185, v184, v185
    v_lshlrev_b32 v184, 16, v185
    v_and_b32 v185, 0xffff0000, v185
    v_mul_f32 v184, v184, v200
    v_mul_f32 v185, v185, v201
    v_cvt_pk_bf16_f32 v24, v184, v185
    v_add_f32 v186, v186, v194
    v_add_f32 v202, v202, v210
    v_add_f32 v187, v187, v195
    v_add_f32 v203, v203, v211
    v_cvt_pk_bf16_f32 v187, v186, v187
    v_lshlrev_b32 v186, 16, v187
    v_and_b32 v187, 0xffff0000, v187
    v_cvt_pk_bf16_f32 v203, v202, v203
    v_lshlrev_b32 v202, 16, v203
    v_and_b32 v203, 0xffff0000, v203
    v_mul_f32 v2, s6, v186
    v_mul_f32 v3, s6, v187
    v_exp_f32 v2, v2
    v_exp_f32 v3, v3
    s_nop 0
    v_add_f32 v2, 1.0, v2
    v_add_f32 v3, 1.0, v3
    v_rcp_f32 v2, v2
    v_rcp_f32 v3, v3
    s_nop 0
    v_mul_f32 v186, v186, v2
    v_mul_f32 v187, v187, v3
    v_cvt_pk_bf16_f32 v187, v186, v187
    v_lshlrev_b32 v186, 16, v187
    v_and_b32 v187, 0xffff0000, v187
    v_mul_f32 v186, v186, v202
    v_mul_f32 v187, v187, v203
    v_cvt_pk_bf16_f32 v25, v186, v187
    v_add_f32 v188, v188, v196
    v_add_f32 v204, v204, v212
    v_add_f32 v189, v189, v197
    v_add_f32 v205, v205, v213
    v_cvt_pk_bf16_f32 v189, v188, v189
    v_lshlrev_b32 v188, 16, v189
    v_and_b32 v189, 0xffff0000, v189
    v_cvt_pk_bf16_f32 v205, v204, v205
    v_lshlrev_b32 v204, 16, v205
    v_and_b32 v205, 0xffff0000, v205
    v_mul_f32 v2, s6, v188
    v_mul_f32 v3, s6, v189
    v_exp_f32 v2, v2
    v_exp_f32 v3, v3
    s_nop 0
    v_add_f32 v2, 1.0, v2
    v_add_f32 v3, 1.0, v3
    v_rcp_f32 v2, v2
    v_rcp_f32 v3, v3
    s_nop 0
    v_mul_f32 v188, v188, v2
    v_mul_f32 v189, v189, v3
    v_cvt_pk_bf16_f32 v189, v188, v189
    v_lshlrev_b32 v188, 16, v189
    v_and_b32 v189, 0xffff0000, v189
    v_mul_f32 v188, v188, v204
    v_mul_f32 v189, v189, v205
    v_cvt_pk_bf16_f32 v26, v188, v189
    v_add_f32 v190, v190, v198
    v_add_f32 v206, v206, v214
    v_add_f32 v191, v191, v199
    v_add_f32 v207, v207, v215
    v_cvt_pk_bf16_f32 v191, v190, v191
    v_lshlrev_b32 v190, 16, v191
    v_and_b32 v191, 0xffff0000, v191
    v_cvt_pk_bf16_f32 v207, v206, v207
    v_lshlrev_b32 v206, 16, v207
    v_and_b32 v207, 0xffff0000, v207
    v_mul_f32 v2, s6, v190
    v_mul_f32 v3, s6, v191
    v_exp_f32 v2, v2
    v_exp_f32 v3, v3
    s_nop 0
    v_add_f32 v2, 1.0, v2
    v_add_f32 v3, 1.0, v3
    v_rcp_f32 v2, v2
    v_rcp_f32 v3, v3
    s_nop 0
    v_mul_f32 v190, v190, v2
    v_mul_f32 v191, v191, v3
    v_cvt_pk_bf16_f32 v191, v190, v191
    v_lshlrev_b32 v190, 16, v191
    v_and_b32 v191, 0xffff0000, v191
    v_mul_f32 v190, v190, v206
    v_mul_f32 v191, v191, v207
    v_cvt_pk_bf16_f32 v27, v190, v191
    s_nop 1
    v_mfma_f32_16x16x32_bf16 v[216:219], v[32:35], v[24:27], 0
    v_mfma_f32_16x16x32_bf16 v[220:223], v[36:39], v[24:27], 0
    v_mfma_f32_16x16x32_bf16 v[224:227], v[40:43], v[24:27], 0
    v_mfma_f32_16x16x32_bf16 v[228:231], v[44:47], v[24:27], 0
    s_nop 7
    buffer_store_dwordx4 v[216:219], v20, s[8:11], s87 offen offset:0 sc1
    buffer_store_dwordx4 v[220:223], v20, s[8:11], s87 offen offset:64 sc1
    buffer_store_dwordx4 v[224:227], v20, s[8:11], s87 offen offset:128 sc1
    buffer_store_dwordx4 v[228:231], v20, s[8:11], s87 offen offset:192 sc1
    s_nop 1
    s_waitcnt vmcnt(4) lgkmcnt(0)
    s_call_b64 s[82:83], L_pend
    s_barrier
    s_call_b64 s[82:83], L_load
    s_add_i32 s62, s62, 1
    v_mfma_f32_16x16x32_bf16 v[216:219], v[240:243], v[24:27], 0
    v_mfma_f32_16x16x32_bf16 v[220:223], v[244:247], v[24:27], 0
    v_mfma_f32_16x16x32_bf16 v[224:227], v[248:251], v[24:27], 0
    v_mfma_f32_16x16x32_bf16 v[228:231], v[252:255], v[24:27], 0
    s_nop 7
    buffer_store_dwordx4 v[216:219], v20, s[8:11], s87 offen offset:1024 sc1
    buffer_store_dwordx4 v[220:223], v20, s[8:11], s87 offen offset:1088 sc1
    buffer_store_dwordx4 v[224:227], v20, s[8:11], s87 offen offset:1152 sc1
    buffer_store_dwordx4 v[228:231], v20, s[8:11], s87 offen offset:1216 sc1
    s_nop 1
    s_cmp_ge_u32 s3, 2
    s_cbranch_scc1 L_moe5b
    ds_read_b64_tr_b16 v[32:33], v19 offset:0
    ds_read_b64_tr_b16 v[34:35], v19 offset:2048
    ds_read_b64_tr_b16 v[36:37], v19 offset:32
    ds_read_b64_tr_b16 v[38:39], v19 offset:2080
    ds_read_b64_tr_b16 v[40:41], v19 offset:64
    ds_read_b64_tr_b16 v[42:43], v19 offset:2112
    ds_read_b64_tr_b16 v[44:45], v19 offset:96
    ds_read_b64_tr_b16 v[46:47], v19 offset:2144
    s_waitcnt lgkmcnt(0)
    v_mfma_f32_16x16x32_bf16 v[216:219], v[32:35], v[24:27], 0
    v_mfma_f32_16x16x32_bf16 v[220:223], v[36:39], v[24:27], 0
    v_mfma_f32_16x16x32_bf16 v[224:227], v[40:43], v[24:27], 0
    v_mfma_f32_16x16x32_bf16 v[228:231], v[44:47], v[24:27], 0
    s_nop 7
    buffer_store_dwordx4 v[216:219], v20, s[8:11], s87 offen offset:2048 sc1
    buffer_store_dwordx4 v[220:223], v20, s[8:11], s87 offen offset:2112 sc1
    buffer_store_dwordx4 v[224:227], v20, s[8:11], s87 offen offset:2176 sc1
    buffer_store_dwordx4 v[228:231], v20, s[8:11], s87 offen offset:2240 sc1
    s_nop 1
L_moe5b:
    s_waitcnt vmcnt(4) lgkmcnt(0)
    s_call_b64 s[82:83], L_pend
    s_barrier
    s_waitcnt vmcnt(0)
    s_lshl_b32 s6, s61, 5
    s_add_u32 s6, s6, s3
    s_lshl_b32 s6, s6, 2
    s_add_u32 s6, s6, 15859712
    v_mov_b32 v2, 1
    v_mov_b32 v3, 0x5000000
    v_writelane_b32 v3, s6, 0
    buffer_store_dword v2, v3, s[8:11], 0 offen sc1
    s_call_b64 s[82:83], L_load
    s_add_i32 s62, s62, 1
    s_branch L_idle
L_top:
    s_mov_b32 s6, 0x280000
    v_lshrrev_b32 v2, 1, v1
    v_and_b32 v3, 1, v1
    v_lshlrev_b32 v3, 4, v3
    v_lshl_add_u32 v2, v2, 7, v3
    buffer_load_dwordx4 v[64:67], v2, s[8:11], s6 offen sc1
    s_add_u32 s6, s6, 4096
    buffer_load_dwordx4 v[68:71], v2, s[8:11], s6 offen sc1
    s_add_u32 s6, s6, 4096
    buffer_load_dwordx4 v[72:75], v2, s[8:11], s6 offen sc1
    s_add_u32 s6, s6, 4096
    buffer_load_dwordx4 v[76:79], v2, s[8:11], s6 offen sc1
    s_add_u32 s6, s6, 4096
    buffer_load_dwordx4 v[80:83], v2, s[8:11], s6 offen sc1
    s_add_u32 s6, s6, 4096
    buffer_load_dwordx4 v[84:87], v2, s[8:11], s6 offen sc1
    s_add_u32 s6, s6, 4096
    buffer_load_dwordx4 v[88:91], v2, s[8:11], s6 offen sc1
    s_add_u32 s6, s6, 4096
    buffer_load_dwordx4 v[92:95], v2, s[8:11], s6 offen sc1
    s_add_u32 s6, s6, 4096
    s_waitcnt vmcnt(0)
    v_mov_b32 v24, 0
    s_mov_b32 s7, 0
    s_mov_b32 s84, 0
L_top_l:
    v_max3_u32 v4, v64, v65, v66
    v_max3_u32 v5, v67, v68, v69
    v_max3_u32 v4, v4, v70, v71
    v_max3_u32 v5, v5, v72, v73
    v_max3_u32 v4, v4, v74, v75
    v_max3_u32 v5, v5, v76, v77
    v_max3_u32 v4, v4, v78, v79
    v_max3_u32 v5, v5, v80, v81
    v_max3_u32 v4, v4, v82, v83
    v_max3_u32 v5, v5, v84, v85
    v_max3_u32 v4, v4, v86, v87
    v_max3_u32 v5, v5, v88, v89
    v_max3_u32 v4, v4, v90, v91
    v_max3_u32 v5, v5, v92, v93
    v_max3_u32 v4, v4, v94, v95
    v_max_u32 v4, v4, v5
    s_nop 1
    v_max_u32_dpp v4, v4, v4 quad_perm:[1,0,3,2] row_mask:0xf bank_mask:0xf
    s_nop 1
    v_max_u32_dpp v4, v4, v4 quad_perm:[2,3,0,1] row_mask:0xf bank_mask:0xf
    s_nop 1
    v_max_u32_dpp v4, v4, v4 row_half_mirror row_mask:0xf bank_mask:0xf
    s_nop 1
    v_max_u32_dpp v4, v4, v4 row_mirror row_mask:0xf bank_mask:0xf
    s_nop 1
    v_max_u32_dpp v4, v4, v4 row_bcast:15 row_mask:0xa bank_mask:0xf
    s_nop 1
    v_max_u32_dpp v4, v4, v4 row_bcast:31 row_mask:0xc bank_mask:0xf
    s_nop 1
    v_readlane_b32 s6, v4, 63
    s_mov_b32 m0, s7
    s_nop 3
    s_add_u32 s84, s84, s6
    v_writelane_b32 v24, s84, m0
    v_subrev_u32 v64, s6, v64
    v_subrev_u32 v65, s6, v65
    v_subrev_u32 v66, s6, v66
    v_subrev_u32 v67, s6, v67
    v_subrev_u32 v68, s6, v68
    v_subrev_u32 v69, s6, v69
    v_subrev_u32 v70, s6, v70
    v_subrev_u32 v71, s6, v71
    v_subrev_u32 v72, s6, v72
    v_subrev_u32 v73, s6, v73
    v_subrev_u32 v74, s6, v74
    v_subrev_u32 v75, s6, v75
    v_subrev_u32 v76, s6, v76
    v_subrev_u32 v77, s6, v77
    v_subrev_u32 v78, s6, v78
    v_subrev_u32 v79, s6, v79
    v_subrev_u32 v80, s6, v80
    v_subrev_u32 v81, s6, v81
    v_subrev_u32 v82, s6, v82
    v_subrev_u32 v83, s6, v83
    v_subrev_u32 v84, s6, v84
    v_subrev_u32 v85, s6, v85
    v_subrev_u32 v86, s6, v86
    v_subrev_u32 v87, s6, v87
    v_subrev_u32 v88, s6, v88
    v_subrev_u32 v89, s6, v89
    v_subrev_u32 v90, s6, v90
    v_subrev_u32 v91, s6, v91
    v_subrev_u32 v92, s6, v92
    v_subrev_u32 v93, s6, v93
    v_subrev_u32 v94, s6, v94
    v_subrev_u32 v95, s6, v95
    s_add_u32 s7, s7, 1
    s_cmp_lt_u32 s7, 8
    s_cbranch_scc1 L_top_l
    v_and_b32 v2, 7, v1
    v_lshlrev_b32 v2, 2, v2
    ds_bpermute_b32 v4, v2, v24
    s_waitcnt lgkmcnt(0)
    v_and_b32 v4, 0x7ff, v4
    v_sub_u32 v4, 0x7ff, v4
    v_lshrrev_b32 v5, 4, v4
    v_mul_u32_u24 v5, 20480, v5
    v_and_b32 v4, 15, v4
    v_lshl_add_u32 v5, v4, 4, v5
    v_lshrrev_b32 v7, 4, v1
    v_lshl_add_u32 v5, v7, 8, v5
    v_mov_b32 v6, 0x5000000
    v_and_b32 v2, 8, v1
    v_cmp_eq_u32 vcc, 0, v2
    s_mov_b32 s6, 0
    s_nop 0
    v_cndmask_b32 v5, v6, v5, vcc
    buffer_load_dwordx4 v[64:67], v5, s[8:11], s6 offen offset:0 sc1
    buffer_load_dwordx4 v[68:71], v5, s[8:11], s6 offen offset:1024 sc1
    buffer_load_dwordx4 v[72:75], v5, s[8:11], s6 offen offset:2048 sc1
    buffer_load_dwordx4 v[76:79], v5, s[8:11], s6 offen offset:3072 sc1
    s_add_u32 s6, s6, 4096
    buffer_load_dwordx4 v[80:83], v5, s[8:11], s6 offen offset:0 sc1
    buffer_load_dwordx4 v[84:87], v5, s[8:11], s6 offen offset:1024 sc1
    buffer_load_dwordx4 v[88:91], v5, s[8:11], s6 offen offset:2048 sc1
    buffer_load_dwordx4 v[92:95], v5, s[8:11], s6 offen offset:3072 sc1
    s_add_u32 s6, s6, 4096
    buffer_load_dwordx4 v[96:99], v5, s[8:11], s6 offen offset:0 sc1
    buffer_load_dwordx4 v[100:103], v5, s[8:11], s6 offen offset:1024 sc1
    buffer_load_dwordx4 v[104:107], v5, s[8:11], s6 offen offset:2048 sc1
    buffer_load_dwordx4 v[108:111], v5, s[8:11], s6 offen offset:3072 sc1
    s_add_u32 s6, s6, 4096
    buffer_load_dwordx4 v[112:115], v5, s[8:11], s6 offen offset:0 sc1
    buffer_load_dwordx4 v[116:119], v5, s[8:11], s6 offen offset:1024 sc1
    buffer_load_dwordx4 v[120:123], v5, s[8:11], s6 offen offset:2048 sc1
    buffer_load_dwordx4 v[124:127], v5, s[8:11], s6 offen offset:3072 sc1
    s_add_u32 s6, s6, 4096
    buffer_load_dwordx4 v[128:131], v5, s[8:11], s6 offen offset:0 sc1
    buffer_load_dwordx4 v[132:135], v5, s[8:11], s6 offen offset:1024 sc1
    buffer_load_dwordx4 v[136:139], v5, s[8:11], s6 offen offset:2048 sc1
    buffer_load_dwordx4 v[140:143], v5, s[8:11], s6 offen offset:3072 sc1
    s_waitcnt vmcnt(20)
    s_call_b64 s[82:83], L_pend
    s_barrier
    s_waitcnt vmcnt(0)
    s_mov_b32 s6, 0xc00000
    buffer_store_dwordx4 v[64:67], v13, s[8:11], s6 offen offset:0 sc1
    buffer_store_dwordx4 v[68:71], v13, s[8:11], s6 offen offset:1024 sc1
    buffer_store_dwordx4 v[72:75], v13, s[8:11], s6 offen offset:2048 sc1
    buffer_store_dwordx4 v[76:79], v13, s[8:11], s6 offen offset:3072 sc1
    s_add_u32 s6, s6, 4096
    buffer_store_dwordx4 v[80:83], v13, s[8:11], s6 offen offset:0 sc1
    buffer_store_dwordx4 v[84:87], v13, s[8:11], s6 offen offset:1024 sc1
    buffer_store_dwordx4 v[88:91], v13, s[8:11], s6 offen offset:2048 sc1
    buffer_store_dwordx4 v[92:95], v13, s[8:11], s6 offen offset:3072 sc1
    s_add_u32 s6, s6, 4096
    buffer_store_dwordx4 v[96:99], v13, s[8:11], s6 offen offset:0 sc1
    buffer_store_dwordx4 v[100:103], v13, s[8:11], s6 offen offset:1024 sc1
    buffer_store_dwordx4 v[104:107], v13, s[8:11], s6 offen offset:2048 sc1
    buffer_store_dwordx4 v[108:111], v13, s[8:11], s6 offen offset:3072 sc1
    s_add_u32 s6, s6, 4096
    buffer_store_dwordx4 v[112:115], v13, s[8:11], s6 offen offset:0 sc1
    buffer_store_dwordx4 v[116:119], v13, s[8:11], s6 offen offset:1024 sc1
    buffer_store_dwordx4 v[120:123], v13, s[8:11], s6 offen offset:2048 sc1
    buffer_store_dwordx4 v[124:127], v13, s[8:11], s6 offen offset:3072 sc1
    s_add_u32 s6, s6, 4096
    buffer_store_dwordx4 v[128:131], v13, s[8:11], s6 offen offset:0 sc1
    buffer_store_dwordx4 v[132:135], v13, s[8:11], s6 offen offset:1024 sc1
    buffer_store_dwordx4 v[136:139], v13, s[8:11], s6 offen offset:2048 sc1
    buffer_store_dwordx4 v[140:143], v13, s[8:11], s6 offen offset:3072 sc1
    s_call_b64 s[82:83], L_load
    s_add_i32 s62, s62, 1
    s_waitcnt vmcnt(16)
    v_or_b32 v24, 0x80000000, v24
    v_lshlrev_b32 v5, 2, v1
    v_mov_b32 v6, 0x5000000
    v_cmp_gt_u32 vcc, 8, v1
    s_mov_b32 s6, 0x3a0000
    s_nop 0
    v_cndmask_b32 v5, v6, v5, vcc
    buffer_store_dword v24, v5, s[8:11], s6 offen sc1
    s_branch L_idle
L_back_9_h:
    v_cmp_ne_u32 vcc, 0, v62
    s_cbranch_vccz L_back_9_n
    s_call_b64 s[80:81], L_rare0
L_back_9_n:
    s_branch L_back_9
L_back_10_h:
    v_cmp_ne_u32 vcc, 0, v62
    s_cbranch_vccz L_back_10_n
    s_call_b64 s[80:81], L_rare1
    v_exp_f32 v58, v64
    v_exp_f32 v59, v65
L_back_10_n:
    s_cmp_lt_i32 s64, 0
    s_cbranch_scc1 L_tail1
    s_cmp_gt_i32 s64, 0
    s_cbranch_scc1 L_back_10
    s_call_b64 s[82:83], L_mask
    s_branch L_back_10
L_back_11_h:
    v_cmp_ne_u32 vcc, 0, v62
    s_cbranch_vccz L_back_11_n
    s_call_b64 s[80:81], L_rare0
    v_exp_f32 v58, v80
    v_exp_f32 v59, v81
L_back_11_n:
    s_cmp_lt_i32 s64, 0
    s_cbranch_scc1 L_tail2
    s_cmp_gt_i32 s64, 0
    s_cbranch_scc1 L_back_11
    s_call_b64 s[82:83], L_mask
    s_branch L_back_11
L_back_12_h:
    v_cmp_ne_u32 vcc, 0, v62
    s_cbranch_vccz L_back_12_n
    s_call_b64 s[80:81], L_rare1
    v_exp_f32 v58, v64
    v_exp_f32 v59, v65
L_back_12_n:
    s_cmp_lt_i32 s64, 0
    s_cbranch_scc1 L_tail3
    s_cmp_gt_i32 s64, 0
    s_cbranch_scc1 L_back_12
    s_call_b64 s[82:83], L_mask
    s_branch L_back_12
L_ldback_13_c:
    s_waitcnt vmcnt(0) lgkmcnt(0)
    s_call_b64 s[82:83], L_pend
    s_barrier
    s_call_b64 s[82:83], L_load
    s_branch L_ldback_13
L_back_14_h:
    v_cmp_ne_u32 vcc, 0, v62
    s_cbranch_vccz L_back_14_n
    s_call_b64 s[80:81], L_rare0
    v_exp_f32 v58, v80
    v_exp_f32 v59, v81
L_back_14_n:
    s_cmp_lt_i32 s64, 0
    s_cbranch_scc1 L_tail0
    s_cmp_gt_i32 s64, 0
    s_cbranch_scc1 L_st0
    s_call_b64 s[82:83], L_mask
    s_branch L_st0
L_back_15_h:
    v_cmp_ne_u32 vcc, 0, v62
    s_cbranch_vccz L_back_15_n
    s_call_b64 s[80:81], L_rare1
L_back_15_n:
    s_branch L_back_15
L_back_16_h:
    v_cmp_ne_u32 vcc, 0, v62
    s_cbranch_vccz L_back_16_n
    s_call_b64 s[80:81], L_rare0
L_back_16_n:
    s_branch L_back_16
L_back_17_h:
    v_cmp_ne_u32 vcc, 0, v62
    s_cbranch_vccz L_back_17_n
    s_call_b64 s[80:81], L_rare1
L_back_17_n:
    s_branch L_back_17
L_back_20_h:
    v_cmp_ne_u32 vcc, 0, v62
    s_cbranch_vccz L_back_20_n
    s_call_b64 s[80:81], L_rare0
L_back_20_n:
    s_branch L_back_20
L_load:
    s_bitcmp1_b32 s89, 0
    s_cbranch_scc0 L_load_r
    s_add_u32 s77, s77, 32768
    s_xor_b32 s78, s78, 0x10000
    s_add_i32 s73, s62, 1
    s_cmp_gt_i32 s73, s63
    s_cbranch_scc1 L_load_r
    s_cmp_eq_i32 s73, s63
    s_cbranch_scc1 L_load_v
    s_cmp_lg_i32 s73, 3
    s_cbranch_scc1 L_load_k
    v_cmp_gt_u32 vcc, 2, v12
    s_cbranch_vccz L_load_k
    s_lshl_b32 s7, s4, 10
    s_add_u32 s7, s7, 3866624
    v_lshrrev_b32 v2, 3, v1
    v_and_b32 v3, 7, v1
    v_lshlrev_b32 v3, 2, v3
    v_lshl_add_u32 v3, v2, 7, v3
    s_mov_b32 s79, 262144
L_poll_48:
    buffer_load_dword v2, v3, s[8:11], s7 offen sc1
    s_waitcnt vmcnt(0)
    v_cmp_gt_u32 vcc, 2, v2
    s_cbranch_vccz L_polldone_49
    s_sleep 2
    s_sub_u32 s79, s79, 1
    s_cmp_lg_u32 s79, 0
    s_cbranch_scc1 L_poll_48
L_polldone_49:
L_load_k:
    s_lshl_b32 s6, s76, 13
    s_add_u32 s6, s6, s78
    s_add_u32 m0, s6, 0
    s_add_u32 s7, s77, 0
    buffer_load_dwordx4 v49, s[8:11], s7 offen offset:0 sc1 lds
    buffer_load_dwordx4 v49, s[8:11], s7 offen offset:1024 sc1 lds
    buffer_load_dwordx4 v49, s[8:11], s7 offen offset:2048 sc1 lds
    buffer_load_dwordx4 v49, s[8:11], s7 offen offset:3072 sc1 lds
    s_lshl_b32 s6, s76, 13
    s_add_u32 s6, s6, s78
    s_add_u32 m0, s6, 4096
    s_add_u32 s7, s77, 4096
    buffer_load_dwordx4 v49, s[8:11], s7 offen offset:0 sc1 lds
    buffer_load_dwordx4 v49, s[8:11], s7 offen offset:1024 sc1 lds
    buffer_load_dwordx4 v49, s[8:11], s7 offen offset:2048 sc1 lds
    buffer_load_dwordx4 v49, s[8:11], s7 offen offset:3072 sc1 lds
    s_lshl_b32 s6, s76, 12
    s_add_u32 s6, s6, s78
    s_add_u32 m0, s6, 49152
    s_add_u32 s7, s77, 524288
    buffer_load_dwordx4 v50, s[8:11], s7 offen offset:0 sc1 lds
    buffer_load_dwordx4 v50, s[8:11], s7 offen offset:1024 sc1 lds
    buffer_load_dwordx4 v50, s[8:11], s7 offen offset:2048 sc1 lds
    buffer_load_dwordx4 v50, s[8:11], s7 offen offset:3072 sc1 lds
L_load_v:
    s_lshl_b32 s6, s76, 12
    s_add_u32 s6, s6, s78
    s_add_u32 m0, s6, 32768
    s_add_u32 s7, s77, 507904
    buffer_load_dwordx4 v50, s[8:11], s7 offen offset:0 sc1 lds
    buffer_load_dwordx4 v50, s[8:11], s7 offen offset:1024 sc1 lds
    buffer_load_dwordx4 v50, s[8:11], s7 offen offset:2048 sc1 lds
    buffer_load_dwordx4 v50, s[8:11], s7 offen offset:3072 sc1 lds
    s_cmp_eq_i32 s73, s63
    s_cbranch_scc1 L_xa
    s_cmp_lg_i32 s73, 2
    s_cbranch_scc1 L_nolook
    s_lshl_b32 s7, s4, 10
    s_add_u32 s7, s7, 3866624
    v_lshrrev_b32 v2, 3, v1
    v_and_b32 v3, 7, v1
    v_lshlrev_b32 v3, 2, v3
    v_lshl_add_u32 v3, v2, 7, v3
    buffer_load_dword v12, v3, s[8:11], s7 offen sc1
L_nolook:
    s_cmp_lt_u32 s5, 4
    s_cbranch_scc1 L_load_r
    s_sub_i32 s6, s62, 0
    s_cmp_gt_u32 s6, 4
    s_cbranch_scc1 L_wb
    s_cbranch_scc0 L_wsel
L_wb:
    s_sub_i32 s79, s73, 1
    s_cmp_lt_u32 s79, 2
    s_cbranch_scc1 L_x3
L_load_r:
    s_setpc_b64 s[82:83]
L_pend:
    s_bitcmp1_b32 s89, 1
    s_cbranch_scc0 L_load_a
    s_cmp_lt_i32 s62, 0
    s_cbranch_scc1 L_load_a
    s_lshl_b32 s6, s4, 3
    s_add_u32 s6, s6, s5
    s_lshl_b32 s6, s6, 5
    s_add_u32 s6, s6, s3
    s_lshl_b32 s6, s6, 2
    s_add_u32 s6, s6, 3866624
    v_mov_b32 v2, 2
    v_mov_b32 v3, 0x5000000
    v_writelane_b32 v3, s6, 0
    buffer_store_dword v2, v3, s[8:11], 0 offen sc1
    s_and_b32 s89, s89, 1
L_load_a:
    s_setpc_b64 s[82:83]
L_wsel:
    s_lshr_b32 s7, s6, 1
    s_lshl_b32 s91, s2, 1
    s_add_u32 s91, s91, s7
    s_sub_u32 s91, s91, 256
    s_cmp_eq_u32 s6, 4
    s_cbranch_scc1 L_w2
    s_bitcmp1_b32 s6, 0
    s_cbranch_scc1 L_w1
L_w0:
    s_mov_b32 s28, s42
    s_mov_b32 s29, s43
    s_mov_b32 s30, 0x500000
    s_mov_b32 s31, 0x20000
    s_lshr_b32 s75, s91, 1
    s_mul_i32 s75, s75, 40960
    s_and_b32 s6, s91, 1
    s_mul_i32 s6, s6, 640
    s_add_u32 s75, s75, s6
    s_movk_i32 s7, 1639
    s_mul_i32 s74, s76, 5120
    s_add_u32 s74, s74, 141312
    s_mul_i32 s6, s76, 320
    v_add_u32 v9, s6, v1
    v_add_u32 v2, 0, v9
    v_mul_lo_u32 v3, v2, s7
    v_lshrrev_b32 v3, 16, v3
    v_mul_u32_u24 v4, 40, v3
    v_sub_u32 v4, v2, v4
    v_mul_u32_u24 v3, 1280, v3
    v_lshl_add_u32 v3, v4, 4, v3
    s_add_u32 m0, s74, 0
    s_nop 0
    buffer_load_dwordx4 v3, s[28:31], s75 offen nt lds
    v_add_u32 v2, 64, v9
    v_mul_lo_u32 v3, v2, s7
    v_lshrrev_b32 v3, 16, v3
    v_mul_u32_u24 v4, 40, v3
    v_sub_u32 v4, v2, v4
    v_mul_u32_u24 v3, 1280, v3
    v_lshl_add_u32 v3, v4, 4, v3
    s_add_u32 m0, s74, 1024
    s_nop 0
    buffer_load_dwordx4 v3, s[28:31], s75 offen nt lds
    v_add_u32 v2, 128, v9
    v_mul_lo_u32 v3, v2, s7
    v_lshrrev_b32 v3, 16, v3
    v_mul_u32_u24 v4, 40, v3
    v_sub_u32 v4, v2, v4
    v_mul_u32_u24 v3, 1280, v3
    v_lshl_add_u32 v3, v4, 4, v3
    s_add_u32 m0, s74, 2048
    s_nop 0
    buffer_load_dwordx4 v3, s[28:31], s75 offen nt lds
    v_add_u32 v2, 192, v9
    v_mul_lo_u32 v3, v2, s7
    v_lshrrev_b32 v3, 16, v3
    v_mul_u32_u24 v4, 40, v3
    v_sub_u32 v4, v2, v4
    v_mul_u32_u24 v3, 1280, v3
    v_lshl_add_u32 v3, v4, 4, v3
    s_add_u32 m0, s74, 3072
    s_nop 0
    buffer_load_dwordx4 v3, s[28:31], s75 offen nt lds
    v_add_u32 v2, 256, v9
    v_mul_lo_u32 v3, v2, s7
    v_lshrrev_b32 v3, 16, v3
    v_mul_u32_u24 v4, 40, v3
    v_sub_u32 v4, v2, v4
    v_mul_u32_u24 v3, 1280, v3
    v_lshl_add_u32 v3, v4, 4, v3
    s_add_u32 m0, s74, 4096
    s_nop 0
    buffer_load_dwordx4 v3, s[28:31], s75 offen nt lds
    s_branch L_wb
L_w1:
    v_and_b32 v2, 15, v1
    v_lshrrev_b32 v3, 4, v1
    v_lshrrev_b32 v4, 2, v2
    v_lshl_add_u32 v4, v3, 2, v4
    v_mul_u32_u24 v4, 640, v4
    v_and_b32 v2, 3, v2
    v_lshl_add_u32 v4, v2, 3, v4
    s_mul_i32 s6, s76, 160
    s_add_u32 s6, s6, 141312
    v_add_u32 v4, s6, v4
    s_mul_i32 s6, s91, 20480
    s_mul_i32 s7, s76, 5120
    s_add_u32 s6, s6, s7
    s_add_u32 s6, s6, 4194304
    s_add_u32 s7, s6, 4096
    ds_read_b64_tr_b16 v[172:173], v4 offset:0
    ds_read_b64_tr_b16 v[174:175], v4 offset:10240
    ds_read_b64_tr_b16 v[176:177], v4 offset:32
    ds_read_b64_tr_b16 v[178:179], v4 offset:10272
    ds_read_b64_tr_b16 v[180:181], v4 offset:64
    ds_read_b64_tr_b16 v[182:183], v4 offset:10304
    ds_read_b64_tr_b16 v[184:185], v4 offset:96
    ds_read_b64_tr_b16 v[186:187], v4 offset:10336
    ds_read_b64_tr_b16 v[188:189], v4 offset:128
    ds_read_b64_tr_b16 v[190:191], v4 offset:10368
    s_waitcnt lgkmcnt(0)
    buffer_store_dwordx4 v[172:175], v13, s[8:11], s6 offen offset:0 sc1
    buffer_store_dwordx4 v[176:179], v13, s[8:11], s6 offen offset:1024 sc1
    buffer_store_dwordx4 v[180:183], v13, s[8:11], s6 offen offset:2048 sc1
    buffer_store_dwordx4 v[184:187], v13, s[8:11], s6 offen offset:3072 sc1
    buffer_store_dwordx4 v[188:191], v13, s[8:11], s7 offen offset:0 sc1
    s_branch L_wb
L_w2:
    s_cmp_lg_u32 s3, 0
    s_cbranch_scc1 L_wb
    s_mov_b32 s28, s56
    s_mov_b32 s29, s57
    s_mov_b32 s30, 0x100
    s_mov_b32 s31, 0x20000
    v_mov_b32 v2, 1
    v_lshlrev_b32 v3, 8, v1
    s_and_b32 s6, s2, 31
    s_lshl_b32 s6, s6, 2
    buffer_atomic_add v2, v3, s[28:31], s6 offen offset:128 sc1
    s_branch L_wb
L_xa:
    s_cmp_lg_u32 s90, 0
    s_cbranch_scc1 L_xa1
    s_mov_b32 s28, s56
    s_mov_b32 s29, s57
    s_mov_b32 s30, 0x100
    s_mov_b32 s31, 0x20000
    v_and_b32 v3, 31, v1
    v_lshlrev_b32 v3, 2, v3
    s_mov_b32 s79, 262144
L_poll_50:
    buffer_load_dword v2, v3, s[28:31], 0 offen offset:128 sc1
    s_waitcnt vmcnt(0)
    v_cmp_gt_u32 vcc, 4, v2
    s_cbranch_vccz L_polldone_51
    s_sleep 8
    s_sub_u32 s79, s79, 1
    s_cmp_lg_u32 s79, 0
    s_cbranch_scc1 L_poll_50
L_polldone_51:
L_xa1:
    s_lshr_b32 s74, s4, 3
    s_lshl_b32 s74, s74, 2
    s_add_u32 s74, s74, s76
    s_mul_i32 s74, s74, 327680
    s_and_b32 s7, s4, 3
    s_mul_i32 s7, s7, 10240
    s_add_u32 s74, s74, s7
    s_add_u32 s74, s74, 4199424
    s_add_u32 s6, s76, 0
    s_and_b32 s6, s6, 3
    s_lshl_b32 s6, s6, 10
    s_add_u32 s84, s6, s74
    s_add_u32 s6, s76, 1
    s_and_b32 s6, s6, 3
    s_lshl_b32 s6, s6, 10
    s_add_u32 s85, s6, s74
    s_add_u32 s6, s76, 2
    s_and_b32 s6, s6, 3
    s_lshl_b32 s6, s6, 10
    s_add_u32 s86, s6, s74
    s_add_u32 s6, s76, 3
    s_and_b32 s6, s6, 3
    s_lshl_b32 s6, s6, 10
    s_add_u32 s87, s6, s74
    s_add_u32 s88, s74, 4096
    s_lshl_b32 s73, s3, 13
    s_add_u32 s75, s73, s78
    s_add_u32 m0, s73, 131072
    s_add_u32 s7, s84, 0
    buffer_load_dwordx4 v13, s[8:11], s7 offen sc1 lds
    s_add_u32 m0, s73, 132096
    s_add_u32 s7, s85, 0
    buffer_load_dwordx4 v13, s[8:11], s7 offen sc1 lds
    s_add_u32 m0, s73, 133120
    s_add_u32 s7, s86, 0
    buffer_load_dwordx4 v13, s[8:11], s7 offen sc1 lds
    s_add_u32 m0, s73, 134144
    s_add_u32 s7, s87, 0
    buffer_load_dwordx4 v13, s[8:11], s7 offen sc1 lds
    s_add_u32 m0, s73, 135168
    s_add_u32 s7, s88, 0
    buffer_load_dwordx4 v13, s[8:11], s7 offen sc1 lds
    s_add_u32 m0, s73, 136192
    s_add_u32 s7, s84, 40960
    buffer_load_dwordx4 v13, s[8:11], s7 offen sc1 lds
    s_add_u32 m0, s73, 137216
    s_add_u32 s7, s85, 40960
    buffer_load_dwordx4 v13, s[8:11], s7 offen sc1 lds
    s_add_u32 m0, s73, 138240
    s_add_u32 s7, s86, 40960
    buffer_load_dwordx4 v13, s[8:11], s7 offen sc1 lds
    s_add_u32 m0, s75, 0
    s_add_u32 s7, s87, 40960
    buffer_load_dwordx4 v13, s[8:11], s7 offen sc1 lds
    s_add_u32 m0, s75, 1024
    s_add_u32 s7, s88, 40960
    buffer_load_dwordx4 v13, s[8:11], s7 offen sc1 lds
    s_add_u32 m0, s75, 2048
    s_add_u32 s7, s84, 81920
    buffer_load_dwordx4 v13, s[8:11], s7 offen sc1 lds
    s_add_u32 m0, s75, 3072
    s_add_u32 s7, s85, 81920
    buffer_load_dwordx4 v13, s[8:11], s7 offen sc1 lds
    s_add_u32 m0, s75, 4096
    s_add_u32 s7, s86, 81920
    buffer_load_dwordx4 v13, s[8:11], s7 offen sc1 lds
    s_add_u32 m0, s75, 5120
    s_add_u32 s7, s87, 81920
    buffer_load_dwordx4 v13, s[8:11], s7 offen sc1 lds
    s_add_u32 m0, s75, 6144
    s_add_u32 s7, s88, 81920
    buffer_load_dwordx4 v13, s[8:11], s7 offen sc1 lds
    s_add_u32 m0, s75, 7168
    s_add_u32 s7, s84, 122880
    buffer_load_dwordx4 v13, s[8:11], s7 offen sc1 lds
    s_lshl_b32 s75, s3, 12
    s_add_u32 s75, s75, s78
    s_add_u32 m0, s75, 49152
    s_add_u32 s7, s85, 122880
    buffer_load_dwordx4 v13, s[8:11], s7 offen sc1 lds
    s_add_u32 m0, s75, 50176
    s_add_u32 s7, s86, 122880
    buffer_load_dwordx4 v13, s[8:11], s7 offen sc1 lds
    s_add_u32 m0, s75, 51200
    s_add_u32 s7, s87, 122880
    buffer_load_dwordx4 v13, s[8:11], s7 offen sc1 lds
    s_add_u32 m0, s75, 52224
    s_add_u32 s7, s88, 122880
    buffer_load_dwordx4 v13, s[8:11], s7 offen sc1 lds
    s_setpc_b64 s[82:83]
L_x3:
    s_mov_b32 s12, s48
    s_mov_b32 s13, s49
    s_mov_b32 s14, 0x21c000
    s_mov_b32 s15, 0x20000
    s_cmp_eq_u32 s3, 3
    s_cbranch_scc1 L_load_r
    s_cmp_eq_u32 s3, 1
    s_cselect_b32 s12, s50, s12
    s_cselect_b32 s13, s51, s13
    s_cmp_eq_u32 s3, 2
    s_cselect_b32 s12, s52, s12
    s_cselect_b32 s13, s53, s13
    s_mov_b32 s73, 3456
    s_cmov_b32 s73, 256
    s_mov_b32 s75, 256
    s_cmov_b32 s75, 163840
    s_lshr_b32 s6, s2, 3
    s_sub_u32 s6, s6, 16
    s_mul_i32 s6, s6, 40
    v_lshrrev_b32 v2, 2, v1
    v_add_u32 v2, s6, v2
    v_mul_lo_u32 v2, v2, s73
    v_and_b32 v3, 3, v1
    v_lshl_add_u32 v2, v3, 6, v2
    s_xor_b32 s79, s79, 1
    s_lshl_b32 s6, s79, 3
    s_lshr_b32 s7, s4, 2
    s_add_u32 s6, s6, s7
    s_mul_i32 s6, s6, s75
    v_mov_b32 v3, 0x5000000
    v_cmp_gt_u32 vcc, 32, v1
    s_lshl_b32 s73, s73, 4
    s_nop 0
    v_cndmask_b32 v3, v3, v2, vcc
    buffer_load_dword v11, v2, s[12:15], s6 offen
    s_add_u32 s7, s6, s73
    buffer_load_dword v11, v2, s[12:15], s7 offen
    s_add_u32 s7, s7, s73
    buffer_load_dword v11, v3, s[12:15], s7 offen
    s_setpc_b64 s[82:83]
L_mask:
    v_and_b32 v2, 15, v1
    v_lshrrev_b32 v3, 4, v1
    v_lshlrev_b32 v3, 2, v3
    v_sub_u32 v2, v2, v3
    v_mov_b32 v3, 0xff800000
    v_cmp_gt_i32 vcc, 0, v2
    v_mov_b32 v152, v3
    s_nop 0
    v_cndmask_b32 v144, v144, v3, vcc
    v_cndmask_b32 v156, v156, v3, vcc
    v_cmp_gt_i32 vcc, 1, v2
    v_mov_b32 v153, v3
    s_nop 0
    v_cndmask_b32 v145, v145, v3, vcc
    v_cndmask_b32 v157, v157, v3, vcc
    v_cmp_gt_i32 vcc, 2, v2
    v_mov_b32 v154, v3
    s_nop 0
    v_cndmask_b32 v146, v146, v3, vcc
    v_cndmask_b32 v158, v158, v3, vcc
    v_cmp_gt_i32 vcc, 3, v2
    v_mov_b32 v155, v3
    s_nop 0
    v_cndmask_b32 v147, v147, v3, vcc
    v_cndmask_b32 v159, v159, v3, vcc
    s_nop 1
    s_setpc_b64 s[82:83]
L_rare0:
    s_nop 15
    v_max_f32 v62, v64, v65
    v_max3_f32 v62, v62, v66, v67
    v_max3_f32 v62, v62, v72, v73
    v_max3_f32 v62, v62, v74, v75
    v_mov_b32 v58, v62
    s_nop 1
    v_permlane16_swap_b32 v62, v58
    s_nop 1
    v_max_f32 v62, v62, v58
    v_mov_b32 v58, v62
    s_nop 1
    v_permlane32_swap_b32 v62, v58
    s_nop 1
    v_max_f32 v62, v62, v58
    v_add_f32 v62, 0x41c00000, v62
    v_max_f32 v62, 0, v62
    v_exp_f32 v58, -v62
    v_sub_f32 v64, v64, v62
    v_sub_f32 v80, v80, v62
    v_sub_f32 v144, v144, v62
    v_sub_f32 v65, v65, v62
    v_sub_f32 v81, v81, v62
    v_sub_f32 v145, v145, v62
    v_sub_f32 v66, v66, v62
    v_sub_f32 v82, v82, v62
    v_sub_f32 v146, v146, v62
    v_sub_f32 v67, v67, v62
    v_sub_f32 v83, v83, v62
    v_sub_f32 v147, v147, v62
    v_sub_f32 v72, v72, v62
    v_sub_f32 v88, v88, v62
    v_sub_f32 v152, v152, v62
    v_sub_f32 v73, v73, v62
    v_sub_f32 v89, v89, v62
    v_sub_f32 v153, v153, v62
    v_sub_f32 v74, v74, v62
    v_sub_f32 v90, v90, v62
    v_sub_f32 v154, v154, v62
    v_sub_f32 v75, v75, v62
    v_sub_f32 v91, v91, v62
    v_sub_f32 v155, v155, v62
    v_mul_f32 v160, v58, v160
    v_mul_f32 v161, v58, v161
    v_mul_f32 v162, v58, v162
    v_mul_f32 v163, v58, v163
    v_mul_f32 v192, v58, v192
    v_mul_f32 v193, v58, v193
    v_mul_f32 v194, v58, v194
    v_mul_f32 v195, v58, v195
    v_mul_f32 v200, v58, v200
    v_mul_f32 v201, v58, v201
    v_mul_f32 v202, v58, v202
    v_mul_f32 v203, v58, v203
    v_mul_f32 v208, v58, v208
    v_mul_f32 v209, v58, v209
    v_mul_f32 v210, v58, v210
    v_mul_f32 v211, v58, v211
    v_mul_f32 v216, v58, v216
    v_mul_f32 v217, v58, v217
    v_mul_f32 v218, v58, v218
    v_mul_f32 v219, v58, v219
    v_mul_f32 v224, v58, v224
    v_mul_f32 v225, v58, v225
    v_mul_f32 v226, v58, v226
    v_mul_f32 v227, v58, v227
    v_mul_f32 v232, v58, v232
    v_mul_f32 v233, v58, v233
    v_mul_f32 v234, v58, v234
    v_mul_f32 v235, v58, v235
    v_mul_f32 v240, v58, v240
    v_mul_f32 v241, v58, v241
    v_mul_f32 v242, v58, v242
    v_mul_f32 v243, v58, v243
    v_mul_f32 v248, v58, v248
    v_mul_f32 v249, v58, v249
    v_mul_f32 v250, v58, v250
    v_mul_f32 v251, v58, v251
    v_max_f32 v62, v68, v69
    v_max3_f32 v62, v62, v70, v71
    v_max3_f32 v62, v62, v76, v77
    v_max3_f32 v62, v62, v78, v79
    v_mov_b32 v58, v62
    s_nop 1
    v_permlane16_swap_b32 v62, v58
    s_nop 1
    v_max_f32 v62, v62, v58
    v_mov_b32 v58, v62
    s_nop 1
    v_permlane32_swap_b32 v62, v58
    s_nop 1
    v_max_f32 v62, v62, v58
    v_add_f32 v62, 0x41c00000, v62
    v_max_f32 v62, 0, v62
    v_exp_f32 v58, -v62
    v_sub_f32 v68, v68, v62
    v_sub_f32 v84, v84, v62
    v_sub_f32 v148, v148, v62
    v_sub_f32 v69, v69, v62
    v_sub_f32 v85, v85, v62
    v_sub_f32 v149, v149, v62
    v_sub_f32 v70, v70, v62
    v_sub_f32 v86, v86, v62
    v_sub_f32 v150, v150, v62
    v_sub_f32 v71, v71, v62
    v_sub_f32 v87, v87, v62
    v_sub_f32 v151, v151, v62
    v_sub_f32 v76, v76, v62
    v_sub_f32 v92, v92, v62
    v_sub_f32 v156, v156, v62
    v_sub_f32 v77, v77, v62
    v_sub_f32 v93, v93, v62
    v_sub_f32 v157, v157, v62
    v_sub_f32 v78, v78, v62
    v_sub_f32 v94, v94, v62
    v_sub_f32 v158, v158, v62
    v_sub_f32 v79, v79, v62
    v_sub_f32 v95, v95, v62
    v_sub_f32 v159, v159, v62
    v_mul_f32 v164, v58, v164
    v_mul_f32 v165, v58, v165
    v_mul_f32 v166, v58, v166
    v_mul_f32 v167, v58, v167
    v_mul_f32 v196, v58, v196
    v_mul_f32 v197, v58, v197
    v_mul_f32 v198, v58, v198
    v_mul_f32 v199, v58, v199
    v_mul_f32 v204, v58, v204
    v_mul_f32 v205, v58, v205
    v_mul_f32 v206, v58, v206
    v_mul_f32 v207, v58, v207
    v_mul_f32 v212, v58, v212
    v_mul_f32 v213, v58, v213
    v_mul_f32 v214, v58, v214
    v_mul_f32 v215, v58, v215
    v_mul_f32 v220, v58, v220
    v_mul_f32 v221, v58, v221
    v_mul_f32 v222, v58, v222
    v_mul_f32 v223, v58, v223
    v_mul_f32 v228, v58, v228
    v_mul_f32 v229, v58, v229
    v_mul_f32 v230, v58, v230
    v_mul_f32 v231, v58, v231
    v_mul_f32 v236, v58, v236
    v_mul_f32 v237, v58, v237
    v_mul_f32 v238, v58, v238
    v_mul_f32 v239, v58, v239
    v_mul_f32 v244, v58, v244
    v_mul_f32 v245, v58, v245
    v_mul_f32 v246, v58, v246
    v_mul_f32 v247, v58, v247
    v_mul_f32 v252, v58, v252
    v_mul_f32 v253, v58, v253
    v_mul_f32 v254, v58, v254
    v_mul_f32 v255, v58, v255
    v_exp_f32 v58, v64
    s_nop 0
    v_exp_f32 v59, v65
    s_nop 0
    v_cvt_pk_bf16_f32 v128, v58, v59
    v_exp_f32 v60, v66
    s_nop 0
    v_exp_f32 v61, v67
    s_nop 0
    v_cvt_pk_bf16_f32 v129, v60, v61
    v_exp_f32 v58, v68
    s_nop 0
    v_exp_f32 v59, v69
    s_nop 0
    v_cvt_pk_bf16_f32 v132, v58, v59
    v_exp_f32 v60, v70
    s_nop 0
    v_exp_f32 v61, v71
    s_nop 0
    v_cvt_pk_bf16_f32 v133, v60, v61
    v_exp_f32 v58, v72
    s_nop 0
    v_exp_f32 v59, v73
    s_nop 0
    v_cvt_pk_bf16_f32 v130, v58, v59
    v_exp_f32 v60, v74
    s_nop 0
    v_exp_f32 v61, v75
    s_nop 0
    v_cvt_pk_bf16_f32 v131, v60, v61
    v_exp_f32 v58, v76
    s_nop 0
    v_exp_f32 v59, v77
    s_nop 0
    v_cvt_pk_bf16_f32 v134, v58, v59
    v_exp_f32 v60, v78
    s_nop 0
    v_exp_f32 v61, v79
    s_nop 0
    v_cvt_pk_bf16_f32 v135, v60, v61
    s_nop 1
    s_setpc_b64 s[80:81]
L_rare1:
    s_nop 15
    v_max_f32 v62, v80, v81
    v_max3_f32 v62, v62, v82, v83
    v_max3_f32 v62, v62, v88, v89
    v_max3_f32 v62, v62, v90, v91
    v_mov_b32 v58, v62
    s_nop 1
    v_permlane16_swap_b32 v62, v58
    s_nop 1
    v_max_f32 v62, v62, v58
    v_mov_b32 v58, v62
    s_nop 1
    v_permlane32_swap_b32 v62, v58
    s_nop 1
    v_max_f32 v62, v62, v58
    v_add_f32 v62, 0x41c00000, v62
    v_max_f32 v62, 0, v62
    v_exp_f32 v58, -v62
    v_sub_f32 v64, v64, v62
    v_sub_f32 v80, v80, v62
    v_sub_f32 v144, v144, v62
    v_sub_f32 v65, v65, v62
    v_sub_f32 v81, v81, v62
    v_sub_f32 v145, v145, v62
    v_sub_f32 v66, v66, v62
    v_sub_f32 v82, v82, v62
    v_sub_f32 v146, v146, v62
    v_sub_f32 v67, v67, v62
    v_sub_f32 v83, v83, v62
    v_sub_f32 v147, v147, v62
    v_sub_f32 v72, v72, v62
    v_sub_f32 v88, v88, v62
    v_sub_f32 v152, v152, v62
    v_sub_f32 v73, v73, v62
    v_sub_f32 v89, v89, v62
    v_sub_f32 v153, v153, v62
    v_sub_f32 v74, v74, v62
    v_sub_f32 v90, v90, v62
    v_sub_f32 v154, v154, v62
    v_sub_f32 v75, v75, v62
    v_sub_f32 v91, v91, v62
    v_sub_f32 v155, v155, v62
    v_mul_f32 v160, v58, v160
    v_mul_f32 v161, v58, v161
    v_mul_f32 v162, v58, v162
    v_mul_f32 v163, v58, v163
    v_mul_f32 v192, v58, v192
    v_mul_f32 v193, v58, v193
    v_mul_f32 v194, v58, v194
    v_mul_f32 v195, v58, v195
    v_mul_f32 v200, v58, v200
    v_mul_f32 v201, v58, v201
    v_mul_f32 v202, v58, v202
    v_mul_f32 v203, v58, v203
    v_mul_f32 v208, v58, v208
    v_mul_f32 v209, v58, v209
    v_mul_f32 v210, v58, v210
    v_mul_f32 v211, v58, v211
    v_mul_f32 v216, v58, v216
    v_mul_f32 v217, v58, v217
    v_mul_f32 v218, v58, v218
    v_mul_f32 v219, v58, v219
    v_mul_f32 v224, v58, v224
    v_mul_f32 v225, v58, v225
    v_mul_f32 v226, v58, v226
    v_mul_f32 v227, v58, v227
    v_mul_f32 v232, v58, v232
    v_mul_f32 v233, v58, v233
    v_mul_f32 v234, v58, v234
    v_mul_f32 v235, v58, v235
    v_mul_f32 v240, v58, v240
    v_mul_f32 v241, v58, v241
    v_mul_f32 v242, v58, v242
    v_mul_f32 v243, v58, v243
    v_mul_f32 v248, v58, v248
    v_mul_f32 v249, v58, v249
    v_mul_f32 v250, v58, v250
    v_mul_f32 v251, v58, v251
    v_max_f32 v62, v84, v85
    v_max3_f32 v62, v62, v86, v87
    v_max3_f32 v62, v62, v92, v93
    v_max3_f32 v62, v62, v94, v95
    v_mov_b32 v58, v62
    s_nop 1
    v_permlane16_swap_b32 v62, v58
    s_nop 1
    v_max_f32 v62, v62, v58
    v_mov_b32 v58, v62
    s_nop 1
    v_permlane32_swap_b32 v62, v58
    s_nop 1
    v_max_f32 v62, v62, v58
    v_add_f32 v62, 0x41c00000, v62
    v_max_f32 v62, 0, v62
    v_exp_f32 v58, -v62
    v_sub_f32 v68, v68, v62
    v_sub_f32 v84, v84, v62
    v_sub_f32 v148, v148, v62
    v_sub_f32 v69, v69, v62
    v_sub_f32 v85, v85, v62
    v_sub_f32 v149, v149, v62
    v_sub_f32 v70, v70, v62
    v_sub_f32 v86, v86, v62
    v_sub_f32 v150, v150, v62
    v_sub_f32 v71, v71, v62
    v_sub_f32 v87, v87, v62
    v_sub_f32 v151, v151, v62
    v_sub_f32 v76, v76, v62
    v_sub_f32 v92, v92, v62
    v_sub_f32 v156, v156, v62
    v_sub_f32 v77, v77, v62
    v_sub_f32 v93, v93, v62
    v_sub_f32 v157, v157, v62
    v_sub_f32 v78, v78, v62
    v_sub_f32 v94, v94, v62
    v_sub_f32 v158, v158, v62
    v_sub_f32 v79, v79, v62
    v_sub_f32 v95, v95, v62
    v_sub_f32 v159, v159, v62
    v_mul_f32 v164, v58, v164
    v_mul_f32 v165, v58, v165
    v_mul_f32 v166, v58, v166
    v_mul_f32 v167, v58, v167
    v_mul_f32 v196, v58, v196
    v_mul_f32 v197, v58, v197
    v_mul_f32 v198, v58, v198
    v_mul_f32 v199, v58, v199
    v_mul_f32 v204, v58, v204
    v_mul_f32 v205, v58, v205
    v_mul_f32 v206, v58, v206
    v_mul_f32 v207, v58, v207
    v_mul_f32 v212, v58, v212
    v_mul_f32 v213, v58, v213
    v_mul_f32 v214, v58, v214
    v_mul_f32 v215, v58, v215
    v_mul_f32 v220, v58, v220
    v_mul_f32 v221, v58, v221
    v_mul_f32 v222, v58, v222
    v_mul_f32 v223, v58, v223
    v_mul_f32 v228, v58, v228
    v_mul_f32 v229, v58, v229
    v_mul_f32 v230, v58, v230
    v_mul_f32 v231, v58, v231
    v_mul_f32 v236, v58, v236
    v_mul_f32 v237, v58, v237
    v_mul_f32 v238, v58, v238
    v_mul_f32 v239, v58, v239
    v_mul_f32 v244, v58, v244
    v_mul_f32 v245, v58, v245
    v_mul_f32 v246, v58, v246
    v_mul_f32 v247, v58, v247
    v_mul_f32 v252, v58, v252
    v_mul_f32 v253, v58, v253
    v_mul_f32 v254, v58, v254
    v_mul_f32 v255, v58, v255
    v_exp_f32 v58, v80
    s_nop 0
    v_exp_f32 v59, v81
    s_nop 0
    v_cvt_pk_bf16_f32 v136, v58, v59
    v_exp_f32 v60, v82
    s_nop 0
    v_exp_f32 v61, v83
    s_nop 0
    v_cvt_pk_bf16_f32 v137, v60, v61
    v_exp_f32 v58, v84
    s_nop 0
    v_exp_f32 v59, v85
    s_nop 0
    v_cvt_pk_bf16_f32 v140, v58, v59
    v_exp_f32 v60, v86
    s_nop 0
    v_exp_f32 v61, v87
    s_nop 0
    v_cvt_pk_bf16_f32 v141, v60, v61
    v_exp_f32 v58, v88
    s_nop 0
    v_exp_f32 v59, v89
    s_nop 0
    v_cvt_pk_bf16_f32 v138, v58, v59
    v_exp_f32 v60, v90
    s_nop 0
    v_exp_f32 v61, v91
    s_nop 0
    v_cvt_pk_bf16_f32 v139, v60, v61
    v_exp_f32 v58, v92
    s_nop 0
    v_exp_f32 v59, v93
    s_nop 0
    v_cvt_pk_bf16_f32 v142, v58, v59
    v_exp_f32 v60, v94
    s_nop 0
    v_exp_f32 v61, v95
    s_nop 0
    v_cvt_pk_bf16_f32 v143, v60, v61
    s_nop 1
    s_setpc_b64 s[80:81]
L_adone:
    s_barrier
    ds_read_b128 v[16:19], v4 offset:0
    ds_read_b128 v[20:23], v4 offset:1024
    ds_read_b128 v[24:27], v4 offset:2048
    ds_read_b128 v[28:31], v4 offset:3072
    s_waitcnt lgkmcnt(3)
    v_mfma_f32_16x16x32_bf16 v[56:59], v[96:99], v[16:19], 0
    v_mfma_f32_16x16x32_bf16 v[60:63], v[100:103], v[16:19], 0
    v_mfma_f32_16x16x32_bf16 v[64:67], v[104:107], v[16:19], 0
    v_mfma_f32_16x16x32_bf16 v[68:71], v[108:111], v[16:19], 0
    s_waitcnt lgkmcnt(2)
    v_mfma_f32_16x16x32_bf16 v[72:75], v[112:115], v[16:19], 0
    ds_read_b128 v[16:19], v4 offset:4096
    s_cmp_lt_u32 s3, 4
    s_cbranch_scc1 L_nowl_52
    s_add_u32 s75, s69, 204800
    buffer_load_dwordx4 v[196:199], v44, s[8:11], s75 offen sc1
    buffer_load_dwordx4 v[200:203], v45, s[8:11], s75 offen sc1
    buffer_load_dwordx4 v[204:207], v46, s[8:11], s75 offen sc1
    buffer_load_dwordx4 v[208:211], v47, s[8:11], s75 offen sc1
    buffer_load_dwordx4 v[212:215], v52, s[8:11], s75 offen sc1
L_nowl_52:
    v_mfma_f32_16x16x32_bf16 v[56:59], v[116:119], v[20:23], v[56:59]
    v_mfma_f32_16x16x32_bf16 v[60:63], v[120:123], v[20:23], v[60:63]
    v_mfma_f32_16x16x32_bf16 v[64:67], v[124:127], v[20:23], v[64:67]
    v_mfma_f32_16x16x32_bf16 v[68:71], v[128:131], v[20:23], v[68:71]
    s_waitcnt lgkmcnt(2)
    v_mfma_f32_16x16x32_bf16 v[72:75], v[132:135], v[20:23], v[72:75]
    ds_read_b128 v[20:23], v4 offset:5120
    s_cmp_lt_u32 s3, 4
    s_cbranch_scc1 L_nowl_53
    s_add_u32 s75, s69, 245760
    buffer_load_dwordx4 v[216:219], v44, s[8:11], s75 offen sc1
    buffer_load_dwordx4 v[220:223], v45, s[8:11], s75 offen sc1
    buffer_load_dwordx4 v[224:227], v46, s[8:11], s75 offen sc1
    buffer_load_dwordx4 v[228:231], v47, s[8:11], s75 offen sc1
    buffer_load_dwordx4 v[232:235], v52, s[8:11], s75 offen sc1
L_nowl_53:
    v_mfma_f32_16x16x32_bf16 v[56:59], v[136:139], v[24:27], v[56:59]
    v_mfma_f32_16x16x32_bf16 v[60:63], v[140:143], v[24:27], v[60:63]
    s_add_u32 s65, s68, 3
    s_and_b32 s65, s65, 3
    s_andn2_b32 s7, s68, 3
    v_mfma_f32_16x16x32_bf16 v[64:67], v[144:147], v[24:27], v[64:67]
    s_add_u32 s65, s65, s7
    s_lshl_b32 s65, s65, 17
    s_add_u32 s65, s65, s66
    v_mfma_f32_16x16x32_bf16 v[68:71], v[148:151], v[24:27], v[68:71]
    s_waitcnt lgkmcnt(2)
    s_add_u32 m0, s99, 65536
    v_mfma_f32_16x16x32_bf16 v[72:75], v[152:155], v[24:27], v[72:75]
    ds_read_b128 v[24:27], v4 offset:6144
    s_cmp_lt_u32 s3, 4
    s_cbranch_scc1 L_nowl_54
    s_add_u32 s75, s69, 286720
    buffer_load_dwordx4 v[236:239], v44, s[8:11], s75 offen sc1
    buffer_load_dwordx4 v[240:243], v45, s[8:11], s75 offen sc1
    buffer_load_dwordx4 v[244:247], v46, s[8:11], s75 offen sc1
    buffer_load_dwordx4 v[248:251], v47, s[8:11], s75 offen sc1
    buffer_load_dwordx4 v[252:255], v52, s[8:11], s75 offen sc1
L_nowl_54:
    v_mfma_f32_16x16x32_bf16 v[56:59], v[156:159], v[28:31], v[56:59]
    buffer_load_dwordx4 v13, s[8:11], s65 offen offset:0 sc1 lds
    v_mfma_f32_16x16x32_bf16 v[60:63], v[160:163], v[28:31], v[60:63]
    buffer_load_dwordx4 v13, s[8:11], s65 offen offset:1024 sc1 lds
    v_mfma_f32_16x16x32_bf16 v[64:67], v[164:167], v[28:31], v[64:67]
    buffer_load_dwordx4 v13, s[8:11], s65 offen offset:2048 sc1 lds
    v_mfma_f32_16x16x32_bf16 v[68:71], v[168:171], v[28:31], v[68:71]
    buffer_load_dwordx4 v13, s[8:11], s65 offen offset:3072 sc1 lds
    s_waitcnt lgkmcnt(2)
    v_mfma_f32_16x16x32_bf16 v[72:75], v[172:175], v[28:31], v[72:75]
    ds_read_b128 v[28:31], v4 offset:7168
    s_waitcnt vmcnt(20)
    v_mfma_f32_16x16x32_bf16 v[56:59], v[176:179], v[16:19], v[56:59]
    v_mfma_f32_16x16x32_bf16 v[60:63], v[180:183], v[16:19], v[60:63]
    v_mfma_f32_16x16x32_bf16 v[64:67], v[184:187], v[16:19], v[64:67]
    v_mfma_f32_16x16x32_bf16 v[68:71], v[188:191], v[16:19], v[68:71]
    s_waitcnt lgkmcnt(2)
    v_mfma_f32_16x16x32_bf16 v[72:75], v[192:195], v[16:19], v[72:75]
    s_cmp_ge_u32 s3, 4
    s_cbranch_scc1 L_o0
    s_waitcnt vmcnt(4)
L_o0:
    s_waitcnt lgkmcnt(0)
    s_barrier
    ds_read_b128 v[16:19], v4 offset:32768
    s_waitcnt vmcnt(14)
    v_mfma_f32_16x16x32_bf16 v[56:59], v[196:199], v[20:23], v[56:59]
    v_mfma_f32_16x16x32_bf16 v[60:63], v[200:203], v[20:23], v[60:63]
    v_mfma_f32_16x16x32_bf16 v[64:67], v[204:207], v[20:23], v[64:67]
    v_mfma_f32_16x16x32_bf16 v[68:71], v[208:211], v[20:23], v[68:71]
    v_mfma_f32_16x16x32_bf16 v[72:75], v[212:215], v[20:23], v[72:75]
    ds_read_b128 v[20:23], v4 offset:33792
    s_waitcnt vmcnt(9)
    v_mfma_f32_16x16x32_bf16 v[56:59], v[216:219], v[24:27], v[56:59]
    v_mfma_f32_16x16x32_bf16 v[60:63], v[220:223], v[24:27], v[60:63]
    v_mfma_f32_16x16x32_bf16 v[64:67], v[224:227], v[24:27], v[64:67]
    v_mfma_f32_16x16x32_bf16 v[68:71], v[228:231], v[24:27], v[68:71]
    v_mfma_f32_16x16x32_bf16 v[72:75], v[232:235], v[24:27], v[72:75]
    ds_read_b128 v[24:27], v4 offset:34816
    s_waitcnt vmcnt(4)
    v_mfma_f32_16x16x32_bf16 v[56:59], v[236:239], v[28:31], v[56:59]
    v_mfma_f32_16x16x32_bf16 v[60:63], v[240:243], v[28:31], v[60:63]
    v_mfma_f32_16x16x32_bf16 v[64:67], v[244:247], v[28:31], v[64:67]
    v_mfma_f32_16x16x32_bf16 v[68:71], v[248:251], v[28:31], v[68:71]
    s_waitcnt lgkmcnt(2)
    v_mfma_f32_16x16x32_bf16 v[72:75], v[252:255], v[28:31], v[72:75]
    ds_read_b128 v[28:31], v4 offset:35840
    v_mfma_f32_16x16x32_bf16 v[76:79], v[96:99], v[16:19], 0
    s_sub_u32 s6, s71, 1
    s_and_b32 s6, s6, 3
    s_mul_i32 s7, s6, 5120
    v_mfma_f32_16x16x32_bf16 v[80:83], v[100:103], v[16:19], 0
    s_add_u32 s7, s7, s67
    s_cmp_eq_u32 s6, 3
    s_cselect_b32 s7, 155648, s7
    v_mfma_f32_16x16x32_bf16 v[84:87], v[104:107], v[16:19], 0
    v_add_u32 v12, s7, v52
    v_add_u32 v5, s67, v45
    v_mfma_f32_16x16x32_bf16 v[88:91], v[108:111], v[16:19], 0
    s_waitcnt lgkmcnt(2)
    v_mfma_f32_16x16x32_bf16 v[92:95], v[112:115], v[16:19], 0
    ds_read_b128 v[16:19], v4 offset:36864
    v_mfma_f32_16x16x32_bf16 v[76:79], v[116:119], v[20:23], v[76:79]
    ds_write_b128 v5, v[60:63] offset:0
    v_add_u32 v5, s67, v46
    v_mfma_f32_16x16x32_bf16 v[80:83], v[120:123], v[20:23], v[80:83]
    v_mfma_f32_16x16x32_bf16 v[84:87], v[124:127], v[20:23], v[84:87]
    v_mfma_f32_16x16x32_bf16 v[88:91], v[128:131], v[20:23], v[88:91]
    s_waitcnt lgkmcnt(3)
    v_mfma_f32_16x16x32_bf16 v[92:95], v[132:135], v[20:23], v[92:95]
    ds_read_b128 v[20:23], v4 offset:37888
    v_mfma_f32_16x16x32_bf16 v[76:79], v[136:139], v[24:27], v[76:79]
    ds_write_b128 v5, v[64:67] offset:5120
    v_add_u32 v5, s67, v47
    v_mfma_f32_16x16x32_bf16 v[80:83], v[140:143], v[24:27], v[80:83]
    v_mfma_f32_16x16x32_bf16 v[84:87], v[144:147], v[24:27], v[84:87]
    v_mfma_f32_16x16x32_bf16 v[88:91], v[148:151], v[24:27], v[88:91]
    s_waitcnt lgkmcnt(4)
    v_mfma_f32_16x16x32_bf16 v[92:95], v[152:155], v[24:27], v[92:95]
    ds_read_b128 v[24:27], v4 offset:38912
    v_mfma_f32_16x16x32_bf16 v[76:79], v[156:159], v[28:31], v[76:79]
    ds_write_b128 v5, v[68:71] offset:10240
    v_add_u32 v5, s67, v52
    v_mfma_f32_16x16x32_bf16 v[80:83], v[160:163], v[28:31], v[80:83]
    v_mfma_f32_16x16x32_bf16 v[84:87], v[164:167], v[28:31], v[84:87]
    v_mfma_f32_16x16x32_bf16 v[88:91], v[168:171], v[28:31], v[88:91]
    s_waitcnt lgkmcnt(5)
    v_mfma_f32_16x16x32_bf16 v[92:95], v[172:175], v[28:31], v[92:95]
    ds_read_b128 v[28:31], v4 offset:39936
    v_mfma_f32_16x16x32_bf16 v[76:79], v[176:179], v[16:19], v[76:79]
    ds_write_b128 v12, v[72:75] offset:0
    v_mfma_f32_16x16x32_bf16 v[80:83], v[180:183], v[16:19], v[80:83]
    v_mfma_f32_16x16x32_bf16 v[84:87], v[184:187], v[16:19], v[84:87]
    v_and_b32 v3, 1, v1
    v_lshlrev_b32 v3, 12, v3
    s_lshr_b32 s72, s61, 2
    s_lshl_b32 s72, s72, 6
    s_andn2_b32 s6, s4, 7
    s_add_u32 s72, s72, s6
    s_add_u32 s72, s72, s3
    s_lshl_b32 s72, s72, 7
    s_add_u32 s72, s72, 3932160
    v_mfma_f32_16x16x32_bf16 v[88:91], v[188:191], v[16:19], v[88:91]
    s_waitcnt lgkmcnt(5)
    v_mfma_f32_16x16x32_bf16 v[92:95], v[192:195], v[16:19], v[92:95]
    s_waitcnt vmcnt(0)
    s_waitcnt lgkmcnt(0)
    s_barrier
    ds_read_b128 v[32:35], v6 offset:0
    ds_read_b128 v[36:39], v6 offset:5120
    ds_read_b128 v[40:43], v6 offset:10240
    ds_read_b128 v[16:19], v7 offset:0
    v_mfma_f32_16x16x32_bf16 v[76:79], v[196:199], v[20:23], v[76:79]
    v_mfma_f32_16x16x32_bf16 v[80:83], v[200:203], v[20:23], v[80:83]
    v_mfma_f32_16x16x32_bf16 v[84:87], v[204:207], v[20:23], v[84:87]
    s_waitcnt lgkmcnt(3)
    v_add_f32 v56, v56, v32
    v_add_f32 v57, v57, v33
    v_mfma_f32_16x16x32_bf16 v[88:91], v[208:211], v[20:23], v[88:91]
    v_add_f32 v58, v58, v34
    v_add_f32 v59, v59, v35
    v_mfma_f32_16x16x32_bf16 v[92:95], v[212:215], v[20:23], v[92:95]
    s_waitcnt lgkmcnt(2)
    ds_read_b128 v[32:35], v5 offset:0
    ds_read_b128 v[20:23], v7 offset:1024
    v_add_f32 v56, v56, v36
    v_add_f32 v57, v57, v37
    v_mfma_f32_16x16x32_bf16 v[76:79], v[216:219], v[24:27], v[76:79]
    buffer_load_dword v50, v3, s[8:11], s72 offen sc1
    v_add_f32 v58, v58, v38
    v_add_f32 v59, v59, v39
    v_mfma_f32_16x16x32_bf16 v[80:83], v[220:223], v[24:27], v[80:83]
    s_waitcnt lgkmcnt(3)
    ds_read_b128 v[36:39], v5 offset:5120
    v_add_f32 v56, v56, v40
    v_add_f32 v57, v57, v41
    v_mfma_f32_16x16x32_bf16 v[84:87], v[224:227], v[24:27], v[84:87]
    v_add_f32 v58, v58, v42
    v_add_f32 v59, v59, v43
    v_mfma_f32_16x16x32_bf16 v[88:91], v[228:231], v[24:27], v[88:91]
    ds_read_b128 v[40:43], v5 offset:10240
    s_waitcnt lgkmcnt(3)
    v_add_f32 v72, v72, v32
    v_add_f32 v73, v73, v33
    s_add_u32 s6, s96, 0
    v_mfma_f32_16x16x32_bf16 v[92:95], v[232:235], v[24:27], v[92:95]
    ds_read_b128 v[24:27], v7 offset:2048
    v_add_f32 v74, v74, v34
    v_add_f32 v75, v75, v35
    v_mfma_f32_16x16x32_bf16 v[76:79], v[236:239], v[28:31], v[76:79]
    buffer_store_dwordx4 v[56:59], v44, s[8:11], s6 offen sc1
    s_waitcnt lgkmcnt(2)
    v_add_f32 v72, v72, v36
    v_add_f32 v73, v73, v37
    v_mfma_f32_16x16x32_bf16 v[80:83], v[240:243], v[28:31], v[80:83]
    v_add_f32 v74, v74, v38
    v_add_f32 v75, v75, v39
    v_mfma_f32_16x16x32_bf16 v[84:87], v[244:247], v[28:31], v[84:87]
    s_waitcnt lgkmcnt(1)
    v_add_f32 v72, v72, v40
    v_add_f32 v73, v73, v41
    v_mfma_f32_16x16x32_bf16 v[88:91], v[248:251], v[28:31], v[88:91]
    v_add_f32 v74, v74, v42
    v_add_f32 v75, v75, v43
    s_cmp_lg_u32 s71, 0
    v_mfma_f32_16x16x32_bf16 v[92:95], v[252:255], v[28:31], v[92:95]
    s_cbranch_scc1 L_nost_55
    buffer_store_dwordx4 v[72:75], v52, s[8:11], s6 offen sc1
L_nost_55:
    ds_read_b128 v[28:31], v7 offset:3072
    v_mfma_f32_16x16x32_bf16 v[56:59], v[96:99], v[16:19], 0
    s_sub_u32 s6, s71, 2
    s_and_b32 s6, s6, 3
    s_mul_i32 s7, s6, 5120
    v_mfma_f32_16x16x32_bf16 v[60:63], v[100:103], v[16:19], 0
    s_add_u32 s7, s7, s67
    s_cmp_eq_u32 s6, 3
    s_cselect_b32 s7, 124928, s7
    v_mfma_f32_16x16x32_bf16 v[64:67], v[104:107], v[16:19], 0
    v_add_u32 v12, s7, v52
    v_add_u32 v5, s67, v45
    s_waitcnt vmcnt(1)
    v_cmp_ne_u32 vcc, 1, v50
    s_cbranch_vccz L_o1
    s_mov_b32 s79, 262144
L_poll_57:
    buffer_load_dword v2, v3, s[8:11], s72 offen sc1
    s_waitcnt vmcnt(0)
    v_cmp_ne_u32 vcc, 1, v2
    s_cbranch_vccz L_polldone_58
    s_sleep 1
    s_sub_u32 s79, s79, 1
    s_cmp_lg_u32 s79, 0
    s_cbranch_scc1 L_poll_57
L_polldone_58:
L_o1:
    v_mfma_f32_16x16x32_bf16 v[68:71], v[108:111], v[16:19], 0
    s_add_u32 s65, s61, 1
    s_and_b32 s65, s65, 3
    s_andn2_b32 s7, s61, 3
    v_mfma_f32_16x16x32_bf16 v[72:75], v[112:115], v[16:19], 0
    ds_read_b128 v[16:19], v7 offset:4096
    s_add_u32 s65, s65, s7
    s_lshl_b32 s65, s65, 17
    s_add_u32 s65, s65, s66
    v_mfma_f32_16x16x32_bf16 v[56:59], v[116:119], v[20:23], v[56:59]
    ds_write_b128 v5, v[80:83] offset:30720
    v_add_u32 v5, s67, v46
    s_add_u32 m0, s99, 0
    v_mfma_f32_16x16x32_bf16 v[60:63], v[120:123], v[20:23], v[60:63]
    buffer_load_dwordx4 v13, s[8:11], s65 offen offset:1024 sc1 lds
    buffer_load_dwordx4 v13, s[8:11], s65 offen offset:0 sc1 lds
    v_mfma_f32_16x16x32_bf16 v[64:67], v[124:127], v[20:23], v[64:67]
    buffer_load_dwordx4 v13, s[8:11], s65 offen offset:3072 sc1 lds
    buffer_load_dwordx4 v13, s[8:11], s65 offen offset:2048 sc1 lds
    v_mfma_f32_16x16x32_bf16 v[68:71], v[128:131], v[20:23], v[68:71]
    s_waitcnt lgkmcnt(3)
    s_add_u32 s65, s61, 2
    s_and_b32 s65, s65, 3
    s_andn2_b32 s7, s61, 3
    v_mfma_f32_16x16x32_bf16 v[72:75], v[132:135], v[20:23], v[72:75]
    ds_read_b128 v[20:23], v7 offset:5120
    s_add_u32 s65, s65, s7
    s_lshl_b32 s65, s65, 17
    s_add_u32 s65, s65, s66
    v_mfma_f32_16x16x32_bf16 v[56:59], v[136:139], v[24:27], v[56:59]
    ds_write_b128 v5, v[84:87] offset:35840
    v_add_u32 v5, s67, v47
    s_add_u32 m0, s99, 32768
    v_mfma_f32_16x16x32_bf16 v[60:63], v[140:143], v[24:27], v[60:63]
    buffer_load_dwordx4 v13, s[8:11], s65 offen offset:0 sc1 lds
    v_mfma_f32_16x16x32_bf16 v[64:67], v[144:147], v[24:27], v[64:67]
    buffer_load_dwordx4 v13, s[8:11], s65 offen offset:1024 sc1 lds
    v_mfma_f32_16x16x32_bf16 v[68:71], v[148:151], v[24:27], v[68:71]
    buffer_load_dwordx4 v13, s[8:11], s65 offen offset:2048 sc1 lds
    s_waitcnt lgkmcnt(4)
    v_mfma_f32_16x16x32_bf16 v[72:75], v[152:155], v[24:27], v[72:75]
    ds_read_b128 v[24:27], v7 offset:6144
    v_mfma_f32_16x16x32_bf16 v[56:59], v[156:159], v[28:31], v[56:59]
    ds_write_b128 v5, v[88:91] offset:40960
    v_add_u32 v5, s67, v52
    v_mfma_f32_16x16x32_bf16 v[60:63], v[160:163], v[28:31], v[60:63]
    buffer_load_dwordx4 v13, s[8:11], s65 offen offset:3072 sc1 lds
    v_mfma_f32_16x16x32_bf16 v[64:67], v[164:167], v[28:31], v[64:67]
    v_mfma_f32_16x16x32_bf16 v[68:71], v[168:171], v[28:31], v[68:71]
    s_waitcnt lgkmcnt(5)
    v_mfma_f32_16x16x32_bf16 v[72:75], v[172:175], v[28:31], v[72:75]
    ds_read_b128 v[28:31], v7 offset:7168
    v_mfma_f32_16x16x32_bf16 v[56:59], v[176:179], v[16:19], v[56:59]
    ds_write_b128 v12, v[92:95] offset:30720
    v_mfma_f32_16x16x32_bf16 v[60:63], v[180:183], v[16:19], v[60:63]
    s_add_u32 s65, s61, 3
    s_and_b32 s65, s65, 3
    s_andn2_b32 s7, s61, 3
    v_mfma_f32_16x16x32_bf16 v[64:67], v[184:187], v[16:19], v[64:67]
    s_add_u32 s65, s65, s7
    s_lshl_b32 s65, s65, 17
    s_add_u32 s65, s65, s66
    v_mfma_f32_16x16x32_bf16 v[68:71], v[188:191], v[16:19], v[68:71]
    s_waitcnt lgkmcnt(5)
    s_add_u32 m0, s99, 65536
    v_mfma_f32_16x16x32_bf16 v[72:75], v[192:195], v[16:19], v[72:75]
    s_waitcnt vmcnt(4)
    s_waitcnt lgkmcnt(0)
    s_barrier
    ds_read_b128 v[32:35], v6 offset:30720
    ds_read_b128 v[36:39], v6 offset:35840
    ds_read_b128 v[40:43], v6 offset:40960
    ds_read_b128 v[16:19], v4 offset:0
    v_mfma_f32_16x16x32_bf16 v[56:59], v[196:199], v[20:23], v[56:59]
    buffer_load_dwordx4 v13, s[8:11], s65 offen offset:0 sc1 lds
    v_mfma_f32_16x16x32_bf16 v[60:63], v[200:203], v[20:23], v[60:63]
    buffer_load_dwordx4 v13, s[8:11], s65 offen offset:1024 sc1 lds
    v_mfma_f32_16x16x32_bf16 v[64:67], v[204:207], v[20:23], v[64:67]
    s_waitcnt lgkmcnt(3)
    v_add_f32 v76, v76, v32
    v_add_f32 v77, v77, v33
    v_mfma_f32_16x16x32_bf16 v[68:71], v[208:211], v[20:23], v[68:71]
    buffer_load_dwordx4 v13, s[8:11], s65 offen offset:2048 sc1 lds
    v_add_f32 v78, v78, v34
    v_add_f32 v79, v79, v35
    v_mfma_f32_16x16x32_bf16 v[72:75], v[212:215], v[20:23], v[72:75]
    s_waitcnt lgkmcnt(2)
    ds_read_b128 v[32:35], v5 offset:30720
    ds_read_b128 v[20:23], v4 offset:1024
    v_add_f32 v76, v76, v36
    v_add_f32 v77, v77, v37
    v_mfma_f32_16x16x32_bf16 v[56:59], v[216:219], v[24:27], v[56:59]
    buffer_load_dwordx4 v13, s[8:11], s65 offen offset:3072 sc1 lds
    v_add_f32 v78, v78, v38
    v_add_f32 v79, v79, v39
    v_mfma_f32_16x16x32_bf16 v[60:63], v[220:223], v[24:27], v[60:63]
    s_waitcnt lgkmcnt(3)
    ds_read_b128 v[36:39], v5 offset:35840
    v_add_f32 v76, v76, v40
    v_add_f32 v77, v77, v41
    v_mfma_f32_16x16x32_bf16 v[64:67], v[224:227], v[24:27], v[64:67]
    v_add_f32 v78, v78, v42
    v_add_f32 v79, v79, v43
    v_mfma_f32_16x16x32_bf16 v[68:71], v[228:231], v[24:27], v[68:71]
    ds_read_b128 v[40:43], v5 offset:40960
    s_waitcnt lgkmcnt(3)
    v_add_f32 v92, v92, v32
    v_add_f32 v93, v93, v33
    s_add_u32 s6, s97, 0
    v_mfma_f32_16x16x32_bf16 v[72:75], v[232:235], v[24:27], v[72:75]
    ds_read_b128 v[24:27], v4 offset:2048
    v_add_f32 v94, v94, v34
    v_add_f32 v95, v95, v35
    v_mfma_f32_16x16x32_bf16 v[56:59], v[236:239], v[28:31], v[56:59]
    buffer_store_dwordx4 v[76:79], v44, s[8:11], s6 offen sc1
    s_waitcnt lgkmcnt(2)
    v_add_f32 v92, v92, v36
    v_add_f32 v93, v93, v37
    v_mfma_f32_16x16x32_bf16 v[60:63], v[240:243], v[28:31], v[60:63]
    v_add_f32 v94, v94, v38
    v_add_f32 v95, v95, v39
    v_mfma_f32_16x16x32_bf16 v[64:67], v[244:247], v[28:31], v[64:67]
    s_waitcnt lgkmcnt(1)
    v_add_f32 v92, v92, v40
    v_add_f32 v93, v93, v41
    v_mfma_f32_16x16x32_bf16 v[68:71], v[248:251], v[28:31], v[68:71]
    v_add_f32 v94, v94, v42
    v_add_f32 v95, v95, v43
    s_cmp_lg_u32 s71, 1
    v_mfma_f32_16x16x32_bf16 v[72:75], v[252:255], v[28:31], v[72:75]
    s_cbranch_scc1 L_nost_56
    buffer_store_dwordx4 v[92:95], v52, s[8:11], s6 offen sc1
L_nost_56:
    ds_read_b128 v[28:31], v4 offset:3072
    v_mfma_f32_16x16x32_bf16 v[76:79], v[96:99], v[16:19], 0
    s_sub_u32 s6, s71, 3
    s_and_b32 s6, s6, 3
    s_mul_i32 s7, s6, 5120
    v_mfma_f32_16x16x32_bf16 v[80:83], v[100:103], v[16:19], 0
    s_add_u32 s7, s7, s67
    s_cmp_eq_u32 s6, 3
    s_cselect_b32 s7, 155648, s7
    v_mfma_f32_16x16x32_bf16 v[84:87], v[104:107], v[16:19], 0
    v_add_u32 v12, s7, v52
    v_add_u32 v5, s67, v45
    v_mfma_f32_16x16x32_bf16 v[88:91], v[108:111], v[16:19], 0
    v_mfma_f32_16x16x32_bf16 v[92:95], v[112:115], v[16:19], 0
    ds_read_b128 v[16:19], v4 offset:4096
    v_mfma_f32_16x16x32_bf16 v[76:79], v[116:119], v[20:23], v[76:79]
    ds_write_b128 v5, v[60:63] offset:0
    v_add_u32 v5, s67, v46
    v_mfma_f32_16x16x32_bf16 v[80:83], v[120:123], v[20:23], v[80:83]
    v_mfma_f32_16x16x32_bf16 v[84:87], v[124:127], v[20:23], v[84:87]
    v_mfma_f32_16x16x32_bf16 v[88:91], v[128:131], v[20:23], v[88:91]
    s_waitcnt lgkmcnt(3)
    v_mfma_f32_16x16x32_bf16 v[92:95], v[132:135], v[20:23], v[92:95]
    ds_read_b128 v[20:23], v4 offset:5120
    v_mfma_f32_16x16x32_bf16 v[76:79], v[136:139], v[24:27], v[76:79]
    ds_write_b128 v5, v[64:67] offset:5120
    v_add_u32 v5, s67, v47
    v_mfma_f32_16x16x32_bf16 v[80:83], v[140:143], v[24:27], v[80:83]
    v_mfma_f32_16x16x32_bf16 v[84:87], v[144:147], v[24:27], v[84:87]
    v_mfma_f32_16x16x32_bf16 v[88:91], v[148:151], v[24:27], v[88:91]
    s_waitcnt lgkmcnt(4)
    v_mfma_f32_16x16x32_bf16 v[92:95], v[152:155], v[24:27], v[92:95]
    ds_read_b128 v[24:27], v4 offset:6144
    v_mfma_f32_16x16x32_bf16 v[76:79], v[156:159], v[28:31], v[76:79]
    ds_write_b128 v5, v[68:71] offset:10240
    v_add_u32 v5, s67, v52
    v_mfma_f32_16x16x32_bf16 v[80:83], v[160:163], v[28:31], v[80:83]
    v_mfma_f32_16x16x32_bf16 v[84:87], v[164:167], v[28:31], v[84:87]
    v_mfma_f32_16x16x32_bf16 v[88:91], v[168:171], v[28:31], v[88:91]
    s_waitcnt lgkmcnt(5)
    v_mfma_f32_16x16x32_bf16 v[92:95], v[172:175], v[28:31], v[92:95]
    ds_read_b128 v[28:31], v4 offset:7168
    v_mfma_f32_16x16x32_bf16 v[76:79], v[176:179], v[16:19], v[76:79]
    ds_write_b128 v12, v[72:75] offset:0
    v_mfma_f32_16x16x32_bf16 v[80:83], v[180:183], v[16:19], v[80:83]
    s_add_u32 s65, s68, 0
    s_and_b32 s65, s65, 3
    s_andn2_b32 s7, s68, 3
    v_mfma_f32_16x16x32_bf16 v[84:87], v[184:187], v[16:19], v[84:87]
    s_add_u32 s65, s65, s7
    s_lshl_b32 s65, s65, 17
    s_add_u32 s65, s65, s66
    v_mfma_f32_16x16x32_bf16 v[88:91], v[188:191], v[16:19], v[88:91]
    s_waitcnt lgkmcnt(5)
    s_add_u32 m0, s99, 0
    v_mfma_f32_16x16x32_bf16 v[92:95], v[192:195], v[16:19], v[92:95]
    s_waitcnt vmcnt(5)
    s_waitcnt lgkmcnt(0)
    s_barrier
    ds_read_b128 v[32:35], v6 offset:0
    ds_read_b128 v[36:39], v6 offset:5120
    ds_read_b128 v[40:43], v6 offset:10240
    ds_read_b128 v[16:19], v4 offset:32768
    v_mfma_f32_16x16x32_bf16 v[76:79], v[196:199], v[20:23], v[76:79]
    buffer_load_dwordx4 v13, s[8:11], s65 offen offset:0 sc1 lds
    v_mfma_f32_16x16x32_bf16 v[80:83], v[200:203], v[20:23], v[80:83]
    buffer_load_dwordx4 v13, s[8:11], s65 offen offset:1024 sc1 lds
    v_mfma_f32_16x16x32_bf16 v[84:87], v[204:207], v[20:23], v[84:87]
    s_waitcnt lgkmcnt(3)
    v_add_f32 v56, v56, v32
    v_add_f32 v57, v57, v33
    v_mfma_f32_16x16x32_bf16 v[88:91], v[208:211], v[20:23], v[88:91]
    buffer_load_dwordx4 v13, s[8:11], s65 offen offset:2048 sc1 lds
    v_add_f32 v58, v58, v34
    v_add_f32 v59, v59, v35
    v_mfma_f32_16x16x32_bf16 v[92:95], v[212:215], v[20:23], v[92:95]
    s_waitcnt lgkmcnt(2)
    ds_read_b128 v[32:35], v5 offset:0
    ds_read_b128 v[20:23], v4 offset:33792
    v_add_f32 v56, v56, v36
    v_add_f32 v57, v57, v37
    v_mfma_f32_16x16x32_bf16 v[76:79], v[216:219], v[24:27], v[76:79]
    buffer_load_dwordx4 v13, s[8:11], s65 offen offset:3072 sc1 lds
    v_add_f32 v58, v58, v38
    v_add_f32 v59, v59, v39
    v_mfma_f32_16x16x32_bf16 v[80:83], v[220:223], v[24:27], v[80:83]
    s_waitcnt lgkmcnt(3)
    ds_read_b128 v[36:39], v5 offset:5120
    v_add_f32 v56, v56, v40
    v_add_f32 v57, v57, v41
    v_mfma_f32_16x16x32_bf16 v[84:87], v[224:227], v[24:27], v[84:87]
    v_add_f32 v58, v58, v42
    v_add_f32 v59, v59, v43
    v_mfma_f32_16x16x32_bf16 v[88:91], v[228:231], v[24:27], v[88:91]
    ds_read_b128 v[40:43], v5 offset:10240
    s_waitcnt lgkmcnt(3)
    v_add_f32 v72, v72, v32
    v_add_f32 v73, v73, v33
    s_add_u32 s6, s98, 0
    v_mfma_f32_16x16x32_bf16 v[92:95], v[232:235], v[24:27], v[92:95]
    ds_read_b128 v[24:27], v4 offset:34816
    v_add_f32 v74, v74, v34
    v_add_f32 v75, v75, v35
    v_mfma_f32_16x16x32_bf16 v[76:79], v[236:239], v[28:31], v[76:79]
    buffer_store_dwordx4 v[56:59], v44, s[8:11], s6 offen sc1
    s_waitcnt lgkmcnt(2)
    v_add_f32 v72, v72, v36
    v_add_f32 v73, v73, v37
    v_mfma_f32_16x16x32_bf16 v[80:83], v[240:243], v[28:31], v[80:83]
    v_add_f32 v74, v74, v38
    v_add_f32 v75, v75, v39
    v_mfma_f32_16x16x32_bf16 v[84:87], v[244:247], v[28:31], v[84:87]
    s_waitcnt lgkmcnt(1)
    v_add_f32 v72, v72, v40
    v_add_f32 v73, v73, v41
    v_mfma_f32_16x16x32_bf16 v[88:91], v[248:251], v[28:31], v[88:91]
    v_add_f32 v74, v74, v42
    v_add_f32 v75, v75, v43
    s_cmp_lg_u32 s71, 2
    v_mfma_f32_16x16x32_bf16 v[92:95], v[252:255], v[28:31], v[92:95]
    s_cbranch_scc1 L_nost_59
    buffer_store_dwordx4 v[72:75], v52, s[8:11], s6 offen sc1
L_nost_59:
    ds_read_b128 v[28:31], v4 offset:35840
    v_mfma_f32_16x16x32_bf16 v[56:59], v[96:99], v[16:19], 0
    s_sub_u32 s6, s71, 4
    s_and_b32 s6, s6, 3
    s_mul_i32 s7, s6, 5120
    v_mfma_f32_16x16x32_bf16 v[60:63], v[100:103], v[16:19], 0
    s_add_u32 s7, s7, s67
    s_cmp_eq_u32 s6, 3
    s_cselect_b32 s7, 124928, s7
    v_mfma_f32_16x16x32_bf16 v[64:67], v[104:107], v[16:19], 0
    v_add_u32 v12, s7, v52
    v_add_u32 v5, s67, v45
    v_mfma_f32_16x16x32_bf16 v[68:71], v[108:111], v[16:19], 0
    v_mfma_f32_16x16x32_bf16 v[72:75], v[112:115], v[16:19], 0
    ds_read_b128 v[16:19], v4 offset:36864
    v_mfma_f32_16x16x32_bf16 v[56:59], v[116:119], v[20:23], v[56:59]
    ds_write_b128 v5, v[80:83] offset:30720
    v_add_u32 v5, s67, v46
    v_mfma_f32_16x16x32_bf16 v[60:63], v[120:123], v[20:23], v[60:63]
    v_mfma_f32_16x16x32_bf16 v[64:67], v[124:127], v[20:23], v[64:67]
    v_mfma_f32_16x16x32_bf16 v[68:71], v[128:131], v[20:23], v[68:71]
    s_waitcnt lgkmcnt(3)
    v_mfma_f32_16x16x32_bf16 v[72:75], v[132:135], v[20:23], v[72:75]
    ds_read_b128 v[20:23], v4 offset:37888
    v_mfma_f32_16x16x32_bf16 v[56:59], v[136:139], v[24:27], v[56:59]
    ds_write_b128 v5, v[84:87] offset:35840
    v_add_u32 v5, s67, v47
    v_mfma_f32_16x16x32_bf16 v[60:63], v[140:143], v[24:27], v[60:63]
    v_mfma_f32_16x16x32_bf16 v[64:67], v[144:147], v[24:27], v[64:67]
    v_mfma_f32_16x16x32_bf16 v[68:71], v[148:151], v[24:27], v[68:71]
    s_waitcnt lgkmcnt(4)
    v_mfma_f32_16x16x32_bf16 v[72:75], v[152:155], v[24:27], v[72:75]
    ds_read_b128 v[24:27], v4 offset:38912
    v_mfma_f32_16x16x32_bf16 v[56:59], v[156:159], v[28:31], v[56:59]
    ds_write_b128 v5, v[88:91] offset:40960
    v_add_u32 v5, s67, v52
    v_mfma_f32_16x16x32_bf16 v[60:63], v[160:163], v[28:31], v[60:63]
    v_mfma_f32_16x16x32_bf16 v[64:67], v[164:167], v[28:31], v[64:67]
    v_mfma_f32_16x16x32_bf16 v[68:71], v[168:171], v[28:31], v[68:71]
    s_waitcnt lgkmcnt(5)
    v_mfma_f32_16x16x32_bf16 v[72:75], v[172:175], v[28:31], v[72:75]
    ds_read_b128 v[28:31], v4 offset:39936
    v_mfma_f32_16x16x32_bf16 v[56:59], v[176:179], v[16:19], v[56:59]
    ds_write_b128 v12, v[92:95] offset:30720
    v_mfma_f32_16x16x32_bf16 v[60:63], v[180:183], v[16:19], v[60:63]
    s_add_u32 s65, s61, 0
    s_and_b32 s65, s65, 3
    s_andn2_b32 s7, s61, 3
    v_mfma_f32_16x16x32_bf16 v[64:67], v[184:187], v[16:19], v[64:67]
    s_add_u32 s65, s65, s7
    s_lshl_b32 s65, s65, 17
    s_add_u32 s65, s65, s66
    v_mfma_f32_16x16x32_bf16 v[68:71], v[188:191], v[16:19], v[68:71]
    s_waitcnt lgkmcnt(5)
    s_add_u32 m0, s99, 32768
    v_mfma_f32_16x16x32_bf16 v[72:75], v[192:195], v[16:19], v[72:75]
    s_waitcnt vmcnt(5)
    s_waitcnt lgkmcnt(0)
    s_barrier
    ds_read_b128 v[32:35], v6 offset:30720
    ds_read_b128 v[36:39], v6 offset:35840
    ds_read_b128 v[40:43], v6 offset:40960
    ds_read_b128 v[16:19], v7 offset:0
    v_mfma_f32_16x16x32_bf16 v[56:59], v[196:199], v[20:23], v[56:59]
    buffer_load_dwordx4 v13, s[8:11], s65 offen offset:0 sc1 lds
    v_mfma_f32_16x16x32_bf16 v[60:63], v[200:203], v[20:23], v[60:63]
    buffer_load_dwordx4 v13, s[8:11], s65 offen offset:1024 sc1 lds
    v_mfma_f32_16x16x32_bf16 v[64:67], v[204:207], v[20:23], v[64:67]
    s_waitcnt lgkmcnt(3)
    v_add_f32 v76, v76, v32
    v_add_f32 v77, v77, v33
    v_mfma_f32_16x16x32_bf16 v[68:71], v[208:211], v[20:23], v[68:71]
    buffer_load_dwordx4 v13, s[8:11], s65 offen offset:2048 sc1 lds
    v_add_f32 v78, v78, v34
    v_add_f32 v79, v79, v35
    v_mfma_f32_16x16x32_bf16 v[72:75], v[212:215], v[20:23], v[72:75]
    s_waitcnt lgkmcnt(2)
    ds_read_b128 v[32:35], v5 offset:30720
    ds_read_b128 v[20:23], v7 offset:1024
    v_add_f32 v76, v76, v36
    v_add_f32 v77, v77, v37
    v_mfma_f32_16x16x32_bf16 v[56:59], v[216:219], v[24:27], v[56:59]
    buffer_load_dwordx4 v13, s[8:11], s65 offen offset:3072 sc1 lds
    v_add_f32 v78, v78, v38
    v_add_f32 v79, v79, v39
    v_mfma_f32_16x16x32_bf16 v[60:63], v[220:223], v[24:27], v[60:63]
    s_waitcnt lgkmcnt(3)
    ds_read_b128 v[36:39], v5 offset:35840
    v_add_f32 v76, v76, v40
    v_add_f32 v77, v77, v41
    v_mfma_f32_16x16x32_bf16 v[64:67], v[224:227], v[24:27], v[64:67]
    v_add_f32 v78, v78, v42
    v_add_f32 v79, v79, v43
    v_mfma_f32_16x16x32_bf16 v[68:71], v[228:231], v[24:27], v[68:71]
    ds_read_b128 v[40:43], v5 offset:40960
    s_waitcnt lgkmcnt(3)
    v_add_f32 v92, v92, v32
    v_add_f32 v93, v93, v33
    s_add_u32 s6, s96, 10240
    v_mfma_f32_16x16x32_bf16 v[72:75], v[232:235], v[24:27], v[72:75]
    ds_read_b128 v[24:27], v7 offset:2048
    v_add_f32 v94, v94, v34
    v_add_f32 v95, v95, v35
    v_mfma_f32_16x16x32_bf16 v[56:59], v[236:239], v[28:31], v[56:59]
    buffer_store_dwordx4 v[76:79], v44, s[8:11], s6 offen sc1
    s_waitcnt lgkmcnt(2)
    v_add_f32 v92, v92, v36
    v_add_f32 v93, v93, v37
    v_mfma_f32_16x16x32_bf16 v[60:63], v[240:243], v[28:31], v[60:63]
    v_add_f32 v94, v94, v38
    v_add_f32 v95, v95, v39
    v_mfma_f32_16x16x32_bf16 v[64:67], v[244:247], v[28:31], v[64:67]
    s_waitcnt lgkmcnt(1)
    v_add_f32 v92, v92, v40
    v_add_f32 v93, v93, v41
    v_mfma_f32_16x16x32_bf16 v[68:71], v[248:251], v[28:31], v[68:71]
    v_add_f32 v94, v94, v42
    v_add_f32 v95, v95, v43
    s_cmp_lg_u32 s71, 3
    v_mfma_f32_16x16x32_bf16 v[72:75], v[252:255], v[28:31], v[72:75]
    s_cbranch_scc1 L_nost_60
    buffer_store_dwordx4 v[92:95], v52, s[8:11], s6 offen sc1
L_nost_60:
    ds_read_b128 v[28:31], v7 offset:3072
    v_mfma_f32_16x16x32_bf16 v[76:79], v[96:99], v[16:19], 0
    s_sub_u32 s6, s71, 5
    s_and_b32 s6, s6, 3
    s_mul_i32 s7, s6, 5120
    v_mfma_f32_16x16x32_bf16 v[80:83], v[100:103], v[16:19], 0
    s_add_u32 s7, s7, s67
    s_cmp_eq_u32 s6, 3
    s_cselect_b32 s7, 155648, s7
    v_mfma_f32_16x16x32_bf16 v[84:87], v[104:107], v[16:19], 0
    v_add_u32 v12, s7, v52
    v_add_u32 v5, s67, v45
    v_mfma_f32_16x16x32_bf16 v[88:91], v[108:111], v[16:19], 0
    v_mfma_f32_16x16x32_bf16 v[92:95], v[112:115], v[16:19], 0
    ds_read_b128 v[16:19], v7 offset:4096
    v_mfma_f32_16x16x32_bf16 v[76:79], v[116:119], v[20:23], v[76:79]
    ds_write_b128 v5, v[60:63] offset:0
    v_add_u32 v5, s67, v46
    v_mfma_f32_16x16x32_bf16 v[80:83], v[120:123], v[20:23], v[80:83]
    v_mfma_f32_16x16x32_bf16 v[84:87], v[124:127], v[20:23], v[84:87]
    v_mfma_f32_16x16x32_bf16 v[88:91], v[128:131], v[20:23], v[88:91]
    s_waitcnt lgkmcnt(3)
    v_mfma_f32_16x16x32_bf16 v[92:95], v[132:135], v[20:23], v[92:95]
    ds_read_b128 v[20:23], v7 offset:5120
    v_mfma_f32_16x16x32_bf16 v[76:79], v[136:139], v[24:27], v[76:79]
    ds_write_b128 v5, v[64:67] offset:5120
    v_add_u32 v5, s67, v47
    v_mfma_f32_16x16x32_bf16 v[80:83], v[140:143], v[24:27], v[80:83]
    v_mfma_f32_16x16x32_bf16 v[84:87], v[144:147], v[24:27], v[84:87]
    v_mfma_f32_16x16x32_bf16 v[88:91], v[148:151], v[24:27], v[88:91]
    s_waitcnt lgkmcnt(4)
    v_mfma_f32_16x16x32_bf16 v[92:95], v[152:155], v[24:27], v[92:95]
    ds_read_b128 v[24:27], v7 offset:6144
    v_mfma_f32_16x16x32_bf16 v[76:79], v[156:159], v[28:31], v[76:79]
    ds_write_b128 v5, v[68:71] offset:10240
    v_add_u32 v5, s67, v52
    v_mfma_f32_16x16x32_bf16 v[80:83], v[160:163], v[28:31], v[80:83]
    v_mfma_f32_16x16x32_bf16 v[84:87], v[164:167], v[28:31], v[84:87]
    v_mfma_f32_16x16x32_bf16 v[88:91], v[168:171], v[28:31], v[88:91]
    s_waitcnt lgkmcnt(5)
    v_mfma_f32_16x16x32_bf16 v[92:95], v[172:175], v[28:31], v[92:95]
    ds_read_b128 v[28:31], v7 offset:7168
    v_mfma_f32_16x16x32_bf16 v[76:79], v[176:179], v[16:19], v[76:79]
    ds_write_b128 v12, v[72:75] offset:0
    v_mfma_f32_16x16x32_bf16 v[80:83], v[180:183], v[16:19], v[80:83]
    v_mfma_f32_16x16x32_bf16 v[84:87], v[184:187], v[16:19], v[84:87]
    v_mfma_f32_16x16x32_bf16 v[88:91], v[188:191], v[16:19], v[88:91]
    s_waitcnt lgkmcnt(5)
    v_mfma_f32_16x16x32_bf16 v[92:95], v[192:195], v[16:19], v[92:95]
    s_waitcnt vmcnt(5)
    s_waitcnt lgkmcnt(0)
    s_barrier
    ds_read_b128 v[32:35], v6 offset:0
    ds_read_b128 v[36:39], v6 offset:5120
    ds_read_b128 v[40:43], v6 offset:10240
    ds_read_b128 v[16:19], v4 offset:0
    v_mfma_f32_16x16x32_bf16 v[76:79], v[196:199], v[20:23], v[76:79]
    v_mfma_f32_16x16x32_bf16 v[80:83], v[200:203], v[20:23], v[80:83]
    v_mfma_f32_16x16x32_bf16 v[84:87], v[204:207], v[20:23], v[84:87]
    s_waitcnt lgkmcnt(3)
    v_add_f32 v56, v56, v32
    v_add_f32 v57, v57, v33
    v_mfma_f32_16x16x32_bf16 v[88:91], v[208:211], v[20:23], v[88:91]
    v_add_f32 v58, v58, v34
    v_add_f32 v59, v59, v35
    v_mfma_f32_16x16x32_bf16 v[92:95], v[212:215], v[20:23], v[92:95]
    s_waitcnt lgkmcnt(2)
    ds_read_b128 v[32:35], v5 offset:0
    ds_read_b128 v[20:23], v4 offset:1024
    v_add_f32 v56, v56, v36
    v_add_f32 v57, v57, v37
    v_mfma_f32_16x16x32_bf16 v[76:79], v[216:219], v[24:27], v[76:79]
    v_add_f32 v58, v58, v38
    v_add_f32 v59, v59, v39
    v_mfma_f32_16x16x32_bf16 v[80:83], v[220:223], v[24:27], v[80:83]
    s_waitcnt lgkmcnt(3)
    ds_read_b128 v[36:39], v5 offset:5120
    v_add_f32 v56, v56, v40
    v_add_f32 v57, v57, v41
    v_mfma_f32_16x16x32_bf16 v[84:87], v[224:227], v[24:27], v[84:87]
    v_add_f32 v58, v58, v42
    v_add_f32 v59, v59, v43
    v_mfma_f32_16x16x32_bf16 v[88:91], v[228:231], v[24:27], v[88:91]
    ds_read_b128 v[40:43], v5 offset:10240
    s_waitcnt lgkmcnt(3)
    v_add_f32 v72, v72, v32
    v_add_f32 v73, v73, v33
    s_add_u32 s6, s97, 10240
    v_mfma_f32_16x16x32_bf16 v[92:95], v[232:235], v[24:27], v[92:95]
    ds_read_b128 v[24:27], v4 offset:2048
    v_add_f32 v74, v74, v34
    v_add_f32 v75, v75, v35
    v_mfma_f32_16x16x32_bf16 v[76:79], v[236:239], v[28:31], v[76:79]
    buffer_store_dwordx4 v[56:59], v44, s[8:11], s6 offen sc1
    s_waitcnt lgkmcnt(2)
    v_add_f32 v72, v72, v36
    v_add_f32 v73, v73, v37
    v_mfma_f32_16x16x32_bf16 v[80:83], v[240:243], v[28:31], v[80:83]
    v_add_f32 v74, v74, v38
    v_add_f32 v75, v75, v39
    v_mfma_f32_16x16x32_bf16 v[84:87], v[244:247], v[28:31], v[84:87]
    s_waitcnt lgkmcnt(1)
    v_add_f32 v72, v72, v40
    v_add_f32 v73, v73, v41
    v_mfma_f32_16x16x32_bf16 v[88:91], v[248:251], v[28:31], v[88:91]
    v_add_f32 v74, v74, v42
    v_add_f32 v75, v75, v43
    s_cmp_lg_u32 s71, 0
    v_mfma_f32_16x16x32_bf16 v[92:95], v[252:255], v[28:31], v[92:95]
    s_cbranch_scc1 L_nost_61
    buffer_store_dwordx4 v[72:75], v52, s[8:11], s6 offen sc1
L_nost_61:
    ds_read_b128 v[28:31], v4 offset:3072
    v_mfma_f32_16x16x32_bf16 v[56:59], v[96:99], v[16:19], 0
    s_sub_u32 s6, s71, 6
    s_and_b32 s6, s6, 3
    s_mul_i32 s7, s6, 5120
    v_mfma_f32_16x16x32_bf16 v[60:63], v[100:103], v[16:19], 0
    s_add_u32 s7, s7, s67
    s_cmp_eq_u32 s6, 3
    s_cselect_b32 s7, 124928, s7
    v_mfma_f32_16x16x32_bf16 v[64:67], v[104:107], v[16:19], 0
    v_add_u32 v12, s7, v52
    v_add_u32 v5, s67, v45
    v_mfma_f32_16x16x32_bf16 v[68:71], v[108:111], v[16:19], 0
    v_mfma_f32_16x16x32_bf16 v[72:75], v[112:115], v[16:19], 0
    ds_read_b128 v[16:19], v4 offset:4096
    v_mfma_f32_16x16x32_bf16 v[56:59], v[116:119], v[20:23], v[56:59]
    ds_write_b128 v5, v[80:83] offset:30720
    v_add_u32 v5, s67, v46
    v_mfma_f32_16x16x32_bf16 v[60:63], v[120:123], v[20:23], v[60:63]
    v_mfma_f32_16x16x32_bf16 v[64:67], v[124:127], v[20:23], v[64:67]
    v_mfma_f32_16x16x32_bf16 v[68:71], v[128:131], v[20:23], v[68:71]
    s_waitcnt lgkmcnt(3)
    v_mfma_f32_16x16x32_bf16 v[72:75], v[132:135], v[20:23], v[72:75]
    ds_read_b128 v[20:23], v4 offset:5120
    v_mfma_f32_16x16x32_bf16 v[56:59], v[136:139], v[24:27], v[56:59]
    ds_write_b128 v5, v[84:87] offset:35840
    v_add_u32 v5, s67, v47
    v_mfma_f32_16x16x32_bf16 v[60:63], v[140:143], v[24:27], v[60:63]
    v_mfma_f32_16x16x32_bf16 v[64:67], v[144:147], v[24:27], v[64:67]
    v_mfma_f32_16x16x32_bf16 v[68:71], v[148:151], v[24:27], v[68:71]
    s_waitcnt lgkmcnt(4)
    v_mfma_f32_16x16x32_bf16 v[72:75], v[152:155], v[24:27], v[72:75]
    ds_read_b128 v[24:27], v4 offset:6144
    v_mfma_f32_16x16x32_bf16 v[56:59], v[156:159], v[28:31], v[56:59]
    ds_write_b128 v5, v[88:91] offset:40960
    v_add_u32 v5, s67, v52
    v_mfma_f32_16x16x32_bf16 v[60:63], v[160:163], v[28:31], v[60:63]
    v_mfma_f32_16x16x32_bf16 v[64:67], v[164:167], v[28:31], v[64:67]
    v_mfma_f32_16x16x32_bf16 v[68:71], v[168:171], v[28:31], v[68:71]
    s_waitcnt lgkmcnt(5)
    v_mfma_f32_16x16x32_bf16 v[72:75], v[172:175], v[28:31], v[72:75]
    ds_read_b128 v[28:31], v4 offset:7168
    v_mfma_f32_16x16x32_bf16 v[56:59], v[176:179], v[16:19], v[56:59]
    ds_write_b128 v12, v[92:95] offset:30720
    v_mfma_f32_16x16x32_bf16 v[60:63], v[180:183], v[16:19], v[60:63]
    v_mfma_f32_16x16x32_bf16 v[64:67], v[184:187], v[16:19], v[64:67]
    v_mov_b32 v2, 1
    v_writelane_b32 v2, 2, 0
    v_mfma_f32_16x16x32_bf16 v[68:71], v[188:191], v[16:19], v[68:71]
    s_waitcnt lgkmcnt(5)
    v_mfma_f32_16x16x32_bf16 v[72:75], v[192:195], v[16:19], v[72:75]
    s_waitcnt vmcnt(1)
    buffer_store_dword v2, v11, s[8:11], 0 offen sc1
    s_waitcnt lgkmcnt(0)
    s_barrier
    ds_read_b128 v[32:35], v6 offset:30720
    ds_read_b128 v[36:39], v6 offset:35840
    ds_read_b128 v[40:43], v6 offset:40960
    ds_read_b128 v[16:19], v4 offset:32768
    v_mfma_f32_16x16x32_bf16 v[56:59], v[196:199], v[20:23], v[56:59]
    v_mfma_f32_16x16x32_bf16 v[60:63], v[200:203], v[20:23], v[60:63]
    v_mfma_f32_16x16x32_bf16 v[64:67], v[204:207], v[20:23], v[64:67]
    s_waitcnt lgkmcnt(3)
    v_add_f32 v76, v76, v32
    v_add_f32 v77, v77, v33
    v_mfma_f32_16x16x32_bf16 v[68:71], v[208:211], v[20:23], v[68:71]
    v_add_f32 v78, v78, v34
    v_add_f32 v79, v79, v35
    v_mfma_f32_16x16x32_bf16 v[72:75], v[212:215], v[20:23], v[72:75]
    s_waitcnt lgkmcnt(2)
    ds_read_b128 v[32:35], v5 offset:30720
    ds_read_b128 v[20:23], v4 offset:33792
    v_add_f32 v76, v76, v36
    v_add_f32 v77, v77, v37
    v_mfma_f32_16x16x32_bf16 v[56:59], v[216:219], v[24:27], v[56:59]
    v_add_f32 v78, v78, v38
    v_add_f32 v79, v79, v39
    v_mfma_f32_16x16x32_bf16 v[60:63], v[220:223], v[24:27], v[60:63]
    s_waitcnt lgkmcnt(3)
    ds_read_b128 v[36:39], v5 offset:35840
    v_add_f32 v76, v76, v40
    v_add_f32 v77, v77, v41
    v_mfma_f32_16x16x32_bf16 v[64:67], v[224:227], v[24:27], v[64:67]
    v_add_f32 v78, v78, v42
    v_add_f32 v79, v79, v43
    v_mfma_f32_16x16x32_bf16 v[68:71], v[228:231], v[24:27], v[68:71]
    ds_read_b128 v[40:43], v5 offset:40960
    s_waitcnt lgkmcnt(3)
    v_add_f32 v92, v92, v32
    v_add_f32 v93, v93, v33
    s_add_u32 s6, s98, 10240
    v_mfma_f32_16x16x32_bf16 v[72:75], v[232:235], v[24:27], v[72:75]
    ds_read_b128 v[24:27], v4 offset:34816
    v_add_f32 v94, v94, v34
    v_add_f32 v95, v95, v35
    v_mfma_f32_16x16x32_bf16 v[56:59], v[236:239], v[28:31], v[56:59]
    buffer_store_dwordx4 v[76:79], v44, s[8:11], s6 offen sc1
    s_waitcnt lgkmcnt(2)
    v_add_f32 v92, v92, v36
    v_add_f32 v93, v93, v37
    v_mfma_f32_16x16x32_bf16 v[60:63], v[240:243], v[28:31], v[60:63]
    v_add_f32 v94, v94, v38
    v_add_f32 v95, v95, v39
    v_mfma_f32_16x16x32_bf16 v[64:67], v[244:247], v[28:31], v[64:67]
    s_waitcnt lgkmcnt(1)
    v_add_f32 v92, v92, v40
    v_add_f32 v93, v93, v41
    v_mfma_f32_16x16x32_bf16 v[68:71], v[248:251], v[28:31], v[68:71]
    v_add_f32 v94, v94, v42
    v_add_f32 v95, v95, v43
    s_cmp_lg_u32 s71, 1
    v_mfma_f32_16x16x32_bf16 v[72:75], v[252:255], v[28:31], v[72:75]
    s_cbranch_scc1 L_nost_62
    buffer_store_dwordx4 v[92:95], v52, s[8:11], s6 offen sc1
L_nost_62:
    ds_read_b128 v[28:31], v4 offset:35840
    v_mfma_f32_16x16x32_bf16 v[76:79], v[96:99], v[16:19], 0
    v_mfma_f32_16x16x32_bf16 v[80:83], v[100:103], v[16:19], 0
    v_mfma_f32_16x16x32_bf16 v[84:87], v[104:107], v[16:19], 0
    s_mul_i32 s73, s3, 5120
    s_add_u32 s6, s73, 65536
    v_mfma_f32_16x16x32_bf16 v[88:91], v[108:111], v[16:19], 0
    v_add_u32 v5, s6, v44
    v_mfma_f32_16x16x32_bf16 v[92:95], v[112:115], v[16:19], 0
    ds_read_b128 v[16:19], v4 offset:36864
    v_mfma_f32_16x16x32_bf16 v[76:79], v[116:119], v[20:23], v[76:79]
    ds_write_b128 v5, v[56:59]
    s_add_u32 s6, s73, 65536
    v_add_u32 v5, s6, v45
    v_mfma_f32_16x16x32_bf16 v[80:83], v[120:123], v[20:23], v[80:83]
    v_mfma_f32_16x16x32_bf16 v[84:87], v[124:127], v[20:23], v[84:87]
    v_mfma_f32_16x16x32_bf16 v[88:91], v[128:131], v[20:23], v[88:91]
    s_waitcnt lgkmcnt(3)
    v_mfma_f32_16x16x32_bf16 v[92:95], v[132:135], v[20:23], v[92:95]
    ds_read_b128 v[20:23], v4 offset:37888
    v_mfma_f32_16x16x32_bf16 v[76:79], v[136:139], v[24:27], v[76:79]
    ds_write_b128 v5, v[60:63]
    s_add_u32 s6, s73, 65536
    v_add_u32 v5, s6, v46
    v_mfma_f32_16x16x32_bf16 v[80:83], v[140:143], v[24:27], v[80:83]
    v_mfma_f32_16x16x32_bf16 v[84:87], v[144:147], v[24:27], v[84:87]
    v_mfma_f32_16x16x32_bf16 v[88:91], v[148:151], v[24:27], v[88:91]
    s_waitcnt lgkmcnt(4)
    v_mfma_f32_16x16x32_bf16 v[92:95], v[152:155], v[24:27], v[92:95]
    ds_read_b128 v[24:27], v4 offset:38912
    v_mfma_f32_16x16x32_bf16 v[76:79], v[156:159], v[28:31], v[76:79]
    ds_write_b128 v5, v[64:67]
    s_add_u32 s6, s73, 65536
    v_add_u32 v5, s6, v47
    v_mfma_f32_16x16x32_bf16 v[80:83], v[160:163], v[28:31], v[80:83]
    v_mov_b32 v2, 2
    s_waitcnt vmcnt(0)
    buffer_store_dword v2, v11, s[8:11], 0 offen sc1
    v_mfma_f32_16x16x32_bf16 v[84:87], v[164:167], v[28:31], v[84:87]
    v_mfma_f32_16x16x32_bf16 v[88:91], v[168:171], v[28:31], v[88:91]
    s_waitcnt lgkmcnt(5)
    s_cmp_eq_u32 s64, 0
    s_cbranch_scc1 L_nb
    v_bfe_u32 v2, v1, 1, 3
    v_and_b32 v3, 1, v1
    v_lshl_add_u32 v3, v2, 7, v3
    v_lshlrev_b32 v3, 2, v3
    s_and_b32 s6, s4, 3
    s_lshl_b32 s6, s6, 7
    s_add_u32 s6, s6, 3911680
    s_mov_b32 s79, 262144
L_poll_63:
    buffer_load_dword v2, v3, s[8:11], s6 offen sc1
    s_waitcnt vmcnt(0)
    v_cmp_ne_u32 vcc, 1, v2
    s_cbranch_vccz L_polldone_64
    s_sleep 2
    s_sub_u32 s79, s79, 1
    s_cmp_lg_u32 s79, 0
    s_cbranch_scc1 L_poll_63
L_polldone_64:
L_nb:
    buffer_load_dwordx4 v[96:99], v53, s[12:15], s70 offen
    buffer_load_dwordx4 v[100:103], v48, s[8:11], 0 offen sc1
    s_cmp_ge_u32 s3, 2
    s_cbranch_scc1 L_itskip_65
    buffer_load_dwordx4 v[104:107], v54, s[12:15], s70 offen
    buffer_load_dwordx4 v[108:111], v49, s[8:11], 0 offen sc1
L_itskip_65:
    v_mfma_f32_16x16x32_bf16 v[92:95], v[172:175], v[28:31], v[92:95]
    ds_read_b128 v[28:31], v4 offset:39936
    v_mfma_f32_16x16x32_bf16 v[76:79], v[176:179], v[16:19], v[76:79]
    ds_write_b128 v5, v[68:71]
    s_add_u32 s6, s73, 65536
    v_add_u32 v5, s6, v52
    v_mfma_f32_16x16x32_bf16 v[80:83], v[180:183], v[16:19], v[80:83]
    v_mfma_f32_16x16x32_bf16 v[84:87], v[184:187], v[16:19], v[84:87]
    v_mfma_f32_16x16x32_bf16 v[88:91], v[188:191], v[16:19], v[88:91]
    s_waitcnt lgkmcnt(5)
    v_mfma_f32_16x16x32_bf16 v[92:95], v[192:195], v[16:19], v[92:95]
    v_mfma_f32_16x16x32_bf16 v[76:79], v[196:199], v[20:23], v[76:79]
    ds_write_b128 v5, v[72:75]
    v_mfma_f32_16x16x32_bf16 v[80:83], v[200:203], v[20:23], v[80:83]
    v_mfma_f32_16x16x32_bf16 v[84:87], v[204:207], v[20:23], v[84:87]
    v_mfma_f32_16x16x32_bf16 v[88:91], v[208:211], v[20:23], v[88:91]
    s_waitcnt lgkmcnt(4)
    v_mfma_f32_16x16x32_bf16 v[92:95], v[212:215], v[20:23], v[92:95]
    v_mfma_f32_16x16x32_bf16 v[76:79], v[216:219], v[24:27], v[76:79]
    v_bfe_u32 v2, v1, 3, 2
    v_min_u32 v2, 2, v2
    v_and_b32 v3, 7, v1
    v_lshlrev_b32 v3, 2, v3
    v_lshl_add_u32 v3, v2, 7, v3
    v_mfma_f32_16x16x32_bf16 v[80:83], v[220:223], v[24:27], v[80:83]
    s_bitcmp1_b32 13, s3
    s_cselect_b32 s77, 1, 2
    buffer_load_dword v50, v3, s[8:11], s63 offen sc1
    v_mfma_f32_16x16x32_bf16 v[84:87], v[224:227], v[24:27], v[84:87]
    v_mfma_f32_16x16x32_bf16 v[88:91], v[228:231], v[24:27], v[88:91]
    s_waitcnt lgkmcnt(2)
    s_add_u32 s6, s73, 86016
    s_cmp_lt_u32 s3, 4
    s_cselect_b32 s73, s73, s6
    v_mfma_f32_16x16x32_bf16 v[92:95], v[232:235], v[24:27], v[92:95]
    v_mfma_f32_16x16x32_bf16 v[76:79], v[236:239], v[28:31], v[76:79]
    v_mfma_f32_16x16x32_bf16 v[80:83], v[240:243], v[28:31], v[80:83]
    v_mfma_f32_16x16x32_bf16 v[84:87], v[244:247], v[28:31], v[84:87]
    v_mfma_f32_16x16x32_bf16 v[88:91], v[248:251], v[28:31], v[88:91]
    v_mfma_f32_16x16x32_bf16 v[92:95], v[252:255], v[28:31], v[92:95]
    s_nop 4
    v_add_u32 v5, s73, v44
    ds_write_b128 v5, v[76:79]
    v_add_u32 v5, s73, v45
    ds_write_b128 v5, v[80:83]
    v_add_u32 v5, s73, v46
    ds_write_b128 v5, v[84:87]
    v_add_u32 v5, s73, v47
    ds_write_b128 v5, v[88:91]
    v_add_u32 v5, s73, v52
    ds_write_b128 v5, v[92:95]
    s_waitcnt vmcnt(0)
    v_cmp_gt_u32 s[78:79], s77, v50
    s_nop 3
    s_cmp_lg_u64 s[78:79], 0
    s_cbranch_scc1 L_x2a
    s_add_u32 s6, s62, 0
    buffer_load_dwordx4 v[112:115], v8, s[8:11], s6 offen offset:0 sc1
    buffer_load_dwordx4 v[116:119], v8, s[8:11], s6 offen offset:256 sc1
    s_add_u32 s6, s62, 20480
    buffer_load_dwordx4 v[120:123], v8, s[8:11], s6 offen offset:0 sc1
    buffer_load_dwordx4 v[124:127], v8, s[8:11], s6 offen offset:256 sc1
    s_add_u32 s6, s62, 40960
    buffer_load_dwordx4 v[128:131], v8, s[8:11], s6 offen offset:0 sc1
    buffer_load_dwordx4 v[132:135], v8, s[8:11], s6 offen offset:256 sc1
    s_cmp_ge_u32 s3, 2
    s_cbranch_scc1 L_xi_66
    s_add_u32 s6, s62, 0
    buffer_load_dwordx4 v[136:139], v9, s[8:11], s6 offen offset:0 sc1
    buffer_load_dwordx4 v[140:143], v9, s[8:11], s6 offen offset:256 sc1
    s_add_u32 s6, s62, 20480
    buffer_load_dwordx4 v[144:147], v9, s[8:11], s6 offen offset:0 sc1
    buffer_load_dwordx4 v[148:151], v9, s[8:11], s6 offen offset:256 sc1
    s_add_u32 s6, s62, 40960
    buffer_load_dwordx4 v[152:155], v9, s[8:11], s6 offen offset:0 sc1
    buffer_load_dwordx4 v[156:159], v9, s[8:11], s6 offen offset:256 sc1
L_xi_66:
L_x2a:
    s_waitcnt lgkmcnt(0)
    s_barrier
    ds_read_b128 v[160:163], v10 offset:0
    ds_read_b128 v[164:167], v10 offset:256
    ds_read_b128 v[168:171], v10 offset:5120
    ds_read_b128 v[172:175], v10 offset:5376
    ds_read_b128 v[176:179], v10 offset:10240
    ds_read_b128 v[180:183], v10 offset:10496
    ds_read_b128 v[184:187], v10 offset:15360
    ds_read_b128 v[188:191], v10 offset:15616
    ds_read_b128 v[192:195], v55 offset:0
    ds_read_b128 v[196:199], v55 offset:256
    ds_read_b128 v[200:203], v55 offset:5120
    ds_read_b128 v[204:207], v55 offset:5376
    ds_read_b128 v[208:211], v55 offset:10240
    ds_read_b128 v[212:215], v55 offset:10496
    ds_read_b128 v[216:219], v55 offset:15360
    ds_read_b128 v[220:223], v55 offset:15616
    s_cmp_eq_u64 s[78:79], 0
    s_cbranch_scc1 L_x2b
    s_mov_b32 s79, 262144
L_poll_67:
    buffer_load_dword v2, v3, s[8:11], s63 offen sc1
    s_waitcnt vmcnt(0)
    v_cmp_gt_u32 vcc, s77, v2
    s_cbranch_vccz L_polldone_68
    s_sleep 1
    s_sub_u32 s79, s79, 1
    s_cmp_lg_u32 s79, 0
    s_cbranch_scc1 L_poll_67
L_polldone_68:
    s_add_u32 s6, s62, 0
    buffer_load_dwordx4 v[112:115], v8, s[8:11], s6 offen offset:0 sc1
    buffer_load_dwordx4 v[116:119], v8, s[8:11], s6 offen offset:256 sc1
    s_add_u32 s6, s62, 20480
    buffer_load_dwordx4 v[120:123], v8, s[8:11], s6 offen offset:0 sc1
    buffer_load_dwordx4 v[124:127], v8, s[8:11], s6 offen offset:256 sc1
    s_add_u32 s6, s62, 40960
    buffer_load_dwordx4 v[128:131], v8, s[8:11], s6 offen offset:0 sc1
    buffer_load_dwordx4 v[132:135], v8, s[8:11], s6 offen offset:256 sc1
    s_cmp_ge_u32 s3, 2
    s_cbranch_scc1 L_xi_69
    s_add_u32 s6, s62, 0
    buffer_load_dwordx4 v[136:139], v9, s[8:11], s6 offen offset:0 sc1
    buffer_load_dwordx4 v[140:143], v9, s[8:11], s6 offen offset:256 sc1
    s_add_u32 s6, s62, 20480
    buffer_load_dwordx4 v[144:147], v9, s[8:11], s6 offen offset:0 sc1
    buffer_load_dwordx4 v[148:151], v9, s[8:11], s6 offen offset:256 sc1
    s_add_u32 s6, s62, 40960
    buffer_load_dwordx4 v[152:155], v9, s[8:11], s6 offen offset:0 sc1
    buffer_load_dwordx4 v[156:159], v9, s[8:11], s6 offen offset:256 sc1
L_xi_69:
L_x2b:
    s_mov_b32 s16, s54
    s_mov_b32 s17, s55
    s_mov_b32 s18, 0x280000
    s_mov_b32 s19, 0x20000
    s_waitcnt lgkmcnt(8)
    v_pk_add_f32 v[160:161], v[160:161], v[168:169]
    v_pk_add_f32 v[162:163], v[162:163], v[170:171]
    v_pk_add_f32 v[164:165], v[164:165], v[172:173]
    v_pk_add_f32 v[166:167], v[166:167], v[174:175]
    v_pk_add_f32 v[160:161], v[160:161], v[176:177]
    v_pk_add_f32 v[162:163], v[162:163], v[178:179]
    v_pk_add_f32 v[164:165], v[164:165], v[180:181]
    v_pk_add_f32 v[166:167], v[166:167], v[182:183]
    v_pk_add_f32 v[160:161], v[160:161], v[184:185]
    v_pk_add_f32 v[162:163], v[162:163], v[186:187]
    v_pk_add_f32 v[164:165], v[164:165], v[188:189]
    v_pk_add_f32 v[166:167], v[166:167], v[190:191]
    s_waitcnt vmcnt(0)
    v_pk_add_f32 v[160:161], v[160:161], v[112:113]
    v_pk_add_f32 v[162:163], v[162:163], v[114:115]
    v_pk_add_f32 v[164:165], v[164:165], v[116:117]
    v_pk_add_f32 v[166:167], v[166:167], v[118:119]
    v_pk_add_f32 v[160:161], v[160:161], v[120:121]
    v_pk_add_f32 v[162:163], v[162:163], v[122:123]
    v_pk_add_f32 v[164:165], v[164:165], v[124:125]
    v_pk_add_f32 v[166:167], v[166:167], v[126:127]
    v_pk_add_f32 v[160:161], v[160:161], v[128:129]
    v_pk_add_f32 v[162:163], v[162:163], v[130:131]
    v_pk_add_f32 v[164:165], v[164:165], v[132:133]
    v_pk_add_f32 v[166:167], v[166:167], v[134:135]
    v_cvt_pk_bf16_f32 v2, v160, v161
    v_lshlrev_b32 v160, 16, v2
    v_and_b32 v161, 0xffff0000, v2
    v_lshlrev_b32 v2, 16, v96
    v_and_b32 v3, 0xffff0000, v96
    v_pk_add_f32 v[160:161], v[160:161], v[2:3]
    v_cvt_pk_bf16_f32 v2, v160, v161
    v_lshlrev_b32 v160, 16, v2
    v_and_b32 v161, 0xffff0000, v2
    v_lshlrev_b32 v2, 16, v100
    v_and_b32 v3, 0xffff0000, v100
    v_pk_add_f32 v[160:161], v[160:161], v[2:3]
    v_cvt_pk_bf16_f32 v224, v160, v161
    v_cvt_pk_bf16_f32 v2, v162, v163
    v_lshlrev_b32 v162, 16, v2
    v_and_b32 v163, 0xffff0000, v2
    v_lshlrev_b32 v2, 16, v97
    v_and_b32 v3, 0xffff0000, v97
    v_pk_add_f32 v[162:163], v[162:163], v[2:3]
    v_cvt_pk_bf16_f32 v2, v162, v163
    v_lshlrev_b32 v162, 16, v2
    v_and_b32 v163, 0xffff0000, v2
    v_lshlrev_b32 v2, 16, v101
    v_and_b32 v3, 0xffff0000, v101
    v_pk_add_f32 v[162:163], v[162:163], v[2:3]
    v_cvt_pk_bf16_f32 v225, v162, v163
    v_cvt_pk_bf16_f32 v2, v164, v165
    v_lshlrev_b32 v164, 16, v2
    v_and_b32 v165, 0xffff0000, v2
    v_lshlrev_b32 v2, 16, v98
    v_and_b32 v3, 0xffff0000, v98
    v_pk_add_f32 v[164:165], v[164:165], v[2:3]
    v_cvt_pk_bf16_f32 v2, v164, v165
    v_lshlrev_b32 v164, 16, v2
    v_and_b32 v165, 0xffff0000, v2
    v_lshlrev_b32 v2, 16, v102
    v_and_b32 v3, 0xffff0000, v102
    v_pk_add_f32 v[164:165], v[164:165], v[2:3]
    v_cvt_pk_bf16_f32 v226, v164, v165
    v_cvt_pk_bf16_f32 v2, v166, v167
    v_lshlrev_b32 v166, 16, v2
    v_and_b32 v167, 0xffff0000, v2
    v_lshlrev_b32 v2, 16, v99
    v_and_b32 v3, 0xffff0000, v99
    v_pk_add_f32 v[166:167], v[166:167], v[2:3]
    v_cvt_pk_bf16_f32 v2, v166, v167
    v_lshlrev_b32 v166, 16, v2
    v_and_b32 v167, 0xffff0000, v2
    v_lshlrev_b32 v2, 16, v103
    v_and_b32 v3, 0xffff0000, v103
    v_pk_add_f32 v[166:167], v[166:167], v[2:3]
    v_cvt_pk_bf16_f32 v227, v166, v167
    buffer_store_dwordx4 v[224:227], v53, s[16:19], s70 offen
    s_cmp_ge_u32 s3, 2
    s_cbranch_scc1 L_end
    s_waitcnt lgkmcnt(0)
    v_pk_add_f32 v[192:193], v[192:193], v[200:201]
    v_pk_add_f32 v[194:195], v[194:195], v[202:203]
    v_pk_add_f32 v[196:197], v[196:197], v[204:205]
    v_pk_add_f32 v[198:199], v[198:199], v[206:207]
    v_pk_add_f32 v[192:193], v[192:193], v[208:209]
    v_pk_add_f32 v[194:195], v[194:195], v[210:211]
    v_pk_add_f32 v[196:197], v[196:197], v[212:213]
    v_pk_add_f32 v[198:199], v[198:199], v[214:215]
    v_pk_add_f32 v[192:193], v[192:193], v[216:217]
    v_pk_add_f32 v[194:195], v[194:195], v[218:219]
    v_pk_add_f32 v[196:197], v[196:197], v[220:221]
    v_pk_add_f32 v[198:199], v[198:199], v[222:223]
    s_nop 0
    v_pk_add_f32 v[192:193], v[192:193], v[136:137]
    v_pk_add_f32 v[194:195], v[194:195], v[138:139]
    v_pk_add_f32 v[196:197], v[196:197], v[140:141]
    v_pk_add_f32 v[198:199], v[198:199], v[142:143]
    v_pk_add_f32 v[192:193], v[192:193], v[144:145]
    v_pk_add_f32 v[194:195], v[194:195], v[146:147]
    v_pk_add_f32 v[196:197], v[196:197], v[148:149]
    v_pk_add_f32 v[198:199], v[198:199], v[150:151]
    v_pk_add_f32 v[192:193], v[192:193], v[152:153]
    v_pk_add_f32 v[194:195], v[194:195], v[154:155]
    v_pk_add_f32 v[196:197], v[196:197], v[156:157]
    v_pk_add_f32 v[198:199], v[198:199], v[158:159]
    v_cvt_pk_bf16_f32 v2, v192, v193
    v_lshlrev_b32 v192, 16, v2
    v_and_b32 v193, 0xffff0000, v2
    v_lshlrev_b32 v2, 16, v104
    v_and_b32 v3, 0xffff0000, v104
    v_pk_add_f32 v[192:193], v[192:193], v[2:3]
    v_cvt_pk_bf16_f32 v2, v192, v193
    v_lshlrev_b32 v192, 16, v2
    v_and_b32 v193, 0xffff0000, v2
    v_lshlrev_b32 v2, 16, v108
    v_and_b32 v3, 0xffff0000, v108
    v_pk_add_f32 v[192:193], v[192:193], v[2:3]
    v_cvt_pk_bf16_f32 v228, v192, v193
    v_cvt_pk_bf16_f32 v2, v194, v195
    v_lshlrev_b32 v194, 16, v2
    v_and_b32 v195, 0xffff0000, v2
    v_lshlrev_b32 v2, 16, v105
    v_and_b32 v3, 0xffff0000, v105
    v_pk_add_f32 v[194:195], v[194:195], v[2:3]
    v_cvt_pk_bf16_f32 v2, v194, v195
    v_lshlrev_b32 v194, 16, v2
    v_and_b32 v195, 0xffff0000, v2
    v_lshlrev_b32 v2, 16, v109
    v_and_b32 v3, 0xffff0000, v109
    v_pk_add_f32 v[194:195], v[194:195], v[2:3]
    v_cvt_pk_bf16_f32 v229, v194, v195
    v_cvt_pk_bf16_f32 v2, v196, v197
    v_lshlrev_b32 v196, 16, v2
    v_and_b32 v197, 0xffff0000, v2
    v_lshlrev_b32 v2, 16, v106
    v_and_b32 v3, 0xffff0000, v106
    v_pk_add_f32 v[196:197], v[196:197], v[2:3]
    v_cvt_pk_bf16_f32 v2, v196, v197
    v_lshlrev_b32 v196, 16, v2
    v_and_b32 v197, 0xffff0000, v2
    v_lshlrev_b32 v2, 16, v110
    v_and_b32 v3, 0xffff0000, v110
    v_pk_add_f32 v[196:197], v[196:197], v[2:3]
    v_cvt_pk_bf16_f32 v230, v196, v197
    v_cvt_pk_bf16_f32 v2, v198, v199
    v_lshlrev_b32 v198, 16, v2
    v_and_b32 v199, 0xffff0000, v2
    v_lshlrev_b32 v2, 16, v107
    v_and_b32 v3, 0xffff0000, v107
    v_pk_add_f32 v[198:199], v[198:199], v[2:3]
    v_cvt_pk_bf16_f32 v2, v198, v199
    v_lshlrev_b32 v198, 16, v2
    v_and_b32 v199, 0xffff0000, v2
    v_lshlrev_b32 v2, 16, v111
    v_and_b32 v3, 0xffff0000, v111
    v_pk_add_f32 v[198:199], v[198:199], v[2:3]
    v_cvt_pk_bf16_f32 v231, v198, v199
    buffer_store_dwordx4 v[228:231], v54, s[16:19], s70 offen
L_end:
L_exit:
    s_endpgm
.section .rodata,"a"
.p2align 6
.amdhsa_kernel parallel_sum__compressed_kv_cla__moe_arch_mod__prompt_kernel
  .amdhsa_next_free_vgpr 256
  .amdhsa_next_free_sgpr 102
  .amdhsa_accum_offset 256
  .amdhsa_group_segment_fixed_size 0
  .amdhsa_kernarg_size 112
  .amdhsa_user_sgpr_count 2
  .amdhsa_user_sgpr_kernarg_segment_ptr 1
  .amdhsa_system_sgpr_workgroup_id_x 1
  .amdhsa_float_denorm_mode_32 3
.end_amdhsa_kernel
```

```asm
; @launch grid=(256,1,1) block=(512,1,1) lds=163840
.amdgcn_target "amdgcn-amd-amdhsa--gfx950"
.text
.globl parallel_sum__compressed_kv_cla__moe_arch_mod__prompt_kernel
.p2align 8
.type parallel_sum__compressed_kv_cla__moe_arch_mod__prompt_kernel,@function
parallel_sum__compressed_kv_cla__moe_arch_mod__prompt_kernel:
    s_cmp_ge_u32 s2, 256
    s_cbranch_scc1 L_exit
    s_load_dwordx16 s[32:47], s[0:1], 0
    s_load_dwordx8 s[48:55], s[0:1], 64
    s_load_dwordx4 s[56:59], s[0:1], 96
    v_lshrrev_b32 v2, 6, v0
    v_and_b32 v1, 63, v0
    v_readfirstlane_b32 s3, v2
    s_getpc_b64 s[80:81]
L_pc:
    s_lshr_b32 s6, s2, 3
    s_and_b32 s6, s6, 15
    s_lshl_b32 s6, s6, 12
    s_cmp_lt_u32 s3, 2
    s_cselect_b32 s6, 0, s6
    v_lshl_add_u32 v3, v0, 6, s6
    v_min_u32 v3, L_exit-L_pc, v3
    s_cmp_ge_u32 s3, 3
    s_cbranch_scc1 L_noct
    global_load_dword v11, v3, s[80:81]
L_noct:
    v_lshrrev_b32 v62, 5, v0
    v_and_b32 v62, 7, v62
    v_and_b32 v2, 31, v0
    v_lshlrev_b32 v2, 3, v2
    v_mul_u32_u24 v63, 1280, v62
    v_add_u32 v63, v63, v2
    s_mul_i32 s6, s2, 10240
    v_add_u32 v10, s6, v63
    s_cmp_lt_u32 s3, 4
    s_cbranch_scc1 L_st_k0
    s_waitcnt lgkmcnt(0)
    global_load_dwordx2 v[16:17], v10, s[32:33] offset:0
    global_load_dwordx2 v[18:19], v10, s[32:33] offset:256
    global_load_dwordx2 v[20:21], v10, s[32:33] offset:512
    global_load_dwordx2 v[22:23], v10, s[32:33] offset:768
    global_load_dwordx2 v[24:25], v10, s[32:33] offset:1024
    global_load_dwordx2 v[26:27], v2, s[46:47] offset:0
    global_load_dwordx2 v[28:29], v2, s[46:47] offset:256
    global_load_dwordx2 v[30:31], v2, s[46:47] offset:512
    global_load_dwordx2 v[32:33], v2, s[46:47] offset:768
    global_load_dwordx2 v[34:35], v2, s[46:47] offset:1024
    s_barrier
L_st_k0:
    s_and_b32 s6, s2, 7
    s_lshl_b32 s6, s6, 2
    s_lshr_b32 s7, s2, 3
    s_and_b32 s7, s7, 3
    s_add_u32 s4, s6, s7
    s_lshr_b32 s5, s2, 5
    s_and_b32 s76, s3, 3
    v_lshrrev_b32 v2, 3, v1
    v_and_b32 v3, 7, v1
    v_lshrrev_b32 v4, 4, v1
    v_xor_b32 v5, v3, v4
    v_lshlrev_b32 v5, 4, v5
    v_lshl_add_u32 v40, v2, 10, v5
    v_xor_b32 v5, 64, v40
    v_add_u32 v41, 7168, v5
    v_add_u32 v42, 14336, v40
    v_add_u32 v43, 14336, v41
    v_and_b32 v6, 15, v1
    s_lshl_b32 s6, s76, 4
    v_add_u32 v7, s6, v4
    v_lshlrev_b32 v5, 1, v4
    v_xor_b32 v5, v6, v5
    v_lshlrev_b32 v5, 4, v5
    v_lshl_add_u32 v44, v7, 13, v5
    v_add_u32 v45, 31744, v44
    v_xor_b32 v5, 0x80, v44
    v_add_u32 v46, 63488, v5
    v_add_u32 v47, 31744, v46
    s_and_b32 s6, s76, 1
    s_lshl_b32 s6, s6, 20
    s_lshr_b32 s7, s76, 1
    s_lshl_b32 s7, s7, 18
    s_add_u32 s6, s6, s7
    s_lshl_b32 s62, s5, 15
    s_add_u32 s62, s62, s6
    s_lshl_b32 s63, s4, 8
    s_lshl_b32 s64, s76, 13
    s_lshl_b32 s73, s76, 12
    s_add_u32 s73, s73, 32768
    s_andn2_b32 s100, 1, s5
    s_lshl_b32 s100, s100, 16
    s_add_u32 s64, s64, s100
    s_add_u32 s73, s73, s100
    s_waitcnt lgkmcnt(0)
    s_mov_b32 s12, s34
    s_mov_b32 s13, s35
    s_mov_b32 s14, 0x200000
    s_mov_b32 s15, 0x20000
    s_mov_b32 s16, s38
    s_mov_b32 s17, s39
    s_mov_b32 s18, 0x400000
    s_mov_b32 s19, 0x20000
    s_mov_b32 s20, s40
    s_mov_b32 s21, s41
    s_mov_b32 s22, 0x400000
    s_mov_b32 s23, 0x20000
    s_cmp_ge_u32 s3, 4
    s_cbranch_scc1 L_st_v0
    s_barrier
    s_mov_b32 m0, s64
    s_add_u32 s72, s62, 524288
    buffer_load_dwordx4 v40, s[12:15], s62 offen offset:0 lds
    buffer_load_dwordx4 v41, s[12:15], s62 offen offset:1024 lds
    buffer_load_dwordx4 v42, s[12:15], s62 offen offset:2048 lds
    buffer_load_dwordx4 v43, s[12:15], s62 offen offset:3072 lds
    s_add_u32 m0, s64, 4096
    s_add_u32 s62, s62, 128
    s_bitset0_b32 s62, 10
    buffer_load_dwordx4 v40, s[12:15], s72 offen offset:0 lds
    buffer_load_dwordx4 v41, s[12:15], s72 offen offset:1024 lds
    buffer_load_dwordx4 v42, s[12:15], s72 offen offset:2048 lds
    buffer_load_dwordx4 v43, s[12:15], s72 offen offset:3072 lds
    s_mov_b32 m0, s73
    s_xor_b32 s64, s64, 0x10000
    buffer_load_dwordx4 v44, s[16:19], s63 offen offset:0 lds
    buffer_load_dwordx4 v45, s[16:19], s63 offen offset:1024 lds
    buffer_load_dwordx4 v46, s[16:19], s63 offen offset:2048 lds
    buffer_load_dwordx4 v47, s[16:19], s63 offen offset:3072 lds
    s_add_u32 m0, s73, 16384
    s_xor_b32 s73, s73, 0x10000
    buffer_load_dwordx4 v44, s[20:23], s63 offen offset:0 lds
    buffer_load_dwordx4 v45, s[20:23], s63 offen offset:1024 lds
    buffer_load_dwordx4 v46, s[20:23], s63 offen offset:2048 lds
    buffer_load_dwordx4 v47, s[20:23], s63 offen offset:3072 lds
    s_add_u32 s63, s63, 524288
    s_bitset0_b32 s63, 22
    s_setprio 1
L_st_v0:
    s_mov_b32 s8, s58
    s_mov_b32 s9, s59
    s_mov_b32 s10, 0x5000000
    s_mov_b32 s11, 0x20000
    s_mov_b32 s24, s36
    s_mov_b32 s25, s37
    s_mov_b32 s26, 0x500000
    s_mov_b32 s27, 0x20000
    v_lshlrev_b32 v13, 4, v1
    s_lshl_b32 s6, s5, 2
    s_add_u32 s7, s6, s3
    s_sub_u32 s6, 56, s6
    s_add_u32 s6, s6, s3
    s_cmp_lt_u32 s3, 4
    s_cselect_b32 s60, s7, s6
    s_sub_u32 s6, 2, s5
    s_and_b32 s6, s6, 7
    s_lshl_b32 s6, s6, 5
    s_add_u32 s61, s6, s4
    v_and_b32 v2, 15, v1
    v_lshrrev_b32 v3, 4, v1
    s_and_b32 s6, s3, 1
    s_lshl_b32 s6, s6, 7
    v_add_u32 v4, s6, v2
    v_lshlrev_b32 v4, 7, v4
    v_add_u32 v4, s100, v4
    v_lshrrev_b32 v5, 1, v2
    v_add_u32 v6, 0, v3
    v_xor_b32 v6, v6, v5
    v_lshl_add_u32 v48, v6, 4, v4
    v_add_u32 v6, 4, v3
    v_xor_b32 v6, v6, v5
    v_lshl_add_u32 v49, v6, 4, v4
    v_lshrrev_b32 v4, 2, v2
    v_lshl_add_u32 v5, v3, 3, v4
    v_lshlrev_b32 v5, 8, v5
    v_and_b32 v6, 1, v2
    v_lshl_add_u32 v5, v6, 3, v5
    v_and_b32 v6, 1, v3
    v_lshl_or_b32 v4, v6, 2, v4
    v_lshlrev_b32 v4, 1, v4
    v_bfe_u32 v6, v2, 1, 1
    v_add_u32 v8, 131072, v5
    v_add_u32 v7, 0, v6
    v_xor_b32 v7, v7, v4
    v_lshl_add_u32 v54, v7, 4, v8
    v_add_u32 v7, 2, v6
    v_xor_b32 v7, v7, v4
    v_lshl_add_u32 v55, v7, 4, v8
    v_add_u32 v7, 4, v6
    v_xor_b32 v7, v7, v4
    v_lshl_add_u32 v56, v7, 4, v8
    v_add_u32 v7, 6, v6
    v_xor_b32 v7, v7, v4
    v_lshl_add_u32 v57, v7, 4, v8
    v_add_u32 v7, 8, v6
    v_xor_b32 v7, v7, v4
    v_lshl_add_u32 v58, v7, 4, v8
    v_add_u32 v7, 10, v6
    v_xor_b32 v7, v7, v4
    v_lshl_add_u32 v59, v7, 4, v8
    v_add_u32 v7, 12, v6
    v_xor_b32 v7, v7, v4
    v_lshl_add_u32 v60, v7, 4, v8
    v_add_u32 v7, 14, v6
    v_xor_b32 v7, v7, v4
    v_lshl_add_u32 v61, v7, 4, v8
    s_lshr_b32 s6, s3, 2
    s_lshl_b32 s6, s6, 14
    s_add_u32 s6, s6, 32768
    s_add_u32 s6, s6, s100
    v_add_u32 v5, s6, v5
    s_lshr_b32 s7, s3, 1
    s_and_b32 s7, s7, 1
    s_lshl_b32 s7, s7, 3
    s_add_u32 s6, s7, 0
    v_add_u32 v7, s6, v6
    v_xor_b32 v7, v7, v4
    v_lshl_add_u32 v50, v7, 4, v5
    s_add_u32 s6, s7, 2
    v_add_u32 v7, s6, v6
    v_xor_b32 v7, v7, v4
    v_lshl_add_u32 v51, v7, 4, v5
    s_add_u32 s6, s7, 4
    v_add_u32 v7, s6, v6
    v_xor_b32 v7, v7, v4
    v_lshl_add_u32 v52, v7, 4, v5
    s_add_u32 s6, s7, 6
    v_add_u32 v7, s6, v6
    v_xor_b32 v7, v7, v4
    v_lshl_add_u32 v53, v7, 4, v5
    v_mov_b64 v[128:129], 0
    v_mov_b64 v[130:131], 0
    v_mov_b64 v[132:133], 0
    v_mov_b64 v[134:135], 0
    v_mov_b64 v[136:137], 0
    v_mov_b64 v[138:139], 0
    v_mov_b64 v[140:141], 0
    v_mov_b64 v[142:143], 0
    v_mov_b64 v[144:145], 0
    v_mov_b64 v[146:147], 0
    v_mov_b64 v[148:149], 0
    v_mov_b64 v[150:151], 0
    v_mov_b64 v[152:153], 0
    v_mov_b64 v[154:155], 0
    v_mov_b64 v[156:157], 0
    v_mov_b64 v[158:159], 0
    v_mov_b64 v[160:161], 0
    v_mov_b64 v[162:163], 0
    v_mov_b64 v[164:165], 0
    v_mov_b64 v[166:167], 0
    v_mov_b64 v[168:169], 0
    v_mov_b64 v[170:171], 0
    v_mov_b64 v[172:173], 0
    v_mov_b64 v[174:175], 0
    v_mov_b64 v[176:177], 0
    v_mov_b64 v[178:179], 0
    v_mov_b64 v[180:181], 0
    v_mov_b64 v[182:183], 0
    v_mov_b64 v[184:185], 0
    v_mov_b64 v[186:187], 0
    v_mov_b64 v[188:189], 0
    v_mov_b64 v[190:191], 0
    v_mov_b64 v[192:193], 0
    v_mov_b64 v[194:195], 0
    v_mov_b64 v[196:197], 0
    v_mov_b64 v[198:199], 0
    v_mov_b64 v[200:201], 0
    v_mov_b64 v[202:203], 0
    v_mov_b64 v[204:205], 0
    v_mov_b64 v[206:207], 0
    v_mov_b64 v[208:209], 0
    v_mov_b64 v[210:211], 0
    v_mov_b64 v[212:213], 0
    v_mov_b64 v[214:215], 0
    v_mov_b64 v[216:217], 0
    v_mov_b64 v[218:219], 0
    v_mov_b64 v[220:221], 0
    v_mov_b64 v[222:223], 0
    v_mov_b64 v[224:225], 0
    v_mov_b64 v[226:227], 0
    v_mov_b64 v[228:229], 0
    v_mov_b64 v[230:231], 0
    v_mov_b64 v[232:233], 0
    v_mov_b64 v[234:235], 0
    v_mov_b64 v[236:237], 0
    v_mov_b64 v[238:239], 0
    v_mov_b64 v[240:241], 0
    v_mov_b64 v[242:243], 0
    v_mov_b64 v[244:245], 0
    v_mov_b64 v[246:247], 0
    v_mov_b64 v[248:249], 0
    v_mov_b64 v[250:251], 0
    v_mov_b64 v[252:253], 0
    v_mov_b64 v[254:255], 0
    v_add_u32 v12, 20480, v13
    s_mul_i32 s70, s60, 40960
    s_mov_b32 s65, 0
    s_lshl_b32 s6, s4, 20
    s_lshl_b32 s7, s5, 13
    s_add_u32 s6, s6, s7
    s_and_b32 s7, s3, 1
    s_lshl_b32 s7, s7, 16
    s_add_u32 s6, s6, s7
    s_add_u32 s67, s6, 16777216
    s_and_b32 s6, s4, 3
    s_add_u32 s6, s6, s5
    s_sub_u32 s7, s6, 5
    s_cselect_b32 s6, s6, s7
    s_sub_u32 s7, s6, 5
    s_cselect_b32 s6, s6, s7
    s_lshl_b32 s71, s6, 20
    s_lshl_b32 s7, s4, 8
    s_add_u32 s71, s71, s7
    s_lshl_b32 s7, s6, 12
    s_add_u32 s84, s70, s7
    s_add_u32 s6, s6, 1
    s_cmp_eq_u32 s6, 5
    s_cselect_b32 s6, 0, s6
    s_lshl_b32 s7, s6, 12
    s_add_u32 s85, s70, s7
    s_add_u32 s6, s6, 1
    s_cmp_eq_u32 s6, 5
    s_cselect_b32 s6, 0, s6
    s_lshl_b32 s7, s6, 12
    s_add_u32 s86, s70, s7
    s_add_u32 s6, s6, 1
    s_cmp_eq_u32 s6, 5
    s_cselect_b32 s6, 0, s6
    s_lshl_b32 s7, s6, 12
    s_add_u32 s87, s70, s7
    s_add_u32 s6, s6, 1
    s_cmp_eq_u32 s6, 5
    s_cselect_b32 s6, 0, s6
    s_lshl_b32 s7, s6, 12
    s_add_u32 s88, s70, s7
    s_lshr_b32 s7, s3, 1
    s_and_b32 s7, s7, 1
    s_cmp_ge_u32 s3, 4
    s_cbranch_scc1 L_c_v
    s_lshl_b32 s7, s7, 11
    s_add_u32 s67, s67, s7
    s_movk_i32 s68, 3072
    s_mov_b32 s69, 125952
    s_add_u32 s71, s71, 1048576
    s_sub_u32 s75, s71, 5242880
    s_cselect_b32 s71, s71, s75
    s_lshl_b32 s74, s76, 12
    s_add_u32 s74, s74, s100
    s_branch L_c_j
L_c_v:
    s_lshl_b32 s7, s7, 12
    s_add_u32 s67, s67, s7
    s_add_u32 s67, s67, 0x80000
    s_movk_i32 s68, 1024
    s_mov_b32 s69, 128000
L_c_j:
    s_cmp_ge_u32 s3, 4
    s_cbranch_scc1 L_st_v1
    s_mov_b32 m0, s64
    s_add_u32 s72, s62, 524288
    buffer_load_dwordx4 v40, s[12:15], s62 offen offset:0 lds
    buffer_load_dwordx4 v41, s[12:15], s62 offen offset:1024 lds
    buffer_load_dwordx4 v42, s[12:15], s62 offen offset:2048 lds
    buffer_load_dwordx4 v43, s[12:15], s62 offen offset:3072 lds
    s_add_u32 m0, s64, 4096
    s_add_u32 s62, s62, 128
    s_bitset0_b32 s62, 10
    buffer_load_dwordx4 v40, s[12:15], s72 offen offset:0 lds
    buffer_load_dwordx4 v41, s[12:15], s72 offen offset:1024 lds
    buffer_load_dwordx4 v42, s[12:15], s72 offen offset:2048 lds
    buffer_load_dwordx4 v43, s[12:15], s72 offen offset:3072 lds
    s_waitcnt vmcnt(8)
    s_branch L_st_j1
L_st_v1:
    s_waitcnt vmcnt(0)
    v_lshlrev_b32 v64, 16, v16
    v_and_b32 v65, 0xffff0000, v16
    v_lshlrev_b32 v66, 16, v17
    v_and_b32 v67, 0xffff0000, v17
    v_lshlrev_b32 v68, 16, v18
    v_and_b32 v69, 0xffff0000, v18
    v_lshlrev_b32 v70, 16, v19
    v_and_b32 v71, 0xffff0000, v19
    v_lshlrev_b32 v72, 16, v20
    v_and_b32 v73, 0xffff0000, v20
    v_lshlrev_b32 v74, 16, v21
    v_and_b32 v75, 0xffff0000, v21
    v_lshlrev_b32 v76, 16, v22
    v_and_b32 v77, 0xffff0000, v22
    v_lshlrev_b32 v78, 16, v23
    v_and_b32 v79, 0xffff0000, v23
    v_lshlrev_b32 v80, 16, v24
    v_and_b32 v81, 0xffff0000, v24
    v_lshlrev_b32 v82, 16, v25
    v_and_b32 v83, 0xffff0000, v25
    v_pk_add_f32 v[2:3], v[64:65], v[66:67]
    v_pk_add_f32 v[2:3], v[2:3], v[68:69]
    v_pk_add_f32 v[2:3], v[2:3], v[70:71]
    v_pk_add_f32 v[2:3], v[2:3], v[72:73]
    v_pk_add_f32 v[2:3], v[2:3], v[74:75]
    v_pk_add_f32 v[2:3], v[2:3], v[76:77]
    v_pk_add_f32 v[2:3], v[2:3], v[78:79]
    v_pk_add_f32 v[2:3], v[2:3], v[80:81]
    v_pk_add_f32 v[2:3], v[2:3], v[82:83]
    v_add_f32 v2, v2, v3
    s_nop 1
    v_add_f32_dpp v2, v2, v2 quad_perm:[1,0,3,2] row_mask:0xf bank_mask:0xf
    s_nop 1
    v_add_f32_dpp v2, v2, v2 quad_perm:[2,3,0,1] row_mask:0xf bank_mask:0xf
    s_nop 1
    v_add_f32_dpp v2, v2, v2 row_half_mirror row_mask:0xf bank_mask:0xf
    s_nop 1
    v_add_f32_dpp v2, v2, v2 row_mirror row_mask:0xf bank_mask:0xf
    v_mov_b32 v8, v2
    s_nop 1
    v_permlane16_swap_b32 v2, v8
    s_nop 1
    v_add_f32 v2, v2, v8
    s_mov_b32 s7, 0x3acccccd
    v_mul_f32 v2, s7, v2
    v_mov_b64 v[4:5], 0
    v_pk_add_f32 v[6:7], v[64:65], v[2:3] op_sel_hi:[1,0] neg_lo:[0,1] neg_hi:[0,1]
    v_pk_fma_f32 v[4:5], v[6:7], v[6:7], v[4:5]
    v_pk_add_f32 v[6:7], v[66:67], v[2:3] op_sel_hi:[1,0] neg_lo:[0,1] neg_hi:[0,1]
    v_pk_fma_f32 v[4:5], v[6:7], v[6:7], v[4:5]
    v_pk_add_f32 v[6:7], v[68:69], v[2:3] op_sel_hi:[1,0] neg_lo:[0,1] neg_hi:[0,1]
    v_pk_fma_f32 v[4:5], v[6:7], v[6:7], v[4:5]
    v_pk_add_f32 v[6:7], v[70:71], v[2:3] op_sel_hi:[1,0] neg_lo:[0,1] neg_hi:[0,1]
    v_pk_fma_f32 v[4:5], v[6:7], v[6:7], v[4:5]
    v_pk_add_f32 v[6:7], v[72:73], v[2:3] op_sel_hi:[1,0] neg_lo:[0,1] neg_hi:[0,1]
    v_pk_fma_f32 v[4:5], v[6:7], v[6:7], v[4:5]
    v_pk_add_f32 v[6:7], v[74:75], v[2:3] op_sel_hi:[1,0] neg_lo:[0,1] neg_hi:[0,1]
    v_pk_fma_f32 v[4:5], v[6:7], v[6:7], v[4:5]
    v_pk_add_f32 v[6:7], v[76:77], v[2:3] op_sel_hi:[1,0] neg_lo:[0,1] neg_hi:[0,1]
    v_pk_fma_f32 v[4:5], v[6:7], v[6:7], v[4:5]
    v_pk_add_f32 v[6:7], v[78:79], v[2:3] op_sel_hi:[1,0] neg_lo:[0,1] neg_hi:[0,1]
    v_pk_fma_f32 v[4:5], v[6:7], v[6:7], v[4:5]
    v_pk_add_f32 v[6:7], v[80:81], v[2:3] op_sel_hi:[1,0] neg_lo:[0,1] neg_hi:[0,1]
    v_pk_fma_f32 v[4:5], v[6:7], v[6:7], v[4:5]
    v_pk_add_f32 v[6:7], v[82:83], v[2:3] op_sel_hi:[1,0] neg_lo:[0,1] neg_hi:[0,1]
    v_pk_fma_f32 v[4:5], v[6:7], v[6:7], v[4:5]
    v_add_f32 v4, v4, v5
    s_nop 1
    v_add_f32_dpp v4, v4, v4 quad_perm:[1,0,3,2] row_mask:0xf bank_mask:0xf
    s_nop 1
    v_add_f32_dpp v4, v4, v4 quad_perm:[2,3,0,1] row_mask:0xf bank_mask:0xf
    s_nop 1
    v_add_f32_dpp v4, v4, v4 row_half_mirror row_mask:0xf bank_mask:0xf
    s_nop 1
    v_add_f32_dpp v4, v4, v4 row_mirror row_mask:0xf bank_mask:0xf
    v_mov_b32 v8, v4
    s_nop 1
    v_permlane16_swap_b32 v4, v8
    s_nop 1
    v_add_f32 v4, v4, v8
    v_mul_f32 v4, s7, v4
    v_cvt_pk_bf16_f32 v2, v2, v2
    v_lshlrev_b32 v2, 16, v2
    v_cvt_pk_bf16_f32 v4, v4, v4
    v_lshlrev_b32 v4, 16, v4
    v_add_f32 v4, 0x3727c5ac, v4
    v_cvt_pk_bf16_f32 v4, v4, v4
    v_lshlrev_b32 v4, 16, v4
    v_sqrt_f32 v4, v4
    s_nop 0
    v_cvt_pk_bf16_f32 v4, v4, v4
    v_lshlrev_b32 v4, 16, v4
    v_rcp_f32 v6, v4
    s_nop 0
    v_fma_f32 v5, -v4, v6, 1.0
    v_fmac_f32 v6, v5, v6
    v_mov_b32 v9, 0
    v_pk_add_f32 v[64:65], v[64:65], v[2:3] op_sel_hi:[1,0] neg_lo:[0,1] neg_hi:[0,1]
    v_cvt_pk_bf16_f32 v5, v64, v65
    v_lshlrev_b32 v64, 16, v5
    v_and_b32 v65, 0xffff0000, v5
    v_pk_mul_f32 v[64:65], v[64:65], v[6:7] op_sel_hi:[1,0]
    v_cvt_pk_bf16_f32 v16, v64, v65
    v_pk_add_f32 v[66:67], v[66:67], v[2:3] op_sel_hi:[1,0] neg_lo:[0,1] neg_hi:[0,1]
    v_cvt_pk_bf16_f32 v5, v66, v67
    v_lshlrev_b32 v66, 16, v5
    v_and_b32 v67, 0xffff0000, v5
    v_pk_mul_f32 v[66:67], v[66:67], v[6:7] op_sel_hi:[1,0]
    v_cvt_pk_bf16_f32 v17, v66, v67
    v_pk_add_f32 v[68:69], v[68:69], v[2:3] op_sel_hi:[1,0] neg_lo:[0,1] neg_hi:[0,1]
    v_cvt_pk_bf16_f32 v5, v68, v69
    v_lshlrev_b32 v68, 16, v5
    v_and_b32 v69, 0xffff0000, v5
    v_pk_mul_f32 v[68:69], v[68:69], v[6:7] op_sel_hi:[1,0]
    v_cvt_pk_bf16_f32 v18, v68, v69
    v_pk_add_f32 v[70:71], v[70:71], v[2:3] op_sel_hi:[1,0] neg_lo:[0,1] neg_hi:[0,1]
    v_cvt_pk_bf16_f32 v5, v70, v71
    v_lshlrev_b32 v70, 16, v5
    v_and_b32 v71, 0xffff0000, v5
    v_pk_mul_f32 v[70:71], v[70:71], v[6:7] op_sel_hi:[1,0]
    v_cvt_pk_bf16_f32 v19, v70, v71
    v_pk_add_f32 v[72:73], v[72:73], v[2:3] op_sel_hi:[1,0] neg_lo:[0,1] neg_hi:[0,1]
    v_cvt_pk_bf16_f32 v5, v72, v73
    v_lshlrev_b32 v72, 16, v5
    v_and_b32 v73, 0xffff0000, v5
    v_pk_mul_f32 v[72:73], v[72:73], v[6:7] op_sel_hi:[1,0]
    v_cvt_pk_bf16_f32 v20, v72, v73
    v_pk_add_f32 v[74:75], v[74:75], v[2:3] op_sel_hi:[1,0] neg_lo:[0,1] neg_hi:[0,1]
    v_cvt_pk_bf16_f32 v5, v74, v75
    v_lshlrev_b32 v74, 16, v5
    v_and_b32 v75, 0xffff0000, v5
    v_pk_mul_f32 v[74:75], v[74:75], v[6:7] op_sel_hi:[1,0]
    v_cvt_pk_bf16_f32 v21, v74, v75
    v_pk_add_f32 v[76:77], v[76:77], v[2:3] op_sel_hi:[1,0] neg_lo:[0,1] neg_hi:[0,1]
    v_cvt_pk_bf16_f32 v5, v76, v77
    v_lshlrev_b32 v76, 16, v5
    v_and_b32 v77, 0xffff0000, v5
    v_pk_mul_f32 v[76:77], v[76:77], v[6:7] op_sel_hi:[1,0]
    v_cvt_pk_bf16_f32 v22, v76, v77
    v_pk_add_f32 v[78:79], v[78:79], v[2:3] op_sel_hi:[1,0] neg_lo:[0,1] neg_hi:[0,1]
    v_cvt_pk_bf16_f32 v5, v78, v79
    v_lshlrev_b32 v78, 16, v5
    v_and_b32 v79, 0xffff0000, v5
    v_pk_mul_f32 v[78:79], v[78:79], v[6:7] op_sel_hi:[1,0]
    v_cvt_pk_bf16_f32 v23, v78, v79
    v_pk_add_f32 v[80:81], v[80:81], v[2:3] op_sel_hi:[1,0] neg_lo:[0,1] neg_hi:[0,1]
    v_cvt_pk_bf16_f32 v5, v80, v81
    v_lshlrev_b32 v80, 16, v5
    v_and_b32 v81, 0xffff0000, v5
    v_pk_mul_f32 v[80:81], v[80:81], v[6:7] op_sel_hi:[1,0]
    v_cvt_pk_bf16_f32 v24, v80, v81
    v_pk_add_f32 v[82:83], v[82:83], v[2:3] op_sel_hi:[1,0] neg_lo:[0,1] neg_hi:[0,1]
    v_cvt_pk_bf16_f32 v5, v82, v83
    v_lshlrev_b32 v82, 16, v5
    v_and_b32 v83, 0xffff0000, v5
    v_pk_mul_f32 v[82:83], v[82:83], v[6:7] op_sel_hi:[1,0]
    v_cvt_pk_bf16_f32 v25, v82, v83
    v_add_u32 v10, 131072, v63
    ds_write_b64 v10, v[16:17] offset:0
    ds_write_b64 v10, v[18:19] offset:256
    ds_write_b64 v10, v[20:21] offset:512
    ds_write_b64 v10, v[22:23] offset:768
    ds_write_b64 v10, v[24:25] offset:1024
    s_waitcnt lgkmcnt(0)
    v_mov_b32 v2, 0
    v_lshlrev_b32 v4, 16, v16
    v_lshlrev_b32 v5, 16, v26
    v_fmac_f32 v2, v4, v5
    v_and_b32 v4, 0xffff0000, v16
    v_and_b32 v5, 0xffff0000, v26
    v_fmac_f32 v2, v4, v5
    v_lshlrev_b32 v4, 16, v17
    v_lshlrev_b32 v5, 16, v27
    v_fmac_f32 v2, v4, v5
    v_and_b32 v4, 0xffff0000, v17
    v_and_b32 v5, 0xffff0000, v27
    v_fmac_f32 v2, v4, v5
    v_lshlrev_b32 v4, 16, v18
    v_lshlrev_b32 v5, 16, v28
    v_fmac_f32 v2, v4, v5
    v_and_b32 v4, 0xffff0000, v18
    v_and_b32 v5, 0xffff0000, v28
    v_fmac_f32 v2, v4, v5
    v_lshlrev_b32 v4, 16, v19
    v_lshlrev_b32 v5, 16, v29
    v_fmac_f32 v2, v4, v5
    v_and_b32 v4, 0xffff0000, v19
    v_and_b32 v5, 0xffff0000, v29
    v_fmac_f32 v2, v4, v5
    v_lshlrev_b32 v4, 16, v20
    v_lshlrev_b32 v5, 16, v30
    v_fmac_f32 v2, v4, v5
    v_and_b32 v4, 0xffff0000, v20
    v_and_b32 v5, 0xffff0000, v30
    v_fmac_f32 v2, v4, v5
    v_lshlrev_b32 v4, 16, v21
    v_lshlrev_b32 v5, 16, v31
    v_fmac_f32 v2, v4, v5
    v_and_b32 v4, 0xffff0000, v21
    v_and_b32 v5, 0xffff0000, v31
    v_fmac_f32 v2, v4, v5
    v_lshlrev_b32 v4, 16, v22
    v_lshlrev_b32 v5, 16, v32
    v_fmac_f32 v2, v4, v5
    v_and_b32 v4, 0xffff0000, v22
    v_and_b32 v5, 0xffff0000, v32
    v_fmac_f32 v2, v4, v5
    v_lshlrev_b32 v4, 16, v23
    v_lshlrev_b32 v5, 16, v33
    v_fmac_f32 v2, v4, v5
    v_and_b32 v4, 0xffff0000, v23
    v_and_b32 v5, 0xffff0000, v33
    v_fmac_f32 v2, v4, v5
    v_lshlrev_b32 v4, 16, v24
    v_lshlrev_b32 v5, 16, v34
    v_fmac_f32 v2, v4, v5
    v_and_b32 v4, 0xffff0000, v24
    v_and_b32 v5, 0xffff0000, v34
    v_fmac_f32 v2, v4, v5
    v_lshlrev_b32 v4, 16, v25
    v_lshlrev_b32 v5, 16, v35
    v_fmac_f32 v2, v4, v5
    v_and_b32 v4, 0xffff0000, v25
    v_and_b32 v5, 0xffff0000, v35
    v_fmac_f32 v2, v4, v5
    s_nop 1
    v_add_f32_dpp v2, v2, v2 quad_perm:[1,0,3,2] row_mask:0xf bank_mask:0xf
    s_nop 1
    v_add_f32_dpp v2, v2, v2 quad_perm:[2,3,0,1] row_mask:0xf bank_mask:0xf
    s_nop 1
    v_add_f32_dpp v2, v2, v2 row_half_mirror row_mask:0xf bank_mask:0xf
    s_nop 1
    v_add_f32_dpp v2, v2, v2 row_mirror row_mask:0xf bank_mask:0xf
    v_mov_b32 v8, v2
    s_nop 1
    v_permlane16_swap_b32 v2, v8
    s_nop 1
    v_add_f32 v2, v2, v8
    v_cvt_pk_bf16_f32 v2, v2, v2
    v_and_b32 v2, 0xffff, v2
    v_bfe_i32 v3, v2, 15, 1
    v_and_b32 v3, 0x7fff, v3
    v_or_b32 v3, 0x8000, v3
    v_xor_b32 v2, v2, v3
    s_lshl_b32 s7, s2, 3
    s_sub_u32 s6, 2047, s7
    v_sub_u32 v3, s6, v62
    v_lshl_or_b32 v2, v2, 11, v3
    v_lshlrev_b32 v3, 2, v62
    v_add_u32 v3, 161792, v3
    ds_write_b32 v3, v2
    s_waitcnt lgkmcnt(0)
L_st_j1:
    s_barrier
    s_cmp_ge_u32 s3, 4
    s_cbranch_scc1 L_kv_v
    ds_read_b128 v[64:67], v48 offset:0
    ds_read_b128 v[68:71], v48 offset:2048
    ds_read_b64_tr_b16 v[96:97], v50 offset:0
    ds_read_b64_tr_b16 v[98:99], v50 offset:1024
    ds_read_b64_tr_b16 v[100:101], v51 offset:0
    ds_read_b64_tr_b16 v[102:103], v51 offset:1024
    ds_read_b128 v[72:75], v48 offset:4096
    ds_read_b64_tr_b16 v[104:105], v52 offset:0
    ds_read_b64_tr_b16 v[106:107], v52 offset:1024
    ds_read_b64_tr_b16 v[108:109], v53 offset:0
    ds_read_b64_tr_b16 v[110:111], v53 offset:1024
    ds_read_b128 v[76:79], v48 offset:6144
    ds_read_b128 v[80:83], v48 offset:8192
    ds_read_b128 v[84:87], v48 offset:10240
    ds_read_b128 v[88:91], v48 offset:12288
    ds_read_b128 v[92:95], v48 offset:14336
    s_mov_b32 m0, s73
    s_xor_b32 s64, s64, 0x10000
    buffer_load_dwordx4 v44, s[16:19], s63 offen offset:0 lds
    buffer_load_dwordx4 v45, s[16:19], s63 offen offset:1024 lds
    buffer_load_dwordx4 v46, s[16:19], s63 offen offset:2048 lds
    buffer_load_dwordx4 v47, s[16:19], s63 offen offset:3072 lds
    s_add_u32 m0, s73, 16384
    s_xor_b32 s73, s73, 0x10000
    buffer_load_dwordx4 v44, s[20:23], s63 offen offset:0 lds
    buffer_load_dwordx4 v45, s[20:23], s63 offen offset:1024 lds
    buffer_load_dwordx4 v46, s[20:23], s63 offen offset:2048 lds
    buffer_load_dwordx4 v47, s[20:23], s63 offen offset:3072 lds
    s_add_u32 s63, s63, 524288
    s_bitset0_b32 s63, 22
.p2align 4
L_kloopA:
    s_waitcnt lgkmcnt(12)
    v_mfma_f32_16x16x32_bf16 v[128:131], v[96:99], v[64:67], v[128:131]
    ds_read_b64_tr_b16 v[112:113], v50 offset:8192
    s_waitcnt lgkmcnt(11)
    v_mfma_f32_16x16x32_bf16 v[132:135], v[100:103], v[64:67], v[132:135]
    ds_read_b64_tr_b16 v[114:115], v50 offset:9216
    s_waitcnt lgkmcnt(9)
    v_mfma_f32_16x16x32_bf16 v[136:139], v[104:107], v[64:67], v[136:139]
    ds_read_b64_tr_b16 v[116:117], v51 offset:8192
    s_waitcnt lgkmcnt(8)
    v_mfma_f32_16x16x32_bf16 v[140:143], v[108:111], v[64:67], v[140:143]
    ds_read_b64_tr_b16 v[118:119], v51 offset:9216
    ds_read_b128 v[64:67], v49 offset:0
    v_mfma_f32_16x16x32_bf16 v[156:159], v[108:111], v[68:71], v[156:159]
    ds_read_b64_tr_b16 v[120:121], v52 offset:8192
    v_mfma_f32_16x16x32_bf16 v[152:155], v[104:107], v[68:71], v[152:155]
    ds_read_b64_tr_b16 v[122:123], v52 offset:9216
    v_mfma_f32_16x16x32_bf16 v[148:151], v[100:103], v[68:71], v[148:151]
    ds_read_b64_tr_b16 v[124:125], v53 offset:8192
    v_mfma_f32_16x16x32_bf16 v[144:147], v[96:99], v[68:71], v[144:147]
    ds_read_b64_tr_b16 v[126:127], v53 offset:9216
    ds_read_b128 v[68:71], v49 offset:2048
    v_mfma_f32_16x16x32_bf16 v[160:163], v[96:99], v[72:75], v[160:163]
    v_mfma_f32_16x16x32_bf16 v[164:167], v[100:103], v[72:75], v[164:167]
    v_mfma_f32_16x16x32_bf16 v[168:171], v[104:107], v[72:75], v[168:171]
    v_mfma_f32_16x16x32_bf16 v[172:175], v[108:111], v[72:75], v[172:175]
    ds_read_b128 v[72:75], v49 offset:4096
    s_waitcnt lgkmcnt(15)
    v_mfma_f32_16x16x32_bf16 v[188:191], v[108:111], v[76:79], v[188:191]
    v_mfma_f32_16x16x32_bf16 v[184:187], v[104:107], v[76:79], v[184:187]
    v_mfma_f32_16x16x32_bf16 v[180:183], v[100:103], v[76:79], v[180:183]
    v_mfma_f32_16x16x32_bf16 v[176:179], v[96:99], v[76:79], v[176:179]
    ds_read_b128 v[76:79], v49 offset:6144
    s_waitcnt lgkmcnt(15)
    v_mfma_f32_16x16x32_bf16 v[192:195], v[96:99], v[80:83], v[192:195]
    v_mfma_f32_16x16x32_bf16 v[196:199], v[100:103], v[80:83], v[196:199]
    v_mfma_f32_16x16x32_bf16 v[200:203], v[104:107], v[80:83], v[200:203]
    v_mfma_f32_16x16x32_bf16 v[204:207], v[108:111], v[80:83], v[204:207]
    ds_read_b128 v[80:83], v49 offset:8192
    s_waitcnt lgkmcnt(15)
    v_mfma_f32_16x16x32_bf16 v[220:223], v[108:111], v[84:87], v[220:223]
    v_mfma_f32_16x16x32_bf16 v[216:219], v[104:107], v[84:87], v[216:219]
    v_mfma_f32_16x16x32_bf16 v[212:215], v[100:103], v[84:87], v[212:215]
    v_mfma_f32_16x16x32_bf16 v[208:211], v[96:99], v[84:87], v[208:211]
    ds_read_b128 v[84:87], v49 offset:10240
    s_waitcnt lgkmcnt(15)
    v_mfma_f32_16x16x32_bf16 v[224:227], v[96:99], v[88:91], v[224:227]
    v_mfma_f32_16x16x32_bf16 v[228:231], v[100:103], v[88:91], v[228:231]
    v_mfma_f32_16x16x32_bf16 v[232:235], v[104:107], v[88:91], v[232:235]
    v_mfma_f32_16x16x32_bf16 v[236:239], v[108:111], v[88:91], v[236:239]
    ds_read_b128 v[88:91], v49 offset:12288
    s_waitcnt lgkmcnt(15)
    v_mfma_f32_16x16x32_bf16 v[252:255], v[108:111], v[92:95], v[252:255]
    v_mfma_f32_16x16x32_bf16 v[248:251], v[104:107], v[92:95], v[248:251]
    v_mfma_f32_16x16x32_bf16 v[244:247], v[100:103], v[92:95], v[244:247]
    v_mfma_f32_16x16x32_bf16 v[240:243], v[96:99], v[92:95], v[240:243]
    ds_read_b128 v[92:95], v49 offset:14336
    s_waitcnt lgkmcnt(11)
    v_mfma_f32_16x16x32_bf16 v[128:131], v[112:115], v[64:67], v[128:131]
    v_mfma_f32_16x16x32_bf16 v[132:135], v[116:119], v[64:67], v[132:135]
    s_waitcnt lgkmcnt(9)
    v_mfma_f32_16x16x32_bf16 v[136:139], v[120:123], v[64:67], v[136:139]
    s_waitcnt lgkmcnt(7)
    v_mfma_f32_16x16x32_bf16 v[140:143], v[124:127], v[64:67], v[140:143]
    s_waitcnt lgkmcnt(6)
    v_mfma_f32_16x16x32_bf16 v[156:159], v[124:127], v[68:71], v[156:159]
    v_mfma_f32_16x16x32_bf16 v[152:155], v[120:123], v[68:71], v[152:155]
    v_mfma_f32_16x16x32_bf16 v[148:151], v[116:119], v[68:71], v[148:151]
    v_mfma_f32_16x16x32_bf16 v[144:147], v[112:115], v[68:71], v[144:147]
    v_xor_b32 v48, 0x10000, v48
    v_xor_b32 v49, 0x10000, v49
    v_xor_b32 v50, 0x10000, v50
    v_xor_b32 v51, 0x10000, v51
    v_xor_b32 v52, 0x10000, v52
    v_xor_b32 v53, 0x10000, v53
    s_waitcnt vmcnt(0) lgkmcnt(0)
    s_barrier
    ds_read_b128 v[64:67], v48 offset:0
    ds_read_b128 v[68:71], v48 offset:2048
    v_mfma_f32_16x16x32_bf16 v[160:163], v[112:115], v[72:75], v[160:163]
    ds_read_b64_tr_b16 v[96:97], v50 offset:0
    s_mov_b32 m0, s64
    s_add_u32 s72, s62, 524288
    v_mfma_f32_16x16x32_bf16 v[164:167], v[116:119], v[72:75], v[164:167]
    ds_read_b64_tr_b16 v[98:99], v50 offset:1024
    buffer_load_dwordx4 v40, s[12:15], s62 offen offset:0 lds
    v_mfma_f32_16x16x32_bf16 v[168:171], v[120:123], v[72:75], v[168:171]
    ds_read_b64_tr_b16 v[100:101], v51 offset:0
    buffer_load_dwordx4 v41, s[12:15], s62 offen offset:1024 lds
    v_mfma_f32_16x16x32_bf16 v[172:175], v[124:127], v[72:75], v[172:175]
    ds_read_b64_tr_b16 v[102:103], v51 offset:1024
    buffer_load_dwordx4 v42, s[12:15], s62 offen offset:2048 lds
    ds_read_b128 v[72:75], v48 offset:4096
    v_mfma_f32_16x16x32_bf16 v[188:191], v[124:127], v[76:79], v[188:191]
    ds_read_b64_tr_b16 v[104:105], v52 offset:0
    buffer_load_dwordx4 v43, s[12:15], s62 offen offset:3072 lds
    v_mfma_f32_16x16x32_bf16 v[184:187], v[120:123], v[76:79], v[184:187]
    ds_read_b64_tr_b16 v[106:107], v52 offset:1024
    s_add_u32 m0, s64, 4096
    s_add_u32 s62, s62, 128
    s_bitset0_b32 s62, 10
    v_mfma_f32_16x16x32_bf16 v[180:183], v[116:119], v[76:79], v[180:183]
    ds_read_b64_tr_b16 v[108:109], v53 offset:0
    buffer_load_dwordx4 v40, s[12:15], s72 offen offset:0 lds
    v_mfma_f32_16x16x32_bf16 v[176:179], v[112:115], v[76:79], v[176:179]
    ds_read_b64_tr_b16 v[110:111], v53 offset:1024
    buffer_load_dwordx4 v41, s[12:15], s72 offen offset:1024 lds
    ds_read_b128 v[76:79], v48 offset:6144
    v_mfma_f32_16x16x32_bf16 v[192:195], v[112:115], v[80:83], v[192:195]
    buffer_load_dwordx4 v42, s[12:15], s72 offen offset:2048 lds
    v_mfma_f32_16x16x32_bf16 v[196:199], v[116:119], v[80:83], v[196:199]
    buffer_load_dwordx4 v43, s[12:15], s72 offen offset:3072 lds
    v_mfma_f32_16x16x32_bf16 v[200:203], v[120:123], v[80:83], v[200:203]
    s_mov_b32 m0, s73
    s_xor_b32 s64, s64, 0x10000
    v_mfma_f32_16x16x32_bf16 v[204:207], v[124:127], v[80:83], v[204:207]
    buffer_load_dwordx4 v44, s[16:19], s63 offen offset:0 lds
    ds_read_b128 v[80:83], v48 offset:8192
    v_mfma_f32_16x16x32_bf16 v[220:223], v[124:127], v[84:87], v[220:223]
    buffer_load_dwordx4 v45, s[16:19], s63 offen offset:1024 lds
    v_mfma_f32_16x16x32_bf16 v[216:219], v[120:123], v[84:87], v[216:219]
    buffer_load_dwordx4 v46, s[16:19], s63 offen offset:2048 lds
    v_mfma_f32_16x16x32_bf16 v[212:215], v[116:119], v[84:87], v[212:215]
    buffer_load_dwordx4 v47, s[16:19], s63 offen offset:3072 lds
    v_mfma_f32_16x16x32_bf16 v[208:211], v[112:115], v[84:87], v[208:211]
    s_add_u32 m0, s73, 16384
    s_xor_b32 s73, s73, 0x10000
    ds_read_b128 v[84:87], v48 offset:10240
    v_mfma_f32_16x16x32_bf16 v[224:227], v[112:115], v[88:91], v[224:227]
    buffer_load_dwordx4 v44, s[20:23], s63 offen offset:0 lds
    v_mfma_f32_16x16x32_bf16 v[228:231], v[116:119], v[88:91], v[228:231]
    buffer_load_dwordx4 v45, s[20:23], s63 offen offset:1024 lds
    v_mfma_f32_16x16x32_bf16 v[232:235], v[120:123], v[88:91], v[232:235]
    buffer_load_dwordx4 v46, s[20:23], s63 offen offset:2048 lds
    v_mfma_f32_16x16x32_bf16 v[236:239], v[124:127], v[88:91], v[236:239]
    buffer_load_dwordx4 v47, s[20:23], s63 offen offset:3072 lds
    ds_read_b128 v[88:91], v48 offset:12288
    v_mfma_f32_16x16x32_bf16 v[252:255], v[124:127], v[92:95], v[252:255]
    s_add_u32 s63, s63, 524288
    s_bitset0_b32 s63, 22
    v_mfma_f32_16x16x32_bf16 v[248:251], v[120:123], v[92:95], v[248:251]
    v_mfma_f32_16x16x32_bf16 v[244:247], v[116:119], v[92:95], v[244:247]
    v_mfma_f32_16x16x32_bf16 v[240:243], v[112:115], v[92:95], v[240:243]
    ds_read_b128 v[92:95], v48 offset:14336
    s_add_u32 s65, s65, 1
    s_cmp_lt_u32 s65, 6
    s_cbranch_scc1 L_kloopA
.p2align 4
L_kloopB:
    s_bitcmp1_b32 128, s65
    s_cbranch_scc1 L_khook
L_khook_back:
    s_waitcnt lgkmcnt(12)
    v_mfma_f32_16x16x32_bf16 v[128:131], v[96:99], v[64:67], v[128:131]
    ds_read_b64_tr_b16 v[112:113], v50 offset:8192
    s_waitcnt lgkmcnt(11)
    v_mfma_f32_16x16x32_bf16 v[132:135], v[100:103], v[64:67], v[132:135]
    ds_read_b64_tr_b16 v[114:115], v50 offset:9216
    s_waitcnt lgkmcnt(9)
    v_mfma_f32_16x16x32_bf16 v[136:139], v[104:107], v[64:67], v[136:139]
    ds_read_b64_tr_b16 v[116:117], v51 offset:8192
    s_waitcnt lgkmcnt(8)
    v_mfma_f32_16x16x32_bf16 v[140:143], v[108:111], v[64:67], v[140:143]
    ds_read_b64_tr_b16 v[118:119], v51 offset:9216
    ds_read_b128 v[64:67], v49 offset:0
    v_mfma_f32_16x16x32_bf16 v[156:159], v[108:111], v[68:71], v[156:159]
    ds_read_b64_tr_b16 v[120:121], v52 offset:8192
    v_mfma_f32_16x16x32_bf16 v[152:155], v[104:107], v[68:71], v[152:155]
    ds_read_b64_tr_b16 v[122:123], v52 offset:9216
    v_mfma_f32_16x16x32_bf16 v[148:151], v[100:103], v[68:71], v[148:151]
    ds_read_b64_tr_b16 v[124:125], v53 offset:8192
    v_mfma_f32_16x16x32_bf16 v[144:147], v[96:99], v[68:71], v[144:147]
    ds_read_b64_tr_b16 v[126:127], v53 offset:9216
    ds_read_b128 v[68:71], v49 offset:2048
    v_mfma_f32_16x16x32_bf16 v[160:163], v[96:99], v[72:75], v[160:163]
    v_mfma_f32_16x16x32_bf16 v[164:167], v[100:103], v[72:75], v[164:167]
    v_mfma_f32_16x16x32_bf16 v[168:171], v[104:107], v[72:75], v[168:171]
    v_mfma_f32_16x16x32_bf16 v[172:175], v[108:111], v[72:75], v[172:175]
    ds_read_b128 v[72:75], v49 offset:4096
    s_waitcnt lgkmcnt(15)
    v_mfma_f32_16x16x32_bf16 v[188:191], v[108:111], v[76:79], v[188:191]
    v_mfma_f32_16x16x32_bf16 v[184:187], v[104:107], v[76:79], v[184:187]
    v_mfma_f32_16x16x32_bf16 v[180:183], v[100:103], v[76:79], v[180:183]
    v_mfma_f32_16x16x32_bf16 v[176:179], v[96:99], v[76:79], v[176:179]
    ds_read_b128 v[76:79], v49 offset:6144
    s_waitcnt lgkmcnt(15)
    v_mfma_f32_16x16x32_bf16 v[192:195], v[96:99], v[80:83], v[192:195]
    v_mfma_f32_16x16x32_bf16 v[196:199], v[100:103], v[80:83], v[196:199]
    v_mfma_f32_16x16x32_bf16 v[200:203], v[104:107], v[80:83], v[200:203]
    v_mfma_f32_16x16x32_bf16 v[204:207], v[108:111], v[80:83], v[204:207]
    ds_read_b128 v[80:83], v49 offset:8192
    s_waitcnt lgkmcnt(15)
    v_mfma_f32_16x16x32_bf16 v[220:223], v[108:111], v[84:87], v[220:223]
    v_mfma_f32_16x16x32_bf16 v[216:219], v[104:107], v[84:87], v[216:219]
    v_mfma_f32_16x16x32_bf16 v[212:215], v[100:103], v[84:87], v[212:215]
    v_mfma_f32_16x16x32_bf16 v[208:211], v[96:99], v[84:87], v[208:211]
    ds_read_b128 v[84:87], v49 offset:10240
    s_waitcnt lgkmcnt(15)
    v_mfma_f32_16x16x32_bf16 v[224:227], v[96:99], v[88:91], v[224:227]
    v_mfma_f32_16x16x32_bf16 v[228:231], v[100:103], v[88:91], v[228:231]
    v_mfma_f32_16x16x32_bf16 v[232:235], v[104:107], v[88:91], v[232:235]
    v_mfma_f32_16x16x32_bf16 v[236:239], v[108:111], v[88:91], v[236:239]
    ds_read_b128 v[88:91], v49 offset:12288
    s_waitcnt lgkmcnt(15)
    v_mfma_f32_16x16x32_bf16 v[252:255], v[108:111], v[92:95], v[252:255]
    v_mfma_f32_16x16x32_bf16 v[248:251], v[104:107], v[92:95], v[248:251]
    v_mfma_f32_16x16x32_bf16 v[244:247], v[100:103], v[92:95], v[244:247]
    v_mfma_f32_16x16x32_bf16 v[240:243], v[96:99], v[92:95], v[240:243]
    ds_read_b128 v[92:95], v49 offset:14336
    s_waitcnt lgkmcnt(11)
    v_mfma_f32_16x16x32_bf16 v[128:131], v[112:115], v[64:67], v[128:131]
    v_mfma_f32_16x16x32_bf16 v[132:135], v[116:119], v[64:67], v[132:135]
    s_waitcnt lgkmcnt(9)
    v_mfma_f32_16x16x32_bf16 v[136:139], v[120:123], v[64:67], v[136:139]
    s_waitcnt lgkmcnt(7)
    v_mfma_f32_16x16x32_bf16 v[140:143], v[124:127], v[64:67], v[140:143]
    s_waitcnt lgkmcnt(6)
    v_mfma_f32_16x16x32_bf16 v[156:159], v[124:127], v[68:71], v[156:159]
    v_mfma_f32_16x16x32_bf16 v[152:155], v[120:123], v[68:71], v[152:155]
    v_mfma_f32_16x16x32_bf16 v[148:151], v[116:119], v[68:71], v[148:151]
    v_mfma_f32_16x16x32_bf16 v[144:147], v[112:115], v[68:71], v[144:147]
    v_xor_b32 v48, 0x10000, v48
    v_xor_b32 v49, 0x10000, v49
    v_xor_b32 v50, 0x10000, v50
    v_xor_b32 v51, 0x10000, v51
    v_xor_b32 v52, 0x10000, v52
    v_xor_b32 v53, 0x10000, v53
    s_waitcnt vmcnt(0) lgkmcnt(0)
    s_barrier
    ds_read_b128 v[64:67], v48 offset:0
    ds_read_b128 v[68:71], v48 offset:2048
    v_mfma_f32_16x16x32_bf16 v[160:163], v[112:115], v[72:75], v[160:163]
    ds_read_b64_tr_b16 v[96:97], v50 offset:0
    s_mov_b32 m0, s74
    s_add_u32 s74, s74, 16384
    s_bitset0_b32 s74, 17
    v_mfma_f32_16x16x32_bf16 v[164:167], v[116:119], v[72:75], v[164:167]
    ds_read_b64_tr_b16 v[98:99], v50 offset:1024
    buffer_load_dwordx4 v44, s[24:27], s71 offen offset:0 lds
    v_mfma_f32_16x16x32_bf16 v[168:171], v[120:123], v[72:75], v[168:171]
    ds_read_b64_tr_b16 v[100:101], v51 offset:0
    buffer_load_dwordx4 v45, s[24:27], s71 offen offset:1024 lds
    v_mfma_f32_16x16x32_bf16 v[172:175], v[124:127], v[72:75], v[172:175]
    ds_read_b64_tr_b16 v[102:103], v51 offset:1024
    buffer_load_dwordx4 v46, s[24:27], s71 offen offset:2048 lds
    ds_read_b128 v[72:75], v48 offset:4096
    v_mfma_f32_16x16x32_bf16 v[188:191], v[124:127], v[76:79], v[188:191]
    ds_read_b64_tr_b16 v[104:105], v52 offset:0
    buffer_load_dwordx4 v47, s[24:27], s71 offen offset:3072 lds
    v_mfma_f32_16x16x32_bf16 v[184:187], v[120:123], v[76:79], v[184:187]
    ds_read_b64_tr_b16 v[106:107], v52 offset:1024
    s_add_u32 s71, s71, 524288
    s_sub_u32 s75, s71, 5242880
    s_cselect_b32 s71, s71, s75
    v_mfma_f32_16x16x32_bf16 v[180:183], v[116:119], v[76:79], v[180:183]
    ds_read_b64_tr_b16 v[108:109], v53 offset:0
    s_mov_b32 m0, s74
    s_add_u32 s74, s74, 16384
    s_bitset0_b32 s74, 17
    v_mfma_f32_16x16x32_bf16 v[176:179], v[112:115], v[76:79], v[176:179]
    ds_read_b64_tr_b16 v[110:111], v53 offset:1024
    buffer_load_dwordx4 v44, s[24:27], s71 offen offset:0 lds
    ds_read_b128 v[76:79], v48 offset:6144
    v_mfma_f32_16x16x32_bf16 v[192:195], v[112:115], v[80:83], v[192:195]
    buffer_load_dwordx4 v45, s[24:27], s71 offen offset:1024 lds
    v_mfma_f32_16x16x32_bf16 v[196:199], v[116:119], v[80:83], v[196:199]
    buffer_load_dwordx4 v46, s[24:27], s71 offen offset:2048 lds
    v_mfma_f32_16x16x32_bf16 v[200:203], v[120:123], v[80:83], v[200:203]
    buffer_load_dwordx4 v47, s[24:27], s71 offen offset:3072 lds
    v_mfma_f32_16x16x32_bf16 v[204:207], v[124:127], v[80:83], v[204:207]
    s_add_u32 s71, s71, 524288
    s_sub_u32 s75, s71, 5242880
    s_cselect_b32 s71, s71, s75
    ds_read_b128 v[80:83], v48 offset:8192
    v_mfma_f32_16x16x32_bf16 v[220:223], v[124:127], v[84:87], v[220:223]
    s_mov_b32 m0, s74
    s_add_u32 s74, s74, 16384
    s_bitset0_b32 s74, 17
    v_mfma_f32_16x16x32_bf16 v[216:219], v[120:123], v[84:87], v[216:219]
    buffer_load_dwordx4 v44, s[24:27], s71 offen offset:0 lds
    v_mfma_f32_16x16x32_bf16 v[212:215], v[116:119], v[84:87], v[212:215]
    buffer_load_dwordx4 v45, s[24:27], s71 offen offset:1024 lds
    v_mfma_f32_16x16x32_bf16 v[208:211], v[112:115], v[84:87], v[208:211]
    buffer_load_dwordx4 v46, s[24:27], s71 offen offset:2048 lds
    ds_read_b128 v[84:87], v48 offset:10240
    v_mfma_f32_16x16x32_bf16 v[224:227], v[112:115], v[88:91], v[224:227]
    buffer_load_dwordx4 v47, s[24:27], s71 offen offset:3072 lds
    v_mfma_f32_16x16x32_bf16 v[228:231], v[116:119], v[88:91], v[228:231]
    s_add_u32 s71, s71, 524288
    s_sub_u32 s75, s71, 5242880
    s_cselect_b32 s71, s71, s75
    v_mfma_f32_16x16x32_bf16 v[232:235], v[120:123], v[88:91], v[232:235]
    s_mov_b32 m0, s74
    s_add_u32 s74, s74, 16384
    s_bitset0_b32 s74, 17
    v_mfma_f32_16x16x32_bf16 v[236:239], v[124:127], v[88:91], v[236:239]
    buffer_load_dwordx4 v44, s[24:27], s71 offen offset:0 lds
    ds_read_b128 v[88:91], v48 offset:12288
    v_mfma_f32_16x16x32_bf16 v[252:255], v[124:127], v[92:95], v[252:255]
    buffer_load_dwordx4 v45, s[24:27], s71 offen offset:1024 lds
    v_mfma_f32_16x16x32_bf16 v[248:251], v[120:123], v[92:95], v[248:251]
    buffer_load_dwordx4 v46, s[24:27], s71 offen offset:2048 lds
    v_mfma_f32_16x16x32_bf16 v[244:247], v[116:119], v[92:95], v[244:247]
    buffer_load_dwordx4 v47, s[24:27], s71 offen offset:3072 lds
    v_mfma_f32_16x16x32_bf16 v[240:243], v[112:115], v[92:95], v[240:243]
    s_add_u32 s71, s71, 524288
    s_sub_u32 s75, s71, 5242880
    s_cselect_b32 s71, s71, s75
    ds_read_b128 v[92:95], v48 offset:14336
    s_add_u32 s65, s65, 1
    s_cmp_lt_u32 s65, 8
    s_cbranch_scc1 L_kloopB
    s_waitcnt lgkmcnt(0)
    s_nop 7
    v_cvt_pk_bf16_f32 v128, v128, v129
    v_cvt_pk_bf16_f32 v129, v130, v131
    v_cvt_pk_bf16_f32 v130, v132, v133
    v_cvt_pk_bf16_f32 v131, v134, v135
    v_cvt_pk_bf16_f32 v132, v136, v137
    v_cvt_pk_bf16_f32 v133, v138, v139
    v_cvt_pk_bf16_f32 v134, v140, v141
    v_cvt_pk_bf16_f32 v135, v142, v143
    v_cvt_pk_bf16_f32 v136, v144, v145
    v_cvt_pk_bf16_f32 v137, v146, v147
    v_cvt_pk_bf16_f32 v138, v148, v149
    v_cvt_pk_bf16_f32 v139, v150, v151
    v_cvt_pk_bf16_f32 v140, v152, v153
    v_cvt_pk_bf16_f32 v141, v154, v155
    v_cvt_pk_bf16_f32 v142, v156, v157
    v_cvt_pk_bf16_f32 v143, v158, v159
    v_cvt_pk_bf16_f32 v144, v160, v161
    v_cvt_pk_bf16_f32 v145, v162, v163
    v_cvt_pk_bf16_f32 v146, v164, v165
    v_cvt_pk_bf16_f32 v147, v166, v167
    v_cvt_pk_bf16_f32 v148, v168, v169
    v_cvt_pk_bf16_f32 v149, v170, v171
    v_cvt_pk_bf16_f32 v150, v172, v173
    v_cvt_pk_bf16_f32 v151, v174, v175
    v_cvt_pk_bf16_f32 v152, v176, v177
    v_cvt_pk_bf16_f32 v153, v178, v179
    v_cvt_pk_bf16_f32 v154, v180, v181
    v_cvt_pk_bf16_f32 v155, v182, v183
    v_cvt_pk_bf16_f32 v156, v184, v185
    v_cvt_pk_bf16_f32 v157, v186, v187
    v_cvt_pk_bf16_f32 v158, v188, v189
    v_cvt_pk_bf16_f32 v159, v190, v191
    v_cvt_pk_bf16_f32 v160, v192, v193
    v_cvt_pk_bf16_f32 v161, v194, v195
    v_cvt_pk_bf16_f32 v162, v196, v197
    v_cvt_pk_bf16_f32 v163, v198, v199
    v_cvt_pk_bf16_f32 v164, v200, v201
    v_cvt_pk_bf16_f32 v165, v202, v203
    v_cvt_pk_bf16_f32 v166, v204, v205
    v_cvt_pk_bf16_f32 v167, v206, v207
    v_cvt_pk_bf16_f32 v168, v208, v209
    v_cvt_pk_bf16_f32 v169, v210, v211
    v_cvt_pk_bf16_f32 v170, v212, v213
    v_cvt_pk_bf16_f32 v171, v214, v215
    v_cvt_pk_bf16_f32 v172, v216, v217
    v_cvt_pk_bf16_f32 v173, v218, v219
    v_cvt_pk_bf16_f32 v174, v220, v221
    v_cvt_pk_bf16_f32 v175, v222, v223
    v_cvt_pk_bf16_f32 v176, v224, v225
    v_cvt_pk_bf16_f32 v177, v226, v227
    v_cvt_pk_bf16_f32 v178, v228, v229
    v_cvt_pk_bf16_f32 v179, v230, v231
    v_cvt_pk_bf16_f32 v180, v232, v233
    v_cvt_pk_bf16_f32 v181, v234, v235
    v_cvt_pk_bf16_f32 v182, v236, v237
    v_cvt_pk_bf16_f32 v183, v238, v239
    v_cvt_pk_bf16_f32 v184, v240, v241
    v_cvt_pk_bf16_f32 v185, v242, v243
    v_cvt_pk_bf16_f32 v186, v244, v245
    v_cvt_pk_bf16_f32 v187, v246, v247
    v_cvt_pk_bf16_f32 v188, v248, v249
    v_cvt_pk_bf16_f32 v189, v250, v251
    v_cvt_pk_bf16_f32 v190, v252, v253
    v_cvt_pk_bf16_f32 v191, v254, v255
    s_waitcnt vmcnt(16)
    s_branch L_q
L_hook:
    s_cmp_eq_u32 s65, 1
    s_cbranch_scc1 L_hook1
    s_cmp_eq_u32 s65, 2
    s_cbranch_scc1 L_hook2
    s_cmp_eq_u32 s65, 4
    s_cbranch_scc1 L_hook4
    s_cmp_eq_u32 s65, 6
    s_cbranch_scc1 L_hook6
    s_cmp_lg_u32 s65, 7
    s_cbranch_scc1 L_hook_back
    buffer_load_dwordx4 v[16:19], v13, s[8:11], s84 offen offset:0 sc1
    buffer_load_dwordx4 v[20:23], v12, s[8:11], s84 offen offset:0 sc1
    buffer_load_dwordx4 v[24:27], v13, s[8:11], s84 offen offset:1024 sc1
    buffer_load_dwordx4 v[28:31], v12, s[8:11], s84 offen offset:1024 sc1
    buffer_load_dwordx4 v[32:35], v13, s[8:11], s84 offen offset:2048 sc1
    buffer_load_dwordx4 v[36:39], v12, s[8:11], s84 offen offset:2048 sc1
    s_branch L_hook_back
L_hook1:
    s_cmp_ge_u32 s76, 2
    s_cbranch_scc1 L_tch_1a
    s_and_b32 s6, s4, 3
    s_lshl_b32 s6, s6, 19
    s_lshl_b32 s7, s5, 15
    s_add_u32 s6, s6, s7
    s_lshl_b32 s7, s76, 7
    s_add_u32 s6, s6, s7
    s_add_u32 s6, s6, 512
    v_lshrrev_b32 v6, 1, v1
    v_lshlrev_b32 v6, 10, v6
    v_and_b32 v7, 1, v1
    v_lshl_add_u32 v6, v7, 6, v6
    buffer_load_dword v11, v6, s[12:15], s6 offen
    s_add_u32 s6, s6, 262144
    buffer_load_dword v11, v6, s[12:15], s6 offen
    s_branch L_tch_1c
L_tch_1a:
    v_lshrrev_b32 v6, 5, v1
    v_lshlrev_b32 v6, 6, v6
    v_bfe_u32 v7, v1, 2, 3
    v_add_u32 v6, v6, v7
    v_lshlrev_b32 v6, 13, v6
    v_and_b32 v7, 3, v1
    v_lshl_add_u32 v6, v7, 6, v6
    s_lshl_b32 s6, s4, 8
    s_lshl_b32 s7, s5, 16
    s_add_u32 s6, s6, s7
    s_add_u32 s6, s6, 2097152
    s_cmp_lg_u32 s76, 2
    s_cbranch_scc1 L_tch_1b
    buffer_load_dword v11, v6, s[16:19], s6 offen
    s_branch L_tch_1c
L_tch_1b:
    buffer_load_dword v11, v6, s[20:23], s6 offen
L_tch_1c:
    s_branch L_hook_back
L_hook2:
    s_lshr_b32 s72, s2, 1
    s_mul_i32 s72, s72, 20480
    s_and_b32 s7, s2, 1
    s_lshl_b32 s7, s7, 7
    s_add_u32 s72, s72, s7
    v_add_u32 v2, -256, v0
    v_lshrrev_b32 v3, 3, v2
    v_and_b32 v4, 7, v2
    v_mul_u32_u24 v5, 1280, v4
    v_lshl_add_u32 v5, v3, 4, v5
    v_add_u32 v5, 131072, v5
    ds_read_b128 v[16:19], v5
    v_lshlrev_b32 v5, 8, v3
    v_lshl_add_u32 v6, v4, 4, v5
    v_add_u32 v2, 0, v0
    v_lshrrev_b32 v3, 3, v2
    v_and_b32 v4, 7, v2
    v_mul_u32_u24 v5, 1280, v4
    v_lshl_add_u32 v5, v3, 4, v5
    v_add_u32 v5, 131072, v5
    ds_read_b128 v[24:27], v5
    v_lshlrev_b32 v5, 8, v3
    v_lshl_add_u32 v7, v4, 4, v5
    v_add_u32 v2, 256, v0
    v_lshrrev_b32 v3, 3, v2
    v_and_b32 v4, 7, v2
    v_mul_u32_u24 v5, 1280, v4
    v_lshl_add_u32 v5, v3, 4, v5
    v_add_u32 v5, 131072, v5
    ds_read_b128 v[32:35], v5
    v_lshlrev_b32 v5, 8, v3
    v_lshl_add_u32 v8, v4, 4, v5
    s_waitcnt lgkmcnt(0)
    buffer_store_dwordx4 v[16:19], v6, s[8:11], s72 offen sc1
    buffer_store_dwordx4 v[24:27], v7, s[8:11], s72 offen sc1
    s_cmp_ge_u32 s3, 6
    s_cbranch_scc1 L_lns
    buffer_store_dwordx4 v[32:35], v8, s[8:11], s72 offen sc1
L_lns:
    s_cmp_lt_u32 s3, 6
    s_cbranch_scc1 L_zd
    v_mov_b64 v[36:37], 0
    v_mov_b64 v[38:39], 0
    v_lshrrev_b32 v2, 3, v1
    s_cmp_eq_u32 s3, 6
    s_cbranch_scc1 L_z6
    s_lshl_b32 s6, s5, 2
    s_sub_u32 s7, 56, s6
    v_mov_b32 v3, s6
    v_mov_b32 v4, s7
    v_cmp_gt_u32 vcc, 4, v2
    s_lshl_b32 s6, s4, 7
    s_add_u32 s6, s6, 3932160
    v_cndmask_b32 v3, v4, v3, vcc
    v_add_u32 v3, v3, v2
    v_lshl_add_u32 v3, v3, 12, s6
    s_branch L_z7
L_z6:
    v_mov_b32 v3, 0x5000000
    s_lshl_b32 s6, s4, 3
    s_add_u32 s6, s6, s5
    s_lshl_b32 s6, s6, 5
    s_add_u32 s6, s6, s3
    s_lshl_b32 s6, s6, 2
    s_add_u32 s6, s6, 3866624
    s_andn2_b32 s6, s6, 127
    v_cmp_eq_u32 vcc, 0, v2
    v_mov_b32 v4, s6
    s_nop 0
    v_cndmask_b32 v3, v3, v4, vcc
    s_lshl_b32 s6, s61, 5
    s_add_u32 s6, s6, s3
    s_lshl_b32 s6, s6, 2
    s_add_u32 s6, s6, 15859712
    s_andn2_b32 s6, s6, 127
    v_cmp_eq_u32 vcc, 1, v2
    v_mov_b32 v4, s6
    s_nop 0
    v_cndmask_b32 v3, v3, v4, vcc
    s_lshl_b32 s6, s5, 5
    s_add_u32 s6, s6, s4
    s_lshl_b32 s6, s6, 5
    s_add_u32 s6, s6, s3
    s_lshl_b32 s6, s6, 2
    s_add_u32 s6, s6, 3899392
    s_andn2_b32 s6, s6, 127
    v_cmp_eq_u32 vcc, 2, v2
    v_mov_b32 v4, s6
    s_nop 0
    v_cndmask_b32 v3, v3, v4, vcc
    s_and_b32 s6, s4, 7
    s_lshl_b32 s7, s5, 3
    s_add_u32 s6, s6, s7
    s_lshr_b32 s7, s4, 3
    s_add_u32 s7, s7, 0
    s_add_u32 s7, s7, 1
    s_and_b32 s7, s7, 3
    s_lshl_b32 s6, s6, 2
    s_add_u32 s6, s6, s7
    s_mul_i32 s6, s6, 3
    s_add_u32 s6, s6, 0
    s_lshl_b32 s6, s6, 5
    s_add_u32 s6, s6, s3
    s_lshl_b32 s6, s6, 2
    s_add_u32 s6, s6, 15728640
    s_andn2_b32 s6, s6, 127
    v_cmp_eq_u32 vcc, 3, v2
    v_mov_b32 v4, s6
    s_nop 0
    v_cndmask_b32 v3, v3, v4, vcc
    s_and_b32 s6, s4, 7
    s_lshl_b32 s7, s5, 3
    s_add_u32 s6, s6, s7
    s_lshr_b32 s7, s4, 3
    s_add_u32 s7, s7, 1
    s_add_u32 s7, s7, 1
    s_and_b32 s7, s7, 3
    s_lshl_b32 s6, s6, 2
    s_add_u32 s6, s6, s7
    s_mul_i32 s6, s6, 3
    s_add_u32 s6, s6, 1
    s_lshl_b32 s6, s6, 5
    s_add_u32 s6, s6, s3
    s_lshl_b32 s6, s6, 2
    s_add_u32 s6, s6, 15728640
    s_andn2_b32 s6, s6, 127
    v_cmp_eq_u32 vcc, 4, v2
    v_mov_b32 v4, s6
    s_nop 0
    v_cndmask_b32 v3, v3, v4, vcc
    s_and_b32 s6, s4, 7
    s_lshl_b32 s7, s5, 3
    s_add_u32 s6, s6, s7
    s_lshr_b32 s7, s4, 3
    s_add_u32 s7, s7, 2
    s_add_u32 s7, s7, 1
    s_and_b32 s7, s7, 3
    s_lshl_b32 s6, s6, 2
    s_add_u32 s6, s6, s7
    s_mul_i32 s6, s6, 3
    s_add_u32 s6, s6, 2
    s_lshl_b32 s6, s6, 5
    s_add_u32 s6, s6, s3
    s_lshl_b32 s6, s6, 2
    s_add_u32 s6, s6, 15728640
    s_andn2_b32 s6, s6, 127
    v_cmp_eq_u32 vcc, 5, v2
    v_mov_b32 v4, s6
    s_nop 0
    v_cndmask_b32 v3, v3, v4, vcc
    s_mov_b32 s6, 0x5000000
    s_cmp_eq_u32 s2, 31
    s_cmov_b32 s6, 3801088
    s_andn2_b32 s6, s6, 127
    v_cmp_eq_u32 vcc, 6, v2
    v_mov_b32 v4, s6
    s_nop 0
    v_cndmask_b32 v3, v3, v4, vcc
    s_lshl_b32 s6, s2, 7
    s_add_u32 s6, s6, 2621440
    s_andn2_b32 s6, s6, 127
    v_cmp_eq_u32 vcc, 7, v2
    v_mov_b32 v4, s6
    s_nop 0
    v_cndmask_b32 v3, v3, v4, vcc
    v_add_u32 v4, 160896, v13
    s_mov_b32 exec_lo, 0
    s_mov_b32 exec_hi, 0x03000000
    ds_read_b128 v[36:39], v4
    s_mov_b64 exec, -1
    s_waitcnt lgkmcnt(0)
L_z7:
    v_and_b32 v2, 7, v1
    v_lshl_add_u32 v3, v2, 4, v3
    buffer_store_dwordx4 v[36:39], v3, s[8:11], 0 offen sc1
L_zd:
    s_cmp_ge_u32 s76, 2
    s_cbranch_scc1 L_tch_2a
    s_and_b32 s6, s4, 3
    s_lshl_b32 s6, s6, 19
    s_lshl_b32 s7, s5, 15
    s_add_u32 s6, s6, s7
    s_lshl_b32 s7, s76, 7
    s_add_u32 s6, s6, s7
    s_add_u32 s6, s6, 768
    v_lshrrev_b32 v6, 1, v1
    v_lshlrev_b32 v6, 10, v6
    v_and_b32 v7, 1, v1
    v_lshl_add_u32 v6, v7, 6, v6
    buffer_load_dword v11, v6, s[12:15], s6 offen
    s_add_u32 s6, s6, 262144
    buffer_load_dword v11, v6, s[12:15], s6 offen
    s_branch L_tch_2c
L_tch_2a:
    v_lshrrev_b32 v6, 5, v1
    v_lshlrev_b32 v6, 6, v6
    v_bfe_u32 v7, v1, 2, 3
    v_add_u32 v6, v6, v7
    v_lshlrev_b32 v6, 13, v6
    v_and_b32 v7, 3, v1
    v_lshl_add_u32 v6, v7, 6, v6
    s_lshl_b32 s6, s4, 8
    s_lshl_b32 s7, s5, 16
    s_add_u32 s6, s6, s7
    s_add_u32 s6, s6, 3145728
    s_cmp_lg_u32 s76, 2
    s_cbranch_scc1 L_tch_2b
    buffer_load_dword v11, v6, s[16:19], s6 offen
    s_branch L_tch_2c
L_tch_2b:
    buffer_load_dword v11, v6, s[20:23], s6 offen
L_tch_2c:
    s_branch L_hook_back
L_hook4:
    s_cmp_lg_u32 s3, 4
    s_cbranch_scc1 L_hook4b
    s_mov_b32 s28, s56
    s_mov_b32 s29, s57
    s_mov_b32 s30, 0x100
    s_mov_b32 s31, 0x20000
    v_mov_b32 v2, 1
    v_lshlrev_b32 v3, 8, v1
    s_and_b32 s6, s2, 31
    s_lshl_b32 s6, s6, 2
    buffer_atomic_add v2, v3, s[28:31], s6 offen offset:0 sc1
L_hook4b:
    s_lshl_b32 s74, s76, 12
    s_add_u32 s74, s74, 131072
    s_mov_b32 m0, s74
    s_add_u32 s74, s74, 16384
    buffer_load_dwordx4 v44, s[24:27], s71 offen offset:0 lds
    buffer_load_dwordx4 v45, s[24:27], s71 offen offset:1024 lds
    buffer_load_dwordx4 v46, s[24:27], s71 offen offset:2048 lds
    buffer_load_dwordx4 v47, s[24:27], s71 offen offset:3072 lds
    s_add_u32 s71, s71, 524288
    s_sub_u32 s75, s71, 5242880
    s_cselect_b32 s71, s71, s75
    s_mov_b32 m0, s74
    s_add_u32 s74, s74, 16384
    buffer_load_dwordx4 v44, s[24:27], s71 offen offset:0 lds
    buffer_load_dwordx4 v45, s[24:27], s71 offen offset:1024 lds
    buffer_load_dwordx4 v46, s[24:27], s71 offen offset:2048 lds
    buffer_load_dwordx4 v47, s[24:27], s71 offen offset:3072 lds
    s_add_u32 s71, s71, 524288
    s_sub_u32 s75, s71, 5242880
    s_cselect_b32 s71, s71, s75
    s_branch L_hook_back
L_hook6:
    s_cmp_lg_u32 s3, 5
    s_cbranch_scc1 L_hook_back
    s_mov_b32 s28, s56
    s_mov_b32 s29, s57
    s_mov_b32 s30, 0x100
    s_mov_b32 s31, 0x20000
    v_and_b32 v3, 31, v1
    v_lshlrev_b32 v3, 2, v3
    buffer_load_dword v62, v3, s[28:31], 0 offen offset:0 sc1
    s_branch L_hook_back
L_vpre:
    s_waitcnt vmcnt(0)
    s_lshl_b32 s6, s65, 4
    s_add_u32 s6, s6, s3
    s_cmp_lg_u32 s6, 0x65
    s_cbranch_scc1 L_vnow
    v_cmp_gt_u32 vcc, 8, v62
    s_cbranch_vccz L_cntok_3
    s_mov_b32 s28, s56
    s_mov_b32 s29, s57
    s_mov_b32 s30, 0x100
    s_mov_b32 s31, 0x20000
    v_and_b32 v3, 31, v1
    v_lshlrev_b32 v3, 2, v3
    s_mov_b32 s79, 262144
L_poll_4:
    buffer_load_dword v2, v3, s[28:31], 0 offen offset:0 sc1
    s_waitcnt vmcnt(0)
    v_cmp_gt_u32 vcc, 8, v2
    s_cbranch_vccz L_polldone_5
    s_sleep 8
    s_sub_u32 s79, s79, 1
    s_cmp_lg_u32 s79, 0
    s_cbranch_scc1 L_poll_4
L_polldone_5:
L_cntok_3:
    s_branch L_vnow
L_khook:
    s_cmp_lg_u32 s65, 7
    s_cbranch_scc1 L_khook_back
    buffer_load_dwordx4 v[16:19], v13, s[8:11], s84 offen offset:0 sc1
    buffer_load_dwordx4 v[20:23], v12, s[8:11], s84 offen offset:0 sc1
    buffer_load_dwordx4 v[24:27], v13, s[8:11], s84 offen offset:1024 sc1
    buffer_load_dwordx4 v[28:31], v12, s[8:11], s84 offen offset:1024 sc1
    buffer_load_dwordx4 v[32:35], v13, s[8:11], s84 offen offset:2048 sc1
    buffer_load_dwordx4 v[36:39], v12, s[8:11], s84 offen offset:2048 sc1
    s_branch L_khook_back
L_kv_v:
    ds_read_b128 v[64:67], v48 offset:0
    ds_read_b128 v[68:71], v48 offset:2048
    ds_read_b64_tr_b16 v[96:97], v50 offset:0
    ds_read_b64_tr_b16 v[98:99], v50 offset:1024
    ds_read_b64_tr_b16 v[100:101], v51 offset:0
    ds_read_b64_tr_b16 v[102:103], v51 offset:1024
    ds_read_b128 v[72:75], v48 offset:4096
    ds_read_b64_tr_b16 v[104:105], v52 offset:0
    ds_read_b64_tr_b16 v[106:107], v52 offset:1024
    ds_read_b64_tr_b16 v[108:109], v53 offset:0
    ds_read_b64_tr_b16 v[110:111], v53 offset:1024
    ds_read_b128 v[76:79], v48 offset:6144
    ds_read_b128 v[80:83], v48 offset:8192
    ds_read_b128 v[84:87], v48 offset:10240
    ds_read_b128 v[88:91], v48 offset:12288
    ds_read_b128 v[92:95], v48 offset:14336
    s_cmp_ge_u32 s76, 2
    s_cbranch_scc1 L_tch_6a
    s_and_b32 s6, s4, 3
    s_lshl_b32 s6, s6, 19
    s_lshl_b32 s7, s5, 15
    s_add_u32 s6, s6, s7
    s_lshl_b32 s7, s76, 7
    s_add_u32 s6, s6, s7
    s_add_u32 s6, s6, 256
    v_lshrrev_b32 v6, 1, v1
    v_lshlrev_b32 v6, 10, v6
    v_and_b32 v7, 1, v1
    v_lshl_add_u32 v6, v7, 6, v6
    buffer_load_dword v11, v6, s[12:15], s6 offen
    s_add_u32 s6, s6, 262144
    buffer_load_dword v11, v6, s[12:15], s6 offen
    s_branch L_tch_6c
L_tch_6a:
    v_lshrrev_b32 v6, 5, v1
    v_lshlrev_b32 v6, 6, v6
    v_bfe_u32 v7, v1, 2, 3
    v_add_u32 v6, v6, v7
    v_lshlrev_b32 v6, 13, v6
    v_and_b32 v7, 3, v1
    v_lshl_add_u32 v6, v7, 6, v6
    s_lshl_b32 s6, s4, 8
    s_lshl_b32 s7, s5, 16
    s_add_u32 s6, s6, s7
    s_add_u32 s6, s6, 1048576
    s_cmp_lg_u32 s76, 2
    s_cbranch_scc1 L_tch_6b
    buffer_load_dword v11, v6, s[16:19], s6 offen
    s_branch L_tch_6c
L_tch_6b:
    buffer_load_dword v11, v6, s[20:23], s6 offen
L_tch_6c:
.p2align 4
L_vloop:
    s_bitcmp1_b32 214, s65
    s_cbranch_scc1 L_hook
L_hook_back:
    s_waitcnt lgkmcnt(12)
    v_mfma_f32_16x16x32_bf16 v[128:131], v[64:67], v[96:99], v[128:131]
    ds_read_b64_tr_b16 v[112:113], v50 offset:8192
    s_waitcnt lgkmcnt(11)
    v_mfma_f32_16x16x32_bf16 v[132:135], v[64:67], v[100:103], v[132:135]
    ds_read_b64_tr_b16 v[114:115], v50 offset:9216
    s_waitcnt lgkmcnt(9)
    v_mfma_f32_16x16x32_bf16 v[136:139], v[64:67], v[104:107], v[136:139]
    ds_read_b64_tr_b16 v[116:117], v51 offset:8192
    s_waitcnt lgkmcnt(8)
    v_mfma_f32_16x16x32_bf16 v[140:143], v[64:67], v[108:111], v[140:143]
    ds_read_b64_tr_b16 v[118:119], v51 offset:9216
    ds_read_b128 v[64:67], v49 offset:0
    v_mfma_f32_16x16x32_bf16 v[156:159], v[68:71], v[108:111], v[156:159]
    ds_read_b64_tr_b16 v[120:121], v52 offset:8192
    v_mfma_f32_16x16x32_bf16 v[152:155], v[68:71], v[104:107], v[152:155]
    ds_read_b64_tr_b16 v[122:123], v52 offset:9216
    v_mfma_f32_16x16x32_bf16 v[148:151], v[68:71], v[100:103], v[148:151]
    ds_read_b64_tr_b16 v[124:125], v53 offset:8192
    v_mfma_f32_16x16x32_bf16 v[144:147], v[68:71], v[96:99], v[144:147]
    ds_read_b64_tr_b16 v[126:127], v53 offset:9216
    ds_read_b128 v[68:71], v49 offset:2048
    v_mfma_f32_16x16x32_bf16 v[160:163], v[72:75], v[96:99], v[160:163]
    v_mfma_f32_16x16x32_bf16 v[164:167], v[72:75], v[100:103], v[164:167]
    v_mfma_f32_16x16x32_bf16 v[168:171], v[72:75], v[104:107], v[168:171]
    v_mfma_f32_16x16x32_bf16 v[172:175], v[72:75], v[108:111], v[172:175]
    ds_read_b128 v[72:75], v49 offset:4096
    s_waitcnt lgkmcnt(15)
    v_mfma_f32_16x16x32_bf16 v[188:191], v[76:79], v[108:111], v[188:191]
    v_mfma_f32_16x16x32_bf16 v[184:187], v[76:79], v[104:107], v[184:187]
    v_mfma_f32_16x16x32_bf16 v[180:183], v[76:79], v[100:103], v[180:183]
    v_mfma_f32_16x16x32_bf16 v[176:179], v[76:79], v[96:99], v[176:179]
    ds_read_b128 v[76:79], v49 offset:6144
    s_waitcnt lgkmcnt(15)
    v_mfma_f32_16x16x32_bf16 v[192:195], v[80:83], v[96:99], v[192:195]
    v_mfma_f32_16x16x32_bf16 v[196:199], v[80:83], v[100:103], v[196:199]
    v_mfma_f32_16x16x32_bf16 v[200:203], v[80:83], v[104:107], v[200:203]
    v_mfma_f32_16x16x32_bf16 v[204:207], v[80:83], v[108:111], v[204:207]
    ds_read_b128 v[80:83], v49 offset:8192
    s_waitcnt lgkmcnt(15)
    v_mfma_f32_16x16x32_bf16 v[220:223], v[84:87], v[108:111], v[220:223]
    v_mfma_f32_16x16x32_bf16 v[216:219], v[84:87], v[104:107], v[216:219]
    v_mfma_f32_16x16x32_bf16 v[212:215], v[84:87], v[100:103], v[212:215]
    v_mfma_f32_16x16x32_bf16 v[208:211], v[84:87], v[96:99], v[208:211]
    ds_read_b128 v[84:87], v49 offset:10240
    s_waitcnt lgkmcnt(15)
    v_mfma_f32_16x16x32_bf16 v[224:227], v[88:91], v[96:99], v[224:227]
    v_mfma_f32_16x16x32_bf16 v[228:231], v[88:91], v[100:103], v[228:231]
    v_mfma_f32_16x16x32_bf16 v[232:235], v[88:91], v[104:107], v[232:235]
    v_mfma_f32_16x16x32_bf16 v[236:239], v[88:91], v[108:111], v[236:239]
    ds_read_b128 v[88:91], v49 offset:12288
    s_waitcnt lgkmcnt(15)
    v_mfma_f32_16x16x32_bf16 v[252:255], v[92:95], v[108:111], v[252:255]
    v_mfma_f32_16x16x32_bf16 v[248:251], v[92:95], v[104:107], v[248:251]
    v_mfma_f32_16x16x32_bf16 v[244:247], v[92:95], v[100:103], v[244:247]
    v_mfma_f32_16x16x32_bf16 v[240:243], v[92:95], v[96:99], v[240:243]
    ds_read_b128 v[92:95], v49 offset:14336
    s_waitcnt lgkmcnt(11)
    v_mfma_f32_16x16x32_bf16 v[128:131], v[64:67], v[112:115], v[128:131]
    v_mfma_f32_16x16x32_bf16 v[132:135], v[64:67], v[116:119], v[132:135]
    s_waitcnt lgkmcnt(9)
    v_mfma_f32_16x16x32_bf16 v[136:139], v[64:67], v[120:123], v[136:139]
    s_waitcnt lgkmcnt(7)
    v_mfma_f32_16x16x32_bf16 v[140:143], v[64:67], v[124:127], v[140:143]
    s_waitcnt lgkmcnt(6)
    v_mfma_f32_16x16x32_bf16 v[156:159], v[68:71], v[124:127], v[156:159]
    v_mfma_f32_16x16x32_bf16 v[152:155], v[68:71], v[120:123], v[152:155]
    v_mfma_f32_16x16x32_bf16 v[148:151], v[68:71], v[116:119], v[148:151]
    v_mfma_f32_16x16x32_bf16 v[144:147], v[68:71], v[112:115], v[144:147]
    v_xor_b32 v48, 0x10000, v48
    v_xor_b32 v49, 0x10000, v49
    v_xor_b32 v50, 0x10000, v50
    v_xor_b32 v51, 0x10000, v51
    v_xor_b32 v52, 0x10000, v52
    v_xor_b32 v53, 0x10000, v53
    s_bitcmp1_b32 0x48, s65
    s_cbranch_scc1 L_vpre
L_vnow:
    s_waitcnt lgkmcnt(0)
    s_barrier
    ds_read_b128 v[64:67], v48 offset:0
    ds_read_b128 v[68:71], v48 offset:2048
    v_mfma_f32_16x16x32_bf16 v[160:163], v[72:75], v[112:115], v[160:163]
    ds_read_b64_tr_b16 v[96:97], v50 offset:0
    v_mfma_f32_16x16x32_bf16 v[164:167], v[72:75], v[116:119], v[164:167]
    ds_read_b64_tr_b16 v[98:99], v50 offset:1024
    v_mfma_f32_16x16x32_bf16 v[168:171], v[72:75], v[120:123], v[168:171]
    ds_read_b64_tr_b16 v[100:101], v51 offset:0
    v_mfma_f32_16x16x32_bf16 v[172:175], v[72:75], v[124:127], v[172:175]
    ds_read_b64_tr_b16 v[102:103], v51 offset:1024
    ds_read_b128 v[72:75], v48 offset:4096
    v_mfma_f32_16x16x32_bf16 v[188:191], v[76:79], v[124:127], v[188:191]
    ds_read_b64_tr_b16 v[104:105], v52 offset:0
    v_mfma_f32_16x16x32_bf16 v[184:187], v[76:79], v[120:123], v[184:187]
    ds_read_b64_tr_b16 v[106:107], v52 offset:1024
    v_mfma_f32_16x16x32_bf16 v[180:183], v[76:79], v[116:119], v[180:183]
    ds_read_b64_tr_b16 v[108:109], v53 offset:0
    v_mfma_f32_16x16x32_bf16 v[176:179], v[76:79], v[112:115], v[176:179]
    ds_read_b64_tr_b16 v[110:111], v53 offset:1024
    ds_read_b128 v[76:79], v48 offset:6144
    v_mfma_f32_16x16x32_bf16 v[192:195], v[80:83], v[112:115], v[192:195]
    v_mfma_f32_16x16x32_bf16 v[196:199], v[80:83], v[116:119], v[196:199]
    v_mfma_f32_16x16x32_bf16 v[200:203], v[80:83], v[120:123], v[200:203]
    v_mfma_f32_16x16x32_bf16 v[204:207], v[80:83], v[124:127], v[204:207]
    ds_read_b128 v[80:83], v48 offset:8192
    v_mfma_f32_16x16x32_bf16 v[220:223], v[84:87], v[124:127], v[220:223]
    v_mfma_f32_16x16x32_bf16 v[216:219], v[84:87], v[120:123], v[216:219]
    v_mfma_f32_16x16x32_bf16 v[212:215], v[84:87], v[116:119], v[212:215]
    v_mfma_f32_16x16x32_bf16 v[208:211], v[84:87], v[112:115], v[208:211]
    ds_read_b128 v[84:87], v48 offset:10240
    v_mfma_f32_16x16x32_bf16 v[224:227], v[88:91], v[112:115], v[224:227]
    v_mfma_f32_16x16x32_bf16 v[228:231], v[88:91], v[116:119], v[228:231]
    v_mfma_f32_16x16x32_bf16 v[232:235], v[88:91], v[120:123], v[232:235]
    v_mfma_f32_16x16x32_bf16 v[236:239], v[88:91], v[124:127], v[236:239]
    ds_read_b128 v[88:91], v48 offset:12288
    v_mfma_f32_16x16x32_bf16 v[252:255], v[92:95], v[124:127], v[252:255]
    v_mfma_f32_16x16x32_bf16 v[248:251], v[92:95], v[120:123], v[248:251]
    v_mfma_f32_16x16x32_bf16 v[244:247], v[92:95], v[116:119], v[244:247]
    v_mfma_f32_16x16x32_bf16 v[240:243], v[92:95], v[112:115], v[240:243]
    ds_read_b128 v[92:95], v48 offset:14336
    s_add_u32 s65, s65, 1
    s_cmp_lt_u32 s65, 8
    s_cbranch_scc1 L_vloop
    s_waitcnt lgkmcnt(0)
    s_nop 7
    v_cvt_pk_bf16_f32 v128, v128, v129
    v_cvt_pk_bf16_f32 v129, v130, v131
    v_cvt_pk_bf16_f32 v130, v144, v145
    v_cvt_pk_bf16_f32 v131, v146, v147
    v_cvt_pk_bf16_f32 v132, v132, v133
    v_cvt_pk_bf16_f32 v133, v134, v135
    v_cvt_pk_bf16_f32 v134, v148, v149
    v_cvt_pk_bf16_f32 v135, v150, v151
    v_cvt_pk_bf16_f32 v136, v136, v137
    v_cvt_pk_bf16_f32 v137, v138, v139
    v_cvt_pk_bf16_f32 v138, v152, v153
    v_cvt_pk_bf16_f32 v139, v154, v155
    v_cvt_pk_bf16_f32 v140, v140, v141
    v_cvt_pk_bf16_f32 v141, v142, v143
    v_cvt_pk_bf16_f32 v142, v156, v157
    v_cvt_pk_bf16_f32 v143, v158, v159
    v_cvt_pk_bf16_f32 v144, v160, v161
    v_cvt_pk_bf16_f32 v145, v162, v163
    v_cvt_pk_bf16_f32 v146, v176, v177
    v_cvt_pk_bf16_f32 v147, v178, v179
    v_cvt_pk_bf16_f32 v148, v164, v165
    v_cvt_pk_bf16_f32 v149, v166, v167
    v_cvt_pk_bf16_f32 v150, v180, v181
    v_cvt_pk_bf16_f32 v151, v182, v183
    v_cvt_pk_bf16_f32 v152, v168, v169
    v_cvt_pk_bf16_f32 v153, v170, v171
    v_cvt_pk_bf16_f32 v154, v184, v185
    v_cvt_pk_bf16_f32 v155, v186, v187
    v_cvt_pk_bf16_f32 v156, v172, v173
    v_cvt_pk_bf16_f32 v157, v174, v175
    v_cvt_pk_bf16_f32 v158, v188, v189
    v_cvt_pk_bf16_f32 v159, v190, v191
    v_cvt_pk_bf16_f32 v160, v192, v193
    v_cvt_pk_bf16_f32 v161, v194, v195
    v_cvt_pk_bf16_f32 v162, v208, v209
    v_cvt_pk_bf16_f32 v163, v210, v211
    v_cvt_pk_bf16_f32 v164, v196, v197
    v_cvt_pk_bf16_f32 v165, v198, v199
    v_cvt_pk_bf16_f32 v166, v212, v213
    v_cvt_pk_bf16_f32 v167, v214, v215
    v_cvt_pk_bf16_f32 v168, v200, v201
    v_cvt_pk_bf16_f32 v169, v202, v203
    v_cvt_pk_bf16_f32 v170, v216, v217
    v_cvt_pk_bf16_f32 v171, v218, v219
    v_cvt_pk_bf16_f32 v172, v204, v205
    v_cvt_pk_bf16_f32 v173, v206, v207
    v_cvt_pk_bf16_f32 v174, v220, v221
    v_cvt_pk_bf16_f32 v175, v222, v223
    v_cvt_pk_bf16_f32 v176, v224, v225
    v_cvt_pk_bf16_f32 v177, v226, v227
    v_cvt_pk_bf16_f32 v178, v240, v241
    v_cvt_pk_bf16_f32 v179, v242, v243
    v_cvt_pk_bf16_f32 v180, v228, v229
    v_cvt_pk_bf16_f32 v181, v230, v231
    v_cvt_pk_bf16_f32 v182, v244, v245
    v_cvt_pk_bf16_f32 v183, v246, v247
    v_cvt_pk_bf16_f32 v184, v232, v233
    v_cvt_pk_bf16_f32 v185, v234, v235
    v_cvt_pk_bf16_f32 v186, v248, v249
    v_cvt_pk_bf16_f32 v187, v250, v251
    v_cvt_pk_bf16_f32 v188, v236, v237
    v_cvt_pk_bf16_f32 v189, v238, v239
    v_cvt_pk_bf16_f32 v190, v252, v253
    v_cvt_pk_bf16_f32 v191, v254, v255
    s_waitcnt vmcnt(0)
L_q:
    s_mov_b32 s28, s56
    s_mov_b32 s29, s57
    s_mov_b32 s30, 0x100
    s_mov_b32 s31, 0x20000
    s_lshl_b32 s6, s76, 13
    v_add_u32 v49, s6, v13
    s_lshl_b32 s6, s76, 12
    v_add_u32 v50, s6, v13
    s_lshl_b32 s77, s4, 20
    s_add_u32 s77, s77, 16777216
    s_mov_b32 s78, s100
    s_sub_u32 s101, s100, 131072
    s_mov_b32 s90, 0
    s_cmp_lt_u32 s3, 4
    s_cselect_b32 s89, 3, 2
    ds_read_b64_tr_b16 v[96:97], v54 offset:0
    ds_read_b64_tr_b16 v[98:99], v54 offset:1024
    ds_read_b64_tr_b16 v[100:101], v55 offset:0
    ds_read_b64_tr_b16 v[102:103], v55 offset:1024
    ds_read_b64_tr_b16 v[104:105], v56 offset:0
    ds_read_b64_tr_b16 v[106:107], v56 offset:1024
    ds_read_b64_tr_b16 v[108:109], v57 offset:0
    ds_read_b64_tr_b16 v[110:111], v57 offset:1024
    ds_read_b64_tr_b16 v[112:113], v58 offset:0
    ds_read_b64_tr_b16 v[114:115], v58 offset:1024
    ds_read_b64_tr_b16 v[116:117], v59 offset:0
    ds_read_b64_tr_b16 v[118:119], v59 offset:1024
    ds_read_b64_tr_b16 v[120:121], v60 offset:0
    ds_read_b64_tr_b16 v[122:123], v60 offset:1024
    ds_read_b64_tr_b16 v[124:125], v61 offset:0
    ds_read_b64_tr_b16 v[126:127], v61 offset:1024
    buffer_load_dwordx4 v[64:67], v13, s[8:11], s84 offen offset:3072 sc1
    buffer_load_dwordx4 v[68:71], v12, s[8:11], s84 offen offset:3072 sc1
    buffer_load_dwordx4 v[72:75], v13, s[8:11], s85 offen offset:0 sc1
    buffer_load_dwordx4 v[76:79], v12, s[8:11], s85 offen offset:0 sc1
    buffer_load_dwordx4 v[80:83], v13, s[8:11], s85 offen offset:1024 sc1
    buffer_load_dwordx4 v[84:87], v12, s[8:11], s85 offen offset:1024 sc1
    buffer_load_dwordx4 v[88:91], v13, s[8:11], s85 offen offset:2048 sc1
    buffer_load_dwordx4 v[92:95], v12, s[8:11], s85 offen offset:2048 sc1
    s_waitcnt lgkmcnt(14)
    v_mfma_f32_16x16x32_bf16 v[192:195], v[96:99], v[16:19], 0
    v_mfma_f32_16x16x32_bf16 v[196:199], v[96:99], v[20:23], 0
    ds_read_b64_tr_b16 v[96:97], v54 offset:8192
    s_waitcnt lgkmcnt(13)
    v_mfma_f32_16x16x32_bf16 v[204:207], v[100:103], v[20:23], 0
    ds_read_b64_tr_b16 v[98:99], v54 offset:9216
    v_mfma_f32_16x16x32_bf16 v[200:203], v[100:103], v[16:19], 0
    ds_read_b64_tr_b16 v[100:101], v55 offset:8192
    s_waitcnt lgkmcnt(13)
    v_mfma_f32_16x16x32_bf16 v[208:211], v[104:107], v[16:19], 0
    ds_read_b64_tr_b16 v[102:103], v55 offset:9216
    v_mfma_f32_16x16x32_bf16 v[212:215], v[104:107], v[20:23], 0
    ds_read_b64_tr_b16 v[104:105], v56 offset:8192
    s_waitcnt lgkmcnt(13)
    v_mfma_f32_16x16x32_bf16 v[220:223], v[108:111], v[20:23], 0
    ds_read_b64_tr_b16 v[106:107], v56 offset:9216
    buffer_store_dwordx4 v[128:131], v13, s[8:11], s67 offen sc1
    s_add_u32 s67, s67, 1024
    v_mfma_f32_16x16x32_bf16 v[216:219], v[108:111], v[16:19], 0
    ds_read_b64_tr_b16 v[108:109], v57 offset:8192
    s_waitcnt lgkmcnt(13)
    v_mfma_f32_16x16x32_bf16 v[224:227], v[112:115], v[16:19], 0
    ds_read_b64_tr_b16 v[110:111], v57 offset:9216
    v_mfma_f32_16x16x32_bf16 v[228:231], v[112:115], v[20:23], 0
    ds_read_b64_tr_b16 v[112:113], v58 offset:8192
    s_waitcnt lgkmcnt(13)
    v_mfma_f32_16x16x32_bf16 v[236:239], v[116:119], v[20:23], 0
    ds_read_b64_tr_b16 v[114:115], v58 offset:9216
    v_mfma_f32_16x16x32_bf16 v[232:235], v[116:119], v[16:19], 0
    ds_read_b64_tr_b16 v[116:117], v59 offset:8192
    s_waitcnt lgkmcnt(13)
    v_mfma_f32_16x16x32_bf16 v[240:243], v[120:123], v[16:19], 0
    ds_read_b64_tr_b16 v[118:119], v59 offset:9216
    v_mfma_f32_16x16x32_bf16 v[244:247], v[120:123], v[20:23], 0
    ds_read_b64_tr_b16 v[120:121], v60 offset:8192
    s_waitcnt lgkmcnt(13)
    v_mfma_f32_16x16x32_bf16 v[252:255], v[124:127], v[20:23], 0
    ds_read_b64_tr_b16 v[122:123], v60 offset:9216
    v_mfma_f32_16x16x32_bf16 v[248:251], v[124:127], v[16:19], 0
    ds_read_b64_tr_b16 v[124:125], v61 offset:8192
    ds_read_b64_tr_b16 v[126:127], v61 offset:9216
    buffer_load_dwordx4 v[16:19], v13, s[8:11], s85 offen offset:3072 sc1
    buffer_load_dwordx4 v[20:23], v12, s[8:11], s85 offen offset:3072 sc1
    s_waitcnt lgkmcnt(14)
    v_mfma_f32_16x16x32_bf16 v[192:195], v[96:99], v[24:27], v[192:195]
    v_mfma_f32_16x16x32_bf16 v[196:199], v[96:99], v[28:31], v[196:199]
    ds_read_b64_tr_b16 v[96:97], v54 offset:16384
    s_waitcnt lgkmcnt(13)
    v_mfma_f32_16x16x32_bf16 v[204:207], v[100:103], v[28:31], v[204:207]
    ds_read_b64_tr_b16 v[98:99], v54 offset:17408
    v_mfma_f32_16x16x32_bf16 v[200:203], v[100:103], v[24:27], v[200:203]
    ds_read_b64_tr_b16 v[100:101], v55 offset:16384
    s_waitcnt lgkmcnt(13)
    v_mfma_f32_16x16x32_bf16 v[208:211], v[104:107], v[24:27], v[208:211]
    ds_read_b64_tr_b16 v[102:103], v55 offset:17408
    v_mfma_f32_16x16x32_bf16 v[212:215], v[104:107], v[28:31], v[212:215]
    ds_read_b64_tr_b16 v[104:105], v56 offset:16384
    s_waitcnt lgkmcnt(13)
    v_mfma_f32_16x16x32_bf16 v[220:223], v[108:111], v[28:31], v[220:223]
    ds_read_b64_tr_b16 v[106:107], v56 offset:17408
    buffer_store_dwordx4 v[132:135], v13, s[8:11], s67 offen sc1
    s_add_u32 s67, s67, s68
    v_mfma_f32_16x16x32_bf16 v[216:219], v[108:111], v[24:27], v[216:219]
    ds_read_b64_tr_b16 v[108:109], v57 offset:16384
    s_waitcnt lgkmcnt(13)
    v_mfma_f32_16x16x32_bf16 v[224:227], v[112:115], v[24:27], v[224:227]
    ds_read_b64_tr_b16 v[110:111], v57 offset:17408
    v_mfma_f32_16x16x32_bf16 v[228:231], v[112:115], v[28:31], v[228:231]
    ds_read_b64_tr_b16 v[112:113], v58 offset:16384
    s_waitcnt lgkmcnt(13)
    v_mfma_f32_16x16x32_bf16 v[236:239], v[116:119], v[28:31], v[236:239]
    ds_read_b64_tr_b16 v[114:115], v58 offset:17408
    v_mfma_f32_16x16x32_bf16 v[232:235], v[116:119], v[24:27], v[232:235]
    ds_read_b64_tr_b16 v[116:117], v59 offset:16384
    s_waitcnt lgkmcnt(13)
    v_mfma_f32_16x16x32_bf16 v[240:243], v[120:123], v[24:27], v[240:243]
    ds_read_b64_tr_b16 v[118:119], v59 offset:17408
    v_mfma_f32_16x16x32_bf16 v[244:247], v[120:123], v[28:31], v[244:247]
    ds_read_b64_tr_b16 v[120:121], v60 offset:16384
    s_waitcnt lgkmcnt(13)
    v_mfma_f32_16x16x32_bf16 v[252:255], v[124:127], v[28:31], v[252:255]
    ds_read_b64_tr_b16 v[122:123], v60 offset:17408
    v_mfma_f32_16x16x32_bf16 v[248:251], v[124:127], v[24:27], v[248:251]
    ds_read_b64_tr_b16 v[124:125], v61 offset:16384
    ds_read_b64_tr_b16 v[126:127], v61 offset:17408
    buffer_load_dwordx4 v[24:27], v13, s[8:11], s86 offen offset:0 sc1
    buffer_load_dwordx4 v[28:31], v12, s[8:11], s86 offen offset:0 sc1
    s_waitcnt lgkmcnt(14)
    v_mfma_f32_16x16x32_bf16 v[192:195], v[96:99], v[32:35], v[192:195]
    v_mfma_f32_16x16x32_bf16 v[196:199], v[96:99], v[36:39], v[196:199]
    ds_read_b64_tr_b16 v[96:97], v54 offset:24576
    s_waitcnt lgkmcnt(13)
    v_mfma_f32_16x16x32_bf16 v[204:207], v[100:103], v[36:39], v[204:207]
    ds_read_b64_tr_b16 v[98:99], v54 offset:25600
    v_mfma_f32_16x16x32_bf16 v[200:203], v[100:103], v[32:35], v[200:203]
    ds_read_b64_tr_b16 v[100:101], v55 offset:24576
    s_waitcnt lgkmcnt(13)
    v_mfma_f32_16x16x32_bf16 v[208:211], v[104:107], v[32:35], v[208:211]
    ds_read_b64_tr_b16 v[102:103], v55 offset:25600
    v_mfma_f32_16x16x32_bf16 v[212:215], v[104:107], v[36:39], v[212:215]
    ds_read_b64_tr_b16 v[104:105], v56 offset:24576
    s_waitcnt lgkmcnt(13)
    v_mfma_f32_16x16x32_bf16 v[220:223], v[108:111], v[36:39], v[220:223]
    ds_read_b64_tr_b16 v[106:107], v56 offset:25600
    buffer_store_dwordx4 v[136:139], v13, s[8:11], s67 offen sc1
    s_add_u32 s67, s67, 1024
    v_mfma_f32_16x16x32_bf16 v[216:219], v[108:111], v[32:35], v[216:219]
    ds_read_b64_tr_b16 v[108:109], v57 offset:24576
    s_waitcnt lgkmcnt(13)
    v_mfma_f32_16x16x32_bf16 v[224:227], v[112:115], v[32:35], v[224:227]
    ds_read_b64_tr_b16 v[110:111], v57 offset:25600
    v_mfma_f32_16x16x32_bf16 v[228:231], v[112:115], v[36:39], v[228:231]
    ds_read_b64_tr_b16 v[112:113], v58 offset:24576
    s_waitcnt lgkmcnt(13)
    v_mfma_f32_16x16x32_bf16 v[236:239], v[116:119], v[36:39], v[236:239]
    ds_read_b64_tr_b16 v[114:115], v58 offset:25600
    v_mfma_f32_16x16x32_bf16 v[232:235], v[116:119], v[32:35], v[232:235]
    ds_read_b64_tr_b16 v[116:117], v59 offset:24576
    s_waitcnt lgkmcnt(13)
    v_mfma_f32_16x16x32_bf16 v[240:243], v[120:123], v[32:35], v[240:243]
    ds_read_b64_tr_b16 v[118:119], v59 offset:25600
    v_mfma_f32_16x16x32_bf16 v[244:247], v[120:123], v[36:39], v[244:247]
    ds_read_b64_tr_b16 v[120:121], v60 offset:24576
    s_waitcnt lgkmcnt(13)
    v_mfma_f32_16x16x32_bf16 v[252:255], v[124:127], v[36:39], v[252:255]
    ds_read_b64_tr_b16 v[122:123], v60 offset:25600
    v_mfma_f32_16x16x32_bf16 v[248:251], v[124:127], v[32:35], v[248:251]
    ds_read_b64_tr_b16 v[124:125], v61 offset:24576
    ds_read_b64_tr_b16 v[126:127], v61 offset:25600
    buffer_load_dwordx4 v[32:35], v13, s[8:11], s86 offen offset:1024 sc1
    buffer_load_dwordx4 v[36:39], v12, s[8:11], s86 offen offset:1024 sc1
    s_waitcnt vmcnt(15)
    s_waitcnt lgkmcnt(14)
    v_mfma_f32_16x16x32_bf16 v[192:195], v[96:99], v[64:67], v[192:195]
    v_add_u32 v54, s101, v54
    v_mfma_f32_16x16x32_bf16 v[196:199], v[96:99], v[68:71], v[196:199]
    ds_read_b64_tr_b16 v[96:97], v54 offset:0
    s_waitcnt lgkmcnt(13)
    v_mfma_f32_16x16x32_bf16 v[204:207], v[100:103], v[68:71], v[204:207]
    ds_read_b64_tr_b16 v[98:99], v54 offset:1024
    v_add_u32 v55, s101, v55
    v_mfma_f32_16x16x32_bf16 v[200:203], v[100:103], v[64:67], v[200:203]
    ds_read_b64_tr_b16 v[100:101], v55 offset:0
    s_waitcnt lgkmcnt(13)
    v_mfma_f32_16x16x32_bf16 v[208:211], v[104:107], v[64:67], v[208:211]
    ds_read_b64_tr_b16 v[102:103], v55 offset:1024
    v_add_u32 v56, s101, v56
    v_mfma_f32_16x16x32_bf16 v[212:215], v[104:107], v[68:71], v[212:215]
    ds_read_b64_tr_b16 v[104:105], v56 offset:0
    s_waitcnt lgkmcnt(13)
    v_mfma_f32_16x16x32_bf16 v[220:223], v[108:111], v[68:71], v[220:223]
    ds_read_b64_tr_b16 v[106:107], v56 offset:1024
    v_add_u32 v57, s101, v57
    buffer_store_dwordx4 v[140:143], v13, s[8:11], s67 offen sc1
    s_add_u32 s67, s67, s69
    v_mfma_f32_16x16x32_bf16 v[216:219], v[108:111], v[64:67], v[216:219]
    ds_read_b64_tr_b16 v[108:109], v57 offset:0
    s_waitcnt lgkmcnt(13)
    v_mfma_f32_16x16x32_bf16 v[224:227], v[112:115], v[64:67], v[224:227]
    ds_read_b64_tr_b16 v[110:111], v57 offset:1024
    v_add_u32 v58, s101, v58
    v_mfma_f32_16x16x32_bf16 v[228:231], v[112:115], v[68:71], v[228:231]
    ds_read_b64_tr_b16 v[112:113], v58 offset:0
    s_waitcnt lgkmcnt(13)
    v_mfma_f32_16x16x32_bf16 v[236:239], v[116:119], v[68:71], v[236:239]
    ds_read_b64_tr_b16 v[114:115], v58 offset:1024
    v_add_u32 v59, s101, v59
    v_mfma_f32_16x16x32_bf16 v[232:235], v[116:119], v[64:67], v[232:235]
    ds_read_b64_tr_b16 v[116:117], v59 offset:0
    s_waitcnt lgkmcnt(13)
    v_mfma_f32_16x16x32_bf16 v[240:243], v[120:123], v[64:67], v[240:243]
    ds_read_b64_tr_b16 v[118:119], v59 offset:1024
    v_add_u32 v60, s101, v60
    v_mfma_f32_16x16x32_bf16 v[244:247], v[120:123], v[68:71], v[244:247]
    ds_read_b64_tr_b16 v[120:121], v60 offset:0
    s_waitcnt lgkmcnt(13)
    v_mfma_f32_16x16x32_bf16 v[252:255], v[124:127], v[68:71], v[252:255]
    ds_read_b64_tr_b16 v[122:123], v60 offset:1024
    v_add_u32 v61, s101, v61
    v_mfma_f32_16x16x32_bf16 v[248:251], v[124:127], v[64:67], v[248:251]
    ds_read_b64_tr_b16 v[124:125], v61 offset:0
    ds_read_b64_tr_b16 v[126:127], v61 offset:1024
    buffer_load_dwordx4 v[64:67], v13, s[8:11], s86 offen offset:2048 sc1
    buffer_load_dwordx4 v[68:71], v12, s[8:11], s86 offen offset:2048 sc1
    s_waitcnt vmcnt(16)
    s_waitcnt lgkmcnt(14)
    v_mfma_f32_16x16x32_bf16 v[192:195], v[96:99], v[72:75], v[192:195]
    v_mfma_f32_16x16x32_bf16 v[196:199], v[96:99], v[76:79], v[196:199]
    ds_read_b64_tr_b16 v[96:97], v54 offset:8192
    s_waitcnt lgkmcnt(13)
    v_mfma_f32_16x16x32_bf16 v[204:207], v[100:103], v[76:79], v[204:207]
    ds_read_b64_tr_b16 v[98:99], v54 offset:9216
    v_mfma_f32_16x16x32_bf16 v[200:203], v[100:103], v[72:75], v[200:203]
    ds_read_b64_tr_b16 v[100:101], v55 offset:8192
    s_waitcnt lgkmcnt(13)
    v_mfma_f32_16x16x32_bf16 v[208:211], v[104:107], v[72:75], v[208:211]
    ds_read_b64_tr_b16 v[102:103], v55 offset:9216
    v_mfma_f32_16x16x32_bf16 v[212:215], v[104:107], v[76:79], v[212:215]
    ds_read_b64_tr_b16 v[104:105], v56 offset:8192
    s_waitcnt lgkmcnt(13)
    v_mfma_f32_16x16x32_bf16 v[220:223], v[108:111], v[76:79], v[220:223]
    ds_read_b64_tr_b16 v[106:107], v56 offset:9216
    v_mfma_f32_16x16x32_bf16 v[216:219], v[108:111], v[72:75], v[216:219]
    ds_read_b64_tr_b16 v[108:109], v57 offset:8192
    s_waitcnt lgkmcnt(13)
    v_mfma_f32_16x16x32_bf16 v[224:227], v[112:115], v[72:75], v[224:227]
    ds_read_b64_tr_b16 v[110:111], v57 offset:9216
    v_mfma_f32_16x16x32_bf16 v[228:231], v[112:115], v[76:79], v[228:231]
    ds_read_b64_tr_b16 v[112:113], v58 offset:8192
    s_waitcnt lgkmcnt(13)
    v_mfma_f32_16x16x32_bf16 v[236:239], v[116:119], v[76:79], v[236:239]
    ds_read_b64_tr_b16 v[114:115], v58 offset:9216
    v_mfma_f32_16x16x32_bf16 v[232:235], v[116:119], v[72:75], v[232:235]
    ds_read_b64_tr_b16 v[116:117], v59 offset:8192
    s_waitcnt lgkmcnt(13)
    v_mfma_f32_16x16x32_bf16 v[240:243], v[120:123], v[72:75], v[240:243]
    ds_read_b64_tr_b16 v[118:119], v59 offset:9216
    v_mfma_f32_16x16x32_bf16 v[244:247], v[120:123], v[76:79], v[244:247]
    ds_read_b64_tr_b16 v[120:121], v60 offset:8192
    s_waitcnt lgkmcnt(13)
    v_mfma_f32_16x16x32_bf16 v[252:255], v[124:127], v[76:79], v[252:255]
    ds_read_b64_tr_b16 v[122:123], v60 offset:9216
    v_mfma_f32_16x16x32_bf16 v[248:251], v[124:127], v[72:75], v[248:251]
    ds_read_b64_tr_b16 v[124:125], v61 offset:8192
    ds_read_b64_tr_b16 v[126:127], v61 offset:9216
    buffer_load_dwordx4 v[72:75], v13, s[8:11], s86 offen offset:3072 sc1
    buffer_load_dwordx4 v[76:79], v12, s[8:11], s86 offen offset:3072 sc1
    s_waitcnt vmcnt(16)
    s_waitcnt lgkmcnt(14)
    v_mfma_f32_16x16x32_bf16 v[192:195], v[96:99], v[80:83], v[192:195]
    v_mfma_f32_16x16x32_bf16 v[196:199], v[96:99], v[84:87], v[196:199]
    ds_read_b64_tr_b16 v[96:97], v54 offset:16384
    s_waitcnt lgkmcnt(13)
    v_mfma_f32_16x16x32_bf16 v[204:207], v[100:103], v[84:87], v[204:207]
    ds_read_b64_tr_b16 v[98:99], v54 offset:17408
    v_mfma_f32_16x16x32_bf16 v[200:203], v[100:103], v[80:83], v[200:203]
    ds_read_b64_tr_b16 v[100:101], v55 offset:16384
    s_waitcnt lgkmcnt(13)
    v_mfma_f32_16x16x32_bf16 v[208:211], v[104:107], v[80:83], v[208:211]
    ds_read_b64_tr_b16 v[102:103], v55 offset:17408
    v_mfma_f32_16x16x32_bf16 v[212:215], v[104:107], v[84:87], v[212:215]
    ds_read_b64_tr_b16 v[104:105], v56 offset:16384
    s_waitcnt lgkmcnt(13)
    v_mfma_f32_16x16x32_bf16 v[220:223], v[108:111], v[84:87], v[220:223]
    ds_read_b64_tr_b16 v[106:107], v56 offset:17408
    v_mfma_f32_16x16x32_bf16 v[216:219], v[108:111], v[80:83], v[216:219]
    ds_read_b64_tr_b16 v[108:109], v57 offset:16384
    s_waitcnt lgkmcnt(13)
    v_mfma_f32_16x16x32_bf16 v[224:227], v[112:115], v[80:83], v[224:227]
    ds_read_b64_tr_b16 v[110:111], v57 offset:17408
    v_mfma_f32_16x16x32_bf16 v[228:231], v[112:115], v[84:87], v[228:231]
    ds_read_b64_tr_b16 v[112:113], v58 offset:16384
    s_waitcnt lgkmcnt(13)
    v_mfma_f32_16x16x32_bf16 v[236:239], v[116:119], v[84:87], v[236:239]
    ds_read_b64_tr_b16 v[114:115], v58 offset:17408
    v_mfma_f32_16x16x32_bf16 v[232:235], v[116:119], v[80:83], v[232:235]
    ds_read_b64_tr_b16 v[116:117], v59 offset:16384
    s_waitcnt lgkmcnt(13)
    v_mfma_f32_16x16x32_bf16 v[240:243], v[120:123], v[80:83], v[240:243]
    ds_read_b64_tr_b16 v[118:119], v59 offset:17408
    v_mfma_f32_16x16x32_bf16 v[244:247], v[120:123], v[84:87], v[244:247]
    ds_read_b64_tr_b16 v[120:121], v60 offset:16384
    s_waitcnt lgkmcnt(13)
    v_mfma_f32_16x16x32_bf16 v[252:255], v[124:127], v[84:87], v[252:255]
    ds_read_b64_tr_b16 v[122:123], v60 offset:17408
    v_mfma_f32_16x16x32_bf16 v[248:251], v[124:127], v[80:83], v[248:251]
    ds_read_b64_tr_b16 v[124:125], v61 offset:16384
    ds_read_b64_tr_b16 v[126:127], v61 offset:17408
    buffer_load_dwordx4 v[80:83], v13, s[8:11], s87 offen offset:0 sc1
    buffer_load_dwordx4 v[84:87], v12, s[8:11], s87 offen offset:0 sc1
    s_waitcnt vmcnt(16)
    s_waitcnt lgkmcnt(14)
    v_mfma_f32_16x16x32_bf16 v[192:195], v[96:99], v[88:91], v[192:195]
    v_mfma_f32_16x16x32_bf16 v[196:199], v[96:99], v[92:95], v[196:199]
    ds_read_b64_tr_b16 v[96:97], v54 offset:24576
    s_waitcnt lgkmcnt(13)
    v_mfma_f32_16x16x32_bf16 v[204:207], v[100:103], v[92:95], v[204:207]
    ds_read_b64_tr_b16 v[98:99], v54 offset:25600
    v_mfma_f32_16x16x32_bf16 v[200:203], v[100:103], v[88:91], v[200:203]
    ds_read_b64_tr_b16 v[100:101], v55 offset:24576
    s_waitcnt lgkmcnt(13)
    v_mfma_f32_16x16x32_bf16 v[208:211], v[104:107], v[88:91], v[208:211]
    ds_read_b64_tr_b16 v[102:103], v55 offset:25600
    v_mfma_f32_16x16x32_bf16 v[212:215], v[104:107], v[92:95], v[212:215]
    ds_read_b64_tr_b16 v[104:105], v56 offset:24576
    s_waitcnt lgkmcnt(13)
    v_mfma_f32_16x16x32_bf16 v[220:223], v[108:111], v[92:95], v[220:223]
    ds_read_b64_tr_b16 v[106:107], v56 offset:25600
    v_mfma_f32_16x16x32_bf16 v[216:219], v[108:111], v[88:91], v[216:219]
    ds_read_b64_tr_b16 v[108:109], v57 offset:24576
    s_waitcnt lgkmcnt(13)
    v_mfma_f32_16x16x32_bf16 v[224:227], v[112:115], v[88:91], v[224:227]
    ds_read_b64_tr_b16 v[110:111], v57 offset:25600
    v_mfma_f32_16x16x32_bf16 v[228:231], v[112:115], v[92:95], v[228:231]
    ds_read_b64_tr_b16 v[112:113], v58 offset:24576
    s_waitcnt lgkmcnt(13)
    v_mfma_f32_16x16x32_bf16 v[236:239], v[116:119], v[92:95], v[236:239]
    ds_read_b64_tr_b16 v[114:115], v58 offset:25600
    v_mfma_f32_16x16x32_bf16 v[232:235], v[116:119], v[88:91], v[232:235]
    ds_read_b64_tr_b16 v[116:117], v59 offset:24576
    s_waitcnt lgkmcnt(13)
    v_mfma_f32_16x16x32_bf16 v[240:243], v[120:123], v[88:91], v[240:243]
    ds_read_b64_tr_b16 v[118:119], v59 offset:25600
    v_mfma_f32_16x16x32_bf16 v[244:247], v[120:123], v[92:95], v[244:247]
    ds_read_b64_tr_b16 v[120:121], v60 offset:24576
    s_waitcnt lgkmcnt(13)
    v_mfma_f32_16x16x32_bf16 v[252:255], v[124:127], v[92:95], v[252:255]
    ds_read_b64_tr_b16 v[122:123], v60 offset:25600
    v_mfma_f32_16x16x32_bf16 v[248:251], v[124:127], v[88:91], v[248:251]
    ds_read_b64_tr_b16 v[124:125], v61 offset:24576
    ds_read_b64_tr_b16 v[126:127], v61 offset:25600
    buffer_load_dwordx4 v[88:91], v13, s[8:11], s87 offen offset:1024 sc1
    buffer_load_dwordx4 v[92:95], v12, s[8:11], s87 offen offset:1024 sc1
    s_waitcnt vmcnt(8)
    s_lshl_b32 s6, s4, 3
    s_add_u32 s6, s6, s5
    s_lshl_b32 s6, s6, 5
    s_add_u32 s6, s6, s3
    s_lshl_b32 s6, s6, 2
    s_add_u32 s6, s6, 3866624
    v_mov_b32 v2, 1
    v_mov_b32 v3, 0x5000000
    v_writelane_b32 v3, s6, 0
    buffer_store_dword v2, v3, s[8:11], 0 offen sc1
    s_waitcnt lgkmcnt(14)
    v_mfma_f32_16x16x32_bf16 v[192:195], v[96:99], v[16:19], v[192:195]
    v_mfma_f32_16x16x32_bf16 v[196:199], v[96:99], v[20:23], v[196:199]
    ds_read_b64_tr_b16 v[96:97], v54 offset:32768
    s_waitcnt lgkmcnt(13)
    v_mfma_f32_16x16x32_bf16 v[204:207], v[100:103], v[20:23], v[204:207]
    ds_read_b64_tr_b16 v[98:99], v54 offset:33792
    v_mfma_f32_16x16x32_bf16 v[200:203], v[100:103], v[16:19], v[200:203]
    ds_read_b64_tr_b16 v[100:101], v55 offset:32768
    s_waitcnt lgkmcnt(13)
    v_mfma_f32_16x16x32_bf16 v[208:211], v[104:107], v[16:19], v[208:211]
    ds_read_b64_tr_b16 v[102:103], v55 offset:33792
    v_mfma_f32_16x16x32_bf16 v[212:215], v[104:107], v[20:23], v[212:215]
    ds_read_b64_tr_b16 v[104:105], v56 offset:32768
    s_waitcnt lgkmcnt(13)
    v_mfma_f32_16x16x32_bf16 v[220:223], v[108:111], v[20:23], v[220:223]
    ds_read_b64_tr_b16 v[106:107], v56 offset:33792
    v_mfma_f32_16x16x32_bf16 v[216:219], v[108:111], v[16:19], v[216:219]
    ds_read_b64_tr_b16 v[108:109], v57 offset:32768
    s_waitcnt lgkmcnt(13)
    v_mfma_f32_16x16x32_bf16 v[224:227], v[112:115], v[16:19], v[224:227]
    ds_read_b64_tr_b16 v[110:111], v57 offset:33792
    v_mfma_f32_16x16x32_bf16 v[228:231], v[112:115], v[20:23], v[228:231]
    ds_read_b64_tr_b16 v[112:113], v58 offset:32768
    s_waitcnt lgkmcnt(13)
    v_mfma_f32_16x16x32_bf16 v[236:239], v[116:119], v[20:23], v[236:239]
    ds_read_b64_tr_b16 v[114:115], v58 offset:33792
    v_mfma_f32_16x16x32_bf16 v[232:235], v[116:119], v[16:19], v[232:235]
    ds_read_b64_tr_b16 v[116:117], v59 offset:32768
    s_waitcnt lgkmcnt(13)
    v_mfma_f32_16x16x32_bf16 v[240:243], v[120:123], v[16:19], v[240:243]
    ds_read_b64_tr_b16 v[118:119], v59 offset:33792
    v_mfma_f32_16x16x32_bf16 v[244:247], v[120:123], v[20:23], v[244:247]
    ds_read_b64_tr_b16 v[120:121], v60 offset:32768
    s_waitcnt lgkmcnt(13)
    v_mfma_f32_16x16x32_bf16 v[252:255], v[124:127], v[20:23], v[252:255]
    ds_read_b64_tr_b16 v[122:123], v60 offset:33792
    v_mfma_f32_16x16x32_bf16 v[248:251], v[124:127], v[16:19], v[248:251]
    ds_read_b64_tr_b16 v[124:125], v61 offset:32768
    ds_read_b64_tr_b16 v[126:127], v61 offset:33792
    buffer_load_dwordx4 v[16:19], v13, s[8:11], s87 offen offset:2048 sc1
    buffer_load_dwordx4 v[20:23], v12, s[8:11], s87 offen offset:2048 sc1
    s_waitcnt lgkmcnt(14)
    v_mfma_f32_16x16x32_bf16 v[192:195], v[96:99], v[24:27], v[192:195]
    v_mfma_f32_16x16x32_bf16 v[196:199], v[96:99], v[28:31], v[196:199]
    ds_read_b64_tr_b16 v[96:97], v54 offset:40960
    s_waitcnt lgkmcnt(13)
    v_mfma_f32_16x16x32_bf16 v[204:207], v[100:103], v[28:31], v[204:207]
    ds_read_b64_tr_b16 v[98:99], v54 offset:41984
    v_mfma_f32_16x16x32_bf16 v[200:203], v[100:103], v[24:27], v[200:203]
    ds_read_b64_tr_b16 v[100:101], v55 offset:40960
    s_waitcnt lgkmcnt(13)
    v_mfma_f32_16x16x32_bf16 v[208:211], v[104:107], v[24:27], v[208:211]
    ds_read_b64_tr_b16 v[102:103], v55 offset:41984
    v_mfma_f32_16x16x32_bf16 v[212:215], v[104:107], v[28:31], v[212:215]
    ds_read_b64_tr_b16 v[104:105], v56 offset:40960
    s_waitcnt lgkmcnt(13)
    v_mfma_f32_16x16x32_bf16 v[220:223], v[108:111], v[28:31], v[220:223]
    ds_read_b64_tr_b16 v[106:107], v56 offset:41984
    v_mfma_f32_16x16x32_bf16 v[216:219], v[108:111], v[24:27], v[216:219]
    ds_read_b64_tr_b16 v[108:109], v57 offset:40960
    s_waitcnt lgkmcnt(13)
    v_mfma_f32_16x16x32_bf16 v[224:227], v[112:115], v[24:27], v[224:227]
    ds_read_b64_tr_b16 v[110:111], v57 offset:41984
    v_mfma_f32_16x16x32_bf16 v[228:231], v[112:115], v[28:31], v[228:231]
    ds_read_b64_tr_b16 v[112:113], v58 offset:40960
    s_waitcnt lgkmcnt(13)
    v_mfma_f32_16x16x32_bf16 v[236:239], v[116:119], v[28:31], v[236:239]
    ds_read_b64_tr_b16 v[114:115], v58 offset:41984
    v_mfma_f32_16x16x32_bf16 v[232:235], v[116:119], v[24:27], v[232:235]
    ds_read_b64_tr_b16 v[116:117], v59 offset:40960
    s_waitcnt lgkmcnt(13)
    v_mfma_f32_16x16x32_bf16 v[240:243], v[120:123], v[24:27], v[240:243]
    ds_read_b64_tr_b16 v[118:119], v59 offset:41984
    v_mfma_f32_16x16x32_bf16 v[244:247], v[120:123], v[28:31], v[244:247]
    ds_read_b64_tr_b16 v[120:121], v60 offset:40960
    s_waitcnt lgkmcnt(13)
    v_mfma_f32_16x16x32_bf16 v[252:255], v[124:127], v[28:31], v[252:255]
    ds_read_b64_tr_b16 v[122:123], v60 offset:41984
    v_mfma_f32_16x16x32_bf16 v[248:251], v[124:127], v[24:27], v[248:251]
    ds_read_b64_tr_b16 v[124:125], v61 offset:40960
    ds_read_b64_tr_b16 v[126:127], v61 offset:41984
    buffer_load_dwordx4 v[24:27], v13, s[8:11], s87 offen offset:3072 sc1
    buffer_load_dwordx4 v[28:31], v12, s[8:11], s87 offen offset:3072 sc1
    s_waitcnt lgkmcnt(14)
    v_mfma_f32_16x16x32_bf16 v[192:195], v[96:99], v[32:35], v[192:195]
    v_mfma_f32_16x16x32_bf16 v[196:199], v[96:99], v[36:39], v[196:199]
    ds_read_b64_tr_b16 v[96:97], v54 offset:49152
    s_waitcnt lgkmcnt(13)
    v_mfma_f32_16x16x32_bf16 v[204:207], v[100:103], v[36:39], v[204:207]
    ds_read_b64_tr_b16 v[98:99], v54 offset:50176
    v_mfma_f32_16x16x32_bf16 v[200:203], v[100:103], v[32:35], v[200:203]
    ds_read_b64_tr_b16 v[100:101], v55 offset:49152
    s_waitcnt lgkmcnt(13)
    v_mfma_f32_16x16x32_bf16 v[208:211], v[104:107], v[32:35], v[208:211]
    ds_read_b64_tr_b16 v[102:103], v55 offset:50176
    v_mfma_f32_16x16x32_bf16 v[212:215], v[104:107], v[36:39], v[212:215]
    ds_read_b64_tr_b16 v[104:105], v56 offset:49152
    s_waitcnt lgkmcnt(13)
    v_mfma_f32_16x16x32_bf16 v[220:223], v[108:111], v[36:39], v[220:223]
    ds_read_b64_tr_b16 v[106:107], v56 offset:50176
    v_mfma_f32_16x16x32_bf16 v[216:219], v[108:111], v[32:35], v[216:219]
    ds_read_b64_tr_b16 v[108:109], v57 offset:49152
    s_waitcnt lgkmcnt(13)
    v_mfma_f32_16x16x32_bf16 v[224:227], v[112:115], v[32:35], v[224:227]
    ds_read_b64_tr_b16 v[110:111], v57 offset:50176
    v_mfma_f32_16x16x32_bf16 v[228:231], v[112:115], v[36:39], v[228:231]
    ds_read_b64_tr_b16 v[112:113], v58 offset:49152
    s_waitcnt lgkmcnt(13)
    v_mfma_f32_16x16x32_bf16 v[236:239], v[116:119], v[36:39], v[236:239]
    ds_read_b64_tr_b16 v[114:115], v58 offset:50176
    v_mfma_f32_16x16x32_bf16 v[232:235], v[116:119], v[32:35], v[232:235]
    ds_read_b64_tr_b16 v[116:117], v59 offset:49152
    s_waitcnt lgkmcnt(13)
    v_mfma_f32_16x16x32_bf16 v[240:243], v[120:123], v[32:35], v[240:243]
    ds_read_b64_tr_b16 v[118:119], v59 offset:50176
    v_mfma_f32_16x16x32_bf16 v[244:247], v[120:123], v[36:39], v[244:247]
    ds_read_b64_tr_b16 v[120:121], v60 offset:49152
    s_waitcnt lgkmcnt(13)
    v_mfma_f32_16x16x32_bf16 v[252:255], v[124:127], v[36:39], v[252:255]
    ds_read_b64_tr_b16 v[122:123], v60 offset:50176
    v_mfma_f32_16x16x32_bf16 v[248:251], v[124:127], v[32:35], v[248:251]
    ds_read_b64_tr_b16 v[124:125], v61 offset:49152
    ds_read_b64_tr_b16 v[126:127], v61 offset:50176
    buffer_load_dwordx4 v[32:35], v13, s[8:11], s88 offen offset:0 sc1
    buffer_load_dwordx4 v[36:39], v12, s[8:11], s88 offen offset:0 sc1
    s_waitcnt vmcnt(13)
    s_waitcnt lgkmcnt(14)
    v_mfma_f32_16x16x32_bf16 v[192:195], v[96:99], v[64:67], v[192:195]
    v_mfma_f32_16x16x32_bf16 v[196:199], v[96:99], v[68:71], v[196:199]
    ds_read_b64_tr_b16 v[96:97], v54 offset:57344
    s_waitcnt lgkmcnt(13)
    v_mfma_f32_16x16x32_bf16 v[204:207], v[100:103], v[68:71], v[204:207]
    ds_read_b64_tr_b16 v[98:99], v54 offset:58368
    v_mfma_f32_16x16x32_bf16 v[200:203], v[100:103], v[64:67], v[200:203]
    ds_read_b64_tr_b16 v[100:101], v55 offset:57344
    s_waitcnt lgkmcnt(13)
    v_mfma_f32_16x16x32_bf16 v[208:211], v[104:107], v[64:67], v[208:211]
    ds_read_b64_tr_b16 v[102:103], v55 offset:58368
    v_mfma_f32_16x16x32_bf16 v[212:215], v[104:107], v[68:71], v[212:215]
    ds_read_b64_tr_b16 v[104:105], v56 offset:57344
    s_waitcnt lgkmcnt(13)
    v_mfma_f32_16x16x32_bf16 v[220:223], v[108:111], v[68:71], v[220:223]
    ds_read_b64_tr_b16 v[106:107], v56 offset:58368
    v_mfma_f32_16x16x32_bf16 v[216:219], v[108:111], v[64:67], v[216:219]
    ds_read_b64_tr_b16 v[108:109], v57 offset:57344
    s_waitcnt lgkmcnt(13)
    v_mfma_f32_16x16x32_bf16 v[224:227], v[112:115], v[64:67], v[224:227]
    ds_read_b64_tr_b16 v[110:111], v57 offset:58368
    v_mfma_f32_16x16x32_bf16 v[228:231], v[112:115], v[68:71], v[228:231]
    ds_read_b64_tr_b16 v[112:113], v58 offset:57344
    s_waitcnt lgkmcnt(13)
    v_mfma_f32_16x16x32_bf16 v[236:239], v[116:119], v[68:71], v[236:239]
    ds_read_b64_tr_b16 v[114:115], v58 offset:58368
    v_mfma_f32_16x16x32_bf16 v[232:235], v[116:119], v[64:67], v[232:235]
    ds_read_b64_tr_b16 v[116:117], v59 offset:57344
    s_waitcnt lgkmcnt(13)
    v_mfma_f32_16x16x32_bf16 v[240:243], v[120:123], v[64:67], v[240:243]
    ds_read_b64_tr_b16 v[118:119], v59 offset:58368
    v_mfma_f32_16x16x32_bf16 v[244:247], v[120:123], v[68:71], v[244:247]
    ds_read_b64_tr_b16 v[120:121], v60 offset:57344
    s_waitcnt lgkmcnt(13)
    v_mfma_f32_16x16x32_bf16 v[252:255], v[124:127], v[68:71], v[252:255]
    ds_read_b64_tr_b16 v[122:123], v60 offset:58368
    v_mfma_f32_16x16x32_bf16 v[248:251], v[124:127], v[64:67], v[248:251]
    ds_read_b64_tr_b16 v[124:125], v61 offset:57344
    ds_read_b64_tr_b16 v[126:127], v61 offset:58368
    buffer_load_dwordx4 v[64:67], v13, s[8:11], s88 offen offset:1024 sc1
    buffer_load_dwordx4 v[68:71], v12, s[8:11], s88 offen offset:1024 sc1
    s_waitcnt vmcnt(13)
    s_waitcnt lgkmcnt(14)
    v_mfma_f32_16x16x32_bf16 v[192:195], v[96:99], v[72:75], v[192:195]
    v_xor_b32 v54, 0x10000, v54
    v_mfma_f32_16x16x32_bf16 v[196:199], v[96:99], v[76:79], v[196:199]
    s_waitcnt lgkmcnt(12)
    v_mfma_f32_16x16x32_bf16 v[204:207], v[100:103], v[76:79], v[204:207]
    v_xor_b32 v55, 0x10000, v55
    v_mfma_f32_16x16x32_bf16 v[200:203], v[100:103], v[72:75], v[200:203]
    s_waitcnt lgkmcnt(0)
    s_barrier
    ds_read_b64_tr_b16 v[96:97], v54 offset:0
    ds_read_b64_tr_b16 v[98:99], v54 offset:1024
    ds_read_b64_tr_b16 v[100:101], v55 offset:0
    v_mfma_f32_16x16x32_bf16 v[208:211], v[104:107], v[72:75], v[208:211]
    ds_read_b64_tr_b16 v[102:103], v55 offset:1024
    v_xor_b32 v56, 0x10000, v56
    v_mfma_f32_16x16x32_bf16 v[212:215], v[104:107], v[76:79], v[212:215]
    ds_read_b64_tr_b16 v[104:105], v56 offset:0
    v_mfma_f32_16x16x32_bf16 v[220:223], v[108:111], v[76:79], v[220:223]
    ds_read_b64_tr_b16 v[106:107], v56 offset:1024
    v_xor_b32 v57, 0x10000, v57
    v_mfma_f32_16x16x32_bf16 v[216:219], v[108:111], v[72:75], v[216:219]
    ds_read_b64_tr_b16 v[108:109], v57 offset:0
    v_mfma_f32_16x16x32_bf16 v[224:227], v[112:115], v[72:75], v[224:227]
    ds_read_b64_tr_b16 v[110:111], v57 offset:1024
    v_xor_b32 v58, 0x10000, v58
    v_mfma_f32_16x16x32_bf16 v[228:231], v[112:115], v[76:79], v[228:231]
    ds_read_b64_tr_b16 v[112:113], v58 offset:0
    v_mfma_f32_16x16x32_bf16 v[236:239], v[116:119], v[76:79], v[236:239]
    ds_read_b64_tr_b16 v[114:115], v58 offset:1024
    v_xor_b32 v59, 0x10000, v59
    v_mfma_f32_16x16x32_bf16 v[232:235], v[116:119], v[72:75], v[232:235]
    ds_read_b64_tr_b16 v[116:117], v59 offset:0
    v_mfma_f32_16x16x32_bf16 v[240:243], v[120:123], v[72:75], v[240:243]
    ds_read_b64_tr_b16 v[118:119], v59 offset:1024
    v_xor_b32 v60, 0x10000, v60
    v_mfma_f32_16x16x32_bf16 v[244:247], v[120:123], v[76:79], v[244:247]
    ds_read_b64_tr_b16 v[120:121], v60 offset:0
    v_mfma_f32_16x16x32_bf16 v[252:255], v[124:127], v[76:79], v[252:255]
    ds_read_b64_tr_b16 v[122:123], v60 offset:1024
    v_xor_b32 v61, 0x10000, v61
    v_mfma_f32_16x16x32_bf16 v[248:251], v[124:127], v[72:75], v[248:251]
    ds_read_b64_tr_b16 v[124:125], v61 offset:0
    ds_read_b64_tr_b16 v[126:127], v61 offset:1024
    buffer_load_dwordx4 v[72:75], v13, s[8:11], s88 offen offset:2048 sc1
    buffer_load_dwordx4 v[76:79], v12, s[8:11], s88 offen offset:2048 sc1
    s_waitcnt vmcnt(13)
    s_waitcnt lgkmcnt(14)
    v_mfma_f32_16x16x32_bf16 v[192:195], v[96:99], v[80:83], v[192:195]
    v_mfma_f32_16x16x32_bf16 v[196:199], v[96:99], v[84:87], v[196:199]
    ds_read_b64_tr_b16 v[96:97], v54 offset:8192
    s_waitcnt lgkmcnt(13)
    v_mfma_f32_16x16x32_bf16 v[204:207], v[100:103], v[84:87], v[204:207]
    ds_read_b64_tr_b16 v[98:99], v54 offset:9216
    v_mfma_f32_16x16x32_bf16 v[200:203], v[100:103], v[80:83], v[200:203]
    ds_read_b64_tr_b16 v[100:101], v55 offset:8192
    s_waitcnt lgkmcnt(13)
    v_mfma_f32_16x16x32_bf16 v[208:211], v[104:107], v[80:83], v[208:211]
    ds_read_b64_tr_b16 v[102:103], v55 offset:9216
    v_mfma_f32_16x16x32_bf16 v[212:215], v[104:107], v[84:87], v[212:215]
    ds_read_b64_tr_b16 v[104:105], v56 offset:8192
    s_waitcnt lgkmcnt(13)
    v_mfma_f32_16x16x32_bf16 v[220:223], v[108:111], v[84:87], v[220:223]
    ds_read_b64_tr_b16 v[106:107], v56 offset:9216
    v_mfma_f32_16x16x32_bf16 v[216:219], v[108:111], v[80:83], v[216:219]
    ds_read_b64_tr_b16 v[108:109], v57 offset:8192
    s_waitcnt lgkmcnt(13)
    v_mfma_f32_16x16x32_bf16 v[224:227], v[112:115], v[80:83], v[224:227]
    ds_read_b64_tr_b16 v[110:111], v57 offset:9216
    v_mfma_f32_16x16x32_bf16 v[228:231], v[112:115], v[84:87], v[228:231]
    ds_read_b64_tr_b16 v[112:113], v58 offset:8192
    s_waitcnt lgkmcnt(13)
    v_mfma_f32_16x16x32_bf16 v[236:239], v[116:119], v[84:87], v[236:239]
    ds_read_b64_tr_b16 v[114:115], v58 offset:9216
    v_mfma_f32_16x16x32_bf16 v[232:235], v[116:119], v[80:83], v[232:235]
    ds_read_b64_tr_b16 v[116:117], v59 offset:8192
    s_waitcnt lgkmcnt(13)
    v_mfma_f32_16x16x32_bf16 v[240:243], v[120:123], v[80:83], v[240:243]
    ds_read_b64_tr_b16 v[118:119], v59 offset:9216
    v_mfma_f32_16x16x32_bf16 v[244:247], v[120:123], v[84:87], v[244:247]
    ds_read_b64_tr_b16 v[120:121], v60 offset:8192
    s_waitcnt lgkmcnt(13)
    v_mfma_f32_16x16x32_bf16 v[252:255], v[124:127], v[84:87], v[252:255]
    ds_read_b64_tr_b16 v[122:123], v60 offset:9216
    v_mfma_f32_16x16x32_bf16 v[248:251], v[124:127], v[80:83], v[248:251]
    ds_read_b64_tr_b16 v[124:125], v61 offset:8192
    ds_read_b64_tr_b16 v[126:127], v61 offset:9216
    buffer_load_dwordx4 v[80:83], v13, s[8:11], s88 offen offset:3072 sc1
    buffer_load_dwordx4 v[84:87], v12, s[8:11], s88 offen offset:3072 sc1
    s_waitcnt vmcnt(13)
    s_waitcnt lgkmcnt(14)
    v_mfma_f32_16x16x32_bf16 v[192:195], v[96:99], v[88:91], v[192:195]
    v_mfma_f32_16x16x32_bf16 v[196:199], v[96:99], v[92:95], v[196:199]
    ds_read_b64_tr_b16 v[96:97], v54 offset:16384
    s_waitcnt lgkmcnt(13)
    v_mfma_f32_16x16x32_bf16 v[204:207], v[100:103], v[92:95], v[204:207]
    ds_read_b64_tr_b16 v[98:99], v54 offset:17408
    v_mfma_f32_16x16x32_bf16 v[200:203], v[100:103], v[88:91], v[200:203]
    ds_read_b64_tr_b16 v[100:101], v55 offset:16384
    s_waitcnt lgkmcnt(13)
    v_mfma_f32_16x16x32_bf16 v[208:211], v[104:107], v[88:91], v[208:211]
    ds_read_b64_tr_b16 v[102:103], v55 offset:17408
    v_mfma_f32_16x16x32_bf16 v[212:215], v[104:107], v[92:95], v[212:215]
    ds_read_b64_tr_b16 v[104:105], v56 offset:16384
    s_waitcnt lgkmcnt(13)
    v_mfma_f32_16x16x32_bf16 v[220:223], v[108:111], v[92:95], v[220:223]
    ds_read_b64_tr_b16 v[106:107], v56 offset:17408
    v_mfma_f32_16x16x32_bf16 v[216:219], v[108:111], v[88:91], v[216:219]
    ds_read_b64_tr_b16 v[108:109], v57 offset:16384
    s_waitcnt lgkmcnt(13)
    v_mfma_f32_16x16x32_bf16 v[224:227], v[112:115], v[88:91], v[224:227]
    ds_read_b64_tr_b16 v[110:111], v57 offset:17408
    v_mfma_f32_16x16x32_bf16 v[228:231], v[112:115], v[92:95], v[228:231]
    ds_read_b64_tr_b16 v[112:113], v58 offset:16384
    s_waitcnt lgkmcnt(13)
    v_mfma_f32_16x16x32_bf16 v[236:239], v[116:119], v[92:95], v[236:239]
    ds_read_b64_tr_b16 v[114:115], v58 offset:17408
    v_mfma_f32_16x16x32_bf16 v[232:235], v[116:119], v[88:91], v[232:235]
    ds_read_b64_tr_b16 v[116:117], v59 offset:16384
    s_waitcnt lgkmcnt(13)
    v_mfma_f32_16x16x32_bf16 v[240:243], v[120:123], v[88:91], v[240:243]
    ds_read_b64_tr_b16 v[118:119], v59 offset:17408
    v_mfma_f32_16x16x32_bf16 v[244:247], v[120:123], v[92:95], v[244:247]
    ds_read_b64_tr_b16 v[120:121], v60 offset:16384
    s_waitcnt lgkmcnt(13)
    v_mfma_f32_16x16x32_bf16 v[252:255], v[124:127], v[92:95], v[252:255]
    ds_read_b64_tr_b16 v[122:123], v60 offset:17408
    v_mfma_f32_16x16x32_bf16 v[248:251], v[124:127], v[88:91], v[248:251]
    ds_read_b64_tr_b16 v[124:125], v61 offset:16384
    ds_read_b64_tr_b16 v[126:127], v61 offset:17408
    s_waitcnt vmcnt(10)
    s_waitcnt lgkmcnt(14)
    v_mfma_f32_16x16x32_bf16 v[192:195], v[96:99], v[16:19], v[192:195]
    v_mfma_f32_16x16x32_bf16 v[196:199], v[96:99], v[20:23], v[196:199]
    ds_read_b64_tr_b16 v[96:97], v54 offset:24576
    s_waitcnt lgkmcnt(13)
    v_mfma_f32_16x16x32_bf16 v[204:207], v[100:103], v[20:23], v[204:207]
    ds_read_b64_tr_b16 v[98:99], v54 offset:25600
    v_mfma_f32_16x16x32_bf16 v[200:203], v[100:103], v[16:19], v[200:203]
    ds_read_b64_tr_b16 v[100:101], v55 offset:24576
    s_waitcnt lgkmcnt(13)
    v_mfma_f32_16x16x32_bf16 v[208:211], v[104:107], v[16:19], v[208:211]
    ds_read_b64_tr_b16 v[102:103], v55 offset:25600
    v_mfma_f32_16x16x32_bf16 v[212:215], v[104:107], v[20:23], v[212:215]
    ds_read_b64_tr_b16 v[104:105], v56 offset:24576
    s_waitcnt lgkmcnt(13)
    v_mfma_f32_16x16x32_bf16 v[220:223], v[108:111], v[20:23], v[220:223]
    ds_read_b64_tr_b16 v[106:107], v56 offset:25600
    v_mfma_f32_16x16x32_bf16 v[216:219], v[108:111], v[16:19], v[216:219]
    ds_read_b64_tr_b16 v[108:109], v57 offset:24576
    s_waitcnt lgkmcnt(13)
    v_mfma_f32_16x16x32_bf16 v[224:227], v[112:115], v[16:19], v[224:227]
    ds_read_b64_tr_b16 v[110:111], v57 offset:25600
    v_mfma_f32_16x16x32_bf16 v[228:231], v[112:115], v[20:23], v[228:231]
    ds_read_b64_tr_b16 v[112:113], v58 offset:24576
    s_waitcnt lgkmcnt(13)
    v_mfma_f32_16x16x32_bf16 v[236:239], v[116:119], v[20:23], v[236:239]
    ds_read_b64_tr_b16 v[114:115], v58 offset:25600
    v_mfma_f32_16x16x32_bf16 v[232:235], v[116:119], v[16:19], v[232:235]
    ds_read_b64_tr_b16 v[116:117], v59 offset:24576
    s_waitcnt lgkmcnt(13)
    v_mfma_f32_16x16x32_bf16 v[240:243], v[120:123], v[16:19], v[240:243]
    ds_read_b64_tr_b16 v[118:119], v59 offset:25600
    v_mfma_f32_16x16x32_bf16 v[244:247], v[120:123], v[20:23], v[244:247]
    ds_read_b64_tr_b16 v[120:121], v60 offset:24576
    s_waitcnt lgkmcnt(13)
    v_mfma_f32_16x16x32_bf16 v[252:255], v[124:127], v[20:23], v[252:255]
    ds_read_b64_tr_b16 v[122:123], v60 offset:25600
    v_mfma_f32_16x16x32_bf16 v[248:251], v[124:127], v[16:19], v[248:251]
    ds_read_b64_tr_b16 v[124:125], v61 offset:24576
    ds_read_b64_tr_b16 v[126:127], v61 offset:25600
    s_waitcnt vmcnt(8)
    s_waitcnt lgkmcnt(14)
    v_mfma_f32_16x16x32_bf16 v[192:195], v[96:99], v[24:27], v[192:195]
    v_mfma_f32_16x16x32_bf16 v[196:199], v[96:99], v[28:31], v[196:199]
    ds_read_b64_tr_b16 v[96:97], v54 offset:32768
    s_waitcnt lgkmcnt(13)
    v_mfma_f32_16x16x32_bf16 v[204:207], v[100:103], v[28:31], v[204:207]
    ds_read_b64_tr_b16 v[98:99], v54 offset:33792
    v_mfma_f32_16x16x32_bf16 v[200:203], v[100:103], v[24:27], v[200:203]
    ds_read_b64_tr_b16 v[100:101], v55 offset:32768
    s_waitcnt lgkmcnt(13)
    v_mfma_f32_16x16x32_bf16 v[208:211], v[104:107], v[24:27], v[208:211]
    ds_read_b64_tr_b16 v[102:103], v55 offset:33792
    v_mfma_f32_16x16x32_bf16 v[212:215], v[104:107], v[28:31], v[212:215]
    ds_read_b64_tr_b16 v[104:105], v56 offset:32768
    s_waitcnt lgkmcnt(13)
    v_mfma_f32_16x16x32_bf16 v[220:223], v[108:111], v[28:31], v[220:223]
    ds_read_b64_tr_b16 v[106:107], v56 offset:33792
    v_mfma_f32_16x16x32_bf16 v[216:219], v[108:111], v[24:27], v[216:219]
    ds_read_b64_tr_b16 v[108:109], v57 offset:32768
    s_waitcnt lgkmcnt(13)
    v_mfma_f32_16x16x32_bf16 v[224:227], v[112:115], v[24:27], v[224:227]
    ds_read_b64_tr_b16 v[110:111], v57 offset:33792
    v_mfma_f32_16x16x32_bf16 v[228:231], v[112:115], v[28:31], v[228:231]
    ds_read_b64_tr_b16 v[112:113], v58 offset:32768
    s_waitcnt lgkmcnt(13)
    v_mfma_f32_16x16x32_bf16 v[236:239], v[116:119], v[28:31], v[236:239]
    ds_read_b64_tr_b16 v[114:115], v58 offset:33792
    v_mfma_f32_16x16x32_bf16 v[232:235], v[116:119], v[24:27], v[232:235]
    ds_read_b64_tr_b16 v[116:117], v59 offset:32768
    s_waitcnt lgkmcnt(13)
    v_mfma_f32_16x16x32_bf16 v[240:243], v[120:123], v[24:27], v[240:243]
    ds_read_b64_tr_b16 v[118:119], v59 offset:33792
    v_mfma_f32_16x16x32_bf16 v[244:247], v[120:123], v[28:31], v[244:247]
    ds_read_b64_tr_b16 v[120:121], v60 offset:32768
    s_waitcnt lgkmcnt(13)
    v_mfma_f32_16x16x32_bf16 v[252:255], v[124:127], v[28:31], v[252:255]
    ds_read_b64_tr_b16 v[122:123], v60 offset:33792
    v_mfma_f32_16x16x32_bf16 v[248:251], v[124:127], v[24:27], v[248:251]
    ds_read_b64_tr_b16 v[124:125], v61 offset:32768
    ds_read_b64_tr_b16 v[126:127], v61 offset:33792
    s_waitcnt vmcnt(0)
    s_cmp_ge_u32 s3, 4
    s_cbranch_scc1 L_q_nold
    s_lshl_b32 s7, s4, 10
    s_add_u32 s7, s7, 3866624
    v_lshrrev_b32 v2, 3, v1
    v_and_b32 v3, 7, v1
    v_lshlrev_b32 v3, 2, v3
    v_lshl_add_u32 v3, v2, 7, v3
    s_mov_b32 s79, 262144
L_poll_7:
    buffer_load_dword v2, v3, s[8:11], s7 offen sc1
    s_waitcnt vmcnt(0)
    v_cmp_gt_u32 vcc, 1, v2
    s_cbranch_vccz L_polldone_8
    s_sleep 2
    s_sub_u32 s79, s79, 1
    s_cmp_lg_u32 s79, 0
    s_cbranch_scc1 L_poll_7
L_polldone_8:
    s_lshl_b32 s6, s76, 13
    s_add_u32 s6, s6, s78
    s_add_u32 m0, s6, 0
    s_add_u32 s7, s77, 0
    buffer_load_dwordx4 v49, s[8:11], s7 offen offset:0 sc1 lds
    buffer_load_dwordx4 v49, s[8:11], s7 offen offset:1024 sc1 lds
    buffer_load_dwordx4 v49, s[8:11], s7 offen offset:2048 sc1 lds
    buffer_load_dwordx4 v49, s[8:11], s7 offen offset:3072 sc1 lds
    s_lshl_b32 s6, s76, 13
    s_add_u32 s6, s6, s78
    s_add_u32 m0, s6, 4096
    s_add_u32 s7, s77, 4096
    buffer_load_dwordx4 v49, s[8:11], s7 offen offset:0 sc1 lds
    buffer_load_dwordx4 v49, s[8:11], s7 offen offset:1024 sc1 lds
    buffer_load_dwordx4 v49, s[8:11], s7 offen offset:2048 sc1 lds
    buffer_load_dwordx4 v49, s[8:11], s7 offen offset:3072 sc1 lds
    s_lshl_b32 s6, s76, 12
    s_add_u32 s6, s6, s78
    s_add_u32 m0, s6, 49152
    s_add_u32 s7, s77, 524288
    buffer_load_dwordx4 v50, s[8:11], s7 offen offset:0 sc1 lds
    buffer_load_dwordx4 v50, s[8:11], s7 offen offset:1024 sc1 lds
    buffer_load_dwordx4 v50, s[8:11], s7 offen offset:2048 sc1 lds
    buffer_load_dwordx4 v50, s[8:11], s7 offen offset:3072 sc1 lds
L_q_nold:
    s_waitcnt lgkmcnt(14)
    v_mfma_f32_16x16x32_bf16 v[192:195], v[96:99], v[32:35], v[192:195]
    v_mfma_f32_16x16x32_bf16 v[196:199], v[96:99], v[36:39], v[196:199]
    ds_read_b64_tr_b16 v[96:97], v54 offset:40960
    s_waitcnt lgkmcnt(13)
    v_mfma_f32_16x16x32_bf16 v[204:207], v[100:103], v[36:39], v[204:207]
    ds_read_b64_tr_b16 v[98:99], v54 offset:41984
    v_mfma_f32_16x16x32_bf16 v[200:203], v[100:103], v[32:35], v[200:203]
    ds_read_b64_tr_b16 v[100:101], v55 offset:40960
    s_waitcnt lgkmcnt(13)
    v_mfma_f32_16x16x32_bf16 v[208:211], v[104:107], v[32:35], v[208:211]
    ds_read_b64_tr_b16 v[102:103], v55 offset:41984
    v_mfma_f32_16x16x32_bf16 v[212:215], v[104:107], v[36:39], v[212:215]
    ds_read_b64_tr_b16 v[104:105], v56 offset:40960
    s_waitcnt lgkmcnt(13)
    v_mfma_f32_16x16x32_bf16 v[220:223], v[108:111], v[36:39], v[220:223]
    ds_read_b64_tr_b16 v[106:107], v56 offset:41984
    buffer_store_dwordx4 v[144:147], v13, s[8:11], s67 offen sc1
    s_add_u32 s67, s67, 1024
    v_mfma_f32_16x16x32_bf16 v[216:219], v[108:111], v[32:35], v[216:219]
    ds_read_b64_tr_b16 v[108:109], v57 offset:40960
    s_waitcnt lgkmcnt(13)
    v_mfma_f32_16x16x32_bf16 v[224:227], v[112:115], v[32:35], v[224:227]
    ds_read_b64_tr_b16 v[110:111], v57 offset:41984
    v_mfma_f32_16x16x32_bf16 v[228:231], v[112:115], v[36:39], v[228:231]
    ds_read_b64_tr_b16 v[112:113], v58 offset:40960
    s_waitcnt lgkmcnt(13)
    v_mfma_f32_16x16x32_bf16 v[236:239], v[116:119], v[36:39], v[236:239]
    ds_read_b64_tr_b16 v[114:115], v58 offset:41984
    v_mfma_f32_16x16x32_bf16 v[232:235], v[116:119], v[32:35], v[232:235]
    ds_read_b64_tr_b16 v[116:117], v59 offset:40960
    s_waitcnt lgkmcnt(13)
    v_mfma_f32_16x16x32_bf16 v[240:243], v[120:123], v[32:35], v[240:243]
    ds_read_b64_tr_b16 v[118:119], v59 offset:41984
    v_mfma_f32_16x16x32_bf16 v[244:247], v[120:123], v[36:39], v[244:247]
    ds_read_b64_tr_b16 v[120:121], v60 offset:40960
    s_waitcnt lgkmcnt(13)
    v_mfma_f32_16x16x32_bf16 v[252:255], v[124:127], v[36:39], v[252:255]
    ds_read_b64_tr_b16 v[122:123], v60 offset:41984
    v_mfma_f32_16x16x32_bf16 v[248:251], v[124:127], v[32:35], v[248:251]
    ds_read_b64_tr_b16 v[124:125], v61 offset:40960
    ds_read_b64_tr_b16 v[126:127], v61 offset:41984
    s_waitcnt lgkmcnt(14)
    v_mfma_f32_16x16x32_bf16 v[192:195], v[96:99], v[64:67], v[192:195]
    v_mfma_f32_16x16x32_bf16 v[196:199], v[96:99], v[68:71], v[196:199]
    ds_read_b64_tr_b16 v[96:97], v54 offset:49152
    s_waitcnt lgkmcnt(13)
    v_mfma_f32_16x16x32_bf16 v[204:207], v[100:103], v[68:71], v[204:207]
    ds_read_b64_tr_b16 v[98:99], v54 offset:50176
    v_mfma_f32_16x16x32_bf16 v[200:203], v[100:103], v[64:67], v[200:203]
    ds_read_b64_tr_b16 v[100:101], v55 offset:49152
    s_waitcnt lgkmcnt(13)
    v_mfma_f32_16x16x32_bf16 v[208:211], v[104:107], v[64:67], v[208:211]
    ds_read_b64_tr_b16 v[102:103], v55 offset:50176
    v_mfma_f32_16x16x32_bf16 v[212:215], v[104:107], v[68:71], v[212:215]
    ds_read_b64_tr_b16 v[104:105], v56 offset:49152
    s_waitcnt lgkmcnt(13)
    v_mfma_f32_16x16x32_bf16 v[220:223], v[108:111], v[68:71], v[220:223]
    ds_read_b64_tr_b16 v[106:107], v56 offset:50176
    buffer_store_dwordx4 v[148:151], v13, s[8:11], s67 offen sc1
    s_add_u32 s67, s67, s68
    v_mfma_f32_16x16x32_bf16 v[216:219], v[108:111], v[64:67], v[216:219]
    ds_read_b64_tr_b16 v[108:109], v57 offset:49152
    s_waitcnt lgkmcnt(13)
    v_mfma_f32_16x16x32_bf16 v[224:227], v[112:115], v[64:67], v[224:227]
    ds_read_b64_tr_b16 v[110:111], v57 offset:50176
    v_mfma_f32_16x16x32_bf16 v[228:231], v[112:115], v[68:71], v[228:231]
    ds_read_b64_tr_b16 v[112:113], v58 offset:49152
    s_waitcnt lgkmcnt(13)
    v_mfma_f32_16x16x32_bf16 v[236:239], v[116:119], v[68:71], v[236:239]
    ds_read_b64_tr_b16 v[114:115], v58 offset:50176
    v_mfma_f32_16x16x32_bf16 v[232:235], v[116:119], v[64:67], v[232:235]
    ds_read_b64_tr_b16 v[116:117], v59 offset:49152
    s_waitcnt lgkmcnt(13)
    v_mfma_f32_16x16x32_bf16 v[240:243], v[120:123], v[64:67], v[240:243]
    ds_read_b64_tr_b16 v[118:119], v59 offset:50176
    v_mfma_f32_16x16x32_bf16 v[244:247], v[120:123], v[68:71], v[244:247]
    ds_read_b64_tr_b16 v[120:121], v60 offset:49152
    s_waitcnt lgkmcnt(13)
    v_mfma_f32_16x16x32_bf16 v[252:255], v[124:127], v[68:71], v[252:255]
    ds_read_b64_tr_b16 v[122:123], v60 offset:50176
    v_mfma_f32_16x16x32_bf16 v[248:251], v[124:127], v[64:67], v[248:251]
    ds_read_b64_tr_b16 v[124:125], v61 offset:49152
    ds_read_b64_tr_b16 v[126:127], v61 offset:50176
    s_waitcnt lgkmcnt(14)
    v_mfma_f32_16x16x32_bf16 v[192:195], v[96:99], v[72:75], v[192:195]
    v_mfma_f32_16x16x32_bf16 v[196:199], v[96:99], v[76:79], v[196:199]
    ds_read_b64_tr_b16 v[96:97], v54 offset:57344
    s_waitcnt lgkmcnt(13)
    v_mfma_f32_16x16x32_bf16 v[204:207], v[100:103], v[76:79], v[204:207]
    ds_read_b64_tr_b16 v[98:99], v54 offset:58368
    v_mfma_f32_16x16x32_bf16 v[200:203], v[100:103], v[72:75], v[200:203]
    ds_read_b64_tr_b16 v[100:101], v55 offset:57344
    s_waitcnt lgkmcnt(13)
    v_mfma_f32_16x16x32_bf16 v[208:211], v[104:107], v[72:75], v[208:211]
    ds_read_b64_tr_b16 v[102:103], v55 offset:58368
    v_mfma_f32_16x16x32_bf16 v[212:215], v[104:107], v[76:79], v[212:215]
    ds_read_b64_tr_b16 v[104:105], v56 offset:57344
    s_waitcnt lgkmcnt(13)
    v_mfma_f32_16x16x32_bf16 v[220:223], v[108:111], v[76:79], v[220:223]
    ds_read_b64_tr_b16 v[106:107], v56 offset:58368
    buffer_store_dwordx4 v[152:155], v13, s[8:11], s67 offen sc1
    s_add_u32 s67, s67, 1024
    v_mfma_f32_16x16x32_bf16 v[216:219], v[108:111], v[72:75], v[216:219]
    ds_read_b64_tr_b16 v[108:109], v57 offset:57344
    s_waitcnt lgkmcnt(13)
    v_mfma_f32_16x16x32_bf16 v[224:227], v[112:115], v[72:75], v[224:227]
    ds_read_b64_tr_b16 v[110:111], v57 offset:58368
    v_mfma_f32_16x16x32_bf16 v[228:231], v[112:115], v[76:79], v[228:231]
    ds_read_b64_tr_b16 v[112:113], v58 offset:57344
    s_waitcnt lgkmcnt(13)
    v_mfma_f32_16x16x32_bf16 v[236:239], v[116:119], v[76:79], v[236:239]
    ds_read_b64_tr_b16 v[114:115], v58 offset:58368
    v_mfma_f32_16x16x32_bf16 v[232:235], v[116:119], v[72:75], v[232:235]
    ds_read_b64_tr_b16 v[116:117], v59 offset:57344
    s_waitcnt lgkmcnt(13)
    v_mfma_f32_16x16x32_bf16 v[240:243], v[120:123], v[72:75], v[240:243]
    ds_read_b64_tr_b16 v[118:119], v59 offset:58368
    v_mfma_f32_16x16x32_bf16 v[244:247], v[120:123], v[76:79], v[244:247]
    ds_read_b64_tr_b16 v[120:121], v60 offset:57344
    s_waitcnt lgkmcnt(13)
    v_mfma_f32_16x16x32_bf16 v[252:255], v[124:127], v[76:79], v[252:255]
    ds_read_b64_tr_b16 v[122:123], v60 offset:58368
    v_mfma_f32_16x16x32_bf16 v[248:251], v[124:127], v[72:75], v[248:251]
    ds_read_b64_tr_b16 v[124:125], v61 offset:57344
    ds_read_b64_tr_b16 v[126:127], v61 offset:58368
    s_waitcnt lgkmcnt(14)
    v_mfma_f32_16x16x32_bf16 v[192:195], v[96:99], v[80:83], v[192:195]
    v_mfma_f32_16x16x32_bf16 v[196:199], v[96:99], v[84:87], v[196:199]
    s_waitcnt lgkmcnt(12)
    v_mfma_f32_16x16x32_bf16 v[204:207], v[100:103], v[84:87], v[204:207]
    v_mfma_f32_16x16x32_bf16 v[200:203], v[100:103], v[80:83], v[200:203]
    s_waitcnt lgkmcnt(10)
    v_mfma_f32_16x16x32_bf16 v[208:211], v[104:107], v[80:83], v[208:211]
    v_mfma_f32_16x16x32_bf16 v[212:215], v[104:107], v[84:87], v[212:215]
    s_waitcnt lgkmcnt(8)
    v_mfma_f32_16x16x32_bf16 v[220:223], v[108:111], v[84:87], v[220:223]
    buffer_store_dwordx4 v[156:159], v13, s[8:11], s67 offen sc1
    s_add_u32 s67, s67, s69
    v_mfma_f32_16x16x32_bf16 v[216:219], v[108:111], v[80:83], v[216:219]
    s_waitcnt lgkmcnt(6)
    v_mfma_f32_16x16x32_bf16 v[224:227], v[112:115], v[80:83], v[224:227]
    v_mfma_f32_16x16x32_bf16 v[228:231], v[112:115], v[84:87], v[228:231]
    s_waitcnt lgkmcnt(4)
    v_mfma_f32_16x16x32_bf16 v[236:239], v[116:119], v[84:87], v[236:239]
    v_mfma_f32_16x16x32_bf16 v[232:235], v[116:119], v[80:83], v[232:235]
    s_waitcnt lgkmcnt(2)
    v_mfma_f32_16x16x32_bf16 v[240:243], v[120:123], v[80:83], v[240:243]
    v_mfma_f32_16x16x32_bf16 v[244:247], v[120:123], v[84:87], v[244:247]
    s_waitcnt lgkmcnt(0)
    v_mfma_f32_16x16x32_bf16 v[252:255], v[124:127], v[84:87], v[252:255]
    v_mfma_f32_16x16x32_bf16 v[248:251], v[124:127], v[80:83], v[248:251]
    s_cmp_lt_u32 s3, 4
    s_cbranch_scc1 L_qb
    s_barrier
L_qb:
    s_mov_b32 s6, 0x3e0293ee
    s_nop 7
    buffer_store_dwordx4 v[160:163], v13, s[8:11], s67 offen sc1
    s_add_u32 s67, s67, 1024
    buffer_store_dwordx4 v[164:167], v13, s[8:11], s67 offen sc1
    s_add_u32 s67, s67, s68
    buffer_store_dwordx4 v[168:171], v13, s[8:11], s67 offen sc1
    s_add_u32 s67, s67, 1024
    buffer_store_dwordx4 v[172:175], v13, s[8:11], s67 offen sc1
    s_add_u32 s67, s67, s69
    v_mul_f32 v192, s6, v192
    v_mul_f32 v193, s6, v193
    v_mul_f32 v194, s6, v194
    v_mul_f32 v195, s6, v195
    v_cvt_pk_bf16_f32 v16, v192, v193
    v_cvt_pk_bf16_f32 v17, v194, v195
    v_mul_f32 v200, s6, v200
    v_mul_f32 v201, s6, v201
    v_mul_f32 v202, s6, v202
    v_mul_f32 v203, s6, v203
    v_cvt_pk_bf16_f32 v18, v200, v201
    v_cvt_pk_bf16_f32 v19, v202, v203
    v_mul_f32 v208, s6, v208
    v_mul_f32 v209, s6, v209
    v_mul_f32 v210, s6, v210
    v_mul_f32 v211, s6, v211
    v_cvt_pk_bf16_f32 v20, v208, v209
    v_cvt_pk_bf16_f32 v21, v210, v211
    v_mul_f32 v216, s6, v216
    v_mul_f32 v217, s6, v217
    v_mul_f32 v218, s6, v218
    v_mul_f32 v219, s6, v219
    v_cvt_pk_bf16_f32 v22, v216, v217
    v_cvt_pk_bf16_f32 v23, v218, v219
    v_mul_f32 v224, s6, v224
    v_mul_f32 v225, s6, v225
    v_mul_f32 v226, s6, v226
    v_mul_f32 v227, s6, v227
    v_cvt_pk_bf16_f32 v24, v224, v225
    v_cvt_pk_bf16_f32 v25, v226, v227
    v_mul_f32 v232, s6, v232
    v_mul_f32 v233, s6, v233
    v_mul_f32 v234, s6, v234
    v_mul_f32 v235, s6, v235
    v_cvt_pk_bf16_f32 v26, v232, v233
    v_cvt_pk_bf16_f32 v27, v234, v235
    v_mul_f32 v240, s6, v240
    v_mul_f32 v241, s6, v241
    v_mul_f32 v242, s6, v242
    v_mul_f32 v243, s6, v243
    v_cvt_pk_bf16_f32 v28, v240, v241
    v_cvt_pk_bf16_f32 v29, v242, v243
    v_mul_f32 v248, s6, v248
    v_mul_f32 v249, s6, v249
    v_mul_f32 v250, s6, v250
    v_mul_f32 v251, s6, v251
    v_cvt_pk_bf16_f32 v30, v248, v249
    v_cvt_pk_bf16_f32 v31, v250, v251
    v_mul_f32 v196, s6, v196
    v_mul_f32 v197, s6, v197
    v_mul_f32 v198, s6, v198
    v_mul_f32 v199, s6, v199
    v_cvt_pk_bf16_f32 v32, v196, v197
    v_cvt_pk_bf16_f32 v33, v198, v199
    v_mul_f32 v204, s6, v204
    v_mul_f32 v205, s6, v205
    v_mul_f32 v206, s6, v206
    v_mul_f32 v207, s6, v207
    v_cvt_pk_bf16_f32 v34, v204, v205
    v_cvt_pk_bf16_f32 v35, v206, v207
    v_mul_f32 v212, s6, v212
    v_mul_f32 v213, s6, v213
    v_mul_f32 v214, s6, v214
    v_mul_f32 v215, s6, v215
    v_cvt_pk_bf16_f32 v36, v212, v213
    v_cvt_pk_bf16_f32 v37, v214, v215
    v_mul_f32 v220, s6, v220
    v_mul_f32 v221, s6, v221
    v_mul_f32 v222, s6, v222
    v_mul_f32 v223, s6, v223
    v_cvt_pk_bf16_f32 v38, v220, v221
    v_cvt_pk_bf16_f32 v39, v222, v223
    v_mul_f32 v228, s6, v228
    v_mul_f32 v229, s6, v229
    v_mul_f32 v230, s6, v230
    v_mul_f32 v231, s6, v231
    v_cvt_pk_bf16_f32 v40, v228, v229
    v_cvt_pk_bf16_f32 v41, v230, v231
    v_mul_f32 v236, s6, v236
    v_mul_f32 v237, s6, v237
    v_mul_f32 v238, s6, v238
    v_mul_f32 v239, s6, v239
    v_cvt_pk_bf16_f32 v42, v236, v237
    v_cvt_pk_bf16_f32 v43, v238, v239
    v_mul_f32 v244, s6, v244
    v_mul_f32 v245, s6, v245
    v_mul_f32 v246, s6, v246
    v_mul_f32 v247, s6, v247
    v_cvt_pk_bf16_f32 v44, v244, v245
    v_cvt_pk_bf16_f32 v45, v246, v247
    v_mul_f32 v252, s6, v252
    v_mul_f32 v253, s6, v253
    v_mul_f32 v254, s6, v254
    v_mul_f32 v255, s6, v255
    v_cvt_pk_bf16_f32 v46, v252, v253
    v_cvt_pk_bf16_f32 v47, v254, v255
    v_mov_b64 v[192:193], 0
    v_mov_b64 v[194:195], 0
    v_mov_b64 v[196:197], 0
    v_mov_b64 v[198:199], 0
    v_mov_b64 v[200:201], 0
    v_mov_b64 v[202:203], 0
    v_mov_b64 v[204:205], 0
    v_mov_b64 v[206:207], 0
    v_mov_b64 v[208:209], 0
    v_mov_b64 v[210:211], 0
    v_mov_b64 v[212:213], 0
    v_mov_b64 v[214:215], 0
    v_mov_b64 v[216:217], 0
    v_mov_b64 v[218:219], 0
    v_mov_b64 v[220:221], 0
    v_mov_b64 v[222:223], 0
    v_mov_b64 v[224:225], 0
    v_mov_b64 v[226:227], 0
    v_mov_b64 v[228:229], 0
    v_mov_b64 v[230:231], 0
    v_mov_b64 v[232:233], 0
    v_mov_b64 v[234:235], 0
    v_mov_b64 v[236:237], 0
    v_mov_b64 v[238:239], 0
    v_mov_b64 v[240:241], 0
    v_mov_b64 v[242:243], 0
    v_mov_b64 v[244:245], 0
    v_mov_b64 v[246:247], 0
    v_mov_b64 v[248:249], 0
    v_mov_b64 v[250:251], 0
    v_mov_b64 v[252:253], 0
    v_mov_b64 v[254:255], 0
    v_mov_b64 v[144:145], 0
    v_mov_b64 v[146:147], 0
    v_mov_b64 v[148:149], 0
    v_mov_b64 v[150:151], 0
    v_mov_b64 v[152:153], 0
    v_mov_b64 v[154:155], 0
    v_mov_b64 v[156:157], 0
    v_mov_b64 v[158:159], 0
    v_mov_b64 v[160:161], 0
    v_mov_b64 v[162:163], 0
    v_mov_b64 v[164:165], 0
    v_mov_b64 v[166:167], 0
    v_mov_b32 v168, 0x3f803f80
    v_mov_b32 v169, 0x3f803f80
    v_mov_b32 v170, 0x3f803f80
    v_mov_b32 v171, 0x3f803f80
    v_add_u32 v48, s100, v13
    s_waitcnt vmcnt(8)
    s_mov_b32 s72, 0x40004000
    s_mov_b32 s65, 0
    s_sub_u32 s63, 15, s5
    s_mov_b32 s62, -1
    s_cmp_ge_u32 s3, 4
    s_cbranch_scc1 L_qb2
    s_barrier
L_qb2:
    ds_read_b128 v[96:99], v48 offset:0
    ds_read_b128 v[100:103], v48 offset:1024
    ds_read_b128 v[104:107], v48 offset:2048
    ds_read_b128 v[108:111], v48 offset:3072
    ds_read_b128 v[112:115], v48 offset:4096
    ds_read_b128 v[116:119], v48 offset:5120
    ds_read_b128 v[120:123], v48 offset:6144
    ds_read_b128 v[124:127], v48 offset:7168
    s_cmp_lg_u32 s60, 0
    s_cbranch_scc1 L_nm0
    s_call_b64 s[82:83], L_mask
L_nm0:
    s_waitcnt lgkmcnt(7)
    v_mfma_f32_16x16x32_bf16 v[64:67], v[96:99], v[16:19], v[144:147]
    v_mfma_f32_16x16x32_bf16 v[68:71], v[96:99], v[32:35], v[148:151]
    ds_read_b128 v[96:99], v48 offset:8192
    s_waitcnt lgkmcnt(7)
    v_mfma_f32_16x16x32_bf16 v[64:67], v[100:103], v[20:23], v[64:67]
    v_mfma_f32_16x16x32_bf16 v[68:71], v[100:103], v[36:39], v[68:71]
    ds_read_b128 v[100:103], v48 offset:9216
    s_waitcnt lgkmcnt(7)
    v_mfma_f32_16x16x32_bf16 v[64:67], v[104:107], v[24:27], v[64:67]
    v_mfma_f32_16x16x32_bf16 v[68:71], v[104:107], v[40:43], v[68:71]
    ds_read_b128 v[104:107], v48 offset:10240
    s_waitcnt lgkmcnt(7)
    v_mfma_f32_16x16x32_bf16 v[64:67], v[108:111], v[28:31], v[64:67]
    v_mfma_f32_16x16x32_bf16 v[68:71], v[108:111], v[44:47], v[68:71]
    ds_read_b128 v[108:111], v48 offset:11264
    s_waitcnt lgkmcnt(7)
    v_mfma_f32_16x16x32_bf16 v[72:75], v[112:115], v[16:19], v[152:155]
    v_mfma_f32_16x16x32_bf16 v[76:79], v[112:115], v[32:35], v[156:159]
    ds_read_b128 v[112:115], v48 offset:12288
    s_waitcnt lgkmcnt(7)
    v_mfma_f32_16x16x32_bf16 v[72:75], v[116:119], v[20:23], v[72:75]
    v_mfma_f32_16x16x32_bf16 v[76:79], v[116:119], v[36:39], v[76:79]
    ds_read_b128 v[116:119], v48 offset:13312
    s_waitcnt lgkmcnt(7)
    v_mfma_f32_16x16x32_bf16 v[72:75], v[120:123], v[24:27], v[72:75]
    v_mfma_f32_16x16x32_bf16 v[76:79], v[120:123], v[40:43], v[76:79]
    ds_read_b128 v[120:123], v48 offset:14336
    s_waitcnt lgkmcnt(7)
    v_mfma_f32_16x16x32_bf16 v[72:75], v[124:127], v[28:31], v[72:75]
    v_mfma_f32_16x16x32_bf16 v[76:79], v[124:127], v[44:47], v[76:79]
    ds_read_b128 v[124:127], v48 offset:15360
    s_nop 7
    v_max3_f32 v58, v64, v65, v66
    v_max3_f32 v58, v58, v67, v72
    v_max3_f32 v58, v58, v73, v74
    v_max_f32 v58, v58, v75
    v_mov_b32 v60, v58
    s_nop 1
    v_permlane16_swap_b32 v58, v60
    s_nop 1
    v_max_f32 v58, v58, v60
    v_mov_b32 v60, v58
    s_nop 1
    v_permlane32_swap_b32 v58, v60
    s_nop 1
    v_max_f32 v58, v58, v60
    v_add_f32 v58, 0x41c00000, v58
    v_sub_f32 v64, v64, v58
    v_sub_f32 v144, 0, v58
    v_sub_f32 v65, v65, v58
    v_sub_f32 v145, 0, v58
    v_sub_f32 v66, v66, v58
    v_sub_f32 v146, 0, v58
    v_sub_f32 v67, v67, v58
    v_sub_f32 v147, 0, v58
    v_sub_f32 v72, v72, v58
    v_sub_f32 v152, 0, v58
    v_sub_f32 v73, v73, v58
    v_sub_f32 v153, 0, v58
    v_sub_f32 v74, v74, v58
    v_sub_f32 v154, 0, v58
    v_sub_f32 v75, v75, v58
    v_sub_f32 v155, 0, v58
    v_max3_f32 v59, v68, v69, v70
    v_max3_f32 v59, v59, v71, v76
    v_max3_f32 v59, v59, v77, v78
    v_max_f32 v59, v59, v79
    v_mov_b32 v60, v59
    s_nop 1
    v_permlane16_swap_b32 v59, v60
    s_nop 1
    v_max_f32 v59, v59, v60
    v_mov_b32 v60, v59
    s_nop 1
    v_permlane32_swap_b32 v59, v60
    s_nop 1
    v_max_f32 v59, v59, v60
    v_add_f32 v59, 0x41c00000, v59
    v_sub_f32 v68, v68, v59
    v_sub_f32 v148, 0, v59
    v_sub_f32 v69, v69, v59
    v_sub_f32 v149, 0, v59
    v_sub_f32 v70, v70, v59
    v_sub_f32 v150, 0, v59
    v_sub_f32 v71, v71, v59
    v_sub_f32 v151, 0, v59
    v_sub_f32 v76, v76, v59
    v_sub_f32 v156, 0, v59
    v_sub_f32 v77, v77, v59
    v_sub_f32 v157, 0, v59
    v_sub_f32 v78, v78, v59
    v_sub_f32 v158, 0, v59
    v_sub_f32 v79, v79, v59
    v_sub_f32 v159, 0, v59
    s_cmp_lg_u32 s60, 1
    s_cbranch_scc1 L_nm1
    s_call_b64 s[82:83], L_mask
L_nm1:
    v_exp_f32 v58, v64
    v_exp_f32 v59, v65
    s_waitcnt lgkmcnt(7)
    v_mfma_f32_16x16x32_bf16 v[80:83], v[96:99], v[16:19], v[144:147]
    s_waitcnt lgkmcnt(6)
    v_exp_f32 v60, v66
    v_exp_f32 v61, v67
    v_mfma_f32_16x16x32_bf16 v[84:87], v[96:99], v[32:35], v[148:151]
    ds_read_b128 v[96:99], v48 offset:49152
    v_cvt_pk_bf16_f32 v128, v58, v59
    v_cvt_pk_bf16_f32 v129, v60, v61
    v_mfma_f32_16x16x32_bf16 v[84:87], v[100:103], v[36:39], v[84:87]
    s_waitcnt lgkmcnt(6)
    v_exp_f32 v58, v68
    v_exp_f32 v59, v69
    v_mfma_f32_16x16x32_bf16 v[80:83], v[100:103], v[20:23], v[80:83]
    ds_read_b128 v[100:103], v48 offset:50176
    v_cvt_pk_bf16_f32 v132, v58, v59
    v_mfma_f32_16x16x32_bf16 v[80:83], v[104:107], v[24:27], v[80:83]
    s_waitcnt lgkmcnt(6)
    v_exp_f32 v60, v70
    v_exp_f32 v61, v71
    v_mfma_f32_16x16x32_bf16 v[84:87], v[104:107], v[40:43], v[84:87]
    ds_read_b128 v[104:107], v48 offset:51200
    v_cvt_pk_bf16_f32 v133, v60, v61
    v_mfma_f32_16x16x32_bf16 v[84:87], v[108:111], v[44:47], v[84:87]
    s_waitcnt lgkmcnt(6)
    v_exp_f32 v58, v72
    v_exp_f32 v59, v73
    v_mfma_f32_16x16x32_bf16 v[80:83], v[108:111], v[28:31], v[80:83]
    ds_read_b128 v[108:111], v48 offset:52224
    v_cvt_pk_bf16_f32 v130, v58, v59
    v_mfma_f32_16x16x32_bf16 v[88:91], v[112:115], v[16:19], v[152:155]
    s_waitcnt lgkmcnt(6)
    v_exp_f32 v60, v74
    v_exp_f32 v61, v75
    v_mfma_f32_16x16x32_bf16 v[92:95], v[112:115], v[32:35], v[156:159]
    ds_read_b128 v[112:115], v48 offset:53248
    v_cvt_pk_bf16_f32 v131, v60, v61
    v_mfma_f32_16x16x32_bf16 v[92:95], v[116:119], v[36:39], v[92:95]
    s_waitcnt lgkmcnt(6)
    v_exp_f32 v58, v76
    v_exp_f32 v59, v77
    v_mfma_f32_16x16x32_bf16 v[88:91], v[116:119], v[20:23], v[88:91]
    ds_read_b128 v[116:119], v48 offset:54272
    v_cvt_pk_bf16_f32 v134, v58, v59
    v_mfma_f32_16x16x32_bf16 v[88:91], v[120:123], v[24:27], v[88:91]
    s_waitcnt lgkmcnt(6)
    v_exp_f32 v60, v78
    v_exp_f32 v61, v79
    v_mfma_f32_16x16x32_bf16 v[92:95], v[120:123], v[40:43], v[92:95]
    ds_read_b128 v[120:123], v48 offset:55296
    v_cvt_pk_bf16_f32 v135, v60, v61
    v_mfma_f32_16x16x32_bf16 v[92:95], v[124:127], v[44:47], v[92:95]
    s_waitcnt lgkmcnt(6)
    v_or3_b32 v62, v128, v129, v132
    v_or3_b32 v62, v62, v133, v130
    v_or3_b32 v62, v62, v131, v134
    v_bitop3_b32 v62, v62, v135, s72 bitop3:0xa8
    v_cmp_ne_u32 vcc, s65, v62
    v_mfma_f32_16x16x32_bf16 v[88:91], v[124:127], v[28:31], v[88:91]
    ds_read_b128 v[124:127], v48 offset:56320
    s_cbranch_vccnz L_back_9_h
L_back_9:
    s_nop 7
    v_exp_f32 v58, v80
    v_exp_f32 v59, v81
    s_call_b64 s[82:83], L_load
    s_mov_b32 s62, 0
    buffer_store_dwordx4 v[176:179], v13, s[8:11], s67 offen sc1
    s_add_u32 s67, s67, 1024
    buffer_store_dwordx4 v[180:183], v13, s[8:11], s67 offen sc1
    s_add_u32 s67, s67, s68
    buffer_store_dwordx4 v[184:187], v13, s[8:11], s67 offen sc1
    s_add_u32 s67, s67, 1024
    buffer_store_dwordx4 v[188:191], v13, s[8:11], s67 offen sc1
    s_add_u32 s67, s67, s69
    s_sub_i32 s64, s60, 2
    s_cmp_eq_u32 s60, 0
    s_cbranch_scc1 L_pv2
    s_cmp_eq_u32 s60, 1
    s_cbranch_scc1 L_tail2
    s_cmp_lg_u32 s60, 2
    s_cbranch_scc1 L_st2
    s_call_b64 s[82:83], L_mask
    s_branch L_st2
.p2align 6
L_st0:
    v_mfma_f32_16x16x32_bf16 v[192:195], v[96:99], v[128:131], v[192:195]
    s_waitcnt lgkmcnt(6)
    v_exp_f32 v60, v82
    v_mfma_f32_16x16x32_bf16 v[196:199], v[96:99], v[132:135], v[196:199]
    ds_read_b128 v[96:99], v48 offset:0
    v_cvt_pk_bf16_f32 v136, v58, v59
    v_mfma_f32_16x16x32_bf16 v[204:207], v[100:103], v[132:135], v[204:207]
    s_waitcnt lgkmcnt(6)
    v_exp_f32 v61, v83
    v_mfma_f32_16x16x32_bf16 v[200:203], v[100:103], v[128:131], v[200:203]
    s_sub_i32 s64, s64, 1
    ds_read_b128 v[100:103], v48 offset:1024
    v_cvt_pk_bf16_f32 v137, v60, v61
    v_mfma_f32_16x16x32_bf16 v[208:211], v[104:107], v[128:131], v[208:211]
    s_waitcnt lgkmcnt(6)
    v_exp_f32 v58, v84
    v_mfma_f32_16x16x32_bf16 v[212:215], v[104:107], v[132:135], v[212:215]
    ds_read_b128 v[104:107], v48 offset:2048
    v_mfma_f32_16x16x32_bf16 v[220:223], v[108:111], v[132:135], v[220:223]
    s_waitcnt lgkmcnt(6)
    v_exp_f32 v59, v85
    v_mfma_f32_16x16x32_bf16 v[216:219], v[108:111], v[128:131], v[216:219]
    s_cmp_gt_i32 s64, 0
    ds_read_b128 v[108:111], v48 offset:3072
    v_cvt_pk_bf16_f32 v140, v58, v59
    v_mfma_f32_16x16x32_bf16 v[224:227], v[112:115], v[128:131], v[224:227]
    s_waitcnt lgkmcnt(6)
    v_exp_f32 v60, v86
    v_mfma_f32_16x16x32_bf16 v[228:231], v[112:115], v[132:135], v[228:231]
    ds_read_b128 v[112:115], v48 offset:4096
    v_or3_b32 v62, v136, v137, v140
    v_mfma_f32_16x16x32_bf16 v[236:239], v[116:119], v[132:135], v[236:239]
    s_waitcnt lgkmcnt(6)
    v_exp_f32 v61, v87
    v_mfma_f32_16x16x32_bf16 v[232:235], v[116:119], v[128:131], v[232:235]
    s_cselect_b32 s65, 0, 1
    ds_read_b128 v[116:119], v48 offset:5120
    v_cvt_pk_bf16_f32 v141, v60, v61
    v_mfma_f32_16x16x32_bf16 v[240:243], v[120:123], v[128:131], v[240:243]
    s_waitcnt lgkmcnt(6)
    v_exp_f32 v58, v88
    v_mfma_f32_16x16x32_bf16 v[244:247], v[120:123], v[132:135], v[244:247]
    ds_read_b128 v[120:123], v48 offset:6144
    v_mfma_f32_16x16x32_bf16 v[252:255], v[124:127], v[132:135], v[252:255]
    s_waitcnt lgkmcnt(6)
    v_exp_f32 v59, v89
    v_mfma_f32_16x16x32_bf16 v[248:251], v[124:127], v[128:131], v[248:251]
    ds_read_b128 v[124:127], v48 offset:7168
    v_cvt_pk_bf16_f32 v138, v58, v59
    v_mfma_f32_16x16x32_bf16 v[64:67], v[96:99], v[16:19], v[144:147]
    s_waitcnt lgkmcnt(6)
    v_exp_f32 v60, v90
    v_mfma_f32_16x16x32_bf16 v[68:71], v[96:99], v[32:35], v[148:151]
    ds_read_b128 v[96:99], v48 offset:40960
    v_or3_b32 v62, v62, v141, v138
    v_mfma_f32_16x16x32_bf16 v[68:71], v[100:103], v[36:39], v[68:71]
    v_exp_f32 v61, v91
    v_mfma_f32_16x16x32_bf16 v[64:67], v[100:103], v[20:23], v[64:67]
    ds_read_b128 v[100:103], v48 offset:41984
    v_cvt_pk_bf16_f32 v139, v60, v61
    v_mfma_f32_16x16x32_bf16 v[160:163], v[168:171], v[128:131], v[160:163]
    s_waitcnt lgkmcnt(7)
    v_exp_f32 v58, v92
    v_mfma_f32_16x16x32_bf16 v[164:167], v[168:171], v[132:135], v[164:167]
    v_mfma_f32_16x16x32_bf16 v[64:67], v[104:107], v[24:27], v[64:67]
    s_waitcnt lgkmcnt(6)
    v_exp_f32 v59, v93
    v_mfma_f32_16x16x32_bf16 v[68:71], v[104:107], v[40:43], v[68:71]
    ds_read_b128 v[104:107], v48 offset:43008
    v_cvt_pk_bf16_f32 v142, v58, v59
    v_mfma_f32_16x16x32_bf16 v[68:71], v[108:111], v[44:47], v[68:71]
    s_waitcnt lgkmcnt(6)
    v_exp_f32 v60, v94
    v_mfma_f32_16x16x32_bf16 v[64:67], v[108:111], v[28:31], v[64:67]
    ds_read_b128 v[108:111], v48 offset:44032
    v_or3_b32 v62, v62, v139, v142
    v_mfma_f32_16x16x32_bf16 v[72:75], v[112:115], v[16:19], v[152:155]
    s_waitcnt lgkmcnt(6)
    v_exp_f32 v61, v95
    v_mfma_f32_16x16x32_bf16 v[76:79], v[112:115], v[32:35], v[156:159]
    ds_read_b128 v[112:115], v48 offset:45056
    v_cvt_pk_bf16_f32 v143, v60, v61
    v_mfma_f32_16x16x32_bf16 v[76:79], v[116:119], v[36:39], v[76:79]
    s_waitcnt lgkmcnt(6)
    v_bitop3_b32 v62, v62, v143, s72 bitop3:0xa8
    v_cmp_ne_u32 vcc, s65, v62
    v_mfma_f32_16x16x32_bf16 v[72:75], v[116:119], v[20:23], v[72:75]
    ds_read_b128 v[116:119], v48 offset:46080
    v_mfma_f32_16x16x32_bf16 v[72:75], v[120:123], v[24:27], v[72:75]
    s_waitcnt lgkmcnt(6)
    v_exp_f32 v58, v64
    v_mfma_f32_16x16x32_bf16 v[76:79], v[120:123], v[40:43], v[76:79]
    ds_read_b128 v[120:123], v48 offset:47104
    v_mfma_f32_16x16x32_bf16 v[76:79], v[124:127], v[44:47], v[76:79]
    s_waitcnt lgkmcnt(6)
    v_exp_f32 v59, v65
    v_mfma_f32_16x16x32_bf16 v[72:75], v[124:127], v[28:31], v[72:75]
    ds_read_b128 v[124:127], v48 offset:48128
    s_cbranch_vccnz L_back_10_h
L_back_10:
    v_mfma_f32_16x16x32_bf16 v[192:195], v[96:99], v[136:139], v[192:195]
    s_waitcnt lgkmcnt(6)
    v_exp_f32 v60, v66
    v_mfma_f32_16x16x32_bf16 v[196:199], v[96:99], v[140:143], v[196:199]
    ds_read_b128 v[96:99], v48 offset:8192
    v_cvt_pk_bf16_f32 v128, v58, v59
    v_mfma_f32_16x16x32_bf16 v[204:207], v[100:103], v[140:143], v[204:207]
    s_waitcnt lgkmcnt(6)
    v_exp_f32 v61, v67
    v_mfma_f32_16x16x32_bf16 v[200:203], v[100:103], v[136:139], v[200:203]
    s_sub_i32 s64, s64, 1
    ds_read_b128 v[100:103], v48 offset:9216
    v_cvt_pk_bf16_f32 v129, v60, v61
    v_mfma_f32_16x16x32_bf16 v[208:211], v[104:107], v[136:139], v[208:211]
    s_waitcnt lgkmcnt(6)
    v_exp_f32 v58, v68
    v_mfma_f32_16x16x32_bf16 v[212:215], v[104:107], v[140:143], v[212:215]
    ds_read_b128 v[104:107], v48 offset:10240
    v_mfma_f32_16x16x32_bf16 v[220:223], v[108:111], v[140:143], v[220:223]
    s_waitcnt lgkmcnt(6)
    v_exp_f32 v59, v69
    v_mfma_f32_16x16x32_bf16 v[216:219], v[108:111], v[136:139], v[216:219]
    s_cmp_gt_i32 s64, 0
    ds_read_b128 v[108:111], v48 offset:11264
    v_cvt_pk_bf16_f32 v132, v58, v59
    v_mfma_f32_16x16x32_bf16 v[224:227], v[112:115], v[136:139], v[224:227]
    s_waitcnt lgkmcnt(6)
    v_exp_f32 v60, v70
    v_mfma_f32_16x16x32_bf16 v[228:231], v[112:115], v[140:143], v[228:231]
    ds_read_b128 v[112:115], v48 offset:12288
    v_or3_b32 v62, v128, v129, v132
    v_mfma_f32_16x16x32_bf16 v[236:239], v[116:119], v[140:143], v[236:239]
    s_waitcnt lgkmcnt(6)
    v_exp_f32 v61, v71
    v_mfma_f32_16x16x32_bf16 v[232:235], v[116:119], v[136:139], v[232:235]
    s_cselect_b32 s65, 0, 1
    ds_read_b128 v[116:119], v48 offset:13312
    v_cvt_pk_bf16_f32 v133, v60, v61
    v_mfma_f32_16x16x32_bf16 v[240:243], v[120:123], v[136:139], v[240:243]
    s_waitcnt lgkmcnt(6)
    v_exp_f32 v58, v72
    v_mfma_f32_16x16x32_bf16 v[244:247], v[120:123], v[140:143], v[244:247]
    ds_read_b128 v[120:123], v48 offset:14336
    v_mfma_f32_16x16x32_bf16 v[252:255], v[124:127], v[140:143], v[252:255]
    s_waitcnt lgkmcnt(6)
    v_exp_f32 v59, v73
    v_mfma_f32_16x16x32_bf16 v[248:251], v[124:127], v[136:139], v[248:251]
    ds_read_b128 v[124:127], v48 offset:15360
    v_cvt_pk_bf16_f32 v130, v58, v59
    v_mfma_f32_16x16x32_bf16 v[80:83], v[96:99], v[16:19], v[144:147]
    s_waitcnt lgkmcnt(6)
    v_exp_f32 v60, v74
    v_mfma_f32_16x16x32_bf16 v[84:87], v[96:99], v[32:35], v[148:151]
    ds_read_b128 v[96:99], v48 offset:49152
    v_or3_b32 v62, v62, v133, v130
    v_mfma_f32_16x16x32_bf16 v[84:87], v[100:103], v[36:39], v[84:87]
    v_exp_f32 v61, v75
    v_mfma_f32_16x16x32_bf16 v[80:83], v[100:103], v[20:23], v[80:83]
    ds_read_b128 v[100:103], v48 offset:50176
    v_cvt_pk_bf16_f32 v131, v60, v61
    v_mfma_f32_16x16x32_bf16 v[160:163], v[168:171], v[136:139], v[160:163]
    s_waitcnt lgkmcnt(7)
    v_exp_f32 v58, v76
    v_mfma_f32_16x16x32_bf16 v[164:167], v[168:171], v[140:143], v[164:167]
    v_mfma_f32_16x16x32_bf16 v[80:83], v[104:107], v[24:27], v[80:83]
    s_waitcnt lgkmcnt(6)
    v_exp_f32 v59, v77
    v_mfma_f32_16x16x32_bf16 v[84:87], v[104:107], v[40:43], v[84:87]
    ds_read_b128 v[104:107], v48 offset:51200
    v_cvt_pk_bf16_f32 v134, v58, v59
    v_mfma_f32_16x16x32_bf16 v[84:87], v[108:111], v[44:47], v[84:87]
    s_waitcnt lgkmcnt(6)
    v_exp_f32 v60, v78
    v_mfma_f32_16x16x32_bf16 v[80:83], v[108:111], v[28:31], v[80:83]
    ds_read_b128 v[108:111], v48 offset:52224
    v_or3_b32 v62, v62, v131, v134
    v_mfma_f32_16x16x32_bf16 v[88:91], v[112:115], v[16:19], v[152:155]
    s_waitcnt lgkmcnt(6)
    v_exp_f32 v61, v79
    v_mfma_f32_16x16x32_bf16 v[92:95], v[112:115], v[32:35], v[156:159]
    ds_read_b128 v[112:115], v48 offset:53248
    v_cvt_pk_bf16_f32 v135, v60, v61
    v_mfma_f32_16x16x32_bf16 v[92:95], v[116:119], v[36:39], v[92:95]
    s_waitcnt lgkmcnt(6)
    v_bitop3_b32 v62, v62, v135, s72 bitop3:0xa8
    v_cmp_ne_u32 vcc, s65, v62
    v_mfma_f32_16x16x32_bf16 v[88:91], v[116:119], v[20:23], v[88:91]
    ds_read_b128 v[116:119], v48 offset:54272
    v_mfma_f32_16x16x32_bf16 v[88:91], v[120:123], v[24:27], v[88:91]
    s_waitcnt lgkmcnt(6)
    v_exp_f32 v58, v80
    v_mfma_f32_16x16x32_bf16 v[92:95], v[120:123], v[40:43], v[92:95]
    ds_read_b128 v[120:123], v48 offset:55296
    v_mfma_f32_16x16x32_bf16 v[92:95], v[124:127], v[44:47], v[92:95]
    s_waitcnt lgkmcnt(6)
    v_exp_f32 v59, v81
    v_mfma_f32_16x16x32_bf16 v[88:91], v[124:127], v[28:31], v[88:91]
    ds_read_b128 v[124:127], v48 offset:56320
    s_cbranch_vccnz L_back_11_h
L_back_11:
L_st2:
    v_mfma_f32_16x16x32_bf16 v[192:195], v[96:99], v[128:131], v[192:195]
    s_waitcnt lgkmcnt(6)
    v_exp_f32 v60, v82
    v_mfma_f32_16x16x32_bf16 v[196:199], v[96:99], v[132:135], v[196:199]
    ds_read_b128 v[96:99], v48 offset:16384
    v_cvt_pk_bf16_f32 v136, v58, v59
    v_mfma_f32_16x16x32_bf16 v[204:207], v[100:103], v[132:135], v[204:207]
    s_waitcnt lgkmcnt(6)
    v_exp_f32 v61, v83
    v_mfma_f32_16x16x32_bf16 v[200:203], v[100:103], v[128:131], v[200:203]
    s_sub_i32 s64, s64, 1
    ds_read_b128 v[100:103], v48 offset:17408
    v_cvt_pk_bf16_f32 v137, v60, v61
    v_mfma_f32_16x16x32_bf16 v[208:211], v[104:107], v[128:131], v[208:211]
    s_waitcnt lgkmcnt(6)
    v_exp_f32 v58, v84
    v_mfma_f32_16x16x32_bf16 v[212:215], v[104:107], v[132:135], v[212:215]
    ds_read_b128 v[104:107], v48 offset:18432
    v_mfma_f32_16x16x32_bf16 v[220:223], v[108:111], v[132:135], v[220:223]
    s_waitcnt lgkmcnt(6)
    v_exp_f32 v59, v85
    v_mfma_f32_16x16x32_bf16 v[216:219], v[108:111], v[128:131], v[216:219]
    s_cmp_gt_i32 s64, 0
    ds_read_b128 v[108:111], v48 offset:19456
    v_cvt_pk_bf16_f32 v140, v58, v59
    v_mfma_f32_16x16x32_bf16 v[224:227], v[112:115], v[128:131], v[224:227]
    s_waitcnt lgkmcnt(6)
    v_exp_f32 v60, v86
    v_mfma_f32_16x16x32_bf16 v[228:231], v[112:115], v[132:135], v[228:231]
    ds_read_b128 v[112:115], v48 offset:20480
    v_or3_b32 v62, v136, v137, v140
    v_mfma_f32_16x16x32_bf16 v[236:239], v[116:119], v[132:135], v[236:239]
    s_waitcnt lgkmcnt(6)
    v_exp_f32 v61, v87
    v_mfma_f32_16x16x32_bf16 v[232:235], v[116:119], v[128:131], v[232:235]
    s_cselect_b32 s65, 0, 1
    ds_read_b128 v[116:119], v48 offset:21504
    v_cvt_pk_bf16_f32 v141, v60, v61
    v_mfma_f32_16x16x32_bf16 v[240:243], v[120:123], v[128:131], v[240:243]
    s_waitcnt lgkmcnt(6)
    v_exp_f32 v58, v88
    v_mfma_f32_16x16x32_bf16 v[244:247], v[120:123], v[132:135], v[244:247]
    ds_read_b128 v[120:123], v48 offset:22528
    v_mfma_f32_16x16x32_bf16 v[252:255], v[124:127], v[132:135], v[252:255]
    s_waitcnt lgkmcnt(6)
    v_exp_f32 v59, v89
    v_mfma_f32_16x16x32_bf16 v[248:251], v[124:127], v[128:131], v[248:251]
    ds_read_b128 v[124:127], v48 offset:23552
    v_cvt_pk_bf16_f32 v138, v58, v59
    v_mfma_f32_16x16x32_bf16 v[64:67], v[96:99], v[16:19], v[144:147]
    s_waitcnt lgkmcnt(6)
    v_exp_f32 v60, v90
    v_mfma_f32_16x16x32_bf16 v[68:71], v[96:99], v[32:35], v[148:151]
    ds_read_b128 v[96:99], v48 offset:57344
    v_or3_b32 v62, v62, v141, v138
    v_mfma_f32_16x16x32_bf16 v[68:71], v[100:103], v[36:39], v[68:71]
    v_exp_f32 v61, v91
    v_mfma_f32_16x16x32_bf16 v[64:67], v[100:103], v[20:23], v[64:67]
    ds_read_b128 v[100:103], v48 offset:58368
    v_cvt_pk_bf16_f32 v139, v60, v61
    v_mfma_f32_16x16x32_bf16 v[160:163], v[168:171], v[128:131], v[160:163]
    s_waitcnt lgkmcnt(7)
    v_exp_f32 v58, v92
    v_mfma_f32_16x16x32_bf16 v[164:167], v[168:171], v[132:135], v[164:167]
    v_mfma_f32_16x16x32_bf16 v[64:67], v[104:107], v[24:27], v[64:67]
    s_waitcnt lgkmcnt(6)
    v_exp_f32 v59, v93
    v_mfma_f32_16x16x32_bf16 v[68:71], v[104:107], v[40:43], v[68:71]
    ds_read_b128 v[104:107], v48 offset:59392
    v_cvt_pk_bf16_f32 v142, v58, v59
    v_mfma_f32_16x16x32_bf16 v[68:71], v[108:111], v[44:47], v[68:71]
    s_waitcnt lgkmcnt(6)
    v_exp_f32 v60, v94
    v_mfma_f32_16x16x32_bf16 v[64:67], v[108:111], v[28:31], v[64:67]
    ds_read_b128 v[108:111], v48 offset:60416
    v_or3_b32 v62, v62, v139, v142
    v_mfma_f32_16x16x32_bf16 v[72:75], v[112:115], v[16:19], v[152:155]
    s_waitcnt lgkmcnt(6)
    v_exp_f32 v61, v95
    v_mfma_f32_16x16x32_bf16 v[76:79], v[112:115], v[32:35], v[156:159]
    ds_read_b128 v[112:115], v48 offset:61440
    v_cvt_pk_bf16_f32 v143, v60, v61
    v_mfma_f32_16x16x32_bf16 v[76:79], v[116:119], v[36:39], v[76:79]
    s_waitcnt lgkmcnt(6)
    v_bitop3_b32 v62, v62, v143, s72 bitop3:0xa8
    v_cmp_ne_u32 vcc, s65, v62
    v_mfma_f32_16x16x32_bf16 v[72:75], v[116:119], v[20:23], v[72:75]
    ds_read_b128 v[116:119], v48 offset:62464
    v_mfma_f32_16x16x32_bf16 v[72:75], v[120:123], v[24:27], v[72:75]
    s_waitcnt lgkmcnt(6)
    v_exp_f32 v58, v64
    v_mfma_f32_16x16x32_bf16 v[76:79], v[120:123], v[40:43], v[76:79]
    ds_read_b128 v[120:123], v48 offset:63488
    v_mfma_f32_16x16x32_bf16 v[76:79], v[124:127], v[44:47], v[76:79]
    s_waitcnt lgkmcnt(6)
    v_exp_f32 v59, v65
    v_mfma_f32_16x16x32_bf16 v[72:75], v[124:127], v[28:31], v[72:75]
    ds_read_b128 v[124:127], v48 offset:64512
    s_cbranch_vccnz L_back_12_h
L_back_12:
    v_mfma_f32_16x16x32_bf16 v[192:195], v[96:99], v[136:139], v[192:195]
    s_waitcnt lgkmcnt(6)
    v_exp_f32 v60, v66
    v_mfma_f32_16x16x32_bf16 v[196:199], v[96:99], v[140:143], v[196:199]
    ds_read_b128 v[96:99], v48 offset:24576
    v_cvt_pk_bf16_f32 v128, v58, v59
    v_mfma_f32_16x16x32_bf16 v[204:207], v[100:103], v[140:143], v[204:207]
    s_waitcnt lgkmcnt(6)
    v_exp_f32 v61, v67
    v_mfma_f32_16x16x32_bf16 v[200:203], v[100:103], v[136:139], v[200:203]
    s_sub_i32 s64, s64, 1
    ds_read_b128 v[100:103], v48 offset:25600
    v_cvt_pk_bf16_f32 v129, v60, v61
    v_mfma_f32_16x16x32_bf16 v[208:211], v[104:107], v[136:139], v[208:211]
    s_waitcnt lgkmcnt(6)
    v_exp_f32 v58, v68
    v_mfma_f32_16x16x32_bf16 v[212:215], v[104:107], v[140:143], v[212:215]
    ds_read_b128 v[104:107], v48 offset:26624
    v_mfma_f32_16x16x32_bf16 v[220:223], v[108:111], v[140:143], v[220:223]
    s_waitcnt lgkmcnt(6)
    v_exp_f32 v59, v69
    v_mfma_f32_16x16x32_bf16 v[216:219], v[108:111], v[136:139], v[216:219]
    s_cmp_gt_i32 s64, 0
    ds_read_b128 v[108:111], v48 offset:27648
    v_cvt_pk_bf16_f32 v132, v58, v59
    v_mfma_f32_16x16x32_bf16 v[224:227], v[112:115], v[136:139], v[224:227]
    s_waitcnt lgkmcnt(6)
    v_exp_f32 v60, v70
    v_mfma_f32_16x16x32_bf16 v[228:231], v[112:115], v[140:143], v[228:231]
    ds_read_b128 v[112:115], v48 offset:28672
    v_or3_b32 v62, v128, v129, v132
    v_mfma_f32_16x16x32_bf16 v[236:239], v[116:119], v[140:143], v[236:239]
    s_waitcnt lgkmcnt(6)
    v_exp_f32 v61, v71
    v_mfma_f32_16x16x32_bf16 v[232:235], v[116:119], v[136:139], v[232:235]
    s_cselect_b32 s65, 0, 1
    ds_read_b128 v[116:119], v48 offset:29696
    v_cvt_pk_bf16_f32 v133, v60, v61
    v_mfma_f32_16x16x32_bf16 v[240:243], v[120:123], v[136:139], v[240:243]
    s_waitcnt lgkmcnt(6)
    v_exp_f32 v58, v72
    v_mfma_f32_16x16x32_bf16 v[244:247], v[120:123], v[140:143], v[244:247]
    ds_read_b128 v[120:123], v48 offset:30720
    v_mfma_f32_16x16x32_bf16 v[252:255], v[124:127], v[140:143], v[252:255]
    s_waitcnt lgkmcnt(6)
    v_exp_f32 v59, v73
    v_mfma_f32_16x16x32_bf16 v[248:251], v[124:127], v[136:139], v[248:251]
    ds_read_b128 v[124:127], v48 offset:31744
    v_cvt_pk_bf16_f32 v130, v58, v59
    v_mfma_f32_16x16x32_bf16 v[80:83], v[96:99], v[16:19], v[144:147]
    s_waitcnt lgkmcnt(6)
    v_exp_f32 v60, v74
    v_mfma_f32_16x16x32_bf16 v[84:87], v[96:99], v[32:35], v[148:151]
    v_or3_b32 v62, v62, v133, v130
    v_xor_b32 v48, 0x10000, v48
    v_mfma_f32_16x16x32_bf16 v[84:87], v[100:103], v[36:39], v[84:87]
    v_exp_f32 v61, v75
    v_mfma_f32_16x16x32_bf16 v[80:83], v[100:103], v[20:23], v[80:83]
    s_cmp_lg_u32 s89, 0
    v_cvt_pk_bf16_f32 v131, v60, v61
    v_mfma_f32_16x16x32_bf16 v[160:163], v[168:171], v[136:139], v[160:163]
    s_waitcnt lgkmcnt(0)
    v_exp_f32 v58, v76
    v_mfma_f32_16x16x32_bf16 v[164:167], v[168:171], v[140:143], v[164:167]
    s_cbranch_scc1 L_ldback_13_c
    s_barrier
L_ldback_13:
    s_add_i32 s62, s62, 1
    ds_read_b128 v[96:99], v48 offset:32768
    ds_read_b128 v[100:103], v48 offset:33792
    v_mfma_f32_16x16x32_bf16 v[80:83], v[104:107], v[24:27], v[80:83]
    v_exp_f32 v59, v77
    v_mfma_f32_16x16x32_bf16 v[84:87], v[104:107], v[40:43], v[84:87]
    ds_read_b128 v[104:107], v48 offset:34816
    v_cvt_pk_bf16_f32 v134, v58, v59
    v_mfma_f32_16x16x32_bf16 v[84:87], v[108:111], v[44:47], v[84:87]
    v_exp_f32 v60, v78
    v_mfma_f32_16x16x32_bf16 v[80:83], v[108:111], v[28:31], v[80:83]
    ds_read_b128 v[108:111], v48 offset:35840
    v_or3_b32 v62, v62, v131, v134
    v_mfma_f32_16x16x32_bf16 v[88:91], v[112:115], v[16:19], v[152:155]
    v_exp_f32 v61, v79
    v_mfma_f32_16x16x32_bf16 v[92:95], v[112:115], v[32:35], v[156:159]
    ds_read_b128 v[112:115], v48 offset:36864
    v_cvt_pk_bf16_f32 v135, v60, v61
    v_mfma_f32_16x16x32_bf16 v[92:95], v[116:119], v[36:39], v[92:95]
    v_bitop3_b32 v62, v62, v135, s72 bitop3:0xa8
    v_cmp_ne_u32 vcc, s65, v62
    v_mfma_f32_16x16x32_bf16 v[88:91], v[116:119], v[20:23], v[88:91]
    ds_read_b128 v[116:119], v48 offset:37888
    v_mfma_f32_16x16x32_bf16 v[88:91], v[120:123], v[24:27], v[88:91]
    v_exp_f32 v58, v80
    v_mfma_f32_16x16x32_bf16 v[92:95], v[120:123], v[40:43], v[92:95]
    ds_read_b128 v[120:123], v48 offset:38912
    v_mfma_f32_16x16x32_bf16 v[92:95], v[124:127], v[44:47], v[92:95]
    s_waitcnt lgkmcnt(6)
    v_exp_f32 v59, v81
    v_mfma_f32_16x16x32_bf16 v[88:91], v[124:127], v[28:31], v[88:91]
    ds_read_b128 v[124:127], v48 offset:39936
    s_cbranch_vccz L_st0
    s_branch L_back_14_h
L_tail0:
    s_mov_b32 s65, 0
    v_mfma_f32_16x16x32_bf16 v[192:195], v[96:99], v[128:131], v[192:195]
    s_waitcnt lgkmcnt(6)
    v_exp_f32 v60, v82
    v_exp_f32 v61, v83
    v_mfma_f32_16x16x32_bf16 v[196:199], v[96:99], v[132:135], v[196:199]
    ds_read_b128 v[96:99], v48 offset:40960
    v_cvt_pk_bf16_f32 v136, v58, v59
    v_cvt_pk_bf16_f32 v137, v60, v61
    v_mfma_f32_16x16x32_bf16 v[204:207], v[100:103], v[132:135], v[204:207]
    v_exp_f32 v58, v84
    v_exp_f32 v59, v85
    v_mfma_f32_16x16x32_bf16 v[200:203], v[100:103], v[128:131], v[200:203]
    ds_read_b128 v[100:103], v48 offset:41984
    v_cvt_pk_bf16_f32 v140, v58, v59
    v_mfma_f32_16x16x32_bf16 v[160:163], v[168:171], v[128:131], v[160:163]
    s_waitcnt lgkmcnt(7)
    v_exp_f32 v60, v86
    v_exp_f32 v61, v87
    v_mfma_f32_16x16x32_bf16 v[164:167], v[168:171], v[132:135], v[164:167]
    v_cvt_pk_bf16_f32 v141, v60, v61
    v_mfma_f32_16x16x32_bf16 v[208:211], v[104:107], v[128:131], v[208:211]
    s_waitcnt lgkmcnt(6)
    v_exp_f32 v58, v88
    v_exp_f32 v59, v89
    v_mfma_f32_16x16x32_bf16 v[212:215], v[104:107], v[132:135], v[212:215]
    ds_read_b128 v[104:107], v48 offset:43008
    v_cvt_pk_bf16_f32 v138, v58, v59
    v_mfma_f32_16x16x32_bf16 v[220:223], v[108:111], v[132:135], v[220:223]
    s_waitcnt lgkmcnt(6)
    v_exp_f32 v60, v90
    v_exp_f32 v61, v91
    v_mfma_f32_16x16x32_bf16 v[216:219], v[108:111], v[128:131], v[216:219]
    ds_read_b128 v[108:111], v48 offset:44032
    v_cvt_pk_bf16_f32 v139, v60, v61
    v_mfma_f32_16x16x32_bf16 v[224:227], v[112:115], v[128:131], v[224:227]
    s_waitcnt lgkmcnt(6)
    v_exp_f32 v58, v92
    v_exp_f32 v59, v93
    v_mfma_f32_16x16x32_bf16 v[228:231], v[112:115], v[132:135], v[228:231]
    ds_read_b128 v[112:115], v48 offset:45056
    v_cvt_pk_bf16_f32 v142, v58, v59
    v_mfma_f32_16x16x32_bf16 v[236:239], v[116:119], v[132:135], v[236:239]
    s_waitcnt lgkmcnt(6)
    v_exp_f32 v60, v94
    v_exp_f32 v61, v95
    v_mfma_f32_16x16x32_bf16 v[232:235], v[116:119], v[128:131], v[232:235]
    ds_read_b128 v[116:119], v48 offset:46080
    v_cvt_pk_bf16_f32 v143, v60, v61
    v_mfma_f32_16x16x32_bf16 v[240:243], v[120:123], v[128:131], v[240:243]
    s_waitcnt lgkmcnt(6)
    v_or3_b32 v62, v136, v137, v140
    v_or3_b32 v62, v62, v141, v138
    v_or3_b32 v62, v62, v139, v142
    v_bitop3_b32 v62, v62, v143, s72 bitop3:0xa8
    v_cmp_ne_u32 vcc, s65, v62
    v_mfma_f32_16x16x32_bf16 v[244:247], v[120:123], v[132:135], v[244:247]
    ds_read_b128 v[120:123], v48 offset:47104
    v_mfma_f32_16x16x32_bf16 v[252:255], v[124:127], v[132:135], v[252:255]
    s_waitcnt lgkmcnt(6)
    v_mfma_f32_16x16x32_bf16 v[248:251], v[124:127], v[128:131], v[248:251]
    ds_read_b128 v[124:127], v48 offset:48128
    s_cbranch_vccnz L_back_15_h
L_back_15:
L_pv1:
    v_mfma_f32_16x16x32_bf16 v[192:195], v[96:99], v[136:139], v[192:195]
    s_waitcnt lgkmcnt(6)
    v_mfma_f32_16x16x32_bf16 v[196:199], v[96:99], v[140:143], v[196:199]
    v_mfma_f32_16x16x32_bf16 v[204:207], v[100:103], v[140:143], v[204:207]
    v_mfma_f32_16x16x32_bf16 v[200:203], v[100:103], v[136:139], v[200:203]
    v_mfma_f32_16x16x32_bf16 v[160:163], v[168:171], v[136:139], v[160:163]
    s_waitcnt lgkmcnt(5)
    v_mfma_f32_16x16x32_bf16 v[164:167], v[168:171], v[140:143], v[164:167]
    v_mfma_f32_16x16x32_bf16 v[208:211], v[104:107], v[136:139], v[208:211]
    s_waitcnt lgkmcnt(4)
    v_mfma_f32_16x16x32_bf16 v[212:215], v[104:107], v[140:143], v[212:215]
    v_mfma_f32_16x16x32_bf16 v[220:223], v[108:111], v[140:143], v[220:223]
    s_waitcnt lgkmcnt(3)
    v_mfma_f32_16x16x32_bf16 v[216:219], v[108:111], v[136:139], v[216:219]
    v_mfma_f32_16x16x32_bf16 v[224:227], v[112:115], v[136:139], v[224:227]
    s_waitcnt lgkmcnt(2)
    v_mfma_f32_16x16x32_bf16 v[228:231], v[112:115], v[140:143], v[228:231]
    v_mfma_f32_16x16x32_bf16 v[236:239], v[116:119], v[140:143], v[236:239]
    s_waitcnt lgkmcnt(1)
    v_mfma_f32_16x16x32_bf16 v[232:235], v[116:119], v[136:139], v[232:235]
    v_mfma_f32_16x16x32_bf16 v[240:243], v[120:123], v[136:139], v[240:243]
    s_waitcnt lgkmcnt(0)
    v_mfma_f32_16x16x32_bf16 v[244:247], v[120:123], v[140:143], v[244:247]
    v_mfma_f32_16x16x32_bf16 v[252:255], v[124:127], v[140:143], v[252:255]
    v_mfma_f32_16x16x32_bf16 v[248:251], v[124:127], v[136:139], v[248:251]
    s_branch L_fin
L_tail1:
    s_mov_b32 s65, 0
    v_mfma_f32_16x16x32_bf16 v[192:195], v[96:99], v[136:139], v[192:195]
    s_waitcnt lgkmcnt(6)
    v_exp_f32 v60, v66
    v_exp_f32 v61, v67
    v_mfma_f32_16x16x32_bf16 v[196:199], v[96:99], v[140:143], v[196:199]
    ds_read_b128 v[96:99], v48 offset:49152
    v_cvt_pk_bf16_f32 v128, v58, v59
    v_cvt_pk_bf16_f32 v129, v60, v61
    v_mfma_f32_16x16x32_bf16 v[204:207], v[100:103], v[140:143], v[204:207]
    v_exp_f32 v58, v68
    v_exp_f32 v59, v69
    v_mfma_f32_16x16x32_bf16 v[200:203], v[100:103], v[136:139], v[200:203]
    ds_read_b128 v[100:103], v48 offset:50176
    v_cvt_pk_bf16_f32 v132, v58, v59
    v_mfma_f32_16x16x32_bf16 v[160:163], v[168:171], v[136:139], v[160:163]
    s_waitcnt lgkmcnt(7)
    v_exp_f32 v60, v70
    v_exp_f32 v61, v71
    v_mfma_f32_16x16x32_bf16 v[164:167], v[168:171], v[140:143], v[164:167]
    v_cvt_pk_bf16_f32 v133, v60, v61
    v_mfma_f32_16x16x32_bf16 v[208:211], v[104:107], v[136:139], v[208:211]
    s_waitcnt lgkmcnt(6)
    v_exp_f32 v58, v72
    v_exp_f32 v59, v73
    v_mfma_f32_16x16x32_bf16 v[212:215], v[104:107], v[140:143], v[212:215]
    ds_read_b128 v[104:107], v48 offset:51200
    v_cvt_pk_bf16_f32 v130, v58, v59
    v_mfma_f32_16x16x32_bf16 v[220:223], v[108:111], v[140:143], v[220:223]
    s_waitcnt lgkmcnt(6)
    v_exp_f32 v60, v74
    v_exp_f32 v61, v75
    v_mfma_f32_16x16x32_bf16 v[216:219], v[108:111], v[136:139], v[216:219]
    ds_read_b128 v[108:111], v48 offset:52224
    v_cvt_pk_bf16_f32 v131, v60, v61
    v_mfma_f32_16x16x32_bf16 v[224:227], v[112:115], v[136:139], v[224:227]
    s_waitcnt lgkmcnt(6)
    v_exp_f32 v58, v76
    v_exp_f32 v59, v77
    v_mfma_f32_16x16x32_bf16 v[228:231], v[112:115], v[140:143], v[228:231]
    ds_read_b128 v[112:115], v48 offset:53248
    v_cvt_pk_bf16_f32 v134, v58, v59
    v_mfma_f32_16x16x32_bf16 v[236:239], v[116:119], v[140:143], v[236:239]
    s_waitcnt lgkmcnt(6)
    v_exp_f32 v60, v78
    v_exp_f32 v61, v79
    v_mfma_f32_16x16x32_bf16 v[232:235], v[116:119], v[136:139], v[232:235]
    ds_read_b128 v[116:119], v48 offset:54272
    v_cvt_pk_bf16_f32 v135, v60, v61
    v_mfma_f32_16x16x32_bf16 v[240:243], v[120:123], v[136:139], v[240:243]
    s_waitcnt lgkmcnt(6)
    v_or3_b32 v62, v128, v129, v132
    v_or3_b32 v62, v62, v133, v130
    v_or3_b32 v62, v62, v131, v134
    v_bitop3_b32 v62, v62, v135, s72 bitop3:0xa8
    v_cmp_ne_u32 vcc, s65, v62
    v_mfma_f32_16x16x32_bf16 v[244:247], v[120:123], v[140:143], v[244:247]
    ds_read_b128 v[120:123], v48 offset:55296
    v_mfma_f32_16x16x32_bf16 v[252:255], v[124:127], v[140:143], v[252:255]
    s_waitcnt lgkmcnt(6)
    v_mfma_f32_16x16x32_bf16 v[248:251], v[124:127], v[136:139], v[248:251]
    ds_read_b128 v[124:127], v48 offset:56320
    s_cbranch_vccnz L_back_16_h
L_back_16:
L_pv2:
    v_mfma_f32_16x16x32_bf16 v[192:195], v[96:99], v[128:131], v[192:195]
    s_waitcnt lgkmcnt(6)
    v_mfma_f32_16x16x32_bf16 v[196:199], v[96:99], v[132:135], v[196:199]
    v_mfma_f32_16x16x32_bf16 v[204:207], v[100:103], v[132:135], v[204:207]
    v_mfma_f32_16x16x32_bf16 v[200:203], v[100:103], v[128:131], v[200:203]
    v_mfma_f32_16x16x32_bf16 v[160:163], v[168:171], v[128:131], v[160:163]
    s_waitcnt lgkmcnt(5)
    v_mfma_f32_16x16x32_bf16 v[164:167], v[168:171], v[132:135], v[164:167]
    v_mfma_f32_16x16x32_bf16 v[208:211], v[104:107], v[128:131], v[208:211]
    s_waitcnt lgkmcnt(4)
    v_mfma_f32_16x16x32_bf16 v[212:215], v[104:107], v[132:135], v[212:215]
    v_mfma_f32_16x16x32_bf16 v[220:223], v[108:111], v[132:135], v[220:223]
    s_waitcnt lgkmcnt(3)
    v_mfma_f32_16x16x32_bf16 v[216:219], v[108:111], v[128:131], v[216:219]
    v_mfma_f32_16x16x32_bf16 v[224:227], v[112:115], v[128:131], v[224:227]
    s_waitcnt lgkmcnt(2)
    v_mfma_f32_16x16x32_bf16 v[228:231], v[112:115], v[132:135], v[228:231]
    v_mfma_f32_16x16x32_bf16 v[236:239], v[116:119], v[132:135], v[236:239]
    s_waitcnt lgkmcnt(1)
    v_mfma_f32_16x16x32_bf16 v[232:235], v[116:119], v[128:131], v[232:235]
    v_mfma_f32_16x16x32_bf16 v[240:243], v[120:123], v[128:131], v[240:243]
    s_waitcnt lgkmcnt(0)
    v_mfma_f32_16x16x32_bf16 v[244:247], v[120:123], v[132:135], v[244:247]
    v_mfma_f32_16x16x32_bf16 v[252:255], v[124:127], v[132:135], v[252:255]
    v_mfma_f32_16x16x32_bf16 v[248:251], v[124:127], v[128:131], v[248:251]
    s_branch L_fin
L_tail2:
    s_mov_b32 s65, 0
    v_mfma_f32_16x16x32_bf16 v[192:195], v[96:99], v[128:131], v[192:195]
    s_waitcnt lgkmcnt(6)
    v_exp_f32 v60, v82
    v_exp_f32 v61, v83
    v_mfma_f32_16x16x32_bf16 v[196:199], v[96:99], v[132:135], v[196:199]
    ds_read_b128 v[96:99], v48 offset:57344
    v_cvt_pk_bf16_f32 v136, v58, v59
    v_cvt_pk_bf16_f32 v137, v60, v61
    v_mfma_f32_16x16x32_bf16 v[204:207], v[100:103], v[132:135], v[204:207]
    v_exp_f32 v58, v84
    v_exp_f32 v59, v85
    v_mfma_f32_16x16x32_bf16 v[200:203], v[100:103], v[128:131], v[200:203]
    ds_read_b128 v[100:103], v48 offset:58368
    v_cvt_pk_bf16_f32 v140, v58, v59
    v_mfma_f32_16x16x32_bf16 v[160:163], v[168:171], v[128:131], v[160:163]
    s_waitcnt lgkmcnt(7)
    v_exp_f32 v60, v86
    v_exp_f32 v61, v87
    v_mfma_f32_16x16x32_bf16 v[164:167], v[168:171], v[132:135], v[164:167]
    v_cvt_pk_bf16_f32 v141, v60, v61
    v_mfma_f32_16x16x32_bf16 v[208:211], v[104:107], v[128:131], v[208:211]
    s_waitcnt lgkmcnt(6)
    v_exp_f32 v58, v88
    v_exp_f32 v59, v89
    v_mfma_f32_16x16x32_bf16 v[212:215], v[104:107], v[132:135], v[212:215]
    ds_read_b128 v[104:107], v48 offset:59392
    v_cvt_pk_bf16_f32 v138, v58, v59
    v_mfma_f32_16x16x32_bf16 v[220:223], v[108:111], v[132:135], v[220:223]
    s_waitcnt lgkmcnt(6)
    v_exp_f32 v60, v90
    v_exp_f32 v61, v91
    v_mfma_f32_16x16x32_bf16 v[216:219], v[108:111], v[128:131], v[216:219]
    ds_read_b128 v[108:111], v48 offset:60416
    v_cvt_pk_bf16_f32 v139, v60, v61
    v_mfma_f32_16x16x32_bf16 v[224:227], v[112:115], v[128:131], v[224:227]
    s_waitcnt lgkmcnt(6)
    v_exp_f32 v58, v92
    v_exp_f32 v59, v93
    v_mfma_f32_16x16x32_bf16 v[228:231], v[112:115], v[132:135], v[228:231]
    ds_read_b128 v[112:115], v48 offset:61440
    v_cvt_pk_bf16_f32 v142, v58, v59
    v_mfma_f32_16x16x32_bf16 v[236:239], v[116:119], v[132:135], v[236:239]
    s_waitcnt lgkmcnt(6)
    v_exp_f32 v60, v94
    v_exp_f32 v61, v95
    v_mfma_f32_16x16x32_bf16 v[232:235], v[116:119], v[128:131], v[232:235]
    ds_read_b128 v[116:119], v48 offset:62464
    v_cvt_pk_bf16_f32 v143, v60, v61
    v_mfma_f32_16x16x32_bf16 v[240:243], v[120:123], v[128:131], v[240:243]
    s_waitcnt lgkmcnt(6)
    v_or3_b32 v62, v136, v137, v140
    v_or3_b32 v62, v62, v141, v138
    v_or3_b32 v62, v62, v139, v142
    v_bitop3_b32 v62, v62, v143, s72 bitop3:0xa8
    v_cmp_ne_u32 vcc, s65, v62
    v_mfma_f32_16x16x32_bf16 v[244:247], v[120:123], v[132:135], v[244:247]
    ds_read_b128 v[120:123], v48 offset:63488
    v_mfma_f32_16x16x32_bf16 v[252:255], v[124:127], v[132:135], v[252:255]
    s_waitcnt lgkmcnt(6)
    v_mfma_f32_16x16x32_bf16 v[248:251], v[124:127], v[128:131], v[248:251]
    ds_read_b128 v[124:127], v48 offset:64512
    s_cbranch_vccnz L_back_17_h
L_back_17:
L_pv3:
    v_mfma_f32_16x16x32_bf16 v[192:195], v[96:99], v[136:139], v[192:195]
    s_waitcnt lgkmcnt(6)
    v_mfma_f32_16x16x32_bf16 v[196:199], v[96:99], v[140:143], v[196:199]
    v_xor_b32 v48, 0x10000, v48
    v_mfma_f32_16x16x32_bf16 v[204:207], v[100:103], v[140:143], v[204:207]
    v_mfma_f32_16x16x32_bf16 v[200:203], v[100:103], v[136:139], v[200:203]
    v_mfma_f32_16x16x32_bf16 v[160:163], v[168:171], v[136:139], v[160:163]
    s_waitcnt lgkmcnt(5)
    v_mfma_f32_16x16x32_bf16 v[164:167], v[168:171], v[140:143], v[164:167]
    s_waitcnt vmcnt(0) lgkmcnt(0)
    s_call_b64 s[82:83], L_pend
    s_barrier
    s_call_b64 s[82:83], L_load
    s_add_i32 s62, s62, 1
    v_mfma_f32_16x16x32_bf16 v[208:211], v[104:107], v[136:139], v[208:211]
    v_mfma_f32_16x16x32_bf16 v[212:215], v[104:107], v[140:143], v[212:215]
    v_mfma_f32_16x16x32_bf16 v[220:223], v[108:111], v[140:143], v[220:223]
    v_mfma_f32_16x16x32_bf16 v[216:219], v[108:111], v[136:139], v[216:219]
    v_mfma_f32_16x16x32_bf16 v[224:227], v[112:115], v[136:139], v[224:227]
    v_mfma_f32_16x16x32_bf16 v[228:231], v[112:115], v[140:143], v[228:231]
    v_mfma_f32_16x16x32_bf16 v[236:239], v[116:119], v[140:143], v[236:239]
    v_mfma_f32_16x16x32_bf16 v[232:235], v[116:119], v[136:139], v[232:235]
    v_mfma_f32_16x16x32_bf16 v[240:243], v[120:123], v[136:139], v[240:243]
    v_mfma_f32_16x16x32_bf16 v[244:247], v[120:123], v[140:143], v[244:247]
    v_mfma_f32_16x16x32_bf16 v[252:255], v[124:127], v[140:143], v[252:255]
    v_mfma_f32_16x16x32_bf16 v[248:251], v[124:127], v[136:139], v[248:251]
    s_branch L_fin
L_tail3:
    s_mov_b32 s65, 0
    v_mfma_f32_16x16x32_bf16 v[192:195], v[96:99], v[136:139], v[192:195]
    s_waitcnt lgkmcnt(6)
    v_exp_f32 v60, v66
    v_exp_f32 v61, v67
    v_mfma_f32_16x16x32_bf16 v[196:199], v[96:99], v[140:143], v[196:199]
    v_cvt_pk_bf16_f32 v128, v58, v59
    v_cvt_pk_bf16_f32 v129, v60, v61
    v_xor_b32 v48, 0x10000, v48
    v_mfma_f32_16x16x32_bf16 v[204:207], v[100:103], v[140:143], v[204:207]
    v_exp_f32 v58, v68
    v_exp_f32 v59, v69
    v_mfma_f32_16x16x32_bf16 v[200:203], v[100:103], v[136:139], v[200:203]
    v_cvt_pk_bf16_f32 v132, v58, v59
    v_mfma_f32_16x16x32_bf16 v[160:163], v[168:171], v[136:139], v[160:163]
    s_waitcnt lgkmcnt(5)
    v_exp_f32 v60, v70
    v_exp_f32 v61, v71
    v_mfma_f32_16x16x32_bf16 v[164:167], v[168:171], v[140:143], v[164:167]
    s_waitcnt vmcnt(0) lgkmcnt(0)
    s_call_b64 s[82:83], L_pend
    s_barrier
    s_call_b64 s[82:83], L_load
    s_add_i32 s62, s62, 1
    ds_read_b128 v[96:99], v48 offset:32768
    ds_read_b128 v[100:103], v48 offset:33792
    v_cvt_pk_bf16_f32 v133, v60, v61
    v_mfma_f32_16x16x32_bf16 v[208:211], v[104:107], v[136:139], v[208:211]
    v_exp_f32 v58, v72
    v_exp_f32 v59, v73
    v_mfma_f32_16x16x32_bf16 v[212:215], v[104:107], v[140:143], v[212:215]
    ds_read_b128 v[104:107], v48 offset:34816
    v_cvt_pk_bf16_f32 v130, v58, v59
    v_mfma_f32_16x16x32_bf16 v[220:223], v[108:111], v[140:143], v[220:223]
    v_exp_f32 v60, v74
    v_exp_f32 v61, v75
    v_mfma_f32_16x16x32_bf16 v[216:219], v[108:111], v[136:139], v[216:219]
    ds_read_b128 v[108:111], v48 offset:35840
    v_cvt_pk_bf16_f32 v131, v60, v61
    v_mfma_f32_16x16x32_bf16 v[224:227], v[112:115], v[136:139], v[224:227]
    v_exp_f32 v58, v76
    v_exp_f32 v59, v77
    v_mfma_f32_16x16x32_bf16 v[228:231], v[112:115], v[140:143], v[228:231]
    ds_read_b128 v[112:115], v48 offset:36864
    v_cvt_pk_bf16_f32 v134, v58, v59
    v_mfma_f32_16x16x32_bf16 v[236:239], v[116:119], v[140:143], v[236:239]
    v_exp_f32 v60, v78
    v_exp_f32 v61, v79
    v_mfma_f32_16x16x32_bf16 v[232:235], v[116:119], v[136:139], v[232:235]
    ds_read_b128 v[116:119], v48 offset:37888
    v_cvt_pk_bf16_f32 v135, v60, v61
    v_mfma_f32_16x16x32_bf16 v[240:243], v[120:123], v[136:139], v[240:243]
    v_or3_b32 v62, v128, v129, v132
    v_or3_b32 v62, v62, v133, v130
    v_or3_b32 v62, v62, v131, v134
    v_bitop3_b32 v62, v62, v135, s72 bitop3:0xa8
    v_cmp_ne_u32 vcc, s65, v62
    v_mfma_f32_16x16x32_bf16 v[244:247], v[120:123], v[140:143], v[244:247]
    ds_read_b128 v[120:123], v48 offset:38912
    v_mfma_f32_16x16x32_bf16 v[252:255], v[124:127], v[140:143], v[252:255]
    s_waitcnt lgkmcnt(6)
    v_mfma_f32_16x16x32_bf16 v[248:251], v[124:127], v[136:139], v[248:251]
    ds_read_b128 v[124:127], v48 offset:39936
    s_cbranch_vccnz L_back_20_h
L_back_20:
L_pv0:
    v_mfma_f32_16x16x32_bf16 v[192:195], v[96:99], v[128:131], v[192:195]
    s_waitcnt lgkmcnt(6)
    v_mfma_f32_16x16x32_bf16 v[196:199], v[96:99], v[132:135], v[196:199]
    v_mfma_f32_16x16x32_bf16 v[204:207], v[100:103], v[132:135], v[204:207]
    v_mfma_f32_16x16x32_bf16 v[200:203], v[100:103], v[128:131], v[200:203]
    v_mfma_f32_16x16x32_bf16 v[160:163], v[168:171], v[128:131], v[160:163]
    s_waitcnt lgkmcnt(5)
    v_mfma_f32_16x16x32_bf16 v[164:167], v[168:171], v[132:135], v[164:167]
    v_mfma_f32_16x16x32_bf16 v[208:211], v[104:107], v[128:131], v[208:211]
    s_waitcnt lgkmcnt(4)
    v_mfma_f32_16x16x32_bf16 v[212:215], v[104:107], v[132:135], v[212:215]
    v_mfma_f32_16x16x32_bf16 v[220:223], v[108:111], v[132:135], v[220:223]
    s_waitcnt lgkmcnt(3)
    v_mfma_f32_16x16x32_bf16 v[216:219], v[108:111], v[128:131], v[216:219]
    v_mfma_f32_16x16x32_bf16 v[224:227], v[112:115], v[128:131], v[224:227]
    s_waitcnt lgkmcnt(2)
    v_mfma_f32_16x16x32_bf16 v[228:231], v[112:115], v[132:135], v[228:231]
    v_mfma_f32_16x16x32_bf16 v[236:239], v[116:119], v[132:135], v[236:239]
    s_waitcnt lgkmcnt(1)
    v_mfma_f32_16x16x32_bf16 v[232:235], v[116:119], v[128:131], v[232:235]
    v_mfma_f32_16x16x32_bf16 v[240:243], v[120:123], v[128:131], v[240:243]
    s_waitcnt lgkmcnt(0)
    v_mfma_f32_16x16x32_bf16 v[244:247], v[120:123], v[132:135], v[244:247]
    v_mfma_f32_16x16x32_bf16 v[252:255], v[124:127], v[132:135], v[252:255]
    v_mfma_f32_16x16x32_bf16 v[248:251], v[124:127], v[128:131], v[248:251]
L_fin:
    v_and_b32 v3, 7, v1
    v_lshlrev_b32 v3, 2, v3
    s_mov_b32 s72, 0x3a0000
    buffer_load_dword v51, v3, s[8:11], s72 offen sc1
    v_rcp_f32 v56, v160
    v_rcp_f32 v57, v164
    s_lshl_b32 s6, s60, 18
    s_lshl_b32 s7, s4, 12
    s_add_u32 s6, s6, s7
    s_add_u32 s6, s6, 50331648
    s_nop 4
    v_mul_f32 v192, v56, v192
    v_mul_f32 v193, v56, v193
    v_mul_f32 v194, v56, v194
    v_mul_f32 v195, v56, v195
    v_cvt_pk_bf16_f32 v16, v192, v193
    v_cvt_pk_bf16_f32 v17, v194, v195
    v_mul_f32 v200, v56, v200
    v_mul_f32 v201, v56, v201
    v_mul_f32 v202, v56, v202
    v_mul_f32 v203, v56, v203
    v_cvt_pk_bf16_f32 v18, v200, v201
    v_cvt_pk_bf16_f32 v19, v202, v203
    buffer_store_dwordx4 v[16:19], v13, s[8:11], s6 offen offset:0 sc1
    v_mul_f32 v208, v56, v208
    v_mul_f32 v209, v56, v209
    v_mul_f32 v210, v56, v210
    v_mul_f32 v211, v56, v211
    v_cvt_pk_bf16_f32 v20, v208, v209
    v_cvt_pk_bf16_f32 v21, v210, v211
    v_mul_f32 v216, v56, v216
    v_mul_f32 v217, v56, v217
    v_mul_f32 v218, v56, v218
    v_mul_f32 v219, v56, v219
    v_cvt_pk_bf16_f32 v22, v216, v217
    v_cvt_pk_bf16_f32 v23, v218, v219
    buffer_store_dwordx4 v[20:23], v13, s[8:11], s6 offen offset:1024 sc1
    v_mul_f32 v224, v56, v224
    v_mul_f32 v225, v56, v225
    v_mul_f32 v226, v56, v226
    v_mul_f32 v227, v56, v227
    v_cvt_pk_bf16_f32 v24, v224, v225
    v_cvt_pk_bf16_f32 v25, v226, v227
    v_mul_f32 v232, v56, v232
    v_mul_f32 v233, v56, v233
    v_mul_f32 v234, v56, v234
    v_mul_f32 v235, v56, v235
    v_cvt_pk_bf16_f32 v26, v232, v233
    v_cvt_pk_bf16_f32 v27, v234, v235
    buffer_store_dwordx4 v[24:27], v13, s[8:11], s6 offen offset:2048 sc1
    v_mul_f32 v240, v56, v240
    v_mul_f32 v241, v56, v241
    v_mul_f32 v242, v56, v242
    v_mul_f32 v243, v56, v243
    v_cvt_pk_bf16_f32 v28, v240, v241
    v_cvt_pk_bf16_f32 v29, v242, v243
    v_mul_f32 v248, v56, v248
    v_mul_f32 v249, v56, v249
    v_mul_f32 v250, v56, v250
    v_mul_f32 v251, v56, v251
    v_cvt_pk_bf16_f32 v30, v248, v249
    v_cvt_pk_bf16_f32 v31, v250, v251
    buffer_store_dwordx4 v[28:31], v13, s[8:11], s6 offen offset:3072 sc1
    s_add_u32 s6, s6, 0x20000
    v_mul_f32 v196, v57, v196
    v_mul_f32 v197, v57, v197
    v_mul_f32 v198, v57, v198
    v_mul_f32 v199, v57, v199
    v_cvt_pk_bf16_f32 v32, v196, v197
    v_cvt_pk_bf16_f32 v33, v198, v199
    v_mul_f32 v204, v57, v204
    v_mul_f32 v205, v57, v205
    v_mul_f32 v206, v57, v206
    v_mul_f32 v207, v57, v207
    v_cvt_pk_bf16_f32 v34, v204, v205
    v_cvt_pk_bf16_f32 v35, v206, v207
    buffer_store_dwordx4 v[32:35], v13, s[8:11], s6 offen offset:0 sc1
    v_mul_f32 v212, v57, v212
    v_mul_f32 v213, v57, v213
    v_mul_f32 v214, v57, v214
    v_mul_f32 v215, v57, v215
    v_cvt_pk_bf16_f32 v36, v212, v213
    v_cvt_pk_bf16_f32 v37, v214, v215
    v_mul_f32 v220, v57, v220
    v_mul_f32 v221, v57, v221
    v_mul_f32 v222, v57, v222
    v_mul_f32 v223, v57, v223
    v_cvt_pk_bf16_f32 v38, v220, v221
    v_cvt_pk_bf16_f32 v39, v222, v223
    buffer_store_dwordx4 v[36:39], v13, s[8:11], s6 offen offset:1024 sc1
    v_mul_f32 v228, v57, v228
    v_mul_f32 v229, v57, v229
    v_mul_f32 v230, v57, v230
    v_mul_f32 v231, v57, v231
    v_cvt_pk_bf16_f32 v40, v228, v229
    v_cvt_pk_bf16_f32 v41, v230, v231
    v_mul_f32 v236, v57, v236
    v_mul_f32 v237, v57, v237
    v_mul_f32 v238, v57, v238
    v_mul_f32 v239, v57, v239
    v_cvt_pk_bf16_f32 v42, v236, v237
    v_cvt_pk_bf16_f32 v43, v238, v239
    buffer_store_dwordx4 v[40:43], v13, s[8:11], s6 offen offset:2048 sc1
    v_mul_f32 v244, v57, v244
    v_mul_f32 v245, v57, v245
    v_mul_f32 v246, v57, v246
    v_mul_f32 v247, v57, v247
    v_cvt_pk_bf16_f32 v44, v244, v245
    v_cvt_pk_bf16_f32 v45, v246, v247
    v_mul_f32 v252, v57, v252
    v_mul_f32 v253, v57, v253
    v_mul_f32 v254, v57, v254
    v_mul_f32 v255, v57, v255
    v_cvt_pk_bf16_f32 v46, v252, v253
    v_cvt_pk_bf16_f32 v47, v254, v255
    buffer_store_dwordx4 v[44:47], v13, s[8:11], s6 offen offset:3072 sc1
    s_cmp_gt_i32 s62, s63
    s_cbranch_scc1 L_pre
    s_waitcnt vmcnt(8)
    s_call_b64 s[82:83], L_pend
    s_barrier
    s_waitcnt vmcnt(0)
    s_lshl_b32 s6, s60, 5
    s_add_u32 s6, s6, s4
    s_lshl_b32 s6, s6, 7
    s_add_u32 s6, s6, 3932160
    v_mov_b32 v2, 1
    v_mov_b32 v3, 0x5000000
    v_writelane_b32 v3, s6, 0
    buffer_store_dword v2, v3, s[8:11], 0 offen sc1
    s_call_b64 s[82:83], L_load
    s_add_i32 s62, s62, 1
    s_lshl_b32 s6, s3, 8
    s_add_u32 s6, s6, s2
    s_cmp_eq_u32 s6, 31
    s_cbranch_scc1 L_top
L_idle:
    s_sub_i32 s6, s63, 5
    s_cmp_gt_i32 s62, s6
    s_cbranch_scc1 L_pre
    s_waitcnt vmcnt(0) lgkmcnt(0)
    s_call_b64 s[82:83], L_pend
    s_barrier
    s_call_b64 s[82:83], L_load
    s_add_i32 s62, s62, 1
    s_cmp_lt_u32 s61, 54
    s_cbranch_scc1 L_moe
    s_branch L_idle
L_pre:
    s_cmp_lt_u32 s3, 4
    s_cbranch_scc1 L_pre1
    s_add_u32 s6, s76, 0
    s_and_b32 s6, s6, 3
    s_lshl_b32 s6, s6, 10
    v_add_u32 v44, s6, v13
    s_add_u32 s6, s76, 1
    s_and_b32 s6, s6, 3
    s_lshl_b32 s6, s6, 10
    v_add_u32 v45, s6, v13
    s_add_u32 s6, s76, 2
    s_and_b32 s6, s6, 3
    s_lshl_b32 s6, s6, 10
    v_add_u32 v46, s6, v13
    s_add_u32 s6, s76, 3
    s_and_b32 s6, s6, 3
    s_lshl_b32 s6, s6, 10
    v_add_u32 v47, s6, v13
    v_add_u32 v52, 4096, v13
    s_lshr_b32 s69, s4, 3
    s_lshl_b32 s69, s69, 2
    s_add_u32 s69, s69, s76
    s_mul_i32 s69, s69, 327680
    s_and_b32 s7, s4, 3
    s_mul_i32 s7, s7, 10240
    s_add_u32 s69, s69, s7
    s_add_u32 s69, s69, 4199424
    s_and_b32 s6, s4, 4
    s_lshr_b32 s7, s4, 3
    s_add_u32 s6, s6, s7
    s_lshl_b32 s7, s5, 3
    s_add_u32 s68, s6, s7
    s_sub_u32 s7, 120, s7
    s_add_u32 s61, s6, s7
    s_waitcnt vmcnt(8)
    v_cmp_le_i32 vcc, 0, v51
    s_cbranch_vccz L_idx_okb
    v_and_b32 v3, 7, v1
    v_lshlrev_b32 v3, 2, v3
    s_mov_b32 s72, 0x3a0000
    s_mov_b32 s79, 262144
L_poll_23:
    buffer_load_dword v51, v3, s[8:11], s72 offen sc1
    s_waitcnt vmcnt(0)
    v_cmp_le_i32 vcc, 0, v51
    s_cbranch_vccz L_polldone_24
    s_sleep 2
    s_sub_u32 s79, s79, 1
    s_cmp_lg_u32 s79, 0
    s_cbranch_scc1 L_poll_23
L_polldone_24:
L_idx_okb:
    s_call_b64 s[80:81], L_oprep
    s_mov_b32 s6, 0x10000
    s_lshl_b32 s7, s76, 12
    s_add_u32 s7, s7, s6
    v_add_u32 v12, s7, v13
    s_lshl_b32 s7, s76, 13
    s_add_u32 s6, s6, s7
    v_add_u32 v3, s6, v13
    s_add_u32 s7, s7, 131072
    v_add_u32 v2, s7, v13
    s_barrier
    s_add_u32 s75, s69, 163840
    buffer_load_dwordx4 v[176:179], v44, s[8:11], s75 offen sc1
    buffer_load_dwordx4 v[180:183], v45, s[8:11], s75 offen sc1
    buffer_load_dwordx4 v[184:187], v46, s[8:11], s75 offen sc1
    buffer_load_dwordx4 v[188:191], v47, s[8:11], s75 offen sc1
    buffer_load_dwordx4 v[192:195], v52, s[8:11], s75 offen sc1
    ds_read_b128 v[96:99], v2 offset:0
    ds_read_b128 v[100:103], v2 offset:1024
    ds_read_b128 v[104:107], v2 offset:2048
    ds_read_b128 v[108:111], v2 offset:3072
    ds_read_b128 v[112:115], v2 offset:4096
    ds_read_b128 v[116:119], v2 offset:5120
    ds_read_b128 v[120:123], v2 offset:6144
    ds_read_b128 v[124:127], v2 offset:7168
    s_waitcnt lgkmcnt(6)
    ds_read_b128 v[128:131], v3 offset:0
    ds_read_b128 v[132:135], v3 offset:1024
    ds_read_b128 v[136:139], v3 offset:2048
    ds_read_b128 v[140:143], v3 offset:3072
    ds_read_b128 v[144:147], v3 offset:4096
    ds_read_b128 v[148:151], v3 offset:5120
    ds_read_b128 v[152:155], v3 offset:6144
    ds_read_b128 v[156:159], v3 offset:7168
    s_waitcnt lgkmcnt(6)
    ds_read_b128 v[160:163], v12 offset:49152
    ds_read_b128 v[164:167], v12 offset:50176
    ds_read_b128 v[168:171], v12 offset:51200
    ds_read_b128 v[172:175], v12 offset:52224
    s_waitcnt vmcnt(5)
    s_lshl_b32 s6, s60, 5
    s_add_u32 s6, s6, s4
    s_lshl_b32 s6, s6, 7
    s_add_u32 s6, s6, 3932160
    v_mov_b32 v2, 1
    v_mov_b32 v3, 0x5000000
    v_writelane_b32 v3, s6, 0
    buffer_store_dword v2, v3, s[8:11], 0 offen sc1
    s_waitcnt lgkmcnt(0)
    s_branch L_adone
L_oprep:
    s_add_u32 s6, s76, 0
    s_and_b32 s6, s6, 3
    s_lshl_b32 s6, s6, 10
    v_add_u32 v44, s6, v13
    s_add_u32 s6, s76, 1
    s_and_b32 s6, s6, 3
    s_lshl_b32 s6, s6, 10
    v_add_u32 v45, s6, v13
    s_add_u32 s6, s76, 2
    s_and_b32 s6, s6, 3
    s_lshl_b32 s6, s6, 10
    v_add_u32 v46, s6, v13
    s_add_u32 s6, s76, 3
    s_and_b32 s6, s6, 3
    s_lshl_b32 s6, s6, 10
    v_add_u32 v47, s6, v13
    v_add_u32 v52, 4096, v13
    s_lshr_b32 s6, s3, 2
    s_lshl_b32 s6, s6, 1
    s_sub_u32 s71, s76, s6
    s_and_b32 s71, s71, 3
    s_lshr_b32 s6, s4, 3
    s_lshl_b32 s6, s6, 15
    s_lshl_b32 s99, s3, 12
    s_add_u32 s66, s6, s99
    s_add_u32 s66, s66, 50331648
    s_lshl_b32 s6, s76, 13
    v_add_u32 v4, s6, v13
    v_add_u32 v7, 65536, v4
    s_lshr_b32 s6, s3, 2
    s_mul_i32 s67, s6, 15360
    s_add_u32 s67, s67, 98304
    v_add_u32 v6, s67, v44
    v_mov_b32 v11, 0x5000000
    s_and_b32 s63, s4, 7
    s_lshl_b32 s7, s5, 3
    s_add_u32 s63, s63, s7
    s_lshl_b32 s63, s63, 2
    s_lshr_b32 s7, s4, 3
    s_add_u32 s63, s63, s7
    s_mul_i32 s62, s63, 61440
    s_add_u32 s62, s62, 67108864
    s_mul_i32 s63, s63, 384
    s_add_u32 s63, s63, 15728640
    s_and_b32 s96, s4, 7
    s_lshl_b32 s7, s5, 3
    s_add_u32 s96, s96, s7
    s_lshr_b32 s7, s4, 3
    s_add_u32 s7, s7, 0
    s_add_u32 s7, s7, 1
    s_and_b32 s7, s7, 3
    s_lshl_b32 s96, s96, 2
    s_add_u32 s96, s96, s7
    s_mul_i32 s96, s96, 3
    s_add_u32 s96, s96, 0
    s_lshl_b32 s6, s96, 5
    s_add_u32 s6, s6, s3
    s_lshl_b32 s6, s6, 2
    s_add_u32 s6, s6, 15728640
    v_writelane_b32 v11, s6, 0
    s_mul_i32 s96, s96, 20480
    s_lshr_b32 s6, s3, 2
    s_mul_i32 s6, s6, 5120
    s_add_u32 s96, s96, s6
    s_add_u32 s96, s96, 67108864
    s_and_b32 s97, s4, 7
    s_lshl_b32 s7, s5, 3
    s_add_u32 s97, s97, s7
    s_lshr_b32 s7, s4, 3
    s_add_u32 s7, s7, 1
    s_add_u32 s7, s7, 1
    s_and_b32 s7, s7, 3
    s_lshl_b32 s97, s97, 2
    s_add_u32 s97, s97, s7
    s_mul_i32 s97, s97, 3
    s_add_u32 s97, s97, 1
    s_lshl_b32 s6, s97, 5
    s_add_u32 s6, s6, s3
    s_lshl_b32 s6, s6, 2
    s_add_u32 s6, s6, 15728640
    v_writelane_b32 v11, s6, 1
    s_mul_i32 s97, s97, 20480
    s_lshr_b32 s6, s3, 2
    s_mul_i32 s6, s6, 5120
    s_add_u32 s97, s97, s6
    s_add_u32 s97, s97, 67108864
    s_and_b32 s98, s4, 7
    s_lshl_b32 s7, s5, 3
    s_add_u32 s98, s98, s7
    s_lshr_b32 s7, s4, 3
    s_add_u32 s7, s7, 2
    s_add_u32 s7, s7, 1
    s_and_b32 s7, s7, 3
    s_lshl_b32 s98, s98, 2
    s_add_u32 s98, s98, s7
    s_mul_i32 s98, s98, 3
    s_add_u32 s98, s98, 2
    s_lshl_b32 s6, s98, 5
    s_add_u32 s6, s6, s3
    s_lshl_b32 s6, s6, 2
    s_add_u32 s6, s6, 15728640
    v_writelane_b32 v11, s6, 2
    s_mul_i32 s98, s98, 20480
    s_lshr_b32 s6, s3, 2
    s_mul_i32 s6, s6, 5120
    s_add_u32 s98, s98, s6
    s_add_u32 s98, s98, 67108864
    s_mov_b32 s12, s32
    s_mov_b32 s13, s33
    s_mov_b32 s14, 0x280000
    s_mov_b32 s15, 0x20000
    s_and_b32 s75, s4, 3
    s_mul_i32 s70, s75, 320
    s_add_u32 s73, s70, 3837952
    s_mul_i32 s72, s75, 5120
    v_lshrrev_b32 v2, 4, v1
    v_and_b32 v3, 15, v1
    v_mul_u32_u24 v54, 1280, v3
    v_lshl_add_u32 v54, v2, 4, v54
    v_lshlrev_b32 v3, 4, v3
    v_lshl_add_u32 v9, v2, 9, v3
    s_lshr_b32 s100, s3, 2
    s_cselect_b32 s6, s61, s68
    s_mul_i32 s6, s6, 20480
    s_lshl_b32 s7, s76, 6
    s_add_u32 s7, s7, s6
    v_add_u32 v53, s7, v54
    s_lshl_b32 s7, s76, 10
    s_add_u32 s7, s7, s6
    s_add_u32 s7, s7, s72
    v_add_u32 v48, s7, v13
    s_mul_i32 s6, s100, 10240
    s_lshl_b32 s7, s76, 11
    s_add_u32 s6, s6, s7
    v_add_u32 v8, s6, v9
    s_mul_i32 s6, s100, 75776
    s_sub_u32 s6, 65536, s6
    v_add_u32 v10, s6, v8
    s_lshl_b32 s7, s76, 2
    v_add_u32 v2, s7, v2
    v_cmp_lt_u32 vcc, 9, v2
    s_mul_i32 s6, s100, 86016
    s_add_u32 s6, s6, 15360
    v_add_u32 v3, s6, v10
    v_cndmask_b32 v10, v10, v3, vcc
    s_and_b32 s100, s3, 1
    s_cselect_b32 s6, s61, s68
    s_mul_i32 s6, s6, 20480
    s_add_u32 s7, s6, 256
    v_add_u32 v54, s7, v54
    s_add_u32 s7, s6, s72
    s_add_u32 s7, s7, 4096
    v_add_u32 v49, s7, v13
    s_mul_i32 s6, s100, 10240
    s_add_u32 s6, s6, 8192
    v_add_u32 v9, s6, v9
    s_mul_i32 s6, s100, 10240
    s_add_u32 s6, s6, 80896
    v_add_u32 v55, s6, v9
    s_mov_b32 s64, 0
    v_and_b32 v2, 0x7ff, v51
    v_sub_u32 v2, 0x7ff, v2
    v_lshrrev_b32 v3, 4, v2
    v_cmp_eq_u32 vcc, s68, v3
    v_cmp_eq_u32 s[74:75], s61, v3
    s_nop 3
    s_or_b64 vcc, vcc, s[74:75]
    s_cbranch_scc0 L_notok_25
    v_readlane_b32 s84, v2, 0
    v_readlane_b32 s85, v2, 1
    v_readlane_b32 s86, v2, 2
    v_readlane_b32 s87, v2, 3
    v_readlane_b32 s88, v2, 4
    v_readlane_b32 s65, v2, 5
    v_readlane_b32 s91, v2, 6
    v_readlane_b32 s101, v2, 7
    s_lshl_b32 s7, s76, 6
    s_lshr_b32 s100, s3, 2
    s_cselect_b32 s6, s61, s68
    s_lshl_b32 s6, s6, 4
    v_and_b32 v2, 15, v1
    v_add_u32 v2, s6, v2
    s_add_u32 s7, s7, s73
    v_and_b32 v3, 48, v1
    v_add_u32 v3, s7, v3
    v_cmp_eq_u32 vcc, s84, v2
    s_nop 1
    v_cndmask_b32 v48, v48, v3, vcc
    v_add_u32 v3, 1280, v3
    v_cmp_eq_u32 vcc, s85, v2
    s_nop 1
    v_cndmask_b32 v48, v48, v3, vcc
    v_add_u32 v3, 1280, v3
    v_cmp_eq_u32 vcc, s86, v2
    s_nop 1
    v_cndmask_b32 v48, v48, v3, vcc
    v_add_u32 v3, 1280, v3
    v_cmp_eq_u32 vcc, s87, v2
    s_nop 1
    v_cndmask_b32 v48, v48, v3, vcc
    v_add_u32 v3, 1280, v3
    v_cmp_eq_u32 vcc, s88, v2
    s_nop 1
    v_cndmask_b32 v48, v48, v3, vcc
    v_add_u32 v3, 1280, v3
    v_cmp_eq_u32 vcc, s65, v2
    s_nop 1
    v_cndmask_b32 v48, v48, v3, vcc
    v_add_u32 v3, 1280, v3
    v_cmp_eq_u32 vcc, s91, v2
    s_nop 1
    v_cndmask_b32 v48, v48, v3, vcc
    v_add_u32 v3, 1280, v3
    v_cmp_eq_u32 vcc, s101, v2
    s_nop 1
    v_cndmask_b32 v48, v48, v3, vcc
    s_movk_i32 s7, 256
    s_and_b32 s100, s3, 1
    s_cselect_b32 s6, s61, s68
    s_lshl_b32 s6, s6, 4
    v_and_b32 v2, 15, v1
    v_add_u32 v2, s6, v2
    s_add_u32 s7, s7, s73
    v_and_b32 v3, 48, v1
    v_add_u32 v3, s7, v3
    v_cmp_eq_u32 vcc, s84, v2
    s_nop 1
    v_cndmask_b32 v49, v49, v3, vcc
    v_add_u32 v3, 1280, v3
    v_cmp_eq_u32 vcc, s85, v2
    s_nop 1
    v_cndmask_b32 v49, v49, v3, vcc
    v_add_u32 v3, 1280, v3
    v_cmp_eq_u32 vcc, s86, v2
    s_nop 1
    v_cndmask_b32 v49, v49, v3, vcc
    v_add_u32 v3, 1280, v3
    v_cmp_eq_u32 vcc, s87, v2
    s_nop 1
    v_cndmask_b32 v49, v49, v3, vcc
    v_add_u32 v3, 1280, v3
    v_cmp_eq_u32 vcc, s88, v2
    s_nop 1
    v_cndmask_b32 v49, v49, v3, vcc
    v_add_u32 v3, 1280, v3
    v_cmp_eq_u32 vcc, s65, v2
    s_nop 1
    v_cndmask_b32 v49, v49, v3, vcc
    v_add_u32 v3, 1280, v3
    v_cmp_eq_u32 vcc, s91, v2
    s_nop 1
    v_cndmask_b32 v49, v49, v3, vcc
    v_add_u32 v3, 1280, v3
    v_cmp_eq_u32 vcc, s101, v2
    s_nop 1
    v_cndmask_b32 v49, v49, v3, vcc
    s_mov_b32 s64, 1
L_notok_25:
    s_setpc_b64 s[80:81]
L_pre1:
    s_mov_b32 s28, s56
    s_mov_b32 s29, s57
    s_mov_b32 s30, 0x100
    s_mov_b32 s31, 0x20000
    v_and_b32 v3, 31, v1
    v_lshlrev_b32 v3, 2, v3
    s_mov_b32 s79, 262144
L_poll_26:
    buffer_load_dword v2, v3, s[28:31], 0 offen offset:128 sc1
    s_waitcnt vmcnt(0)
    v_cmp_gt_u32 vcc, 4, v2
    s_cbranch_vccz L_polldone_27
    s_sleep 8
    s_sub_u32 s79, s79, 1
    s_cmp_lg_u32 s79, 0
    s_cbranch_scc1 L_poll_26
L_polldone_27:
    s_mov_b32 s90, 1
    v_and_b32 v3, 7, v1
    v_lshlrev_b32 v3, 2, v3
    s_mov_b32 s72, 0x3a0000
    buffer_load_dword v51, v3, s[8:11], s72 offen sc1
    s_add_u32 s6, s76, 0
    s_and_b32 s6, s6, 3
    s_lshl_b32 s6, s6, 10
    v_add_u32 v44, s6, v13
    s_add_u32 s6, s76, 1
    s_and_b32 s6, s6, 3
    s_lshl_b32 s6, s6, 10
    v_add_u32 v45, s6, v13
    s_add_u32 s6, s76, 2
    s_and_b32 s6, s6, 3
    s_lshl_b32 s6, s6, 10
    v_add_u32 v46, s6, v13
    s_add_u32 s6, s76, 3
    s_and_b32 s6, s6, 3
    s_lshl_b32 s6, s6, 10
    v_add_u32 v47, s6, v13
    v_add_u32 v52, 4096, v13
    s_lshr_b32 s69, s4, 3
    s_lshl_b32 s69, s69, 2
    s_add_u32 s69, s69, s76
    s_mul_i32 s69, s69, 327680
    s_and_b32 s7, s4, 3
    s_mul_i32 s7, s7, 10240
    s_add_u32 s69, s69, s7
    s_add_u32 s69, s69, 4194304
    s_and_b32 s6, s4, 4
    s_lshr_b32 s7, s4, 3
    s_add_u32 s6, s6, s7
    s_lshl_b32 s7, s5, 3
    s_add_u32 s68, s6, s7
    s_sub_u32 s7, 120, s7
    s_add_u32 s61, s6, s7
    s_add_u32 s75, s69, 0
    buffer_load_dwordx4 v[96:99], v44, s[8:11], s75 offen sc1
    buffer_load_dwordx4 v[100:103], v45, s[8:11], s75 offen sc1
    buffer_load_dwordx4 v[104:107], v46, s[8:11], s75 offen sc1
    buffer_load_dwordx4 v[108:111], v47, s[8:11], s75 offen sc1
    buffer_load_dwordx4 v[112:115], v52, s[8:11], s75 offen sc1
    s_add_u32 s75, s69, 40960
    buffer_load_dwordx4 v[116:119], v44, s[8:11], s75 offen sc1
    buffer_load_dwordx4 v[120:123], v45, s[8:11], s75 offen sc1
    buffer_load_dwordx4 v[124:127], v46, s[8:11], s75 offen sc1
    buffer_load_dwordx4 v[128:131], v47, s[8:11], s75 offen sc1
    buffer_load_dwordx4 v[132:135], v52, s[8:11], s75 offen sc1
    s_cmp_gt_i32 s62, s63
    s_cbranch_scc1 L_e2
    s_cmp_eq_i32 s62, s63
    s_cbranch_scc1 L_lw0
    s_waitcnt vmcnt(11)
L_lw0:
    s_waitcnt vmcnt(20)
    s_call_b64 s[82:83], L_pend
    s_barrier
    s_call_b64 s[82:83], L_load
    s_add_i32 s62, s62, 1
L_e2:
    s_add_u32 s75, s69, 81920
    buffer_load_dwordx4 v[136:139], v44, s[8:11], s75 offen sc1
    buffer_load_dwordx4 v[140:143], v45, s[8:11], s75 offen sc1
    buffer_load_dwordx4 v[144:147], v46, s[8:11], s75 offen sc1
    buffer_load_dwordx4 v[148:151], v47, s[8:11], s75 offen sc1
    buffer_load_dwordx4 v[152:155], v52, s[8:11], s75 offen sc1
    s_add_u32 s75, s69, 122880
    buffer_load_dwordx4 v[156:159], v44, s[8:11], s75 offen sc1
    buffer_load_dwordx4 v[160:163], v45, s[8:11], s75 offen sc1
    buffer_load_dwordx4 v[164:167], v46, s[8:11], s75 offen sc1
    buffer_load_dwordx4 v[168:171], v47, s[8:11], s75 offen sc1
    buffer_load_dwordx4 v[172:175], v52, s[8:11], s75 offen sc1
    s_cmp_gt_i32 s62, s63
    s_cbranch_scc1 L_e3
    s_cmp_eq_i32 s62, s63
    s_cbranch_scc1 L_lw1
    s_waitcnt vmcnt(10)
L_lw1:
    s_waitcnt vmcnt(20)
    s_call_b64 s[82:83], L_pend
    s_barrier
    s_call_b64 s[82:83], L_load
    s_add_i32 s62, s62, 1
L_e3:
    s_add_u32 s75, s69, 163840
    buffer_load_dwordx4 v[176:179], v44, s[8:11], s75 offen sc1
    buffer_load_dwordx4 v[180:183], v45, s[8:11], s75 offen sc1
    buffer_load_dwordx4 v[184:187], v46, s[8:11], s75 offen sc1
    buffer_load_dwordx4 v[188:191], v47, s[8:11], s75 offen sc1
    buffer_load_dwordx4 v[192:195], v52, s[8:11], s75 offen sc1
    s_add_u32 s75, s69, 204800
    buffer_load_dwordx4 v[196:199], v44, s[8:11], s75 offen sc1
    buffer_load_dwordx4 v[200:203], v45, s[8:11], s75 offen sc1
    buffer_load_dwordx4 v[204:207], v46, s[8:11], s75 offen sc1
    buffer_load_dwordx4 v[208:211], v47, s[8:11], s75 offen sc1
    buffer_load_dwordx4 v[212:215], v52, s[8:11], s75 offen sc1
    s_cmp_gt_i32 s62, s63
    s_cbranch_scc1 L_e4
    s_cmp_eq_i32 s62, s63
    s_cbranch_scc1 L_lw2
    s_waitcnt vmcnt(10)
L_lw2:
    s_waitcnt vmcnt(20)
    s_call_b64 s[82:83], L_pend
    s_barrier
    s_call_b64 s[82:83], L_load
    s_add_i32 s62, s62, 1
L_e4:
    s_add_u32 s75, s69, 245760
    buffer_load_dwordx4 v[216:219], v44, s[8:11], s75 offen sc1
    buffer_load_dwordx4 v[220:223], v45, s[8:11], s75 offen sc1
    buffer_load_dwordx4 v[224:227], v46, s[8:11], s75 offen sc1
    buffer_load_dwordx4 v[228:231], v47, s[8:11], s75 offen sc1
    buffer_load_dwordx4 v[232:235], v52, s[8:11], s75 offen sc1
    s_add_u32 s75, s69, 286720
    buffer_load_dwordx4 v[236:239], v44, s[8:11], s75 offen sc1
    buffer_load_dwordx4 v[240:243], v45, s[8:11], s75 offen sc1
    buffer_load_dwordx4 v[244:247], v46, s[8:11], s75 offen sc1
    buffer_load_dwordx4 v[248:251], v47, s[8:11], s75 offen sc1
    buffer_load_dwordx4 v[252:255], v52, s[8:11], s75 offen sc1
    s_cmp_gt_i32 s62, s63
    s_cbranch_scc1 L_e5
    s_cmp_eq_i32 s62, s63
    s_cbranch_scc1 L_lw3
    s_waitcnt vmcnt(10)
L_lw3:
    s_waitcnt vmcnt(20)
    s_call_b64 s[82:83], L_pend
    s_barrier
    s_call_b64 s[82:83], L_load
    s_add_i32 s62, s62, 1
L_e5:
    v_and_b32 v3, 1, v1
    v_lshlrev_b32 v3, 12, v3
    v_and_b32 v2, 2, v1
    v_lshl_add_u32 v3, v2, 8, v3
    s_lshr_b32 s72, s68, 2
    s_lshl_b32 s72, s72, 6
    s_andn2_b32 s6, s4, 7
    s_add_u32 s72, s72, s6
    s_add_u32 s72, s72, s3
    s_lshl_b32 s72, s72, 7
    s_add_u32 s72, s72, 3932160
    buffer_load_dword v50, v3, s[8:11], s72 offen sc1
    s_cmp_gt_i32 s62, s63
    s_cbranch_scc1 L_e6
    s_waitcnt vmcnt(20)
    s_call_b64 s[82:83], L_pend
    s_barrier
    s_call_b64 s[82:83], L_load
    s_add_i32 s62, s62, 1
L_e6:
    s_waitcnt vmcnt(20)
    v_cmp_le_i32 vcc, 0, v51
    s_cbranch_vccz L_idx_oka
    v_and_b32 v3, 7, v1
    v_lshlrev_b32 v3, 2, v3
    s_mov_b32 s72, 0x3a0000
    s_mov_b32 s79, 262144
L_poll_33:
    buffer_load_dword v51, v3, s[8:11], s72 offen sc1
    s_waitcnt vmcnt(0)
    v_cmp_le_i32 vcc, 0, v51
    s_cbranch_vccz L_polldone_34
    s_sleep 2
    s_sub_u32 s79, s79, 1
    s_cmp_lg_u32 s79, 0
    s_cbranch_scc1 L_poll_33
L_polldone_34:
L_idx_oka:
    s_lshr_b32 s7, s3, 1
    s_lshl_b32 s7, s7, 4
    s_add_u32 s6, s5, s7
    s_cmp_lg_u32 s6, 3
    s_cbranch_scc1 L_yd
    s_lshr_b32 s87, s4, 2
    s_and_b32 s88, s4, 3
    s_lshl_b32 s88, s88, 1
    s_add_u32 s88, s88, s3
    s_mov_b32 m0, s87
    s_nop 3
    v_readlane_b32 s85, v51, m0
    s_nop 3
    s_and_b32 s86, s85, 0x7ff
    s_sub_u32 s86, 0x7ff, s86
    v_min_u32 v3, 53, v1
    v_lshlrev_b32 v3, 7, v3
    s_mov_b32 s72, 0xf20000
    s_mov_b32 s79, 262144
L_poll_35:
    buffer_load_dwordx4 v[16:19], v3, s[8:11], s72 offen sc1
    s_waitcnt vmcnt(0)
    v_and_b32 v16, v16, v17
    v_and_b32 v16, v16, v18
    v_and_b32 v16, v16, v19
    v_cmp_ne_u32 vcc, 1, v16
    s_cbranch_vccz L_polldone_36
    s_sleep 16
    s_sub_u32 s79, s79, 1
    s_cmp_lg_u32 s79, 0
    s_cbranch_scc1 L_poll_35
L_polldone_36:
    v_mul_u32_u24 v2, 13, v1
    v_lshrrev_b32 v2, 8, v2
    v_mul_u32_u24 v3, 20, v2
    v_sub_u32 v4, v1, v3
    s_mov_b32 s6, 368640
    v_mul_lo_u32 v2, v2, s6
    v_lshl_add_u32 v2, v4, 4, v2
    v_cmp_lt_u32 vcc, 59, v1
    v_mov_b32 v3, 0x5000000
    s_nop 0
    v_cndmask_b32 v2, v2, v3, vcc
    s_mul_i32 s6, s87, 2560
    s_mul_i32 s7, s88, 320
    s_add_u32 s6, s6, s7
    s_add_u32 s6, s6, 2686976
    buffer_load_dwordx4 v[16:19], v2, s[8:11], s6 offen sc1
    s_add_u32 s6, s6, 20480
    buffer_load_dwordx4 v[20:23], v2, s[8:11], s6 offen sc1
    s_add_u32 s6, s6, 20480
    buffer_load_dwordx4 v[24:27], v2, s[8:11], s6 offen sc1
    s_add_u32 s6, s6, 20480
    buffer_load_dwordx4 v[28:31], v2, s[8:11], s6 offen sc1
    s_add_u32 s6, s6, 20480
    buffer_load_dwordx4 v[32:35], v2, s[8:11], s6 offen sc1
    s_add_u32 s6, s6, 20480
    buffer_load_dwordx4 v[36:39], v2, s[8:11], s6 offen sc1
    s_add_u32 s6, s6, 20480
    buffer_load_dwordx4 v[40:43], v2, s[8:11], s6 offen sc1
    s_add_u32 s6, s6, 20480
    buffer_load_dwordx4 v[44:47], v2, s[8:11], s6 offen sc1
    s_add_u32 s6, s6, 20480
    buffer_load_dwordx4 v[56:59], v2, s[8:11], s6 offen sc1
    s_add_u32 s6, s6, 20480
    buffer_load_dwordx4 v[60:63], v2, s[8:11], s6 offen sc1
    s_add_u32 s6, s6, 20480
    buffer_load_dwordx4 v[64:67], v2, s[8:11], s6 offen sc1
    s_add_u32 s6, s6, 20480
    buffer_load_dwordx4 v[68:71], v2, s[8:11], s6 offen sc1
    s_add_u32 s6, s6, 20480
    buffer_load_dwordx4 v[72:75], v2, s[8:11], s6 offen sc1
    s_add_u32 s6, s6, 20480
    buffer_load_dwordx4 v[76:79], v2, s[8:11], s6 offen sc1
    s_add_u32 s6, s6, 20480
    buffer_load_dwordx4 v[80:83], v2, s[8:11], s6 offen sc1
    s_add_u32 s6, s6, 20480
    buffer_load_dwordx4 v[84:87], v2, s[8:11], s6 offen sc1
    s_add_u32 s6, s6, 20480
    buffer_load_dwordx4 v[88:91], v2, s[8:11], s6 offen sc1
    s_add_u32 s6, s6, 20480
    buffer_load_dwordx4 v[92:95], v2, s[8:11], s6 offen sc1
    s_add_u32 s6, s6, 20480
    s_lshr_b32 s6, s86, 4
    s_mul_i32 s6, s6, 20480
    s_and_b32 s7, s86, 15
    s_lshl_b32 s7, s7, 4
    s_add_u32 s6, s6, s7
    s_mul_i32 s7, s88, 2560
    s_add_u32 s6, s6, s7
    v_lshrrev_b32 v5, 1, v4
    v_lshlrev_b32 v5, 8, v5
    v_and_b32 v6, 1, v4
    v_lshl_add_u32 v5, v6, 3, v5
    buffer_load_dwordx2 v[54:55], v5, s[8:11], s6 offen sc1
    s_bfe_u32 s6, s85, 0x10000b
    s_xor_b32 s7, s6, 0xffff
    s_bitcmp1_b32 s6, 15
    s_bitset0_b32 s6, 15
    s_cselect_b32 s6, s6, s7
    s_lshl_b32 s6, s6, 16
    v_mov_b32 v5, s6
    v_mul_f32 v5, 0xbfb8aa3b, v5
    v_exp_f32 v5, v5
    s_nop 0
    v_add_f32 v5, 1.0, v5
    v_rcp_f32 v5, v5
    s_nop 0
    v_cvt_pk_bf16_f32 v5, v5, v5
    v_lshlrev_b32 v5, 16, v5
    v_lshlrev_b32 v6, 2, v1
    s_waitcnt vmcnt(0)
    v_pk_add_f32 v[16:17], v[16:17], v[20:21]
    v_pk_add_f32 v[18:19], v[18:19], v[22:23]
    v_pk_add_f32 v[16:17], v[16:17], v[24:25]
    v_pk_add_f32 v[18:19], v[18:19], v[26:27]
    v_pk_add_f32 v[16:17], v[16:17], v[28:29]
    v_pk_add_f32 v[18:19], v[18:19], v[30:31]
    v_pk_add_f32 v[16:17], v[16:17], v[32:33]
    v_pk_add_f32 v[18:19], v[18:19], v[34:35]
    v_pk_add_f32 v[16:17], v[16:17], v[36:37]
    v_pk_add_f32 v[18:19], v[18:19], v[38:39]
    v_pk_add_f32 v[16:17], v[16:17], v[40:41]
    v_pk_add_f32 v[18:19], v[18:19], v[42:43]
    v_pk_add_f32 v[16:17], v[16:17], v[44:45]
    v_pk_add_f32 v[18:19], v[18:19], v[46:47]
    v_pk_add_f32 v[16:17], v[16:17], v[56:57]
    v_pk_add_f32 v[18:19], v[18:19], v[58:59]
    v_pk_add_f32 v[16:17], v[16:17], v[60:61]
    v_pk_add_f32 v[18:19], v[18:19], v[62:63]
    v_pk_add_f32 v[16:17], v[16:17], v[64:65]
    v_pk_add_f32 v[18:19], v[18:19], v[66:67]
    v_pk_add_f32 v[16:17], v[16:17], v[68:69]
    v_pk_add_f32 v[18:19], v[18:19], v[70:71]
    v_pk_add_f32 v[16:17], v[16:17], v[72:73]
    v_pk_add_f32 v[18:19], v[18:19], v[74:75]
    v_pk_add_f32 v[16:17], v[16:17], v[76:77]
    v_pk_add_f32 v[18:19], v[18:19], v[78:79]
    v_pk_add_f32 v[16:17], v[16:17], v[80:81]
    v_pk_add_f32 v[18:19], v[18:19], v[82:83]
    v_pk_add_f32 v[16:17], v[16:17], v[84:85]
    v_pk_add_f32 v[18:19], v[18:19], v[86:87]
    v_pk_add_f32 v[16:17], v[16:17], v[88:89]
    v_pk_add_f32 v[18:19], v[18:19], v[90:91]
    v_pk_add_f32 v[16:17], v[16:17], v[92:93]
    v_pk_add_f32 v[18:19], v[18:19], v[94:95]
    ds_bpermute_b32 v20, v6, v16 offset:80
    ds_bpermute_b32 v21, v6, v17 offset:80
    ds_bpermute_b32 v22, v6, v18 offset:80
    ds_bpermute_b32 v23, v6, v19 offset:80
    ds_bpermute_b32 v24, v6, v16 offset:160
    ds_bpermute_b32 v25, v6, v17 offset:160
    ds_bpermute_b32 v26, v6, v18 offset:160
    ds_bpermute_b32 v27, v6, v19 offset:160
    s_waitcnt lgkmcnt(0)
    v_add_f32 v16, v16, v20
    v_add_f32 v16, v16, v24
    v_cvt_pk_bf16_f32 v16, v16, v16
    v_lshlrev_b32 v16, 16, v16
    v_mul_f32 v16, v16, v5
    v_cvt_pk_bf16_f32 v16, v16, v16
    v_lshlrev_b32 v16, 16, v16
    v_lshlrev_b32 v7, 16, v54
    v_add_f32 v16, v16, v7
    v_add_f32 v17, v17, v21
    v_add_f32 v17, v17, v25
    v_cvt_pk_bf16_f32 v17, v17, v17
    v_lshlrev_b32 v17, 16, v17
    v_mul_f32 v17, v17, v5
    v_cvt_pk_bf16_f32 v17, v17, v17
    v_lshlrev_b32 v17, 16, v17
    v_and_b32 v7, 0xffff0000, v54
    v_add_f32 v17, v17, v7
    v_add_f32 v18, v18, v22
    v_add_f32 v18, v18, v26
    v_cvt_pk_bf16_f32 v18, v18, v18
    v_lshlrev_b32 v18, 16, v18
    v_mul_f32 v18, v18, v5
    v_cvt_pk_bf16_f32 v18, v18, v18
    v_lshlrev_b32 v18, 16, v18
    v_lshlrev_b32 v7, 16, v55
    v_add_f32 v18, v18, v7
    v_add_f32 v19, v19, v23
    v_add_f32 v19, v19, v27
    v_cvt_pk_bf16_f32 v19, v19, v19
    v_lshlrev_b32 v19, 16, v19
    v_mul_f32 v19, v19, v5
    v_cvt_pk_bf16_f32 v19, v19, v19
    v_lshlrev_b32 v19, 16, v19
    v_and_b32 v7, 0xffff0000, v55
    v_add_f32 v19, v19, v7
    v_cvt_pk_bf16_f32 v20, v16, v17
    v_cvt_pk_bf16_f32 v21, v18, v19
    v_lshlrev_b32 v2, 3, v1
    v_cmp_lt_u32 vcc, 19, v1
    s_mul_i32 s6, s87, 1280
    s_mul_i32 s7, s88, 160
    v_cndmask_b32 v2, v2, v3, vcc
    s_add_u32 s6, s6, s7
    s_add_u32 s6, s6, 3837952
    buffer_store_dwordx2 v[20:21], v2, s[8:11], s6 offen sc1
    s_call_b64 s[80:81], L_oprep
    s_waitcnt vmcnt(0)
    s_lshl_b32 s6, s5, 5
    s_add_u32 s6, s6, s4
    s_lshl_b32 s6, s6, 5
    s_add_u32 s6, s6, s3
    s_lshl_b32 s6, s6, 2
    s_add_u32 s6, s6, 3899392
    v_mov_b32 v2, 1
    v_mov_b32 v3, 0x5000000
    v_writelane_b32 v3, s6, 0
    buffer_store_dword v2, v3, s[8:11], 0 offen sc1
    s_branch L_ye
L_yd:
    s_call_b64 s[80:81], L_oprep
    s_waitcnt vmcnt(0)
L_ye:
    v_cmp_ne_u32 vcc, 1, v50
    s_cbranch_vccz L_ce
    v_and_b32 v3, 1, v1
    v_lshlrev_b32 v3, 12, v3
    v_and_b32 v2, 2, v1
    v_lshl_add_u32 v3, v2, 8, v3
    s_lshr_b32 s72, s68, 2
    s_lshl_b32 s72, s72, 6
    s_andn2_b32 s6, s4, 7
    s_add_u32 s72, s72, s6
    s_add_u32 s72, s72, s3
    s_lshl_b32 s72, s72, 7
    s_add_u32 s72, s72, 3932160
    s_mov_b32 s79, 262144
L_poll_37:
    buffer_load_dword v2, v3, s[8:11], s72 offen sc1
    s_waitcnt vmcnt(0)
    v_cmp_ne_u32 vcc, 1, v2
    s_cbranch_vccz L_polldone_38
    s_sleep 4
    s_sub_u32 s79, s79, 1
    s_cmp_lg_u32 s79, 0
    s_cbranch_scc1 L_poll_37
L_polldone_38:
L_ce:
    s_add_u32 s65, s68, 1
    s_and_b32 s65, s65, 3
    s_andn2_b32 s7, s68, 3
    s_add_u32 s65, s65, s7
    s_lshl_b32 s65, s65, 17
    s_add_u32 s65, s65, s66
    s_add_u32 m0, s99, 0
    s_add_u32 s65, s65, 0
    buffer_load_dwordx4 v13, s[8:11], s65 offen offset:0 sc1 lds
    buffer_load_dwordx4 v13, s[8:11], s65 offen offset:1024 sc1 lds
    buffer_load_dwordx4 v13, s[8:11], s65 offen offset:2048 sc1 lds
    buffer_load_dwordx4 v13, s[8:11], s65 offen offset:3072 sc1 lds
    s_add_u32 s65, s68, 1
    s_and_b32 s65, s65, 3
    s_andn2_b32 s7, s68, 3
    s_add_u32 s65, s65, s7
    s_lshl_b32 s65, s65, 17
    s_add_u32 s65, s65, s66
    s_add_u32 m0, s99, 16384
    s_add_u32 s65, s65, 16384
    buffer_load_dwordx4 v13, s[8:11], s65 offen offset:0 sc1 lds
    buffer_load_dwordx4 v13, s[8:11], s65 offen offset:1024 sc1 lds
    buffer_load_dwordx4 v13, s[8:11], s65 offen offset:2048 sc1 lds
    buffer_load_dwordx4 v13, s[8:11], s65 offen offset:3072 sc1 lds
    s_setprio 0
    s_barrier
    s_add_u32 s65, s68, 2
    s_and_b32 s65, s65, 3
    s_andn2_b32 s7, s68, 3
    s_add_u32 s65, s65, s7
    s_lshl_b32 s65, s65, 17
    s_add_u32 s65, s65, s66
    s_add_u32 m0, s99, 32768
    s_add_u32 s65, s65, 0
    buffer_load_dwordx4 v13, s[8:11], s65 offen offset:0 sc1 lds
    buffer_load_dwordx4 v13, s[8:11], s65 offen offset:1024 sc1 lds
    buffer_load_dwordx4 v13, s[8:11], s65 offen offset:2048 sc1 lds
    buffer_load_dwordx4 v13, s[8:11], s65 offen offset:3072 sc1 lds
    s_add_u32 s65, s68, 2
    s_and_b32 s65, s65, 3
    s_andn2_b32 s7, s68, 3
    s_add_u32 s65, s65, s7
    s_lshl_b32 s65, s65, 17
    s_add_u32 s65, s65, s66
    s_add_u32 m0, s99, 49152
    s_add_u32 s65, s65, 16384
    buffer_load_dwordx4 v13, s[8:11], s65 offen offset:0 sc1 lds
    buffer_load_dwordx4 v13, s[8:11], s65 offen offset:1024 sc1 lds
    buffer_load_dwordx4 v13, s[8:11], s65 offen offset:2048 sc1 lds
    buffer_load_dwordx4 v13, s[8:11], s65 offen offset:3072 sc1 lds
    s_waitcnt vmcnt(8)
    s_branch L_adone
L_moe:
    s_sub_u32 s6, s62, s5
    s_cmp_lg_u32 s6, 3
    s_cbranch_scc1 L_idle
    s_mov_b32 s12, s48
    s_mov_b32 s13, s49
    s_mov_b32 s14, 0x21c000
    s_mov_b32 s15, 0x20000
    s_cmp_ge_u32 s3, 2
    s_cselect_b32 s12, s50, s12
    s_cselect_b32 s13, s51, s13
    s_mov_b32 s16, s52
    s_mov_b32 s17, s53
    s_mov_b32 s18, 0x21c000
    s_mov_b32 s19, 0x20000
    v_lshrrev_b32 v3, 2, v1
    v_mul_u32_u24 v3, 3456, v3
    v_and_b32 v4, 3, v1
    v_lshl_add_u32 v16, v4, 4, v3
    v_lshrrev_b32 v3, 3, v1
    v_mul_u32_u24 v3, 1280, v3
    v_and_b32 v4, 7, v1
    v_lshl_add_u32 v18, v4, 4, v3
    s_and_b32 s7, s3, 1
    s_mul_i32 s84, s7, 1105920
    s_lshl_b32 s6, s61, 6
    s_add_u32 s84, s84, s6
    s_lshl_b32 s85, s3, 13
    s_add_u32 s85, s85, 131072
    s_mul_i32 s86, s61, 40960
    s_lshl_b32 s6, s3, 7
    s_add_u32 s86, s86, s6
    s_add_u32 m0, s85, 0
    s_nop 0
    buffer_load_dwordx4 v16, s[12:15], s84 offen lds
    s_add_u32 s84, s84, 55296
    s_add_u32 m0, s85, 1024
    s_nop 0
    buffer_load_dwordx4 v16, s[12:15], s84 offen lds
    s_add_u32 s84, s84, 55296
    s_add_u32 m0, s85, 2048
    s_nop 0
    buffer_load_dwordx4 v16, s[12:15], s84 offen lds
    s_add_u32 s84, s84, 55296
    s_add_u32 m0, s85, 3072
    s_nop 0
    buffer_load_dwordx4 v16, s[12:15], s84 offen lds
    s_add_u32 s84, s84, 55296
    s_add_u32 m0, s85, 4096
    s_nop 0
    buffer_load_dwordx4 v16, s[12:15], s84 offen lds
    s_add_u32 s84, s84, 55296
    s_add_u32 m0, s85, 5120
    s_nop 0
    buffer_load_dwordx4 v16, s[12:15], s84 offen lds
    s_add_u32 s84, s84, 55296
    s_add_u32 m0, s85, 6144
    s_nop 0
    buffer_load_dwordx4 v16, s[12:15], s84 offen lds
    s_add_u32 s84, s84, 55296
    s_add_u32 m0, s85, 7168
    s_nop 0
    buffer_load_dwordx4 v16, s[12:15], s84 offen lds
    s_add_u32 s84, s84, 55296
    v_lshrrev_b32 v7, 4, v1
    v_and_b32 v2, 15, v1
    v_lshrrev_b32 v3, 2, v2
    v_lshl_add_u32 v8, v7, 3, v3
    v_lshlrev_b32 v8, 6, v8
    v_and_b32 v4, 3, v2
    v_lshl_add_u32 v8, v4, 3, v8
    v_add_u32 v17, s85, v8
    v_lshl_add_u32 v8, v7, 2, v3
    v_lshlrev_b32 v8, 7, v8
    v_lshl_add_u32 v8, v4, 3, v8
    s_add_u32 s6, s85, 4096
    v_add_u32 v19, s6, v8
    v_mul_u32_u24 v3, 2560, v2
    v_lshl_add_u32 v3, v7, 4, v3
    v_mov_b32 v4, 0x5000000
    v_cmp_gt_u32 vcc, 8, v2
    s_mul_i32 s87, s61, 20480
    s_lshl_b32 s7, s3, 8
    s_add_u32 s87, s87, s7
    s_add_u32 s87, s87, 2686976
    v_cndmask_b32 v20, v4, v3, vcc
    s_and_b32 s7, s3, 1
    s_mul_i32 s88, s7, 10240
    s_add_u32 s88, s88, 12582912
    s_waitcnt vmcnt(0) lgkmcnt(0)
    s_call_b64 s[82:83], L_pend
    s_barrier
    ds_read_b64_tr_b16 v[104:105], v17 offset:0
    ds_read_b64_tr_b16 v[106:107], v17 offset:256
    ds_read_b64_tr_b16 v[108:109], v17 offset:32
    ds_read_b64_tr_b16 v[110:111], v17 offset:288
    ds_read_b64_tr_b16 v[112:113], v17 offset:2048
    ds_read_b64_tr_b16 v[114:115], v17 offset:2304
    ds_read_b64_tr_b16 v[116:117], v17 offset:2080
    ds_read_b64_tr_b16 v[118:119], v17 offset:2336
    s_waitcnt lgkmcnt(0)
    ds_read_b64_tr_b16 v[120:121], v17 offset:4096
    ds_read_b64_tr_b16 v[122:123], v17 offset:4352
    ds_read_b64_tr_b16 v[124:125], v17 offset:4128
    ds_read_b64_tr_b16 v[126:127], v17 offset:4384
    ds_read_b64_tr_b16 v[128:129], v17 offset:6144
    ds_read_b64_tr_b16 v[130:131], v17 offset:6400
    ds_read_b64_tr_b16 v[132:133], v17 offset:6176
    ds_read_b64_tr_b16 v[134:135], v17 offset:6432
    s_waitcnt lgkmcnt(0)
    s_add_u32 m0, s85, 0
    s_nop 0
    buffer_load_dwordx4 v16, s[12:15], s84 offen lds
    s_add_u32 s84, s84, 55296
    s_add_u32 m0, s85, 1024
    s_nop 0
    buffer_load_dwordx4 v16, s[12:15], s84 offen lds
    s_add_u32 s84, s84, 55296
    s_add_u32 m0, s85, 2048
    s_nop 0
    buffer_load_dwordx4 v16, s[12:15], s84 offen lds
    s_add_u32 s84, s84, 55296
    s_add_u32 m0, s85, 3072
    s_nop 0
    buffer_load_dwordx4 v16, s[12:15], s84 offen lds
    s_add_u32 s84, s84, 55296
    s_add_u32 m0, s85, 4096
    s_nop 0
    buffer_load_dwordx4 v16, s[12:15], s84 offen lds
    s_add_u32 s84, s84, 55296
    s_add_u32 m0, s85, 5120
    s_nop 0
    buffer_load_dwordx4 v16, s[12:15], s84 offen lds
    s_add_u32 s84, s84, 55296
    s_add_u32 m0, s85, 6144
    s_nop 0
    buffer_load_dwordx4 v16, s[12:15], s84 offen lds
    s_add_u32 s84, s84, 55296
    s_add_u32 m0, s85, 7168
    s_nop 0
    buffer_load_dwordx4 v16, s[12:15], s84 offen lds
    s_add_u32 s84, s84, 55296
    s_call_b64 s[82:83], L_load
    s_add_i32 s62, s62, 1
    v_and_b32 v3, 7, v1
    v_lshlrev_b32 v3, 2, v3
    s_mov_b32 s72, 0x3a0000
    buffer_load_dword v51, v3, s[8:11], s72 offen sc1
    s_waitcnt vmcnt(0) lgkmcnt(0)
    s_call_b64 s[82:83], L_pend
    s_barrier
    ds_read_b64_tr_b16 v[136:137], v17 offset:0
    ds_read_b64_tr_b16 v[138:139], v17 offset:256
    ds_read_b64_tr_b16 v[140:141], v17 offset:32
    ds_read_b64_tr_b16 v[142:143], v17 offset:288
    ds_read_b64_tr_b16 v[144:145], v17 offset:2048
    ds_read_b64_tr_b16 v[146:147], v17 offset:2304
    ds_read_b64_tr_b16 v[148:149], v17 offset:2080
    ds_read_b64_tr_b16 v[150:151], v17 offset:2336
    s_waitcnt lgkmcnt(0)
    ds_read_b64_tr_b16 v[152:153], v17 offset:4096
    ds_read_b64_tr_b16 v[154:155], v17 offset:4352
    ds_read_b64_tr_b16 v[156:157], v17 offset:4128
    ds_read_b64_tr_b16 v[158:159], v17 offset:4384
    ds_read_b64_tr_b16 v[160:161], v17 offset:6144
    ds_read_b64_tr_b16 v[162:163], v17 offset:6400
    ds_read_b64_tr_b16 v[164:165], v17 offset:6176
    ds_read_b64_tr_b16 v[166:167], v17 offset:6432
    s_waitcnt lgkmcnt(0)
    s_add_u32 m0, s85, 0
    s_nop 0
    buffer_load_dwordx4 v16, s[12:15], s84 offen lds
    s_add_u32 s84, s84, 55296
    s_add_u32 m0, s85, 1024
    s_nop 0
    buffer_load_dwordx4 v16, s[12:15], s84 offen lds
    s_add_u32 s84, s84, 55296
    s_add_u32 m0, s85, 2048
    s_nop 0
    buffer_load_dwordx4 v16, s[12:15], s84 offen lds
    s_add_u32 s84, s84, 55296
    s_add_u32 m0, s85, 3072
    s_nop 0
    buffer_load_dwordx4 v16, s[12:15], s84 offen lds
    s_add_u32 s84, s84, 55296
    s_add_u32 m0, s85, 4096
    s_add_u32 s6, s86, 0
    buffer_load_dwordx4 v18, s[16:19], s6 offen lds
    s_add_u32 m0, s85, 5120
    s_add_u32 s6, s86, 10240
    buffer_load_dwordx4 v18, s[16:19], s6 offen lds
    s_add_u32 m0, s85, 6144
    s_add_u32 s6, s86, 20480
    buffer_load_dwordx4 v18, s[16:19], s6 offen lds
    s_add_u32 m0, s85, 7168
    s_add_u32 s6, s86, 30720
    buffer_load_dwordx4 v18, s[16:19], s6 offen lds
    s_add_u32 s86, s86, 512
    s_call_b64 s[82:83], L_load
    s_add_i32 s62, s62, 1
    v_cmp_le_i32 vcc, 0, v51
    s_cbranch_vccz L_idx_okm
    v_and_b32 v3, 7, v1
    v_lshlrev_b32 v3, 2, v3
    s_mov_b32 s72, 0x3a0000
    s_mov_b32 s79, 262144
L_poll_41:
    buffer_load_dword v51, v3, s[8:11], s72 offen sc1
    s_waitcnt vmcnt(0)
    v_cmp_le_i32 vcc, 0, v51
    s_cbranch_vccz L_polldone_42
    s_sleep 2
    s_sub_u32 s79, s79, 1
    s_cmp_lg_u32 s79, 0
    s_cbranch_scc1 L_poll_41
L_polldone_42:
L_idx_okm:
    buffer_load_dwordx4 v[64:67], v13, s[8:11], s88 offen sc1
    s_add_u32 s88, s88, 1024
    buffer_load_dwordx4 v[68:71], v13, s[8:11], s88 offen sc1
    s_add_u32 s88, s88, 1024
    buffer_load_dwordx4 v[72:75], v13, s[8:11], s88 offen sc1
    s_add_u32 s88, s88, 1024
    buffer_load_dwordx4 v[76:79], v13, s[8:11], s88 offen sc1
    s_add_u32 s88, s88, 1024
    buffer_load_dwordx4 v[80:83], v13, s[8:11], s88 offen sc1
    s_add_u32 s88, s88, 1024
    buffer_load_dwordx4 v[84:87], v13, s[8:11], s88 offen sc1
    s_add_u32 s88, s88, 1024
    buffer_load_dwordx4 v[88:91], v13, s[8:11], s88 offen sc1
    s_add_u32 s88, s88, 1024
    buffer_load_dwordx4 v[92:95], v13, s[8:11], s88 offen sc1
    s_add_u32 s88, s88, 1024
    buffer_load_dwordx4 v[96:99], v13, s[8:11], s88 offen sc1
    s_add_u32 s88, s88, 1024
    buffer_load_dwordx4 v[100:103], v13, s[8:11], s88 offen sc1
    s_add_u32 s88, s88, 1024
    s_waitcnt vmcnt(10) lgkmcnt(0)
    s_call_b64 s[82:83], L_pend
    s_barrier
    ds_read_b64_tr_b16 v[168:169], v17 offset:0
    ds_read_b64_tr_b16 v[170:171], v17 offset:256
    ds_read_b64_tr_b16 v[172:173], v17 offset:32
    ds_read_b64_tr_b16 v[174:175], v17 offset:288
    ds_read_b64_tr_b16 v[176:177], v17 offset:2048
    ds_read_b64_tr_b16 v[178:179], v17 offset:2304
    ds_read_b64_tr_b16 v[180:181], v17 offset:2080
    ds_read_b64_tr_b16 v[182:183], v17 offset:2336
    s_waitcnt lgkmcnt(0)
    ds_read_b64_tr_b16 v[32:33], v19 offset:0
    ds_read_b64_tr_b16 v[34:35], v19 offset:2048
    ds_read_b64_tr_b16 v[36:37], v19 offset:32
    ds_read_b64_tr_b16 v[38:39], v19 offset:2080
    ds_read_b64_tr_b16 v[40:41], v19 offset:64
    ds_read_b64_tr_b16 v[42:43], v19 offset:2112
    ds_read_b64_tr_b16 v[44:45], v19 offset:96
    ds_read_b64_tr_b16 v[46:47], v19 offset:2144
    s_waitcnt lgkmcnt(0)
    s_add_u32 m0, s85, 4096
    s_add_u32 s6, s86, 0
    buffer_load_dwordx4 v18, s[16:19], s6 offen lds
    s_add_u32 m0, s85, 5120
    s_add_u32 s6, s86, 10240
    buffer_load_dwordx4 v18, s[16:19], s6 offen lds
    s_add_u32 m0, s85, 6144
    s_add_u32 s6, s86, 20480
    buffer_load_dwordx4 v18, s[16:19], s6 offen lds
    s_add_u32 m0, s85, 7168
    s_add_u32 s6, s86, 30720
    buffer_load_dwordx4 v18, s[16:19], s6 offen lds
    s_add_u32 s86, s86, 512
    s_call_b64 s[82:83], L_load
    s_add_i32 s62, s62, 1
    s_waitcnt vmcnt(20)
    v_mfma_f32_16x16x32_bf16 v[24:27], v[104:107], v[64:67], 0
    v_mfma_f32_16x16x32_bf16 v[28:31], v[108:111], v[64:67], 0
    v_mfma_f32_16x16x32_bf16 v[24:27], v[112:115], v[68:71], v[24:27]
    v_mfma_f32_16x16x32_bf16 v[28:31], v[116:119], v[68:71], v[28:31]
    v_mfma_f32_16x16x32_bf16 v[24:27], v[120:123], v[72:75], v[24:27]
    v_mfma_f32_16x16x32_bf16 v[28:31], v[124:127], v[72:75], v[28:31]
    v_mfma_f32_16x16x32_bf16 v[24:27], v[128:131], v[76:79], v[24:27]
    v_mfma_f32_16x16x32_bf16 v[28:31], v[132:135], v[76:79], v[28:31]
    v_mfma_f32_16x16x32_bf16 v[24:27], v[136:139], v[80:83], v[24:27]
    v_mfma_f32_16x16x32_bf16 v[28:31], v[140:143], v[80:83], v[28:31]
    v_mfma_f32_16x16x32_bf16 v[24:27], v[144:147], v[84:87], v[24:27]
    v_mfma_f32_16x16x32_bf16 v[28:31], v[148:151], v[84:87], v[28:31]
    v_mfma_f32_16x16x32_bf16 v[24:27], v[152:155], v[88:91], v[24:27]
    v_mfma_f32_16x16x32_bf16 v[28:31], v[156:159], v[88:91], v[28:31]
    v_mfma_f32_16x16x32_bf16 v[24:27], v[160:163], v[92:95], v[24:27]
    v_mfma_f32_16x16x32_bf16 v[28:31], v[164:167], v[92:95], v[28:31]
    v_mfma_f32_16x16x32_bf16 v[24:27], v[168:171], v[96:99], v[24:27]
    v_mfma_f32_16x16x32_bf16 v[28:31], v[172:175], v[96:99], v[28:31]
    v_mfma_f32_16x16x32_bf16 v[24:27], v[176:179], v[100:103], v[24:27]
    v_mfma_f32_16x16x32_bf16 v[28:31], v[180:183], v[100:103], v[28:31]
    v_add_u32 v10, s85, v13
    s_nop 7
    ds_write_b128 v10, v[24:27]
    ds_write_b128 v10, v[28:31] offset:1024
    s_waitcnt vmcnt(0) lgkmcnt(0)
    s_call_b64 s[82:83], L_pend
    s_barrier
    ds_read_b64_tr_b16 v[240:241], v19 offset:0
    ds_read_b64_tr_b16 v[242:243], v19 offset:2048
    ds_read_b64_tr_b16 v[244:245], v19 offset:32
    ds_read_b64_tr_b16 v[246:247], v19 offset:2080
    ds_read_b64_tr_b16 v[248:249], v19 offset:64
    ds_read_b64_tr_b16 v[250:251], v19 offset:2112
    ds_read_b64_tr_b16 v[252:253], v19 offset:96
    ds_read_b64_tr_b16 v[254:255], v19 offset:2144
    v_add_u32 v10, 131072, v13
    s_waitcnt lgkmcnt(0)
    ds_read_b128 v[184:187], v10 offset:0
    ds_read_b128 v[188:191], v10 offset:1024
    ds_read_b128 v[192:195], v10 offset:8192
    ds_read_b128 v[196:199], v10 offset:9216
    ds_read_b128 v[200:203], v10 offset:16384
    ds_read_b128 v[204:207], v10 offset:17408
    ds_read_b128 v[208:211], v10 offset:24576
    ds_read_b128 v[212:215], v10 offset:25600
    s_cmp_ge_u32 s3, 2
    s_cbranch_scc1 L_moe4b
    s_add_u32 m0, s85, 4096
    s_add_u32 s6, s86, 0
    buffer_load_dwordx4 v18, s[16:19], s6 offen lds
    s_add_u32 m0, s85, 5120
    s_add_u32 s6, s86, 10240
    buffer_load_dwordx4 v18, s[16:19], s6 offen lds
    s_add_u32 m0, s85, 6144
    s_add_u32 s6, s86, 20480
    buffer_load_dwordx4 v18, s[16:19], s6 offen lds
    s_add_u32 m0, s85, 7168
    s_add_u32 s6, s86, 30720
    buffer_load_dwordx4 v18, s[16:19], s6 offen lds
    s_add_u32 s86, s86, 512
L_moe4b:
    s_call_b64 s[82:83], L_load
    s_add_i32 s62, s62, 1
    s_waitcnt lgkmcnt(0)
    s_mov_b32 s6, 0xbfb8aa3b
    v_add_f32 v184, v184, v192
    v_add_f32 v200, v200, v208
    v_add_f32 v185, v185, v193
    v_add_f32 v201, v201, v209
    v_cvt_pk_bf16_f32 v185, v184, v185
    v_lshlrev_b32 v184, 16, v185
    v_and_b32 v185, 0xffff0000, v185
    v_cvt_pk_bf16_f32 v201, v200, v201
    v_lshlrev_b32 v200, 16, v201
    v_and_b32 v201, 0xffff0000, v201
    v_mul_f32 v2, s6, v184
    v_mul_f32 v3, s6, v185
    v_exp_f32 v2, v2
    v_exp_f32 v3, v3
    s_nop 0
    v_add_f32 v2, 1.0, v2
    v_add_f32 v3, 1.0, v3
    v_rcp_f32 v2, v2
    v_rcp_f32 v3, v3
    s_nop 0
    v_mul_f32 v184, v184, v2
    v_mul_f32 v185, v185, v3
    v_cvt_pk_bf16_f32 v185, v184, v185
    v_lshlrev_b32 v184, 16, v185
    v_and_b32 v185, 0xffff0000, v185
    v_mul_f32 v184, v184, v200
    v_mul_f32 v185, v185, v201
    v_cvt_pk_bf16_f32 v24, v184, v185
    v_add_f32 v186, v186, v194
    v_add_f32 v202, v202, v210
    v_add_f32 v187, v187, v195
    v_add_f32 v203, v203, v211
    v_cvt_pk_bf16_f32 v187, v186, v187
    v_lshlrev_b32 v186, 16, v187
    v_and_b32 v187, 0xffff0000, v187
    v_cvt_pk_bf16_f32 v203, v202, v203
    v_lshlrev_b32 v202, 16, v203
    v_and_b32 v203, 0xffff0000, v203
    v_mul_f32 v2, s6, v186
    v_mul_f32 v3, s6, v187
    v_exp_f32 v2, v2
    v_exp_f32 v3, v3
    s_nop 0
    v_add_f32 v2, 1.0, v2
    v_add_f32 v3, 1.0, v3
    v_rcp_f32 v2, v2
    v_rcp_f32 v3, v3
    s_nop 0
    v_mul_f32 v186, v186, v2
    v_mul_f32 v187, v187, v3
    v_cvt_pk_bf16_f32 v187, v186, v187
    v_lshlrev_b32 v186, 16, v187
    v_and_b32 v187, 0xffff0000, v187
    v_mul_f32 v186, v186, v202
    v_mul_f32 v187, v187, v203
    v_cvt_pk_bf16_f32 v25, v186, v187
    v_add_f32 v188, v188, v196
    v_add_f32 v204, v204, v212
    v_add_f32 v189, v189, v197
    v_add_f32 v205, v205, v213
    v_cvt_pk_bf16_f32 v189, v188, v189
    v_lshlrev_b32 v188, 16, v189
    v_and_b32 v189, 0xffff0000, v189
    v_cvt_pk_bf16_f32 v205, v204, v205
    v_lshlrev_b32 v204, 16, v205
    v_and_b32 v205, 0xffff0000, v205
    v_mul_f32 v2, s6, v188
    v_mul_f32 v3, s6, v189
    v_exp_f32 v2, v2
    v_exp_f32 v3, v3
    s_nop 0
    v_add_f32 v2, 1.0, v2
    v_add_f32 v3, 1.0, v3
    v_rcp_f32 v2, v2
    v_rcp_f32 v3, v3
    s_nop 0
    v_mul_f32 v188, v188, v2
    v_mul_f32 v189, v189, v3
    v_cvt_pk_bf16_f32 v189, v188, v189
    v_lshlrev_b32 v188, 16, v189
    v_and_b32 v189, 0xffff0000, v189
    v_mul_f32 v188, v188, v204
    v_mul_f32 v189, v189, v205
    v_cvt_pk_bf16_f32 v26, v188, v189
    v_add_f32 v190, v190, v198
    v_add_f32 v206, v206, v214
    v_add_f32 v191, v191, v199
    v_add_f32 v207, v207, v215
    v_cvt_pk_bf16_f32 v191, v190, v191
    v_lshlrev_b32 v190, 16, v191
    v_and_b32 v191, 0xffff0000, v191
    v_cvt_pk_bf16_f32 v207, v206, v207
    v_lshlrev_b32 v206, 16, v207
    v_and_b32 v207, 0xffff0000, v207
    v_mul_f32 v2, s6, v190
    v_mul_f32 v3, s6, v191
    v_exp_f32 v2, v2
    v_exp_f32 v3, v3
    s_nop 0
    v_add_f32 v2, 1.0, v2
    v_add_f32 v3, 1.0, v3
    v_rcp_f32 v2, v2
    v_rcp_f32 v3, v3
    s_nop 0
    v_mul_f32 v190, v190, v2
    v_mul_f32 v191, v191, v3
    v_cvt_pk_bf16_f32 v191, v190, v191
    v_lshlrev_b32 v190, 16, v191
    v_and_b32 v191, 0xffff0000, v191
    v_mul_f32 v190, v190, v206
    v_mul_f32 v191, v191, v207
    v_cvt_pk_bf16_f32 v27, v190, v191
    s_nop 1
    v_mfma_f32_16x16x32_bf16 v[216:219], v[32:35], v[24:27], 0
    v_mfma_f32_16x16x32_bf16 v[220:223], v[36:39], v[24:27], 0
    v_mfma_f32_16x16x32_bf16 v[224:227], v[40:43], v[24:27], 0
    v_mfma_f32_16x16x32_bf16 v[228:231], v[44:47], v[24:27], 0
    s_nop 7
    buffer_store_dwordx4 v[216:219], v20, s[8:11], s87 offen offset:0 sc1
    buffer_store_dwordx4 v[220:223], v20, s[8:11], s87 offen offset:64 sc1
    buffer_store_dwordx4 v[224:227], v20, s[8:11], s87 offen offset:128 sc1
    buffer_store_dwordx4 v[228:231], v20, s[8:11], s87 offen offset:192 sc1
    s_nop 1
    s_waitcnt vmcnt(4) lgkmcnt(0)
    s_call_b64 s[82:83], L_pend
    s_barrier
    s_call_b64 s[82:83], L_load
    s_add_i32 s62, s62, 1
    v_mfma_f32_16x16x32_bf16 v[216:219], v[240:243], v[24:27], 0
    v_mfma_f32_16x16x32_bf16 v[220:223], v[244:247], v[24:27], 0
    v_mfma_f32_16x16x32_bf16 v[224:227], v[248:251], v[24:27], 0
    v_mfma_f32_16x16x32_bf16 v[228:231], v[252:255], v[24:27], 0
    s_nop 7
    buffer_store_dwordx4 v[216:219], v20, s[8:11], s87 offen offset:1024 sc1
    buffer_store_dwordx4 v[220:223], v20, s[8:11], s87 offen offset:1088 sc1
    buffer_store_dwordx4 v[224:227], v20, s[8:11], s87 offen offset:1152 sc1
    buffer_store_dwordx4 v[228:231], v20, s[8:11], s87 offen offset:1216 sc1
    s_nop 1
    s_cmp_ge_u32 s3, 2
    s_cbranch_scc1 L_moe5b
    ds_read_b64_tr_b16 v[32:33], v19 offset:0
    ds_read_b64_tr_b16 v[34:35], v19 offset:2048
    ds_read_b64_tr_b16 v[36:37], v19 offset:32
    ds_read_b64_tr_b16 v[38:39], v19 offset:2080
    ds_read_b64_tr_b16 v[40:41], v19 offset:64
    ds_read_b64_tr_b16 v[42:43], v19 offset:2112
    ds_read_b64_tr_b16 v[44:45], v19 offset:96
    ds_read_b64_tr_b16 v[46:47], v19 offset:2144
    s_waitcnt lgkmcnt(0)
    v_mfma_f32_16x16x32_bf16 v[216:219], v[32:35], v[24:27], 0
    v_mfma_f32_16x16x32_bf16 v[220:223], v[36:39], v[24:27], 0
    v_mfma_f32_16x16x32_bf16 v[224:227], v[40:43], v[24:27], 0
    v_mfma_f32_16x16x32_bf16 v[228:231], v[44:47], v[24:27], 0
    s_nop 7
    buffer_store_dwordx4 v[216:219], v20, s[8:11], s87 offen offset:2048 sc1
    buffer_store_dwordx4 v[220:223], v20, s[8:11], s87 offen offset:2112 sc1
    buffer_store_dwordx4 v[224:227], v20, s[8:11], s87 offen offset:2176 sc1
    buffer_store_dwordx4 v[228:231], v20, s[8:11], s87 offen offset:2240 sc1
    s_nop 1
L_moe5b:
    s_waitcnt vmcnt(4) lgkmcnt(0)
    s_call_b64 s[82:83], L_pend
    s_barrier
    s_waitcnt vmcnt(0)
    s_lshl_b32 s6, s61, 5
    s_add_u32 s6, s6, s3
    s_lshl_b32 s6, s6, 2
    s_add_u32 s6, s6, 15859712
    v_mov_b32 v2, 1
    v_mov_b32 v3, 0x5000000
    v_writelane_b32 v3, s6, 0
    buffer_store_dword v2, v3, s[8:11], 0 offen sc1
    s_call_b64 s[82:83], L_load
    s_add_i32 s62, s62, 1
    s_branch L_idle
L_top:
    s_mov_b32 s6, 0x280000
    v_lshrrev_b32 v2, 1, v1
    v_and_b32 v3, 1, v1
    v_lshlrev_b32 v3, 4, v3
    v_lshl_add_u32 v2, v2, 7, v3
    buffer_load_dwordx4 v[64:67], v2, s[8:11], s6 offen sc1
    s_add_u32 s6, s6, 4096
    buffer_load_dwordx4 v[68:71], v2, s[8:11], s6 offen sc1
    s_add_u32 s6, s6, 4096
    buffer_load_dwordx4 v[72:75], v2, s[8:11], s6 offen sc1
    s_add_u32 s6, s6, 4096
    buffer_load_dwordx4 v[76:79], v2, s[8:11], s6 offen sc1
    s_add_u32 s6, s6, 4096
    buffer_load_dwordx4 v[80:83], v2, s[8:11], s6 offen sc1
    s_add_u32 s6, s6, 4096
    buffer_load_dwordx4 v[84:87], v2, s[8:11], s6 offen sc1
    s_add_u32 s6, s6, 4096
    buffer_load_dwordx4 v[88:91], v2, s[8:11], s6 offen sc1
    s_add_u32 s6, s6, 4096
    buffer_load_dwordx4 v[92:95], v2, s[8:11], s6 offen sc1
    s_add_u32 s6, s6, 4096
    s_waitcnt vmcnt(0)
    v_mov_b32 v24, 0
    s_mov_b32 s7, 0
    s_mov_b32 s84, 0
L_top_l:
    v_max3_u32 v4, v64, v65, v66
    v_max3_u32 v5, v67, v68, v69
    v_max3_u32 v4, v4, v70, v71
    v_max3_u32 v5, v5, v72, v73
    v_max3_u32 v4, v4, v74, v75
    v_max3_u32 v5, v5, v76, v77
    v_max3_u32 v4, v4, v78, v79
    v_max3_u32 v5, v5, v80, v81
    v_max3_u32 v4, v4, v82, v83
    v_max3_u32 v5, v5, v84, v85
    v_max3_u32 v4, v4, v86, v87
    v_max3_u32 v5, v5, v88, v89
    v_max3_u32 v4, v4, v90, v91
    v_max3_u32 v5, v5, v92, v93
    v_max3_u32 v4, v4, v94, v95
    v_max_u32 v4, v4, v5
    s_nop 1
    v_max_u32_dpp v4, v4, v4 quad_perm:[1,0,3,2] row_mask:0xf bank_mask:0xf
    s_nop 1
    v_max_u32_dpp v4, v4, v4 quad_perm:[2,3,0,1] row_mask:0xf bank_mask:0xf
    s_nop 1
    v_max_u32_dpp v4, v4, v4 row_half_mirror row_mask:0xf bank_mask:0xf
    s_nop 1
    v_max_u32_dpp v4, v4, v4 row_mirror row_mask:0xf bank_mask:0xf
    s_nop 1
    v_max_u32_dpp v4, v4, v4 row_bcast:15 row_mask:0xa bank_mask:0xf
    s_nop 1
    v_max_u32_dpp v4, v4, v4 row_bcast:31 row_mask:0xc bank_mask:0xf
    s_nop 1
    v_readlane_b32 s6, v4, 63
    s_mov_b32 m0, s7
    s_nop 3
    s_add_u32 s84, s84, s6
    v_writelane_b32 v24, s84, m0
    v_subrev_u32 v64, s6, v64
    v_subrev_u32 v65, s6, v65
    v_subrev_u32 v66, s6, v66
    v_subrev_u32 v67, s6, v67
    v_subrev_u32 v68, s6, v68
    v_subrev_u32 v69, s6, v69
    v_subrev_u32 v70, s6, v70
    v_subrev_u32 v71, s6, v71
    v_subrev_u32 v72, s6, v72
    v_subrev_u32 v73, s6, v73
    v_subrev_u32 v74, s6, v74
    v_subrev_u32 v75, s6, v75
    v_subrev_u32 v76, s6, v76
    v_subrev_u32 v77, s6, v77
    v_subrev_u32 v78, s6, v78
    v_subrev_u32 v79, s6, v79
    v_subrev_u32 v80, s6, v80
    v_subrev_u32 v81, s6, v81
    v_subrev_u32 v82, s6, v82
    v_subrev_u32 v83, s6, v83
    v_subrev_u32 v84, s6, v84
    v_subrev_u32 v85, s6, v85
    v_subrev_u32 v86, s6, v86
    v_subrev_u32 v87, s6, v87
    v_subrev_u32 v88, s6, v88
    v_subrev_u32 v89, s6, v89
    v_subrev_u32 v90, s6, v90
    v_subrev_u32 v91, s6, v91
    v_subrev_u32 v92, s6, v92
    v_subrev_u32 v93, s6, v93
    v_subrev_u32 v94, s6, v94
    v_subrev_u32 v95, s6, v95
    s_add_u32 s7, s7, 1
    s_cmp_lt_u32 s7, 8
    s_cbranch_scc1 L_top_l
    v_and_b32 v2, 7, v1
    v_lshlrev_b32 v2, 2, v2
    ds_bpermute_b32 v4, v2, v24
    s_waitcnt lgkmcnt(0)
    v_and_b32 v4, 0x7ff, v4
    v_sub_u32 v4, 0x7ff, v4
    v_lshrrev_b32 v5, 4, v4
    v_mul_u32_u24 v5, 20480, v5
    v_and_b32 v4, 15, v4
    v_lshl_add_u32 v5, v4, 4, v5
    v_lshrrev_b32 v7, 4, v1
    v_lshl_add_u32 v5, v7, 8, v5
    v_mov_b32 v6, 0x5000000
    v_and_b32 v2, 8, v1
    v_cmp_eq_u32 vcc, 0, v2
    s_mov_b32 s6, 0
    s_nop 0
    v_cndmask_b32 v5, v6, v5, vcc
    buffer_load_dwordx4 v[64:67], v5, s[8:11], s6 offen offset:0 sc1
    buffer_load_dwordx4 v[68:71], v5, s[8:11], s6 offen offset:1024 sc1
    buffer_load_dwordx4 v[72:75], v5, s[8:11], s6 offen offset:2048 sc1
    buffer_load_dwordx4 v[76:79], v5, s[8:11], s6 offen offset:3072 sc1
    s_add_u32 s6, s6, 4096
    buffer_load_dwordx4 v[80:83], v5, s[8:11], s6 offen offset:0 sc1
    buffer_load_dwordx4 v[84:87], v5, s[8:11], s6 offen offset:1024 sc1
    buffer_load_dwordx4 v[88:91], v5, s[8:11], s6 offen offset:2048 sc1
    buffer_load_dwordx4 v[92:95], v5, s[8:11], s6 offen offset:3072 sc1
    s_add_u32 s6, s6, 4096
    buffer_load_dwordx4 v[96:99], v5, s[8:11], s6 offen offset:0 sc1
    buffer_load_dwordx4 v[100:103], v5, s[8:11], s6 offen offset:1024 sc1
    buffer_load_dwordx4 v[104:107], v5, s[8:11], s6 offen offset:2048 sc1
    buffer_load_dwordx4 v[108:111], v5, s[8:11], s6 offen offset:3072 sc1
    s_add_u32 s6, s6, 4096
    buffer_load_dwordx4 v[112:115], v5, s[8:11], s6 offen offset:0 sc1
    buffer_load_dwordx4 v[116:119], v5, s[8:11], s6 offen offset:1024 sc1
    buffer_load_dwordx4 v[120:123], v5, s[8:11], s6 offen offset:2048 sc1
    buffer_load_dwordx4 v[124:127], v5, s[8:11], s6 offen offset:3072 sc1
    s_add_u32 s6, s6, 4096
    buffer_load_dwordx4 v[128:131], v5, s[8:11], s6 offen offset:0 sc1
    buffer_load_dwordx4 v[132:135], v5, s[8:11], s6 offen offset:1024 sc1
    buffer_load_dwordx4 v[136:139], v5, s[8:11], s6 offen offset:2048 sc1
    buffer_load_dwordx4 v[140:143], v5, s[8:11], s6 offen offset:3072 sc1
    s_waitcnt vmcnt(20)
    s_call_b64 s[82:83], L_pend
    s_barrier
    s_waitcnt vmcnt(0)
    s_mov_b32 s6, 0xc00000
    buffer_store_dwordx4 v[64:67], v13, s[8:11], s6 offen offset:0 sc1
    buffer_store_dwordx4 v[68:71], v13, s[8:11], s6 offen offset:1024 sc1
    buffer_store_dwordx4 v[72:75], v13, s[8:11], s6 offen offset:2048 sc1
    buffer_store_dwordx4 v[76:79], v13, s[8:11], s6 offen offset:3072 sc1
    s_add_u32 s6, s6, 4096
    buffer_store_dwordx4 v[80:83], v13, s[8:11], s6 offen offset:0 sc1
    buffer_store_dwordx4 v[84:87], v13, s[8:11], s6 offen offset:1024 sc1
    buffer_store_dwordx4 v[88:91], v13, s[8:11], s6 offen offset:2048 sc1
    buffer_store_dwordx4 v[92:95], v13, s[8:11], s6 offen offset:3072 sc1
    s_add_u32 s6, s6, 4096
    buffer_store_dwordx4 v[96:99], v13, s[8:11], s6 offen offset:0 sc1
    buffer_store_dwordx4 v[100:103], v13, s[8:11], s6 offen offset:1024 sc1
    buffer_store_dwordx4 v[104:107], v13, s[8:11], s6 offen offset:2048 sc1
    buffer_store_dwordx4 v[108:111], v13, s[8:11], s6 offen offset:3072 sc1
    s_add_u32 s6, s6, 4096
    buffer_store_dwordx4 v[112:115], v13, s[8:11], s6 offen offset:0 sc1
    buffer_store_dwordx4 v[116:119], v13, s[8:11], s6 offen offset:1024 sc1
    buffer_store_dwordx4 v[120:123], v13, s[8:11], s6 offen offset:2048 sc1
    buffer_store_dwordx4 v[124:127], v13, s[8:11], s6 offen offset:3072 sc1
    s_add_u32 s6, s6, 4096
    buffer_store_dwordx4 v[128:131], v13, s[8:11], s6 offen offset:0 sc1
    buffer_store_dwordx4 v[132:135], v13, s[8:11], s6 offen offset:1024 sc1
    buffer_store_dwordx4 v[136:139], v13, s[8:11], s6 offen offset:2048 sc1
    buffer_store_dwordx4 v[140:143], v13, s[8:11], s6 offen offset:3072 sc1
    s_call_b64 s[82:83], L_load
    s_add_i32 s62, s62, 1
    s_waitcnt vmcnt(16)
    v_or_b32 v24, 0x80000000, v24
    v_lshlrev_b32 v5, 2, v1
    v_mov_b32 v6, 0x5000000
    v_cmp_gt_u32 vcc, 8, v1
    s_mov_b32 s6, 0x3a0000
    s_nop 0
    v_cndmask_b32 v5, v6, v5, vcc
    buffer_store_dword v24, v5, s[8:11], s6 offen sc1
    s_branch L_idle
L_back_9_h:
    v_cmp_ne_u32 vcc, 0, v62
    s_cbranch_vccz L_back_9_n
    s_call_b64 s[80:81], L_rare0
L_back_9_n:
    s_branch L_back_9
L_back_10_h:
    v_cmp_ne_u32 vcc, 0, v62
    s_cbranch_vccz L_back_10_n
    s_call_b64 s[80:81], L_rare1
    v_exp_f32 v58, v64
    v_exp_f32 v59, v65
L_back_10_n:
    s_cmp_lt_i32 s64, 0
    s_cbranch_scc1 L_tail1
    s_cmp_gt_i32 s64, 0
    s_cbranch_scc1 L_back_10
    s_call_b64 s[82:83], L_mask
    s_branch L_back_10
L_back_11_h:
    v_cmp_ne_u32 vcc, 0, v62
    s_cbranch_vccz L_back_11_n
    s_call_b64 s[80:81], L_rare0
    v_exp_f32 v58, v80
    v_exp_f32 v59, v81
L_back_11_n:
    s_cmp_lt_i32 s64, 0
    s_cbranch_scc1 L_tail2
    s_cmp_gt_i32 s64, 0
    s_cbranch_scc1 L_back_11
    s_call_b64 s[82:83], L_mask
    s_branch L_back_11
L_back_12_h:
    v_cmp_ne_u32 vcc, 0, v62
    s_cbranch_vccz L_back_12_n
    s_call_b64 s[80:81], L_rare1
    v_exp_f32 v58, v64
    v_exp_f32 v59, v65
L_back_12_n:
    s_cmp_lt_i32 s64, 0
    s_cbranch_scc1 L_tail3
    s_cmp_gt_i32 s64, 0
    s_cbranch_scc1 L_back_12
    s_call_b64 s[82:83], L_mask
    s_branch L_back_12
L_ldback_13_c:
    s_waitcnt vmcnt(0) lgkmcnt(0)
    s_call_b64 s[82:83], L_pend
    s_barrier
    s_call_b64 s[82:83], L_load
    s_branch L_ldback_13
L_back_14_h:
    v_cmp_ne_u32 vcc, 0, v62
    s_cbranch_vccz L_back_14_n
    s_call_b64 s[80:81], L_rare0
    v_exp_f32 v58, v80
    v_exp_f32 v59, v81
L_back_14_n:
    s_cmp_lt_i32 s64, 0
    s_cbranch_scc1 L_tail0
    s_cmp_gt_i32 s64, 0
    s_cbranch_scc1 L_st0
    s_call_b64 s[82:83], L_mask
    s_branch L_st0
L_back_15_h:
    v_cmp_ne_u32 vcc, 0, v62
    s_cbranch_vccz L_back_15_n
    s_call_b64 s[80:81], L_rare1
L_back_15_n:
    s_branch L_back_15
L_back_16_h:
    v_cmp_ne_u32 vcc, 0, v62
    s_cbranch_vccz L_back_16_n
    s_call_b64 s[80:81], L_rare0
L_back_16_n:
    s_branch L_back_16
L_back_17_h:
    v_cmp_ne_u32 vcc, 0, v62
    s_cbranch_vccz L_back_17_n
    s_call_b64 s[80:81], L_rare1
L_back_17_n:
    s_branch L_back_17
L_back_20_h:
    v_cmp_ne_u32 vcc, 0, v62
    s_cbranch_vccz L_back_20_n
    s_call_b64 s[80:81], L_rare0
L_back_20_n:
    s_branch L_back_20
L_load:
    s_bitcmp1_b32 s89, 0
    s_cbranch_scc0 L_load_r
    s_add_u32 s77, s77, 32768
    s_xor_b32 s78, s78, 0x10000
    s_add_i32 s73, s62, 1
    s_cmp_gt_i32 s73, s63
    s_cbranch_scc1 L_load_r
    s_cmp_eq_i32 s73, s63
    s_cbranch_scc1 L_load_v
    s_cmp_lg_i32 s73, 3
    s_cbranch_scc1 L_load_k
    v_cmp_gt_u32 vcc, 2, v12
    s_cbranch_vccz L_load_k
    s_lshl_b32 s7, s4, 10
    s_add_u32 s7, s7, 3866624
    v_lshrrev_b32 v2, 3, v1
    v_and_b32 v3, 7, v1
    v_lshlrev_b32 v3, 2, v3
    v_lshl_add_u32 v3, v2, 7, v3
    s_mov_b32 s79, 262144
L_poll_48:
    buffer_load_dword v2, v3, s[8:11], s7 offen sc1
    s_waitcnt vmcnt(0)
    v_cmp_gt_u32 vcc, 2, v2
    s_cbranch_vccz L_polldone_49
    s_sleep 2
    s_sub_u32 s79, s79, 1
    s_cmp_lg_u32 s79, 0
    s_cbranch_scc1 L_poll_48
L_polldone_49:
L_load_k:
    s_lshl_b32 s6, s76, 13
    s_add_u32 s6, s6, s78
    s_add_u32 m0, s6, 0
    s_add_u32 s7, s77, 0
    buffer_load_dwordx4 v49, s[8:11], s7 offen offset:0 sc1 lds
    buffer_load_dwordx4 v49, s[8:11], s7 offen offset:1024 sc1 lds
    buffer_load_dwordx4 v49, s[8:11], s7 offen offset:2048 sc1 lds
    buffer_load_dwordx4 v49, s[8:11], s7 offen offset:3072 sc1 lds
    s_lshl_b32 s6, s76, 13
    s_add_u32 s6, s6, s78
    s_add_u32 m0, s6, 4096
    s_add_u32 s7, s77, 4096
    buffer_load_dwordx4 v49, s[8:11], s7 offen offset:0 sc1 lds
    buffer_load_dwordx4 v49, s[8:11], s7 offen offset:1024 sc1 lds
    buffer_load_dwordx4 v49, s[8:11], s7 offen offset:2048 sc1 lds
    buffer_load_dwordx4 v49, s[8:11], s7 offen offset:3072 sc1 lds
    s_lshl_b32 s6, s76, 12
    s_add_u32 s6, s6, s78
    s_add_u32 m0, s6, 49152
    s_add_u32 s7, s77, 524288
    buffer_load_dwordx4 v50, s[8:11], s7 offen offset:0 sc1 lds
    buffer_load_dwordx4 v50, s[8:11], s7 offen offset:1024 sc1 lds
    buffer_load_dwordx4 v50, s[8:11], s7 offen offset:2048 sc1 lds
    buffer_load_dwordx4 v50, s[8:11], s7 offen offset:3072 sc1 lds
L_load_v:
    s_lshl_b32 s6, s76, 12
    s_add_u32 s6, s6, s78
    s_add_u32 m0, s6, 32768
    s_add_u32 s7, s77, 507904
    buffer_load_dwordx4 v50, s[8:11], s7 offen offset:0 sc1 lds
    buffer_load_dwordx4 v50, s[8:11], s7 offen offset:1024 sc1 lds
    buffer_load_dwordx4 v50, s[8:11], s7 offen offset:2048 sc1 lds
    buffer_load_dwordx4 v50, s[8:11], s7 offen offset:3072 sc1 lds
    s_cmp_eq_i32 s73, s63
    s_cbranch_scc1 L_xa
    s_cmp_lg_i32 s73, 2
    s_cbranch_scc1 L_nolook
    s_lshl_b32 s7, s4, 10
    s_add_u32 s7, s7, 3866624
    v_lshrrev_b32 v2, 3, v1
    v_and_b32 v3, 7, v1
    v_lshlrev_b32 v3, 2, v3
    v_lshl_add_u32 v3, v2, 7, v3
    buffer_load_dword v12, v3, s[8:11], s7 offen sc1
L_nolook:
    s_cmp_lt_u32 s5, 4
    s_cbranch_scc1 L_load_r
    s_sub_i32 s6, s62, 0
    s_cmp_gt_u32 s6, 4
    s_cbranch_scc1 L_wb
    s_cbranch_scc0 L_wsel
L_wb:
    s_sub_i32 s79, s73, 1
    s_cmp_lt_u32 s79, 2
    s_cbranch_scc1 L_x3
L_load_r:
    s_setpc_b64 s[82:83]
L_pend:
    s_bitcmp1_b32 s89, 1
    s_cbranch_scc0 L_load_a
    s_cmp_lt_i32 s62, 0
    s_cbranch_scc1 L_load_a
    s_lshl_b32 s6, s4, 3
    s_add_u32 s6, s6, s5
    s_lshl_b32 s6, s6, 5
    s_add_u32 s6, s6, s3
    s_lshl_b32 s6, s6, 2
    s_add_u32 s6, s6, 3866624
    v_mov_b32 v2, 2
    v_mov_b32 v3, 0x5000000
    v_writelane_b32 v3, s6, 0
    buffer_store_dword v2, v3, s[8:11], 0 offen sc1
    s_and_b32 s89, s89, 1
L_load_a:
    s_setpc_b64 s[82:83]
L_wsel:
    s_lshr_b32 s7, s6, 1
    s_lshl_b32 s91, s2, 1
    s_add_u32 s91, s91, s7
    s_sub_u32 s91, s91, 256
    s_cmp_eq_u32 s6, 4
    s_cbranch_scc1 L_w2
    s_bitcmp1_b32 s6, 0
    s_cbranch_scc1 L_w1
L_w0:
    s_mov_b32 s28, s42
    s_mov_b32 s29, s43
    s_mov_b32 s30, 0x500000
    s_mov_b32 s31, 0x20000
    s_lshr_b32 s75, s91, 1
    s_mul_i32 s75, s75, 40960
    s_and_b32 s6, s91, 1
    s_mul_i32 s6, s6, 640
    s_add_u32 s75, s75, s6
    s_movk_i32 s7, 1639
    s_mul_i32 s74, s76, 5120
    s_add_u32 s74, s74, 141312
    s_mul_i32 s6, s76, 320
    v_add_u32 v9, s6, v1
    v_add_u32 v2, 0, v9
    v_mul_lo_u32 v3, v2, s7
    v_lshrrev_b32 v3, 16, v3
    v_mul_u32_u24 v4, 40, v3
    v_sub_u32 v4, v2, v4
    v_mul_u32_u24 v3, 1280, v3
    v_lshl_add_u32 v3, v4, 4, v3
    s_add_u32 m0, s74, 0
    s_nop 0
    buffer_load_dwordx4 v3, s[28:31], s75 offen nt lds
    v_add_u32 v2, 64, v9
    v_mul_lo_u32 v3, v2, s7
    v_lshrrev_b32 v3, 16, v3
    v_mul_u32_u24 v4, 40, v3
    v_sub_u32 v4, v2, v4
    v_mul_u32_u24 v3, 1280, v3
    v_lshl_add_u32 v3, v4, 4, v3
    s_add_u32 m0, s74, 1024
    s_nop 0
    buffer_load_dwordx4 v3, s[28:31], s75 offen nt lds
    v_add_u32 v2, 128, v9
    v_mul_lo_u32 v3, v2, s7
    v_lshrrev_b32 v3, 16, v3
    v_mul_u32_u24 v4, 40, v3
    v_sub_u32 v4, v2, v4
    v_mul_u32_u24 v3, 1280, v3
    v_lshl_add_u32 v3, v4, 4, v3
    s_add_u32 m0, s74, 2048
    s_nop 0
    buffer_load_dwordx4 v3, s[28:31], s75 offen nt lds
    v_add_u32 v2, 192, v9
    v_mul_lo_u32 v3, v2, s7
    v_lshrrev_b32 v3, 16, v3
    v_mul_u32_u24 v4, 40, v3
    v_sub_u32 v4, v2, v4
    v_mul_u32_u24 v3, 1280, v3
    v_lshl_add_u32 v3, v4, 4, v3
    s_add_u32 m0, s74, 3072
    s_nop 0
    buffer_load_dwordx4 v3, s[28:31], s75 offen nt lds
    v_add_u32 v2, 256, v9
    v_mul_lo_u32 v3, v2, s7
    v_lshrrev_b32 v3, 16, v3
    v_mul_u32_u24 v4, 40, v3
    v_sub_u32 v4, v2, v4
    v_mul_u32_u24 v3, 1280, v3
    v_lshl_add_u32 v3, v4, 4, v3
    s_add_u32 m0, s74, 4096
    s_nop 0
    buffer_load_dwordx4 v3, s[28:31], s75 offen nt lds
    s_branch L_wb
L_w1:
    v_and_b32 v2, 15, v1
    v_lshrrev_b32 v3, 4, v1
    v_lshrrev_b32 v4, 2, v2
    v_lshl_add_u32 v4, v3, 2, v4
    v_mul_u32_u24 v4, 640, v4
    v_and_b32 v2, 3, v2
    v_lshl_add_u32 v4, v2, 3, v4
    s_mul_i32 s6, s76, 160
    s_add_u32 s6, s6, 141312
    v_add_u32 v4, s6, v4
    s_mul_i32 s6, s91, 20480
    s_mul_i32 s7, s76, 5120
    s_add_u32 s6, s6, s7
    s_add_u32 s6, s6, 4194304
    s_add_u32 s7, s6, 4096
    ds_read_b64_tr_b16 v[172:173], v4 offset:0
    ds_read_b64_tr_b16 v[174:175], v4 offset:10240
    ds_read_b64_tr_b16 v[176:177], v4 offset:32
    ds_read_b64_tr_b16 v[178:179], v4 offset:10272
    ds_read_b64_tr_b16 v[180:181], v4 offset:64
    ds_read_b64_tr_b16 v[182:183], v4 offset:10304
    ds_read_b64_tr_b16 v[184:185], v4 offset:96
    ds_read_b64_tr_b16 v[186:187], v4 offset:10336
    ds_read_b64_tr_b16 v[188:189], v4 offset:128
    ds_read_b64_tr_b16 v[190:191], v4 offset:10368
    s_waitcnt lgkmcnt(0)
    buffer_store_dwordx4 v[172:175], v13, s[8:11], s6 offen offset:0 sc1
    buffer_store_dwordx4 v[176:179], v13, s[8:11], s6 offen offset:1024 sc1
    buffer_store_dwordx4 v[180:183], v13, s[8:11], s6 offen offset:2048 sc1
    buffer_store_dwordx4 v[184:187], v13, s[8:11], s6 offen offset:3072 sc1
    buffer_store_dwordx4 v[188:191], v13, s[8:11], s7 offen offset:0 sc1
    s_branch L_wb
L_w2:
    s_cmp_lg_u32 s3, 0
    s_cbranch_scc1 L_wb
    s_mov_b32 s28, s56
    s_mov_b32 s29, s57
    s_mov_b32 s30, 0x100
    s_mov_b32 s31, 0x20000
    v_mov_b32 v2, 1
    v_lshlrev_b32 v3, 8, v1
    s_and_b32 s6, s2, 31
    s_lshl_b32 s6, s6, 2
    buffer_atomic_add v2, v3, s[28:31], s6 offen offset:128 sc1
    s_branch L_wb
L_xa:
    s_cmp_lg_u32 s90, 0
    s_cbranch_scc1 L_xa1
    s_mov_b32 s28, s56
    s_mov_b32 s29, s57
    s_mov_b32 s30, 0x100
    s_mov_b32 s31, 0x20000
    v_and_b32 v3, 31, v1
    v_lshlrev_b32 v3, 2, v3
    s_mov_b32 s79, 262144
L_poll_50:
    buffer_load_dword v2, v3, s[28:31], 0 offen offset:128 sc1
    s_waitcnt vmcnt(0)
    v_cmp_gt_u32 vcc, 4, v2
    s_cbranch_vccz L_polldone_51
    s_sleep 8
    s_sub_u32 s79, s79, 1
    s_cmp_lg_u32 s79, 0
    s_cbranch_scc1 L_poll_50
L_polldone_51:
L_xa1:
    s_lshr_b32 s74, s4, 3
    s_lshl_b32 s74, s74, 2
    s_add_u32 s74, s74, s76
    s_mul_i32 s74, s74, 327680
    s_and_b32 s7, s4, 3
    s_mul_i32 s7, s7, 10240
    s_add_u32 s74, s74, s7
    s_add_u32 s74, s74, 4199424
    s_add_u32 s6, s76, 0
    s_and_b32 s6, s6, 3
    s_lshl_b32 s6, s6, 10
    s_add_u32 s84, s6, s74
    s_add_u32 s6, s76, 1
    s_and_b32 s6, s6, 3
    s_lshl_b32 s6, s6, 10
    s_add_u32 s85, s6, s74
    s_add_u32 s6, s76, 2
    s_and_b32 s6, s6, 3
    s_lshl_b32 s6, s6, 10
    s_add_u32 s86, s6, s74
    s_add_u32 s6, s76, 3
    s_and_b32 s6, s6, 3
    s_lshl_b32 s6, s6, 10
    s_add_u32 s87, s6, s74
    s_add_u32 s88, s74, 4096
    s_lshl_b32 s73, s3, 13
    s_add_u32 s75, s73, s78
    s_add_u32 m0, s73, 131072
    s_add_u32 s7, s84, 0
    buffer_load_dwordx4 v13, s[8:11], s7 offen sc1 lds
    s_add_u32 m0, s73, 132096
    s_add_u32 s7, s85, 0
    buffer_load_dwordx4 v13, s[8:11], s7 offen sc1 lds
    s_add_u32 m0, s73, 133120
    s_add_u32 s7, s86, 0
    buffer_load_dwordx4 v13, s[8:11], s7 offen sc1 lds
    s_add_u32 m0, s73, 134144
    s_add_u32 s7, s87, 0
    buffer_load_dwordx4 v13, s[8:11], s7 offen sc1 lds
    s_add_u32 m0, s73, 135168
    s_add_u32 s7, s88, 0
    buffer_load_dwordx4 v13, s[8:11], s7 offen sc1 lds
    s_add_u32 m0, s73, 136192
    s_add_u32 s7, s84, 40960
    buffer_load_dwordx4 v13, s[8:11], s7 offen sc1 lds
    s_add_u32 m0, s73, 137216
    s_add_u32 s7, s85, 40960
    buffer_load_dwordx4 v13, s[8:11], s7 offen sc1 lds
    s_add_u32 m0, s73, 138240
    s_add_u32 s7, s86, 40960
    buffer_load_dwordx4 v13, s[8:11], s7 offen sc1 lds
    s_add_u32 m0, s75, 0
    s_add_u32 s7, s87, 40960
    buffer_load_dwordx4 v13, s[8:11], s7 offen sc1 lds
    s_add_u32 m0, s75, 1024
    s_add_u32 s7, s88, 40960
    buffer_load_dwordx4 v13, s[8:11], s7 offen sc1 lds
    s_add_u32 m0, s75, 2048
    s_add_u32 s7, s84, 81920
    buffer_load_dwordx4 v13, s[8:11], s7 offen sc1 lds
    s_add_u32 m0, s75, 3072
    s_add_u32 s7, s85, 81920
    buffer_load_dwordx4 v13, s[8:11], s7 offen sc1 lds
    s_add_u32 m0, s75, 4096
    s_add_u32 s7, s86, 81920
    buffer_load_dwordx4 v13, s[8:11], s7 offen sc1 lds
    s_add_u32 m0, s75, 5120
    s_add_u32 s7, s87, 81920
    buffer_load_dwordx4 v13, s[8:11], s7 offen sc1 lds
    s_add_u32 m0, s75, 6144
    s_add_u32 s7, s88, 81920
    buffer_load_dwordx4 v13, s[8:11], s7 offen sc1 lds
    s_add_u32 m0, s75, 7168
    s_add_u32 s7, s84, 122880
    buffer_load_dwordx4 v13, s[8:11], s7 offen sc1 lds
    s_lshl_b32 s75, s3, 12
    s_add_u32 s75, s75, s78
    s_add_u32 m0, s75, 49152
    s_add_u32 s7, s85, 122880
    buffer_load_dwordx4 v13, s[8:11], s7 offen sc1 lds
    s_add_u32 m0, s75, 50176
    s_add_u32 s7, s86, 122880
    buffer_load_dwordx4 v13, s[8:11], s7 offen sc1 lds
    s_add_u32 m0, s75, 51200
    s_add_u32 s7, s87, 122880
    buffer_load_dwordx4 v13, s[8:11], s7 offen sc1 lds
    s_add_u32 m0, s75, 52224
    s_add_u32 s7, s88, 122880
    buffer_load_dwordx4 v13, s[8:11], s7 offen sc1 lds
    s_setpc_b64 s[82:83]
L_x3:
    s_mov_b32 s12, s48
    s_mov_b32 s13, s49
    s_mov_b32 s14, 0x21c000
    s_mov_b32 s15, 0x20000
    s_cmp_eq_u32 s3, 3
    s_cbranch_scc1 L_load_r
    s_cmp_eq_u32 s3, 1
    s_cselect_b32 s12, s50, s12
    s_cselect_b32 s13, s51, s13
    s_cmp_eq_u32 s3, 2
    s_cselect_b32 s12, s52, s12
    s_cselect_b32 s13, s53, s13
    s_mov_b32 s73, 3456
    s_cmov_b32 s73, 256
    s_mov_b32 s75, 256
    s_cmov_b32 s75, 163840
    s_lshr_b32 s6, s2, 3
    s_sub_u32 s6, s6, 16
    s_mul_i32 s6, s6, 40
    v_lshrrev_b32 v2, 2, v1
    v_add_u32 v2, s6, v2
    v_mul_lo_u32 v2, v2, s73
    v_and_b32 v3, 3, v1
    v_lshl_add_u32 v2, v3, 6, v2
    s_xor_b32 s79, s79, 1
    s_lshl_b32 s6, s79, 3
    s_lshr_b32 s7, s4, 2
    s_add_u32 s6, s6, s7
    s_mul_i32 s6, s6, s75
    v_mov_b32 v3, 0x5000000
    v_cmp_gt_u32 vcc, 32, v1
    s_lshl_b32 s73, s73, 4
    s_nop 0
    v_cndmask_b32 v3, v3, v2, vcc
    buffer_load_dword v11, v2, s[12:15], s6 offen
    s_add_u32 s7, s6, s73
    buffer_load_dword v11, v2, s[12:15], s7 offen
    s_add_u32 s7, s7, s73
    buffer_load_dword v11, v3, s[12:15], s7 offen
    s_setpc_b64 s[82:83]
L_mask:
    v_and_b32 v2, 15, v1
    v_lshrrev_b32 v3, 4, v1
    v_lshlrev_b32 v3, 2, v3
    v_sub_u32 v2, v2, v3
    v_mov_b32 v3, 0xff800000
    v_cmp_gt_i32 vcc, 0, v2
    v_mov_b32 v152, v3
    s_nop 0
    v_cndmask_b32 v144, v144, v3, vcc
    v_cndmask_b32 v156, v156, v3, vcc
    v_cmp_gt_i32 vcc, 1, v2
    v_mov_b32 v153, v3
    s_nop 0
    v_cndmask_b32 v145, v145, v3, vcc
    v_cndmask_b32 v157, v157, v3, vcc
    v_cmp_gt_i32 vcc, 2, v2
    v_mov_b32 v154, v3
    s_nop 0
    v_cndmask_b32 v146, v146, v3, vcc
    v_cndmask_b32 v158, v158, v3, vcc
    v_cmp_gt_i32 vcc, 3, v2
    v_mov_b32 v155, v3
    s_nop 0
    v_cndmask_b32 v147, v147, v3, vcc
    v_cndmask_b32 v159, v159, v3, vcc
    s_nop 1
    s_setpc_b64 s[82:83]
L_rare0:
    s_nop 15
    v_max_f32 v62, v64, v65
    v_max3_f32 v62, v62, v66, v67
    v_max3_f32 v62, v62, v72, v73
    v_max3_f32 v62, v62, v74, v75
    v_mov_b32 v58, v62
    s_nop 1
    v_permlane16_swap_b32 v62, v58
    s_nop 1
    v_max_f32 v62, v62, v58
    v_mov_b32 v58, v62
    s_nop 1
    v_permlane32_swap_b32 v62, v58
    s_nop 1
    v_max_f32 v62, v62, v58
    v_add_f32 v62, 0x41c00000, v62
    v_max_f32 v62, 0, v62
    v_exp_f32 v58, -v62
    v_sub_f32 v64, v64, v62
    v_sub_f32 v80, v80, v62
    v_sub_f32 v144, v144, v62
    v_sub_f32 v65, v65, v62
    v_sub_f32 v81, v81, v62
    v_sub_f32 v145, v145, v62
    v_sub_f32 v66, v66, v62
    v_sub_f32 v82, v82, v62
    v_sub_f32 v146, v146, v62
    v_sub_f32 v67, v67, v62
    v_sub_f32 v83, v83, v62
    v_sub_f32 v147, v147, v62
    v_sub_f32 v72, v72, v62
    v_sub_f32 v88, v88, v62
    v_sub_f32 v152, v152, v62
    v_sub_f32 v73, v73, v62
    v_sub_f32 v89, v89, v62
    v_sub_f32 v153, v153, v62
    v_sub_f32 v74, v74, v62
    v_sub_f32 v90, v90, v62
    v_sub_f32 v154, v154, v62
    v_sub_f32 v75, v75, v62
    v_sub_f32 v91, v91, v62
    v_sub_f32 v155, v155, v62
    v_mul_f32 v160, v58, v160
    v_mul_f32 v161, v58, v161
    v_mul_f32 v162, v58, v162
    v_mul_f32 v163, v58, v163
    v_mul_f32 v192, v58, v192
    v_mul_f32 v193, v58, v193
    v_mul_f32 v194, v58, v194
    v_mul_f32 v195, v58, v195
    v_mul_f32 v200, v58, v200
    v_mul_f32 v201, v58, v201
    v_mul_f32 v202, v58, v202
    v_mul_f32 v203, v58, v203
    v_mul_f32 v208, v58, v208
    v_mul_f32 v209, v58, v209
    v_mul_f32 v210, v58, v210
    v_mul_f32 v211, v58, v211
    v_mul_f32 v216, v58, v216
    v_mul_f32 v217, v58, v217
    v_mul_f32 v218, v58, v218
    v_mul_f32 v219, v58, v219
    v_mul_f32 v224, v58, v224
    v_mul_f32 v225, v58, v225
    v_mul_f32 v226, v58, v226
    v_mul_f32 v227, v58, v227
    v_mul_f32 v232, v58, v232
    v_mul_f32 v233, v58, v233
    v_mul_f32 v234, v58, v234
    v_mul_f32 v235, v58, v235
    v_mul_f32 v240, v58, v240
    v_mul_f32 v241, v58, v241
    v_mul_f32 v242, v58, v242
    v_mul_f32 v243, v58, v243
    v_mul_f32 v248, v58, v248
    v_mul_f32 v249, v58, v249
    v_mul_f32 v250, v58, v250
    v_mul_f32 v251, v58, v251
    v_max_f32 v62, v68, v69
    v_max3_f32 v62, v62, v70, v71
    v_max3_f32 v62, v62, v76, v77
    v_max3_f32 v62, v62, v78, v79
    v_mov_b32 v58, v62
    s_nop 1
    v_permlane16_swap_b32 v62, v58
    s_nop 1
    v_max_f32 v62, v62, v58
    v_mov_b32 v58, v62
    s_nop 1
    v_permlane32_swap_b32 v62, v58
    s_nop 1
    v_max_f32 v62, v62, v58
    v_add_f32 v62, 0x41c00000, v62
    v_max_f32 v62, 0, v62
    v_exp_f32 v58, -v62
    v_sub_f32 v68, v68, v62
    v_sub_f32 v84, v84, v62
    v_sub_f32 v148, v148, v62
    v_sub_f32 v69, v69, v62
    v_sub_f32 v85, v85, v62
    v_sub_f32 v149, v149, v62
    v_sub_f32 v70, v70, v62
    v_sub_f32 v86, v86, v62
    v_sub_f32 v150, v150, v62
    v_sub_f32 v71, v71, v62
    v_sub_f32 v87, v87, v62
    v_sub_f32 v151, v151, v62
    v_sub_f32 v76, v76, v62
    v_sub_f32 v92, v92, v62
    v_sub_f32 v156, v156, v62
    v_sub_f32 v77, v77, v62
    v_sub_f32 v93, v93, v62
    v_sub_f32 v157, v157, v62
    v_sub_f32 v78, v78, v62
    v_sub_f32 v94, v94, v62
    v_sub_f32 v158, v158, v62
    v_sub_f32 v79, v79, v62
    v_sub_f32 v95, v95, v62
    v_sub_f32 v159, v159, v62
    v_mul_f32 v164, v58, v164
    v_mul_f32 v165, v58, v165
    v_mul_f32 v166, v58, v166
    v_mul_f32 v167, v58, v167
    v_mul_f32 v196, v58, v196
    v_mul_f32 v197, v58, v197
    v_mul_f32 v198, v58, v198
    v_mul_f32 v199, v58, v199
    v_mul_f32 v204, v58, v204
    v_mul_f32 v205, v58, v205
    v_mul_f32 v206, v58, v206
    v_mul_f32 v207, v58, v207
    v_mul_f32 v212, v58, v212
    v_mul_f32 v213, v58, v213
    v_mul_f32 v214, v58, v214
    v_mul_f32 v215, v58, v215
    v_mul_f32 v220, v58, v220
    v_mul_f32 v221, v58, v221
    v_mul_f32 v222, v58, v222
    v_mul_f32 v223, v58, v223
    v_mul_f32 v228, v58, v228
    v_mul_f32 v229, v58, v229
    v_mul_f32 v230, v58, v230
    v_mul_f32 v231, v58, v231
    v_mul_f32 v236, v58, v236
    v_mul_f32 v237, v58, v237
    v_mul_f32 v238, v58, v238
    v_mul_f32 v239, v58, v239
    v_mul_f32 v244, v58, v244
    v_mul_f32 v245, v58, v245
    v_mul_f32 v246, v58, v246
    v_mul_f32 v247, v58, v247
    v_mul_f32 v252, v58, v252
    v_mul_f32 v253, v58, v253
    v_mul_f32 v254, v58, v254
    v_mul_f32 v255, v58, v255
    v_exp_f32 v58, v64
    s_nop 0
    v_exp_f32 v59, v65
    s_nop 0
    v_cvt_pk_bf16_f32 v128, v58, v59
    v_exp_f32 v60, v66
    s_nop 0
    v_exp_f32 v61, v67
    s_nop 0
    v_cvt_pk_bf16_f32 v129, v60, v61
    v_exp_f32 v58, v68
    s_nop 0
    v_exp_f32 v59, v69
    s_nop 0
    v_cvt_pk_bf16_f32 v132, v58, v59
    v_exp_f32 v60, v70
    s_nop 0
    v_exp_f32 v61, v71
    s_nop 0
    v_cvt_pk_bf16_f32 v133, v60, v61
    v_exp_f32 v58, v72
    s_nop 0
    v_exp_f32 v59, v73
    s_nop 0
    v_cvt_pk_bf16_f32 v130, v58, v59
    v_exp_f32 v60, v74
    s_nop 0
    v_exp_f32 v61, v75
    s_nop 0
    v_cvt_pk_bf16_f32 v131, v60, v61
    v_exp_f32 v58, v76
    s_nop 0
    v_exp_f32 v59, v77
    s_nop 0
    v_cvt_pk_bf16_f32 v134, v58, v59
    v_exp_f32 v60, v78
    s_nop 0
    v_exp_f32 v61, v79
    s_nop 0
    v_cvt_pk_bf16_f32 v135, v60, v61
    s_nop 1
    s_setpc_b64 s[80:81]
L_rare1:
    s_nop 15
    v_max_f32 v62, v80, v81
    v_max3_f32 v62, v62, v82, v83
    v_max3_f32 v62, v62, v88, v89
    v_max3_f32 v62, v62, v90, v91
    v_mov_b32 v58, v62
    s_nop 1
    v_permlane16_swap_b32 v62, v58
    s_nop 1
    v_max_f32 v62, v62, v58
    v_mov_b32 v58, v62
    s_nop 1
    v_permlane32_swap_b32 v62, v58
    s_nop 1
    v_max_f32 v62, v62, v58
    v_add_f32 v62, 0x41c00000, v62
    v_max_f32 v62, 0, v62
    v_exp_f32 v58, -v62
    v_sub_f32 v64, v64, v62
    v_sub_f32 v80, v80, v62
    v_sub_f32 v144, v144, v62
    v_sub_f32 v65, v65, v62
    v_sub_f32 v81, v81, v62
    v_sub_f32 v145, v145, v62
    v_sub_f32 v66, v66, v62
    v_sub_f32 v82, v82, v62
    v_sub_f32 v146, v146, v62
    v_sub_f32 v67, v67, v62
    v_sub_f32 v83, v83, v62
    v_sub_f32 v147, v147, v62
    v_sub_f32 v72, v72, v62
    v_sub_f32 v88, v88, v62
    v_sub_f32 v152, v152, v62
    v_sub_f32 v73, v73, v62
    v_sub_f32 v89, v89, v62
    v_sub_f32 v153, v153, v62
    v_sub_f32 v74, v74, v62
    v_sub_f32 v90, v90, v62
    v_sub_f32 v154, v154, v62
    v_sub_f32 v75, v75, v62
    v_sub_f32 v91, v91, v62
    v_sub_f32 v155, v155, v62
    v_mul_f32 v160, v58, v160
    v_mul_f32 v161, v58, v161
    v_mul_f32 v162, v58, v162
    v_mul_f32 v163, v58, v163
    v_mul_f32 v192, v58, v192
    v_mul_f32 v193, v58, v193
    v_mul_f32 v194, v58, v194
    v_mul_f32 v195, v58, v195
    v_mul_f32 v200, v58, v200
    v_mul_f32 v201, v58, v201
    v_mul_f32 v202, v58, v202
    v_mul_f32 v203, v58, v203
    v_mul_f32 v208, v58, v208
    v_mul_f32 v209, v58, v209
    v_mul_f32 v210, v58, v210
    v_mul_f32 v211, v58, v211
    v_mul_f32 v216, v58, v216
    v_mul_f32 v217, v58, v217
    v_mul_f32 v218, v58, v218
    v_mul_f32 v219, v58, v219
    v_mul_f32 v224, v58, v224
    v_mul_f32 v225, v58, v225
    v_mul_f32 v226, v58, v226
    v_mul_f32 v227, v58, v227
    v_mul_f32 v232, v58, v232
    v_mul_f32 v233, v58, v233
    v_mul_f32 v234, v58, v234
    v_mul_f32 v235, v58, v235
    v_mul_f32 v240, v58, v240
    v_mul_f32 v241, v58, v241
    v_mul_f32 v242, v58, v242
    v_mul_f32 v243, v58, v243
    v_mul_f32 v248, v58, v248
    v_mul_f32 v249, v58, v249
    v_mul_f32 v250, v58, v250
    v_mul_f32 v251, v58, v251
    v_max_f32 v62, v84, v85
    v_max3_f32 v62, v62, v86, v87
    v_max3_f32 v62, v62, v92, v93
    v_max3_f32 v62, v62, v94, v95
    v_mov_b32 v58, v62
    s_nop 1
    v_permlane16_swap_b32 v62, v58
    s_nop 1
    v_max_f32 v62, v62, v58
    v_mov_b32 v58, v62
    s_nop 1
    v_permlane32_swap_b32 v62, v58
    s_nop 1
    v_max_f32 v62, v62, v58
    v_add_f32 v62, 0x41c00000, v62
    v_max_f32 v62, 0, v62
    v_exp_f32 v58, -v62
    v_sub_f32 v68, v68, v62
    v_sub_f32 v84, v84, v62
    v_sub_f32 v148, v148, v62
    v_sub_f32 v69, v69, v62
    v_sub_f32 v85, v85, v62
    v_sub_f32 v149, v149, v62
    v_sub_f32 v70, v70, v62
    v_sub_f32 v86, v86, v62
    v_sub_f32 v150, v150, v62
    v_sub_f32 v71, v71, v62
    v_sub_f32 v87, v87, v62
    v_sub_f32 v151, v151, v62
    v_sub_f32 v76, v76, v62
    v_sub_f32 v92, v92, v62
    v_sub_f32 v156, v156, v62
    v_sub_f32 v77, v77, v62
    v_sub_f32 v93, v93, v62
    v_sub_f32 v157, v157, v62
    v_sub_f32 v78, v78, v62
    v_sub_f32 v94, v94, v62
    v_sub_f32 v158, v158, v62
    v_sub_f32 v79, v79, v62
    v_sub_f32 v95, v95, v62
    v_sub_f32 v159, v159, v62
    v_mul_f32 v164, v58, v164
    v_mul_f32 v165, v58, v165
    v_mul_f32 v166, v58, v166
    v_mul_f32 v167, v58, v167
    v_mul_f32 v196, v58, v196
    v_mul_f32 v197, v58, v197
    v_mul_f32 v198, v58, v198
    v_mul_f32 v199, v58, v199
    v_mul_f32 v204, v58, v204
    v_mul_f32 v205, v58, v205
    v_mul_f32 v206, v58, v206
    v_mul_f32 v207, v58, v207
    v_mul_f32 v212, v58, v212
    v_mul_f32 v213, v58, v213
    v_mul_f32 v214, v58, v214
    v_mul_f32 v215, v58, v215
    v_mul_f32 v220, v58, v220
    v_mul_f32 v221, v58, v221
    v_mul_f32 v222, v58, v222
    v_mul_f32 v223, v58, v223
    v_mul_f32 v228, v58, v228
    v_mul_f32 v229, v58, v229
    v_mul_f32 v230, v58, v230
    v_mul_f32 v231, v58, v231
    v_mul_f32 v236, v58, v236
    v_mul_f32 v237, v58, v237
    v_mul_f32 v238, v58, v238
    v_mul_f32 v239, v58, v239
    v_mul_f32 v244, v58, v244
    v_mul_f32 v245, v58, v245
    v_mul_f32 v246, v58, v246
    v_mul_f32 v247, v58, v247
    v_mul_f32 v252, v58, v252
    v_mul_f32 v253, v58, v253
    v_mul_f32 v254, v58, v254
    v_mul_f32 v255, v58, v255
    v_exp_f32 v58, v80
    s_nop 0
    v_exp_f32 v59, v81
    s_nop 0
    v_cvt_pk_bf16_f32 v136, v58, v59
    v_exp_f32 v60, v82
    s_nop 0
    v_exp_f32 v61, v83
    s_nop 0
    v_cvt_pk_bf16_f32 v137, v60, v61
    v_exp_f32 v58, v84
    s_nop 0
    v_exp_f32 v59, v85
    s_nop 0
    v_cvt_pk_bf16_f32 v140, v58, v59
    v_exp_f32 v60, v86
    s_nop 0
    v_exp_f32 v61, v87
    s_nop 0
    v_cvt_pk_bf16_f32 v141, v60, v61
    v_exp_f32 v58, v88
    s_nop 0
    v_exp_f32 v59, v89
    s_nop 0
    v_cvt_pk_bf16_f32 v138, v58, v59
    v_exp_f32 v60, v90
    s_nop 0
    v_exp_f32 v61, v91
    s_nop 0
    v_cvt_pk_bf16_f32 v139, v60, v61
    v_exp_f32 v58, v92
    s_nop 0
    v_exp_f32 v59, v93
    s_nop 0
    v_cvt_pk_bf16_f32 v142, v58, v59
    v_exp_f32 v60, v94
    s_nop 0
    v_exp_f32 v61, v95
    s_nop 0
    v_cvt_pk_bf16_f32 v143, v60, v61
    s_nop 1
    s_setpc_b64 s[80:81]
L_adone:
    s_barrier
    ds_read_b128 v[16:19], v4 offset:0
    ds_read_b128 v[20:23], v4 offset:1024
    ds_read_b128 v[24:27], v4 offset:2048
    ds_read_b128 v[28:31], v4 offset:3072
    s_waitcnt lgkmcnt(3)
    v_mfma_f32_16x16x32_bf16 v[56:59], v[96:99], v[16:19], 0
    v_mfma_f32_16x16x32_bf16 v[60:63], v[100:103], v[16:19], 0
    v_mfma_f32_16x16x32_bf16 v[64:67], v[104:107], v[16:19], 0
    v_mfma_f32_16x16x32_bf16 v[68:71], v[108:111], v[16:19], 0
    s_waitcnt lgkmcnt(2)
    v_mfma_f32_16x16x32_bf16 v[72:75], v[112:115], v[16:19], 0
    ds_read_b128 v[16:19], v4 offset:4096
    s_cmp_lt_u32 s3, 4
    s_cbranch_scc1 L_nowl_52
    s_add_u32 s75, s69, 204800
    buffer_load_dwordx4 v[196:199], v44, s[8:11], s75 offen sc1
    buffer_load_dwordx4 v[200:203], v45, s[8:11], s75 offen sc1
    buffer_load_dwordx4 v[204:207], v46, s[8:11], s75 offen sc1
    buffer_load_dwordx4 v[208:211], v47, s[8:11], s75 offen sc1
    buffer_load_dwordx4 v[212:215], v52, s[8:11], s75 offen sc1
L_nowl_52:
    v_mfma_f32_16x16x32_bf16 v[56:59], v[116:119], v[20:23], v[56:59]
    v_mfma_f32_16x16x32_bf16 v[60:63], v[120:123], v[20:23], v[60:63]
    v_mfma_f32_16x16x32_bf16 v[64:67], v[124:127], v[20:23], v[64:67]
    v_mfma_f32_16x16x32_bf16 v[68:71], v[128:131], v[20:23], v[68:71]
    s_waitcnt lgkmcnt(2)
    v_mfma_f32_16x16x32_bf16 v[72:75], v[132:135], v[20:23], v[72:75]
    ds_read_b128 v[20:23], v4 offset:5120
    s_cmp_lt_u32 s3, 4
    s_cbranch_scc1 L_nowl_53
    s_add_u32 s75, s69, 245760
    buffer_load_dwordx4 v[216:219], v44, s[8:11], s75 offen sc1
    buffer_load_dwordx4 v[220:223], v45, s[8:11], s75 offen sc1
    buffer_load_dwordx4 v[224:227], v46, s[8:11], s75 offen sc1
    buffer_load_dwordx4 v[228:231], v47, s[8:11], s75 offen sc1
    buffer_load_dwordx4 v[232:235], v52, s[8:11], s75 offen sc1
L_nowl_53:
    v_mfma_f32_16x16x32_bf16 v[72:75], v[152:155], v[24:27], v[72:75]
    v_mfma_f32_16x16x32_bf16 v[68:71], v[148:151], v[24:27], v[68:71]
    s_add_u32 s65, s68, 3
    s_and_b32 s65, s65, 3
    s_andn2_b32 s7, s68, 3
    v_mfma_f32_16x16x32_bf16 v[64:67], v[144:147], v[24:27], v[64:67]
    s_add_u32 s65, s65, s7
    s_lshl_b32 s65, s65, 17
    s_add_u32 s65, s65, s66
    v_mfma_f32_16x16x32_bf16 v[60:63], v[140:143], v[24:27], v[60:63]
    s_waitcnt lgkmcnt(2)
    s_add_u32 m0, s99, 65536
    v_mfma_f32_16x16x32_bf16 v[56:59], v[136:139], v[24:27], v[56:59]
    ds_read_b128 v[24:27], v4 offset:6144
    s_cmp_lt_u32 s3, 4
    s_cbranch_scc1 L_nowl_54
    s_add_u32 s75, s69, 286720
    buffer_load_dwordx4 v[236:239], v44, s[8:11], s75 offen sc1
    buffer_load_dwordx4 v[240:243], v45, s[8:11], s75 offen sc1
    buffer_load_dwordx4 v[244:247], v46, s[8:11], s75 offen sc1
    buffer_load_dwordx4 v[248:251], v47, s[8:11], s75 offen sc1
    buffer_load_dwordx4 v[252:255], v52, s[8:11], s75 offen sc1
L_nowl_54:
    v_mfma_f32_16x16x32_bf16 v[56:59], v[156:159], v[28:31], v[56:59]
    buffer_load_dwordx4 v13, s[8:11], s65 offen offset:0 sc1 lds
    v_mfma_f32_16x16x32_bf16 v[60:63], v[160:163], v[28:31], v[60:63]
    buffer_load_dwordx4 v13, s[8:11], s65 offen offset:1024 sc1 lds
    v_mfma_f32_16x16x32_bf16 v[64:67], v[164:167], v[28:31], v[64:67]
    buffer_load_dwordx4 v13, s[8:11], s65 offen offset:2048 sc1 lds
    v_mfma_f32_16x16x32_bf16 v[68:71], v[168:171], v[28:31], v[68:71]
    buffer_load_dwordx4 v13, s[8:11], s65 offen offset:3072 sc1 lds
    s_waitcnt lgkmcnt(2)
    v_mfma_f32_16x16x32_bf16 v[72:75], v[172:175], v[28:31], v[72:75]
    ds_read_b128 v[28:31], v4 offset:7168
    s_waitcnt vmcnt(20)
    v_mfma_f32_16x16x32_bf16 v[72:75], v[192:195], v[16:19], v[72:75]
    v_mfma_f32_16x16x32_bf16 v[68:71], v[188:191], v[16:19], v[68:71]
    v_mfma_f32_16x16x32_bf16 v[64:67], v[184:187], v[16:19], v[64:67]
    v_mfma_f32_16x16x32_bf16 v[60:63], v[180:183], v[16:19], v[60:63]
    s_waitcnt lgkmcnt(2)
    v_mfma_f32_16x16x32_bf16 v[56:59], v[176:179], v[16:19], v[56:59]
    s_cmp_ge_u32 s3, 4
    s_cbranch_scc1 L_o0
    s_waitcnt vmcnt(4)
L_o0:
    s_waitcnt lgkmcnt(0)
    s_barrier
    ds_read_b128 v[16:19], v4 offset:32768
    s_waitcnt vmcnt(14)
    v_mfma_f32_16x16x32_bf16 v[56:59], v[196:199], v[20:23], v[56:59]
    v_mfma_f32_16x16x32_bf16 v[60:63], v[200:203], v[20:23], v[60:63]
    v_mfma_f32_16x16x32_bf16 v[64:67], v[204:207], v[20:23], v[64:67]
    v_mfma_f32_16x16x32_bf16 v[68:71], v[208:211], v[20:23], v[68:71]
    v_mfma_f32_16x16x32_bf16 v[72:75], v[212:215], v[20:23], v[72:75]
    ds_read_b128 v[20:23], v4 offset:33792
    s_waitcnt vmcnt(9)
    v_mfma_f32_16x16x32_bf16 v[72:75], v[232:235], v[24:27], v[72:75]
    v_mfma_f32_16x16x32_bf16 v[68:71], v[228:231], v[24:27], v[68:71]
    v_mfma_f32_16x16x32_bf16 v[64:67], v[224:227], v[24:27], v[64:67]
    v_mfma_f32_16x16x32_bf16 v[60:63], v[220:223], v[24:27], v[60:63]
    v_mfma_f32_16x16x32_bf16 v[56:59], v[216:219], v[24:27], v[56:59]
    ds_read_b128 v[24:27], v4 offset:34816
    s_waitcnt vmcnt(4)
    v_mfma_f32_16x16x32_bf16 v[56:59], v[236:239], v[28:31], v[56:59]
    v_mfma_f32_16x16x32_bf16 v[60:63], v[240:243], v[28:31], v[60:63]
    v_mfma_f32_16x16x32_bf16 v[64:67], v[244:247], v[28:31], v[64:67]
    v_mfma_f32_16x16x32_bf16 v[68:71], v[248:251], v[28:31], v[68:71]
    s_waitcnt lgkmcnt(2)
    v_mfma_f32_16x16x32_bf16 v[72:75], v[252:255], v[28:31], v[72:75]
    ds_read_b128 v[28:31], v4 offset:35840
    v_mfma_f32_16x16x32_bf16 v[76:79], v[96:99], v[16:19], 0
    s_sub_u32 s6, s71, 1
    s_and_b32 s6, s6, 3
    s_mul_i32 s7, s6, 5120
    v_mfma_f32_16x16x32_bf16 v[80:83], v[100:103], v[16:19], 0
    s_add_u32 s7, s7, s67
    s_cmp_eq_u32 s6, 3
    s_cselect_b32 s7, 155648, s7
    v_mfma_f32_16x16x32_bf16 v[84:87], v[104:107], v[16:19], 0
    v_add_u32 v12, s7, v52
    v_add_u32 v5, s67, v45
    v_mfma_f32_16x16x32_bf16 v[88:91], v[108:111], v[16:19], 0
    s_waitcnt lgkmcnt(2)
    v_mfma_f32_16x16x32_bf16 v[92:95], v[112:115], v[16:19], 0
    ds_read_b128 v[16:19], v4 offset:36864
    v_mfma_f32_16x16x32_bf16 v[76:79], v[116:119], v[20:23], v[76:79]
    ds_write_b128 v5, v[60:63] offset:0
    v_add_u32 v5, s67, v46
    v_mfma_f32_16x16x32_bf16 v[80:83], v[120:123], v[20:23], v[80:83]
    v_mfma_f32_16x16x32_bf16 v[84:87], v[124:127], v[20:23], v[84:87]
    v_mfma_f32_16x16x32_bf16 v[88:91], v[128:131], v[20:23], v[88:91]
    s_waitcnt lgkmcnt(3)
    v_mfma_f32_16x16x32_bf16 v[92:95], v[132:135], v[20:23], v[92:95]
    ds_read_b128 v[20:23], v4 offset:37888
    v_mfma_f32_16x16x32_bf16 v[92:95], v[152:155], v[24:27], v[92:95]
    ds_write_b128 v5, v[64:67] offset:5120
    v_add_u32 v5, s67, v47
    v_mfma_f32_16x16x32_bf16 v[88:91], v[148:151], v[24:27], v[88:91]
    v_mfma_f32_16x16x32_bf16 v[84:87], v[144:147], v[24:27], v[84:87]
    v_mfma_f32_16x16x32_bf16 v[80:83], v[140:143], v[24:27], v[80:83]
    s_waitcnt lgkmcnt(4)
    v_mfma_f32_16x16x32_bf16 v[76:79], v[136:139], v[24:27], v[76:79]
    ds_read_b128 v[24:27], v4 offset:38912
    v_mfma_f32_16x16x32_bf16 v[76:79], v[156:159], v[28:31], v[76:79]
    ds_write_b128 v5, v[68:71] offset:10240
    v_add_u32 v5, s67, v52
    v_mfma_f32_16x16x32_bf16 v[80:83], v[160:163], v[28:31], v[80:83]
    v_mfma_f32_16x16x32_bf16 v[84:87], v[164:167], v[28:31], v[84:87]
    v_mfma_f32_16x16x32_bf16 v[88:91], v[168:171], v[28:31], v[88:91]
    s_waitcnt lgkmcnt(5)
    v_mfma_f32_16x16x32_bf16 v[92:95], v[172:175], v[28:31], v[92:95]
    ds_read_b128 v[28:31], v4 offset:39936
    v_mfma_f32_16x16x32_bf16 v[92:95], v[192:195], v[16:19], v[92:95]
    ds_write_b128 v12, v[72:75] offset:0
    v_mfma_f32_16x16x32_bf16 v[88:91], v[188:191], v[16:19], v[88:91]
    v_mfma_f32_16x16x32_bf16 v[84:87], v[184:187], v[16:19], v[84:87]
    v_and_b32 v3, 1, v1
    v_lshlrev_b32 v3, 12, v3
    s_lshr_b32 s72, s61, 2
    s_lshl_b32 s72, s72, 6
    s_andn2_b32 s6, s4, 7
    s_add_u32 s72, s72, s6
    s_add_u32 s72, s72, s3
    s_lshl_b32 s72, s72, 7
    s_add_u32 s72, s72, 3932160
    v_mfma_f32_16x16x32_bf16 v[80:83], v[180:183], v[16:19], v[80:83]
    s_waitcnt lgkmcnt(5)
    v_mfma_f32_16x16x32_bf16 v[76:79], v[176:179], v[16:19], v[76:79]
    s_waitcnt vmcnt(0)
    s_waitcnt lgkmcnt(0)
    s_barrier
    ds_read_b128 v[32:35], v6 offset:0
    ds_read_b128 v[36:39], v6 offset:5120
    ds_read_b128 v[40:43], v6 offset:10240
    ds_read_b128 v[16:19], v7 offset:0
    v_mfma_f32_16x16x32_bf16 v[76:79], v[196:199], v[20:23], v[76:79]
    v_mfma_f32_16x16x32_bf16 v[80:83], v[200:203], v[20:23], v[80:83]
    v_mfma_f32_16x16x32_bf16 v[84:87], v[204:207], v[20:23], v[84:87]
    s_waitcnt lgkmcnt(3)
    v_add_f32 v56, v56, v32
    v_add_f32 v57, v57, v33
    v_mfma_f32_16x16x32_bf16 v[88:91], v[208:211], v[20:23], v[88:91]
    v_add_f32 v58, v58, v34
    v_add_f32 v59, v59, v35
    v_mfma_f32_16x16x32_bf16 v[92:95], v[212:215], v[20:23], v[92:95]
    s_waitcnt lgkmcnt(2)
    ds_read_b128 v[32:35], v5 offset:0
    ds_read_b128 v[20:23], v7 offset:1024
    v_add_f32 v56, v56, v36
    v_add_f32 v57, v57, v37
    v_mfma_f32_16x16x32_bf16 v[92:95], v[232:235], v[24:27], v[92:95]
    buffer_load_dword v50, v3, s[8:11], s72 offen sc1
    v_add_f32 v58, v58, v38
    v_add_f32 v59, v59, v39
    v_mfma_f32_16x16x32_bf16 v[88:91], v[228:231], v[24:27], v[88:91]
    s_waitcnt lgkmcnt(3)
    ds_read_b128 v[36:39], v5 offset:5120
    v_add_f32 v56, v56, v40
    v_add_f32 v57, v57, v41
    v_mfma_f32_16x16x32_bf16 v[84:87], v[224:227], v[24:27], v[84:87]
    v_add_f32 v58, v58, v42
    v_add_f32 v59, v59, v43
    v_mfma_f32_16x16x32_bf16 v[80:83], v[220:223], v[24:27], v[80:83]
    ds_read_b128 v[40:43], v5 offset:10240
    s_waitcnt lgkmcnt(3)
    v_add_f32 v72, v72, v32
    v_add_f32 v73, v73, v33
    s_add_u32 s6, s96, 0
    v_mfma_f32_16x16x32_bf16 v[76:79], v[216:219], v[24:27], v[76:79]
    ds_read_b128 v[24:27], v7 offset:2048
    v_add_f32 v74, v74, v34
    v_add_f32 v75, v75, v35
    v_mfma_f32_16x16x32_bf16 v[76:79], v[236:239], v[28:31], v[76:79]
    buffer_store_dwordx4 v[56:59], v44, s[8:11], s6 offen sc1
    s_waitcnt lgkmcnt(2)
    v_add_f32 v72, v72, v36
    v_add_f32 v73, v73, v37
    v_mfma_f32_16x16x32_bf16 v[80:83], v[240:243], v[28:31], v[80:83]
    v_add_f32 v74, v74, v38
    v_add_f32 v75, v75, v39
    v_mfma_f32_16x16x32_bf16 v[84:87], v[244:247], v[28:31], v[84:87]
    s_waitcnt lgkmcnt(1)
    v_add_f32 v72, v72, v40
    v_add_f32 v73, v73, v41
    v_mfma_f32_16x16x32_bf16 v[88:91], v[248:251], v[28:31], v[88:91]
    v_add_f32 v74, v74, v42
    v_add_f32 v75, v75, v43
    s_cmp_lg_u32 s71, 0
    v_mfma_f32_16x16x32_bf16 v[92:95], v[252:255], v[28:31], v[92:95]
    s_cbranch_scc1 L_nost_55
    buffer_store_dwordx4 v[72:75], v52, s[8:11], s6 offen sc1
L_nost_55:
    ds_read_b128 v[28:31], v7 offset:3072
    v_mfma_f32_16x16x32_bf16 v[56:59], v[96:99], v[16:19], 0
    s_sub_u32 s6, s71, 2
    s_and_b32 s6, s6, 3
    s_mul_i32 s7, s6, 5120
    v_mfma_f32_16x16x32_bf16 v[60:63], v[100:103], v[16:19], 0
    s_add_u32 s7, s7, s67
    s_cmp_eq_u32 s6, 3
    s_cselect_b32 s7, 124928, s7
    v_mfma_f32_16x16x32_bf16 v[64:67], v[104:107], v[16:19], 0
    v_add_u32 v12, s7, v52
    v_add_u32 v5, s67, v45
    s_waitcnt vmcnt(1)
    v_cmp_ne_u32 vcc, 1, v50
    s_cbranch_vccz L_o1
    s_mov_b32 s79, 262144
L_poll_57:
    buffer_load_dword v2, v3, s[8:11], s72 offen sc1
    s_waitcnt vmcnt(0)
    v_cmp_ne_u32 vcc, 1, v2
    s_cbranch_vccz L_polldone_58
    s_sleep 1
    s_sub_u32 s79, s79, 1
    s_cmp_lg_u32 s79, 0
    s_cbranch_scc1 L_poll_57
L_polldone_58:
L_o1:
    v_mfma_f32_16x16x32_bf16 v[68:71], v[108:111], v[16:19], 0
    s_add_u32 s65, s61, 1
    s_and_b32 s65, s65, 3
    s_andn2_b32 s7, s61, 3
    v_mfma_f32_16x16x32_bf16 v[72:75], v[112:115], v[16:19], 0
    ds_read_b128 v[16:19], v7 offset:4096
    s_add_u32 s65, s65, s7
    s_lshl_b32 s65, s65, 17
    s_add_u32 s65, s65, s66
    v_mfma_f32_16x16x32_bf16 v[56:59], v[116:119], v[20:23], v[56:59]
    ds_write_b128 v5, v[80:83] offset:30720
    v_add_u32 v5, s67, v46
    s_add_u32 m0, s99, 0
    v_mfma_f32_16x16x32_bf16 v[60:63], v[120:123], v[20:23], v[60:63]
    buffer_load_dwordx4 v13, s[8:11], s65 offen offset:1024 sc1 lds
    buffer_load_dwordx4 v13, s[8:11], s65 offen offset:0 sc1 lds
    v_mfma_f32_16x16x32_bf16 v[64:67], v[124:127], v[20:23], v[64:67]
    buffer_load_dwordx4 v13, s[8:11], s65 offen offset:3072 sc1 lds
    buffer_load_dwordx4 v13, s[8:11], s65 offen offset:2048 sc1 lds
    v_mfma_f32_16x16x32_bf16 v[68:71], v[128:131], v[20:23], v[68:71]
    s_waitcnt lgkmcnt(3)
    s_add_u32 s65, s61, 2
    s_and_b32 s65, s65, 3
    s_andn2_b32 s7, s61, 3
    v_mfma_f32_16x16x32_bf16 v[72:75], v[132:135], v[20:23], v[72:75]
    ds_read_b128 v[20:23], v7 offset:5120
    s_add_u32 s65, s65, s7
    s_lshl_b32 s65, s65, 17
    s_add_u32 s65, s65, s66
    v_mfma_f32_16x16x32_bf16 v[72:75], v[152:155], v[24:27], v[72:75]
    ds_write_b128 v5, v[84:87] offset:35840
    v_add_u32 v5, s67, v47
    s_add_u32 m0, s99, 32768
    v_mfma_f32_16x16x32_bf16 v[68:71], v[148:151], v[24:27], v[68:71]
    buffer_load_dwordx4 v13, s[8:11], s65 offen offset:0 sc1 lds
    v_mfma_f32_16x16x32_bf16 v[64:67], v[144:147], v[24:27], v[64:67]
    buffer_load_dwordx4 v13, s[8:11], s65 offen offset:1024 sc1 lds
    v_mfma_f32_16x16x32_bf16 v[60:63], v[140:143], v[24:27], v[60:63]
    buffer_load_dwordx4 v13, s[8:11], s65 offen offset:2048 sc1 lds
    s_waitcnt lgkmcnt(4)
    v_mfma_f32_16x16x32_bf16 v[56:59], v[136:139], v[24:27], v[56:59]
    ds_read_b128 v[24:27], v7 offset:6144
    v_mfma_f32_16x16x32_bf16 v[56:59], v[156:159], v[28:31], v[56:59]
    ds_write_b128 v5, v[88:91] offset:40960
    v_add_u32 v5, s67, v52
    v_mfma_f32_16x16x32_bf16 v[60:63], v[160:163], v[28:31], v[60:63]
    buffer_load_dwordx4 v13, s[8:11], s65 offen offset:3072 sc1 lds
    v_mfma_f32_16x16x32_bf16 v[64:67], v[164:167], v[28:31], v[64:67]
    v_mfma_f32_16x16x32_bf16 v[68:71], v[168:171], v[28:31], v[68:71]
    s_waitcnt lgkmcnt(5)
    v_mfma_f32_16x16x32_bf16 v[72:75], v[172:175], v[28:31], v[72:75]
    ds_read_b128 v[28:31], v7 offset:7168
    v_mfma_f32_16x16x32_bf16 v[72:75], v[192:195], v[16:19], v[72:75]
    ds_write_b128 v12, v[92:95] offset:30720
    v_mfma_f32_16x16x32_bf16 v[68:71], v[188:191], v[16:19], v[68:71]
    s_add_u32 s65, s61, 3
    s_and_b32 s65, s65, 3
    s_andn2_b32 s7, s61, 3
    v_mfma_f32_16x16x32_bf16 v[64:67], v[184:187], v[16:19], v[64:67]
    s_add_u32 s65, s65, s7
    s_lshl_b32 s65, s65, 17
    s_add_u32 s65, s65, s66
    v_mfma_f32_16x16x32_bf16 v[60:63], v[180:183], v[16:19], v[60:63]
    s_waitcnt lgkmcnt(5)
    s_add_u32 m0, s99, 65536
    v_mfma_f32_16x16x32_bf16 v[56:59], v[176:179], v[16:19], v[56:59]
    s_waitcnt vmcnt(4)
    s_waitcnt lgkmcnt(0)
    s_barrier
    ds_read_b128 v[32:35], v6 offset:30720
    ds_read_b128 v[36:39], v6 offset:35840
    ds_read_b128 v[40:43], v6 offset:40960
    ds_read_b128 v[16:19], v4 offset:0
    v_mfma_f32_16x16x32_bf16 v[56:59], v[196:199], v[20:23], v[56:59]
    buffer_load_dwordx4 v13, s[8:11], s65 offen offset:0 sc1 lds
    v_mfma_f32_16x16x32_bf16 v[60:63], v[200:203], v[20:23], v[60:63]
    buffer_load_dwordx4 v13, s[8:11], s65 offen offset:1024 sc1 lds
    v_mfma_f32_16x16x32_bf16 v[64:67], v[204:207], v[20:23], v[64:67]
    s_waitcnt lgkmcnt(3)
    v_add_f32 v76, v76, v32
    v_add_f32 v77, v77, v33
    v_mfma_f32_16x16x32_bf16 v[68:71], v[208:211], v[20:23], v[68:71]
    buffer_load_dwordx4 v13, s[8:11], s65 offen offset:2048 sc1 lds
    v_add_f32 v78, v78, v34
    v_add_f32 v79, v79, v35
    v_mfma_f32_16x16x32_bf16 v[72:75], v[212:215], v[20:23], v[72:75]
    s_waitcnt lgkmcnt(2)
    ds_read_b128 v[32:35], v5 offset:30720
    ds_read_b128 v[20:23], v4 offset:1024
    v_add_f32 v76, v76, v36
    v_add_f32 v77, v77, v37
    v_mfma_f32_16x16x32_bf16 v[72:75], v[232:235], v[24:27], v[72:75]
    buffer_load_dwordx4 v13, s[8:11], s65 offen offset:3072 sc1 lds
    v_add_f32 v78, v78, v38
    v_add_f32 v79, v79, v39
    v_mfma_f32_16x16x32_bf16 v[68:71], v[228:231], v[24:27], v[68:71]
    s_waitcnt lgkmcnt(3)
    ds_read_b128 v[36:39], v5 offset:35840
    v_add_f32 v76, v76, v40
    v_add_f32 v77, v77, v41
    v_mfma_f32_16x16x32_bf16 v[64:67], v[224:227], v[24:27], v[64:67]
    v_add_f32 v78, v78, v42
    v_add_f32 v79, v79, v43
    v_mfma_f32_16x16x32_bf16 v[60:63], v[220:223], v[24:27], v[60:63]
    ds_read_b128 v[40:43], v5 offset:40960
    s_waitcnt lgkmcnt(3)
    v_add_f32 v92, v92, v32
    v_add_f32 v93, v93, v33
    s_add_u32 s6, s97, 0
    v_mfma_f32_16x16x32_bf16 v[56:59], v[216:219], v[24:27], v[56:59]
    ds_read_b128 v[24:27], v4 offset:2048
    v_add_f32 v94, v94, v34
    v_add_f32 v95, v95, v35
    v_mfma_f32_16x16x32_bf16 v[56:59], v[236:239], v[28:31], v[56:59]
    buffer_store_dwordx4 v[76:79], v44, s[8:11], s6 offen sc1
    s_waitcnt lgkmcnt(2)
    v_add_f32 v92, v92, v36
    v_add_f32 v93, v93, v37
    v_mfma_f32_16x16x32_bf16 v[60:63], v[240:243], v[28:31], v[60:63]
    v_add_f32 v94, v94, v38
    v_add_f32 v95, v95, v39
    v_mfma_f32_16x16x32_bf16 v[64:67], v[244:247], v[28:31], v[64:67]
    s_waitcnt lgkmcnt(1)
    v_add_f32 v92, v92, v40
    v_add_f32 v93, v93, v41
    v_mfma_f32_16x16x32_bf16 v[68:71], v[248:251], v[28:31], v[68:71]
    v_add_f32 v94, v94, v42
    v_add_f32 v95, v95, v43
    s_cmp_lg_u32 s71, 1
    v_mfma_f32_16x16x32_bf16 v[72:75], v[252:255], v[28:31], v[72:75]
    s_cbranch_scc1 L_nost_56
    buffer_store_dwordx4 v[92:95], v52, s[8:11], s6 offen sc1
L_nost_56:
    ds_read_b128 v[28:31], v4 offset:3072
    v_mfma_f32_16x16x32_bf16 v[76:79], v[96:99], v[16:19], 0
    s_sub_u32 s6, s71, 3
    s_and_b32 s6, s6, 3
    s_mul_i32 s7, s6, 5120
    v_mfma_f32_16x16x32_bf16 v[80:83], v[100:103], v[16:19], 0
    s_add_u32 s7, s7, s67
    s_cmp_eq_u32 s6, 3
    s_cselect_b32 s7, 155648, s7
    v_mfma_f32_16x16x32_bf16 v[84:87], v[104:107], v[16:19], 0
    v_add_u32 v12, s7, v52
    v_add_u32 v5, s67, v45
    v_mfma_f32_16x16x32_bf16 v[88:91], v[108:111], v[16:19], 0
    v_mfma_f32_16x16x32_bf16 v[92:95], v[112:115], v[16:19], 0
    ds_read_b128 v[16:19], v4 offset:4096
    v_mfma_f32_16x16x32_bf16 v[76:79], v[116:119], v[20:23], v[76:79]
    ds_write_b128 v5, v[60:63] offset:0
    v_add_u32 v5, s67, v46
    v_mfma_f32_16x16x32_bf16 v[80:83], v[120:123], v[20:23], v[80:83]
    v_mfma_f32_16x16x32_bf16 v[84:87], v[124:127], v[20:23], v[84:87]
    v_mfma_f32_16x16x32_bf16 v[88:91], v[128:131], v[20:23], v[88:91]
    s_waitcnt lgkmcnt(3)
    v_mfma_f32_16x16x32_bf16 v[92:95], v[132:135], v[20:23], v[92:95]
    ds_read_b128 v[20:23], v4 offset:5120
    v_mfma_f32_16x16x32_bf16 v[92:95], v[152:155], v[24:27], v[92:95]
    ds_write_b128 v5, v[64:67] offset:5120
    v_add_u32 v5, s67, v47
    v_mfma_f32_16x16x32_bf16 v[88:91], v[148:151], v[24:27], v[88:91]
    v_mfma_f32_16x16x32_bf16 v[84:87], v[144:147], v[24:27], v[84:87]
    v_mfma_f32_16x16x32_bf16 v[80:83], v[140:143], v[24:27], v[80:83]
    s_waitcnt lgkmcnt(4)
    v_mfma_f32_16x16x32_bf16 v[76:79], v[136:139], v[24:27], v[76:79]
    ds_read_b128 v[24:27], v4 offset:6144
    v_mfma_f32_16x16x32_bf16 v[76:79], v[156:159], v[28:31], v[76:79]
    ds_write_b128 v5, v[68:71] offset:10240
    v_add_u32 v5, s67, v52
    v_mfma_f32_16x16x32_bf16 v[80:83], v[160:163], v[28:31], v[80:83]
    v_mfma_f32_16x16x32_bf16 v[84:87], v[164:167], v[28:31], v[84:87]
    v_mfma_f32_16x16x32_bf16 v[88:91], v[168:171], v[28:31], v[88:91]
    s_waitcnt lgkmcnt(5)
    v_mfma_f32_16x16x32_bf16 v[92:95], v[172:175], v[28:31], v[92:95]
    ds_read_b128 v[28:31], v4 offset:7168
    v_mfma_f32_16x16x32_bf16 v[92:95], v[192:195], v[16:19], v[92:95]
    ds_write_b128 v12, v[72:75] offset:0
    v_mfma_f32_16x16x32_bf16 v[88:91], v[188:191], v[16:19], v[88:91]
    s_add_u32 s65, s68, 0
    s_and_b32 s65, s65, 3
    s_andn2_b32 s7, s68, 3
    v_mfma_f32_16x16x32_bf16 v[84:87], v[184:187], v[16:19], v[84:87]
    s_add_u32 s65, s65, s7
    s_lshl_b32 s65, s65, 17
    s_add_u32 s65, s65, s66
    v_mfma_f32_16x16x32_bf16 v[80:83], v[180:183], v[16:19], v[80:83]
    s_waitcnt lgkmcnt(5)
    s_add_u32 m0, s99, 0
    v_mfma_f32_16x16x32_bf16 v[76:79], v[176:179], v[16:19], v[76:79]
    s_waitcnt vmcnt(5)
    s_waitcnt lgkmcnt(0)
    s_barrier
    ds_read_b128 v[32:35], v6 offset:0
    ds_read_b128 v[36:39], v6 offset:5120
    ds_read_b128 v[40:43], v6 offset:10240
    ds_read_b128 v[16:19], v4 offset:32768
    v_mfma_f32_16x16x32_bf16 v[76:79], v[196:199], v[20:23], v[76:79]
    buffer_load_dwordx4 v13, s[8:11], s65 offen offset:0 sc1 lds
    v_mfma_f32_16x16x32_bf16 v[80:83], v[200:203], v[20:23], v[80:83]
    buffer_load_dwordx4 v13, s[8:11], s65 offen offset:1024 sc1 lds
    v_mfma_f32_16x16x32_bf16 v[84:87], v[204:207], v[20:23], v[84:87]
    s_waitcnt lgkmcnt(3)
    v_add_f32 v56, v56, v32
    v_add_f32 v57, v57, v33
    v_mfma_f32_16x16x32_bf16 v[88:91], v[208:211], v[20:23], v[88:91]
    buffer_load_dwordx4 v13, s[8:11], s65 offen offset:2048 sc1 lds
    v_add_f32 v58, v58, v34
    v_add_f32 v59, v59, v35
    v_mfma_f32_16x16x32_bf16 v[92:95], v[212:215], v[20:23], v[92:95]
    s_waitcnt lgkmcnt(2)
    ds_read_b128 v[32:35], v5 offset:0
    ds_read_b128 v[20:23], v4 offset:33792
    v_add_f32 v56, v56, v36
    v_add_f32 v57, v57, v37
    v_mfma_f32_16x16x32_bf16 v[92:95], v[232:235], v[24:27], v[92:95]
    buffer_load_dwordx4 v13, s[8:11], s65 offen offset:3072 sc1 lds
    v_add_f32 v58, v58, v38
    v_add_f32 v59, v59, v39
    v_mfma_f32_16x16x32_bf16 v[88:91], v[228:231], v[24:27], v[88:91]
    s_waitcnt lgkmcnt(3)
    ds_read_b128 v[36:39], v5 offset:5120
    v_add_f32 v56, v56, v40
    v_add_f32 v57, v57, v41
    v_mfma_f32_16x16x32_bf16 v[84:87], v[224:227], v[24:27], v[84:87]
    v_add_f32 v58, v58, v42
    v_add_f32 v59, v59, v43
    v_mfma_f32_16x16x32_bf16 v[80:83], v[220:223], v[24:27], v[80:83]
    ds_read_b128 v[40:43], v5 offset:10240
    s_waitcnt lgkmcnt(3)
    v_add_f32 v72, v72, v32
    v_add_f32 v73, v73, v33
    s_add_u32 s6, s98, 0
    v_mfma_f32_16x16x32_bf16 v[76:79], v[216:219], v[24:27], v[76:79]
    ds_read_b128 v[24:27], v4 offset:34816
    v_add_f32 v74, v74, v34
    v_add_f32 v75, v75, v35
    v_mfma_f32_16x16x32_bf16 v[76:79], v[236:239], v[28:31], v[76:79]
    buffer_store_dwordx4 v[56:59], v44, s[8:11], s6 offen sc1
    s_waitcnt lgkmcnt(2)
    v_add_f32 v72, v72, v36
    v_add_f32 v73, v73, v37
    v_mfma_f32_16x16x32_bf16 v[80:83], v[240:243], v[28:31], v[80:83]
    v_add_f32 v74, v74, v38
    v_add_f32 v75, v75, v39
    v_mfma_f32_16x16x32_bf16 v[84:87], v[244:247], v[28:31], v[84:87]
    s_waitcnt lgkmcnt(1)
    v_add_f32 v72, v72, v40
    v_add_f32 v73, v73, v41
    v_mfma_f32_16x16x32_bf16 v[88:91], v[248:251], v[28:31], v[88:91]
    v_add_f32 v74, v74, v42
    v_add_f32 v75, v75, v43
    s_cmp_lg_u32 s71, 2
    v_mfma_f32_16x16x32_bf16 v[92:95], v[252:255], v[28:31], v[92:95]
    s_cbranch_scc1 L_nost_59
    buffer_store_dwordx4 v[72:75], v52, s[8:11], s6 offen sc1
L_nost_59:
    ds_read_b128 v[28:31], v4 offset:35840
    v_mfma_f32_16x16x32_bf16 v[56:59], v[96:99], v[16:19], 0
    s_sub_u32 s6, s71, 4
    s_and_b32 s6, s6, 3
    s_mul_i32 s7, s6, 5120
    v_mfma_f32_16x16x32_bf16 v[60:63], v[100:103], v[16:19], 0
    s_add_u32 s7, s7, s67
    s_cmp_eq_u32 s6, 3
    s_cselect_b32 s7, 124928, s7
    v_mfma_f32_16x16x32_bf16 v[64:67], v[104:107], v[16:19], 0
    v_add_u32 v12, s7, v52
    v_add_u32 v5, s67, v45
    v_mfma_f32_16x16x32_bf16 v[68:71], v[108:111], v[16:19], 0
    v_mfma_f32_16x16x32_bf16 v[72:75], v[112:115], v[16:19], 0
    ds_read_b128 v[16:19], v4 offset:36864
    v_mfma_f32_16x16x32_bf16 v[56:59], v[116:119], v[20:23], v[56:59]
    ds_write_b128 v5, v[80:83] offset:30720
    v_add_u32 v5, s67, v46
    v_mfma_f32_16x16x32_bf16 v[60:63], v[120:123], v[20:23], v[60:63]
    v_mfma_f32_16x16x32_bf16 v[64:67], v[124:127], v[20:23], v[64:67]
    v_mfma_f32_16x16x32_bf16 v[68:71], v[128:131], v[20:23], v[68:71]
    s_waitcnt lgkmcnt(3)
    v_mfma_f32_16x16x32_bf16 v[72:75], v[132:135], v[20:23], v[72:75]
    ds_read_b128 v[20:23], v4 offset:37888
    v_mfma_f32_16x16x32_bf16 v[72:75], v[152:155], v[24:27], v[72:75]
    ds_write_b128 v5, v[84:87] offset:35840
    v_add_u32 v5, s67, v47
    v_mfma_f32_16x16x32_bf16 v[68:71], v[148:151], v[24:27], v[68:71]
    v_mfma_f32_16x16x32_bf16 v[64:67], v[144:147], v[24:27], v[64:67]
    v_mfma_f32_16x16x32_bf16 v[60:63], v[140:143], v[24:27], v[60:63]
    s_waitcnt lgkmcnt(4)
    v_mfma_f32_16x16x32_bf16 v[56:59], v[136:139], v[24:27], v[56:59]
    ds_read_b128 v[24:27], v4 offset:38912
    v_mfma_f32_16x16x32_bf16 v[56:59], v[156:159], v[28:31], v[56:59]
    ds_write_b128 v5, v[88:91] offset:40960
    v_add_u32 v5, s67, v52
    v_mfma_f32_16x16x32_bf16 v[60:63], v[160:163], v[28:31], v[60:63]
    v_mfma_f32_16x16x32_bf16 v[64:67], v[164:167], v[28:31], v[64:67]
    v_mfma_f32_16x16x32_bf16 v[68:71], v[168:171], v[28:31], v[68:71]
    s_waitcnt lgkmcnt(5)
    v_mfma_f32_16x16x32_bf16 v[72:75], v[172:175], v[28:31], v[72:75]
    ds_read_b128 v[28:31], v4 offset:39936
    v_mfma_f32_16x16x32_bf16 v[72:75], v[192:195], v[16:19], v[72:75]
    ds_write_b128 v12, v[92:95] offset:30720
    v_mfma_f32_16x16x32_bf16 v[68:71], v[188:191], v[16:19], v[68:71]
    s_add_u32 s65, s61, 0
    s_and_b32 s65, s65, 3
    s_andn2_b32 s7, s61, 3
    v_mfma_f32_16x16x32_bf16 v[64:67], v[184:187], v[16:19], v[64:67]
    s_add_u32 s65, s65, s7
    s_lshl_b32 s65, s65, 17
    s_add_u32 s65, s65, s66
    v_mfma_f32_16x16x32_bf16 v[60:63], v[180:183], v[16:19], v[60:63]
    s_waitcnt lgkmcnt(5)
    s_add_u32 m0, s99, 32768
    v_mfma_f32_16x16x32_bf16 v[56:59], v[176:179], v[16:19], v[56:59]
    s_waitcnt vmcnt(5)
    s_waitcnt lgkmcnt(0)
    s_barrier
    ds_read_b128 v[32:35], v6 offset:30720
    ds_read_b128 v[36:39], v6 offset:35840
    ds_read_b128 v[40:43], v6 offset:40960
    ds_read_b128 v[16:19], v7 offset:0
    v_mfma_f32_16x16x32_bf16 v[56:59], v[196:199], v[20:23], v[56:59]
    buffer_load_dwordx4 v13, s[8:11], s65 offen offset:0 sc1 lds
    v_mfma_f32_16x16x32_bf16 v[60:63], v[200:203], v[20:23], v[60:63]
    buffer_load_dwordx4 v13, s[8:11], s65 offen offset:1024 sc1 lds
    v_mfma_f32_16x16x32_bf16 v[64:67], v[204:207], v[20:23], v[64:67]
    s_waitcnt lgkmcnt(3)
    v_add_f32 v76, v76, v32
    v_add_f32 v77, v77, v33
    v_mfma_f32_16x16x32_bf16 v[68:71], v[208:211], v[20:23], v[68:71]
    buffer_load_dwordx4 v13, s[8:11], s65 offen offset:2048 sc1 lds
    v_add_f32 v78, v78, v34
    v_add_f32 v79, v79, v35
    v_mfma_f32_16x16x32_bf16 v[72:75], v[212:215], v[20:23], v[72:75]
    s_waitcnt lgkmcnt(2)
    ds_read_b128 v[32:35], v5 offset:30720
    ds_read_b128 v[20:23], v7 offset:1024
    v_add_f32 v76, v76, v36
    v_add_f32 v77, v77, v37
    v_mfma_f32_16x16x32_bf16 v[72:75], v[232:235], v[24:27], v[72:75]
    buffer_load_dwordx4 v13, s[8:11], s65 offen offset:3072 sc1 lds
    v_add_f32 v78, v78, v38
    v_add_f32 v79, v79, v39
    v_mfma_f32_16x16x32_bf16 v[68:71], v[228:231], v[24:27], v[68:71]
    s_waitcnt lgkmcnt(3)
    ds_read_b128 v[36:39], v5 offset:35840
    v_add_f32 v76, v76, v40
    v_add_f32 v77, v77, v41
    v_mfma_f32_16x16x32_bf16 v[64:67], v[224:227], v[24:27], v[64:67]
    v_add_f32 v78, v78, v42
    v_add_f32 v79, v79, v43
    v_mfma_f32_16x16x32_bf16 v[60:63], v[220:223], v[24:27], v[60:63]
    ds_read_b128 v[40:43], v5 offset:40960
    s_waitcnt lgkmcnt(3)
    v_add_f32 v92, v92, v32
    v_add_f32 v93, v93, v33
    s_add_u32 s6, s96, 10240
    v_mfma_f32_16x16x32_bf16 v[56:59], v[216:219], v[24:27], v[56:59]
    ds_read_b128 v[24:27], v7 offset:2048
    v_add_f32 v94, v94, v34
    v_add_f32 v95, v95, v35
    v_mfma_f32_16x16x32_bf16 v[56:59], v[236:239], v[28:31], v[56:59]
    buffer_store_dwordx4 v[76:79], v44, s[8:11], s6 offen sc1
    s_waitcnt lgkmcnt(2)
    v_add_f32 v92, v92, v36
    v_add_f32 v93, v93, v37
    v_mfma_f32_16x16x32_bf16 v[60:63], v[240:243], v[28:31], v[60:63]
    v_add_f32 v94, v94, v38
    v_add_f32 v95, v95, v39
    v_mfma_f32_16x16x32_bf16 v[64:67], v[244:247], v[28:31], v[64:67]
    s_waitcnt lgkmcnt(1)
    v_add_f32 v92, v92, v40
    v_add_f32 v93, v93, v41
    v_mfma_f32_16x16x32_bf16 v[68:71], v[248:251], v[28:31], v[68:71]
    v_add_f32 v94, v94, v42
    v_add_f32 v95, v95, v43
    s_cmp_lg_u32 s71, 3
    v_mfma_f32_16x16x32_bf16 v[72:75], v[252:255], v[28:31], v[72:75]
    s_cbranch_scc1 L_nost_60
    buffer_store_dwordx4 v[92:95], v52, s[8:11], s6 offen sc1
L_nost_60:
    ds_read_b128 v[28:31], v7 offset:3072
    v_mfma_f32_16x16x32_bf16 v[76:79], v[96:99], v[16:19], 0
    s_sub_u32 s6, s71, 5
    s_and_b32 s6, s6, 3
    s_mul_i32 s7, s6, 5120
    v_mfma_f32_16x16x32_bf16 v[80:83], v[100:103], v[16:19], 0
    s_add_u32 s7, s7, s67
    s_cmp_eq_u32 s6, 3
    s_cselect_b32 s7, 155648, s7
    v_mfma_f32_16x16x32_bf16 v[84:87], v[104:107], v[16:19], 0
    v_add_u32 v12, s7, v52
    v_add_u32 v5, s67, v45
    v_mfma_f32_16x16x32_bf16 v[88:91], v[108:111], v[16:19], 0
    v_mfma_f32_16x16x32_bf16 v[92:95], v[112:115], v[16:19], 0
    ds_read_b128 v[16:19], v7 offset:4096
    v_mfma_f32_16x16x32_bf16 v[76:79], v[116:119], v[20:23], v[76:79]
    ds_write_b128 v5, v[60:63] offset:0
    v_add_u32 v5, s67, v46
    v_mfma_f32_16x16x32_bf16 v[80:83], v[120:123], v[20:23], v[80:83]
    v_mfma_f32_16x16x32_bf16 v[84:87], v[124:127], v[20:23], v[84:87]
    v_mfma_f32_16x16x32_bf16 v[88:91], v[128:131], v[20:23], v[88:91]
    s_waitcnt lgkmcnt(3)
    v_mfma_f32_16x16x32_bf16 v[92:95], v[132:135], v[20:23], v[92:95]
    ds_read_b128 v[20:23], v7 offset:5120
    v_mfma_f32_16x16x32_bf16 v[92:95], v[152:155], v[24:27], v[92:95]
    ds_write_b128 v5, v[64:67] offset:5120
    v_add_u32 v5, s67, v47
    v_mfma_f32_16x16x32_bf16 v[88:91], v[148:151], v[24:27], v[88:91]
    v_mfma_f32_16x16x32_bf16 v[84:87], v[144:147], v[24:27], v[84:87]
    v_mfma_f32_16x16x32_bf16 v[80:83], v[140:143], v[24:27], v[80:83]
    s_waitcnt lgkmcnt(4)
    v_mfma_f32_16x16x32_bf16 v[76:79], v[136:139], v[24:27], v[76:79]
    ds_read_b128 v[24:27], v7 offset:6144
    v_mfma_f32_16x16x32_bf16 v[76:79], v[156:159], v[28:31], v[76:79]
    ds_write_b128 v5, v[68:71] offset:10240
    v_add_u32 v5, s67, v52
    v_mfma_f32_16x16x32_bf16 v[80:83], v[160:163], v[28:31], v[80:83]
    v_mfma_f32_16x16x32_bf16 v[84:87], v[164:167], v[28:31], v[84:87]
    v_mfma_f32_16x16x32_bf16 v[88:91], v[168:171], v[28:31], v[88:91]
    s_waitcnt lgkmcnt(5)
    v_mfma_f32_16x16x32_bf16 v[92:95], v[172:175], v[28:31], v[92:95]
    ds_read_b128 v[28:31], v7 offset:7168
    v_mfma_f32_16x16x32_bf16 v[92:95], v[192:195], v[16:19], v[92:95]
    ds_write_b128 v12, v[72:75] offset:0
    v_mfma_f32_16x16x32_bf16 v[88:91], v[188:191], v[16:19], v[88:91]
    v_mfma_f32_16x16x32_bf16 v[84:87], v[184:187], v[16:19], v[84:87]
    v_mfma_f32_16x16x32_bf16 v[80:83], v[180:183], v[16:19], v[80:83]
    s_waitcnt lgkmcnt(5)
    v_mfma_f32_16x16x32_bf16 v[76:79], v[176:179], v[16:19], v[76:79]
    s_waitcnt vmcnt(5)
    s_waitcnt lgkmcnt(0)
    s_barrier
    ds_read_b128 v[32:35], v6 offset:0
    ds_read_b128 v[36:39], v6 offset:5120
    ds_read_b128 v[40:43], v6 offset:10240
    ds_read_b128 v[16:19], v4 offset:0
    v_mfma_f32_16x16x32_bf16 v[76:79], v[196:199], v[20:23], v[76:79]
    v_mfma_f32_16x16x32_bf16 v[80:83], v[200:203], v[20:23], v[80:83]
    v_mfma_f32_16x16x32_bf16 v[84:87], v[204:207], v[20:23], v[84:87]
    s_waitcnt lgkmcnt(3)
    v_add_f32 v56, v56, v32
    v_add_f32 v57, v57, v33
    v_mfma_f32_16x16x32_bf16 v[88:91], v[208:211], v[20:23], v[88:91]
    v_add_f32 v58, v58, v34
    v_add_f32 v59, v59, v35
    v_mfma_f32_16x16x32_bf16 v[92:95], v[212:215], v[20:23], v[92:95]
    s_waitcnt lgkmcnt(2)
    ds_read_b128 v[32:35], v5 offset:0
    ds_read_b128 v[20:23], v4 offset:1024
    v_add_f32 v56, v56, v36
    v_add_f32 v57, v57, v37
    v_mfma_f32_16x16x32_bf16 v[92:95], v[232:235], v[24:27], v[92:95]
    v_add_f32 v58, v58, v38
    v_add_f32 v59, v59, v39
    v_mfma_f32_16x16x32_bf16 v[88:91], v[228:231], v[24:27], v[88:91]
    s_waitcnt lgkmcnt(3)
    ds_read_b128 v[36:39], v5 offset:5120
    v_add_f32 v56, v56, v40
    v_add_f32 v57, v57, v41
    v_mfma_f32_16x16x32_bf16 v[84:87], v[224:227], v[24:27], v[84:87]
    v_add_f32 v58, v58, v42
    v_add_f32 v59, v59, v43
    v_mfma_f32_16x16x32_bf16 v[80:83], v[220:223], v[24:27], v[80:83]
    ds_read_b128 v[40:43], v5 offset:10240
    s_waitcnt lgkmcnt(3)
    v_add_f32 v72, v72, v32
    v_add_f32 v73, v73, v33
    s_add_u32 s6, s97, 10240
    v_mfma_f32_16x16x32_bf16 v[76:79], v[216:219], v[24:27], v[76:79]
    ds_read_b128 v[24:27], v4 offset:2048
    v_add_f32 v74, v74, v34
    v_add_f32 v75, v75, v35
    v_mfma_f32_16x16x32_bf16 v[76:79], v[236:239], v[28:31], v[76:79]
    buffer_store_dwordx4 v[56:59], v44, s[8:11], s6 offen sc1
    s_waitcnt lgkmcnt(2)
    v_add_f32 v72, v72, v36
    v_add_f32 v73, v73, v37
    v_mfma_f32_16x16x32_bf16 v[80:83], v[240:243], v[28:31], v[80:83]
    v_add_f32 v74, v74, v38
    v_add_f32 v75, v75, v39
    v_mfma_f32_16x16x32_bf16 v[84:87], v[244:247], v[28:31], v[84:87]
    s_waitcnt lgkmcnt(1)
    v_add_f32 v72, v72, v40
    v_add_f32 v73, v73, v41
    v_mfma_f32_16x16x32_bf16 v[88:91], v[248:251], v[28:31], v[88:91]
    v_add_f32 v74, v74, v42
    v_add_f32 v75, v75, v43
    s_cmp_lg_u32 s71, 0
    v_mfma_f32_16x16x32_bf16 v[92:95], v[252:255], v[28:31], v[92:95]
    s_cbranch_scc1 L_nost_61
    buffer_store_dwordx4 v[72:75], v52, s[8:11], s6 offen sc1
L_nost_61:
    ds_read_b128 v[28:31], v4 offset:3072
    v_mfma_f32_16x16x32_bf16 v[56:59], v[96:99], v[16:19], 0
    s_sub_u32 s6, s71, 6
    s_and_b32 s6, s6, 3
    s_mul_i32 s7, s6, 5120
    v_mfma_f32_16x16x32_bf16 v[60:63], v[100:103], v[16:19], 0
    s_add_u32 s7, s7, s67
    s_cmp_eq_u32 s6, 3
    s_cselect_b32 s7, 124928, s7
    v_mfma_f32_16x16x32_bf16 v[64:67], v[104:107], v[16:19], 0
    v_add_u32 v12, s7, v52
    v_add_u32 v5, s67, v45
    v_mfma_f32_16x16x32_bf16 v[68:71], v[108:111], v[16:19], 0
    v_mfma_f32_16x16x32_bf16 v[72:75], v[112:115], v[16:19], 0
    ds_read_b128 v[16:19], v4 offset:4096
    v_mfma_f32_16x16x32_bf16 v[56:59], v[116:119], v[20:23], v[56:59]
    ds_write_b128 v5, v[80:83] offset:30720
    v_add_u32 v5, s67, v46
    v_mfma_f32_16x16x32_bf16 v[60:63], v[120:123], v[20:23], v[60:63]
    v_mfma_f32_16x16x32_bf16 v[64:67], v[124:127], v[20:23], v[64:67]
    v_mfma_f32_16x16x32_bf16 v[68:71], v[128:131], v[20:23], v[68:71]
    s_waitcnt lgkmcnt(3)
    v_mfma_f32_16x16x32_bf16 v[72:75], v[132:135], v[20:23], v[72:75]
    ds_read_b128 v[20:23], v4 offset:5120
    v_mfma_f32_16x16x32_bf16 v[72:75], v[152:155], v[24:27], v[72:75]
    ds_write_b128 v5, v[84:87] offset:35840
    v_add_u32 v5, s67, v47
    v_mfma_f32_16x16x32_bf16 v[68:71], v[148:151], v[24:27], v[68:71]
    v_mfma_f32_16x16x32_bf16 v[64:67], v[144:147], v[24:27], v[64:67]
    v_mfma_f32_16x16x32_bf16 v[60:63], v[140:143], v[24:27], v[60:63]
    s_waitcnt lgkmcnt(4)
    v_mfma_f32_16x16x32_bf16 v[56:59], v[136:139], v[24:27], v[56:59]
    ds_read_b128 v[24:27], v4 offset:6144
    v_mfma_f32_16x16x32_bf16 v[56:59], v[156:159], v[28:31], v[56:59]
    ds_write_b128 v5, v[88:91] offset:40960
    v_add_u32 v5, s67, v52
    v_mfma_f32_16x16x32_bf16 v[60:63], v[160:163], v[28:31], v[60:63]
    v_mfma_f32_16x16x32_bf16 v[64:67], v[164:167], v[28:31], v[64:67]
    v_mfma_f32_16x16x32_bf16 v[68:71], v[168:171], v[28:31], v[68:71]
    s_waitcnt lgkmcnt(5)
    v_mfma_f32_16x16x32_bf16 v[72:75], v[172:175], v[28:31], v[72:75]
    ds_read_b128 v[28:31], v4 offset:7168
    v_mfma_f32_16x16x32_bf16 v[72:75], v[192:195], v[16:19], v[72:75]
    ds_write_b128 v12, v[92:95] offset:30720
    v_mfma_f32_16x16x32_bf16 v[68:71], v[188:191], v[16:19], v[68:71]
    v_mfma_f32_16x16x32_bf16 v[64:67], v[184:187], v[16:19], v[64:67]
    v_mov_b32 v2, 1
    v_writelane_b32 v2, 2, 0
    v_mfma_f32_16x16x32_bf16 v[60:63], v[180:183], v[16:19], v[60:63]
    s_waitcnt lgkmcnt(5)
    v_mfma_f32_16x16x32_bf16 v[56:59], v[176:179], v[16:19], v[56:59]
    s_waitcnt vmcnt(1)
    buffer_store_dword v2, v11, s[8:11], 0 offen sc1
    s_waitcnt lgkmcnt(0)
    s_barrier
    ds_read_b128 v[32:35], v6 offset:30720
    ds_read_b128 v[36:39], v6 offset:35840
    ds_read_b128 v[40:43], v6 offset:40960
    ds_read_b128 v[16:19], v4 offset:32768
    v_mfma_f32_16x16x32_bf16 v[56:59], v[196:199], v[20:23], v[56:59]
    v_mfma_f32_16x16x32_bf16 v[60:63], v[200:203], v[20:23], v[60:63]
    v_mfma_f32_16x16x32_bf16 v[64:67], v[204:207], v[20:23], v[64:67]
    s_waitcnt lgkmcnt(3)
    v_add_f32 v76, v76, v32
    v_add_f32 v77, v77, v33
    v_mfma_f32_16x16x32_bf16 v[68:71], v[208:211], v[20:23], v[68:71]
    v_add_f32 v78, v78, v34
    v_add_f32 v79, v79, v35
    v_mfma_f32_16x16x32_bf16 v[72:75], v[212:215], v[20:23], v[72:75]
    s_waitcnt lgkmcnt(2)
    ds_read_b128 v[32:35], v5 offset:30720
    ds_read_b128 v[20:23], v4 offset:33792
    v_add_f32 v76, v76, v36
    v_add_f32 v77, v77, v37
    v_mfma_f32_16x16x32_bf16 v[72:75], v[232:235], v[24:27], v[72:75]
    v_add_f32 v78, v78, v38
    v_add_f32 v79, v79, v39
    v_mfma_f32_16x16x32_bf16 v[68:71], v[228:231], v[24:27], v[68:71]
    s_waitcnt lgkmcnt(3)
    ds_read_b128 v[36:39], v5 offset:35840
    v_add_f32 v76, v76, v40
    v_add_f32 v77, v77, v41
    v_mfma_f32_16x16x32_bf16 v[64:67], v[224:227], v[24:27], v[64:67]
    v_add_f32 v78, v78, v42
    v_add_f32 v79, v79, v43
    v_mfma_f32_16x16x32_bf16 v[60:63], v[220:223], v[24:27], v[60:63]
    ds_read_b128 v[40:43], v5 offset:40960
    s_waitcnt lgkmcnt(3)
    v_add_f32 v92, v92, v32
    v_add_f32 v93, v93, v33
    s_add_u32 s6, s98, 10240
    v_mfma_f32_16x16x32_bf16 v[56:59], v[216:219], v[24:27], v[56:59]
    ds_read_b128 v[24:27], v4 offset:34816
    v_add_f32 v94, v94, v34
    v_add_f32 v95, v95, v35
    v_mfma_f32_16x16x32_bf16 v[56:59], v[236:239], v[28:31], v[56:59]
    buffer_store_dwordx4 v[76:79], v44, s[8:11], s6 offen sc1
    s_waitcnt lgkmcnt(2)
    v_add_f32 v92, v92, v36
    v_add_f32 v93, v93, v37
    v_mfma_f32_16x16x32_bf16 v[60:63], v[240:243], v[28:31], v[60:63]
    v_add_f32 v94, v94, v38
    v_add_f32 v95, v95, v39
    v_mfma_f32_16x16x32_bf16 v[64:67], v[244:247], v[28:31], v[64:67]
    s_waitcnt lgkmcnt(1)
    v_add_f32 v92, v92, v40
    v_add_f32 v93, v93, v41
    v_mfma_f32_16x16x32_bf16 v[68:71], v[248:251], v[28:31], v[68:71]
    v_add_f32 v94, v94, v42
    v_add_f32 v95, v95, v43
    s_cmp_lg_u32 s71, 1
    v_mfma_f32_16x16x32_bf16 v[72:75], v[252:255], v[28:31], v[72:75]
    s_cbranch_scc1 L_nost_62
    buffer_store_dwordx4 v[92:95], v52, s[8:11], s6 offen sc1
L_nost_62:
    ds_read_b128 v[28:31], v4 offset:35840
    v_mfma_f32_16x16x32_bf16 v[76:79], v[96:99], v[16:19], 0
    v_mfma_f32_16x16x32_bf16 v[80:83], v[100:103], v[16:19], 0
    v_mfma_f32_16x16x32_bf16 v[84:87], v[104:107], v[16:19], 0
    s_mul_i32 s73, s3, 5120
    s_add_u32 s6, s73, 65536
    v_mfma_f32_16x16x32_bf16 v[88:91], v[108:111], v[16:19], 0
    v_add_u32 v5, s6, v44
    v_mfma_f32_16x16x32_bf16 v[92:95], v[112:115], v[16:19], 0
    ds_read_b128 v[16:19], v4 offset:36864
    v_mfma_f32_16x16x32_bf16 v[76:79], v[116:119], v[20:23], v[76:79]
    ds_write_b128 v5, v[56:59]
    s_add_u32 s6, s73, 65536
    v_add_u32 v5, s6, v45
    v_mfma_f32_16x16x32_bf16 v[80:83], v[120:123], v[20:23], v[80:83]
    v_mfma_f32_16x16x32_bf16 v[84:87], v[124:127], v[20:23], v[84:87]
    v_mfma_f32_16x16x32_bf16 v[88:91], v[128:131], v[20:23], v[88:91]
    s_waitcnt lgkmcnt(3)
    v_mfma_f32_16x16x32_bf16 v[92:95], v[132:135], v[20:23], v[92:95]
    ds_read_b128 v[20:23], v4 offset:37888
    v_mfma_f32_16x16x32_bf16 v[92:95], v[152:155], v[24:27], v[92:95]
    ds_write_b128 v5, v[60:63]
    s_add_u32 s6, s73, 65536
    v_add_u32 v5, s6, v46
    v_mfma_f32_16x16x32_bf16 v[88:91], v[148:151], v[24:27], v[88:91]
    v_mfma_f32_16x16x32_bf16 v[84:87], v[144:147], v[24:27], v[84:87]
    v_mfma_f32_16x16x32_bf16 v[80:83], v[140:143], v[24:27], v[80:83]
    s_waitcnt lgkmcnt(4)
    v_mfma_f32_16x16x32_bf16 v[76:79], v[136:139], v[24:27], v[76:79]
    ds_read_b128 v[24:27], v4 offset:38912
    v_mfma_f32_16x16x32_bf16 v[76:79], v[156:159], v[28:31], v[76:79]
    ds_write_b128 v5, v[64:67]
    s_add_u32 s6, s73, 65536
    v_add_u32 v5, s6, v47
    v_mfma_f32_16x16x32_bf16 v[80:83], v[160:163], v[28:31], v[80:83]
    v_mov_b32 v2, 2
    s_waitcnt vmcnt(0)
    buffer_store_dword v2, v11, s[8:11], 0 offen sc1
    v_mfma_f32_16x16x32_bf16 v[84:87], v[164:167], v[28:31], v[84:87]
    v_mfma_f32_16x16x32_bf16 v[88:91], v[168:171], v[28:31], v[88:91]
    s_waitcnt lgkmcnt(5)
    s_cmp_eq_u32 s64, 0
    s_cbranch_scc1 L_nb
    v_bfe_u32 v2, v1, 1, 3
    v_and_b32 v3, 1, v1
    v_lshl_add_u32 v3, v2, 7, v3
    v_lshlrev_b32 v3, 2, v3
    s_and_b32 s6, s4, 3
    s_lshl_b32 s6, s6, 7
    s_add_u32 s6, s6, 3911680
    s_mov_b32 s79, 262144
L_poll_63:
    buffer_load_dword v2, v3, s[8:11], s6 offen sc1
    s_waitcnt vmcnt(0)
    v_cmp_ne_u32 vcc, 1, v2
    s_cbranch_vccz L_polldone_64
    s_sleep 2
    s_sub_u32 s79, s79, 1
    s_cmp_lg_u32 s79, 0
    s_cbranch_scc1 L_poll_63
L_polldone_64:
L_nb:
    buffer_load_dwordx4 v[96:99], v53, s[12:15], s70 offen
    buffer_load_dwordx4 v[100:103], v48, s[8:11], 0 offen sc1
    s_cmp_ge_u32 s3, 2
    s_cbranch_scc1 L_itskip_65
    buffer_load_dwordx4 v[104:107], v54, s[12:15], s70 offen
    buffer_load_dwordx4 v[108:111], v49, s[8:11], 0 offen sc1
L_itskip_65:
    v_mfma_f32_16x16x32_bf16 v[92:95], v[172:175], v[28:31], v[92:95]
    ds_read_b128 v[28:31], v4 offset:39936
    v_mfma_f32_16x16x32_bf16 v[92:95], v[192:195], v[16:19], v[92:95]
    ds_write_b128 v5, v[68:71]
    s_add_u32 s6, s73, 65536
    v_add_u32 v5, s6, v52
    v_mfma_f32_16x16x32_bf16 v[88:91], v[188:191], v[16:19], v[88:91]
    v_mfma_f32_16x16x32_bf16 v[84:87], v[184:187], v[16:19], v[84:87]
    v_mfma_f32_16x16x32_bf16 v[80:83], v[180:183], v[16:19], v[80:83]
    s_waitcnt lgkmcnt(5)
    v_mfma_f32_16x16x32_bf16 v[76:79], v[176:179], v[16:19], v[76:79]
    v_mfma_f32_16x16x32_bf16 v[76:79], v[196:199], v[20:23], v[76:79]
    ds_write_b128 v5, v[72:75]
    v_mfma_f32_16x16x32_bf16 v[80:83], v[200:203], v[20:23], v[80:83]
    v_mfma_f32_16x16x32_bf16 v[84:87], v[204:207], v[20:23], v[84:87]
    v_mfma_f32_16x16x32_bf16 v[88:91], v[208:211], v[20:23], v[88:91]
    s_waitcnt lgkmcnt(4)
    v_mfma_f32_16x16x32_bf16 v[92:95], v[212:215], v[20:23], v[92:95]
    v_mfma_f32_16x16x32_bf16 v[92:95], v[232:235], v[24:27], v[92:95]
    v_bfe_u32 v2, v1, 3, 2
    v_min_u32 v2, 2, v2
    v_and_b32 v3, 7, v1
    v_lshlrev_b32 v3, 2, v3
    v_lshl_add_u32 v3, v2, 7, v3
    v_mfma_f32_16x16x32_bf16 v[88:91], v[228:231], v[24:27], v[88:91]
    s_bitcmp1_b32 13, s3
    s_cselect_b32 s77, 1, 2
    buffer_load_dword v50, v3, s[8:11], s63 offen sc1
    v_mfma_f32_16x16x32_bf16 v[84:87], v[224:227], v[24:27], v[84:87]
    v_mfma_f32_16x16x32_bf16 v[80:83], v[220:223], v[24:27], v[80:83]
    s_waitcnt lgkmcnt(2)
    s_add_u32 s6, s73, 86016
    s_cmp_lt_u32 s3, 4
    s_cselect_b32 s73, s73, s6
    v_mfma_f32_16x16x32_bf16 v[76:79], v[216:219], v[24:27], v[76:79]
    v_mfma_f32_16x16x32_bf16 v[76:79], v[236:239], v[28:31], v[76:79]
    v_mfma_f32_16x16x32_bf16 v[80:83], v[240:243], v[28:31], v[80:83]
    v_mfma_f32_16x16x32_bf16 v[84:87], v[244:247], v[28:31], v[84:87]
    v_mfma_f32_16x16x32_bf16 v[88:91], v[248:251], v[28:31], v[88:91]
    v_mfma_f32_16x16x32_bf16 v[92:95], v[252:255], v[28:31], v[92:95]
    s_nop 4
    v_add_u32 v5, s73, v44
    ds_write_b128 v5, v[76:79]
    v_add_u32 v5, s73, v45
    ds_write_b128 v5, v[80:83]
    v_add_u32 v5, s73, v46
    ds_write_b128 v5, v[84:87]
    v_add_u32 v5, s73, v47
    ds_write_b128 v5, v[88:91]
    v_add_u32 v5, s73, v52
    ds_write_b128 v5, v[92:95]
    s_waitcnt vmcnt(0)
    v_cmp_gt_u32 s[78:79], s77, v50
    s_nop 3
    s_cmp_lg_u64 s[78:79], 0
    s_cbranch_scc1 L_x2a
    s_add_u32 s6, s62, 0
    buffer_load_dwordx4 v[112:115], v8, s[8:11], s6 offen offset:0 sc1
    buffer_load_dwordx4 v[116:119], v8, s[8:11], s6 offen offset:256 sc1
    s_add_u32 s6, s62, 20480
    buffer_load_dwordx4 v[120:123], v8, s[8:11], s6 offen offset:0 sc1
    buffer_load_dwordx4 v[124:127], v8, s[8:11], s6 offen offset:256 sc1
    s_add_u32 s6, s62, 40960
    buffer_load_dwordx4 v[128:131], v8, s[8:11], s6 offen offset:0 sc1
    buffer_load_dwordx4 v[132:135], v8, s[8:11], s6 offen offset:256 sc1
    s_cmp_ge_u32 s3, 2
    s_cbranch_scc1 L_xi_66
    s_add_u32 s6, s62, 0
    buffer_load_dwordx4 v[136:139], v9, s[8:11], s6 offen offset:0 sc1
    buffer_load_dwordx4 v[140:143], v9, s[8:11], s6 offen offset:256 sc1
    s_add_u32 s6, s62, 20480
    buffer_load_dwordx4 v[144:147], v9, s[8:11], s6 offen offset:0 sc1
    buffer_load_dwordx4 v[148:151], v9, s[8:11], s6 offen offset:256 sc1
    s_add_u32 s6, s62, 40960
    buffer_load_dwordx4 v[152:155], v9, s[8:11], s6 offen offset:0 sc1
    buffer_load_dwordx4 v[156:159], v9, s[8:11], s6 offen offset:256 sc1
L_xi_66:
L_x2a:
    s_waitcnt lgkmcnt(0)
    s_barrier
    ds_read_b128 v[160:163], v10 offset:0
    ds_read_b128 v[164:167], v10 offset:256
    ds_read_b128 v[168:171], v10 offset:5120
    ds_read_b128 v[172:175], v10 offset:5376
    ds_read_b128 v[176:179], v10 offset:10240
    ds_read_b128 v[180:183], v10 offset:10496
    ds_read_b128 v[184:187], v10 offset:15360
    ds_read_b128 v[188:191], v10 offset:15616
    ds_read_b128 v[192:195], v55 offset:0
    ds_read_b128 v[196:199], v55 offset:256
    ds_read_b128 v[200:203], v55 offset:5120
    ds_read_b128 v[204:207], v55 offset:5376
    ds_read_b128 v[208:211], v55 offset:10240
    ds_read_b128 v[212:215], v55 offset:10496
    ds_read_b128 v[216:219], v55 offset:15360
    ds_read_b128 v[220:223], v55 offset:15616
    s_cmp_eq_u64 s[78:79], 0
    s_cbranch_scc1 L_x2b
    s_mov_b32 s79, 262144
L_poll_67:
    buffer_load_dword v2, v3, s[8:11], s63 offen sc1
    s_waitcnt vmcnt(0)
    v_cmp_gt_u32 vcc, s77, v2
    s_cbranch_vccz L_polldone_68
    s_sleep 1
    s_sub_u32 s79, s79, 1
    s_cmp_lg_u32 s79, 0
    s_cbranch_scc1 L_poll_67
L_polldone_68:
    s_add_u32 s6, s62, 0
    buffer_load_dwordx4 v[112:115], v8, s[8:11], s6 offen offset:0 sc1
    buffer_load_dwordx4 v[116:119], v8, s[8:11], s6 offen offset:256 sc1
    s_add_u32 s6, s62, 20480
    buffer_load_dwordx4 v[120:123], v8, s[8:11], s6 offen offset:0 sc1
    buffer_load_dwordx4 v[124:127], v8, s[8:11], s6 offen offset:256 sc1
    s_add_u32 s6, s62, 40960
    buffer_load_dwordx4 v[128:131], v8, s[8:11], s6 offen offset:0 sc1
    buffer_load_dwordx4 v[132:135], v8, s[8:11], s6 offen offset:256 sc1
    s_cmp_ge_u32 s3, 2
    s_cbranch_scc1 L_xi_69
    s_add_u32 s6, s62, 0
    buffer_load_dwordx4 v[136:139], v9, s[8:11], s6 offen offset:0 sc1
    buffer_load_dwordx4 v[140:143], v9, s[8:11], s6 offen offset:256 sc1
    s_add_u32 s6, s62, 20480
    buffer_load_dwordx4 v[144:147], v9, s[8:11], s6 offen offset:0 sc1
    buffer_load_dwordx4 v[148:151], v9, s[8:11], s6 offen offset:256 sc1
    s_add_u32 s6, s62, 40960
    buffer_load_dwordx4 v[152:155], v9, s[8:11], s6 offen offset:0 sc1
    buffer_load_dwordx4 v[156:159], v9, s[8:11], s6 offen offset:256 sc1
L_xi_69:
L_x2b:
    s_mov_b32 s16, s54
    s_mov_b32 s17, s55
    s_mov_b32 s18, 0x280000
    s_mov_b32 s19, 0x20000
    s_waitcnt lgkmcnt(8)
    v_pk_add_f32 v[160:161], v[160:161], v[168:169]
    v_pk_add_f32 v[162:163], v[162:163], v[170:171]
    v_pk_add_f32 v[164:165], v[164:165], v[172:173]
    v_pk_add_f32 v[166:167], v[166:167], v[174:175]
    v_pk_add_f32 v[160:161], v[160:161], v[176:177]
    v_pk_add_f32 v[162:163], v[162:163], v[178:179]
    v_pk_add_f32 v[164:165], v[164:165], v[180:181]
    v_pk_add_f32 v[166:167], v[166:167], v[182:183]
    v_pk_add_f32 v[160:161], v[160:161], v[184:185]
    v_pk_add_f32 v[162:163], v[162:163], v[186:187]
    v_pk_add_f32 v[164:165], v[164:165], v[188:189]
    v_pk_add_f32 v[166:167], v[166:167], v[190:191]
    s_waitcnt vmcnt(0)
    v_pk_add_f32 v[160:161], v[160:161], v[112:113]
    v_pk_add_f32 v[162:163], v[162:163], v[114:115]
    v_pk_add_f32 v[164:165], v[164:165], v[116:117]
    v_pk_add_f32 v[166:167], v[166:167], v[118:119]
    v_pk_add_f32 v[160:161], v[160:161], v[120:121]
    v_pk_add_f32 v[162:163], v[162:163], v[122:123]
    v_pk_add_f32 v[164:165], v[164:165], v[124:125]
    v_pk_add_f32 v[166:167], v[166:167], v[126:127]
    v_pk_add_f32 v[160:161], v[160:161], v[128:129]
    v_pk_add_f32 v[162:163], v[162:163], v[130:131]
    v_pk_add_f32 v[164:165], v[164:165], v[132:133]
    v_pk_add_f32 v[166:167], v[166:167], v[134:135]
    v_cvt_pk_bf16_f32 v2, v160, v161
    v_lshlrev_b32 v160, 16, v2
    v_and_b32 v161, 0xffff0000, v2
    v_lshlrev_b32 v2, 16, v96
    v_and_b32 v3, 0xffff0000, v96
    v_pk_add_f32 v[160:161], v[160:161], v[2:3]
    v_cvt_pk_bf16_f32 v2, v160, v161
    v_lshlrev_b32 v160, 16, v2
    v_and_b32 v161, 0xffff0000, v2
    v_lshlrev_b32 v2, 16, v100
    v_and_b32 v3, 0xffff0000, v100
    v_pk_add_f32 v[160:161], v[160:161], v[2:3]
    v_cvt_pk_bf16_f32 v224, v160, v161
    v_cvt_pk_bf16_f32 v2, v162, v163
    v_lshlrev_b32 v162, 16, v2
    v_and_b32 v163, 0xffff0000, v2
    v_lshlrev_b32 v2, 16, v97
    v_and_b32 v3, 0xffff0000, v97
    v_pk_add_f32 v[162:163], v[162:163], v[2:3]
    v_cvt_pk_bf16_f32 v2, v162, v163
    v_lshlrev_b32 v162, 16, v2
    v_and_b32 v163, 0xffff0000, v2
    v_lshlrev_b32 v2, 16, v101
    v_and_b32 v3, 0xffff0000, v101
    v_pk_add_f32 v[162:163], v[162:163], v[2:3]
    v_cvt_pk_bf16_f32 v225, v162, v163
    v_cvt_pk_bf16_f32 v2, v164, v165
    v_lshlrev_b32 v164, 16, v2
    v_and_b32 v165, 0xffff0000, v2
    v_lshlrev_b32 v2, 16, v98
    v_and_b32 v3, 0xffff0000, v98
    v_pk_add_f32 v[164:165], v[164:165], v[2:3]
    v_cvt_pk_bf16_f32 v2, v164, v165
    v_lshlrev_b32 v164, 16, v2
    v_and_b32 v165, 0xffff0000, v2
    v_lshlrev_b32 v2, 16, v102
    v_and_b32 v3, 0xffff0000, v102
    v_pk_add_f32 v[164:165], v[164:165], v[2:3]
    v_cvt_pk_bf16_f32 v226, v164, v165
    v_cvt_pk_bf16_f32 v2, v166, v167
    v_lshlrev_b32 v166, 16, v2
    v_and_b32 v167, 0xffff0000, v2
    v_lshlrev_b32 v2, 16, v99
    v_and_b32 v3, 0xffff0000, v99
    v_pk_add_f32 v[166:167], v[166:167], v[2:3]
    v_cvt_pk_bf16_f32 v2, v166, v167
    v_lshlrev_b32 v166, 16, v2
    v_and_b32 v167, 0xffff0000, v2
    v_lshlrev_b32 v2, 16, v103
    v_and_b32 v3, 0xffff0000, v103
    v_pk_add_f32 v[166:167], v[166:167], v[2:3]
    v_cvt_pk_bf16_f32 v227, v166, v167
    buffer_store_dwordx4 v[224:227], v53, s[16:19], s70 offen
    s_cmp_ge_u32 s3, 2
    s_cbranch_scc1 L_end
    s_waitcnt lgkmcnt(0)
    v_pk_add_f32 v[192:193], v[192:193], v[200:201]
    v_pk_add_f32 v[194:195], v[194:195], v[202:203]
    v_pk_add_f32 v[196:197], v[196:197], v[204:205]
    v_pk_add_f32 v[198:199], v[198:199], v[206:207]
    v_pk_add_f32 v[192:193], v[192:193], v[208:209]
    v_pk_add_f32 v[194:195], v[194:195], v[210:211]
    v_pk_add_f32 v[196:197], v[196:197], v[212:213]
    v_pk_add_f32 v[198:199], v[198:199], v[214:215]
    v_pk_add_f32 v[192:193], v[192:193], v[216:217]
    v_pk_add_f32 v[194:195], v[194:195], v[218:219]
    v_pk_add_f32 v[196:197], v[196:197], v[220:221]
    v_pk_add_f32 v[198:199], v[198:199], v[222:223]
    s_nop 0
    v_pk_add_f32 v[192:193], v[192:193], v[136:137]
    v_pk_add_f32 v[194:195], v[194:195], v[138:139]
    v_pk_add_f32 v[196:197], v[196:197], v[140:141]
    v_pk_add_f32 v[198:199], v[198:199], v[142:143]
    v_pk_add_f32 v[192:193], v[192:193], v[144:145]
    v_pk_add_f32 v[194:195], v[194:195], v[146:147]
    v_pk_add_f32 v[196:197], v[196:197], v[148:149]
    v_pk_add_f32 v[198:199], v[198:199], v[150:151]
    v_pk_add_f32 v[192:193], v[192:193], v[152:153]
    v_pk_add_f32 v[194:195], v[194:195], v[154:155]
    v_pk_add_f32 v[196:197], v[196:197], v[156:157]
    v_pk_add_f32 v[198:199], v[198:199], v[158:159]
    v_cvt_pk_bf16_f32 v2, v192, v193
    v_lshlrev_b32 v192, 16, v2
    v_and_b32 v193, 0xffff0000, v2
    v_lshlrev_b32 v2, 16, v104
    v_and_b32 v3, 0xffff0000, v104
    v_pk_add_f32 v[192:193], v[192:193], v[2:3]
    v_cvt_pk_bf16_f32 v2, v192, v193
    v_lshlrev_b32 v192, 16, v2
    v_and_b32 v193, 0xffff0000, v2
    v_lshlrev_b32 v2, 16, v108
    v_and_b32 v3, 0xffff0000, v108
    v_pk_add_f32 v[192:193], v[192:193], v[2:3]
    v_cvt_pk_bf16_f32 v228, v192, v193
    v_cvt_pk_bf16_f32 v2, v194, v195
    v_lshlrev_b32 v194, 16, v2
    v_and_b32 v195, 0xffff0000, v2
    v_lshlrev_b32 v2, 16, v105
    v_and_b32 v3, 0xffff0000, v105
    v_pk_add_f32 v[194:195], v[194:195], v[2:3]
    v_cvt_pk_bf16_f32 v2, v194, v195
    v_lshlrev_b32 v194, 16, v2
    v_and_b32 v195, 0xffff0000, v2
    v_lshlrev_b32 v2, 16, v109
    v_and_b32 v3, 0xffff0000, v109
    v_pk_add_f32 v[194:195], v[194:195], v[2:3]
    v_cvt_pk_bf16_f32 v229, v194, v195
    v_cvt_pk_bf16_f32 v2, v196, v197
    v_lshlrev_b32 v196, 16, v2
    v_and_b32 v197, 0xffff0000, v2
    v_lshlrev_b32 v2, 16, v106
    v_and_b32 v3, 0xffff0000, v106
    v_pk_add_f32 v[196:197], v[196:197], v[2:3]
    v_cvt_pk_bf16_f32 v2, v196, v197
    v_lshlrev_b32 v196, 16, v2
    v_and_b32 v197, 0xffff0000, v2
    v_lshlrev_b32 v2, 16, v110
    v_and_b32 v3, 0xffff0000, v110
    v_pk_add_f32 v[196:197], v[196:197], v[2:3]
    v_cvt_pk_bf16_f32 v230, v196, v197
    v_cvt_pk_bf16_f32 v2, v198, v199
    v_lshlrev_b32 v198, 16, v2
    v_and_b32 v199, 0xffff0000, v2
    v_lshlrev_b32 v2, 16, v107
    v_and_b32 v3, 0xffff0000, v107
    v_pk_add_f32 v[198:199], v[198:199], v[2:3]
    v_cvt_pk_bf16_f32 v2, v198, v199
    v_lshlrev_b32 v198, 16, v2
    v_and_b32 v199, 0xffff0000, v2
    v_lshlrev_b32 v2, 16, v111
    v_and_b32 v3, 0xffff0000, v111
    v_pk_add_f32 v[198:199], v[198:199], v[2:3]
    v_cvt_pk_bf16_f32 v231, v198, v199
    buffer_store_dwordx4 v[228:231], v54, s[16:19], s70 offen
L_end:
L_exit:
    s_endpgm
.section .rodata,"a"
.p2align 6
.amdhsa_kernel parallel_sum__compressed_kv_cla__moe_arch_mod__prompt_kernel
  .amdhsa_next_free_vgpr 256
  .amdhsa_next_free_sgpr 102
  .amdhsa_accum_offset 256
  .amdhsa_group_segment_fixed_size 0
  .amdhsa_kernarg_size 112
  .amdhsa_user_sgpr_count 2
  .amdhsa_user_sgpr_kernarg_segment_ptr 1
  .amdhsa_system_sgpr_workgroup_id_x 1
  .amdhsa_float_denorm_mode_32 3
.end_amdhsa_kernel
```

```asm
; @launch grid=(256,1,1) block=(512,1,1) lds=163840
.amdgcn_target "amdgcn-amd-amdhsa--gfx950"
.text
.globl parallel_sum__compressed_kv_cla__moe_arch_mod__prompt_kernel
.p2align 8
.type parallel_sum__compressed_kv_cla__moe_arch_mod__prompt_kernel,@function
parallel_sum__compressed_kv_cla__moe_arch_mod__prompt_kernel:
    s_cmp_ge_u32 s2, 256
    s_cbranch_scc1 L_exit
    s_load_dwordx16 s[32:47], s[0:1], 0
    s_load_dwordx8 s[48:55], s[0:1], 64
    s_load_dwordx4 s[56:59], s[0:1], 96
    v_lshrrev_b32 v2, 6, v0
    v_and_b32 v1, 63, v0
    v_readfirstlane_b32 s3, v2
    s_getpc_b64 s[80:81]
L_pc:
    s_lshr_b32 s6, s2, 3
    s_and_b32 s6, s6, 15
    s_lshl_b32 s6, s6, 12
    s_cmp_lt_u32 s3, 2
    s_cselect_b32 s6, 0, s6
    v_lshl_add_u32 v3, v0, 6, s6
    v_min_u32 v3, L_exit-L_pc, v3
    s_cmp_ge_u32 s3, 3
    s_cbranch_scc1 L_noct
    global_load_dword v11, v3, s[80:81]
L_noct:
    v_lshrrev_b32 v62, 5, v0
    v_and_b32 v62, 7, v62
    v_and_b32 v2, 31, v0
    v_lshlrev_b32 v2, 3, v2
    v_mul_u32_u24 v63, 1280, v62
    v_add_u32 v63, v63, v2
    s_mul_i32 s6, s2, 10240
    v_add_u32 v10, s6, v63
    s_cmp_lt_u32 s3, 4
    s_cbranch_scc1 L_st_k0
    s_waitcnt lgkmcnt(0)
    global_load_dwordx2 v[16:17], v10, s[32:33] offset:0
    global_load_dwordx2 v[18:19], v10, s[32:33] offset:256
    global_load_dwordx2 v[20:21], v10, s[32:33] offset:512
    global_load_dwordx2 v[22:23], v10, s[32:33] offset:768
    global_load_dwordx2 v[24:25], v10, s[32:33] offset:1024
    global_load_dwordx2 v[26:27], v2, s[46:47] offset:0
    global_load_dwordx2 v[28:29], v2, s[46:47] offset:256
    global_load_dwordx2 v[30:31], v2, s[46:47] offset:512
    global_load_dwordx2 v[32:33], v2, s[46:47] offset:768
    global_load_dwordx2 v[34:35], v2, s[46:47] offset:1024
    s_barrier
L_st_k0:
    s_and_b32 s6, s2, 7
    s_lshl_b32 s6, s6, 2
    s_lshr_b32 s7, s2, 3
    s_and_b32 s7, s7, 3
    s_add_u32 s4, s6, s7
    s_lshr_b32 s5, s2, 5
    s_and_b32 s76, s3, 3
    v_lshrrev_b32 v2, 3, v1
    v_and_b32 v3, 7, v1
    v_lshrrev_b32 v4, 4, v1
    v_xor_b32 v5, v3, v4
    v_lshlrev_b32 v5, 4, v5
    v_lshl_add_u32 v40, v2, 10, v5
    v_xor_b32 v5, 64, v40
    v_add_u32 v41, 7168, v5
    v_add_u32 v42, 14336, v40
    v_add_u32 v43, 14336, v41
    v_and_b32 v6, 15, v1
    s_lshl_b32 s6, s76, 4
    v_add_u32 v7, s6, v4
    v_lshlrev_b32 v5, 1, v4
    v_xor_b32 v5, v6, v5
    v_lshlrev_b32 v5, 4, v5
    v_lshl_add_u32 v44, v7, 13, v5
    v_add_u32 v45, 31744, v44
    v_xor_b32 v5, 0x80, v44
    v_add_u32 v46, 63488, v5
    v_add_u32 v47, 31744, v46
    s_and_b32 s6, s76, 1
    s_lshl_b32 s6, s6, 20
    s_lshr_b32 s7, s76, 1
    s_lshl_b32 s7, s7, 18
    s_add_u32 s6, s6, s7
    s_lshl_b32 s62, s5, 15
    s_add_u32 s62, s62, s6
    s_lshl_b32 s63, s4, 8
    s_lshl_b32 s64, s76, 13
    s_lshl_b32 s73, s76, 12
    s_add_u32 s73, s73, 32768
    s_andn2_b32 s100, 1, s5
    s_lshl_b32 s100, s100, 16
    s_add_u32 s64, s64, s100
    s_add_u32 s73, s73, s100
    s_waitcnt lgkmcnt(0)
    s_mov_b32 s12, s34
    s_mov_b32 s13, s35
    s_mov_b32 s14, 0x200000
    s_mov_b32 s15, 0x20000
    s_mov_b32 s16, s38
    s_mov_b32 s17, s39
    s_mov_b32 s18, 0x400000
    s_mov_b32 s19, 0x20000
    s_mov_b32 s20, s40
    s_mov_b32 s21, s41
    s_mov_b32 s22, 0x400000
    s_mov_b32 s23, 0x20000
    s_cmp_ge_u32 s3, 4
    s_cbranch_scc1 L_st_v0
    s_barrier
    s_mov_b32 m0, s64
    s_add_u32 s72, s62, 524288
    buffer_load_dwordx4 v40, s[12:15], s62 offen offset:0 lds
    buffer_load_dwordx4 v41, s[12:15], s62 offen offset:1024 lds
    buffer_load_dwordx4 v42, s[12:15], s62 offen offset:2048 lds
    buffer_load_dwordx4 v43, s[12:15], s62 offen offset:3072 lds
    s_add_u32 m0, s64, 4096
    s_add_u32 s62, s62, 128
    s_bitset0_b32 s62, 10
    buffer_load_dwordx4 v40, s[12:15], s72 offen offset:0 lds
    buffer_load_dwordx4 v41, s[12:15], s72 offen offset:1024 lds
    buffer_load_dwordx4 v42, s[12:15], s72 offen offset:2048 lds
    buffer_load_dwordx4 v43, s[12:15], s72 offen offset:3072 lds
    s_mov_b32 m0, s73
    s_xor_b32 s64, s64, 0x10000
    buffer_load_dwordx4 v44, s[16:19], s63 offen offset:0 lds
    buffer_load_dwordx4 v45, s[16:19], s63 offen offset:1024 lds
    buffer_load_dwordx4 v46, s[16:19], s63 offen offset:2048 lds
    buffer_load_dwordx4 v47, s[16:19], s63 offen offset:3072 lds
    s_add_u32 m0, s73, 16384
    s_xor_b32 s73, s73, 0x10000
    buffer_load_dwordx4 v44, s[20:23], s63 offen offset:0 lds
    buffer_load_dwordx4 v45, s[20:23], s63 offen offset:1024 lds
    buffer_load_dwordx4 v46, s[20:23], s63 offen offset:2048 lds
    buffer_load_dwordx4 v47, s[20:23], s63 offen offset:3072 lds
    s_add_u32 s63, s63, 524288
    s_bitset0_b32 s63, 22
    s_setprio 1
L_st_v0:
    s_mov_b32 s8, s58
    s_mov_b32 s9, s59
    s_mov_b32 s10, 0x5000000
    s_mov_b32 s11, 0x20000
    s_mov_b32 s24, s36
    s_mov_b32 s25, s37
    s_mov_b32 s26, 0x500000
    s_mov_b32 s27, 0x20000
    v_lshlrev_b32 v13, 4, v1
    s_lshl_b32 s6, s5, 2
    s_add_u32 s7, s6, s3
    s_sub_u32 s6, 56, s6
    s_add_u32 s6, s6, s3
    s_cmp_lt_u32 s3, 4
    s_cselect_b32 s60, s7, s6
    s_sub_u32 s6, 2, s5
    s_and_b32 s6, s6, 7
    s_lshl_b32 s6, s6, 5
    s_add_u32 s61, s6, s4
    v_and_b32 v2, 15, v1
    v_lshrrev_b32 v3, 4, v1
    s_and_b32 s6, s3, 1
    s_lshl_b32 s6, s6, 7
    v_add_u32 v4, s6, v2
    v_lshlrev_b32 v4, 7, v4
    v_add_u32 v4, s100, v4
    v_lshrrev_b32 v5, 1, v2
    v_add_u32 v6, 0, v3
    v_xor_b32 v6, v6, v5
    v_lshl_add_u32 v48, v6, 4, v4
    v_add_u32 v6, 4, v3
    v_xor_b32 v6, v6, v5
    v_lshl_add_u32 v49, v6, 4, v4
    v_lshrrev_b32 v4, 2, v2
    v_lshl_add_u32 v5, v3, 3, v4
    v_lshlrev_b32 v5, 8, v5
    v_and_b32 v6, 1, v2
    v_lshl_add_u32 v5, v6, 3, v5
    v_and_b32 v6, 1, v3
    v_lshl_or_b32 v4, v6, 2, v4
    v_lshlrev_b32 v4, 1, v4
    v_bfe_u32 v6, v2, 1, 1
    v_add_u32 v8, 131072, v5
    v_add_u32 v7, 0, v6
    v_xor_b32 v7, v7, v4
    v_lshl_add_u32 v54, v7, 4, v8
    v_add_u32 v7, 2, v6
    v_xor_b32 v7, v7, v4
    v_lshl_add_u32 v55, v7, 4, v8
    v_add_u32 v7, 4, v6
    v_xor_b32 v7, v7, v4
    v_lshl_add_u32 v56, v7, 4, v8
    v_add_u32 v7, 6, v6
    v_xor_b32 v7, v7, v4
    v_lshl_add_u32 v57, v7, 4, v8
    v_add_u32 v7, 8, v6
    v_xor_b32 v7, v7, v4
    v_lshl_add_u32 v58, v7, 4, v8
    v_add_u32 v7, 10, v6
    v_xor_b32 v7, v7, v4
    v_lshl_add_u32 v59, v7, 4, v8
    v_add_u32 v7, 12, v6
    v_xor_b32 v7, v7, v4
    v_lshl_add_u32 v60, v7, 4, v8
    v_add_u32 v7, 14, v6
    v_xor_b32 v7, v7, v4
    v_lshl_add_u32 v61, v7, 4, v8
    s_lshr_b32 s6, s3, 2
    s_lshl_b32 s6, s6, 14
    s_add_u32 s6, s6, 32768
    s_add_u32 s6, s6, s100
    v_add_u32 v5, s6, v5
    s_lshr_b32 s7, s3, 1
    s_and_b32 s7, s7, 1
    s_lshl_b32 s7, s7, 3
    s_add_u32 s6, s7, 0
    v_add_u32 v7, s6, v6
    v_xor_b32 v7, v7, v4
    v_lshl_add_u32 v50, v7, 4, v5
    s_add_u32 s6, s7, 2
    v_add_u32 v7, s6, v6
    v_xor_b32 v7, v7, v4
    v_lshl_add_u32 v51, v7, 4, v5
    s_add_u32 s6, s7, 4
    v_add_u32 v7, s6, v6
    v_xor_b32 v7, v7, v4
    v_lshl_add_u32 v52, v7, 4, v5
    s_add_u32 s6, s7, 6
    v_add_u32 v7, s6, v6
    v_xor_b32 v7, v7, v4
    v_lshl_add_u32 v53, v7, 4, v5
    v_mov_b64 v[128:129], 0
    v_mov_b64 v[130:131], 0
    v_mov_b64 v[132:133], 0
    v_mov_b64 v[134:135], 0
    v_mov_b64 v[136:137], 0
    v_mov_b64 v[138:139], 0
    v_mov_b64 v[140:141], 0
    v_mov_b64 v[142:143], 0
    v_mov_b64 v[144:145], 0
    v_mov_b64 v[146:147], 0
    v_mov_b64 v[148:149], 0
    v_mov_b64 v[150:151], 0
    v_mov_b64 v[152:153], 0
    v_mov_b64 v[154:155], 0
    v_mov_b64 v[156:157], 0
    v_mov_b64 v[158:159], 0
    v_mov_b64 v[160:161], 0
    v_mov_b64 v[162:163], 0
    v_mov_b64 v[164:165], 0
    v_mov_b64 v[166:167], 0
    v_mov_b64 v[168:169], 0
    v_mov_b64 v[170:171], 0
    v_mov_b64 v[172:173], 0
    v_mov_b64 v[174:175], 0
    v_mov_b64 v[176:177], 0
    v_mov_b64 v[178:179], 0
    v_mov_b64 v[180:181], 0
    v_mov_b64 v[182:183], 0
    v_mov_b64 v[184:185], 0
    v_mov_b64 v[186:187], 0
    v_mov_b64 v[188:189], 0
    v_mov_b64 v[190:191], 0
    v_mov_b64 v[192:193], 0
    v_mov_b64 v[194:195], 0
    v_mov_b64 v[196:197], 0
    v_mov_b64 v[198:199], 0
    v_mov_b64 v[200:201], 0
    v_mov_b64 v[202:203], 0
    v_mov_b64 v[204:205], 0
    v_mov_b64 v[206:207], 0
    v_mov_b64 v[208:209], 0
    v_mov_b64 v[210:211], 0
    v_mov_b64 v[212:213], 0
    v_mov_b64 v[214:215], 0
    v_mov_b64 v[216:217], 0
    v_mov_b64 v[218:219], 0
    v_mov_b64 v[220:221], 0
    v_mov_b64 v[222:223], 0
    v_mov_b64 v[224:225], 0
    v_mov_b64 v[226:227], 0
    v_mov_b64 v[228:229], 0
    v_mov_b64 v[230:231], 0
    v_mov_b64 v[232:233], 0
    v_mov_b64 v[234:235], 0
    v_mov_b64 v[236:237], 0
    v_mov_b64 v[238:239], 0
    v_mov_b64 v[240:241], 0
    v_mov_b64 v[242:243], 0
    v_mov_b64 v[244:245], 0
    v_mov_b64 v[246:247], 0
    v_mov_b64 v[248:249], 0
    v_mov_b64 v[250:251], 0
    v_mov_b64 v[252:253], 0
    v_mov_b64 v[254:255], 0
    v_add_u32 v12, 20480, v13
    s_mul_i32 s70, s60, 40960
    s_mov_b32 s65, 0
    s_lshl_b32 s6, s4, 20
    s_lshl_b32 s7, s5, 13
    s_add_u32 s6, s6, s7
    s_and_b32 s7, s3, 1
    s_lshl_b32 s7, s7, 16
    s_add_u32 s6, s6, s7
    s_add_u32 s67, s6, 16777216
    s_and_b32 s6, s4, 3
    s_add_u32 s6, s6, s5
    s_sub_u32 s7, s6, 5
    s_cselect_b32 s6, s6, s7
    s_sub_u32 s7, s6, 5
    s_cselect_b32 s6, s6, s7
    s_lshl_b32 s71, s6, 20
    s_lshl_b32 s7, s4, 8
    s_add_u32 s71, s71, s7
    s_lshl_b32 s7, s6, 12
    s_add_u32 s84, s70, s7
    s_add_u32 s6, s6, 1
    s_cmp_eq_u32 s6, 5
    s_cselect_b32 s6, 0, s6
    s_lshl_b32 s7, s6, 12
    s_add_u32 s85, s70, s7
    s_add_u32 s6, s6, 1
    s_cmp_eq_u32 s6, 5
    s_cselect_b32 s6, 0, s6
    s_lshl_b32 s7, s6, 12
    s_add_u32 s86, s70, s7
    s_add_u32 s6, s6, 1
    s_cmp_eq_u32 s6, 5
    s_cselect_b32 s6, 0, s6
    s_lshl_b32 s7, s6, 12
    s_add_u32 s87, s70, s7
    s_add_u32 s6, s6, 1
    s_cmp_eq_u32 s6, 5
    s_cselect_b32 s6, 0, s6
    s_lshl_b32 s7, s6, 12
    s_add_u32 s88, s70, s7
    s_lshr_b32 s7, s3, 1
    s_and_b32 s7, s7, 1
    s_cmp_ge_u32 s3, 4
    s_cbranch_scc1 L_c_v
    s_lshl_b32 s7, s7, 11
    s_add_u32 s67, s67, s7
    s_movk_i32 s68, 3072
    s_mov_b32 s69, 125952
    s_add_u32 s71, s71, 1048576
    s_sub_u32 s75, s71, 5242880
    s_cselect_b32 s71, s71, s75
    s_lshl_b32 s74, s76, 12
    s_add_u32 s74, s74, s100
    s_branch L_c_j
L_c_v:
    s_lshl_b32 s7, s7, 12
    s_add_u32 s67, s67, s7
    s_add_u32 s67, s67, 0x80000
    s_movk_i32 s68, 1024
    s_mov_b32 s69, 128000
L_c_j:
    s_cmp_ge_u32 s3, 4
    s_cbranch_scc1 L_st_v1
    s_mov_b32 m0, s64
    s_add_u32 s72, s62, 524288
    buffer_load_dwordx4 v40, s[12:15], s62 offen offset:0 lds
    buffer_load_dwordx4 v41, s[12:15], s62 offen offset:1024 lds
    buffer_load_dwordx4 v42, s[12:15], s62 offen offset:2048 lds
    buffer_load_dwordx4 v43, s[12:15], s62 offen offset:3072 lds
    s_add_u32 m0, s64, 4096
    s_add_u32 s62, s62, 128
    s_bitset0_b32 s62, 10
    buffer_load_dwordx4 v40, s[12:15], s72 offen offset:0 lds
    buffer_load_dwordx4 v41, s[12:15], s72 offen offset:1024 lds
    buffer_load_dwordx4 v42, s[12:15], s72 offen offset:2048 lds
    buffer_load_dwordx4 v43, s[12:15], s72 offen offset:3072 lds
    s_waitcnt vmcnt(8)
    s_branch L_st_j1
L_st_v1:
    s_waitcnt vmcnt(0)
    v_lshlrev_b32 v64, 16, v16
    v_and_b32 v65, 0xffff0000, v16
    v_lshlrev_b32 v66, 16, v17
    v_and_b32 v67, 0xffff0000, v17
    v_lshlrev_b32 v68, 16, v18
    v_and_b32 v69, 0xffff0000, v18
    v_lshlrev_b32 v70, 16, v19
    v_and_b32 v71, 0xffff0000, v19
    v_lshlrev_b32 v72, 16, v20
    v_and_b32 v73, 0xffff0000, v20
    v_lshlrev_b32 v74, 16, v21
    v_and_b32 v75, 0xffff0000, v21
    v_lshlrev_b32 v76, 16, v22
    v_and_b32 v77, 0xffff0000, v22
    v_lshlrev_b32 v78, 16, v23
    v_and_b32 v79, 0xffff0000, v23
    v_lshlrev_b32 v80, 16, v24
    v_and_b32 v81, 0xffff0000, v24
    v_lshlrev_b32 v82, 16, v25
    v_and_b32 v83, 0xffff0000, v25
    v_pk_add_f32 v[2:3], v[64:65], v[66:67]
    v_pk_add_f32 v[2:3], v[2:3], v[68:69]
    v_pk_add_f32 v[2:3], v[2:3], v[70:71]
    v_pk_add_f32 v[2:3], v[2:3], v[72:73]
    v_pk_add_f32 v[2:3], v[2:3], v[74:75]
    v_pk_add_f32 v[2:3], v[2:3], v[76:77]
    v_pk_add_f32 v[2:3], v[2:3], v[78:79]
    v_pk_add_f32 v[2:3], v[2:3], v[80:81]
    v_pk_add_f32 v[2:3], v[2:3], v[82:83]
    v_add_f32 v2, v2, v3
    s_nop 1
    v_add_f32_dpp v2, v2, v2 quad_perm:[1,0,3,2] row_mask:0xf bank_mask:0xf
    s_nop 1
    v_add_f32_dpp v2, v2, v2 quad_perm:[2,3,0,1] row_mask:0xf bank_mask:0xf
    s_nop 1
    v_add_f32_dpp v2, v2, v2 row_half_mirror row_mask:0xf bank_mask:0xf
    s_nop 1
    v_add_f32_dpp v2, v2, v2 row_mirror row_mask:0xf bank_mask:0xf
    v_mov_b32 v8, v2
    s_nop 1
    v_permlane16_swap_b32 v2, v8
    s_nop 1
    v_add_f32 v2, v2, v8
    s_mov_b32 s7, 0x3acccccd
    v_mul_f32 v2, s7, v2
    v_mov_b64 v[4:5], 0
    v_pk_add_f32 v[6:7], v[64:65], v[2:3] op_sel_hi:[1,0] neg_lo:[0,1] neg_hi:[0,1]
    v_pk_fma_f32 v[4:5], v[6:7], v[6:7], v[4:5]
    v_pk_add_f32 v[6:7], v[66:67], v[2:3] op_sel_hi:[1,0] neg_lo:[0,1] neg_hi:[0,1]
    v_pk_fma_f32 v[4:5], v[6:7], v[6:7], v[4:5]
    v_pk_add_f32 v[6:7], v[68:69], v[2:3] op_sel_hi:[1,0] neg_lo:[0,1] neg_hi:[0,1]
    v_pk_fma_f32 v[4:5], v[6:7], v[6:7], v[4:5]
    v_pk_add_f32 v[6:7], v[70:71], v[2:3] op_sel_hi:[1,0] neg_lo:[0,1] neg_hi:[0,1]
    v_pk_fma_f32 v[4:5], v[6:7], v[6:7], v[4:5]
    v_pk_add_f32 v[6:7], v[72:73], v[2:3] op_sel_hi:[1,0] neg_lo:[0,1] neg_hi:[0,1]
    v_pk_fma_f32 v[4:5], v[6:7], v[6:7], v[4:5]
    v_pk_add_f32 v[6:7], v[74:75], v[2:3] op_sel_hi:[1,0] neg_lo:[0,1] neg_hi:[0,1]
    v_pk_fma_f32 v[4:5], v[6:7], v[6:7], v[4:5]
    v_pk_add_f32 v[6:7], v[76:77], v[2:3] op_sel_hi:[1,0] neg_lo:[0,1] neg_hi:[0,1]
    v_pk_fma_f32 v[4:5], v[6:7], v[6:7], v[4:5]
    v_pk_add_f32 v[6:7], v[78:79], v[2:3] op_sel_hi:[1,0] neg_lo:[0,1] neg_hi:[0,1]
    v_pk_fma_f32 v[4:5], v[6:7], v[6:7], v[4:5]
    v_pk_add_f32 v[6:7], v[80:81], v[2:3] op_sel_hi:[1,0] neg_lo:[0,1] neg_hi:[0,1]
    v_pk_fma_f32 v[4:5], v[6:7], v[6:7], v[4:5]
    v_pk_add_f32 v[6:7], v[82:83], v[2:3] op_sel_hi:[1,0] neg_lo:[0,1] neg_hi:[0,1]
    v_pk_fma_f32 v[4:5], v[6:7], v[6:7], v[4:5]
    v_add_f32 v4, v4, v5
    s_nop 1
    v_add_f32_dpp v4, v4, v4 quad_perm:[1,0,3,2] row_mask:0xf bank_mask:0xf
    s_nop 1
    v_add_f32_dpp v4, v4, v4 quad_perm:[2,3,0,1] row_mask:0xf bank_mask:0xf
    s_nop 1
    v_add_f32_dpp v4, v4, v4 row_half_mirror row_mask:0xf bank_mask:0xf
    s_nop 1
    v_add_f32_dpp v4, v4, v4 row_mirror row_mask:0xf bank_mask:0xf
    v_mov_b32 v8, v4
    s_nop 1
    v_permlane16_swap_b32 v4, v8
    s_nop 1
    v_add_f32 v4, v4, v8
    v_mul_f32 v4, s7, v4
    v_cvt_pk_bf16_f32 v2, v2, v2
    v_lshlrev_b32 v2, 16, v2
    v_cvt_pk_bf16_f32 v4, v4, v4
    v_lshlrev_b32 v4, 16, v4
    v_add_f32 v4, 0x3727c5ac, v4
    v_cvt_pk_bf16_f32 v4, v4, v4
    v_lshlrev_b32 v4, 16, v4
    v_sqrt_f32 v4, v4
    s_nop 0
    v_cvt_pk_bf16_f32 v4, v4, v4
    v_lshlrev_b32 v4, 16, v4
    v_rcp_f32 v6, v4
    s_nop 0
    v_fma_f32 v5, -v4, v6, 1.0
    v_fmac_f32 v6, v5, v6
    v_mov_b32 v9, 0
    v_pk_add_f32 v[64:65], v[64:65], v[2:3] op_sel_hi:[1,0] neg_lo:[0,1] neg_hi:[0,1]
    v_cvt_pk_bf16_f32 v5, v64, v65
    v_lshlrev_b32 v64, 16, v5
    v_and_b32 v65, 0xffff0000, v5
    v_pk_mul_f32 v[64:65], v[64:65], v[6:7] op_sel_hi:[1,0]
    v_cvt_pk_bf16_f32 v16, v64, v65
    v_pk_add_f32 v[66:67], v[66:67], v[2:3] op_sel_hi:[1,0] neg_lo:[0,1] neg_hi:[0,1]
    v_cvt_pk_bf16_f32 v5, v66, v67
    v_lshlrev_b32 v66, 16, v5
    v_and_b32 v67, 0xffff0000, v5
    v_pk_mul_f32 v[66:67], v[66:67], v[6:7] op_sel_hi:[1,0]
    v_cvt_pk_bf16_f32 v17, v66, v67
    v_pk_add_f32 v[68:69], v[68:69], v[2:3] op_sel_hi:[1,0] neg_lo:[0,1] neg_hi:[0,1]
    v_cvt_pk_bf16_f32 v5, v68, v69
    v_lshlrev_b32 v68, 16, v5
    v_and_b32 v69, 0xffff0000, v5
    v_pk_mul_f32 v[68:69], v[68:69], v[6:7] op_sel_hi:[1,0]
    v_cvt_pk_bf16_f32 v18, v68, v69
    v_pk_add_f32 v[70:71], v[70:71], v[2:3] op_sel_hi:[1,0] neg_lo:[0,1] neg_hi:[0,1]
    v_cvt_pk_bf16_f32 v5, v70, v71
    v_lshlrev_b32 v70, 16, v5
    v_and_b32 v71, 0xffff0000, v5
    v_pk_mul_f32 v[70:71], v[70:71], v[6:7] op_sel_hi:[1,0]
    v_cvt_pk_bf16_f32 v19, v70, v71
    v_pk_add_f32 v[72:73], v[72:73], v[2:3] op_sel_hi:[1,0] neg_lo:[0,1] neg_hi:[0,1]
    v_cvt_pk_bf16_f32 v5, v72, v73
    v_lshlrev_b32 v72, 16, v5
    v_and_b32 v73, 0xffff0000, v5
    v_pk_mul_f32 v[72:73], v[72:73], v[6:7] op_sel_hi:[1,0]
    v_cvt_pk_bf16_f32 v20, v72, v73
    v_pk_add_f32 v[74:75], v[74:75], v[2:3] op_sel_hi:[1,0] neg_lo:[0,1] neg_hi:[0,1]
    v_cvt_pk_bf16_f32 v5, v74, v75
    v_lshlrev_b32 v74, 16, v5
    v_and_b32 v75, 0xffff0000, v5
    v_pk_mul_f32 v[74:75], v[74:75], v[6:7] op_sel_hi:[1,0]
    v_cvt_pk_bf16_f32 v21, v74, v75
    v_pk_add_f32 v[76:77], v[76:77], v[2:3] op_sel_hi:[1,0] neg_lo:[0,1] neg_hi:[0,1]
    v_cvt_pk_bf16_f32 v5, v76, v77
    v_lshlrev_b32 v76, 16, v5
    v_and_b32 v77, 0xffff0000, v5
    v_pk_mul_f32 v[76:77], v[76:77], v[6:7] op_sel_hi:[1,0]
    v_cvt_pk_bf16_f32 v22, v76, v77
    v_pk_add_f32 v[78:79], v[78:79], v[2:3] op_sel_hi:[1,0] neg_lo:[0,1] neg_hi:[0,1]
    v_cvt_pk_bf16_f32 v5, v78, v79
    v_lshlrev_b32 v78, 16, v5
    v_and_b32 v79, 0xffff0000, v5
    v_pk_mul_f32 v[78:79], v[78:79], v[6:7] op_sel_hi:[1,0]
    v_cvt_pk_bf16_f32 v23, v78, v79
    v_pk_add_f32 v[80:81], v[80:81], v[2:3] op_sel_hi:[1,0] neg_lo:[0,1] neg_hi:[0,1]
    v_cvt_pk_bf16_f32 v5, v80, v81
    v_lshlrev_b32 v80, 16, v5
    v_and_b32 v81, 0xffff0000, v5
    v_pk_mul_f32 v[80:81], v[80:81], v[6:7] op_sel_hi:[1,0]
    v_cvt_pk_bf16_f32 v24, v80, v81
    v_pk_add_f32 v[82:83], v[82:83], v[2:3] op_sel_hi:[1,0] neg_lo:[0,1] neg_hi:[0,1]
    v_cvt_pk_bf16_f32 v5, v82, v83
    v_lshlrev_b32 v82, 16, v5
    v_and_b32 v83, 0xffff0000, v5
    v_pk_mul_f32 v[82:83], v[82:83], v[6:7] op_sel_hi:[1,0]
    v_cvt_pk_bf16_f32 v25, v82, v83
    v_add_u32 v10, 131072, v63
    ds_write_b64 v10, v[16:17] offset:0
    ds_write_b64 v10, v[18:19] offset:256
    ds_write_b64 v10, v[20:21] offset:512
    ds_write_b64 v10, v[22:23] offset:768
    ds_write_b64 v10, v[24:25] offset:1024
    s_waitcnt lgkmcnt(0)
    v_mov_b32 v2, 0
    v_lshlrev_b32 v4, 16, v16
    v_lshlrev_b32 v5, 16, v26
    v_fmac_f32 v2, v4, v5
    v_and_b32 v4, 0xffff0000, v16
    v_and_b32 v5, 0xffff0000, v26
    v_fmac_f32 v2, v4, v5
    v_lshlrev_b32 v4, 16, v17
    v_lshlrev_b32 v5, 16, v27
    v_fmac_f32 v2, v4, v5
    v_and_b32 v4, 0xffff0000, v17
    v_and_b32 v5, 0xffff0000, v27
    v_fmac_f32 v2, v4, v5
    v_lshlrev_b32 v4, 16, v18
    v_lshlrev_b32 v5, 16, v28
    v_fmac_f32 v2, v4, v5
    v_and_b32 v4, 0xffff0000, v18
    v_and_b32 v5, 0xffff0000, v28
    v_fmac_f32 v2, v4, v5
    v_lshlrev_b32 v4, 16, v19
    v_lshlrev_b32 v5, 16, v29
    v_fmac_f32 v2, v4, v5
    v_and_b32 v4, 0xffff0000, v19
    v_and_b32 v5, 0xffff0000, v29
    v_fmac_f32 v2, v4, v5
    v_lshlrev_b32 v4, 16, v20
    v_lshlrev_b32 v5, 16, v30
    v_fmac_f32 v2, v4, v5
    v_and_b32 v4, 0xffff0000, v20
    v_and_b32 v5, 0xffff0000, v30
    v_fmac_f32 v2, v4, v5
    v_lshlrev_b32 v4, 16, v21
    v_lshlrev_b32 v5, 16, v31
    v_fmac_f32 v2, v4, v5
    v_and_b32 v4, 0xffff0000, v21
    v_and_b32 v5, 0xffff0000, v31
    v_fmac_f32 v2, v4, v5
    v_lshlrev_b32 v4, 16, v22
    v_lshlrev_b32 v5, 16, v32
    v_fmac_f32 v2, v4, v5
    v_and_b32 v4, 0xffff0000, v22
    v_and_b32 v5, 0xffff0000, v32
    v_fmac_f32 v2, v4, v5
    v_lshlrev_b32 v4, 16, v23
    v_lshlrev_b32 v5, 16, v33
    v_fmac_f32 v2, v4, v5
    v_and_b32 v4, 0xffff0000, v23
    v_and_b32 v5, 0xffff0000, v33
    v_fmac_f32 v2, v4, v5
    v_lshlrev_b32 v4, 16, v24
    v_lshlrev_b32 v5, 16, v34
    v_fmac_f32 v2, v4, v5
    v_and_b32 v4, 0xffff0000, v24
    v_and_b32 v5, 0xffff0000, v34
    v_fmac_f32 v2, v4, v5
    v_lshlrev_b32 v4, 16, v25
    v_lshlrev_b32 v5, 16, v35
    v_fmac_f32 v2, v4, v5
    v_and_b32 v4, 0xffff0000, v25
    v_and_b32 v5, 0xffff0000, v35
    v_fmac_f32 v2, v4, v5
    s_nop 1
    v_add_f32_dpp v2, v2, v2 quad_perm:[1,0,3,2] row_mask:0xf bank_mask:0xf
    s_nop 1
    v_add_f32_dpp v2, v2, v2 quad_perm:[2,3,0,1] row_mask:0xf bank_mask:0xf
    s_nop 1
    v_add_f32_dpp v2, v2, v2 row_half_mirror row_mask:0xf bank_mask:0xf
    s_nop 1
    v_add_f32_dpp v2, v2, v2 row_mirror row_mask:0xf bank_mask:0xf
    v_mov_b32 v8, v2
    s_nop 1
    v_permlane16_swap_b32 v2, v8
    s_nop 1
    v_add_f32 v2, v2, v8
    v_cvt_pk_bf16_f32 v2, v2, v2
    v_and_b32 v2, 0xffff, v2
    v_bfe_i32 v3, v2, 15, 1
    v_and_b32 v3, 0x7fff, v3
    v_or_b32 v3, 0x8000, v3
    v_xor_b32 v2, v2, v3
    s_lshl_b32 s7, s2, 3
    s_sub_u32 s6, 2047, s7
    v_sub_u32 v3, s6, v62
    v_lshl_or_b32 v2, v2, 11, v3
    v_lshlrev_b32 v3, 2, v62
    v_add_u32 v3, 161792, v3
    ds_write_b32 v3, v2
    s_waitcnt lgkmcnt(0)
L_st_j1:
    s_barrier
    s_cmp_ge_u32 s3, 4
    s_cbranch_scc1 L_kv_v
    ds_read_b128 v[64:67], v48 offset:0
    ds_read_b128 v[68:71], v48 offset:2048
    ds_read_b64_tr_b16 v[96:97], v50 offset:0
    ds_read_b64_tr_b16 v[98:99], v50 offset:1024
    ds_read_b64_tr_b16 v[100:101], v51 offset:0
    ds_read_b64_tr_b16 v[102:103], v51 offset:1024
    ds_read_b128 v[72:75], v48 offset:4096
    ds_read_b64_tr_b16 v[104:105], v52 offset:0
    ds_read_b64_tr_b16 v[106:107], v52 offset:1024
    ds_read_b64_tr_b16 v[108:109], v53 offset:0
    ds_read_b64_tr_b16 v[110:111], v53 offset:1024
    ds_read_b128 v[76:79], v48 offset:6144
    ds_read_b128 v[80:83], v48 offset:8192
    ds_read_b128 v[84:87], v48 offset:10240
    ds_read_b128 v[88:91], v48 offset:12288
    ds_read_b128 v[92:95], v48 offset:14336
    s_mov_b32 m0, s73
    s_xor_b32 s64, s64, 0x10000
    buffer_load_dwordx4 v44, s[16:19], s63 offen offset:0 lds
    buffer_load_dwordx4 v45, s[16:19], s63 offen offset:1024 lds
    buffer_load_dwordx4 v46, s[16:19], s63 offen offset:2048 lds
    buffer_load_dwordx4 v47, s[16:19], s63 offen offset:3072 lds
    s_add_u32 m0, s73, 16384
    s_xor_b32 s73, s73, 0x10000
    buffer_load_dwordx4 v44, s[20:23], s63 offen offset:0 lds
    buffer_load_dwordx4 v45, s[20:23], s63 offen offset:1024 lds
    buffer_load_dwordx4 v46, s[20:23], s63 offen offset:2048 lds
    buffer_load_dwordx4 v47, s[20:23], s63 offen offset:3072 lds
    s_add_u32 s63, s63, 524288
    s_bitset0_b32 s63, 22
.p2align 4
L_kloopA:
    s_waitcnt lgkmcnt(12)
    v_mfma_f32_16x16x32_bf16 v[128:131], v[96:99], v[64:67], v[128:131]
    ds_read_b64_tr_b16 v[112:113], v50 offset:8192
    s_waitcnt lgkmcnt(11)
    v_mfma_f32_16x16x32_bf16 v[132:135], v[100:103], v[64:67], v[132:135]
    ds_read_b64_tr_b16 v[114:115], v50 offset:9216
    s_waitcnt lgkmcnt(9)
    v_mfma_f32_16x16x32_bf16 v[136:139], v[104:107], v[64:67], v[136:139]
    ds_read_b64_tr_b16 v[116:117], v51 offset:8192
    s_waitcnt lgkmcnt(8)
    v_mfma_f32_16x16x32_bf16 v[140:143], v[108:111], v[64:67], v[140:143]
    ds_read_b64_tr_b16 v[118:119], v51 offset:9216
    ds_read_b128 v[64:67], v49 offset:0
    v_mfma_f32_16x16x32_bf16 v[156:159], v[108:111], v[68:71], v[156:159]
    ds_read_b64_tr_b16 v[120:121], v52 offset:8192
    v_mfma_f32_16x16x32_bf16 v[152:155], v[104:107], v[68:71], v[152:155]
    ds_read_b64_tr_b16 v[122:123], v52 offset:9216
    v_mfma_f32_16x16x32_bf16 v[148:151], v[100:103], v[68:71], v[148:151]
    ds_read_b64_tr_b16 v[124:125], v53 offset:8192
    v_mfma_f32_16x16x32_bf16 v[144:147], v[96:99], v[68:71], v[144:147]
    ds_read_b64_tr_b16 v[126:127], v53 offset:9216
    ds_read_b128 v[68:71], v49 offset:2048
    v_mfma_f32_16x16x32_bf16 v[160:163], v[96:99], v[72:75], v[160:163]
    v_mfma_f32_16x16x32_bf16 v[164:167], v[100:103], v[72:75], v[164:167]
    v_mfma_f32_16x16x32_bf16 v[168:171], v[104:107], v[72:75], v[168:171]
    v_mfma_f32_16x16x32_bf16 v[172:175], v[108:111], v[72:75], v[172:175]
    ds_read_b128 v[72:75], v49 offset:4096
    s_waitcnt lgkmcnt(15)
    v_mfma_f32_16x16x32_bf16 v[188:191], v[108:111], v[76:79], v[188:191]
    v_mfma_f32_16x16x32_bf16 v[184:187], v[104:107], v[76:79], v[184:187]
    v_mfma_f32_16x16x32_bf16 v[180:183], v[100:103], v[76:79], v[180:183]
    v_mfma_f32_16x16x32_bf16 v[176:179], v[96:99], v[76:79], v[176:179]
    ds_read_b128 v[76:79], v49 offset:6144
    s_waitcnt lgkmcnt(15)
    v_mfma_f32_16x16x32_bf16 v[192:195], v[96:99], v[80:83], v[192:195]
    v_mfma_f32_16x16x32_bf16 v[196:199], v[100:103], v[80:83], v[196:199]
    v_mfma_f32_16x16x32_bf16 v[200:203], v[104:107], v[80:83], v[200:203]
    v_mfma_f32_16x16x32_bf16 v[204:207], v[108:111], v[80:83], v[204:207]
    ds_read_b128 v[80:83], v49 offset:8192
    s_waitcnt lgkmcnt(15)
    v_mfma_f32_16x16x32_bf16 v[220:223], v[108:111], v[84:87], v[220:223]
    v_mfma_f32_16x16x32_bf16 v[216:219], v[104:107], v[84:87], v[216:219]
    v_mfma_f32_16x16x32_bf16 v[212:215], v[100:103], v[84:87], v[212:215]
    v_mfma_f32_16x16x32_bf16 v[208:211], v[96:99], v[84:87], v[208:211]
    ds_read_b128 v[84:87], v49 offset:10240
    s_waitcnt lgkmcnt(15)
    v_mfma_f32_16x16x32_bf16 v[224:227], v[96:99], v[88:91], v[224:227]
    v_mfma_f32_16x16x32_bf16 v[228:231], v[100:103], v[88:91], v[228:231]
    v_mfma_f32_16x16x32_bf16 v[232:235], v[104:107], v[88:91], v[232:235]
    v_mfma_f32_16x16x32_bf16 v[236:239], v[108:111], v[88:91], v[236:239]
    ds_read_b128 v[88:91], v49 offset:12288
    s_waitcnt lgkmcnt(15)
    v_mfma_f32_16x16x32_bf16 v[252:255], v[108:111], v[92:95], v[252:255]
    v_mfma_f32_16x16x32_bf16 v[248:251], v[104:107], v[92:95], v[248:251]
    v_mfma_f32_16x16x32_bf16 v[244:247], v[100:103], v[92:95], v[244:247]
    v_mfma_f32_16x16x32_bf16 v[240:243], v[96:99], v[92:95], v[240:243]
    ds_read_b128 v[92:95], v49 offset:14336
    s_waitcnt lgkmcnt(11)
    v_mfma_f32_16x16x32_bf16 v[128:131], v[112:115], v[64:67], v[128:131]
    v_mfma_f32_16x16x32_bf16 v[132:135], v[116:119], v[64:67], v[132:135]
    s_waitcnt lgkmcnt(9)
    v_mfma_f32_16x16x32_bf16 v[136:139], v[120:123], v[64:67], v[136:139]
    s_waitcnt lgkmcnt(7)
    v_mfma_f32_16x16x32_bf16 v[140:143], v[124:127], v[64:67], v[140:143]
    s_waitcnt lgkmcnt(6)
    v_mfma_f32_16x16x32_bf16 v[156:159], v[124:127], v[68:71], v[156:159]
    v_mfma_f32_16x16x32_bf16 v[152:155], v[120:123], v[68:71], v[152:155]
    v_mfma_f32_16x16x32_bf16 v[148:151], v[116:119], v[68:71], v[148:151]
    v_mfma_f32_16x16x32_bf16 v[144:147], v[112:115], v[68:71], v[144:147]
    v_xor_b32 v48, 0x10000, v48
    v_xor_b32 v49, 0x10000, v49
    v_xor_b32 v50, 0x10000, v50
    v_xor_b32 v51, 0x10000, v51
    v_xor_b32 v52, 0x10000, v52
    v_xor_b32 v53, 0x10000, v53
    s_waitcnt vmcnt(0) lgkmcnt(0)
    s_barrier
    ds_read_b128 v[64:67], v48 offset:0
    ds_read_b128 v[68:71], v48 offset:2048
    v_mfma_f32_16x16x32_bf16 v[160:163], v[112:115], v[72:75], v[160:163]
    ds_read_b64_tr_b16 v[96:97], v50 offset:0
    s_mov_b32 m0, s64
    s_add_u32 s72, s62, 524288
    v_mfma_f32_16x16x32_bf16 v[164:167], v[116:119], v[72:75], v[164:167]
    ds_read_b64_tr_b16 v[98:99], v50 offset:1024
    buffer_load_dwordx4 v40, s[12:15], s62 offen offset:0 lds
    v_mfma_f32_16x16x32_bf16 v[168:171], v[120:123], v[72:75], v[168:171]
    ds_read_b64_tr_b16 v[100:101], v51 offset:0
    buffer_load_dwordx4 v41, s[12:15], s62 offen offset:1024 lds
    v_mfma_f32_16x16x32_bf16 v[172:175], v[124:127], v[72:75], v[172:175]
    ds_read_b64_tr_b16 v[102:103], v51 offset:1024
    buffer_load_dwordx4 v42, s[12:15], s62 offen offset:2048 lds
    ds_read_b128 v[72:75], v48 offset:4096
    v_mfma_f32_16x16x32_bf16 v[188:191], v[124:127], v[76:79], v[188:191]
    ds_read_b64_tr_b16 v[104:105], v52 offset:0
    buffer_load_dwordx4 v43, s[12:15], s62 offen offset:3072 lds
    v_mfma_f32_16x16x32_bf16 v[184:187], v[120:123], v[76:79], v[184:187]
    ds_read_b64_tr_b16 v[106:107], v52 offset:1024
    s_add_u32 m0, s64, 4096
    s_add_u32 s62, s62, 128
    s_bitset0_b32 s62, 10
    v_mfma_f32_16x16x32_bf16 v[180:183], v[116:119], v[76:79], v[180:183]
    ds_read_b64_tr_b16 v[108:109], v53 offset:0
    buffer_load_dwordx4 v40, s[12:15], s72 offen offset:0 lds
    v_mfma_f32_16x16x32_bf16 v[176:179], v[112:115], v[76:79], v[176:179]
    ds_read_b64_tr_b16 v[110:111], v53 offset:1024
    buffer_load_dwordx4 v41, s[12:15], s72 offen offset:1024 lds
    ds_read_b128 v[76:79], v48 offset:6144
    v_mfma_f32_16x16x32_bf16 v[192:195], v[112:115], v[80:83], v[192:195]
    buffer_load_dwordx4 v42, s[12:15], s72 offen offset:2048 lds
    v_mfma_f32_16x16x32_bf16 v[196:199], v[116:119], v[80:83], v[196:199]
    buffer_load_dwordx4 v43, s[12:15], s72 offen offset:3072 lds
    v_mfma_f32_16x16x32_bf16 v[200:203], v[120:123], v[80:83], v[200:203]
    s_mov_b32 m0, s73
    s_xor_b32 s64, s64, 0x10000
    v_mfma_f32_16x16x32_bf16 v[204:207], v[124:127], v[80:83], v[204:207]
    buffer_load_dwordx4 v44, s[16:19], s63 offen offset:0 lds
    ds_read_b128 v[80:83], v48 offset:8192
    v_mfma_f32_16x16x32_bf16 v[220:223], v[124:127], v[84:87], v[220:223]
    buffer_load_dwordx4 v45, s[16:19], s63 offen offset:1024 lds
    v_mfma_f32_16x16x32_bf16 v[216:219], v[120:123], v[84:87], v[216:219]
    buffer_load_dwordx4 v46, s[16:19], s63 offen offset:2048 lds
    v_mfma_f32_16x16x32_bf16 v[212:215], v[116:119], v[84:87], v[212:215]
    buffer_load_dwordx4 v47, s[16:19], s63 offen offset:3072 lds
    v_mfma_f32_16x16x32_bf16 v[208:211], v[112:115], v[84:87], v[208:211]
    s_add_u32 m0, s73, 16384
    s_xor_b32 s73, s73, 0x10000
    ds_read_b128 v[84:87], v48 offset:10240
    v_mfma_f32_16x16x32_bf16 v[224:227], v[112:115], v[88:91], v[224:227]
    buffer_load_dwordx4 v44, s[20:23], s63 offen offset:0 lds
    v_mfma_f32_16x16x32_bf16 v[228:231], v[116:119], v[88:91], v[228:231]
    buffer_load_dwordx4 v45, s[20:23], s63 offen offset:1024 lds
    v_mfma_f32_16x16x32_bf16 v[232:235], v[120:123], v[88:91], v[232:235]
    buffer_load_dwordx4 v46, s[20:23], s63 offen offset:2048 lds
    v_mfma_f32_16x16x32_bf16 v[236:239], v[124:127], v[88:91], v[236:239]
    buffer_load_dwordx4 v47, s[20:23], s63 offen offset:3072 lds
    ds_read_b128 v[88:91], v48 offset:12288
    v_mfma_f32_16x16x32_bf16 v[252:255], v[124:127], v[92:95], v[252:255]
    s_add_u32 s63, s63, 524288
    s_bitset0_b32 s63, 22
    v_mfma_f32_16x16x32_bf16 v[248:251], v[120:123], v[92:95], v[248:251]
    v_mfma_f32_16x16x32_bf16 v[244:247], v[116:119], v[92:95], v[244:247]
    v_mfma_f32_16x16x32_bf16 v[240:243], v[112:115], v[92:95], v[240:243]
    ds_read_b128 v[92:95], v48 offset:14336
    s_add_u32 s65, s65, 1
    s_cmp_lt_u32 s65, 6
    s_cbranch_scc1 L_kloopA
.p2align 4
L_kloopB:
    s_bitcmp1_b32 128, s65
    s_cbranch_scc1 L_khook
L_khook_back:
    s_waitcnt lgkmcnt(12)
    v_mfma_f32_16x16x32_bf16 v[128:131], v[96:99], v[64:67], v[128:131]
    ds_read_b64_tr_b16 v[112:113], v50 offset:8192
    s_waitcnt lgkmcnt(11)
    v_mfma_f32_16x16x32_bf16 v[132:135], v[100:103], v[64:67], v[132:135]
    ds_read_b64_tr_b16 v[114:115], v50 offset:9216
    s_waitcnt lgkmcnt(9)
    v_mfma_f32_16x16x32_bf16 v[136:139], v[104:107], v[64:67], v[136:139]
    ds_read_b64_tr_b16 v[116:117], v51 offset:8192
    s_waitcnt lgkmcnt(8)
    v_mfma_f32_16x16x32_bf16 v[140:143], v[108:111], v[64:67], v[140:143]
    ds_read_b64_tr_b16 v[118:119], v51 offset:9216
    ds_read_b128 v[64:67], v49 offset:0
    v_mfma_f32_16x16x32_bf16 v[156:159], v[108:111], v[68:71], v[156:159]
    ds_read_b64_tr_b16 v[120:121], v52 offset:8192
    v_mfma_f32_16x16x32_bf16 v[152:155], v[104:107], v[68:71], v[152:155]
    ds_read_b64_tr_b16 v[122:123], v52 offset:9216
    v_mfma_f32_16x16x32_bf16 v[148:151], v[100:103], v[68:71], v[148:151]
    ds_read_b64_tr_b16 v[124:125], v53 offset:8192
    v_mfma_f32_16x16x32_bf16 v[144:147], v[96:99], v[68:71], v[144:147]
    ds_read_b64_tr_b16 v[126:127], v53 offset:9216
    ds_read_b128 v[68:71], v49 offset:2048
    v_mfma_f32_16x16x32_bf16 v[160:163], v[96:99], v[72:75], v[160:163]
    v_mfma_f32_16x16x32_bf16 v[164:167], v[100:103], v[72:75], v[164:167]
    v_mfma_f32_16x16x32_bf16 v[168:171], v[104:107], v[72:75], v[168:171]
    v_mfma_f32_16x16x32_bf16 v[172:175], v[108:111], v[72:75], v[172:175]
    ds_read_b128 v[72:75], v49 offset:4096
    s_waitcnt lgkmcnt(15)
    v_mfma_f32_16x16x32_bf16 v[188:191], v[108:111], v[76:79], v[188:191]
    v_mfma_f32_16x16x32_bf16 v[184:187], v[104:107], v[76:79], v[184:187]
    v_mfma_f32_16x16x32_bf16 v[180:183], v[100:103], v[76:79], v[180:183]
    v_mfma_f32_16x16x32_bf16 v[176:179], v[96:99], v[76:79], v[176:179]
    ds_read_b128 v[76:79], v49 offset:6144
    s_waitcnt lgkmcnt(15)
    v_mfma_f32_16x16x32_bf16 v[192:195], v[96:99], v[80:83], v[192:195]
    v_mfma_f32_16x16x32_bf16 v[196:199], v[100:103], v[80:83], v[196:199]
    v_mfma_f32_16x16x32_bf16 v[200:203], v[104:107], v[80:83], v[200:203]
    v_mfma_f32_16x16x32_bf16 v[204:207], v[108:111], v[80:83], v[204:207]
    ds_read_b128 v[80:83], v49 offset:8192
    s_waitcnt lgkmcnt(15)
    v_mfma_f32_16x16x32_bf16 v[220:223], v[108:111], v[84:87], v[220:223]
    v_mfma_f32_16x16x32_bf16 v[216:219], v[104:107], v[84:87], v[216:219]
    v_mfma_f32_16x16x32_bf16 v[212:215], v[100:103], v[84:87], v[212:215]
    v_mfma_f32_16x16x32_bf16 v[208:211], v[96:99], v[84:87], v[208:211]
    ds_read_b128 v[84:87], v49 offset:10240
    s_waitcnt lgkmcnt(15)
    v_mfma_f32_16x16x32_bf16 v[224:227], v[96:99], v[88:91], v[224:227]
    v_mfma_f32_16x16x32_bf16 v[228:231], v[100:103], v[88:91], v[228:231]
    v_mfma_f32_16x16x32_bf16 v[232:235], v[104:107], v[88:91], v[232:235]
    v_mfma_f32_16x16x32_bf16 v[236:239], v[108:111], v[88:91], v[236:239]
    ds_read_b128 v[88:91], v49 offset:12288
    s_waitcnt lgkmcnt(15)
    v_mfma_f32_16x16x32_bf16 v[252:255], v[108:111], v[92:95], v[252:255]
    v_mfma_f32_16x16x32_bf16 v[248:251], v[104:107], v[92:95], v[248:251]
    v_mfma_f32_16x16x32_bf16 v[244:247], v[100:103], v[92:95], v[244:247]
    v_mfma_f32_16x16x32_bf16 v[240:243], v[96:99], v[92:95], v[240:243]
    ds_read_b128 v[92:95], v49 offset:14336
    s_waitcnt lgkmcnt(11)
    v_mfma_f32_16x16x32_bf16 v[128:131], v[112:115], v[64:67], v[128:131]
    v_mfma_f32_16x16x32_bf16 v[132:135], v[116:119], v[64:67], v[132:135]
    s_waitcnt lgkmcnt(9)
    v_mfma_f32_16x16x32_bf16 v[136:139], v[120:123], v[64:67], v[136:139]
    s_waitcnt lgkmcnt(7)
    v_mfma_f32_16x16x32_bf16 v[140:143], v[124:127], v[64:67], v[140:143]
    s_waitcnt lgkmcnt(6)
    v_mfma_f32_16x16x32_bf16 v[156:159], v[124:127], v[68:71], v[156:159]
    v_mfma_f32_16x16x32_bf16 v[152:155], v[120:123], v[68:71], v[152:155]
    v_mfma_f32_16x16x32_bf16 v[148:151], v[116:119], v[68:71], v[148:151]
    v_mfma_f32_16x16x32_bf16 v[144:147], v[112:115], v[68:71], v[144:147]
    v_xor_b32 v48, 0x10000, v48
    v_xor_b32 v49, 0x10000, v49
    v_xor_b32 v50, 0x10000, v50
    v_xor_b32 v51, 0x10000, v51
    v_xor_b32 v52, 0x10000, v52
    v_xor_b32 v53, 0x10000, v53
    s_waitcnt vmcnt(0) lgkmcnt(0)
    s_barrier
    ds_read_b128 v[64:67], v48 offset:0
    ds_read_b128 v[68:71], v48 offset:2048
    v_mfma_f32_16x16x32_bf16 v[160:163], v[112:115], v[72:75], v[160:163]
    ds_read_b64_tr_b16 v[96:97], v50 offset:0
    s_mov_b32 m0, s74
    s_add_u32 s74, s74, 16384
    s_bitset0_b32 s74, 17
    v_mfma_f32_16x16x32_bf16 v[164:167], v[116:119], v[72:75], v[164:167]
    ds_read_b64_tr_b16 v[98:99], v50 offset:1024
    buffer_load_dwordx4 v44, s[24:27], s71 offen offset:0 lds
    v_mfma_f32_16x16x32_bf16 v[168:171], v[120:123], v[72:75], v[168:171]
    ds_read_b64_tr_b16 v[100:101], v51 offset:0
    buffer_load_dwordx4 v45, s[24:27], s71 offen offset:1024 lds
    v_mfma_f32_16x16x32_bf16 v[172:175], v[124:127], v[72:75], v[172:175]
    ds_read_b64_tr_b16 v[102:103], v51 offset:1024
    buffer_load_dwordx4 v46, s[24:27], s71 offen offset:2048 lds
    ds_read_b128 v[72:75], v48 offset:4096
    v_mfma_f32_16x16x32_bf16 v[188:191], v[124:127], v[76:79], v[188:191]
    ds_read_b64_tr_b16 v[104:105], v52 offset:0
    buffer_load_dwordx4 v47, s[24:27], s71 offen offset:3072 lds
    v_mfma_f32_16x16x32_bf16 v[184:187], v[120:123], v[76:79], v[184:187]
    ds_read_b64_tr_b16 v[106:107], v52 offset:1024
    s_add_u32 s71, s71, 524288
    s_sub_u32 s75, s71, 5242880
    s_cselect_b32 s71, s71, s75
    v_mfma_f32_16x16x32_bf16 v[180:183], v[116:119], v[76:79], v[180:183]
    ds_read_b64_tr_b16 v[108:109], v53 offset:0
    s_mov_b32 m0, s74
    s_add_u32 s74, s74, 16384
    s_bitset0_b32 s74, 17
    v_mfma_f32_16x16x32_bf16 v[176:179], v[112:115], v[76:79], v[176:179]
    ds_read_b64_tr_b16 v[110:111], v53 offset:1024
    buffer_load_dwordx4 v44, s[24:27], s71 offen offset:0 lds
    ds_read_b128 v[76:79], v48 offset:6144
    v_mfma_f32_16x16x32_bf16 v[192:195], v[112:115], v[80:83], v[192:195]
    buffer_load_dwordx4 v45, s[24:27], s71 offen offset:1024 lds
    v_mfma_f32_16x16x32_bf16 v[196:199], v[116:119], v[80:83], v[196:199]
    buffer_load_dwordx4 v46, s[24:27], s71 offen offset:2048 lds
    v_mfma_f32_16x16x32_bf16 v[200:203], v[120:123], v[80:83], v[200:203]
    buffer_load_dwordx4 v47, s[24:27], s71 offen offset:3072 lds
    v_mfma_f32_16x16x32_bf16 v[204:207], v[124:127], v[80:83], v[204:207]
    s_add_u32 s71, s71, 524288
    s_sub_u32 s75, s71, 5242880
    s_cselect_b32 s71, s71, s75
    ds_read_b128 v[80:83], v48 offset:8192
    v_mfma_f32_16x16x32_bf16 v[220:223], v[124:127], v[84:87], v[220:223]
    s_mov_b32 m0, s74
    s_add_u32 s74, s74, 16384
    s_bitset0_b32 s74, 17
    v_mfma_f32_16x16x32_bf16 v[216:219], v[120:123], v[84:87], v[216:219]
    buffer_load_dwordx4 v44, s[24:27], s71 offen offset:0 lds
    v_mfma_f32_16x16x32_bf16 v[212:215], v[116:119], v[84:87], v[212:215]
    buffer_load_dwordx4 v45, s[24:27], s71 offen offset:1024 lds
    v_mfma_f32_16x16x32_bf16 v[208:211], v[112:115], v[84:87], v[208:211]
    buffer_load_dwordx4 v46, s[24:27], s71 offen offset:2048 lds
    ds_read_b128 v[84:87], v48 offset:10240
    v_mfma_f32_16x16x32_bf16 v[224:227], v[112:115], v[88:91], v[224:227]
    buffer_load_dwordx4 v47, s[24:27], s71 offen offset:3072 lds
    v_mfma_f32_16x16x32_bf16 v[228:231], v[116:119], v[88:91], v[228:231]
    s_add_u32 s71, s71, 524288
    s_sub_u32 s75, s71, 5242880
    s_cselect_b32 s71, s71, s75
    v_mfma_f32_16x16x32_bf16 v[232:235], v[120:123], v[88:91], v[232:235]
    s_mov_b32 m0, s74
    s_add_u32 s74, s74, 16384
    s_bitset0_b32 s74, 17
    v_mfma_f32_16x16x32_bf16 v[236:239], v[124:127], v[88:91], v[236:239]
    buffer_load_dwordx4 v44, s[24:27], s71 offen offset:0 lds
    ds_read_b128 v[88:91], v48 offset:12288
    v_mfma_f32_16x16x32_bf16 v[252:255], v[124:127], v[92:95], v[252:255]
    buffer_load_dwordx4 v45, s[24:27], s71 offen offset:1024 lds
    v_mfma_f32_16x16x32_bf16 v[248:251], v[120:123], v[92:95], v[248:251]
    buffer_load_dwordx4 v46, s[24:27], s71 offen offset:2048 lds
    v_mfma_f32_16x16x32_bf16 v[244:247], v[116:119], v[92:95], v[244:247]
    buffer_load_dwordx4 v47, s[24:27], s71 offen offset:3072 lds
    v_mfma_f32_16x16x32_bf16 v[240:243], v[112:115], v[92:95], v[240:243]
    s_add_u32 s71, s71, 524288
    s_sub_u32 s75, s71, 5242880
    s_cselect_b32 s71, s71, s75
    ds_read_b128 v[92:95], v48 offset:14336
    s_add_u32 s65, s65, 1
    s_cmp_lt_u32 s65, 8
    s_cbranch_scc1 L_kloopB
    s_waitcnt lgkmcnt(0)
    s_nop 7
    v_cvt_pk_bf16_f32 v128, v128, v129
    v_cvt_pk_bf16_f32 v129, v130, v131
    v_cvt_pk_bf16_f32 v130, v132, v133
    v_cvt_pk_bf16_f32 v131, v134, v135
    v_cvt_pk_bf16_f32 v132, v136, v137
    v_cvt_pk_bf16_f32 v133, v138, v139
    v_cvt_pk_bf16_f32 v134, v140, v141
    v_cvt_pk_bf16_f32 v135, v142, v143
    v_cvt_pk_bf16_f32 v136, v144, v145
    v_cvt_pk_bf16_f32 v137, v146, v147
    v_cvt_pk_bf16_f32 v138, v148, v149
    v_cvt_pk_bf16_f32 v139, v150, v151
    v_cvt_pk_bf16_f32 v140, v152, v153
    v_cvt_pk_bf16_f32 v141, v154, v155
    v_cvt_pk_bf16_f32 v142, v156, v157
    v_cvt_pk_bf16_f32 v143, v158, v159
    v_cvt_pk_bf16_f32 v144, v160, v161
    v_cvt_pk_bf16_f32 v145, v162, v163
    v_cvt_pk_bf16_f32 v146, v164, v165
    v_cvt_pk_bf16_f32 v147, v166, v167
    v_cvt_pk_bf16_f32 v148, v168, v169
    v_cvt_pk_bf16_f32 v149, v170, v171
    v_cvt_pk_bf16_f32 v150, v172, v173
    v_cvt_pk_bf16_f32 v151, v174, v175
    v_cvt_pk_bf16_f32 v152, v176, v177
    v_cvt_pk_bf16_f32 v153, v178, v179
    v_cvt_pk_bf16_f32 v154, v180, v181
    v_cvt_pk_bf16_f32 v155, v182, v183
    v_cvt_pk_bf16_f32 v156, v184, v185
    v_cvt_pk_bf16_f32 v157, v186, v187
    v_cvt_pk_bf16_f32 v158, v188, v189
    v_cvt_pk_bf16_f32 v159, v190, v191
    v_cvt_pk_bf16_f32 v160, v192, v193
    v_cvt_pk_bf16_f32 v161, v194, v195
    v_cvt_pk_bf16_f32 v162, v196, v197
    v_cvt_pk_bf16_f32 v163, v198, v199
    v_cvt_pk_bf16_f32 v164, v200, v201
    v_cvt_pk_bf16_f32 v165, v202, v203
    v_cvt_pk_bf16_f32 v166, v204, v205
    v_cvt_pk_bf16_f32 v167, v206, v207
    v_cvt_pk_bf16_f32 v168, v208, v209
    v_cvt_pk_bf16_f32 v169, v210, v211
    v_cvt_pk_bf16_f32 v170, v212, v213
    v_cvt_pk_bf16_f32 v171, v214, v215
    v_cvt_pk_bf16_f32 v172, v216, v217
    v_cvt_pk_bf16_f32 v173, v218, v219
    v_cvt_pk_bf16_f32 v174, v220, v221
    v_cvt_pk_bf16_f32 v175, v222, v223
    v_cvt_pk_bf16_f32 v176, v224, v225
    v_cvt_pk_bf16_f32 v177, v226, v227
    v_cvt_pk_bf16_f32 v178, v228, v229
    v_cvt_pk_bf16_f32 v179, v230, v231
    v_cvt_pk_bf16_f32 v180, v232, v233
    v_cvt_pk_bf16_f32 v181, v234, v235
    v_cvt_pk_bf16_f32 v182, v236, v237
    v_cvt_pk_bf16_f32 v183, v238, v239
    v_cvt_pk_bf16_f32 v184, v240, v241
    v_cvt_pk_bf16_f32 v185, v242, v243
    v_cvt_pk_bf16_f32 v186, v244, v245
    v_cvt_pk_bf16_f32 v187, v246, v247
    v_cvt_pk_bf16_f32 v188, v248, v249
    v_cvt_pk_bf16_f32 v189, v250, v251
    v_cvt_pk_bf16_f32 v190, v252, v253
    v_cvt_pk_bf16_f32 v191, v254, v255
    s_waitcnt vmcnt(16)
    s_branch L_q
L_hook:
    s_cmp_eq_u32 s65, 1
    s_cbranch_scc1 L_hook1
    s_cmp_eq_u32 s65, 2
    s_cbranch_scc1 L_hook2
    s_cmp_eq_u32 s65, 4
    s_cbranch_scc1 L_hook4
    s_cmp_eq_u32 s65, 6
    s_cbranch_scc1 L_hook6
    s_cmp_lg_u32 s65, 7
    s_cbranch_scc1 L_hook_back
    buffer_load_dwordx4 v[16:19], v13, s[8:11], s84 offen offset:0 sc1
    buffer_load_dwordx4 v[20:23], v12, s[8:11], s84 offen offset:0 sc1
    buffer_load_dwordx4 v[24:27], v13, s[8:11], s84 offen offset:1024 sc1
    buffer_load_dwordx4 v[28:31], v12, s[8:11], s84 offen offset:1024 sc1
    buffer_load_dwordx4 v[32:35], v13, s[8:11], s84 offen offset:2048 sc1
    buffer_load_dwordx4 v[36:39], v12, s[8:11], s84 offen offset:2048 sc1
    s_branch L_hook_back
L_hook1:
    s_cmp_ge_u32 s76, 2
    s_cbranch_scc1 L_tch_1a
    s_and_b32 s6, s4, 3
    s_lshl_b32 s6, s6, 19
    s_lshl_b32 s7, s5, 15
    s_add_u32 s6, s6, s7
    s_lshl_b32 s7, s76, 7
    s_add_u32 s6, s6, s7
    s_add_u32 s6, s6, 512
    v_lshrrev_b32 v6, 1, v1
    v_lshlrev_b32 v6, 10, v6
    v_and_b32 v7, 1, v1
    v_lshl_add_u32 v6, v7, 6, v6
    buffer_load_dword v11, v6, s[12:15], s6 offen
    s_add_u32 s6, s6, 262144
    buffer_load_dword v11, v6, s[12:15], s6 offen
    s_branch L_tch_1c
L_tch_1a:
    v_lshrrev_b32 v6, 5, v1
    v_lshlrev_b32 v6, 6, v6
    v_bfe_u32 v7, v1, 2, 3
    v_add_u32 v6, v6, v7
    v_lshlrev_b32 v6, 13, v6
    v_and_b32 v7, 3, v1
    v_lshl_add_u32 v6, v7, 6, v6
    s_lshl_b32 s6, s4, 8
    s_lshl_b32 s7, s5, 16
    s_add_u32 s6, s6, s7
    s_add_u32 s6, s6, 2097152
    s_cmp_lg_u32 s76, 2
    s_cbranch_scc1 L_tch_1b
    buffer_load_dword v11, v6, s[16:19], s6 offen
    s_branch L_tch_1c
L_tch_1b:
    buffer_load_dword v11, v6, s[20:23], s6 offen
L_tch_1c:
    s_branch L_hook_back
L_hook2:
    s_lshr_b32 s72, s2, 1
    s_mul_i32 s72, s72, 20480
    s_and_b32 s7, s2, 1
    s_lshl_b32 s7, s7, 7
    s_add_u32 s72, s72, s7
    v_add_u32 v2, -256, v0
    v_lshrrev_b32 v3, 3, v2
    v_and_b32 v4, 7, v2
    v_mul_u32_u24 v5, 1280, v4
    v_lshl_add_u32 v5, v3, 4, v5
    v_add_u32 v5, 131072, v5
    ds_read_b128 v[16:19], v5
    v_lshlrev_b32 v5, 8, v3
    v_lshl_add_u32 v6, v4, 4, v5
    v_add_u32 v2, 0, v0
    v_lshrrev_b32 v3, 3, v2
    v_and_b32 v4, 7, v2
    v_mul_u32_u24 v5, 1280, v4
    v_lshl_add_u32 v5, v3, 4, v5
    v_add_u32 v5, 131072, v5
    ds_read_b128 v[24:27], v5
    v_lshlrev_b32 v5, 8, v3
    v_lshl_add_u32 v7, v4, 4, v5
    v_add_u32 v2, 256, v0
    v_lshrrev_b32 v3, 3, v2
    v_and_b32 v4, 7, v2
    v_mul_u32_u24 v5, 1280, v4
    v_lshl_add_u32 v5, v3, 4, v5
    v_add_u32 v5, 131072, v5
    ds_read_b128 v[32:35], v5
    v_lshlrev_b32 v5, 8, v3
    v_lshl_add_u32 v8, v4, 4, v5
    s_waitcnt lgkmcnt(0)
    buffer_store_dwordx4 v[16:19], v6, s[8:11], s72 offen sc1
    buffer_store_dwordx4 v[24:27], v7, s[8:11], s72 offen sc1
    s_cmp_ge_u32 s3, 6
    s_cbranch_scc1 L_lns
    buffer_store_dwordx4 v[32:35], v8, s[8:11], s72 offen sc1
L_lns:
    s_cmp_lt_u32 s3, 6
    s_cbranch_scc1 L_zd
    v_mov_b64 v[36:37], 0
    v_mov_b64 v[38:39], 0
    v_lshrrev_b32 v2, 3, v1
    s_cmp_eq_u32 s3, 6
    s_cbranch_scc1 L_z6
    s_lshl_b32 s6, s5, 2
    s_sub_u32 s7, 56, s6
    v_mov_b32 v3, s6
    v_mov_b32 v4, s7
    v_cmp_gt_u32 vcc, 4, v2
    s_lshl_b32 s6, s4, 7
    s_add_u32 s6, s6, 3932160
    v_cndmask_b32 v3, v4, v3, vcc
    v_add_u32 v3, v3, v2
    v_lshl_add_u32 v3, v3, 12, s6
    s_branch L_z7
L_z6:
    v_mov_b32 v3, 0x5000000
    s_lshl_b32 s6, s4, 3
    s_add_u32 s6, s6, s5
    s_lshl_b32 s6, s6, 5
    s_add_u32 s6, s6, s3
    s_lshl_b32 s6, s6, 2
    s_add_u32 s6, s6, 3866624
    s_andn2_b32 s6, s6, 127
    v_cmp_eq_u32 vcc, 0, v2
    v_mov_b32 v4, s6
    s_nop 0
    v_cndmask_b32 v3, v3, v4, vcc
    s_lshl_b32 s6, s61, 5
    s_add_u32 s6, s6, s3
    s_lshl_b32 s6, s6, 2
    s_add_u32 s6, s6, 15859712
    s_andn2_b32 s6, s6, 127
    v_cmp_eq_u32 vcc, 1, v2
    v_mov_b32 v4, s6
    s_nop 0
    v_cndmask_b32 v3, v3, v4, vcc
    s_lshl_b32 s6, s5, 5
    s_add_u32 s6, s6, s4
    s_lshl_b32 s6, s6, 5
    s_add_u32 s6, s6, s3
    s_lshl_b32 s6, s6, 2
    s_add_u32 s6, s6, 3899392
    s_andn2_b32 s6, s6, 127
    v_cmp_eq_u32 vcc, 2, v2
    v_mov_b32 v4, s6
    s_nop 0
    v_cndmask_b32 v3, v3, v4, vcc
    s_and_b32 s6, s4, 7
    s_lshl_b32 s7, s5, 3
    s_add_u32 s6, s6, s7
    s_lshr_b32 s7, s4, 3
    s_add_u32 s7, s7, 0
    s_add_u32 s7, s7, 1
    s_and_b32 s7, s7, 3
    s_lshl_b32 s6, s6, 2
    s_add_u32 s6, s6, s7
    s_mul_i32 s6, s6, 3
    s_add_u32 s6, s6, 0
    s_lshl_b32 s6, s6, 5
    s_add_u32 s6, s6, s3
    s_lshl_b32 s6, s6, 2
    s_add_u32 s6, s6, 15728640
    s_andn2_b32 s6, s6, 127
    v_cmp_eq_u32 vcc, 3, v2
    v_mov_b32 v4, s6
    s_nop 0
    v_cndmask_b32 v3, v3, v4, vcc
    s_and_b32 s6, s4, 7
    s_lshl_b32 s7, s5, 3
    s_add_u32 s6, s6, s7
    s_lshr_b32 s7, s4, 3
    s_add_u32 s7, s7, 1
    s_add_u32 s7, s7, 1
    s_and_b32 s7, s7, 3
    s_lshl_b32 s6, s6, 2
    s_add_u32 s6, s6, s7
    s_mul_i32 s6, s6, 3
    s_add_u32 s6, s6, 1
    s_lshl_b32 s6, s6, 5
    s_add_u32 s6, s6, s3
    s_lshl_b32 s6, s6, 2
    s_add_u32 s6, s6, 15728640
    s_andn2_b32 s6, s6, 127
    v_cmp_eq_u32 vcc, 4, v2
    v_mov_b32 v4, s6
    s_nop 0
    v_cndmask_b32 v3, v3, v4, vcc
    s_and_b32 s6, s4, 7
    s_lshl_b32 s7, s5, 3
    s_add_u32 s6, s6, s7
    s_lshr_b32 s7, s4, 3
    s_add_u32 s7, s7, 2
    s_add_u32 s7, s7, 1
    s_and_b32 s7, s7, 3
    s_lshl_b32 s6, s6, 2
    s_add_u32 s6, s6, s7
    s_mul_i32 s6, s6, 3
    s_add_u32 s6, s6, 2
    s_lshl_b32 s6, s6, 5
    s_add_u32 s6, s6, s3
    s_lshl_b32 s6, s6, 2
    s_add_u32 s6, s6, 15728640
    s_andn2_b32 s6, s6, 127
    v_cmp_eq_u32 vcc, 5, v2
    v_mov_b32 v4, s6
    s_nop 0
    v_cndmask_b32 v3, v3, v4, vcc
    s_mov_b32 s6, 0x5000000
    s_cmp_eq_u32 s2, 31
    s_cmov_b32 s6, 3801088
    s_andn2_b32 s6, s6, 127
    v_cmp_eq_u32 vcc, 6, v2
    v_mov_b32 v4, s6
    s_nop 0
    v_cndmask_b32 v3, v3, v4, vcc
    s_lshl_b32 s6, s2, 7
    s_add_u32 s6, s6, 2621440
    s_andn2_b32 s6, s6, 127
    v_cmp_eq_u32 vcc, 7, v2
    v_mov_b32 v4, s6
    s_nop 0
    v_cndmask_b32 v3, v3, v4, vcc
    v_add_u32 v4, 160896, v13
    s_mov_b32 exec_lo, 0
    s_mov_b32 exec_hi, 0x03000000
    ds_read_b128 v[36:39], v4
    s_mov_b64 exec, -1
    s_waitcnt lgkmcnt(0)
L_z7:
    v_and_b32 v2, 7, v1
    v_lshl_add_u32 v3, v2, 4, v3
    buffer_store_dwordx4 v[36:39], v3, s[8:11], 0 offen sc1
L_zd:
    s_cmp_ge_u32 s76, 2
    s_cbranch_scc1 L_tch_2a
    s_and_b32 s6, s4, 3
    s_lshl_b32 s6, s6, 19
    s_lshl_b32 s7, s5, 15
    s_add_u32 s6, s6, s7
    s_lshl_b32 s7, s76, 7
    s_add_u32 s6, s6, s7
    s_add_u32 s6, s6, 768
    v_lshrrev_b32 v6, 1, v1
    v_lshlrev_b32 v6, 10, v6
    v_and_b32 v7, 1, v1
    v_lshl_add_u32 v6, v7, 6, v6
    buffer_load_dword v11, v6, s[12:15], s6 offen
    s_add_u32 s6, s6, 262144
    buffer_load_dword v11, v6, s[12:15], s6 offen
    s_branch L_tch_2c
L_tch_2a:
    v_lshrrev_b32 v6, 5, v1
    v_lshlrev_b32 v6, 6, v6
    v_bfe_u32 v7, v1, 2, 3
    v_add_u32 v6, v6, v7
    v_lshlrev_b32 v6, 13, v6
    v_and_b32 v7, 3, v1
    v_lshl_add_u32 v6, v7, 6, v6
    s_lshl_b32 s6, s4, 8
    s_lshl_b32 s7, s5, 16
    s_add_u32 s6, s6, s7
    s_add_u32 s6, s6, 3145728
    s_cmp_lg_u32 s76, 2
    s_cbranch_scc1 L_tch_2b
    buffer_load_dword v11, v6, s[16:19], s6 offen
    s_branch L_tch_2c
L_tch_2b:
    buffer_load_dword v11, v6, s[20:23], s6 offen
L_tch_2c:
    s_branch L_hook_back
L_hook4:
    s_cmp_lg_u32 s3, 4
    s_cbranch_scc1 L_hook4b
    s_mov_b32 s28, s56
    s_mov_b32 s29, s57
    s_mov_b32 s30, 0x100
    s_mov_b32 s31, 0x20000
    v_mov_b32 v2, 1
    v_lshlrev_b32 v3, 8, v1
    s_and_b32 s6, s2, 31
    s_lshl_b32 s6, s6, 2
    buffer_atomic_add v2, v3, s[28:31], s6 offen offset:0 sc1
L_hook4b:
    s_lshl_b32 s74, s76, 12
    s_add_u32 s74, s74, 131072
    s_mov_b32 m0, s74
    s_add_u32 s74, s74, 16384
    buffer_load_dwordx4 v44, s[24:27], s71 offen offset:0 lds
    buffer_load_dwordx4 v45, s[24:27], s71 offen offset:1024 lds
    buffer_load_dwordx4 v46, s[24:27], s71 offen offset:2048 lds
    buffer_load_dwordx4 v47, s[24:27], s71 offen offset:3072 lds
    s_add_u32 s71, s71, 524288
    s_sub_u32 s75, s71, 5242880
    s_cselect_b32 s71, s71, s75
    s_mov_b32 m0, s74
    s_add_u32 s74, s74, 16384
    buffer_load_dwordx4 v44, s[24:27], s71 offen offset:0 lds
    buffer_load_dwordx4 v45, s[24:27], s71 offen offset:1024 lds
    buffer_load_dwordx4 v46, s[24:27], s71 offen offset:2048 lds
    buffer_load_dwordx4 v47, s[24:27], s71 offen offset:3072 lds
    s_add_u32 s71, s71, 524288
    s_sub_u32 s75, s71, 5242880
    s_cselect_b32 s71, s71, s75
    s_branch L_hook_back
L_hook6:
    s_cmp_lg_u32 s3, 5
    s_cbranch_scc1 L_hook_back
    s_mov_b32 s28, s56
    s_mov_b32 s29, s57
    s_mov_b32 s30, 0x100
    s_mov_b32 s31, 0x20000
    v_and_b32 v3, 31, v1
    v_lshlrev_b32 v3, 2, v3
    buffer_load_dword v62, v3, s[28:31], 0 offen offset:0 sc1
    s_branch L_hook_back
L_vpre:
    s_waitcnt vmcnt(0)
    s_lshl_b32 s6, s65, 4
    s_add_u32 s6, s6, s3
    s_cmp_lg_u32 s6, 0x65
    s_cbranch_scc1 L_vnow
    v_cmp_gt_u32 vcc, 8, v62
    s_cbranch_vccz L_cntok_3
    s_mov_b32 s28, s56
    s_mov_b32 s29, s57
    s_mov_b32 s30, 0x100
    s_mov_b32 s31, 0x20000
    v_and_b32 v3, 31, v1
    v_lshlrev_b32 v3, 2, v3
    s_mov_b32 s79, 262144
L_poll_4:
    buffer_load_dword v2, v3, s[28:31], 0 offen offset:0 sc1
    s_waitcnt vmcnt(0)
    v_cmp_gt_u32 vcc, 8, v2
    s_cbranch_vccz L_polldone_5
    s_sleep 8
    s_sub_u32 s79, s79, 1
    s_cmp_lg_u32 s79, 0
    s_cbranch_scc1 L_poll_4
L_polldone_5:
L_cntok_3:
    s_branch L_vnow
L_khook:
    s_cmp_lg_u32 s65, 7
    s_cbranch_scc1 L_khook_back
    buffer_load_dwordx4 v[16:19], v13, s[8:11], s84 offen offset:0 sc1
    buffer_load_dwordx4 v[20:23], v12, s[8:11], s84 offen offset:0 sc1
    buffer_load_dwordx4 v[24:27], v13, s[8:11], s84 offen offset:1024 sc1
    buffer_load_dwordx4 v[28:31], v12, s[8:11], s84 offen offset:1024 sc1
    buffer_load_dwordx4 v[32:35], v13, s[8:11], s84 offen offset:2048 sc1
    buffer_load_dwordx4 v[36:39], v12, s[8:11], s84 offen offset:2048 sc1
    s_branch L_khook_back
L_kv_v:
    ds_read_b128 v[64:67], v48 offset:0
    ds_read_b128 v[68:71], v48 offset:2048
    ds_read_b64_tr_b16 v[96:97], v50 offset:0
    ds_read_b64_tr_b16 v[98:99], v50 offset:1024
    ds_read_b64_tr_b16 v[100:101], v51 offset:0
    ds_read_b64_tr_b16 v[102:103], v51 offset:1024
    ds_read_b128 v[72:75], v48 offset:4096
    ds_read_b64_tr_b16 v[104:105], v52 offset:0
    ds_read_b64_tr_b16 v[106:107], v52 offset:1024
    ds_read_b64_tr_b16 v[108:109], v53 offset:0
    ds_read_b64_tr_b16 v[110:111], v53 offset:1024
    ds_read_b128 v[76:79], v48 offset:6144
    ds_read_b128 v[80:83], v48 offset:8192
    ds_read_b128 v[84:87], v48 offset:10240
    ds_read_b128 v[88:91], v48 offset:12288
    ds_read_b128 v[92:95], v48 offset:14336
    s_cmp_ge_u32 s76, 2
    s_cbranch_scc1 L_tch_6a
    s_and_b32 s6, s4, 3
    s_lshl_b32 s6, s6, 19
    s_lshl_b32 s7, s5, 15
    s_add_u32 s6, s6, s7
    s_lshl_b32 s7, s76, 7
    s_add_u32 s6, s6, s7
    s_add_u32 s6, s6, 256
    v_lshrrev_b32 v6, 1, v1
    v_lshlrev_b32 v6, 10, v6
    v_and_b32 v7, 1, v1
    v_lshl_add_u32 v6, v7, 6, v6
    buffer_load_dword v11, v6, s[12:15], s6 offen
    s_add_u32 s6, s6, 262144
    buffer_load_dword v11, v6, s[12:15], s6 offen
    s_branch L_tch_6c
L_tch_6a:
    v_lshrrev_b32 v6, 5, v1
    v_lshlrev_b32 v6, 6, v6
    v_bfe_u32 v7, v1, 2, 3
    v_add_u32 v6, v6, v7
    v_lshlrev_b32 v6, 13, v6
    v_and_b32 v7, 3, v1
    v_lshl_add_u32 v6, v7, 6, v6
    s_lshl_b32 s6, s4, 8
    s_lshl_b32 s7, s5, 16
    s_add_u32 s6, s6, s7
    s_add_u32 s6, s6, 1048576
    s_cmp_lg_u32 s76, 2
    s_cbranch_scc1 L_tch_6b
    buffer_load_dword v11, v6, s[16:19], s6 offen
    s_branch L_tch_6c
L_tch_6b:
    buffer_load_dword v11, v6, s[20:23], s6 offen
L_tch_6c:
.p2align 4
L_vloop:
    s_bitcmp1_b32 214, s65
    s_cbranch_scc1 L_hook
L_hook_back:
    s_waitcnt lgkmcnt(12)
    v_mfma_f32_16x16x32_bf16 v[128:131], v[64:67], v[96:99], v[128:131]
    ds_read_b64_tr_b16 v[112:113], v50 offset:8192
    s_waitcnt lgkmcnt(11)
    v_mfma_f32_16x16x32_bf16 v[132:135], v[64:67], v[100:103], v[132:135]
    ds_read_b64_tr_b16 v[114:115], v50 offset:9216
    s_waitcnt lgkmcnt(9)
    v_mfma_f32_16x16x32_bf16 v[136:139], v[64:67], v[104:107], v[136:139]
    ds_read_b64_tr_b16 v[116:117], v51 offset:8192
    s_waitcnt lgkmcnt(8)
    v_mfma_f32_16x16x32_bf16 v[140:143], v[64:67], v[108:111], v[140:143]
    ds_read_b64_tr_b16 v[118:119], v51 offset:9216
    ds_read_b128 v[64:67], v49 offset:0
    v_mfma_f32_16x16x32_bf16 v[156:159], v[68:71], v[108:111], v[156:159]
    ds_read_b64_tr_b16 v[120:121], v52 offset:8192
    v_mfma_f32_16x16x32_bf16 v[152:155], v[68:71], v[104:107], v[152:155]
    ds_read_b64_tr_b16 v[122:123], v52 offset:9216
    v_mfma_f32_16x16x32_bf16 v[148:151], v[68:71], v[100:103], v[148:151]
    ds_read_b64_tr_b16 v[124:125], v53 offset:8192
    v_mfma_f32_16x16x32_bf16 v[144:147], v[68:71], v[96:99], v[144:147]
    ds_read_b64_tr_b16 v[126:127], v53 offset:9216
    ds_read_b128 v[68:71], v49 offset:2048
    v_mfma_f32_16x16x32_bf16 v[160:163], v[72:75], v[96:99], v[160:163]
    v_mfma_f32_16x16x32_bf16 v[164:167], v[72:75], v[100:103], v[164:167]
    v_mfma_f32_16x16x32_bf16 v[168:171], v[72:75], v[104:107], v[168:171]
    v_mfma_f32_16x16x32_bf16 v[172:175], v[72:75], v[108:111], v[172:175]
    ds_read_b128 v[72:75], v49 offset:4096
    s_waitcnt lgkmcnt(15)
    v_mfma_f32_16x16x32_bf16 v[188:191], v[76:79], v[108:111], v[188:191]
    v_mfma_f32_16x16x32_bf16 v[184:187], v[76:79], v[104:107], v[184:187]
    v_mfma_f32_16x16x32_bf16 v[180:183], v[76:79], v[100:103], v[180:183]
    v_mfma_f32_16x16x32_bf16 v[176:179], v[76:79], v[96:99], v[176:179]
    ds_read_b128 v[76:79], v49 offset:6144
    s_waitcnt lgkmcnt(15)
    v_mfma_f32_16x16x32_bf16 v[192:195], v[80:83], v[96:99], v[192:195]
    v_mfma_f32_16x16x32_bf16 v[196:199], v[80:83], v[100:103], v[196:199]
    v_mfma_f32_16x16x32_bf16 v[200:203], v[80:83], v[104:107], v[200:203]
    v_mfma_f32_16x16x32_bf16 v[204:207], v[80:83], v[108:111], v[204:207]
    ds_read_b128 v[80:83], v49 offset:8192
    s_waitcnt lgkmcnt(15)
    v_mfma_f32_16x16x32_bf16 v[220:223], v[84:87], v[108:111], v[220:223]
    v_mfma_f32_16x16x32_bf16 v[216:219], v[84:87], v[104:107], v[216:219]
    v_mfma_f32_16x16x32_bf16 v[212:215], v[84:87], v[100:103], v[212:215]
    v_mfma_f32_16x16x32_bf16 v[208:211], v[84:87], v[96:99], v[208:211]
    ds_read_b128 v[84:87], v49 offset:10240
    s_waitcnt lgkmcnt(15)
    v_mfma_f32_16x16x32_bf16 v[224:227], v[88:91], v[96:99], v[224:227]
    v_mfma_f32_16x16x32_bf16 v[228:231], v[88:91], v[100:103], v[228:231]
    v_mfma_f32_16x16x32_bf16 v[232:235], v[88:91], v[104:107], v[232:235]
    v_mfma_f32_16x16x32_bf16 v[236:239], v[88:91], v[108:111], v[236:239]
    ds_read_b128 v[88:91], v49 offset:12288
    s_waitcnt lgkmcnt(15)
    v_mfma_f32_16x16x32_bf16 v[252:255], v[92:95], v[108:111], v[252:255]
    v_mfma_f32_16x16x32_bf16 v[248:251], v[92:95], v[104:107], v[248:251]
    v_mfma_f32_16x16x32_bf16 v[244:247], v[92:95], v[100:103], v[244:247]
    v_mfma_f32_16x16x32_bf16 v[240:243], v[92:95], v[96:99], v[240:243]
    ds_read_b128 v[92:95], v49 offset:14336
    s_waitcnt lgkmcnt(11)
    v_mfma_f32_16x16x32_bf16 v[128:131], v[64:67], v[112:115], v[128:131]
    v_mfma_f32_16x16x32_bf16 v[132:135], v[64:67], v[116:119], v[132:135]
    s_waitcnt lgkmcnt(9)
    v_mfma_f32_16x16x32_bf16 v[136:139], v[64:67], v[120:123], v[136:139]
    s_waitcnt lgkmcnt(7)
    v_mfma_f32_16x16x32_bf16 v[140:143], v[64:67], v[124:127], v[140:143]
    s_waitcnt lgkmcnt(6)
    v_mfma_f32_16x16x32_bf16 v[156:159], v[68:71], v[124:127], v[156:159]
    v_mfma_f32_16x16x32_bf16 v[152:155], v[68:71], v[120:123], v[152:155]
    v_mfma_f32_16x16x32_bf16 v[148:151], v[68:71], v[116:119], v[148:151]
    v_mfma_f32_16x16x32_bf16 v[144:147], v[68:71], v[112:115], v[144:147]
    v_xor_b32 v48, 0x10000, v48
    v_xor_b32 v49, 0x10000, v49
    v_xor_b32 v50, 0x10000, v50
    v_xor_b32 v51, 0x10000, v51
    v_xor_b32 v52, 0x10000, v52
    v_xor_b32 v53, 0x10000, v53
    s_bitcmp1_b32 0x48, s65
    s_cbranch_scc1 L_vpre
L_vnow:
    s_waitcnt lgkmcnt(0)
    s_barrier
    ds_read_b128 v[64:67], v48 offset:0
    ds_read_b128 v[68:71], v48 offset:2048
    v_mfma_f32_16x16x32_bf16 v[160:163], v[72:75], v[112:115], v[160:163]
    ds_read_b64_tr_b16 v[96:97], v50 offset:0
    v_mfma_f32_16x16x32_bf16 v[164:167], v[72:75], v[116:119], v[164:167]
    ds_read_b64_tr_b16 v[98:99], v50 offset:1024
    v_mfma_f32_16x16x32_bf16 v[168:171], v[72:75], v[120:123], v[168:171]
    ds_read_b64_tr_b16 v[100:101], v51 offset:0
    v_mfma_f32_16x16x32_bf16 v[172:175], v[72:75], v[124:127], v[172:175]
    ds_read_b64_tr_b16 v[102:103], v51 offset:1024
    ds_read_b128 v[72:75], v48 offset:4096
    v_mfma_f32_16x16x32_bf16 v[188:191], v[76:79], v[124:127], v[188:191]
    ds_read_b64_tr_b16 v[104:105], v52 offset:0
    v_mfma_f32_16x16x32_bf16 v[184:187], v[76:79], v[120:123], v[184:187]
    ds_read_b64_tr_b16 v[106:107], v52 offset:1024
    v_mfma_f32_16x16x32_bf16 v[180:183], v[76:79], v[116:119], v[180:183]
    ds_read_b64_tr_b16 v[108:109], v53 offset:0
    v_mfma_f32_16x16x32_bf16 v[176:179], v[76:79], v[112:115], v[176:179]
    ds_read_b64_tr_b16 v[110:111], v53 offset:1024
    ds_read_b128 v[76:79], v48 offset:6144
    v_mfma_f32_16x16x32_bf16 v[192:195], v[80:83], v[112:115], v[192:195]
    v_mfma_f32_16x16x32_bf16 v[196:199], v[80:83], v[116:119], v[196:199]
    v_mfma_f32_16x16x32_bf16 v[200:203], v[80:83], v[120:123], v[200:203]
    v_mfma_f32_16x16x32_bf16 v[204:207], v[80:83], v[124:127], v[204:207]
    ds_read_b128 v[80:83], v48 offset:8192
    v_mfma_f32_16x16x32_bf16 v[220:223], v[84:87], v[124:127], v[220:223]
    v_mfma_f32_16x16x32_bf16 v[216:219], v[84:87], v[120:123], v[216:219]
    v_mfma_f32_16x16x32_bf16 v[212:215], v[84:87], v[116:119], v[212:215]
    v_mfma_f32_16x16x32_bf16 v[208:211], v[84:87], v[112:115], v[208:211]
    ds_read_b128 v[84:87], v48 offset:10240
    v_mfma_f32_16x16x32_bf16 v[224:227], v[88:91], v[112:115], v[224:227]
    v_mfma_f32_16x16x32_bf16 v[228:231], v[88:91], v[116:119], v[228:231]
    v_mfma_f32_16x16x32_bf16 v[232:235], v[88:91], v[120:123], v[232:235]
    v_mfma_f32_16x16x32_bf16 v[236:239], v[88:91], v[124:127], v[236:239]
    ds_read_b128 v[88:91], v48 offset:12288
    v_mfma_f32_16x16x32_bf16 v[252:255], v[92:95], v[124:127], v[252:255]
    v_mfma_f32_16x16x32_bf16 v[248:251], v[92:95], v[120:123], v[248:251]
    v_mfma_f32_16x16x32_bf16 v[244:247], v[92:95], v[116:119], v[244:247]
    v_mfma_f32_16x16x32_bf16 v[240:243], v[92:95], v[112:115], v[240:243]
    ds_read_b128 v[92:95], v48 offset:14336
    s_add_u32 s65, s65, 1
    s_cmp_lt_u32 s65, 8
    s_cbranch_scc1 L_vloop
    s_waitcnt lgkmcnt(0)
    s_nop 7
    v_cvt_pk_bf16_f32 v128, v128, v129
    v_cvt_pk_bf16_f32 v129, v130, v131
    v_cvt_pk_bf16_f32 v130, v144, v145
    v_cvt_pk_bf16_f32 v131, v146, v147
    v_cvt_pk_bf16_f32 v132, v132, v133
    v_cvt_pk_bf16_f32 v133, v134, v135
    v_cvt_pk_bf16_f32 v134, v148, v149
    v_cvt_pk_bf16_f32 v135, v150, v151
    v_cvt_pk_bf16_f32 v136, v136, v137
    v_cvt_pk_bf16_f32 v137, v138, v139
    v_cvt_pk_bf16_f32 v138, v152, v153
    v_cvt_pk_bf16_f32 v139, v154, v155
    v_cvt_pk_bf16_f32 v140, v140, v141
    v_cvt_pk_bf16_f32 v141, v142, v143
    v_cvt_pk_bf16_f32 v142, v156, v157
    v_cvt_pk_bf16_f32 v143, v158, v159
    v_cvt_pk_bf16_f32 v144, v160, v161
    v_cvt_pk_bf16_f32 v145, v162, v163
    v_cvt_pk_bf16_f32 v146, v176, v177
    v_cvt_pk_bf16_f32 v147, v178, v179
    v_cvt_pk_bf16_f32 v148, v164, v165
    v_cvt_pk_bf16_f32 v149, v166, v167
    v_cvt_pk_bf16_f32 v150, v180, v181
    v_cvt_pk_bf16_f32 v151, v182, v183
    v_cvt_pk_bf16_f32 v152, v168, v169
    v_cvt_pk_bf16_f32 v153, v170, v171
    v_cvt_pk_bf16_f32 v154, v184, v185
    v_cvt_pk_bf16_f32 v155, v186, v187
    v_cvt_pk_bf16_f32 v156, v172, v173
    v_cvt_pk_bf16_f32 v157, v174, v175
    v_cvt_pk_bf16_f32 v158, v188, v189
    v_cvt_pk_bf16_f32 v159, v190, v191
    v_cvt_pk_bf16_f32 v160, v192, v193
    v_cvt_pk_bf16_f32 v161, v194, v195
    v_cvt_pk_bf16_f32 v162, v208, v209
    v_cvt_pk_bf16_f32 v163, v210, v211
    v_cvt_pk_bf16_f32 v164, v196, v197
    v_cvt_pk_bf16_f32 v165, v198, v199
    v_cvt_pk_bf16_f32 v166, v212, v213
    v_cvt_pk_bf16_f32 v167, v214, v215
    v_cvt_pk_bf16_f32 v168, v200, v201
    v_cvt_pk_bf16_f32 v169, v202, v203
    v_cvt_pk_bf16_f32 v170, v216, v217
    v_cvt_pk_bf16_f32 v171, v218, v219
    v_cvt_pk_bf16_f32 v172, v204, v205
    v_cvt_pk_bf16_f32 v173, v206, v207
    v_cvt_pk_bf16_f32 v174, v220, v221
    v_cvt_pk_bf16_f32 v175, v222, v223
    v_cvt_pk_bf16_f32 v176, v224, v225
    v_cvt_pk_bf16_f32 v177, v226, v227
    v_cvt_pk_bf16_f32 v178, v240, v241
    v_cvt_pk_bf16_f32 v179, v242, v243
    v_cvt_pk_bf16_f32 v180, v228, v229
    v_cvt_pk_bf16_f32 v181, v230, v231
    v_cvt_pk_bf16_f32 v182, v244, v245
    v_cvt_pk_bf16_f32 v183, v246, v247
    v_cvt_pk_bf16_f32 v184, v232, v233
    v_cvt_pk_bf16_f32 v185, v234, v235
    v_cvt_pk_bf16_f32 v186, v248, v249
    v_cvt_pk_bf16_f32 v187, v250, v251
    v_cvt_pk_bf16_f32 v188, v236, v237
    v_cvt_pk_bf16_f32 v189, v238, v239
    v_cvt_pk_bf16_f32 v190, v252, v253
    v_cvt_pk_bf16_f32 v191, v254, v255
    s_waitcnt vmcnt(0)
L_q:
    s_mov_b32 s28, s56
    s_mov_b32 s29, s57
    s_mov_b32 s30, 0x100
    s_mov_b32 s31, 0x20000
    s_lshl_b32 s6, s76, 13
    v_add_u32 v49, s6, v13
    s_lshl_b32 s6, s76, 12
    v_add_u32 v50, s6, v13
    s_lshl_b32 s77, s4, 20
    s_add_u32 s77, s77, 16777216
    s_mov_b32 s78, s100
    s_sub_u32 s101, s100, 131072
    s_mov_b32 s90, 0
    s_cmp_lt_u32 s3, 4
    s_cselect_b32 s89, 3, 2
    ds_read_b64_tr_b16 v[96:97], v54 offset:0
    ds_read_b64_tr_b16 v[98:99], v54 offset:1024
    ds_read_b64_tr_b16 v[100:101], v55 offset:0
    ds_read_b64_tr_b16 v[102:103], v55 offset:1024
    ds_read_b64_tr_b16 v[104:105], v56 offset:0
    ds_read_b64_tr_b16 v[106:107], v56 offset:1024
    ds_read_b64_tr_b16 v[108:109], v57 offset:0
    ds_read_b64_tr_b16 v[110:111], v57 offset:1024
    ds_read_b64_tr_b16 v[112:113], v58 offset:0
    ds_read_b64_tr_b16 v[114:115], v58 offset:1024
    ds_read_b64_tr_b16 v[116:117], v59 offset:0
    ds_read_b64_tr_b16 v[118:119], v59 offset:1024
    ds_read_b64_tr_b16 v[120:121], v60 offset:0
    ds_read_b64_tr_b16 v[122:123], v60 offset:1024
    ds_read_b64_tr_b16 v[124:125], v61 offset:0
    ds_read_b64_tr_b16 v[126:127], v61 offset:1024
    buffer_load_dwordx4 v[64:67], v13, s[8:11], s84 offen offset:3072 sc1
    buffer_load_dwordx4 v[68:71], v12, s[8:11], s84 offen offset:3072 sc1
    buffer_load_dwordx4 v[72:75], v13, s[8:11], s85 offen offset:0 sc1
    buffer_load_dwordx4 v[76:79], v12, s[8:11], s85 offen offset:0 sc1
    buffer_load_dwordx4 v[80:83], v13, s[8:11], s85 offen offset:1024 sc1
    buffer_load_dwordx4 v[84:87], v12, s[8:11], s85 offen offset:1024 sc1
    buffer_load_dwordx4 v[88:91], v13, s[8:11], s85 offen offset:2048 sc1
    buffer_load_dwordx4 v[92:95], v12, s[8:11], s85 offen offset:2048 sc1
    s_waitcnt lgkmcnt(14)
    v_mfma_f32_16x16x32_bf16 v[192:195], v[96:99], v[16:19], 0
    v_mfma_f32_16x16x32_bf16 v[196:199], v[96:99], v[20:23], 0
    ds_read_b64_tr_b16 v[96:97], v54 offset:8192
    s_waitcnt lgkmcnt(13)
    v_mfma_f32_16x16x32_bf16 v[204:207], v[100:103], v[20:23], 0
    ds_read_b64_tr_b16 v[98:99], v54 offset:9216
    v_mfma_f32_16x16x32_bf16 v[200:203], v[100:103], v[16:19], 0
    ds_read_b64_tr_b16 v[100:101], v55 offset:8192
    s_waitcnt lgkmcnt(13)
    v_mfma_f32_16x16x32_bf16 v[208:211], v[104:107], v[16:19], 0
    ds_read_b64_tr_b16 v[102:103], v55 offset:9216
    v_mfma_f32_16x16x32_bf16 v[212:215], v[104:107], v[20:23], 0
    ds_read_b64_tr_b16 v[104:105], v56 offset:8192
    s_waitcnt lgkmcnt(13)
    v_mfma_f32_16x16x32_bf16 v[220:223], v[108:111], v[20:23], 0
    ds_read_b64_tr_b16 v[106:107], v56 offset:9216
    buffer_store_dwordx4 v[128:131], v13, s[8:11], s67 offen sc1
    s_add_u32 s67, s67, 1024
    v_mfma_f32_16x16x32_bf16 v[216:219], v[108:111], v[16:19], 0
    ds_read_b64_tr_b16 v[108:109], v57 offset:8192
    s_waitcnt lgkmcnt(13)
    v_mfma_f32_16x16x32_bf16 v[224:227], v[112:115], v[16:19], 0
    ds_read_b64_tr_b16 v[110:111], v57 offset:9216
    v_mfma_f32_16x16x32_bf16 v[228:231], v[112:115], v[20:23], 0
    ds_read_b64_tr_b16 v[112:113], v58 offset:8192
    s_waitcnt lgkmcnt(13)
    v_mfma_f32_16x16x32_bf16 v[236:239], v[116:119], v[20:23], 0
    ds_read_b64_tr_b16 v[114:115], v58 offset:9216
    v_mfma_f32_16x16x32_bf16 v[232:235], v[116:119], v[16:19], 0
    ds_read_b64_tr_b16 v[116:117], v59 offset:8192
    s_waitcnt lgkmcnt(13)
    v_mfma_f32_16x16x32_bf16 v[240:243], v[120:123], v[16:19], 0
    ds_read_b64_tr_b16 v[118:119], v59 offset:9216
    v_mfma_f32_16x16x32_bf16 v[244:247], v[120:123], v[20:23], 0
    ds_read_b64_tr_b16 v[120:121], v60 offset:8192
    s_waitcnt lgkmcnt(13)
    v_mfma_f32_16x16x32_bf16 v[252:255], v[124:127], v[20:23], 0
    ds_read_b64_tr_b16 v[122:123], v60 offset:9216
    v_mfma_f32_16x16x32_bf16 v[248:251], v[124:127], v[16:19], 0
    ds_read_b64_tr_b16 v[124:125], v61 offset:8192
    ds_read_b64_tr_b16 v[126:127], v61 offset:9216
    buffer_load_dwordx4 v[16:19], v13, s[8:11], s85 offen offset:3072 sc1
    buffer_load_dwordx4 v[20:23], v12, s[8:11], s85 offen offset:3072 sc1
    s_waitcnt lgkmcnt(14)
    v_mfma_f32_16x16x32_bf16 v[192:195], v[96:99], v[24:27], v[192:195]
    v_mfma_f32_16x16x32_bf16 v[196:199], v[96:99], v[28:31], v[196:199]
    ds_read_b64_tr_b16 v[96:97], v54 offset:16384
    s_waitcnt lgkmcnt(13)
    v_mfma_f32_16x16x32_bf16 v[204:207], v[100:103], v[28:31], v[204:207]
    ds_read_b64_tr_b16 v[98:99], v54 offset:17408
    v_mfma_f32_16x16x32_bf16 v[200:203], v[100:103], v[24:27], v[200:203]
    ds_read_b64_tr_b16 v[100:101], v55 offset:16384
    s_waitcnt lgkmcnt(13)
    v_mfma_f32_16x16x32_bf16 v[208:211], v[104:107], v[24:27], v[208:211]
    ds_read_b64_tr_b16 v[102:103], v55 offset:17408
    v_mfma_f32_16x16x32_bf16 v[212:215], v[104:107], v[28:31], v[212:215]
    ds_read_b64_tr_b16 v[104:105], v56 offset:16384
    s_waitcnt lgkmcnt(13)
    v_mfma_f32_16x16x32_bf16 v[220:223], v[108:111], v[28:31], v[220:223]
    ds_read_b64_tr_b16 v[106:107], v56 offset:17408
    buffer_store_dwordx4 v[132:135], v13, s[8:11], s67 offen sc1
    s_add_u32 s67, s67, s68
    v_mfma_f32_16x16x32_bf16 v[216:219], v[108:111], v[24:27], v[216:219]
    ds_read_b64_tr_b16 v[108:109], v57 offset:16384
    s_waitcnt lgkmcnt(13)
    v_mfma_f32_16x16x32_bf16 v[224:227], v[112:115], v[24:27], v[224:227]
    ds_read_b64_tr_b16 v[110:111], v57 offset:17408
    v_mfma_f32_16x16x32_bf16 v[228:231], v[112:115], v[28:31], v[228:231]
    ds_read_b64_tr_b16 v[112:113], v58 offset:16384
    s_waitcnt lgkmcnt(13)
    v_mfma_f32_16x16x32_bf16 v[236:239], v[116:119], v[28:31], v[236:239]
    ds_read_b64_tr_b16 v[114:115], v58 offset:17408
    v_mfma_f32_16x16x32_bf16 v[232:235], v[116:119], v[24:27], v[232:235]
    ds_read_b64_tr_b16 v[116:117], v59 offset:16384
    s_waitcnt lgkmcnt(13)
    v_mfma_f32_16x16x32_bf16 v[240:243], v[120:123], v[24:27], v[240:243]
    ds_read_b64_tr_b16 v[118:119], v59 offset:17408
    v_mfma_f32_16x16x32_bf16 v[244:247], v[120:123], v[28:31], v[244:247]
    ds_read_b64_tr_b16 v[120:121], v60 offset:16384
    s_waitcnt lgkmcnt(13)
    v_mfma_f32_16x16x32_bf16 v[252:255], v[124:127], v[28:31], v[252:255]
    ds_read_b64_tr_b16 v[122:123], v60 offset:17408
    v_mfma_f32_16x16x32_bf16 v[248:251], v[124:127], v[24:27], v[248:251]
    ds_read_b64_tr_b16 v[124:125], v61 offset:16384
    ds_read_b64_tr_b16 v[126:127], v61 offset:17408
    buffer_load_dwordx4 v[24:27], v13, s[8:11], s86 offen offset:0 sc1
    buffer_load_dwordx4 v[28:31], v12, s[8:11], s86 offen offset:0 sc1
    s_waitcnt lgkmcnt(14)
    v_mfma_f32_16x16x32_bf16 v[192:195], v[96:99], v[32:35], v[192:195]
    v_mfma_f32_16x16x32_bf16 v[196:199], v[96:99], v[36:39], v[196:199]
    ds_read_b64_tr_b16 v[96:97], v54 offset:24576
    s_waitcnt lgkmcnt(13)
    v_mfma_f32_16x16x32_bf16 v[204:207], v[100:103], v[36:39], v[204:207]
    ds_read_b64_tr_b16 v[98:99], v54 offset:25600
    v_mfma_f32_16x16x32_bf16 v[200:203], v[100:103], v[32:35], v[200:203]
    ds_read_b64_tr_b16 v[100:101], v55 offset:24576
    s_waitcnt lgkmcnt(13)
    v_mfma_f32_16x16x32_bf16 v[208:211], v[104:107], v[32:35], v[208:211]
    ds_read_b64_tr_b16 v[102:103], v55 offset:25600
    v_mfma_f32_16x16x32_bf16 v[212:215], v[104:107], v[36:39], v[212:215]
    ds_read_b64_tr_b16 v[104:105], v56 offset:24576
    s_waitcnt lgkmcnt(13)
    v_mfma_f32_16x16x32_bf16 v[220:223], v[108:111], v[36:39], v[220:223]
    ds_read_b64_tr_b16 v[106:107], v56 offset:25600
    buffer_store_dwordx4 v[136:139], v13, s[8:11], s67 offen sc1
    s_add_u32 s67, s67, 1024
    v_mfma_f32_16x16x32_bf16 v[216:219], v[108:111], v[32:35], v[216:219]
    ds_read_b64_tr_b16 v[108:109], v57 offset:24576
    s_waitcnt lgkmcnt(13)
    v_mfma_f32_16x16x32_bf16 v[224:227], v[112:115], v[32:35], v[224:227]
    ds_read_b64_tr_b16 v[110:111], v57 offset:25600
    v_mfma_f32_16x16x32_bf16 v[228:231], v[112:115], v[36:39], v[228:231]
    ds_read_b64_tr_b16 v[112:113], v58 offset:24576
    s_waitcnt lgkmcnt(13)
    v_mfma_f32_16x16x32_bf16 v[236:239], v[116:119], v[36:39], v[236:239]
    ds_read_b64_tr_b16 v[114:115], v58 offset:25600
    v_mfma_f32_16x16x32_bf16 v[232:235], v[116:119], v[32:35], v[232:235]
    ds_read_b64_tr_b16 v[116:117], v59 offset:24576
    s_waitcnt lgkmcnt(13)
    v_mfma_f32_16x16x32_bf16 v[240:243], v[120:123], v[32:35], v[240:243]
    ds_read_b64_tr_b16 v[118:119], v59 offset:25600
    v_mfma_f32_16x16x32_bf16 v[244:247], v[120:123], v[36:39], v[244:247]
    ds_read_b64_tr_b16 v[120:121], v60 offset:24576
    s_waitcnt lgkmcnt(13)
    v_mfma_f32_16x16x32_bf16 v[252:255], v[124:127], v[36:39], v[252:255]
    ds_read_b64_tr_b16 v[122:123], v60 offset:25600
    v_mfma_f32_16x16x32_bf16 v[248:251], v[124:127], v[32:35], v[248:251]
    ds_read_b64_tr_b16 v[124:125], v61 offset:24576
    ds_read_b64_tr_b16 v[126:127], v61 offset:25600
    buffer_load_dwordx4 v[32:35], v13, s[8:11], s86 offen offset:1024 sc1
    buffer_load_dwordx4 v[36:39], v12, s[8:11], s86 offen offset:1024 sc1
    s_waitcnt vmcnt(15)
    s_waitcnt lgkmcnt(14)
    v_mfma_f32_16x16x32_bf16 v[192:195], v[96:99], v[64:67], v[192:195]
    v_add_u32 v54, s101, v54
    v_mfma_f32_16x16x32_bf16 v[196:199], v[96:99], v[68:71], v[196:199]
    ds_read_b64_tr_b16 v[96:97], v54 offset:0
    s_waitcnt lgkmcnt(13)
    v_mfma_f32_16x16x32_bf16 v[204:207], v[100:103], v[68:71], v[204:207]
    ds_read_b64_tr_b16 v[98:99], v54 offset:1024
    v_add_u32 v55, s101, v55
    v_mfma_f32_16x16x32_bf16 v[200:203], v[100:103], v[64:67], v[200:203]
    ds_read_b64_tr_b16 v[100:101], v55 offset:0
    s_waitcnt lgkmcnt(13)
    v_mfma_f32_16x16x32_bf16 v[208:211], v[104:107], v[64:67], v[208:211]
    ds_read_b64_tr_b16 v[102:103], v55 offset:1024
    v_add_u32 v56, s101, v56
    v_mfma_f32_16x16x32_bf16 v[212:215], v[104:107], v[68:71], v[212:215]
    ds_read_b64_tr_b16 v[104:105], v56 offset:0
    s_waitcnt lgkmcnt(13)
    v_mfma_f32_16x16x32_bf16 v[220:223], v[108:111], v[68:71], v[220:223]
    ds_read_b64_tr_b16 v[106:107], v56 offset:1024
    v_add_u32 v57, s101, v57
    buffer_store_dwordx4 v[140:143], v13, s[8:11], s67 offen sc1
    s_add_u32 s67, s67, s69
    v_mfma_f32_16x16x32_bf16 v[216:219], v[108:111], v[64:67], v[216:219]
    ds_read_b64_tr_b16 v[108:109], v57 offset:0
    s_waitcnt lgkmcnt(13)
    v_mfma_f32_16x16x32_bf16 v[224:227], v[112:115], v[64:67], v[224:227]
    ds_read_b64_tr_b16 v[110:111], v57 offset:1024
    v_add_u32 v58, s101, v58
    v_mfma_f32_16x16x32_bf16 v[228:231], v[112:115], v[68:71], v[228:231]
    ds_read_b64_tr_b16 v[112:113], v58 offset:0
    s_waitcnt lgkmcnt(13)
    v_mfma_f32_16x16x32_bf16 v[236:239], v[116:119], v[68:71], v[236:239]
    ds_read_b64_tr_b16 v[114:115], v58 offset:1024
    v_add_u32 v59, s101, v59
    v_mfma_f32_16x16x32_bf16 v[232:235], v[116:119], v[64:67], v[232:235]
    ds_read_b64_tr_b16 v[116:117], v59 offset:0
    s_waitcnt lgkmcnt(13)
    v_mfma_f32_16x16x32_bf16 v[240:243], v[120:123], v[64:67], v[240:243]
    ds_read_b64_tr_b16 v[118:119], v59 offset:1024
    v_add_u32 v60, s101, v60
    v_mfma_f32_16x16x32_bf16 v[244:247], v[120:123], v[68:71], v[244:247]
    ds_read_b64_tr_b16 v[120:121], v60 offset:0
    s_waitcnt lgkmcnt(13)
    v_mfma_f32_16x16x32_bf16 v[252:255], v[124:127], v[68:71], v[252:255]
    ds_read_b64_tr_b16 v[122:123], v60 offset:1024
    v_add_u32 v61, s101, v61
    v_mfma_f32_16x16x32_bf16 v[248:251], v[124:127], v[64:67], v[248:251]
    ds_read_b64_tr_b16 v[124:125], v61 offset:0
    ds_read_b64_tr_b16 v[126:127], v61 offset:1024
    buffer_load_dwordx4 v[64:67], v13, s[8:11], s86 offen offset:2048 sc1
    buffer_load_dwordx4 v[68:71], v12, s[8:11], s86 offen offset:2048 sc1
    s_waitcnt vmcnt(16)
    s_waitcnt lgkmcnt(14)
    v_mfma_f32_16x16x32_bf16 v[192:195], v[96:99], v[72:75], v[192:195]
    v_mfma_f32_16x16x32_bf16 v[196:199], v[96:99], v[76:79], v[196:199]
    ds_read_b64_tr_b16 v[96:97], v54 offset:8192
    s_waitcnt lgkmcnt(13)
    v_mfma_f32_16x16x32_bf16 v[204:207], v[100:103], v[76:79], v[204:207]
    ds_read_b64_tr_b16 v[98:99], v54 offset:9216
    v_mfma_f32_16x16x32_bf16 v[200:203], v[100:103], v[72:75], v[200:203]
    ds_read_b64_tr_b16 v[100:101], v55 offset:8192
    s_waitcnt lgkmcnt(13)
    v_mfma_f32_16x16x32_bf16 v[208:211], v[104:107], v[72:75], v[208:211]
    ds_read_b64_tr_b16 v[102:103], v55 offset:9216
    v_mfma_f32_16x16x32_bf16 v[212:215], v[104:107], v[76:79], v[212:215]
    ds_read_b64_tr_b16 v[104:105], v56 offset:8192
    s_waitcnt lgkmcnt(13)
    v_mfma_f32_16x16x32_bf16 v[220:223], v[108:111], v[76:79], v[220:223]
    ds_read_b64_tr_b16 v[106:107], v56 offset:9216
    v_mfma_f32_16x16x32_bf16 v[216:219], v[108:111], v[72:75], v[216:219]
    ds_read_b64_tr_b16 v[108:109], v57 offset:8192
    s_waitcnt lgkmcnt(13)
    v_mfma_f32_16x16x32_bf16 v[224:227], v[112:115], v[72:75], v[224:227]
    ds_read_b64_tr_b16 v[110:111], v57 offset:9216
    v_mfma_f32_16x16x32_bf16 v[228:231], v[112:115], v[76:79], v[228:231]
    ds_read_b64_tr_b16 v[112:113], v58 offset:8192
    s_waitcnt lgkmcnt(13)
    v_mfma_f32_16x16x32_bf16 v[236:239], v[116:119], v[76:79], v[236:239]
    ds_read_b64_tr_b16 v[114:115], v58 offset:9216
    v_mfma_f32_16x16x32_bf16 v[232:235], v[116:119], v[72:75], v[232:235]
    ds_read_b64_tr_b16 v[116:117], v59 offset:8192
    s_waitcnt lgkmcnt(13)
    v_mfma_f32_16x16x32_bf16 v[240:243], v[120:123], v[72:75], v[240:243]
    ds_read_b64_tr_b16 v[118:119], v59 offset:9216
    v_mfma_f32_16x16x32_bf16 v[244:247], v[120:123], v[76:79], v[244:247]
    ds_read_b64_tr_b16 v[120:121], v60 offset:8192
    s_waitcnt lgkmcnt(13)
    v_mfma_f32_16x16x32_bf16 v[252:255], v[124:127], v[76:79], v[252:255]
    ds_read_b64_tr_b16 v[122:123], v60 offset:9216
    v_mfma_f32_16x16x32_bf16 v[248:251], v[124:127], v[72:75], v[248:251]
    ds_read_b64_tr_b16 v[124:125], v61 offset:8192
    ds_read_b64_tr_b16 v[126:127], v61 offset:9216
    buffer_load_dwordx4 v[72:75], v13, s[8:11], s86 offen offset:3072 sc1
    buffer_load_dwordx4 v[76:79], v12, s[8:11], s86 offen offset:3072 sc1
    s_waitcnt vmcnt(16)
    s_waitcnt lgkmcnt(14)
    v_mfma_f32_16x16x32_bf16 v[192:195], v[96:99], v[80:83], v[192:195]
    v_mfma_f32_16x16x32_bf16 v[196:199], v[96:99], v[84:87], v[196:199]
    ds_read_b64_tr_b16 v[96:97], v54 offset:16384
    s_waitcnt lgkmcnt(13)
    v_mfma_f32_16x16x32_bf16 v[204:207], v[100:103], v[84:87], v[204:207]
    ds_read_b64_tr_b16 v[98:99], v54 offset:17408
    v_mfma_f32_16x16x32_bf16 v[200:203], v[100:103], v[80:83], v[200:203]
    ds_read_b64_tr_b16 v[100:101], v55 offset:16384
    s_waitcnt lgkmcnt(13)
    v_mfma_f32_16x16x32_bf16 v[208:211], v[104:107], v[80:83], v[208:211]
    ds_read_b64_tr_b16 v[102:103], v55 offset:17408
    v_mfma_f32_16x16x32_bf16 v[212:215], v[104:107], v[84:87], v[212:215]
    ds_read_b64_tr_b16 v[104:105], v56 offset:16384
    s_waitcnt lgkmcnt(13)
    v_mfma_f32_16x16x32_bf16 v[220:223], v[108:111], v[84:87], v[220:223]
    ds_read_b64_tr_b16 v[106:107], v56 offset:17408
    v_mfma_f32_16x16x32_bf16 v[216:219], v[108:111], v[80:83], v[216:219]
    ds_read_b64_tr_b16 v[108:109], v57 offset:16384
    s_waitcnt lgkmcnt(13)
    v_mfma_f32_16x16x32_bf16 v[224:227], v[112:115], v[80:83], v[224:227]
    ds_read_b64_tr_b16 v[110:111], v57 offset:17408
    v_mfma_f32_16x16x32_bf16 v[228:231], v[112:115], v[84:87], v[228:231]
    ds_read_b64_tr_b16 v[112:113], v58 offset:16384
    s_waitcnt lgkmcnt(13)
    v_mfma_f32_16x16x32_bf16 v[236:239], v[116:119], v[84:87], v[236:239]
    ds_read_b64_tr_b16 v[114:115], v58 offset:17408
    v_mfma_f32_16x16x32_bf16 v[232:235], v[116:119], v[80:83], v[232:235]
    ds_read_b64_tr_b16 v[116:117], v59 offset:16384
    s_waitcnt lgkmcnt(13)
    v_mfma_f32_16x16x32_bf16 v[240:243], v[120:123], v[80:83], v[240:243]
    ds_read_b64_tr_b16 v[118:119], v59 offset:17408
    v_mfma_f32_16x16x32_bf16 v[244:247], v[120:123], v[84:87], v[244:247]
    ds_read_b64_tr_b16 v[120:121], v60 offset:16384
    s_waitcnt lgkmcnt(13)
    v_mfma_f32_16x16x32_bf16 v[252:255], v[124:127], v[84:87], v[252:255]
    ds_read_b64_tr_b16 v[122:123], v60 offset:17408
    v_mfma_f32_16x16x32_bf16 v[248:251], v[124:127], v[80:83], v[248:251]
    ds_read_b64_tr_b16 v[124:125], v61 offset:16384
    ds_read_b64_tr_b16 v[126:127], v61 offset:17408
    buffer_load_dwordx4 v[80:83], v13, s[8:11], s87 offen offset:0 sc1
    buffer_load_dwordx4 v[84:87], v12, s[8:11], s87 offen offset:0 sc1
    s_waitcnt vmcnt(16)
    s_waitcnt lgkmcnt(14)
    v_mfma_f32_16x16x32_bf16 v[192:195], v[96:99], v[88:91], v[192:195]
    v_mfma_f32_16x16x32_bf16 v[196:199], v[96:99], v[92:95], v[196:199]
    ds_read_b64_tr_b16 v[96:97], v54 offset:24576
    s_waitcnt lgkmcnt(13)
    v_mfma_f32_16x16x32_bf16 v[204:207], v[100:103], v[92:95], v[204:207]
    ds_read_b64_tr_b16 v[98:99], v54 offset:25600
    v_mfma_f32_16x16x32_bf16 v[200:203], v[100:103], v[88:91], v[200:203]
    ds_read_b64_tr_b16 v[100:101], v55 offset:24576
    s_waitcnt lgkmcnt(13)
    v_mfma_f32_16x16x32_bf16 v[208:211], v[104:107], v[88:91], v[208:211]
    ds_read_b64_tr_b16 v[102:103], v55 offset:25600
    v_mfma_f32_16x16x32_bf16 v[212:215], v[104:107], v[92:95], v[212:215]
    ds_read_b64_tr_b16 v[104:105], v56 offset:24576
    s_waitcnt lgkmcnt(13)
    v_mfma_f32_16x16x32_bf16 v[220:223], v[108:111], v[92:95], v[220:223]
    ds_read_b64_tr_b16 v[106:107], v56 offset:25600
    v_mfma_f32_16x16x32_bf16 v[216:219], v[108:111], v[88:91], v[216:219]
    ds_read_b64_tr_b16 v[108:109], v57 offset:24576
    s_waitcnt lgkmcnt(13)
    v_mfma_f32_16x16x32_bf16 v[224:227], v[112:115], v[88:91], v[224:227]
    ds_read_b64_tr_b16 v[110:111], v57 offset:25600
    v_mfma_f32_16x16x32_bf16 v[228:231], v[112:115], v[92:95], v[228:231]
    ds_read_b64_tr_b16 v[112:113], v58 offset:24576
    s_waitcnt lgkmcnt(13)
    v_mfma_f32_16x16x32_bf16 v[236:239], v[116:119], v[92:95], v[236:239]
    ds_read_b64_tr_b16 v[114:115], v58 offset:25600
    v_mfma_f32_16x16x32_bf16 v[232:235], v[116:119], v[88:91], v[232:235]
    ds_read_b64_tr_b16 v[116:117], v59 offset:24576
    s_waitcnt lgkmcnt(13)
    v_mfma_f32_16x16x32_bf16 v[240:243], v[120:123], v[88:91], v[240:243]
    ds_read_b64_tr_b16 v[118:119], v59 offset:25600
    v_mfma_f32_16x16x32_bf16 v[244:247], v[120:123], v[92:95], v[244:247]
    ds_read_b64_tr_b16 v[120:121], v60 offset:24576
    s_waitcnt lgkmcnt(13)
    v_mfma_f32_16x16x32_bf16 v[252:255], v[124:127], v[92:95], v[252:255]
    ds_read_b64_tr_b16 v[122:123], v60 offset:25600
    v_mfma_f32_16x16x32_bf16 v[248:251], v[124:127], v[88:91], v[248:251]
    ds_read_b64_tr_b16 v[124:125], v61 offset:24576
    ds_read_b64_tr_b16 v[126:127], v61 offset:25600
    buffer_load_dwordx4 v[88:91], v13, s[8:11], s87 offen offset:1024 sc1
    buffer_load_dwordx4 v[92:95], v12, s[8:11], s87 offen offset:1024 sc1
    s_waitcnt vmcnt(8)
    s_lshl_b32 s6, s4, 3
    s_add_u32 s6, s6, s5
    s_lshl_b32 s6, s6, 5
    s_add_u32 s6, s6, s3
    s_lshl_b32 s6, s6, 2
    s_add_u32 s6, s6, 3866624
    v_mov_b32 v2, 1
    v_mov_b32 v3, 0x5000000
    v_writelane_b32 v3, s6, 0
    buffer_store_dword v2, v3, s[8:11], 0 offen sc1
    s_waitcnt lgkmcnt(14)
    v_mfma_f32_16x16x32_bf16 v[192:195], v[96:99], v[16:19], v[192:195]
    v_mfma_f32_16x16x32_bf16 v[196:199], v[96:99], v[20:23], v[196:199]
    ds_read_b64_tr_b16 v[96:97], v54 offset:32768
    s_waitcnt lgkmcnt(13)
    v_mfma_f32_16x16x32_bf16 v[204:207], v[100:103], v[20:23], v[204:207]
    ds_read_b64_tr_b16 v[98:99], v54 offset:33792
    v_mfma_f32_16x16x32_bf16 v[200:203], v[100:103], v[16:19], v[200:203]
    ds_read_b64_tr_b16 v[100:101], v55 offset:32768
    s_waitcnt lgkmcnt(13)
    v_mfma_f32_16x16x32_bf16 v[208:211], v[104:107], v[16:19], v[208:211]
    ds_read_b64_tr_b16 v[102:103], v55 offset:33792
    v_mfma_f32_16x16x32_bf16 v[212:215], v[104:107], v[20:23], v[212:215]
    ds_read_b64_tr_b16 v[104:105], v56 offset:32768
    s_waitcnt lgkmcnt(13)
    v_mfma_f32_16x16x32_bf16 v[220:223], v[108:111], v[20:23], v[220:223]
    ds_read_b64_tr_b16 v[106:107], v56 offset:33792
    v_mfma_f32_16x16x32_bf16 v[216:219], v[108:111], v[16:19], v[216:219]
    ds_read_b64_tr_b16 v[108:109], v57 offset:32768
    s_waitcnt lgkmcnt(13)
    v_mfma_f32_16x16x32_bf16 v[224:227], v[112:115], v[16:19], v[224:227]
    ds_read_b64_tr_b16 v[110:111], v57 offset:33792
    v_mfma_f32_16x16x32_bf16 v[228:231], v[112:115], v[20:23], v[228:231]
    ds_read_b64_tr_b16 v[112:113], v58 offset:32768
    s_waitcnt lgkmcnt(13)
    v_mfma_f32_16x16x32_bf16 v[236:239], v[116:119], v[20:23], v[236:239]
    ds_read_b64_tr_b16 v[114:115], v58 offset:33792
    v_mfma_f32_16x16x32_bf16 v[232:235], v[116:119], v[16:19], v[232:235]
    ds_read_b64_tr_b16 v[116:117], v59 offset:32768
    s_waitcnt lgkmcnt(13)
    v_mfma_f32_16x16x32_bf16 v[240:243], v[120:123], v[16:19], v[240:243]
    ds_read_b64_tr_b16 v[118:119], v59 offset:33792
    v_mfma_f32_16x16x32_bf16 v[244:247], v[120:123], v[20:23], v[244:247]
    ds_read_b64_tr_b16 v[120:121], v60 offset:32768
    s_waitcnt lgkmcnt(13)
    v_mfma_f32_16x16x32_bf16 v[252:255], v[124:127], v[20:23], v[252:255]
    ds_read_b64_tr_b16 v[122:123], v60 offset:33792
    v_mfma_f32_16x16x32_bf16 v[248:251], v[124:127], v[16:19], v[248:251]
    ds_read_b64_tr_b16 v[124:125], v61 offset:32768
    ds_read_b64_tr_b16 v[126:127], v61 offset:33792
    buffer_load_dwordx4 v[16:19], v13, s[8:11], s87 offen offset:2048 sc1
    buffer_load_dwordx4 v[20:23], v12, s[8:11], s87 offen offset:2048 sc1
    s_waitcnt lgkmcnt(14)
    v_mfma_f32_16x16x32_bf16 v[192:195], v[96:99], v[24:27], v[192:195]
    v_mfma_f32_16x16x32_bf16 v[196:199], v[96:99], v[28:31], v[196:199]
    ds_read_b64_tr_b16 v[96:97], v54 offset:40960
    s_waitcnt lgkmcnt(13)
    v_mfma_f32_16x16x32_bf16 v[204:207], v[100:103], v[28:31], v[204:207]
    ds_read_b64_tr_b16 v[98:99], v54 offset:41984
    v_mfma_f32_16x16x32_bf16 v[200:203], v[100:103], v[24:27], v[200:203]
    ds_read_b64_tr_b16 v[100:101], v55 offset:40960
    s_waitcnt lgkmcnt(13)
    v_mfma_f32_16x16x32_bf16 v[208:211], v[104:107], v[24:27], v[208:211]
    ds_read_b64_tr_b16 v[102:103], v55 offset:41984
    v_mfma_f32_16x16x32_bf16 v[212:215], v[104:107], v[28:31], v[212:215]
    ds_read_b64_tr_b16 v[104:105], v56 offset:40960
    s_waitcnt lgkmcnt(13)
    v_mfma_f32_16x16x32_bf16 v[220:223], v[108:111], v[28:31], v[220:223]
    ds_read_b64_tr_b16 v[106:107], v56 offset:41984
    v_mfma_f32_16x16x32_bf16 v[216:219], v[108:111], v[24:27], v[216:219]
    ds_read_b64_tr_b16 v[108:109], v57 offset:40960
    s_waitcnt lgkmcnt(13)
    v_mfma_f32_16x16x32_bf16 v[224:227], v[112:115], v[24:27], v[224:227]
    ds_read_b64_tr_b16 v[110:111], v57 offset:41984
    v_mfma_f32_16x16x32_bf16 v[228:231], v[112:115], v[28:31], v[228:231]
    ds_read_b64_tr_b16 v[112:113], v58 offset:40960
    s_waitcnt lgkmcnt(13)
    v_mfma_f32_16x16x32_bf16 v[236:239], v[116:119], v[28:31], v[236:239]
    ds_read_b64_tr_b16 v[114:115], v58 offset:41984
    v_mfma_f32_16x16x32_bf16 v[232:235], v[116:119], v[24:27], v[232:235]
    ds_read_b64_tr_b16 v[116:117], v59 offset:40960
    s_waitcnt lgkmcnt(13)
    v_mfma_f32_16x16x32_bf16 v[240:243], v[120:123], v[24:27], v[240:243]
    ds_read_b64_tr_b16 v[118:119], v59 offset:41984
    v_mfma_f32_16x16x32_bf16 v[244:247], v[120:123], v[28:31], v[244:247]
    ds_read_b64_tr_b16 v[120:121], v60 offset:40960
    s_waitcnt lgkmcnt(13)
    v_mfma_f32_16x16x32_bf16 v[252:255], v[124:127], v[28:31], v[252:255]
    ds_read_b64_tr_b16 v[122:123], v60 offset:41984
    v_mfma_f32_16x16x32_bf16 v[248:251], v[124:127], v[24:27], v[248:251]
    ds_read_b64_tr_b16 v[124:125], v61 offset:40960
    ds_read_b64_tr_b16 v[126:127], v61 offset:41984
    buffer_load_dwordx4 v[24:27], v13, s[8:11], s87 offen offset:3072 sc1
    buffer_load_dwordx4 v[28:31], v12, s[8:11], s87 offen offset:3072 sc1
    s_waitcnt lgkmcnt(14)
    v_mfma_f32_16x16x32_bf16 v[192:195], v[96:99], v[32:35], v[192:195]
    v_mfma_f32_16x16x32_bf16 v[196:199], v[96:99], v[36:39], v[196:199]
    ds_read_b64_tr_b16 v[96:97], v54 offset:49152
    s_waitcnt lgkmcnt(13)
    v_mfma_f32_16x16x32_bf16 v[204:207], v[100:103], v[36:39], v[204:207]
    ds_read_b64_tr_b16 v[98:99], v54 offset:50176
    v_mfma_f32_16x16x32_bf16 v[200:203], v[100:103], v[32:35], v[200:203]
    ds_read_b64_tr_b16 v[100:101], v55 offset:49152
    s_waitcnt lgkmcnt(13)
    v_mfma_f32_16x16x32_bf16 v[208:211], v[104:107], v[32:35], v[208:211]
    ds_read_b64_tr_b16 v[102:103], v55 offset:50176
    v_mfma_f32_16x16x32_bf16 v[212:215], v[104:107], v[36:39], v[212:215]
    ds_read_b64_tr_b16 v[104:105], v56 offset:49152
    s_waitcnt lgkmcnt(13)
    v_mfma_f32_16x16x32_bf16 v[220:223], v[108:111], v[36:39], v[220:223]
    ds_read_b64_tr_b16 v[106:107], v56 offset:50176
    v_mfma_f32_16x16x32_bf16 v[216:219], v[108:111], v[32:35], v[216:219]
    ds_read_b64_tr_b16 v[108:109], v57 offset:49152
    s_waitcnt lgkmcnt(13)
    v_mfma_f32_16x16x32_bf16 v[224:227], v[112:115], v[32:35], v[224:227]
    ds_read_b64_tr_b16 v[110:111], v57 offset:50176
    v_mfma_f32_16x16x32_bf16 v[228:231], v[112:115], v[36:39], v[228:231]
    ds_read_b64_tr_b16 v[112:113], v58 offset:49152
    s_waitcnt lgkmcnt(13)
    v_mfma_f32_16x16x32_bf16 v[236:239], v[116:119], v[36:39], v[236:239]
    ds_read_b64_tr_b16 v[114:115], v58 offset:50176
    v_mfma_f32_16x16x32_bf16 v[232:235], v[116:119], v[32:35], v[232:235]
    ds_read_b64_tr_b16 v[116:117], v59 offset:49152
    s_waitcnt lgkmcnt(13)
    v_mfma_f32_16x16x32_bf16 v[240:243], v[120:123], v[32:35], v[240:243]
    ds_read_b64_tr_b16 v[118:119], v59 offset:50176
    v_mfma_f32_16x16x32_bf16 v[244:247], v[120:123], v[36:39], v[244:247]
    ds_read_b64_tr_b16 v[120:121], v60 offset:49152
    s_waitcnt lgkmcnt(13)
    v_mfma_f32_16x16x32_bf16 v[252:255], v[124:127], v[36:39], v[252:255]
    ds_read_b64_tr_b16 v[122:123], v60 offset:50176
    v_mfma_f32_16x16x32_bf16 v[248:251], v[124:127], v[32:35], v[248:251]
    ds_read_b64_tr_b16 v[124:125], v61 offset:49152
    ds_read_b64_tr_b16 v[126:127], v61 offset:50176
    buffer_load_dwordx4 v[32:35], v13, s[8:11], s88 offen offset:0 sc1
    buffer_load_dwordx4 v[36:39], v12, s[8:11], s88 offen offset:0 sc1
    s_waitcnt vmcnt(13)
    s_waitcnt lgkmcnt(14)
    v_mfma_f32_16x16x32_bf16 v[192:195], v[96:99], v[64:67], v[192:195]
    v_mfma_f32_16x16x32_bf16 v[196:199], v[96:99], v[68:71], v[196:199]
    ds_read_b64_tr_b16 v[96:97], v54 offset:57344
    s_waitcnt lgkmcnt(13)
    v_mfma_f32_16x16x32_bf16 v[204:207], v[100:103], v[68:71], v[204:207]
    ds_read_b64_tr_b16 v[98:99], v54 offset:58368
    v_mfma_f32_16x16x32_bf16 v[200:203], v[100:103], v[64:67], v[200:203]
    ds_read_b64_tr_b16 v[100:101], v55 offset:57344
    s_waitcnt lgkmcnt(13)
    v_mfma_f32_16x16x32_bf16 v[208:211], v[104:107], v[64:67], v[208:211]
    ds_read_b64_tr_b16 v[102:103], v55 offset:58368
    v_mfma_f32_16x16x32_bf16 v[212:215], v[104:107], v[68:71], v[212:215]
    ds_read_b64_tr_b16 v[104:105], v56 offset:57344
    s_waitcnt lgkmcnt(13)
    v_mfma_f32_16x16x32_bf16 v[220:223], v[108:111], v[68:71], v[220:223]
    ds_read_b64_tr_b16 v[106:107], v56 offset:58368
    v_mfma_f32_16x16x32_bf16 v[216:219], v[108:111], v[64:67], v[216:219]
    ds_read_b64_tr_b16 v[108:109], v57 offset:57344
    s_waitcnt lgkmcnt(13)
    v_mfma_f32_16x16x32_bf16 v[224:227], v[112:115], v[64:67], v[224:227]
    ds_read_b64_tr_b16 v[110:111], v57 offset:58368
    v_mfma_f32_16x16x32_bf16 v[228:231], v[112:115], v[68:71], v[228:231]
    ds_read_b64_tr_b16 v[112:113], v58 offset:57344
    s_waitcnt lgkmcnt(13)
    v_mfma_f32_16x16x32_bf16 v[236:239], v[116:119], v[68:71], v[236:239]
    ds_read_b64_tr_b16 v[114:115], v58 offset:58368
    v_mfma_f32_16x16x32_bf16 v[232:235], v[116:119], v[64:67], v[232:235]
    ds_read_b64_tr_b16 v[116:117], v59 offset:57344
    s_waitcnt lgkmcnt(13)
    v_mfma_f32_16x16x32_bf16 v[240:243], v[120:123], v[64:67], v[240:243]
    ds_read_b64_tr_b16 v[118:119], v59 offset:58368
    v_mfma_f32_16x16x32_bf16 v[244:247], v[120:123], v[68:71], v[244:247]
    ds_read_b64_tr_b16 v[120:121], v60 offset:57344
    s_waitcnt lgkmcnt(13)
    v_mfma_f32_16x16x32_bf16 v[252:255], v[124:127], v[68:71], v[252:255]
    ds_read_b64_tr_b16 v[122:123], v60 offset:58368
    v_mfma_f32_16x16x32_bf16 v[248:251], v[124:127], v[64:67], v[248:251]
    ds_read_b64_tr_b16 v[124:125], v61 offset:57344
    ds_read_b64_tr_b16 v[126:127], v61 offset:58368
    buffer_load_dwordx4 v[64:67], v13, s[8:11], s88 offen offset:1024 sc1
    buffer_load_dwordx4 v[68:71], v12, s[8:11], s88 offen offset:1024 sc1
    s_waitcnt vmcnt(13)
    s_waitcnt lgkmcnt(14)
    v_mfma_f32_16x16x32_bf16 v[192:195], v[96:99], v[72:75], v[192:195]
    v_xor_b32 v54, 0x10000, v54
    v_mfma_f32_16x16x32_bf16 v[196:199], v[96:99], v[76:79], v[196:199]
    s_waitcnt lgkmcnt(12)
    v_mfma_f32_16x16x32_bf16 v[204:207], v[100:103], v[76:79], v[204:207]
    v_xor_b32 v55, 0x10000, v55
    v_mfma_f32_16x16x32_bf16 v[200:203], v[100:103], v[72:75], v[200:203]
    s_waitcnt lgkmcnt(0)
    s_barrier
    ds_read_b64_tr_b16 v[96:97], v54 offset:0
    ds_read_b64_tr_b16 v[98:99], v54 offset:1024
    ds_read_b64_tr_b16 v[100:101], v55 offset:0
    v_mfma_f32_16x16x32_bf16 v[208:211], v[104:107], v[72:75], v[208:211]
    ds_read_b64_tr_b16 v[102:103], v55 offset:1024
    v_xor_b32 v56, 0x10000, v56
    v_mfma_f32_16x16x32_bf16 v[212:215], v[104:107], v[76:79], v[212:215]
    ds_read_b64_tr_b16 v[104:105], v56 offset:0
    v_mfma_f32_16x16x32_bf16 v[220:223], v[108:111], v[76:79], v[220:223]
    ds_read_b64_tr_b16 v[106:107], v56 offset:1024
    v_xor_b32 v57, 0x10000, v57
    v_mfma_f32_16x16x32_bf16 v[216:219], v[108:111], v[72:75], v[216:219]
    ds_read_b64_tr_b16 v[108:109], v57 offset:0
    v_mfma_f32_16x16x32_bf16 v[224:227], v[112:115], v[72:75], v[224:227]
    ds_read_b64_tr_b16 v[110:111], v57 offset:1024
    v_xor_b32 v58, 0x10000, v58
    v_mfma_f32_16x16x32_bf16 v[228:231], v[112:115], v[76:79], v[228:231]
    ds_read_b64_tr_b16 v[112:113], v58 offset:0
    v_mfma_f32_16x16x32_bf16 v[236:239], v[116:119], v[76:79], v[236:239]
    ds_read_b64_tr_b16 v[114:115], v58 offset:1024
    v_xor_b32 v59, 0x10000, v59
    v_mfma_f32_16x16x32_bf16 v[232:235], v[116:119], v[72:75], v[232:235]
    ds_read_b64_tr_b16 v[116:117], v59 offset:0
    v_mfma_f32_16x16x32_bf16 v[240:243], v[120:123], v[72:75], v[240:243]
    ds_read_b64_tr_b16 v[118:119], v59 offset:1024
    v_xor_b32 v60, 0x10000, v60
    v_mfma_f32_16x16x32_bf16 v[244:247], v[120:123], v[76:79], v[244:247]
    ds_read_b64_tr_b16 v[120:121], v60 offset:0
    v_mfma_f32_16x16x32_bf16 v[252:255], v[124:127], v[76:79], v[252:255]
    ds_read_b64_tr_b16 v[122:123], v60 offset:1024
    v_xor_b32 v61, 0x10000, v61
    v_mfma_f32_16x16x32_bf16 v[248:251], v[124:127], v[72:75], v[248:251]
    ds_read_b64_tr_b16 v[124:125], v61 offset:0
    ds_read_b64_tr_b16 v[126:127], v61 offset:1024
    buffer_load_dwordx4 v[72:75], v13, s[8:11], s88 offen offset:2048 sc1
    buffer_load_dwordx4 v[76:79], v12, s[8:11], s88 offen offset:2048 sc1
    s_waitcnt vmcnt(13)
    s_waitcnt lgkmcnt(14)
    v_mfma_f32_16x16x32_bf16 v[192:195], v[96:99], v[80:83], v[192:195]
    v_mfma_f32_16x16x32_bf16 v[196:199], v[96:99], v[84:87], v[196:199]
    ds_read_b64_tr_b16 v[96:97], v54 offset:8192
    s_waitcnt lgkmcnt(13)
    v_mfma_f32_16x16x32_bf16 v[204:207], v[100:103], v[84:87], v[204:207]
    ds_read_b64_tr_b16 v[98:99], v54 offset:9216
    v_mfma_f32_16x16x32_bf16 v[200:203], v[100:103], v[80:83], v[200:203]
    ds_read_b64_tr_b16 v[100:101], v55 offset:8192
    s_waitcnt lgkmcnt(13)
    v_mfma_f32_16x16x32_bf16 v[208:211], v[104:107], v[80:83], v[208:211]
    ds_read_b64_tr_b16 v[102:103], v55 offset:9216
    v_mfma_f32_16x16x32_bf16 v[212:215], v[104:107], v[84:87], v[212:215]
    ds_read_b64_tr_b16 v[104:105], v56 offset:8192
    s_waitcnt lgkmcnt(13)
    v_mfma_f32_16x16x32_bf16 v[220:223], v[108:111], v[84:87], v[220:223]
    ds_read_b64_tr_b16 v[106:107], v56 offset:9216
    v_mfma_f32_16x16x32_bf16 v[216:219], v[108:111], v[80:83], v[216:219]
    ds_read_b64_tr_b16 v[108:109], v57 offset:8192
    s_waitcnt lgkmcnt(13)
    v_mfma_f32_16x16x32_bf16 v[224:227], v[112:115], v[80:83], v[224:227]
    ds_read_b64_tr_b16 v[110:111], v57 offset:9216
    v_mfma_f32_16x16x32_bf16 v[228:231], v[112:115], v[84:87], v[228:231]
    ds_read_b64_tr_b16 v[112:113], v58 offset:8192
    s_waitcnt lgkmcnt(13)
    v_mfma_f32_16x16x32_bf16 v[236:239], v[116:119], v[84:87], v[236:239]
    ds_read_b64_tr_b16 v[114:115], v58 offset:9216
    v_mfma_f32_16x16x32_bf16 v[232:235], v[116:119], v[80:83], v[232:235]
    ds_read_b64_tr_b16 v[116:117], v59 offset:8192
    s_waitcnt lgkmcnt(13)
    v_mfma_f32_16x16x32_bf16 v[240:243], v[120:123], v[80:83], v[240:243]
    ds_read_b64_tr_b16 v[118:119], v59 offset:9216
    v_mfma_f32_16x16x32_bf16 v[244:247], v[120:123], v[84:87], v[244:247]
    ds_read_b64_tr_b16 v[120:121], v60 offset:8192
    s_waitcnt lgkmcnt(13)
    v_mfma_f32_16x16x32_bf16 v[252:255], v[124:127], v[84:87], v[252:255]
    ds_read_b64_tr_b16 v[122:123], v60 offset:9216
    v_mfma_f32_16x16x32_bf16 v[248:251], v[124:127], v[80:83], v[248:251]
    ds_read_b64_tr_b16 v[124:125], v61 offset:8192
    ds_read_b64_tr_b16 v[126:127], v61 offset:9216
    buffer_load_dwordx4 v[80:83], v13, s[8:11], s88 offen offset:3072 sc1
    buffer_load_dwordx4 v[84:87], v12, s[8:11], s88 offen offset:3072 sc1
    s_waitcnt vmcnt(13)
    s_waitcnt lgkmcnt(14)
    v_mfma_f32_16x16x32_bf16 v[192:195], v[96:99], v[88:91], v[192:195]
    v_mfma_f32_16x16x32_bf16 v[196:199], v[96:99], v[92:95], v[196:199]
    ds_read_b64_tr_b16 v[96:97], v54 offset:16384
    s_waitcnt lgkmcnt(13)
    v_mfma_f32_16x16x32_bf16 v[204:207], v[100:103], v[92:95], v[204:207]
    ds_read_b64_tr_b16 v[98:99], v54 offset:17408
    v_mfma_f32_16x16x32_bf16 v[200:203], v[100:103], v[88:91], v[200:203]
    ds_read_b64_tr_b16 v[100:101], v55 offset:16384
    s_waitcnt lgkmcnt(13)
    v_mfma_f32_16x16x32_bf16 v[208:211], v[104:107], v[88:91], v[208:211]
    ds_read_b64_tr_b16 v[102:103], v55 offset:17408
    v_mfma_f32_16x16x32_bf16 v[212:215], v[104:107], v[92:95], v[212:215]
    ds_read_b64_tr_b16 v[104:105], v56 offset:16384
    s_waitcnt lgkmcnt(13)
    v_mfma_f32_16x16x32_bf16 v[220:223], v[108:111], v[92:95], v[220:223]
    ds_read_b64_tr_b16 v[106:107], v56 offset:17408
    v_mfma_f32_16x16x32_bf16 v[216:219], v[108:111], v[88:91], v[216:219]
    ds_read_b64_tr_b16 v[108:109], v57 offset:16384
    s_waitcnt lgkmcnt(13)
    v_mfma_f32_16x16x32_bf16 v[224:227], v[112:115], v[88:91], v[224:227]
    ds_read_b64_tr_b16 v[110:111], v57 offset:17408
    v_mfma_f32_16x16x32_bf16 v[228:231], v[112:115], v[92:95], v[228:231]
    ds_read_b64_tr_b16 v[112:113], v58 offset:16384
    s_waitcnt lgkmcnt(13)
    v_mfma_f32_16x16x32_bf16 v[236:239], v[116:119], v[92:95], v[236:239]
    ds_read_b64_tr_b16 v[114:115], v58 offset:17408
    v_mfma_f32_16x16x32_bf16 v[232:235], v[116:119], v[88:91], v[232:235]
    ds_read_b64_tr_b16 v[116:117], v59 offset:16384
    s_waitcnt lgkmcnt(13)
    v_mfma_f32_16x16x32_bf16 v[240:243], v[120:123], v[88:91], v[240:243]
    ds_read_b64_tr_b16 v[118:119], v59 offset:17408
    v_mfma_f32_16x16x32_bf16 v[244:247], v[120:123], v[92:95], v[244:247]
    ds_read_b64_tr_b16 v[120:121], v60 offset:16384
    s_waitcnt lgkmcnt(13)
    v_mfma_f32_16x16x32_bf16 v[252:255], v[124:127], v[92:95], v[252:255]
    ds_read_b64_tr_b16 v[122:123], v60 offset:17408
    v_mfma_f32_16x16x32_bf16 v[248:251], v[124:127], v[88:91], v[248:251]
    ds_read_b64_tr_b16 v[124:125], v61 offset:16384
    ds_read_b64_tr_b16 v[126:127], v61 offset:17408
    s_waitcnt vmcnt(10)
    s_waitcnt lgkmcnt(14)
    v_mfma_f32_16x16x32_bf16 v[192:195], v[96:99], v[16:19], v[192:195]
    v_mfma_f32_16x16x32_bf16 v[196:199], v[96:99], v[20:23], v[196:199]
    ds_read_b64_tr_b16 v[96:97], v54 offset:24576
    s_waitcnt lgkmcnt(13)
    v_mfma_f32_16x16x32_bf16 v[204:207], v[100:103], v[20:23], v[204:207]
    ds_read_b64_tr_b16 v[98:99], v54 offset:25600
    v_mfma_f32_16x16x32_bf16 v[200:203], v[100:103], v[16:19], v[200:203]
    ds_read_b64_tr_b16 v[100:101], v55 offset:24576
    s_waitcnt lgkmcnt(13)
    v_mfma_f32_16x16x32_bf16 v[208:211], v[104:107], v[16:19], v[208:211]
    ds_read_b64_tr_b16 v[102:103], v55 offset:25600
    v_mfma_f32_16x16x32_bf16 v[212:215], v[104:107], v[20:23], v[212:215]
    ds_read_b64_tr_b16 v[104:105], v56 offset:24576
    s_waitcnt lgkmcnt(13)
    v_mfma_f32_16x16x32_bf16 v[220:223], v[108:111], v[20:23], v[220:223]
    ds_read_b64_tr_b16 v[106:107], v56 offset:25600
    v_mfma_f32_16x16x32_bf16 v[216:219], v[108:111], v[16:19], v[216:219]
    ds_read_b64_tr_b16 v[108:109], v57 offset:24576
    s_waitcnt lgkmcnt(13)
    v_mfma_f32_16x16x32_bf16 v[224:227], v[112:115], v[16:19], v[224:227]
    ds_read_b64_tr_b16 v[110:111], v57 offset:25600
    v_mfma_f32_16x16x32_bf16 v[228:231], v[112:115], v[20:23], v[228:231]
    ds_read_b64_tr_b16 v[112:113], v58 offset:24576
    s_waitcnt lgkmcnt(13)
    v_mfma_f32_16x16x32_bf16 v[236:239], v[116:119], v[20:23], v[236:239]
    ds_read_b64_tr_b16 v[114:115], v58 offset:25600
    v_mfma_f32_16x16x32_bf16 v[232:235], v[116:119], v[16:19], v[232:235]
    ds_read_b64_tr_b16 v[116:117], v59 offset:24576
    s_waitcnt lgkmcnt(13)
    v_mfma_f32_16x16x32_bf16 v[240:243], v[120:123], v[16:19], v[240:243]
    ds_read_b64_tr_b16 v[118:119], v59 offset:25600
    v_mfma_f32_16x16x32_bf16 v[244:247], v[120:123], v[20:23], v[244:247]
    ds_read_b64_tr_b16 v[120:121], v60 offset:24576
    s_waitcnt lgkmcnt(13)
    v_mfma_f32_16x16x32_bf16 v[252:255], v[124:127], v[20:23], v[252:255]
    ds_read_b64_tr_b16 v[122:123], v60 offset:25600
    v_mfma_f32_16x16x32_bf16 v[248:251], v[124:127], v[16:19], v[248:251]
    ds_read_b64_tr_b16 v[124:125], v61 offset:24576
    ds_read_b64_tr_b16 v[126:127], v61 offset:25600
    s_waitcnt vmcnt(8)
    s_waitcnt lgkmcnt(14)
    v_mfma_f32_16x16x32_bf16 v[192:195], v[96:99], v[24:27], v[192:195]
    v_mfma_f32_16x16x32_bf16 v[196:199], v[96:99], v[28:31], v[196:199]
    ds_read_b64_tr_b16 v[96:97], v54 offset:32768
    s_waitcnt lgkmcnt(13)
    v_mfma_f32_16x16x32_bf16 v[204:207], v[100:103], v[28:31], v[204:207]
    ds_read_b64_tr_b16 v[98:99], v54 offset:33792
    v_mfma_f32_16x16x32_bf16 v[200:203], v[100:103], v[24:27], v[200:203]
    ds_read_b64_tr_b16 v[100:101], v55 offset:32768
    s_waitcnt lgkmcnt(13)
    v_mfma_f32_16x16x32_bf16 v[208:211], v[104:107], v[24:27], v[208:211]
    ds_read_b64_tr_b16 v[102:103], v55 offset:33792
    v_mfma_f32_16x16x32_bf16 v[212:215], v[104:107], v[28:31], v[212:215]
    ds_read_b64_tr_b16 v[104:105], v56 offset:32768
    s_waitcnt lgkmcnt(13)
    v_mfma_f32_16x16x32_bf16 v[220:223], v[108:111], v[28:31], v[220:223]
    ds_read_b64_tr_b16 v[106:107], v56 offset:33792
    v_mfma_f32_16x16x32_bf16 v[216:219], v[108:111], v[24:27], v[216:219]
    ds_read_b64_tr_b16 v[108:109], v57 offset:32768
    s_waitcnt lgkmcnt(13)
    v_mfma_f32_16x16x32_bf16 v[224:227], v[112:115], v[24:27], v[224:227]
    ds_read_b64_tr_b16 v[110:111], v57 offset:33792
    v_mfma_f32_16x16x32_bf16 v[228:231], v[112:115], v[28:31], v[228:231]
    ds_read_b64_tr_b16 v[112:113], v58 offset:32768
    s_waitcnt lgkmcnt(13)
    v_mfma_f32_16x16x32_bf16 v[236:239], v[116:119], v[28:31], v[236:239]
    ds_read_b64_tr_b16 v[114:115], v58 offset:33792
    v_mfma_f32_16x16x32_bf16 v[232:235], v[116:119], v[24:27], v[232:235]
    ds_read_b64_tr_b16 v[116:117], v59 offset:32768
    s_waitcnt lgkmcnt(13)
    v_mfma_f32_16x16x32_bf16 v[240:243], v[120:123], v[24:27], v[240:243]
    ds_read_b64_tr_b16 v[118:119], v59 offset:33792
    v_mfma_f32_16x16x32_bf16 v[244:247], v[120:123], v[28:31], v[244:247]
    ds_read_b64_tr_b16 v[120:121], v60 offset:32768
    s_waitcnt lgkmcnt(13)
    v_mfma_f32_16x16x32_bf16 v[252:255], v[124:127], v[28:31], v[252:255]
    ds_read_b64_tr_b16 v[122:123], v60 offset:33792
    v_mfma_f32_16x16x32_bf16 v[248:251], v[124:127], v[24:27], v[248:251]
    ds_read_b64_tr_b16 v[124:125], v61 offset:32768
    ds_read_b64_tr_b16 v[126:127], v61 offset:33792
    s_waitcnt vmcnt(0)
    s_cmp_ge_u32 s3, 4
    s_cbranch_scc1 L_q_nold
    s_lshl_b32 s7, s4, 10
    s_add_u32 s7, s7, 3866624
    v_lshrrev_b32 v2, 3, v1
    v_and_b32 v3, 7, v1
    v_lshlrev_b32 v3, 2, v3
    v_lshl_add_u32 v3, v2, 7, v3
    s_mov_b32 s79, 262144
L_poll_7:
    buffer_load_dword v2, v3, s[8:11], s7 offen sc1
    s_waitcnt vmcnt(0)
    v_cmp_gt_u32 vcc, 1, v2
    s_cbranch_vccz L_polldone_8
    s_sleep 2
    s_sub_u32 s79, s79, 1
    s_cmp_lg_u32 s79, 0
    s_cbranch_scc1 L_poll_7
L_polldone_8:
    s_lshl_b32 s6, s76, 13
    s_add_u32 s6, s6, s78
    s_add_u32 m0, s6, 0
    s_add_u32 s7, s77, 0
    buffer_load_dwordx4 v49, s[8:11], s7 offen offset:0 sc1 lds
    buffer_load_dwordx4 v49, s[8:11], s7 offen offset:1024 sc1 lds
    buffer_load_dwordx4 v49, s[8:11], s7 offen offset:2048 sc1 lds
    buffer_load_dwordx4 v49, s[8:11], s7 offen offset:3072 sc1 lds
    s_lshl_b32 s6, s76, 13
    s_add_u32 s6, s6, s78
    s_add_u32 m0, s6, 4096
    s_add_u32 s7, s77, 4096
    buffer_load_dwordx4 v49, s[8:11], s7 offen offset:0 sc1 lds
    buffer_load_dwordx4 v49, s[8:11], s7 offen offset:1024 sc1 lds
    buffer_load_dwordx4 v49, s[8:11], s7 offen offset:2048 sc1 lds
    buffer_load_dwordx4 v49, s[8:11], s7 offen offset:3072 sc1 lds
    s_lshl_b32 s6, s76, 12
    s_add_u32 s6, s6, s78
    s_add_u32 m0, s6, 49152
    s_add_u32 s7, s77, 524288
    buffer_load_dwordx4 v50, s[8:11], s7 offen offset:0 sc1 lds
    buffer_load_dwordx4 v50, s[8:11], s7 offen offset:1024 sc1 lds
    buffer_load_dwordx4 v50, s[8:11], s7 offen offset:2048 sc1 lds
    buffer_load_dwordx4 v50, s[8:11], s7 offen offset:3072 sc1 lds
L_q_nold:
    s_waitcnt lgkmcnt(14)
    v_mfma_f32_16x16x32_bf16 v[192:195], v[96:99], v[32:35], v[192:195]
    v_mfma_f32_16x16x32_bf16 v[196:199], v[96:99], v[36:39], v[196:199]
    ds_read_b64_tr_b16 v[96:97], v54 offset:40960
    s_waitcnt lgkmcnt(13)
    v_mfma_f32_16x16x32_bf16 v[204:207], v[100:103], v[36:39], v[204:207]
    ds_read_b64_tr_b16 v[98:99], v54 offset:41984
    v_mfma_f32_16x16x32_bf16 v[200:203], v[100:103], v[32:35], v[200:203]
    ds_read_b64_tr_b16 v[100:101], v55 offset:40960
    s_waitcnt lgkmcnt(13)
    v_mfma_f32_16x16x32_bf16 v[208:211], v[104:107], v[32:35], v[208:211]
    ds_read_b64_tr_b16 v[102:103], v55 offset:41984
    v_mfma_f32_16x16x32_bf16 v[212:215], v[104:107], v[36:39], v[212:215]
    ds_read_b64_tr_b16 v[104:105], v56 offset:40960
    s_waitcnt lgkmcnt(13)
    v_mfma_f32_16x16x32_bf16 v[220:223], v[108:111], v[36:39], v[220:223]
    ds_read_b64_tr_b16 v[106:107], v56 offset:41984
    buffer_store_dwordx4 v[144:147], v13, s[8:11], s67 offen sc1
    s_add_u32 s67, s67, 1024
    v_mfma_f32_16x16x32_bf16 v[216:219], v[108:111], v[32:35], v[216:219]
    ds_read_b64_tr_b16 v[108:109], v57 offset:40960
    s_waitcnt lgkmcnt(13)
    v_mfma_f32_16x16x32_bf16 v[224:227], v[112:115], v[32:35], v[224:227]
    ds_read_b64_tr_b16 v[110:111], v57 offset:41984
    v_mfma_f32_16x16x32_bf16 v[228:231], v[112:115], v[36:39], v[228:231]
    ds_read_b64_tr_b16 v[112:113], v58 offset:40960
    s_waitcnt lgkmcnt(13)
    v_mfma_f32_16x16x32_bf16 v[236:239], v[116:119], v[36:39], v[236:239]
    ds_read_b64_tr_b16 v[114:115], v58 offset:41984
    v_mfma_f32_16x16x32_bf16 v[232:235], v[116:119], v[32:35], v[232:235]
    ds_read_b64_tr_b16 v[116:117], v59 offset:40960
    s_waitcnt lgkmcnt(13)
    v_mfma_f32_16x16x32_bf16 v[240:243], v[120:123], v[32:35], v[240:243]
    ds_read_b64_tr_b16 v[118:119], v59 offset:41984
    v_mfma_f32_16x16x32_bf16 v[244:247], v[120:123], v[36:39], v[244:247]
    ds_read_b64_tr_b16 v[120:121], v60 offset:40960
    s_waitcnt lgkmcnt(13)
    v_mfma_f32_16x16x32_bf16 v[252:255], v[124:127], v[36:39], v[252:255]
    ds_read_b64_tr_b16 v[122:123], v60 offset:41984
    v_mfma_f32_16x16x32_bf16 v[248:251], v[124:127], v[32:35], v[248:251]
    ds_read_b64_tr_b16 v[124:125], v61 offset:40960
    ds_read_b64_tr_b16 v[126:127], v61 offset:41984
    s_waitcnt lgkmcnt(14)
    v_mfma_f32_16x16x32_bf16 v[192:195], v[96:99], v[64:67], v[192:195]
    v_mfma_f32_16x16x32_bf16 v[196:199], v[96:99], v[68:71], v[196:199]
    ds_read_b64_tr_b16 v[96:97], v54 offset:49152
    s_waitcnt lgkmcnt(13)
    v_mfma_f32_16x16x32_bf16 v[204:207], v[100:103], v[68:71], v[204:207]
    ds_read_b64_tr_b16 v[98:99], v54 offset:50176
    v_mfma_f32_16x16x32_bf16 v[200:203], v[100:103], v[64:67], v[200:203]
    ds_read_b64_tr_b16 v[100:101], v55 offset:49152
    s_waitcnt lgkmcnt(13)
    v_mfma_f32_16x16x32_bf16 v[208:211], v[104:107], v[64:67], v[208:211]
    ds_read_b64_tr_b16 v[102:103], v55 offset:50176
    v_mfma_f32_16x16x32_bf16 v[212:215], v[104:107], v[68:71], v[212:215]
    ds_read_b64_tr_b16 v[104:105], v56 offset:49152
    s_waitcnt lgkmcnt(13)
    v_mfma_f32_16x16x32_bf16 v[220:223], v[108:111], v[68:71], v[220:223]
    ds_read_b64_tr_b16 v[106:107], v56 offset:50176
    buffer_store_dwordx4 v[148:151], v13, s[8:11], s67 offen sc1
    s_add_u32 s67, s67, s68
    v_mfma_f32_16x16x32_bf16 v[216:219], v[108:111], v[64:67], v[216:219]
    ds_read_b64_tr_b16 v[108:109], v57 offset:49152
    s_waitcnt lgkmcnt(13)
    v_mfma_f32_16x16x32_bf16 v[224:227], v[112:115], v[64:67], v[224:227]
    ds_read_b64_tr_b16 v[110:111], v57 offset:50176
    v_mfma_f32_16x16x32_bf16 v[228:231], v[112:115], v[68:71], v[228:231]
    ds_read_b64_tr_b16 v[112:113], v58 offset:49152
    s_waitcnt lgkmcnt(13)
    v_mfma_f32_16x16x32_bf16 v[236:239], v[116:119], v[68:71], v[236:239]
    ds_read_b64_tr_b16 v[114:115], v58 offset:50176
    v_mfma_f32_16x16x32_bf16 v[232:235], v[116:119], v[64:67], v[232:235]
    ds_read_b64_tr_b16 v[116:117], v59 offset:49152
    s_waitcnt lgkmcnt(13)
    v_mfma_f32_16x16x32_bf16 v[240:243], v[120:123], v[64:67], v[240:243]
    ds_read_b64_tr_b16 v[118:119], v59 offset:50176
    v_mfma_f32_16x16x32_bf16 v[244:247], v[120:123], v[68:71], v[244:247]
    ds_read_b64_tr_b16 v[120:121], v60 offset:49152
    s_waitcnt lgkmcnt(13)
    v_mfma_f32_16x16x32_bf16 v[252:255], v[124:127], v[68:71], v[252:255]
    ds_read_b64_tr_b16 v[122:123], v60 offset:50176
    v_mfma_f32_16x16x32_bf16 v[248:251], v[124:127], v[64:67], v[248:251]
    ds_read_b64_tr_b16 v[124:125], v61 offset:49152
    ds_read_b64_tr_b16 v[126:127], v61 offset:50176
    s_waitcnt lgkmcnt(14)
    v_mfma_f32_16x16x32_bf16 v[192:195], v[96:99], v[72:75], v[192:195]
    v_mfma_f32_16x16x32_bf16 v[196:199], v[96:99], v[76:79], v[196:199]
    ds_read_b64_tr_b16 v[96:97], v54 offset:57344
    s_waitcnt lgkmcnt(13)
    v_mfma_f32_16x16x32_bf16 v[204:207], v[100:103], v[76:79], v[204:207]
    ds_read_b64_tr_b16 v[98:99], v54 offset:58368
    v_mfma_f32_16x16x32_bf16 v[200:203], v[100:103], v[72:75], v[200:203]
    ds_read_b64_tr_b16 v[100:101], v55 offset:57344
    s_waitcnt lgkmcnt(13)
    v_mfma_f32_16x16x32_bf16 v[208:211], v[104:107], v[72:75], v[208:211]
    ds_read_b64_tr_b16 v[102:103], v55 offset:58368
    v_mfma_f32_16x16x32_bf16 v[212:215], v[104:107], v[76:79], v[212:215]
    ds_read_b64_tr_b16 v[104:105], v56 offset:57344
    s_waitcnt lgkmcnt(13)
    v_mfma_f32_16x16x32_bf16 v[220:223], v[108:111], v[76:79], v[220:223]
    ds_read_b64_tr_b16 v[106:107], v56 offset:58368
    buffer_store_dwordx4 v[152:155], v13, s[8:11], s67 offen sc1
    s_add_u32 s67, s67, 1024
    v_mfma_f32_16x16x32_bf16 v[216:219], v[108:111], v[72:75], v[216:219]
    ds_read_b64_tr_b16 v[108:109], v57 offset:57344
    s_waitcnt lgkmcnt(13)
    v_mfma_f32_16x16x32_bf16 v[224:227], v[112:115], v[72:75], v[224:227]
    ds_read_b64_tr_b16 v[110:111], v57 offset:58368
    v_mfma_f32_16x16x32_bf16 v[228:231], v[112:115], v[76:79], v[228:231]
    ds_read_b64_tr_b16 v[112:113], v58 offset:57344
    s_waitcnt lgkmcnt(13)
    v_mfma_f32_16x16x32_bf16 v[236:239], v[116:119], v[76:79], v[236:239]
    ds_read_b64_tr_b16 v[114:115], v58 offset:58368
    v_mfma_f32_16x16x32_bf16 v[232:235], v[116:119], v[72:75], v[232:235]
    ds_read_b64_tr_b16 v[116:117], v59 offset:57344
    s_waitcnt lgkmcnt(13)
    v_mfma_f32_16x16x32_bf16 v[240:243], v[120:123], v[72:75], v[240:243]
    ds_read_b64_tr_b16 v[118:119], v59 offset:58368
    v_mfma_f32_16x16x32_bf16 v[244:247], v[120:123], v[76:79], v[244:247]
    ds_read_b64_tr_b16 v[120:121], v60 offset:57344
    s_waitcnt lgkmcnt(13)
    v_mfma_f32_16x16x32_bf16 v[252:255], v[124:127], v[76:79], v[252:255]
    ds_read_b64_tr_b16 v[122:123], v60 offset:58368
    v_mfma_f32_16x16x32_bf16 v[248:251], v[124:127], v[72:75], v[248:251]
    ds_read_b64_tr_b16 v[124:125], v61 offset:57344
    ds_read_b64_tr_b16 v[126:127], v61 offset:58368
    s_waitcnt lgkmcnt(14)
    v_mfma_f32_16x16x32_bf16 v[192:195], v[96:99], v[80:83], v[192:195]
    v_mfma_f32_16x16x32_bf16 v[196:199], v[96:99], v[84:87], v[196:199]
    s_waitcnt lgkmcnt(12)
    v_mfma_f32_16x16x32_bf16 v[204:207], v[100:103], v[84:87], v[204:207]
    v_mfma_f32_16x16x32_bf16 v[200:203], v[100:103], v[80:83], v[200:203]
    s_waitcnt lgkmcnt(10)
    v_mfma_f32_16x16x32_bf16 v[208:211], v[104:107], v[80:83], v[208:211]
    v_mfma_f32_16x16x32_bf16 v[212:215], v[104:107], v[84:87], v[212:215]
    s_waitcnt lgkmcnt(8)
    v_mfma_f32_16x16x32_bf16 v[220:223], v[108:111], v[84:87], v[220:223]
    buffer_store_dwordx4 v[156:159], v13, s[8:11], s67 offen sc1
    s_add_u32 s67, s67, s69
    v_mfma_f32_16x16x32_bf16 v[216:219], v[108:111], v[80:83], v[216:219]
    s_waitcnt lgkmcnt(6)
    v_mfma_f32_16x16x32_bf16 v[224:227], v[112:115], v[80:83], v[224:227]
    v_mfma_f32_16x16x32_bf16 v[228:231], v[112:115], v[84:87], v[228:231]
    s_waitcnt lgkmcnt(4)
    v_mfma_f32_16x16x32_bf16 v[236:239], v[116:119], v[84:87], v[236:239]
    v_mfma_f32_16x16x32_bf16 v[232:235], v[116:119], v[80:83], v[232:235]
    s_waitcnt lgkmcnt(2)
    v_mfma_f32_16x16x32_bf16 v[240:243], v[120:123], v[80:83], v[240:243]
    v_mfma_f32_16x16x32_bf16 v[244:247], v[120:123], v[84:87], v[244:247]
    s_waitcnt lgkmcnt(0)
    v_mfma_f32_16x16x32_bf16 v[252:255], v[124:127], v[84:87], v[252:255]
    v_mfma_f32_16x16x32_bf16 v[248:251], v[124:127], v[80:83], v[248:251]
    s_cmp_lt_u32 s3, 4
    s_cbranch_scc1 L_qb
    s_barrier
L_qb:
    s_mov_b32 s6, 0x3e0293ee
    s_nop 7
    buffer_store_dwordx4 v[160:163], v13, s[8:11], s67 offen sc1
    s_add_u32 s67, s67, 1024
    buffer_store_dwordx4 v[164:167], v13, s[8:11], s67 offen sc1
    s_add_u32 s67, s67, s68
    buffer_store_dwordx4 v[168:171], v13, s[8:11], s67 offen sc1
    s_add_u32 s67, s67, 1024
    buffer_store_dwordx4 v[172:175], v13, s[8:11], s67 offen sc1
    s_add_u32 s67, s67, s69
    v_mul_f32 v192, s6, v192
    v_mul_f32 v193, s6, v193
    v_mul_f32 v194, s6, v194
    v_mul_f32 v195, s6, v195
    v_cvt_pk_bf16_f32 v16, v192, v193
    v_cvt_pk_bf16_f32 v17, v194, v195
    v_mul_f32 v200, s6, v200
    v_mul_f32 v201, s6, v201
    v_mul_f32 v202, s6, v202
    v_mul_f32 v203, s6, v203
    v_cvt_pk_bf16_f32 v18, v200, v201
    v_cvt_pk_bf16_f32 v19, v202, v203
    v_mul_f32 v208, s6, v208
    v_mul_f32 v209, s6, v209
    v_mul_f32 v210, s6, v210
    v_mul_f32 v211, s6, v211
    v_cvt_pk_bf16_f32 v20, v208, v209
    v_cvt_pk_bf16_f32 v21, v210, v211
    v_mul_f32 v216, s6, v216
    v_mul_f32 v217, s6, v217
    v_mul_f32 v218, s6, v218
    v_mul_f32 v219, s6, v219
    v_cvt_pk_bf16_f32 v22, v216, v217
    v_cvt_pk_bf16_f32 v23, v218, v219
    v_mul_f32 v224, s6, v224
    v_mul_f32 v225, s6, v225
    v_mul_f32 v226, s6, v226
    v_mul_f32 v227, s6, v227
    v_cvt_pk_bf16_f32 v24, v224, v225
    v_cvt_pk_bf16_f32 v25, v226, v227
    v_mul_f32 v232, s6, v232
    v_mul_f32 v233, s6, v233
    v_mul_f32 v234, s6, v234
    v_mul_f32 v235, s6, v235
    v_cvt_pk_bf16_f32 v26, v232, v233
    v_cvt_pk_bf16_f32 v27, v234, v235
    v_mul_f32 v240, s6, v240
    v_mul_f32 v241, s6, v241
    v_mul_f32 v242, s6, v242
    v_mul_f32 v243, s6, v243
    v_cvt_pk_bf16_f32 v28, v240, v241
    v_cvt_pk_bf16_f32 v29, v242, v243
    v_mul_f32 v248, s6, v248
    v_mul_f32 v249, s6, v249
    v_mul_f32 v250, s6, v250
    v_mul_f32 v251, s6, v251
    v_cvt_pk_bf16_f32 v30, v248, v249
    v_cvt_pk_bf16_f32 v31, v250, v251
    v_mul_f32 v196, s6, v196
    v_mul_f32 v197, s6, v197
    v_mul_f32 v198, s6, v198
    v_mul_f32 v199, s6, v199
    v_cvt_pk_bf16_f32 v32, v196, v197
    v_cvt_pk_bf16_f32 v33, v198, v199
    v_mul_f32 v204, s6, v204
    v_mul_f32 v205, s6, v205
    v_mul_f32 v206, s6, v206
    v_mul_f32 v207, s6, v207
    v_cvt_pk_bf16_f32 v34, v204, v205
    v_cvt_pk_bf16_f32 v35, v206, v207
    v_mul_f32 v212, s6, v212
    v_mul_f32 v213, s6, v213
    v_mul_f32 v214, s6, v214
    v_mul_f32 v215, s6, v215
    v_cvt_pk_bf16_f32 v36, v212, v213
    v_cvt_pk_bf16_f32 v37, v214, v215
    v_mul_f32 v220, s6, v220
    v_mul_f32 v221, s6, v221
    v_mul_f32 v222, s6, v222
    v_mul_f32 v223, s6, v223
    v_cvt_pk_bf16_f32 v38, v220, v221
    v_cvt_pk_bf16_f32 v39, v222, v223
    v_mul_f32 v228, s6, v228
    v_mul_f32 v229, s6, v229
    v_mul_f32 v230, s6, v230
    v_mul_f32 v231, s6, v231
    v_cvt_pk_bf16_f32 v40, v228, v229
    v_cvt_pk_bf16_f32 v41, v230, v231
    v_mul_f32 v236, s6, v236
    v_mul_f32 v237, s6, v237
    v_mul_f32 v238, s6, v238
    v_mul_f32 v239, s6, v239
    v_cvt_pk_bf16_f32 v42, v236, v237
    v_cvt_pk_bf16_f32 v43, v238, v239
    v_mul_f32 v244, s6, v244
    v_mul_f32 v245, s6, v245
    v_mul_f32 v246, s6, v246
    v_mul_f32 v247, s6, v247
    v_cvt_pk_bf16_f32 v44, v244, v245
    v_cvt_pk_bf16_f32 v45, v246, v247
    v_mul_f32 v252, s6, v252
    v_mul_f32 v253, s6, v253
    v_mul_f32 v254, s6, v254
    v_mul_f32 v255, s6, v255
    v_cvt_pk_bf16_f32 v46, v252, v253
    v_cvt_pk_bf16_f32 v47, v254, v255
    v_mov_b64 v[192:193], 0
    v_mov_b64 v[194:195], 0
    v_mov_b64 v[196:197], 0
    v_mov_b64 v[198:199], 0
    v_mov_b64 v[200:201], 0
    v_mov_b64 v[202:203], 0
    v_mov_b64 v[204:205], 0
    v_mov_b64 v[206:207], 0
    v_mov_b64 v[208:209], 0
    v_mov_b64 v[210:211], 0
    v_mov_b64 v[212:213], 0
    v_mov_b64 v[214:215], 0
    v_mov_b64 v[216:217], 0
    v_mov_b64 v[218:219], 0
    v_mov_b64 v[220:221], 0
    v_mov_b64 v[222:223], 0
    v_mov_b64 v[224:225], 0
    v_mov_b64 v[226:227], 0
    v_mov_b64 v[228:229], 0
    v_mov_b64 v[230:231], 0
    v_mov_b64 v[232:233], 0
    v_mov_b64 v[234:235], 0
    v_mov_b64 v[236:237], 0
    v_mov_b64 v[238:239], 0
    v_mov_b64 v[240:241], 0
    v_mov_b64 v[242:243], 0
    v_mov_b64 v[244:245], 0
    v_mov_b64 v[246:247], 0
    v_mov_b64 v[248:249], 0
    v_mov_b64 v[250:251], 0
    v_mov_b64 v[252:253], 0
    v_mov_b64 v[254:255], 0
    v_mov_b64 v[144:145], 0
    v_mov_b64 v[146:147], 0
    v_mov_b64 v[148:149], 0
    v_mov_b64 v[150:151], 0
    v_mov_b64 v[152:153], 0
    v_mov_b64 v[154:155], 0
    v_mov_b64 v[156:157], 0
    v_mov_b64 v[158:159], 0
    v_mov_b64 v[160:161], 0
    v_mov_b64 v[162:163], 0
    v_mov_b64 v[164:165], 0
    v_mov_b64 v[166:167], 0
    v_mov_b32 v168, 0x3f803f80
    v_mov_b32 v169, 0x3f803f80
    v_mov_b32 v170, 0x3f803f80
    v_mov_b32 v171, 0x3f803f80
    v_add_u32 v48, s100, v13
    s_waitcnt vmcnt(8)
    s_mov_b32 s72, 0x40004000
    s_mov_b32 s65, 0
    s_sub_u32 s63, 15, s5
    s_mov_b32 s62, -1
    s_cmp_ge_u32 s3, 4
    s_cbranch_scc1 L_qb2
    s_barrier
L_qb2:
    ds_read_b128 v[96:99], v48 offset:0
    ds_read_b128 v[100:103], v48 offset:1024
    ds_read_b128 v[104:107], v48 offset:2048
    ds_read_b128 v[108:111], v48 offset:3072
    ds_read_b128 v[112:115], v48 offset:4096
    ds_read_b128 v[116:119], v48 offset:5120
    ds_read_b128 v[120:123], v48 offset:6144
    ds_read_b128 v[124:127], v48 offset:7168
    s_cmp_lg_u32 s60, 0
    s_cbranch_scc1 L_nm0
    s_call_b64 s[82:83], L_mask
L_nm0:
    s_waitcnt lgkmcnt(7)
    v_mfma_f32_16x16x32_bf16 v[64:67], v[96:99], v[16:19], v[144:147]
    v_mfma_f32_16x16x32_bf16 v[68:71], v[96:99], v[32:35], v[148:151]
    ds_read_b128 v[96:99], v48 offset:8192
    s_waitcnt lgkmcnt(7)
    v_mfma_f32_16x16x32_bf16 v[64:67], v[100:103], v[20:23], v[64:67]
    v_mfma_f32_16x16x32_bf16 v[68:71], v[100:103], v[36:39], v[68:71]
    ds_read_b128 v[100:103], v48 offset:9216
    s_waitcnt lgkmcnt(7)
    v_mfma_f32_16x16x32_bf16 v[64:67], v[104:107], v[24:27], v[64:67]
    v_mfma_f32_16x16x32_bf16 v[68:71], v[104:107], v[40:43], v[68:71]
    ds_read_b128 v[104:107], v48 offset:10240
    s_waitcnt lgkmcnt(7)
    v_mfma_f32_16x16x32_bf16 v[64:67], v[108:111], v[28:31], v[64:67]
    v_mfma_f32_16x16x32_bf16 v[68:71], v[108:111], v[44:47], v[68:71]
    ds_read_b128 v[108:111], v48 offset:11264
    s_waitcnt lgkmcnt(7)
    v_mfma_f32_16x16x32_bf16 v[72:75], v[112:115], v[16:19], v[152:155]
    v_mfma_f32_16x16x32_bf16 v[76:79], v[112:115], v[32:35], v[156:159]
    ds_read_b128 v[112:115], v48 offset:12288
    s_waitcnt lgkmcnt(7)
    v_mfma_f32_16x16x32_bf16 v[72:75], v[116:119], v[20:23], v[72:75]
    v_mfma_f32_16x16x32_bf16 v[76:79], v[116:119], v[36:39], v[76:79]
    ds_read_b128 v[116:119], v48 offset:13312
    s_waitcnt lgkmcnt(7)
    v_mfma_f32_16x16x32_bf16 v[72:75], v[120:123], v[24:27], v[72:75]
    v_mfma_f32_16x16x32_bf16 v[76:79], v[120:123], v[40:43], v[76:79]
    ds_read_b128 v[120:123], v48 offset:14336
    s_waitcnt lgkmcnt(7)
    v_mfma_f32_16x16x32_bf16 v[72:75], v[124:127], v[28:31], v[72:75]
    v_mfma_f32_16x16x32_bf16 v[76:79], v[124:127], v[44:47], v[76:79]
    ds_read_b128 v[124:127], v48 offset:15360
    s_nop 7
    v_max3_f32 v58, v64, v65, v66
    v_max3_f32 v58, v58, v67, v72
    v_max3_f32 v58, v58, v73, v74
    v_max_f32 v58, v58, v75
    v_mov_b32 v60, v58
    s_nop 1
    v_permlane16_swap_b32 v58, v60
    s_nop 1
    v_max_f32 v58, v58, v60
    v_mov_b32 v60, v58
    s_nop 1
    v_permlane32_swap_b32 v58, v60
    s_nop 1
    v_max_f32 v58, v58, v60
    v_add_f32 v58, 0x41c00000, v58
    v_sub_f32 v64, v64, v58
    v_sub_f32 v144, 0, v58
    v_sub_f32 v65, v65, v58
    v_sub_f32 v145, 0, v58
    v_sub_f32 v66, v66, v58
    v_sub_f32 v146, 0, v58
    v_sub_f32 v67, v67, v58
    v_sub_f32 v147, 0, v58
    v_sub_f32 v72, v72, v58
    v_sub_f32 v152, 0, v58
    v_sub_f32 v73, v73, v58
    v_sub_f32 v153, 0, v58
    v_sub_f32 v74, v74, v58
    v_sub_f32 v154, 0, v58
    v_sub_f32 v75, v75, v58
    v_sub_f32 v155, 0, v58
    v_max3_f32 v59, v68, v69, v70
    v_max3_f32 v59, v59, v71, v76
    v_max3_f32 v59, v59, v77, v78
    v_max_f32 v59, v59, v79
    v_mov_b32 v60, v59
    s_nop 1
    v_permlane16_swap_b32 v59, v60
    s_nop 1
    v_max_f32 v59, v59, v60
    v_mov_b32 v60, v59
    s_nop 1
    v_permlane32_swap_b32 v59, v60
    s_nop 1
    v_max_f32 v59, v59, v60
    v_add_f32 v59, 0x41c00000, v59
    v_sub_f32 v68, v68, v59
    v_sub_f32 v148, 0, v59
    v_sub_f32 v69, v69, v59
    v_sub_f32 v149, 0, v59
    v_sub_f32 v70, v70, v59
    v_sub_f32 v150, 0, v59
    v_sub_f32 v71, v71, v59
    v_sub_f32 v151, 0, v59
    v_sub_f32 v76, v76, v59
    v_sub_f32 v156, 0, v59
    v_sub_f32 v77, v77, v59
    v_sub_f32 v157, 0, v59
    v_sub_f32 v78, v78, v59
    v_sub_f32 v158, 0, v59
    v_sub_f32 v79, v79, v59
    v_sub_f32 v159, 0, v59
    s_cmp_lg_u32 s60, 1
    s_cbranch_scc1 L_nm1
    s_call_b64 s[82:83], L_mask
L_nm1:
    v_exp_f32 v58, v64
    v_exp_f32 v59, v65
    s_waitcnt lgkmcnt(7)
    v_mfma_f32_16x16x32_bf16 v[80:83], v[96:99], v[16:19], v[144:147]
    s_waitcnt lgkmcnt(6)
    v_exp_f32 v60, v66
    v_exp_f32 v61, v67
    v_mfma_f32_16x16x32_bf16 v[84:87], v[96:99], v[32:35], v[148:151]
    ds_read_b128 v[96:99], v48 offset:49152
    v_cvt_pk_bf16_f32 v128, v58, v59
    v_cvt_pk_bf16_f32 v129, v60, v61
    v_mfma_f32_16x16x32_bf16 v[84:87], v[100:103], v[36:39], v[84:87]
    s_waitcnt lgkmcnt(6)
    v_exp_f32 v58, v68
    v_exp_f32 v59, v69
    v_mfma_f32_16x16x32_bf16 v[80:83], v[100:103], v[20:23], v[80:83]
    ds_read_b128 v[100:103], v48 offset:50176
    v_cvt_pk_bf16_f32 v132, v58, v59
    v_mfma_f32_16x16x32_bf16 v[80:83], v[104:107], v[24:27], v[80:83]
    s_waitcnt lgkmcnt(6)
    v_exp_f32 v60, v70
    v_exp_f32 v61, v71
    v_mfma_f32_16x16x32_bf16 v[84:87], v[104:107], v[40:43], v[84:87]
    ds_read_b128 v[104:107], v48 offset:51200
    v_cvt_pk_bf16_f32 v133, v60, v61
    v_mfma_f32_16x16x32_bf16 v[84:87], v[108:111], v[44:47], v[84:87]
    s_waitcnt lgkmcnt(6)
    v_exp_f32 v58, v72
    v_exp_f32 v59, v73
    v_mfma_f32_16x16x32_bf16 v[80:83], v[108:111], v[28:31], v[80:83]
    ds_read_b128 v[108:111], v48 offset:52224
    v_cvt_pk_bf16_f32 v130, v58, v59
    v_mfma_f32_16x16x32_bf16 v[88:91], v[112:115], v[16:19], v[152:155]
    s_waitcnt lgkmcnt(6)
    v_exp_f32 v60, v74
    v_exp_f32 v61, v75
    v_mfma_f32_16x16x32_bf16 v[92:95], v[112:115], v[32:35], v[156:159]
    ds_read_b128 v[112:115], v48 offset:53248
    v_cvt_pk_bf16_f32 v131, v60, v61
    v_mfma_f32_16x16x32_bf16 v[92:95], v[116:119], v[36:39], v[92:95]
    s_waitcnt lgkmcnt(6)
    v_exp_f32 v58, v76
    v_exp_f32 v59, v77
    v_mfma_f32_16x16x32_bf16 v[88:91], v[116:119], v[20:23], v[88:91]
    ds_read_b128 v[116:119], v48 offset:54272
    v_cvt_pk_bf16_f32 v134, v58, v59
    v_mfma_f32_16x16x32_bf16 v[88:91], v[120:123], v[24:27], v[88:91]
    s_waitcnt lgkmcnt(6)
    v_exp_f32 v60, v78
    v_exp_f32 v61, v79
    v_mfma_f32_16x16x32_bf16 v[92:95], v[120:123], v[40:43], v[92:95]
    ds_read_b128 v[120:123], v48 offset:55296
    v_cvt_pk_bf16_f32 v135, v60, v61
    v_mfma_f32_16x16x32_bf16 v[92:95], v[124:127], v[44:47], v[92:95]
    s_waitcnt lgkmcnt(6)
    v_or3_b32 v62, v128, v129, v132
    v_or3_b32 v62, v62, v133, v130
    v_or3_b32 v62, v62, v131, v134
    v_bitop3_b32 v62, v62, v135, s72 bitop3:0xa8
    v_cmp_ne_u32 vcc, s65, v62
    v_mfma_f32_16x16x32_bf16 v[88:91], v[124:127], v[28:31], v[88:91]
    ds_read_b128 v[124:127], v48 offset:56320
    s_cbranch_vccnz L_back_9_h
L_back_9:
    s_nop 7
    v_exp_f32 v58, v80
    v_exp_f32 v59, v81
    s_call_b64 s[82:83], L_load
    s_mov_b32 s62, 0
    buffer_store_dwordx4 v[176:179], v13, s[8:11], s67 offen sc1
    s_add_u32 s67, s67, 1024
    buffer_store_dwordx4 v[180:183], v13, s[8:11], s67 offen sc1
    s_add_u32 s67, s67, s68
    buffer_store_dwordx4 v[184:187], v13, s[8:11], s67 offen sc1
    s_add_u32 s67, s67, 1024
    buffer_store_dwordx4 v[188:191], v13, s[8:11], s67 offen sc1
    s_add_u32 s67, s67, s69
    s_sub_i32 s64, s60, 2
    s_cmp_eq_u32 s60, 0
    s_cbranch_scc1 L_pv2
    s_cmp_eq_u32 s60, 1
    s_cbranch_scc1 L_tail2
    s_cmp_lg_u32 s60, 2
    s_cbranch_scc1 L_st2
    s_call_b64 s[82:83], L_mask
    s_branch L_st2
.p2align 6
L_st0:
    v_mfma_f32_16x16x32_bf16 v[192:195], v[96:99], v[128:131], v[192:195]
    s_waitcnt lgkmcnt(6)
    v_exp_f32 v60, v82
    v_mfma_f32_16x16x32_bf16 v[196:199], v[96:99], v[132:135], v[196:199]
    ds_read_b128 v[96:99], v48 offset:0
    v_cvt_pk_bf16_f32 v136, v58, v59
    v_mfma_f32_16x16x32_bf16 v[204:207], v[100:103], v[132:135], v[204:207]
    s_waitcnt lgkmcnt(6)
    v_exp_f32 v61, v83
    v_mfma_f32_16x16x32_bf16 v[200:203], v[100:103], v[128:131], v[200:203]
    s_sub_i32 s64, s64, 1
    ds_read_b128 v[100:103], v48 offset:1024
    v_cvt_pk_bf16_f32 v137, v60, v61
    v_mfma_f32_16x16x32_bf16 v[208:211], v[104:107], v[128:131], v[208:211]
    s_waitcnt lgkmcnt(6)
    v_exp_f32 v58, v84
    v_mfma_f32_16x16x32_bf16 v[212:215], v[104:107], v[132:135], v[212:215]
    ds_read_b128 v[104:107], v48 offset:2048
    v_mfma_f32_16x16x32_bf16 v[220:223], v[108:111], v[132:135], v[220:223]
    s_waitcnt lgkmcnt(6)
    v_exp_f32 v59, v85
    v_mfma_f32_16x16x32_bf16 v[216:219], v[108:111], v[128:131], v[216:219]
    s_cmp_gt_i32 s64, 0
    ds_read_b128 v[108:111], v48 offset:3072
    v_cvt_pk_bf16_f32 v140, v58, v59
    v_mfma_f32_16x16x32_bf16 v[224:227], v[112:115], v[128:131], v[224:227]
    s_waitcnt lgkmcnt(6)
    v_exp_f32 v60, v86
    v_mfma_f32_16x16x32_bf16 v[228:231], v[112:115], v[132:135], v[228:231]
    ds_read_b128 v[112:115], v48 offset:4096
    v_or3_b32 v62, v136, v137, v140
    v_mfma_f32_16x16x32_bf16 v[236:239], v[116:119], v[132:135], v[236:239]
    s_waitcnt lgkmcnt(6)
    v_exp_f32 v61, v87
    v_mfma_f32_16x16x32_bf16 v[232:235], v[116:119], v[128:131], v[232:235]
    s_cselect_b32 s65, 0, 1
    ds_read_b128 v[116:119], v48 offset:5120
    v_cvt_pk_bf16_f32 v141, v60, v61
    v_mfma_f32_16x16x32_bf16 v[240:243], v[120:123], v[128:131], v[240:243]
    s_waitcnt lgkmcnt(6)
    v_exp_f32 v58, v88
    v_mfma_f32_16x16x32_bf16 v[244:247], v[120:123], v[132:135], v[244:247]
    ds_read_b128 v[120:123], v48 offset:6144
    v_mfma_f32_16x16x32_bf16 v[252:255], v[124:127], v[132:135], v[252:255]
    s_waitcnt lgkmcnt(6)
    v_exp_f32 v59, v89
    v_mfma_f32_16x16x32_bf16 v[248:251], v[124:127], v[128:131], v[248:251]
    ds_read_b128 v[124:127], v48 offset:7168
    v_cvt_pk_bf16_f32 v138, v58, v59
    v_mfma_f32_16x16x32_bf16 v[64:67], v[96:99], v[16:19], v[144:147]
    s_waitcnt lgkmcnt(6)
    v_exp_f32 v60, v90
    v_mfma_f32_16x16x32_bf16 v[68:71], v[96:99], v[32:35], v[148:151]
    ds_read_b128 v[96:99], v48 offset:40960
    v_or3_b32 v62, v62, v141, v138
    v_mfma_f32_16x16x32_bf16 v[68:71], v[100:103], v[36:39], v[68:71]
    v_exp_f32 v61, v91
    v_mfma_f32_16x16x32_bf16 v[64:67], v[100:103], v[20:23], v[64:67]
    ds_read_b128 v[100:103], v48 offset:41984
    v_cvt_pk_bf16_f32 v139, v60, v61
    v_mfma_f32_16x16x32_bf16 v[160:163], v[168:171], v[128:131], v[160:163]
    s_waitcnt lgkmcnt(7)
    v_exp_f32 v58, v92
    v_mfma_f32_16x16x32_bf16 v[164:167], v[168:171], v[132:135], v[164:167]
    v_mfma_f32_16x16x32_bf16 v[64:67], v[104:107], v[24:27], v[64:67]
    s_waitcnt lgkmcnt(6)
    v_exp_f32 v59, v93
    v_mfma_f32_16x16x32_bf16 v[68:71], v[104:107], v[40:43], v[68:71]
    ds_read_b128 v[104:107], v48 offset:43008
    v_cvt_pk_bf16_f32 v142, v58, v59
    v_mfma_f32_16x16x32_bf16 v[68:71], v[108:111], v[44:47], v[68:71]
    s_waitcnt lgkmcnt(6)
    v_exp_f32 v60, v94
    v_mfma_f32_16x16x32_bf16 v[64:67], v[108:111], v[28:31], v[64:67]
    ds_read_b128 v[108:111], v48 offset:44032
    v_or3_b32 v62, v62, v139, v142
    v_mfma_f32_16x16x32_bf16 v[72:75], v[112:115], v[16:19], v[152:155]
    s_waitcnt lgkmcnt(6)
    v_exp_f32 v61, v95
    v_mfma_f32_16x16x32_bf16 v[76:79], v[112:115], v[32:35], v[156:159]
    ds_read_b128 v[112:115], v48 offset:45056
    v_cvt_pk_bf16_f32 v143, v60, v61
    v_mfma_f32_16x16x32_bf16 v[76:79], v[116:119], v[36:39], v[76:79]
    s_waitcnt lgkmcnt(6)
    v_bitop3_b32 v62, v62, v143, s72 bitop3:0xa8
    v_cmp_ne_u32 vcc, s65, v62
    v_mfma_f32_16x16x32_bf16 v[72:75], v[116:119], v[20:23], v[72:75]
    ds_read_b128 v[116:119], v48 offset:46080
    v_mfma_f32_16x16x32_bf16 v[72:75], v[120:123], v[24:27], v[72:75]
    s_waitcnt lgkmcnt(6)
    v_exp_f32 v58, v64
    v_mfma_f32_16x16x32_bf16 v[76:79], v[120:123], v[40:43], v[76:79]
    ds_read_b128 v[120:123], v48 offset:47104
    v_mfma_f32_16x16x32_bf16 v[76:79], v[124:127], v[44:47], v[76:79]
    s_waitcnt lgkmcnt(6)
    v_exp_f32 v59, v65
    v_mfma_f32_16x16x32_bf16 v[72:75], v[124:127], v[28:31], v[72:75]
    ds_read_b128 v[124:127], v48 offset:48128
    s_cbranch_vccnz L_back_10_h
L_back_10:
    v_mfma_f32_16x16x32_bf16 v[192:195], v[96:99], v[136:139], v[192:195]
    s_waitcnt lgkmcnt(6)
    v_exp_f32 v60, v66
    v_mfma_f32_16x16x32_bf16 v[196:199], v[96:99], v[140:143], v[196:199]
    ds_read_b128 v[96:99], v48 offset:8192
    v_cvt_pk_bf16_f32 v128, v58, v59
    v_mfma_f32_16x16x32_bf16 v[204:207], v[100:103], v[140:143], v[204:207]
    s_waitcnt lgkmcnt(6)
    v_exp_f32 v61, v67
    v_mfma_f32_16x16x32_bf16 v[200:203], v[100:103], v[136:139], v[200:203]
    s_sub_i32 s64, s64, 1
    ds_read_b128 v[100:103], v48 offset:9216
    v_cvt_pk_bf16_f32 v129, v60, v61
    v_mfma_f32_16x16x32_bf16 v[208:211], v[104:107], v[136:139], v[208:211]
    s_waitcnt lgkmcnt(6)
    v_exp_f32 v58, v68
    v_mfma_f32_16x16x32_bf16 v[212:215], v[104:107], v[140:143], v[212:215]
    ds_read_b128 v[104:107], v48 offset:10240
    v_mfma_f32_16x16x32_bf16 v[220:223], v[108:111], v[140:143], v[220:223]
    s_waitcnt lgkmcnt(6)
    v_exp_f32 v59, v69
    v_mfma_f32_16x16x32_bf16 v[216:219], v[108:111], v[136:139], v[216:219]
    s_cmp_gt_i32 s64, 0
    ds_read_b128 v[108:111], v48 offset:11264
    v_cvt_pk_bf16_f32 v132, v58, v59
    v_mfma_f32_16x16x32_bf16 v[224:227], v[112:115], v[136:139], v[224:227]
    s_waitcnt lgkmcnt(6)
    v_exp_f32 v60, v70
    v_mfma_f32_16x16x32_bf16 v[228:231], v[112:115], v[140:143], v[228:231]
    ds_read_b128 v[112:115], v48 offset:12288
    v_or3_b32 v62, v128, v129, v132
    v_mfma_f32_16x16x32_bf16 v[236:239], v[116:119], v[140:143], v[236:239]
    s_waitcnt lgkmcnt(6)
    v_exp_f32 v61, v71
    v_mfma_f32_16x16x32_bf16 v[232:235], v[116:119], v[136:139], v[232:235]
    s_cselect_b32 s65, 0, 1
    ds_read_b128 v[116:119], v48 offset:13312
    v_cvt_pk_bf16_f32 v133, v60, v61
    v_mfma_f32_16x16x32_bf16 v[240:243], v[120:123], v[136:139], v[240:243]
    s_waitcnt lgkmcnt(6)
    v_exp_f32 v58, v72
    v_mfma_f32_16x16x32_bf16 v[244:247], v[120:123], v[140:143], v[244:247]
    ds_read_b128 v[120:123], v48 offset:14336
    v_mfma_f32_16x16x32_bf16 v[252:255], v[124:127], v[140:143], v[252:255]
    s_waitcnt lgkmcnt(6)
    v_exp_f32 v59, v73
    v_mfma_f32_16x16x32_bf16 v[248:251], v[124:127], v[136:139], v[248:251]
    ds_read_b128 v[124:127], v48 offset:15360
    v_cvt_pk_bf16_f32 v130, v58, v59
    v_mfma_f32_16x16x32_bf16 v[80:83], v[96:99], v[16:19], v[144:147]
    s_waitcnt lgkmcnt(6)
    v_exp_f32 v60, v74
    v_mfma_f32_16x16x32_bf16 v[84:87], v[96:99], v[32:35], v[148:151]
    ds_read_b128 v[96:99], v48 offset:49152
    v_or3_b32 v62, v62, v133, v130
    v_mfma_f32_16x16x32_bf16 v[84:87], v[100:103], v[36:39], v[84:87]
    v_exp_f32 v61, v75
    v_mfma_f32_16x16x32_bf16 v[80:83], v[100:103], v[20:23], v[80:83]
    ds_read_b128 v[100:103], v48 offset:50176
    v_cvt_pk_bf16_f32 v131, v60, v61
    v_mfma_f32_16x16x32_bf16 v[160:163], v[168:171], v[136:139], v[160:163]
    s_waitcnt lgkmcnt(7)
    v_exp_f32 v58, v76
    v_mfma_f32_16x16x32_bf16 v[164:167], v[168:171], v[140:143], v[164:167]
    v_mfma_f32_16x16x32_bf16 v[80:83], v[104:107], v[24:27], v[80:83]
    s_waitcnt lgkmcnt(6)
    v_exp_f32 v59, v77
    v_mfma_f32_16x16x32_bf16 v[84:87], v[104:107], v[40:43], v[84:87]
    ds_read_b128 v[104:107], v48 offset:51200
    v_cvt_pk_bf16_f32 v134, v58, v59
    v_mfma_f32_16x16x32_bf16 v[84:87], v[108:111], v[44:47], v[84:87]
    s_waitcnt lgkmcnt(6)
    v_exp_f32 v60, v78
    v_mfma_f32_16x16x32_bf16 v[80:83], v[108:111], v[28:31], v[80:83]
    ds_read_b128 v[108:111], v48 offset:52224
    v_or3_b32 v62, v62, v131, v134
    v_mfma_f32_16x16x32_bf16 v[88:91], v[112:115], v[16:19], v[152:155]
    s_waitcnt lgkmcnt(6)
    v_exp_f32 v61, v79
    v_mfma_f32_16x16x32_bf16 v[92:95], v[112:115], v[32:35], v[156:159]
    ds_read_b128 v[112:115], v48 offset:53248
    v_cvt_pk_bf16_f32 v135, v60, v61
    v_mfma_f32_16x16x32_bf16 v[92:95], v[116:119], v[36:39], v[92:95]
    s_waitcnt lgkmcnt(6)
    v_bitop3_b32 v62, v62, v135, s72 bitop3:0xa8
    v_cmp_ne_u32 vcc, s65, v62
    v_mfma_f32_16x16x32_bf16 v[88:91], v[116:119], v[20:23], v[88:91]
    ds_read_b128 v[116:119], v48 offset:54272
    v_mfma_f32_16x16x32_bf16 v[88:91], v[120:123], v[24:27], v[88:91]
    s_waitcnt lgkmcnt(6)
    v_exp_f32 v58, v80
    v_mfma_f32_16x16x32_bf16 v[92:95], v[120:123], v[40:43], v[92:95]
    ds_read_b128 v[120:123], v48 offset:55296
    v_mfma_f32_16x16x32_bf16 v[92:95], v[124:127], v[44:47], v[92:95]
    s_waitcnt lgkmcnt(6)
    v_exp_f32 v59, v81
    v_mfma_f32_16x16x32_bf16 v[88:91], v[124:127], v[28:31], v[88:91]
    ds_read_b128 v[124:127], v48 offset:56320
    s_cbranch_vccnz L_back_11_h
L_back_11:
L_st2:
    v_mfma_f32_16x16x32_bf16 v[192:195], v[96:99], v[128:131], v[192:195]
    s_waitcnt lgkmcnt(6)
    v_exp_f32 v60, v82
    v_mfma_f32_16x16x32_bf16 v[196:199], v[96:99], v[132:135], v[196:199]
    ds_read_b128 v[96:99], v48 offset:16384
    v_cvt_pk_bf16_f32 v136, v58, v59
    v_mfma_f32_16x16x32_bf16 v[204:207], v[100:103], v[132:135], v[204:207]
    s_waitcnt lgkmcnt(6)
    v_exp_f32 v61, v83
    v_mfma_f32_16x16x32_bf16 v[200:203], v[100:103], v[128:131], v[200:203]
    s_sub_i32 s64, s64, 1
    ds_read_b128 v[100:103], v48 offset:17408
    v_cvt_pk_bf16_f32 v137, v60, v61
    v_mfma_f32_16x16x32_bf16 v[208:211], v[104:107], v[128:131], v[208:211]
    s_waitcnt lgkmcnt(6)
    v_exp_f32 v58, v84
    v_mfma_f32_16x16x32_bf16 v[212:215], v[104:107], v[132:135], v[212:215]
    ds_read_b128 v[104:107], v48 offset:18432
    v_mfma_f32_16x16x32_bf16 v[220:223], v[108:111], v[132:135], v[220:223]
    s_waitcnt lgkmcnt(6)
    v_exp_f32 v59, v85
    v_mfma_f32_16x16x32_bf16 v[216:219], v[108:111], v[128:131], v[216:219]
    s_cmp_gt_i32 s64, 0
    ds_read_b128 v[108:111], v48 offset:19456
    v_cvt_pk_bf16_f32 v140, v58, v59
    v_mfma_f32_16x16x32_bf16 v[224:227], v[112:115], v[128:131], v[224:227]
    s_waitcnt lgkmcnt(6)
    v_exp_f32 v60, v86
    v_mfma_f32_16x16x32_bf16 v[228:231], v[112:115], v[132:135], v[228:231]
    ds_read_b128 v[112:115], v48 offset:20480
    v_or3_b32 v62, v136, v137, v140
    v_mfma_f32_16x16x32_bf16 v[236:239], v[116:119], v[132:135], v[236:239]
    s_waitcnt lgkmcnt(6)
    v_exp_f32 v61, v87
    v_mfma_f32_16x16x32_bf16 v[232:235], v[116:119], v[128:131], v[232:235]
    s_cselect_b32 s65, 0, 1
    ds_read_b128 v[116:119], v48 offset:21504
    v_cvt_pk_bf16_f32 v141, v60, v61
    v_mfma_f32_16x16x32_bf16 v[240:243], v[120:123], v[128:131], v[240:243]
    s_waitcnt lgkmcnt(6)
    v_exp_f32 v58, v88
    v_mfma_f32_16x16x32_bf16 v[244:247], v[120:123], v[132:135], v[244:247]
    ds_read_b128 v[120:123], v48 offset:22528
    v_mfma_f32_16x16x32_bf16 v[252:255], v[124:127], v[132:135], v[252:255]
    s_waitcnt lgkmcnt(6)
    v_exp_f32 v59, v89
    v_mfma_f32_16x16x32_bf16 v[248:251], v[124:127], v[128:131], v[248:251]
    ds_read_b128 v[124:127], v48 offset:23552
    v_cvt_pk_bf16_f32 v138, v58, v59
    v_mfma_f32_16x16x32_bf16 v[64:67], v[96:99], v[16:19], v[144:147]
    s_waitcnt lgkmcnt(6)
    v_exp_f32 v60, v90
    v_mfma_f32_16x16x32_bf16 v[68:71], v[96:99], v[32:35], v[148:151]
    ds_read_b128 v[96:99], v48 offset:57344
    v_or3_b32 v62, v62, v141, v138
    v_mfma_f32_16x16x32_bf16 v[68:71], v[100:103], v[36:39], v[68:71]
    v_exp_f32 v61, v91
    v_mfma_f32_16x16x32_bf16 v[64:67], v[100:103], v[20:23], v[64:67]
    ds_read_b128 v[100:103], v48 offset:58368
    v_cvt_pk_bf16_f32 v139, v60, v61
    v_mfma_f32_16x16x32_bf16 v[160:163], v[168:171], v[128:131], v[160:163]
    s_waitcnt lgkmcnt(7)
    v_exp_f32 v58, v92
    v_mfma_f32_16x16x32_bf16 v[164:167], v[168:171], v[132:135], v[164:167]
    v_mfma_f32_16x16x32_bf16 v[64:67], v[104:107], v[24:27], v[64:67]
    s_waitcnt lgkmcnt(6)
    v_exp_f32 v59, v93
    v_mfma_f32_16x16x32_bf16 v[68:71], v[104:107], v[40:43], v[68:71]
    ds_read_b128 v[104:107], v48 offset:59392
    v_cvt_pk_bf16_f32 v142, v58, v59
    v_mfma_f32_16x16x32_bf16 v[68:71], v[108:111], v[44:47], v[68:71]
    s_waitcnt lgkmcnt(6)
    v_exp_f32 v60, v94
    v_mfma_f32_16x16x32_bf16 v[64:67], v[108:111], v[28:31], v[64:67]
    ds_read_b128 v[108:111], v48 offset:60416
    v_or3_b32 v62, v62, v139, v142
    v_mfma_f32_16x16x32_bf16 v[72:75], v[112:115], v[16:19], v[152:155]
    s_waitcnt lgkmcnt(6)
    v_exp_f32 v61, v95
    v_mfma_f32_16x16x32_bf16 v[76:79], v[112:115], v[32:35], v[156:159]
    ds_read_b128 v[112:115], v48 offset:61440
    v_cvt_pk_bf16_f32 v143, v60, v61
    v_mfma_f32_16x16x32_bf16 v[76:79], v[116:119], v[36:39], v[76:79]
    s_waitcnt lgkmcnt(6)
    v_bitop3_b32 v62, v62, v143, s72 bitop3:0xa8
    v_cmp_ne_u32 vcc, s65, v62
    v_mfma_f32_16x16x32_bf16 v[72:75], v[116:119], v[20:23], v[72:75]
    ds_read_b128 v[116:119], v48 offset:62464
    v_mfma_f32_16x16x32_bf16 v[72:75], v[120:123], v[24:27], v[72:75]
    s_waitcnt lgkmcnt(6)
    v_exp_f32 v58, v64
    v_mfma_f32_16x16x32_bf16 v[76:79], v[120:123], v[40:43], v[76:79]
    ds_read_b128 v[120:123], v48 offset:63488
    v_mfma_f32_16x16x32_bf16 v[76:79], v[124:127], v[44:47], v[76:79]
    s_waitcnt lgkmcnt(6)
    v_exp_f32 v59, v65
    v_mfma_f32_16x16x32_bf16 v[72:75], v[124:127], v[28:31], v[72:75]
    ds_read_b128 v[124:127], v48 offset:64512
    s_cbranch_vccnz L_back_12_h
L_back_12:
    v_mfma_f32_16x16x32_bf16 v[192:195], v[96:99], v[136:139], v[192:195]
    s_waitcnt lgkmcnt(6)
    v_exp_f32 v60, v66
    v_mfma_f32_16x16x32_bf16 v[196:199], v[96:99], v[140:143], v[196:199]
    ds_read_b128 v[96:99], v48 offset:24576
    v_cvt_pk_bf16_f32 v128, v58, v59
    v_mfma_f32_16x16x32_bf16 v[204:207], v[100:103], v[140:143], v[204:207]
    s_waitcnt lgkmcnt(6)
    v_exp_f32 v61, v67
    v_mfma_f32_16x16x32_bf16 v[200:203], v[100:103], v[136:139], v[200:203]
    s_sub_i32 s64, s64, 1
    ds_read_b128 v[100:103], v48 offset:25600
    v_cvt_pk_bf16_f32 v129, v60, v61
    v_mfma_f32_16x16x32_bf16 v[208:211], v[104:107], v[136:139], v[208:211]
    s_waitcnt lgkmcnt(6)
    v_exp_f32 v58, v68
    v_mfma_f32_16x16x32_bf16 v[212:215], v[104:107], v[140:143], v[212:215]
    ds_read_b128 v[104:107], v48 offset:26624
    v_mfma_f32_16x16x32_bf16 v[220:223], v[108:111], v[140:143], v[220:223]
    s_waitcnt lgkmcnt(6)
    v_exp_f32 v59, v69
    v_mfma_f32_16x16x32_bf16 v[216:219], v[108:111], v[136:139], v[216:219]
    s_cmp_gt_i32 s64, 0
    ds_read_b128 v[108:111], v48 offset:27648
    v_cvt_pk_bf16_f32 v132, v58, v59
    v_mfma_f32_16x16x32_bf16 v[224:227], v[112:115], v[136:139], v[224:227]
    s_waitcnt lgkmcnt(6)
    v_exp_f32 v60, v70
    v_mfma_f32_16x16x32_bf16 v[228:231], v[112:115], v[140:143], v[228:231]
    ds_read_b128 v[112:115], v48 offset:28672
    v_or3_b32 v62, v128, v129, v132
    v_mfma_f32_16x16x32_bf16 v[236:239], v[116:119], v[140:143], v[236:239]
    s_waitcnt lgkmcnt(6)
    v_exp_f32 v61, v71
    v_mfma_f32_16x16x32_bf16 v[232:235], v[116:119], v[136:139], v[232:235]
    s_cselect_b32 s65, 0, 1
    ds_read_b128 v[116:119], v48 offset:29696
    v_cvt_pk_bf16_f32 v133, v60, v61
    v_mfma_f32_16x16x32_bf16 v[240:243], v[120:123], v[136:139], v[240:243]
    s_waitcnt lgkmcnt(6)
    v_exp_f32 v58, v72
    v_mfma_f32_16x16x32_bf16 v[244:247], v[120:123], v[140:143], v[244:247]
    ds_read_b128 v[120:123], v48 offset:30720
    v_mfma_f32_16x16x32_bf16 v[252:255], v[124:127], v[140:143], v[252:255]
    s_waitcnt lgkmcnt(6)
    v_exp_f32 v59, v73
    v_mfma_f32_16x16x32_bf16 v[248:251], v[124:127], v[136:139], v[248:251]
    ds_read_b128 v[124:127], v48 offset:31744
    v_cvt_pk_bf16_f32 v130, v58, v59
    v_mfma_f32_16x16x32_bf16 v[80:83], v[96:99], v[16:19], v[144:147]
    s_waitcnt lgkmcnt(6)
    v_exp_f32 v60, v74
    v_mfma_f32_16x16x32_bf16 v[84:87], v[96:99], v[32:35], v[148:151]
    v_or3_b32 v62, v62, v133, v130
    v_xor_b32 v48, 0x10000, v48
    v_mfma_f32_16x16x32_bf16 v[84:87], v[100:103], v[36:39], v[84:87]
    v_exp_f32 v61, v75
    v_mfma_f32_16x16x32_bf16 v[80:83], v[100:103], v[20:23], v[80:83]
    s_cmp_lg_u32 s89, 0
    v_cvt_pk_bf16_f32 v131, v60, v61
    v_mfma_f32_16x16x32_bf16 v[160:163], v[168:171], v[136:139], v[160:163]
    s_waitcnt lgkmcnt(0)
    v_exp_f32 v58, v76
    v_mfma_f32_16x16x32_bf16 v[164:167], v[168:171], v[140:143], v[164:167]
    s_cbranch_scc1 L_ldback_13_c
    s_barrier
L_ldback_13:
    s_add_i32 s62, s62, 1
    ds_read_b128 v[96:99], v48 offset:32768
    ds_read_b128 v[100:103], v48 offset:33792
    v_mfma_f32_16x16x32_bf16 v[80:83], v[104:107], v[24:27], v[80:83]
    v_exp_f32 v59, v77
    v_mfma_f32_16x16x32_bf16 v[84:87], v[104:107], v[40:43], v[84:87]
    ds_read_b128 v[104:107], v48 offset:34816
    v_cvt_pk_bf16_f32 v134, v58, v59
    v_mfma_f32_16x16x32_bf16 v[84:87], v[108:111], v[44:47], v[84:87]
    v_exp_f32 v60, v78
    v_mfma_f32_16x16x32_bf16 v[80:83], v[108:111], v[28:31], v[80:83]
    ds_read_b128 v[108:111], v48 offset:35840
    v_or3_b32 v62, v62, v131, v134
    v_mfma_f32_16x16x32_bf16 v[88:91], v[112:115], v[16:19], v[152:155]
    v_exp_f32 v61, v79
    v_mfma_f32_16x16x32_bf16 v[92:95], v[112:115], v[32:35], v[156:159]
    ds_read_b128 v[112:115], v48 offset:36864
    v_cvt_pk_bf16_f32 v135, v60, v61
    v_mfma_f32_16x16x32_bf16 v[92:95], v[116:119], v[36:39], v[92:95]
    v_bitop3_b32 v62, v62, v135, s72 bitop3:0xa8
    v_cmp_ne_u32 vcc, s65, v62
    v_mfma_f32_16x16x32_bf16 v[88:91], v[116:119], v[20:23], v[88:91]
    ds_read_b128 v[116:119], v48 offset:37888
    v_mfma_f32_16x16x32_bf16 v[88:91], v[120:123], v[24:27], v[88:91]
    v_exp_f32 v58, v80
    v_mfma_f32_16x16x32_bf16 v[92:95], v[120:123], v[40:43], v[92:95]
    ds_read_b128 v[120:123], v48 offset:38912
    v_mfma_f32_16x16x32_bf16 v[92:95], v[124:127], v[44:47], v[92:95]
    s_waitcnt lgkmcnt(6)
    v_exp_f32 v59, v81
    v_mfma_f32_16x16x32_bf16 v[88:91], v[124:127], v[28:31], v[88:91]
    ds_read_b128 v[124:127], v48 offset:39936
    s_cbranch_vccz L_st0
    s_branch L_back_14_h
L_tail0:
    s_mov_b32 s65, 0
    v_mfma_f32_16x16x32_bf16 v[192:195], v[96:99], v[128:131], v[192:195]
    s_waitcnt lgkmcnt(6)
    v_exp_f32 v60, v82
    v_exp_f32 v61, v83
    v_mfma_f32_16x16x32_bf16 v[196:199], v[96:99], v[132:135], v[196:199]
    ds_read_b128 v[96:99], v48 offset:40960
    v_cvt_pk_bf16_f32 v136, v58, v59
    v_cvt_pk_bf16_f32 v137, v60, v61
    v_mfma_f32_16x16x32_bf16 v[204:207], v[100:103], v[132:135], v[204:207]
    v_exp_f32 v58, v84
    v_exp_f32 v59, v85
    v_mfma_f32_16x16x32_bf16 v[200:203], v[100:103], v[128:131], v[200:203]
    ds_read_b128 v[100:103], v48 offset:41984
    v_cvt_pk_bf16_f32 v140, v58, v59
    v_mfma_f32_16x16x32_bf16 v[160:163], v[168:171], v[128:131], v[160:163]
    s_waitcnt lgkmcnt(7)
    v_exp_f32 v60, v86
    v_exp_f32 v61, v87
    v_mfma_f32_16x16x32_bf16 v[164:167], v[168:171], v[132:135], v[164:167]
    v_cvt_pk_bf16_f32 v141, v60, v61
    v_mfma_f32_16x16x32_bf16 v[208:211], v[104:107], v[128:131], v[208:211]
    s_waitcnt lgkmcnt(6)
    v_exp_f32 v58, v88
    v_exp_f32 v59, v89
    v_mfma_f32_16x16x32_bf16 v[212:215], v[104:107], v[132:135], v[212:215]
    ds_read_b128 v[104:107], v48 offset:43008
    v_cvt_pk_bf16_f32 v138, v58, v59
    v_mfma_f32_16x16x32_bf16 v[220:223], v[108:111], v[132:135], v[220:223]
    s_waitcnt lgkmcnt(6)
    v_exp_f32 v60, v90
    v_exp_f32 v61, v91
    v_mfma_f32_16x16x32_bf16 v[216:219], v[108:111], v[128:131], v[216:219]
    ds_read_b128 v[108:111], v48 offset:44032
    v_cvt_pk_bf16_f32 v139, v60, v61
    v_mfma_f32_16x16x32_bf16 v[224:227], v[112:115], v[128:131], v[224:227]
    s_waitcnt lgkmcnt(6)
    v_exp_f32 v58, v92
    v_exp_f32 v59, v93
    v_mfma_f32_16x16x32_bf16 v[228:231], v[112:115], v[132:135], v[228:231]
    ds_read_b128 v[112:115], v48 offset:45056
    v_cvt_pk_bf16_f32 v142, v58, v59
    v_mfma_f32_16x16x32_bf16 v[236:239], v[116:119], v[132:135], v[236:239]
    s_waitcnt lgkmcnt(6)
    v_exp_f32 v60, v94
    v_exp_f32 v61, v95
    v_mfma_f32_16x16x32_bf16 v[232:235], v[116:119], v[128:131], v[232:235]
    ds_read_b128 v[116:119], v48 offset:46080
    v_cvt_pk_bf16_f32 v143, v60, v61
    v_mfma_f32_16x16x32_bf16 v[240:243], v[120:123], v[128:131], v[240:243]
    s_waitcnt lgkmcnt(6)
    v_or3_b32 v62, v136, v137, v140
    v_or3_b32 v62, v62, v141, v138
    v_or3_b32 v62, v62, v139, v142
    v_bitop3_b32 v62, v62, v143, s72 bitop3:0xa8
    v_cmp_ne_u32 vcc, s65, v62
    v_mfma_f32_16x16x32_bf16 v[244:247], v[120:123], v[132:135], v[244:247]
    ds_read_b128 v[120:123], v48 offset:47104
    v_mfma_f32_16x16x32_bf16 v[252:255], v[124:127], v[132:135], v[252:255]
    s_waitcnt lgkmcnt(6)
    v_mfma_f32_16x16x32_bf16 v[248:251], v[124:127], v[128:131], v[248:251]
    ds_read_b128 v[124:127], v48 offset:48128
    s_cbranch_vccnz L_back_15_h
L_back_15:
L_pv1:
    v_mfma_f32_16x16x32_bf16 v[192:195], v[96:99], v[136:139], v[192:195]
    s_waitcnt lgkmcnt(6)
    v_mfma_f32_16x16x32_bf16 v[196:199], v[96:99], v[140:143], v[196:199]
    v_mfma_f32_16x16x32_bf16 v[204:207], v[100:103], v[140:143], v[204:207]
    v_mfma_f32_16x16x32_bf16 v[200:203], v[100:103], v[136:139], v[200:203]
    v_mfma_f32_16x16x32_bf16 v[160:163], v[168:171], v[136:139], v[160:163]
    s_waitcnt lgkmcnt(5)
    v_mfma_f32_16x16x32_bf16 v[164:167], v[168:171], v[140:143], v[164:167]
    v_mfma_f32_16x16x32_bf16 v[208:211], v[104:107], v[136:139], v[208:211]
    s_waitcnt lgkmcnt(4)
    v_mfma_f32_16x16x32_bf16 v[212:215], v[104:107], v[140:143], v[212:215]
    v_mfma_f32_16x16x32_bf16 v[220:223], v[108:111], v[140:143], v[220:223]
    s_waitcnt lgkmcnt(3)
    v_mfma_f32_16x16x32_bf16 v[216:219], v[108:111], v[136:139], v[216:219]
    v_mfma_f32_16x16x32_bf16 v[224:227], v[112:115], v[136:139], v[224:227]
    s_waitcnt lgkmcnt(2)
    v_mfma_f32_16x16x32_bf16 v[228:231], v[112:115], v[140:143], v[228:231]
    v_mfma_f32_16x16x32_bf16 v[236:239], v[116:119], v[140:143], v[236:239]
    s_waitcnt lgkmcnt(1)
    v_mfma_f32_16x16x32_bf16 v[232:235], v[116:119], v[136:139], v[232:235]
    v_mfma_f32_16x16x32_bf16 v[240:243], v[120:123], v[136:139], v[240:243]
    s_waitcnt lgkmcnt(0)
    v_mfma_f32_16x16x32_bf16 v[244:247], v[120:123], v[140:143], v[244:247]
    v_mfma_f32_16x16x32_bf16 v[252:255], v[124:127], v[140:143], v[252:255]
    v_mfma_f32_16x16x32_bf16 v[248:251], v[124:127], v[136:139], v[248:251]
    s_branch L_fin
L_tail1:
    s_mov_b32 s65, 0
    v_mfma_f32_16x16x32_bf16 v[192:195], v[96:99], v[136:139], v[192:195]
    s_waitcnt lgkmcnt(6)
    v_exp_f32 v60, v66
    v_exp_f32 v61, v67
    v_mfma_f32_16x16x32_bf16 v[196:199], v[96:99], v[140:143], v[196:199]
    ds_read_b128 v[96:99], v48 offset:49152
    v_cvt_pk_bf16_f32 v128, v58, v59
    v_cvt_pk_bf16_f32 v129, v60, v61
    v_mfma_f32_16x16x32_bf16 v[204:207], v[100:103], v[140:143], v[204:207]
    v_exp_f32 v58, v68
    v_exp_f32 v59, v69
    v_mfma_f32_16x16x32_bf16 v[200:203], v[100:103], v[136:139], v[200:203]
    ds_read_b128 v[100:103], v48 offset:50176
    v_cvt_pk_bf16_f32 v132, v58, v59
    v_mfma_f32_16x16x32_bf16 v[160:163], v[168:171], v[136:139], v[160:163]
    s_waitcnt lgkmcnt(7)
    v_exp_f32 v60, v70
    v_exp_f32 v61, v71
    v_mfma_f32_16x16x32_bf16 v[164:167], v[168:171], v[140:143], v[164:167]
    v_cvt_pk_bf16_f32 v133, v60, v61
    v_mfma_f32_16x16x32_bf16 v[208:211], v[104:107], v[136:139], v[208:211]
    s_waitcnt lgkmcnt(6)
    v_exp_f32 v58, v72
    v_exp_f32 v59, v73
    v_mfma_f32_16x16x32_bf16 v[212:215], v[104:107], v[140:143], v[212:215]
    ds_read_b128 v[104:107], v48 offset:51200
    v_cvt_pk_bf16_f32 v130, v58, v59
    v_mfma_f32_16x16x32_bf16 v[220:223], v[108:111], v[140:143], v[220:223]
    s_waitcnt lgkmcnt(6)
    v_exp_f32 v60, v74
    v_exp_f32 v61, v75
    v_mfma_f32_16x16x32_bf16 v[216:219], v[108:111], v[136:139], v[216:219]
    ds_read_b128 v[108:111], v48 offset:52224
    v_cvt_pk_bf16_f32 v131, v60, v61
    v_mfma_f32_16x16x32_bf16 v[224:227], v[112:115], v[136:139], v[224:227]
    s_waitcnt lgkmcnt(6)
    v_exp_f32 v58, v76
    v_exp_f32 v59, v77
    v_mfma_f32_16x16x32_bf16 v[228:231], v[112:115], v[140:143], v[228:231]
    ds_read_b128 v[112:115], v48 offset:53248
    v_cvt_pk_bf16_f32 v134, v58, v59
    v_mfma_f32_16x16x32_bf16 v[236:239], v[116:119], v[140:143], v[236:239]
    s_waitcnt lgkmcnt(6)
    v_exp_f32 v60, v78
    v_exp_f32 v61, v79
    v_mfma_f32_16x16x32_bf16 v[232:235], v[116:119], v[136:139], v[232:235]
    ds_read_b128 v[116:119], v48 offset:54272
    v_cvt_pk_bf16_f32 v135, v60, v61
    v_mfma_f32_16x16x32_bf16 v[240:243], v[120:123], v[136:139], v[240:243]
    s_waitcnt lgkmcnt(6)
    v_or3_b32 v62, v128, v129, v132
    v_or3_b32 v62, v62, v133, v130
    v_or3_b32 v62, v62, v131, v134
    v_bitop3_b32 v62, v62, v135, s72 bitop3:0xa8
    v_cmp_ne_u32 vcc, s65, v62
    v_mfma_f32_16x16x32_bf16 v[244:247], v[120:123], v[140:143], v[244:247]
    ds_read_b128 v[120:123], v48 offset:55296
    v_mfma_f32_16x16x32_bf16 v[252:255], v[124:127], v[140:143], v[252:255]
    s_waitcnt lgkmcnt(6)
    v_mfma_f32_16x16x32_bf16 v[248:251], v[124:127], v[136:139], v[248:251]
    ds_read_b128 v[124:127], v48 offset:56320
    s_cbranch_vccnz L_back_16_h
L_back_16:
L_pv2:
    v_mfma_f32_16x16x32_bf16 v[192:195], v[96:99], v[128:131], v[192:195]
    s_waitcnt lgkmcnt(6)
    v_mfma_f32_16x16x32_bf16 v[196:199], v[96:99], v[132:135], v[196:199]
    v_mfma_f32_16x16x32_bf16 v[204:207], v[100:103], v[132:135], v[204:207]
    v_mfma_f32_16x16x32_bf16 v[200:203], v[100:103], v[128:131], v[200:203]
    v_mfma_f32_16x16x32_bf16 v[160:163], v[168:171], v[128:131], v[160:163]
    s_waitcnt lgkmcnt(5)
    v_mfma_f32_16x16x32_bf16 v[164:167], v[168:171], v[132:135], v[164:167]
    v_mfma_f32_16x16x32_bf16 v[208:211], v[104:107], v[128:131], v[208:211]
    s_waitcnt lgkmcnt(4)
    v_mfma_f32_16x16x32_bf16 v[212:215], v[104:107], v[132:135], v[212:215]
    v_mfma_f32_16x16x32_bf16 v[220:223], v[108:111], v[132:135], v[220:223]
    s_waitcnt lgkmcnt(3)
    v_mfma_f32_16x16x32_bf16 v[216:219], v[108:111], v[128:131], v[216:219]
    v_mfma_f32_16x16x32_bf16 v[224:227], v[112:115], v[128:131], v[224:227]
    s_waitcnt lgkmcnt(2)
    v_mfma_f32_16x16x32_bf16 v[228:231], v[112:115], v[132:135], v[228:231]
    v_mfma_f32_16x16x32_bf16 v[236:239], v[116:119], v[132:135], v[236:239]
    s_waitcnt lgkmcnt(1)
    v_mfma_f32_16x16x32_bf16 v[232:235], v[116:119], v[128:131], v[232:235]
    v_mfma_f32_16x16x32_bf16 v[240:243], v[120:123], v[128:131], v[240:243]
    s_waitcnt lgkmcnt(0)
    v_mfma_f32_16x16x32_bf16 v[244:247], v[120:123], v[132:135], v[244:247]
    v_mfma_f32_16x16x32_bf16 v[252:255], v[124:127], v[132:135], v[252:255]
    v_mfma_f32_16x16x32_bf16 v[248:251], v[124:127], v[128:131], v[248:251]
    s_branch L_fin
L_tail2:
    s_mov_b32 s65, 0
    v_mfma_f32_16x16x32_bf16 v[192:195], v[96:99], v[128:131], v[192:195]
    s_waitcnt lgkmcnt(6)
    v_exp_f32 v60, v82
    v_exp_f32 v61, v83
    v_mfma_f32_16x16x32_bf16 v[196:199], v[96:99], v[132:135], v[196:199]
    ds_read_b128 v[96:99], v48 offset:57344
    v_cvt_pk_bf16_f32 v136, v58, v59
    v_cvt_pk_bf16_f32 v137, v60, v61
    v_mfma_f32_16x16x32_bf16 v[204:207], v[100:103], v[132:135], v[204:207]
    v_exp_f32 v58, v84
    v_exp_f32 v59, v85
    v_mfma_f32_16x16x32_bf16 v[200:203], v[100:103], v[128:131], v[200:203]
    ds_read_b128 v[100:103], v48 offset:58368
    v_cvt_pk_bf16_f32 v140, v58, v59
    v_mfma_f32_16x16x32_bf16 v[160:163], v[168:171], v[128:131], v[160:163]
    s_waitcnt lgkmcnt(7)
    v_exp_f32 v60, v86
    v_exp_f32 v61, v87
    v_mfma_f32_16x16x32_bf16 v[164:167], v[168:171], v[132:135], v[164:167]
    v_cvt_pk_bf16_f32 v141, v60, v61
    v_mfma_f32_16x16x32_bf16 v[208:211], v[104:107], v[128:131], v[208:211]
    s_waitcnt lgkmcnt(6)
    v_exp_f32 v58, v88
    v_exp_f32 v59, v89
    v_mfma_f32_16x16x32_bf16 v[212:215], v[104:107], v[132:135], v[212:215]
    ds_read_b128 v[104:107], v48 offset:59392
    v_cvt_pk_bf16_f32 v138, v58, v59
    v_mfma_f32_16x16x32_bf16 v[220:223], v[108:111], v[132:135], v[220:223]
    s_waitcnt lgkmcnt(6)
    v_exp_f32 v60, v90
    v_exp_f32 v61, v91
    v_mfma_f32_16x16x32_bf16 v[216:219], v[108:111], v[128:131], v[216:219]
    ds_read_b128 v[108:111], v48 offset:60416
    v_cvt_pk_bf16_f32 v139, v60, v61
    v_mfma_f32_16x16x32_bf16 v[224:227], v[112:115], v[128:131], v[224:227]
    s_waitcnt lgkmcnt(6)
    v_exp_f32 v58, v92
    v_exp_f32 v59, v93
    v_mfma_f32_16x16x32_bf16 v[228:231], v[112:115], v[132:135], v[228:231]
    ds_read_b128 v[112:115], v48 offset:61440
    v_cvt_pk_bf16_f32 v142, v58, v59
    v_mfma_f32_16x16x32_bf16 v[236:239], v[116:119], v[132:135], v[236:239]
    s_waitcnt lgkmcnt(6)
    v_exp_f32 v60, v94
    v_exp_f32 v61, v95
    v_mfma_f32_16x16x32_bf16 v[232:235], v[116:119], v[128:131], v[232:235]
    ds_read_b128 v[116:119], v48 offset:62464
    v_cvt_pk_bf16_f32 v143, v60, v61
    v_mfma_f32_16x16x32_bf16 v[240:243], v[120:123], v[128:131], v[240:243]
    s_waitcnt lgkmcnt(6)
    v_or3_b32 v62, v136, v137, v140
    v_or3_b32 v62, v62, v141, v138
    v_or3_b32 v62, v62, v139, v142
    v_bitop3_b32 v62, v62, v143, s72 bitop3:0xa8
    v_cmp_ne_u32 vcc, s65, v62
    v_mfma_f32_16x16x32_bf16 v[244:247], v[120:123], v[132:135], v[244:247]
    ds_read_b128 v[120:123], v48 offset:63488
    v_mfma_f32_16x16x32_bf16 v[252:255], v[124:127], v[132:135], v[252:255]
    s_waitcnt lgkmcnt(6)
    v_mfma_f32_16x16x32_bf16 v[248:251], v[124:127], v[128:131], v[248:251]
    ds_read_b128 v[124:127], v48 offset:64512
    s_cbranch_vccnz L_back_17_h
L_back_17:
L_pv3:
    v_mfma_f32_16x16x32_bf16 v[192:195], v[96:99], v[136:139], v[192:195]
    s_waitcnt lgkmcnt(6)
    v_mfma_f32_16x16x32_bf16 v[196:199], v[96:99], v[140:143], v[196:199]
    v_xor_b32 v48, 0x10000, v48
    v_mfma_f32_16x16x32_bf16 v[204:207], v[100:103], v[140:143], v[204:207]
    v_mfma_f32_16x16x32_bf16 v[200:203], v[100:103], v[136:139], v[200:203]
    v_mfma_f32_16x16x32_bf16 v[160:163], v[168:171], v[136:139], v[160:163]
    s_waitcnt lgkmcnt(5)
    v_mfma_f32_16x16x32_bf16 v[164:167], v[168:171], v[140:143], v[164:167]
    s_waitcnt vmcnt(0) lgkmcnt(0)
    s_call_b64 s[82:83], L_pend
    s_barrier
    s_call_b64 s[82:83], L_load
    s_add_i32 s62, s62, 1
    v_mfma_f32_16x16x32_bf16 v[208:211], v[104:107], v[136:139], v[208:211]
    v_mfma_f32_16x16x32_bf16 v[212:215], v[104:107], v[140:143], v[212:215]
    v_mfma_f32_16x16x32_bf16 v[220:223], v[108:111], v[140:143], v[220:223]
    v_mfma_f32_16x16x32_bf16 v[216:219], v[108:111], v[136:139], v[216:219]
    v_mfma_f32_16x16x32_bf16 v[224:227], v[112:115], v[136:139], v[224:227]
    v_mfma_f32_16x16x32_bf16 v[228:231], v[112:115], v[140:143], v[228:231]
    v_mfma_f32_16x16x32_bf16 v[236:239], v[116:119], v[140:143], v[236:239]
    v_mfma_f32_16x16x32_bf16 v[232:235], v[116:119], v[136:139], v[232:235]
    v_mfma_f32_16x16x32_bf16 v[240:243], v[120:123], v[136:139], v[240:243]
    v_mfma_f32_16x16x32_bf16 v[244:247], v[120:123], v[140:143], v[244:247]
    v_mfma_f32_16x16x32_bf16 v[252:255], v[124:127], v[140:143], v[252:255]
    v_mfma_f32_16x16x32_bf16 v[248:251], v[124:127], v[136:139], v[248:251]
    s_branch L_fin
L_tail3:
    s_mov_b32 s65, 0
    v_mfma_f32_16x16x32_bf16 v[192:195], v[96:99], v[136:139], v[192:195]
    s_waitcnt lgkmcnt(6)
    v_exp_f32 v60, v66
    v_exp_f32 v61, v67
    v_mfma_f32_16x16x32_bf16 v[196:199], v[96:99], v[140:143], v[196:199]
    v_cvt_pk_bf16_f32 v128, v58, v59
    v_cvt_pk_bf16_f32 v129, v60, v61
    v_xor_b32 v48, 0x10000, v48
    v_mfma_f32_16x16x32_bf16 v[204:207], v[100:103], v[140:143], v[204:207]
    v_exp_f32 v58, v68
    v_exp_f32 v59, v69
    v_mfma_f32_16x16x32_bf16 v[200:203], v[100:103], v[136:139], v[200:203]
    v_cvt_pk_bf16_f32 v132, v58, v59
    v_mfma_f32_16x16x32_bf16 v[160:163], v[168:171], v[136:139], v[160:163]
    s_waitcnt lgkmcnt(5)
    v_exp_f32 v60, v70
    v_exp_f32 v61, v71
    v_mfma_f32_16x16x32_bf16 v[164:167], v[168:171], v[140:143], v[164:167]
    s_waitcnt vmcnt(0) lgkmcnt(0)
    s_call_b64 s[82:83], L_pend
    s_barrier
    s_call_b64 s[82:83], L_load
    s_add_i32 s62, s62, 1
    ds_read_b128 v[96:99], v48 offset:32768
    ds_read_b128 v[100:103], v48 offset:33792
    v_cvt_pk_bf16_f32 v133, v60, v61
    v_mfma_f32_16x16x32_bf16 v[208:211], v[104:107], v[136:139], v[208:211]
    v_exp_f32 v58, v72
    v_exp_f32 v59, v73
    v_mfma_f32_16x16x32_bf16 v[212:215], v[104:107], v[140:143], v[212:215]
    ds_read_b128 v[104:107], v48 offset:34816
    v_cvt_pk_bf16_f32 v130, v58, v59
    v_mfma_f32_16x16x32_bf16 v[220:223], v[108:111], v[140:143], v[220:223]
    v_exp_f32 v60, v74
    v_exp_f32 v61, v75
    v_mfma_f32_16x16x32_bf16 v[216:219], v[108:111], v[136:139], v[216:219]
    ds_read_b128 v[108:111], v48 offset:35840
    v_cvt_pk_bf16_f32 v131, v60, v61
    v_mfma_f32_16x16x32_bf16 v[224:227], v[112:115], v[136:139], v[224:227]
    v_exp_f32 v58, v76
    v_exp_f32 v59, v77
    v_mfma_f32_16x16x32_bf16 v[228:231], v[112:115], v[140:143], v[228:231]
    ds_read_b128 v[112:115], v48 offset:36864
    v_cvt_pk_bf16_f32 v134, v58, v59
    v_mfma_f32_16x16x32_bf16 v[236:239], v[116:119], v[140:143], v[236:239]
    v_exp_f32 v60, v78
    v_exp_f32 v61, v79
    v_mfma_f32_16x16x32_bf16 v[232:235], v[116:119], v[136:139], v[232:235]
    ds_read_b128 v[116:119], v48 offset:37888
    v_cvt_pk_bf16_f32 v135, v60, v61
    v_mfma_f32_16x16x32_bf16 v[240:243], v[120:123], v[136:139], v[240:243]
    v_or3_b32 v62, v128, v129, v132
    v_or3_b32 v62, v62, v133, v130
    v_or3_b32 v62, v62, v131, v134
    v_bitop3_b32 v62, v62, v135, s72 bitop3:0xa8
    v_cmp_ne_u32 vcc, s65, v62
    v_mfma_f32_16x16x32_bf16 v[244:247], v[120:123], v[140:143], v[244:247]
    ds_read_b128 v[120:123], v48 offset:38912
    v_mfma_f32_16x16x32_bf16 v[252:255], v[124:127], v[140:143], v[252:255]
    s_waitcnt lgkmcnt(6)
    v_mfma_f32_16x16x32_bf16 v[248:251], v[124:127], v[136:139], v[248:251]
    ds_read_b128 v[124:127], v48 offset:39936
    s_cbranch_vccnz L_back_20_h
L_back_20:
L_pv0:
    v_mfma_f32_16x16x32_bf16 v[192:195], v[96:99], v[128:131], v[192:195]
    s_waitcnt lgkmcnt(6)
    v_mfma_f32_16x16x32_bf16 v[196:199], v[96:99], v[132:135], v[196:199]
    v_mfma_f32_16x16x32_bf16 v[204:207], v[100:103], v[132:135], v[204:207]
    v_mfma_f32_16x16x32_bf16 v[200:203], v[100:103], v[128:131], v[200:203]
    v_mfma_f32_16x16x32_bf16 v[160:163], v[168:171], v[128:131], v[160:163]
    s_waitcnt lgkmcnt(5)
    v_mfma_f32_16x16x32_bf16 v[164:167], v[168:171], v[132:135], v[164:167]
    v_mfma_f32_16x16x32_bf16 v[208:211], v[104:107], v[128:131], v[208:211]
    s_waitcnt lgkmcnt(4)
    v_mfma_f32_16x16x32_bf16 v[212:215], v[104:107], v[132:135], v[212:215]
    v_mfma_f32_16x16x32_bf16 v[220:223], v[108:111], v[132:135], v[220:223]
    s_waitcnt lgkmcnt(3)
    v_mfma_f32_16x16x32_bf16 v[216:219], v[108:111], v[128:131], v[216:219]
    v_mfma_f32_16x16x32_bf16 v[224:227], v[112:115], v[128:131], v[224:227]
    s_waitcnt lgkmcnt(2)
    v_mfma_f32_16x16x32_bf16 v[228:231], v[112:115], v[132:135], v[228:231]
    v_mfma_f32_16x16x32_bf16 v[236:239], v[116:119], v[132:135], v[236:239]
    s_waitcnt lgkmcnt(1)
    v_mfma_f32_16x16x32_bf16 v[232:235], v[116:119], v[128:131], v[232:235]
    v_mfma_f32_16x16x32_bf16 v[240:243], v[120:123], v[128:131], v[240:243]
    s_waitcnt lgkmcnt(0)
    v_mfma_f32_16x16x32_bf16 v[244:247], v[120:123], v[132:135], v[244:247]
    v_mfma_f32_16x16x32_bf16 v[252:255], v[124:127], v[132:135], v[252:255]
    v_mfma_f32_16x16x32_bf16 v[248:251], v[124:127], v[128:131], v[248:251]
L_fin:
    v_and_b32 v3, 7, v1
    v_lshlrev_b32 v3, 2, v3
    s_mov_b32 s72, 0x3a0000
    buffer_load_dword v51, v3, s[8:11], s72 offen sc1
    v_rcp_f32 v56, v160
    v_rcp_f32 v57, v164
    s_lshl_b32 s6, s60, 18
    s_lshl_b32 s7, s4, 12
    s_add_u32 s6, s6, s7
    s_add_u32 s6, s6, 50331648
    s_nop 4
    v_mul_f32 v192, v56, v192
    v_mul_f32 v193, v56, v193
    v_mul_f32 v194, v56, v194
    v_mul_f32 v195, v56, v195
    v_cvt_pk_bf16_f32 v16, v192, v193
    v_cvt_pk_bf16_f32 v17, v194, v195
    v_mul_f32 v200, v56, v200
    v_mul_f32 v201, v56, v201
    v_mul_f32 v202, v56, v202
    v_mul_f32 v203, v56, v203
    v_cvt_pk_bf16_f32 v18, v200, v201
    v_cvt_pk_bf16_f32 v19, v202, v203
    buffer_store_dwordx4 v[16:19], v13, s[8:11], s6 offen offset:0 sc1
    v_mul_f32 v208, v56, v208
    v_mul_f32 v209, v56, v209
    v_mul_f32 v210, v56, v210
    v_mul_f32 v211, v56, v211
    v_cvt_pk_bf16_f32 v20, v208, v209
    v_cvt_pk_bf16_f32 v21, v210, v211
    v_mul_f32 v216, v56, v216
    v_mul_f32 v217, v56, v217
    v_mul_f32 v218, v56, v218
    v_mul_f32 v219, v56, v219
    v_cvt_pk_bf16_f32 v22, v216, v217
    v_cvt_pk_bf16_f32 v23, v218, v219
    buffer_store_dwordx4 v[20:23], v13, s[8:11], s6 offen offset:1024 sc1
    v_mul_f32 v224, v56, v224
    v_mul_f32 v225, v56, v225
    v_mul_f32 v226, v56, v226
    v_mul_f32 v227, v56, v227
    v_cvt_pk_bf16_f32 v24, v224, v225
    v_cvt_pk_bf16_f32 v25, v226, v227
    v_mul_f32 v232, v56, v232
    v_mul_f32 v233, v56, v233
    v_mul_f32 v234, v56, v234
    v_mul_f32 v235, v56, v235
    v_cvt_pk_bf16_f32 v26, v232, v233
    v_cvt_pk_bf16_f32 v27, v234, v235
    buffer_store_dwordx4 v[24:27], v13, s[8:11], s6 offen offset:2048 sc1
    v_mul_f32 v240, v56, v240
    v_mul_f32 v241, v56, v241
    v_mul_f32 v242, v56, v242
    v_mul_f32 v243, v56, v243
    v_cvt_pk_bf16_f32 v28, v240, v241
    v_cvt_pk_bf16_f32 v29, v242, v243
    v_mul_f32 v248, v56, v248
    v_mul_f32 v249, v56, v249
    v_mul_f32 v250, v56, v250
    v_mul_f32 v251, v56, v251
    v_cvt_pk_bf16_f32 v30, v248, v249
    v_cvt_pk_bf16_f32 v31, v250, v251
    buffer_store_dwordx4 v[28:31], v13, s[8:11], s6 offen offset:3072 sc1
    s_add_u32 s6, s6, 0x20000
    v_mul_f32 v196, v57, v196
    v_mul_f32 v197, v57, v197
    v_mul_f32 v198, v57, v198
    v_mul_f32 v199, v57, v199
    v_cvt_pk_bf16_f32 v32, v196, v197
    v_cvt_pk_bf16_f32 v33, v198, v199
    v_mul_f32 v204, v57, v204
    v_mul_f32 v205, v57, v205
    v_mul_f32 v206, v57, v206
    v_mul_f32 v207, v57, v207
    v_cvt_pk_bf16_f32 v34, v204, v205
    v_cvt_pk_bf16_f32 v35, v206, v207
    buffer_store_dwordx4 v[32:35], v13, s[8:11], s6 offen offset:0 sc1
    v_mul_f32 v212, v57, v212
    v_mul_f32 v213, v57, v213
    v_mul_f32 v214, v57, v214
    v_mul_f32 v215, v57, v215
    v_cvt_pk_bf16_f32 v36, v212, v213
    v_cvt_pk_bf16_f32 v37, v214, v215
    v_mul_f32 v220, v57, v220
    v_mul_f32 v221, v57, v221
    v_mul_f32 v222, v57, v222
    v_mul_f32 v223, v57, v223
    v_cvt_pk_bf16_f32 v38, v220, v221
    v_cvt_pk_bf16_f32 v39, v222, v223
    buffer_store_dwordx4 v[36:39], v13, s[8:11], s6 offen offset:1024 sc1
    v_mul_f32 v228, v57, v228
    v_mul_f32 v229, v57, v229
    v_mul_f32 v230, v57, v230
    v_mul_f32 v231, v57, v231
    v_cvt_pk_bf16_f32 v40, v228, v229
    v_cvt_pk_bf16_f32 v41, v230, v231
    v_mul_f32 v236, v57, v236
    v_mul_f32 v237, v57, v237
    v_mul_f32 v238, v57, v238
    v_mul_f32 v239, v57, v239
    v_cvt_pk_bf16_f32 v42, v236, v237
    v_cvt_pk_bf16_f32 v43, v238, v239
    buffer_store_dwordx4 v[40:43], v13, s[8:11], s6 offen offset:2048 sc1
    v_mul_f32 v244, v57, v244
    v_mul_f32 v245, v57, v245
    v_mul_f32 v246, v57, v246
    v_mul_f32 v247, v57, v247
    v_cvt_pk_bf16_f32 v44, v244, v245
    v_cvt_pk_bf16_f32 v45, v246, v247
    v_mul_f32 v252, v57, v252
    v_mul_f32 v253, v57, v253
    v_mul_f32 v254, v57, v254
    v_mul_f32 v255, v57, v255
    v_cvt_pk_bf16_f32 v46, v252, v253
    v_cvt_pk_bf16_f32 v47, v254, v255
    buffer_store_dwordx4 v[44:47], v13, s[8:11], s6 offen offset:3072 sc1
    s_cmp_gt_i32 s62, s63
    s_cbranch_scc1 L_pre
    s_waitcnt vmcnt(8)
    s_call_b64 s[82:83], L_pend
    s_barrier
    s_waitcnt vmcnt(0)
    s_lshl_b32 s6, s60, 5
    s_add_u32 s6, s6, s4
    s_lshl_b32 s6, s6, 7
    s_add_u32 s6, s6, 3932160
    v_mov_b32 v2, 1
    v_mov_b32 v3, 0x5000000
    v_writelane_b32 v3, s6, 0
    buffer_store_dword v2, v3, s[8:11], 0 offen sc1
    s_call_b64 s[82:83], L_load
    s_add_i32 s62, s62, 1
    s_lshl_b32 s6, s3, 8
    s_add_u32 s6, s6, s2
    s_cmp_eq_u32 s6, 31
    s_cbranch_scc1 L_top
L_idle:
    s_sub_i32 s6, s63, 5
    s_cmp_gt_i32 s62, s6
    s_cbranch_scc1 L_pre
    s_waitcnt vmcnt(0) lgkmcnt(0)
    s_call_b64 s[82:83], L_pend
    s_barrier
    s_call_b64 s[82:83], L_load
    s_add_i32 s62, s62, 1
    s_cmp_lt_u32 s61, 54
    s_cbranch_scc1 L_moe
    s_branch L_idle
L_pre:
    s_cmp_lt_u32 s3, 4
    s_cbranch_scc1 L_pre1
    s_barrier
    s_lshl_b32 s7, s76, 13
    s_add_u32 s7, s7, 0x10000
    v_add_u32 v3, s7, v13
    v_add_u32 v2, 0x10000, v3
    s_lshl_b32 s7, s76, 12
    s_add_u32 s7, s7, 0x10000
    v_add_u32 v12, s7, v13
    ds_read_b128 v[96:99], v2 offset:0
    ds_read_b128 v[100:103], v2 offset:1024
    ds_read_b128 v[104:107], v2 offset:2048
    ds_read_b128 v[108:111], v2 offset:3072
    ds_read_b128 v[112:115], v2 offset:4096
    ds_read_b128 v[116:119], v2 offset:5120
    ds_read_b128 v[120:123], v2 offset:6144
    ds_read_b128 v[124:127], v2 offset:7168
    ds_read_b128 v[128:131], v3 offset:0
    ds_read_b128 v[132:135], v3 offset:1024
    ds_read_b128 v[136:139], v3 offset:2048
    ds_read_b128 v[140:143], v3 offset:3072
    s_add_u32 s6, s76, 0
    s_and_b32 s6, s6, 3
    s_lshl_b32 s6, s6, 10
    v_add_u32 v44, s6, v13
    s_add_u32 s6, s76, 1
    s_and_b32 s6, s6, 3
    s_lshl_b32 s6, s6, 10
    v_add_u32 v45, s6, v13
    s_add_u32 s6, s76, 2
    s_and_b32 s6, s6, 3
    s_lshl_b32 s6, s6, 10
    v_add_u32 v46, s6, v13
    s_add_u32 s6, s76, 3
    s_and_b32 s6, s6, 3
    s_lshl_b32 s6, s6, 10
    v_add_u32 v47, s6, v13
    v_add_u32 v52, 4096, v13
    s_lshr_b32 s69, s4, 3
    s_lshl_b32 s69, s69, 2
    s_add_u32 s69, s69, s76
    s_mul_i32 s69, s69, 327680
    s_and_b32 s7, s4, 3
    s_mul_i32 s7, s7, 10240
    s_add_u32 s69, s69, s7
    s_add_u32 s69, s69, 4199424
    s_and_b32 s6, s4, 4
    s_lshr_b32 s7, s4, 3
    s_add_u32 s6, s6, s7
    s_lshl_b32 s7, s5, 3
    s_add_u32 s68, s6, s7
    s_sub_u32 s7, 120, s7
    s_add_u32 s61, s6, s7
    s_lshr_b32 s6, s4, 3
    s_lshl_b32 s6, s6, 15
    s_lshl_b32 s99, s3, 12
    s_add_u32 s66, s6, s99
    s_add_u32 s66, s66, 50331648
    s_lshl_b32 s6, s76, 13
    v_add_u32 v4, s6, v13
    v_add_u32 v7, 65536, v4
    ds_read_b128 v[144:147], v3 offset:4096
    ds_read_b128 v[148:151], v3 offset:5120
    ds_read_b128 v[152:155], v3 offset:6144
    ds_read_b128 v[156:159], v3 offset:7168
    ds_read_b128 v[160:163], v12 offset:49152
    ds_read_b128 v[164:167], v12 offset:50176
    ds_read_b128 v[168:171], v12 offset:51200
    ds_read_b128 v[172:175], v12 offset:52224
    s_add_u32 s75, s69, 163840
    buffer_load_dwordx4 v[176:179], v44, s[8:11], s75 offen sc1
    buffer_load_dwordx4 v[180:183], v45, s[8:11], s75 offen sc1
    buffer_load_dwordx4 v[184:187], v46, s[8:11], s75 offen sc1
    buffer_load_dwordx4 v[188:191], v47, s[8:11], s75 offen sc1
    buffer_load_dwordx4 v[192:195], v52, s[8:11], s75 offen sc1
    s_waitcnt vmcnt(5)
    s_lshl_b32 s6, s60, 5
    s_add_u32 s6, s6, s4
    s_lshl_b32 s6, s6, 7
    s_add_u32 s6, s6, 3932160
    v_mov_b32 v2, 1
    v_mov_b32 v3, 0x5000000
    v_writelane_b32 v3, s6, 0
    buffer_store_dword v2, v3, s[8:11], 0 offen sc1
    s_add_u32 s75, s69, 204800
    buffer_load_dwordx4 v[196:199], v44, s[8:11], s75 offen sc1
    buffer_load_dwordx4 v[200:203], v45, s[8:11], s75 offen sc1
    buffer_load_dwordx4 v[204:207], v46, s[8:11], s75 offen sc1
    buffer_load_dwordx4 v[208:211], v47, s[8:11], s75 offen sc1
    buffer_load_dwordx4 v[212:215], v52, s[8:11], s75 offen sc1
    s_add_u32 s75, s69, 245760
    buffer_load_dwordx4 v[216:219], v44, s[8:11], s75 offen sc1
    buffer_load_dwordx4 v[220:223], v45, s[8:11], s75 offen sc1
    buffer_load_dwordx4 v[224:227], v46, s[8:11], s75 offen sc1
    buffer_load_dwordx4 v[228:231], v47, s[8:11], s75 offen sc1
    buffer_load_dwordx4 v[232:235], v52, s[8:11], s75 offen sc1
    s_add_u32 s75, s69, 286720
    buffer_load_dwordx4 v[236:239], v44, s[8:11], s75 offen sc1
    buffer_load_dwordx4 v[240:243], v45, s[8:11], s75 offen sc1
    buffer_load_dwordx4 v[244:247], v46, s[8:11], s75 offen sc1
    buffer_load_dwordx4 v[248:251], v47, s[8:11], s75 offen sc1
    buffer_load_dwordx4 v[252:255], v52, s[8:11], s75 offen sc1
    s_waitcnt lgkmcnt(0)
    s_barrier
    s_branch L_adone
L_pre1:
    s_mov_b32 s28, s56
    s_mov_b32 s29, s57
    s_mov_b32 s30, 0x100
    s_mov_b32 s31, 0x20000
    v_and_b32 v3, 31, v1
    v_lshlrev_b32 v3, 2, v3
    s_mov_b32 s79, 262144
L_poll_23:
    buffer_load_dword v2, v3, s[28:31], 0 offen offset:128 sc1
    s_waitcnt vmcnt(0)
    v_cmp_gt_u32 vcc, 4, v2
    s_cbranch_vccz L_polldone_24
    s_sleep 8
    s_sub_u32 s79, s79, 1
    s_cmp_lg_u32 s79, 0
    s_cbranch_scc1 L_poll_23
L_polldone_24:
    s_mov_b32 s90, 1
    v_and_b32 v3, 7, v1
    v_lshlrev_b32 v3, 2, v3
    s_mov_b32 s72, 0x3a0000
    buffer_load_dword v51, v3, s[8:11], s72 offen sc1
    s_add_u32 s6, s76, 0
    s_and_b32 s6, s6, 3
    s_lshl_b32 s6, s6, 10
    v_add_u32 v44, s6, v13
    s_add_u32 s6, s76, 1
    s_and_b32 s6, s6, 3
    s_lshl_b32 s6, s6, 10
    v_add_u32 v45, s6, v13
    s_add_u32 s6, s76, 2
    s_and_b32 s6, s6, 3
    s_lshl_b32 s6, s6, 10
    v_add_u32 v46, s6, v13
    s_add_u32 s6, s76, 3
    s_and_b32 s6, s6, 3
    s_lshl_b32 s6, s6, 10
    v_add_u32 v47, s6, v13
    v_add_u32 v52, 4096, v13
    s_lshr_b32 s69, s4, 3
    s_lshl_b32 s69, s69, 2
    s_add_u32 s69, s69, s76
    s_mul_i32 s69, s69, 327680
    s_and_b32 s7, s4, 3
    s_mul_i32 s7, s7, 10240
    s_add_u32 s69, s69, s7
    s_add_u32 s69, s69, 4194304
    s_and_b32 s6, s4, 4
    s_lshr_b32 s7, s4, 3
    s_add_u32 s6, s6, s7
    s_lshl_b32 s7, s5, 3
    s_add_u32 s68, s6, s7
    s_sub_u32 s7, 120, s7
    s_add_u32 s61, s6, s7
    s_add_u32 s75, s69, 0
    buffer_load_dwordx4 v[96:99], v44, s[8:11], s75 offen sc1
    buffer_load_dwordx4 v[100:103], v45, s[8:11], s75 offen sc1
    buffer_load_dwordx4 v[104:107], v46, s[8:11], s75 offen sc1
    buffer_load_dwordx4 v[108:111], v47, s[8:11], s75 offen sc1
    buffer_load_dwordx4 v[112:115], v52, s[8:11], s75 offen sc1
    s_add_u32 s75, s69, 40960
    buffer_load_dwordx4 v[116:119], v44, s[8:11], s75 offen sc1
    buffer_load_dwordx4 v[120:123], v45, s[8:11], s75 offen sc1
    buffer_load_dwordx4 v[124:127], v46, s[8:11], s75 offen sc1
    buffer_load_dwordx4 v[128:131], v47, s[8:11], s75 offen sc1
    buffer_load_dwordx4 v[132:135], v52, s[8:11], s75 offen sc1
    s_cmp_gt_i32 s62, s63
    s_cbranch_scc1 L_e2
    s_cmp_eq_i32 s62, s63
    s_cbranch_scc1 L_lw0
    s_waitcnt vmcnt(11)
L_lw0:
    s_waitcnt vmcnt(20)
    s_call_b64 s[82:83], L_pend
    s_barrier
    s_call_b64 s[82:83], L_load
    s_add_i32 s62, s62, 1
L_e2:
    s_add_u32 s75, s69, 81920
    buffer_load_dwordx4 v[136:139], v44, s[8:11], s75 offen sc1
    buffer_load_dwordx4 v[140:143], v45, s[8:11], s75 offen sc1
    buffer_load_dwordx4 v[144:147], v46, s[8:11], s75 offen sc1
    buffer_load_dwordx4 v[148:151], v47, s[8:11], s75 offen sc1
    buffer_load_dwordx4 v[152:155], v52, s[8:11], s75 offen sc1
    s_add_u32 s75, s69, 122880
    buffer_load_dwordx4 v[156:159], v44, s[8:11], s75 offen sc1
    buffer_load_dwordx4 v[160:163], v45, s[8:11], s75 offen sc1
    buffer_load_dwordx4 v[164:167], v46, s[8:11], s75 offen sc1
    buffer_load_dwordx4 v[168:171], v47, s[8:11], s75 offen sc1
    buffer_load_dwordx4 v[172:175], v52, s[8:11], s75 offen sc1
    s_cmp_gt_i32 s62, s63
    s_cbranch_scc1 L_e3
    s_cmp_eq_i32 s62, s63
    s_cbranch_scc1 L_lw1
    s_waitcnt vmcnt(10)
L_lw1:
    s_waitcnt vmcnt(20)
    s_call_b64 s[82:83], L_pend
    s_barrier
    s_call_b64 s[82:83], L_load
    s_add_i32 s62, s62, 1
L_e3:
    s_add_u32 s75, s69, 163840
    buffer_load_dwordx4 v[176:179], v44, s[8:11], s75 offen sc1
    buffer_load_dwordx4 v[180:183], v45, s[8:11], s75 offen sc1
    buffer_load_dwordx4 v[184:187], v46, s[8:11], s75 offen sc1
    buffer_load_dwordx4 v[188:191], v47, s[8:11], s75 offen sc1
    buffer_load_dwordx4 v[192:195], v52, s[8:11], s75 offen sc1
    s_add_u32 s75, s69, 204800
    buffer_load_dwordx4 v[196:199], v44, s[8:11], s75 offen sc1
    buffer_load_dwordx4 v[200:203], v45, s[8:11], s75 offen sc1
    buffer_load_dwordx4 v[204:207], v46, s[8:11], s75 offen sc1
    buffer_load_dwordx4 v[208:211], v47, s[8:11], s75 offen sc1
    buffer_load_dwordx4 v[212:215], v52, s[8:11], s75 offen sc1
    s_cmp_gt_i32 s62, s63
    s_cbranch_scc1 L_e4
    s_cmp_eq_i32 s62, s63
    s_cbranch_scc1 L_lw2
    s_waitcnt vmcnt(10)
L_lw2:
    s_waitcnt vmcnt(20)
    s_call_b64 s[82:83], L_pend
    s_barrier
    s_call_b64 s[82:83], L_load
    s_add_i32 s62, s62, 1
L_e4:
    s_lshr_b32 s7, s3, 1
    s_lshl_b32 s7, s7, 4
    s_add_u32 s6, s5, s7
    s_cmp_lg_u32 s6, 3
    s_cbranch_scc1 L_yl0
    v_min_u32 v3, 53, v1
    v_lshlrev_b32 v3, 7, v3
    s_mov_b32 s72, 0xf20000
    buffer_load_dwordx4 v[16:19], v3, s[8:11], s72 offen sc1
L_yl0:
    s_add_u32 s75, s69, 245760
    buffer_load_dwordx4 v[216:219], v44, s[8:11], s75 offen sc1
    buffer_load_dwordx4 v[220:223], v45, s[8:11], s75 offen sc1
    buffer_load_dwordx4 v[224:227], v46, s[8:11], s75 offen sc1
    buffer_load_dwordx4 v[228:231], v47, s[8:11], s75 offen sc1
    buffer_load_dwordx4 v[232:235], v52, s[8:11], s75 offen sc1
    s_add_u32 s75, s69, 286720
    buffer_load_dwordx4 v[236:239], v44, s[8:11], s75 offen sc1
    buffer_load_dwordx4 v[240:243], v45, s[8:11], s75 offen sc1
    buffer_load_dwordx4 v[244:247], v46, s[8:11], s75 offen sc1
    buffer_load_dwordx4 v[248:251], v47, s[8:11], s75 offen sc1
    buffer_load_dwordx4 v[252:255], v52, s[8:11], s75 offen sc1
    s_cmp_gt_i32 s62, s63
    s_cbranch_scc1 L_e5
    s_cmp_eq_i32 s62, s63
    s_cbranch_scc1 L_lw3
    s_waitcnt vmcnt(10)
L_lw3:
    s_waitcnt vmcnt(20)
    s_call_b64 s[82:83], L_pend
    s_barrier
    s_call_b64 s[82:83], L_load
    s_add_i32 s62, s62, 1
L_e5:
    s_mov_b32 s101, 0
    s_lshr_b32 s7, s3, 1
    s_lshl_b32 s7, s7, 4
    s_add_u32 s6, s5, s7
    s_cmp_lg_u32 s6, 3
    s_cbranch_scc1 L_yl1
    v_and_b32 v16, v16, v17
    v_and_b32 v16, v16, v18
    v_and_b32 v16, v16, v19
    v_cmp_ne_u32 vcc, 1, v16
    s_cbranch_vccnz L_yl1
    s_call_b64 s[80:81], L_yld
L_yl1:
    v_and_b32 v3, 1, v1
    v_lshlrev_b32 v3, 12, v3
    v_and_b32 v2, 2, v1
    v_lshl_add_u32 v3, v2, 8, v3
    s_lshr_b32 s72, s68, 2
    s_lshl_b32 s72, s72, 6
    s_andn2_b32 s6, s4, 7
    s_add_u32 s72, s72, s6
    s_add_u32 s72, s72, s3
    s_lshl_b32 s72, s72, 7
    s_add_u32 s72, s72, 3932160
    buffer_load_dword v50, v3, s[8:11], s72 offen sc1
    s_cmp_gt_i32 s62, s63
    s_cbranch_scc1 L_e6
    s_waitcnt vmcnt(20)
    s_call_b64 s[82:83], L_pend
    s_barrier
    s_call_b64 s[82:83], L_load
    s_add_i32 s62, s62, 1
L_e6:
    s_lshr_b32 s7, s3, 1
    s_lshl_b32 s7, s7, 4
    s_add_u32 s6, s5, s7
    s_cmp_lg_u32 s6, 3
    s_cbranch_scc1 L_yd
    s_cmp_lg_u32 s101, 0
    s_cbranch_scc1 L_yf
    v_min_u32 v3, 53, v1
    v_lshlrev_b32 v3, 7, v3
    s_mov_b32 s72, 0xf20000
    s_mov_b32 s79, 262144
L_poll_30:
    buffer_load_dwordx4 v[16:19], v3, s[8:11], s72 offen sc1
    s_waitcnt vmcnt(0)
    v_and_b32 v16, v16, v17
    v_and_b32 v16, v16, v18
    v_and_b32 v16, v16, v19
    v_cmp_ne_u32 vcc, 1, v16
    s_cbranch_vccz L_polldone_31
    s_sleep 16
    s_sub_u32 s79, s79, 1
    s_cmp_lg_u32 s79, 0
    s_cbranch_scc1 L_poll_30
L_polldone_31:
    s_call_b64 s[80:81], L_yld
L_yf:
    s_bfe_u32 s6, s98, 0x10000b
    s_xor_b32 s7, s6, 0xffff
    s_bitcmp1_b32 s6, 15
    s_bitset0_b32 s6, 15
    s_cselect_b32 s6, s6, s7
    s_lshl_b32 s6, s6, 16
    v_mov_b32 v9, s6
    v_mul_f32 v9, 0xbfb8aa3b, v9
    v_exp_f32 v9, v9
    s_nop 0
    v_add_f32 v9, 1.0, v9
    v_rcp_f32 v9, v9
    s_nop 0
    v_cvt_pk_bf16_f32 v9, v9, v9
    v_lshlrev_b32 v9, 16, v9
    v_lshlrev_b32 v10, 2, v1
    v_mov_b32 v3, 0x5000000
    s_waitcnt vmcnt(0)
    v_pk_add_f32 v[16:17], v[16:17], v[20:21]
    v_pk_add_f32 v[18:19], v[18:19], v[22:23]
    v_pk_add_f32 v[16:17], v[16:17], v[24:25]
    v_pk_add_f32 v[18:19], v[18:19], v[26:27]
    v_pk_add_f32 v[16:17], v[16:17], v[28:29]
    v_pk_add_f32 v[18:19], v[18:19], v[30:31]
    v_pk_add_f32 v[16:17], v[16:17], v[32:33]
    v_pk_add_f32 v[18:19], v[18:19], v[34:35]
    v_pk_add_f32 v[16:17], v[16:17], v[36:37]
    v_pk_add_f32 v[18:19], v[18:19], v[38:39]
    v_pk_add_f32 v[16:17], v[16:17], v[40:41]
    v_pk_add_f32 v[18:19], v[18:19], v[42:43]
    v_pk_add_f32 v[16:17], v[16:17], v[56:57]
    v_pk_add_f32 v[18:19], v[18:19], v[58:59]
    v_pk_add_f32 v[16:17], v[16:17], v[60:61]
    v_pk_add_f32 v[18:19], v[18:19], v[62:63]
    v_pk_add_f32 v[16:17], v[16:17], v[64:65]
    v_pk_add_f32 v[18:19], v[18:19], v[66:67]
    v_pk_add_f32 v[16:17], v[16:17], v[68:69]
    v_pk_add_f32 v[18:19], v[18:19], v[70:71]
    v_pk_add_f32 v[16:17], v[16:17], v[72:73]
    v_pk_add_f32 v[18:19], v[18:19], v[74:75]
    v_pk_add_f32 v[16:17], v[16:17], v[76:77]
    v_pk_add_f32 v[18:19], v[18:19], v[78:79]
    v_pk_add_f32 v[16:17], v[16:17], v[80:81]
    v_pk_add_f32 v[18:19], v[18:19], v[82:83]
    v_pk_add_f32 v[16:17], v[16:17], v[84:85]
    v_pk_add_f32 v[18:19], v[18:19], v[86:87]
    v_pk_add_f32 v[16:17], v[16:17], v[88:89]
    v_pk_add_f32 v[18:19], v[18:19], v[90:91]
    v_pk_add_f32 v[16:17], v[16:17], v[92:93]
    v_pk_add_f32 v[18:19], v[18:19], v[94:95]
    v_pk_add_f32 v[16:17], v[16:17], v[4:5]
    v_pk_add_f32 v[18:19], v[18:19], v[6:7]
    ds_bpermute_b32 v20, v10, v16 offset:80
    ds_bpermute_b32 v21, v10, v17 offset:80
    ds_bpermute_b32 v22, v10, v18 offset:80
    ds_bpermute_b32 v23, v10, v19 offset:80
    ds_bpermute_b32 v24, v10, v16 offset:160
    ds_bpermute_b32 v25, v10, v17 offset:160
    ds_bpermute_b32 v26, v10, v18 offset:160
    ds_bpermute_b32 v27, v10, v19 offset:160
    s_waitcnt lgkmcnt(0)
    v_add_f32 v16, v16, v20
    v_add_f32 v16, v16, v24
    v_cvt_pk_bf16_f32 v16, v16, v16
    v_lshlrev_b32 v16, 16, v16
    v_mul_f32 v16, v16, v9
    v_cvt_pk_bf16_f32 v16, v16, v16
    v_lshlrev_b32 v16, 16, v16
    v_lshlrev_b32 v8, 16, v54
    v_add_f32 v16, v16, v8
    v_add_f32 v17, v17, v21
    v_add_f32 v17, v17, v25
    v_cvt_pk_bf16_f32 v17, v17, v17
    v_lshlrev_b32 v17, 16, v17
    v_mul_f32 v17, v17, v9
    v_cvt_pk_bf16_f32 v17, v17, v17
    v_lshlrev_b32 v17, 16, v17
    v_and_b32 v8, 0xffff0000, v54
    v_add_f32 v17, v17, v8
    v_add_f32 v18, v18, v22
    v_add_f32 v18, v18, v26
    v_cvt_pk_bf16_f32 v18, v18, v18
    v_lshlrev_b32 v18, 16, v18
    v_mul_f32 v18, v18, v9
    v_cvt_pk_bf16_f32 v18, v18, v18
    v_lshlrev_b32 v18, 16, v18
    v_lshlrev_b32 v8, 16, v55
    v_add_f32 v18, v18, v8
    v_add_f32 v19, v19, v23
    v_add_f32 v19, v19, v27
    v_cvt_pk_bf16_f32 v19, v19, v19
    v_lshlrev_b32 v19, 16, v19
    v_mul_f32 v19, v19, v9
    v_cvt_pk_bf16_f32 v19, v19, v19
    v_lshlrev_b32 v19, 16, v19
    v_and_b32 v8, 0xffff0000, v55
    v_add_f32 v19, v19, v8
    v_cvt_pk_bf16_f32 v20, v16, v17
    v_cvt_pk_bf16_f32 v21, v18, v19
    v_lshlrev_b32 v2, 3, v1
    v_cmp_lt_u32 vcc, 19, v1
    s_mul_i32 s6, s96, 1280
    s_mul_i32 s7, s97, 160
    v_cndmask_b32 v2, v2, v3, vcc
    s_add_u32 s6, s6, s7
    s_add_u32 s6, s6, 3837952
    buffer_store_dwordx2 v[20:21], v2, s[8:11], s6 offen sc1
L_yd:
    s_lshr_b32 s6, s4, 3
    s_lshl_b32 s6, s6, 15
    s_lshl_b32 s99, s3, 12
    s_add_u32 s66, s6, s99
    s_add_u32 s66, s66, 50331648
    s_lshl_b32 s6, s76, 13
    v_add_u32 v4, s6, v13
    v_add_u32 v7, 65536, v4
    s_waitcnt vmcnt(0)
    v_cmp_ne_u32 vcc, 1, v50
    s_cbranch_vccz L_ce
    v_and_b32 v3, 1, v1
    v_lshlrev_b32 v3, 12, v3
    v_and_b32 v2, 2, v1
    v_lshl_add_u32 v3, v2, 8, v3
    s_lshr_b32 s72, s68, 2
    s_lshl_b32 s72, s72, 6
    s_andn2_b32 s6, s4, 7
    s_add_u32 s72, s72, s6
    s_add_u32 s72, s72, s3
    s_lshl_b32 s72, s72, 7
    s_add_u32 s72, s72, 3932160
    s_mov_b32 s79, 262144
L_poll_32:
    buffer_load_dword v2, v3, s[8:11], s72 offen sc1
    s_waitcnt vmcnt(0)
    v_cmp_ne_u32 vcc, 1, v2
    s_cbranch_vccz L_polldone_33
    s_sleep 4
    s_sub_u32 s79, s79, 1
    s_cmp_lg_u32 s79, 0
    s_cbranch_scc1 L_poll_32
L_polldone_33:
L_ce:
    s_add_u32 s65, s68, 1
    s_and_b32 s65, s65, 3
    s_andn2_b32 s7, s68, 3
    s_add_u32 s65, s65, s7
    s_lshl_b32 s65, s65, 17
    s_add_u32 s65, s65, s66
    s_add_u32 m0, s99, 0
    s_add_u32 s65, s65, 0
    buffer_load_dwordx4 v13, s[8:11], s65 offen offset:0 sc1 lds
    buffer_load_dwordx4 v13, s[8:11], s65 offen offset:1024 sc1 lds
    buffer_load_dwordx4 v13, s[8:11], s65 offen offset:2048 sc1 lds
    buffer_load_dwordx4 v13, s[8:11], s65 offen offset:3072 sc1 lds
    s_add_u32 s65, s68, 1
    s_and_b32 s65, s65, 3
    s_andn2_b32 s7, s68, 3
    s_add_u32 s65, s65, s7
    s_lshl_b32 s65, s65, 17
    s_add_u32 s65, s65, s66
    s_add_u32 m0, s99, 16384
    s_add_u32 s65, s65, 16384
    buffer_load_dwordx4 v13, s[8:11], s65 offen offset:0 sc1 lds
    buffer_load_dwordx4 v13, s[8:11], s65 offen offset:1024 sc1 lds
    buffer_load_dwordx4 v13, s[8:11], s65 offen offset:2048 sc1 lds
    buffer_load_dwordx4 v13, s[8:11], s65 offen offset:3072 sc1 lds
    s_add_u32 s65, s68, 2
    s_and_b32 s65, s65, 3
    s_andn2_b32 s7, s68, 3
    s_add_u32 s65, s65, s7
    s_lshl_b32 s65, s65, 17
    s_add_u32 s65, s65, s66
    s_add_u32 m0, s99, 32768
    s_add_u32 s65, s65, 0
    buffer_load_dwordx4 v13, s[8:11], s65 offen offset:0 sc1 lds
    buffer_load_dwordx4 v13, s[8:11], s65 offen offset:1024 sc1 lds
    buffer_load_dwordx4 v13, s[8:11], s65 offen offset:2048 sc1 lds
    buffer_load_dwordx4 v13, s[8:11], s65 offen offset:3072 sc1 lds
    s_add_u32 s65, s68, 2
    s_and_b32 s65, s65, 3
    s_andn2_b32 s7, s68, 3
    s_add_u32 s65, s65, s7
    s_lshl_b32 s65, s65, 17
    s_add_u32 s65, s65, s66
    s_add_u32 m0, s99, 49152
    s_add_u32 s65, s65, 16384
    buffer_load_dwordx4 v13, s[8:11], s65 offen offset:0 sc1 lds
    buffer_load_dwordx4 v13, s[8:11], s65 offen offset:1024 sc1 lds
    buffer_load_dwordx4 v13, s[8:11], s65 offen offset:2048 sc1 lds
    buffer_load_dwordx4 v13, s[8:11], s65 offen offset:3072 sc1 lds
    s_lshr_b32 s7, s3, 1
    s_lshl_b32 s7, s7, 4
    s_add_u32 s6, s5, s7
    s_cmp_lg_u32 s6, 3
    s_cbranch_scc1 L_yg
    s_lshl_b32 s6, s5, 5
    s_add_u32 s6, s6, s4
    s_lshl_b32 s6, s6, 5
    s_add_u32 s6, s6, s3
    s_lshl_b32 s6, s6, 2
    s_add_u32 s6, s6, 3899392
    v_mov_b32 v2, 1
    v_mov_b32 v3, 0x5000000
    v_writelane_b32 v3, s6, 0
    buffer_store_dword v2, v3, s[8:11], 0 offen sc1
    s_waitcnt vmcnt(1)
    s_branch L_ye
L_yg:
    s_waitcnt vmcnt(0)
L_ye:
    s_setprio 0
    s_barrier
    s_branch L_adone
L_yld:
    v_cmp_le_i32 vcc, 0, v51
    s_cbranch_vccz L_idx_oka
    v_and_b32 v3, 7, v1
    v_lshlrev_b32 v3, 2, v3
    s_mov_b32 s72, 0x3a0000
    s_mov_b32 s79, 262144
L_poll_34:
    buffer_load_dword v51, v3, s[8:11], s72 offen sc1
    s_waitcnt vmcnt(0)
    v_cmp_le_i32 vcc, 0, v51
    s_cbranch_vccz L_polldone_35
    s_sleep 2
    s_sub_u32 s79, s79, 1
    s_cmp_lg_u32 s79, 0
    s_cbranch_scc1 L_poll_34
L_polldone_35:
L_idx_oka:
    s_lshr_b32 s96, s4, 2
    s_and_b32 s97, s4, 3
    s_lshl_b32 s97, s97, 1
    s_add_u32 s97, s97, s3
    s_mov_b32 m0, s96
    s_nop 3
    v_readlane_b32 s98, v51, m0
    s_nop 3
    s_and_b32 s100, s98, 0x7ff
    s_sub_u32 s100, 0x7ff, s100
    v_mul_u32_u24 v2, 13, v1
    v_lshrrev_b32 v2, 8, v2
    v_mul_u32_u24 v3, 20, v2
    v_sub_u32 v8, v1, v3
    s_mov_b32 s6, 368640
    v_mul_lo_u32 v2, v2, s6
    v_lshl_add_u32 v2, v8, 4, v2
    v_cmp_lt_u32 vcc, 59, v1
    v_mov_b32 v3, 0x5000000
    s_nop 0
    v_cndmask_b32 v2, v2, v3, vcc
    s_mul_i32 s6, s96, 2560
    s_mul_i32 s7, s97, 320
    s_add_u32 s6, s6, s7
    s_add_u32 s6, s6, 2686976
    buffer_load_dwordx4 v[16:19], v2, s[8:11], s6 offen sc1
    s_add_u32 s6, s6, 20480
    buffer_load_dwordx4 v[20:23], v2, s[8:11], s6 offen sc1
    s_add_u32 s6, s6, 20480
    buffer_load_dwordx4 v[24:27], v2, s[8:11], s6 offen sc1
    s_add_u32 s6, s6, 20480
    buffer_load_dwordx4 v[28:31], v2, s[8:11], s6 offen sc1
    s_add_u32 s6, s6, 20480
    buffer_load_dwordx4 v[32:35], v2, s[8:11], s6 offen sc1
    s_add_u32 s6, s6, 20480
    buffer_load_dwordx4 v[36:39], v2, s[8:11], s6 offen sc1
    s_add_u32 s6, s6, 20480
    buffer_load_dwordx4 v[40:43], v2, s[8:11], s6 offen sc1
    s_add_u32 s6, s6, 20480
    buffer_load_dwordx4 v[56:59], v2, s[8:11], s6 offen sc1
    s_add_u32 s6, s6, 20480
    buffer_load_dwordx4 v[60:63], v2, s[8:11], s6 offen sc1
    s_add_u32 s6, s6, 20480
    buffer_load_dwordx4 v[64:67], v2, s[8:11], s6 offen sc1
    s_add_u32 s6, s6, 20480
    buffer_load_dwordx4 v[68:71], v2, s[8:11], s6 offen sc1
    s_add_u32 s6, s6, 20480
    buffer_load_dwordx4 v[72:75], v2, s[8:11], s6 offen sc1
    s_add_u32 s6, s6, 20480
    buffer_load_dwordx4 v[76:79], v2, s[8:11], s6 offen sc1
    s_add_u32 s6, s6, 20480
    buffer_load_dwordx4 v[80:83], v2, s[8:11], s6 offen sc1
    s_add_u32 s6, s6, 20480
    buffer_load_dwordx4 v[84:87], v2, s[8:11], s6 offen sc1
    s_add_u32 s6, s6, 20480
    buffer_load_dwordx4 v[88:91], v2, s[8:11], s6 offen sc1
    s_add_u32 s6, s6, 20480
    buffer_load_dwordx4 v[92:95], v2, s[8:11], s6 offen sc1
    s_add_u32 s6, s6, 20480
    buffer_load_dwordx4 v[4:7], v2, s[8:11], s6 offen sc1
    s_add_u32 s6, s6, 20480
    s_lshr_b32 s6, s100, 4
    s_mul_i32 s6, s6, 20480
    s_and_b32 s7, s100, 15
    s_lshl_b32 s7, s7, 4
    s_add_u32 s6, s6, s7
    s_mul_i32 s7, s97, 2560
    s_add_u32 s6, s6, s7
    v_lshrrev_b32 v9, 1, v8
    v_lshlrev_b32 v9, 8, v9
    v_and_b32 v10, 1, v8
    v_lshl_add_u32 v9, v10, 3, v9
    buffer_load_dwordx2 v[54:55], v9, s[8:11], s6 offen sc1
    s_mov_b32 s101, 1
    s_setpc_b64 s[80:81]
L_moe:
    s_sub_u32 s6, s62, s5
    s_cmp_lg_u32 s6, 3
    s_cbranch_scc1 L_idle
    s_mov_b32 s12, s48
    s_mov_b32 s13, s49
    s_mov_b32 s14, 0x21c000
    s_mov_b32 s15, 0x20000
    s_cmp_ge_u32 s3, 2
    s_cselect_b32 s12, s50, s12
    s_cselect_b32 s13, s51, s13
    s_mov_b32 s16, s52
    s_mov_b32 s17, s53
    s_mov_b32 s18, 0x21c000
    s_mov_b32 s19, 0x20000
    v_lshrrev_b32 v3, 2, v1
    v_mul_u32_u24 v3, 3456, v3
    v_and_b32 v4, 3, v1
    v_lshl_add_u32 v16, v4, 4, v3
    v_lshrrev_b32 v3, 3, v1
    v_mul_u32_u24 v3, 1280, v3
    v_and_b32 v4, 7, v1
    v_lshl_add_u32 v18, v4, 4, v3
    s_and_b32 s7, s3, 1
    s_mul_i32 s84, s7, 1105920
    s_lshl_b32 s6, s61, 6
    s_add_u32 s84, s84, s6
    s_lshl_b32 s85, s3, 13
    s_add_u32 s85, s85, 131072
    s_mul_i32 s86, s61, 40960
    s_lshl_b32 s6, s3, 7
    s_add_u32 s86, s86, s6
    s_add_u32 m0, s85, 0
    s_nop 0
    buffer_load_dwordx4 v16, s[12:15], s84 offen lds
    s_add_u32 s84, s84, 55296
    s_add_u32 m0, s85, 1024
    s_nop 0
    buffer_load_dwordx4 v16, s[12:15], s84 offen lds
    s_add_u32 s84, s84, 55296
    s_add_u32 m0, s85, 2048
    s_nop 0
    buffer_load_dwordx4 v16, s[12:15], s84 offen lds
    s_add_u32 s84, s84, 55296
    s_add_u32 m0, s85, 3072
    s_nop 0
    buffer_load_dwordx4 v16, s[12:15], s84 offen lds
    s_add_u32 s84, s84, 55296
    s_add_u32 m0, s85, 4096
    s_nop 0
    buffer_load_dwordx4 v16, s[12:15], s84 offen lds
    s_add_u32 s84, s84, 55296
    s_add_u32 m0, s85, 5120
    s_nop 0
    buffer_load_dwordx4 v16, s[12:15], s84 offen lds
    s_add_u32 s84, s84, 55296
    s_add_u32 m0, s85, 6144
    s_nop 0
    buffer_load_dwordx4 v16, s[12:15], s84 offen lds
    s_add_u32 s84, s84, 55296
    s_add_u32 m0, s85, 7168
    s_nop 0
    buffer_load_dwordx4 v16, s[12:15], s84 offen lds
    s_add_u32 s84, s84, 55296
    v_lshrrev_b32 v7, 4, v1
    v_and_b32 v2, 15, v1
    v_lshrrev_b32 v3, 2, v2
    v_lshl_add_u32 v8, v7, 3, v3
    v_lshlrev_b32 v8, 6, v8
    v_and_b32 v4, 3, v2
    v_lshl_add_u32 v8, v4, 3, v8
    v_add_u32 v17, s85, v8
    v_lshl_add_u32 v8, v7, 2, v3
    v_lshlrev_b32 v8, 7, v8
    v_lshl_add_u32 v8, v4, 3, v8
    s_add_u32 s6, s85, 4096
    v_add_u32 v19, s6, v8
    v_mul_u32_u24 v3, 2560, v2
    v_lshl_add_u32 v3, v7, 4, v3
    v_mov_b32 v4, 0x5000000
    v_cmp_gt_u32 vcc, 8, v2
    s_mul_i32 s87, s61, 20480
    s_lshl_b32 s7, s3, 8
    s_add_u32 s87, s87, s7
    s_add_u32 s87, s87, 2686976
    v_cndmask_b32 v20, v4, v3, vcc
    s_and_b32 s7, s3, 1
    s_mul_i32 s88, s7, 10240
    s_add_u32 s88, s88, 12582912
    s_waitcnt vmcnt(0) lgkmcnt(0)
    s_call_b64 s[82:83], L_pend
    s_barrier
    ds_read_b64_tr_b16 v[104:105], v17 offset:0
    ds_read_b64_tr_b16 v[106:107], v17 offset:256
    ds_read_b64_tr_b16 v[108:109], v17 offset:32
    ds_read_b64_tr_b16 v[110:111], v17 offset:288
    ds_read_b64_tr_b16 v[112:113], v17 offset:2048
    ds_read_b64_tr_b16 v[114:115], v17 offset:2304
    ds_read_b64_tr_b16 v[116:117], v17 offset:2080
    ds_read_b64_tr_b16 v[118:119], v17 offset:2336
    s_waitcnt lgkmcnt(0)
    ds_read_b64_tr_b16 v[120:121], v17 offset:4096
    ds_read_b64_tr_b16 v[122:123], v17 offset:4352
    ds_read_b64_tr_b16 v[124:125], v17 offset:4128
    ds_read_b64_tr_b16 v[126:127], v17 offset:4384
    ds_read_b64_tr_b16 v[128:129], v17 offset:6144
    ds_read_b64_tr_b16 v[130:131], v17 offset:6400
    ds_read_b64_tr_b16 v[132:133], v17 offset:6176
    ds_read_b64_tr_b16 v[134:135], v17 offset:6432
    s_waitcnt lgkmcnt(0)
    s_add_u32 m0, s85, 0
    s_nop 0
    buffer_load_dwordx4 v16, s[12:15], s84 offen lds
    s_add_u32 s84, s84, 55296
    s_add_u32 m0, s85, 1024
    s_nop 0
    buffer_load_dwordx4 v16, s[12:15], s84 offen lds
    s_add_u32 s84, s84, 55296
    s_add_u32 m0, s85, 2048
    s_nop 0
    buffer_load_dwordx4 v16, s[12:15], s84 offen lds
    s_add_u32 s84, s84, 55296
    s_add_u32 m0, s85, 3072
    s_nop 0
    buffer_load_dwordx4 v16, s[12:15], s84 offen lds
    s_add_u32 s84, s84, 55296
    s_add_u32 m0, s85, 4096
    s_nop 0
    buffer_load_dwordx4 v16, s[12:15], s84 offen lds
    s_add_u32 s84, s84, 55296
    s_add_u32 m0, s85, 5120
    s_nop 0
    buffer_load_dwordx4 v16, s[12:15], s84 offen lds
    s_add_u32 s84, s84, 55296
    s_add_u32 m0, s85, 6144
    s_nop 0
    buffer_load_dwordx4 v16, s[12:15], s84 offen lds
    s_add_u32 s84, s84, 55296
    s_add_u32 m0, s85, 7168
    s_nop 0
    buffer_load_dwordx4 v16, s[12:15], s84 offen lds
    s_add_u32 s84, s84, 55296
    s_call_b64 s[82:83], L_load
    s_add_i32 s62, s62, 1
    v_and_b32 v3, 7, v1
    v_lshlrev_b32 v3, 2, v3
    s_mov_b32 s72, 0x3a0000
    buffer_load_dword v51, v3, s[8:11], s72 offen sc1
    s_waitcnt vmcnt(0) lgkmcnt(0)
    s_call_b64 s[82:83], L_pend
    s_barrier
    ds_read_b64_tr_b16 v[136:137], v17 offset:0
    ds_read_b64_tr_b16 v[138:139], v17 offset:256
    ds_read_b64_tr_b16 v[140:141], v17 offset:32
    ds_read_b64_tr_b16 v[142:143], v17 offset:288
    ds_read_b64_tr_b16 v[144:145], v17 offset:2048
    ds_read_b64_tr_b16 v[146:147], v17 offset:2304
    ds_read_b64_tr_b16 v[148:149], v17 offset:2080
    ds_read_b64_tr_b16 v[150:151], v17 offset:2336
    s_waitcnt lgkmcnt(0)
    ds_read_b64_tr_b16 v[152:153], v17 offset:4096
    ds_read_b64_tr_b16 v[154:155], v17 offset:4352
    ds_read_b64_tr_b16 v[156:157], v17 offset:4128
    ds_read_b64_tr_b16 v[158:159], v17 offset:4384
    ds_read_b64_tr_b16 v[160:161], v17 offset:6144
    ds_read_b64_tr_b16 v[162:163], v17 offset:6400
    ds_read_b64_tr_b16 v[164:165], v17 offset:6176
    ds_read_b64_tr_b16 v[166:167], v17 offset:6432
    s_waitcnt lgkmcnt(0)
    s_add_u32 m0, s85, 0
    s_nop 0
    buffer_load_dwordx4 v16, s[12:15], s84 offen lds
    s_add_u32 s84, s84, 55296
    s_add_u32 m0, s85, 1024
    s_nop 0
    buffer_load_dwordx4 v16, s[12:15], s84 offen lds
    s_add_u32 s84, s84, 55296
    s_add_u32 m0, s85, 2048
    s_nop 0
    buffer_load_dwordx4 v16, s[12:15], s84 offen lds
    s_add_u32 s84, s84, 55296
    s_add_u32 m0, s85, 3072
    s_nop 0
    buffer_load_dwordx4 v16, s[12:15], s84 offen lds
    s_add_u32 s84, s84, 55296
    s_add_u32 m0, s85, 4096
    s_add_u32 s6, s86, 0
    buffer_load_dwordx4 v18, s[16:19], s6 offen lds
    s_add_u32 m0, s85, 5120
    s_add_u32 s6, s86, 10240
    buffer_load_dwordx4 v18, s[16:19], s6 offen lds
    s_add_u32 m0, s85, 6144
    s_add_u32 s6, s86, 20480
    buffer_load_dwordx4 v18, s[16:19], s6 offen lds
    s_add_u32 m0, s85, 7168
    s_add_u32 s6, s86, 30720
    buffer_load_dwordx4 v18, s[16:19], s6 offen lds
    s_add_u32 s86, s86, 512
    s_call_b64 s[82:83], L_load
    s_add_i32 s62, s62, 1
    v_cmp_le_i32 vcc, 0, v51
    s_cbranch_vccz L_idx_okm
    v_and_b32 v3, 7, v1
    v_lshlrev_b32 v3, 2, v3
    s_mov_b32 s72, 0x3a0000
    s_mov_b32 s79, 262144
L_poll_38:
    buffer_load_dword v51, v3, s[8:11], s72 offen sc1
    s_waitcnt vmcnt(0)
    v_cmp_le_i32 vcc, 0, v51
    s_cbranch_vccz L_polldone_39
    s_sleep 2
    s_sub_u32 s79, s79, 1
    s_cmp_lg_u32 s79, 0
    s_cbranch_scc1 L_poll_38
L_polldone_39:
L_idx_okm:
    buffer_load_dwordx4 v[64:67], v13, s[8:11], s88 offen sc1
    s_add_u32 s88, s88, 1024
    buffer_load_dwordx4 v[68:71], v13, s[8:11], s88 offen sc1
    s_add_u32 s88, s88, 1024
    buffer_load_dwordx4 v[72:75], v13, s[8:11], s88 offen sc1
    s_add_u32 s88, s88, 1024
    buffer_load_dwordx4 v[76:79], v13, s[8:11], s88 offen sc1
    s_add_u32 s88, s88, 1024
    buffer_load_dwordx4 v[80:83], v13, s[8:11], s88 offen sc1
    s_add_u32 s88, s88, 1024
    buffer_load_dwordx4 v[84:87], v13, s[8:11], s88 offen sc1
    s_add_u32 s88, s88, 1024
    buffer_load_dwordx4 v[88:91], v13, s[8:11], s88 offen sc1
    s_add_u32 s88, s88, 1024
    buffer_load_dwordx4 v[92:95], v13, s[8:11], s88 offen sc1
    s_add_u32 s88, s88, 1024
    buffer_load_dwordx4 v[96:99], v13, s[8:11], s88 offen sc1
    s_add_u32 s88, s88, 1024
    buffer_load_dwordx4 v[100:103], v13, s[8:11], s88 offen sc1
    s_add_u32 s88, s88, 1024
    s_waitcnt vmcnt(10) lgkmcnt(0)
    s_call_b64 s[82:83], L_pend
    s_barrier
    ds_read_b64_tr_b16 v[168:169], v17 offset:0
    ds_read_b64_tr_b16 v[170:171], v17 offset:256
    ds_read_b64_tr_b16 v[172:173], v17 offset:32
    ds_read_b64_tr_b16 v[174:175], v17 offset:288
    ds_read_b64_tr_b16 v[176:177], v17 offset:2048
    ds_read_b64_tr_b16 v[178:179], v17 offset:2304
    ds_read_b64_tr_b16 v[180:181], v17 offset:2080
    ds_read_b64_tr_b16 v[182:183], v17 offset:2336
    s_waitcnt lgkmcnt(0)
    ds_read_b64_tr_b16 v[32:33], v19 offset:0
    ds_read_b64_tr_b16 v[34:35], v19 offset:2048
    ds_read_b64_tr_b16 v[36:37], v19 offset:32
    ds_read_b64_tr_b16 v[38:39], v19 offset:2080
    ds_read_b64_tr_b16 v[40:41], v19 offset:64
    ds_read_b64_tr_b16 v[42:43], v19 offset:2112
    ds_read_b64_tr_b16 v[44:45], v19 offset:96
    ds_read_b64_tr_b16 v[46:47], v19 offset:2144
    s_waitcnt lgkmcnt(0)
    s_add_u32 m0, s85, 4096
    s_add_u32 s6, s86, 0
    buffer_load_dwordx4 v18, s[16:19], s6 offen lds
    s_add_u32 m0, s85, 5120
    s_add_u32 s6, s86, 10240
    buffer_load_dwordx4 v18, s[16:19], s6 offen lds
    s_add_u32 m0, s85, 6144
    s_add_u32 s6, s86, 20480
    buffer_load_dwordx4 v18, s[16:19], s6 offen lds
    s_add_u32 m0, s85, 7168
    s_add_u32 s6, s86, 30720
    buffer_load_dwordx4 v18, s[16:19], s6 offen lds
    s_add_u32 s86, s86, 512
    s_call_b64 s[82:83], L_load
    s_add_i32 s62, s62, 1
    s_waitcnt vmcnt(20)
    v_mfma_f32_16x16x32_bf16 v[24:27], v[104:107], v[64:67], 0
    v_mfma_f32_16x16x32_bf16 v[28:31], v[108:111], v[64:67], 0
    v_mfma_f32_16x16x32_bf16 v[24:27], v[112:115], v[68:71], v[24:27]
    v_mfma_f32_16x16x32_bf16 v[28:31], v[116:119], v[68:71], v[28:31]
    v_mfma_f32_16x16x32_bf16 v[24:27], v[120:123], v[72:75], v[24:27]
    v_mfma_f32_16x16x32_bf16 v[28:31], v[124:127], v[72:75], v[28:31]
    v_mfma_f32_16x16x32_bf16 v[24:27], v[128:131], v[76:79], v[24:27]
    v_mfma_f32_16x16x32_bf16 v[28:31], v[132:135], v[76:79], v[28:31]
    v_mfma_f32_16x16x32_bf16 v[24:27], v[136:139], v[80:83], v[24:27]
    v_mfma_f32_16x16x32_bf16 v[28:31], v[140:143], v[80:83], v[28:31]
    v_mfma_f32_16x16x32_bf16 v[24:27], v[144:147], v[84:87], v[24:27]
    v_mfma_f32_16x16x32_bf16 v[28:31], v[148:151], v[84:87], v[28:31]
    v_mfma_f32_16x16x32_bf16 v[24:27], v[152:155], v[88:91], v[24:27]
    v_mfma_f32_16x16x32_bf16 v[28:31], v[156:159], v[88:91], v[28:31]
    v_mfma_f32_16x16x32_bf16 v[24:27], v[160:163], v[92:95], v[24:27]
    v_mfma_f32_16x16x32_bf16 v[28:31], v[164:167], v[92:95], v[28:31]
    v_mfma_f32_16x16x32_bf16 v[24:27], v[168:171], v[96:99], v[24:27]
    v_mfma_f32_16x16x32_bf16 v[28:31], v[172:175], v[96:99], v[28:31]
    v_mfma_f32_16x16x32_bf16 v[24:27], v[176:179], v[100:103], v[24:27]
    v_mfma_f32_16x16x32_bf16 v[28:31], v[180:183], v[100:103], v[28:31]
    v_add_u32 v10, s85, v13
    s_nop 7
    ds_write_b128 v10, v[24:27]
    ds_write_b128 v10, v[28:31] offset:1024
    s_waitcnt vmcnt(0) lgkmcnt(0)
    s_call_b64 s[82:83], L_pend
    s_barrier
    ds_read_b64_tr_b16 v[240:241], v19 offset:0
    ds_read_b64_tr_b16 v[242:243], v19 offset:2048
    ds_read_b64_tr_b16 v[244:245], v19 offset:32
    ds_read_b64_tr_b16 v[246:247], v19 offset:2080
    ds_read_b64_tr_b16 v[248:249], v19 offset:64
    ds_read_b64_tr_b16 v[250:251], v19 offset:2112
    ds_read_b64_tr_b16 v[252:253], v19 offset:96
    ds_read_b64_tr_b16 v[254:255], v19 offset:2144
    v_add_u32 v10, 131072, v13
    s_waitcnt lgkmcnt(0)
    ds_read_b128 v[184:187], v10 offset:0
    ds_read_b128 v[188:191], v10 offset:1024
    ds_read_b128 v[192:195], v10 offset:8192
    ds_read_b128 v[196:199], v10 offset:9216
    ds_read_b128 v[200:203], v10 offset:16384
    ds_read_b128 v[204:207], v10 offset:17408
    ds_read_b128 v[208:211], v10 offset:24576
    ds_read_b128 v[212:215], v10 offset:25600
    s_cmp_ge_u32 s3, 2
    s_cbranch_scc1 L_moe4b
    s_add_u32 m0, s85, 4096
    s_add_u32 s6, s86, 0
    buffer_load_dwordx4 v18, s[16:19], s6 offen lds
    s_add_u32 m0, s85, 5120
    s_add_u32 s6, s86, 10240
    buffer_load_dwordx4 v18, s[16:19], s6 offen lds
    s_add_u32 m0, s85, 6144
    s_add_u32 s6, s86, 20480
    buffer_load_dwordx4 v18, s[16:19], s6 offen lds
    s_add_u32 m0, s85, 7168
    s_add_u32 s6, s86, 30720
    buffer_load_dwordx4 v18, s[16:19], s6 offen lds
    s_add_u32 s86, s86, 512
L_moe4b:
    s_call_b64 s[82:83], L_load
    s_add_i32 s62, s62, 1
    s_waitcnt lgkmcnt(0)
    s_mov_b32 s6, 0xbfb8aa3b
    v_add_f32 v184, v184, v192
    v_add_f32 v200, v200, v208
    v_add_f32 v185, v185, v193
    v_add_f32 v201, v201, v209
    v_cvt_pk_bf16_f32 v185, v184, v185
    v_lshlrev_b32 v184, 16, v185
    v_and_b32 v185, 0xffff0000, v185
    v_cvt_pk_bf16_f32 v201, v200, v201
    v_lshlrev_b32 v200, 16, v201
    v_and_b32 v201, 0xffff0000, v201
    v_mul_f32 v2, s6, v184
    v_mul_f32 v3, s6, v185
    v_exp_f32 v2, v2
    v_exp_f32 v3, v3
    s_nop 0
    v_add_f32 v2, 1.0, v2
    v_add_f32 v3, 1.0, v3
    v_rcp_f32 v2, v2
    v_rcp_f32 v3, v3
    s_nop 0
    v_mul_f32 v184, v184, v2
    v_mul_f32 v185, v185, v3
    v_cvt_pk_bf16_f32 v185, v184, v185
    v_lshlrev_b32 v184, 16, v185
    v_and_b32 v185, 0xffff0000, v185
    v_mul_f32 v184, v184, v200
    v_mul_f32 v185, v185, v201
    v_cvt_pk_bf16_f32 v24, v184, v185
    v_add_f32 v186, v186, v194
    v_add_f32 v202, v202, v210
    v_add_f32 v187, v187, v195
    v_add_f32 v203, v203, v211
    v_cvt_pk_bf16_f32 v187, v186, v187
    v_lshlrev_b32 v186, 16, v187
    v_and_b32 v187, 0xffff0000, v187
    v_cvt_pk_bf16_f32 v203, v202, v203
    v_lshlrev_b32 v202, 16, v203
    v_and_b32 v203, 0xffff0000, v203
    v_mul_f32 v2, s6, v186
    v_mul_f32 v3, s6, v187
    v_exp_f32 v2, v2
    v_exp_f32 v3, v3
    s_nop 0
    v_add_f32 v2, 1.0, v2
    v_add_f32 v3, 1.0, v3
    v_rcp_f32 v2, v2
    v_rcp_f32 v3, v3
    s_nop 0
    v_mul_f32 v186, v186, v2
    v_mul_f32 v187, v187, v3
    v_cvt_pk_bf16_f32 v187, v186, v187
    v_lshlrev_b32 v186, 16, v187
    v_and_b32 v187, 0xffff0000, v187
    v_mul_f32 v186, v186, v202
    v_mul_f32 v187, v187, v203
    v_cvt_pk_bf16_f32 v25, v186, v187
    v_add_f32 v188, v188, v196
    v_add_f32 v204, v204, v212
    v_add_f32 v189, v189, v197
    v_add_f32 v205, v205, v213
    v_cvt_pk_bf16_f32 v189, v188, v189
    v_lshlrev_b32 v188, 16, v189
    v_and_b32 v189, 0xffff0000, v189
    v_cvt_pk_bf16_f32 v205, v204, v205
    v_lshlrev_b32 v204, 16, v205
    v_and_b32 v205, 0xffff0000, v205
    v_mul_f32 v2, s6, v188
    v_mul_f32 v3, s6, v189
    v_exp_f32 v2, v2
    v_exp_f32 v3, v3
    s_nop 0
    v_add_f32 v2, 1.0, v2
    v_add_f32 v3, 1.0, v3
    v_rcp_f32 v2, v2
    v_rcp_f32 v3, v3
    s_nop 0
    v_mul_f32 v188, v188, v2
    v_mul_f32 v189, v189, v3
    v_cvt_pk_bf16_f32 v189, v188, v189
    v_lshlrev_b32 v188, 16, v189
    v_and_b32 v189, 0xffff0000, v189
    v_mul_f32 v188, v188, v204
    v_mul_f32 v189, v189, v205
    v_cvt_pk_bf16_f32 v26, v188, v189
    v_add_f32 v190, v190, v198
    v_add_f32 v206, v206, v214
    v_add_f32 v191, v191, v199
    v_add_f32 v207, v207, v215
    v_cvt_pk_bf16_f32 v191, v190, v191
    v_lshlrev_b32 v190, 16, v191
    v_and_b32 v191, 0xffff0000, v191
    v_cvt_pk_bf16_f32 v207, v206, v207
    v_lshlrev_b32 v206, 16, v207
    v_and_b32 v207, 0xffff0000, v207
    v_mul_f32 v2, s6, v190
    v_mul_f32 v3, s6, v191
    v_exp_f32 v2, v2
    v_exp_f32 v3, v3
    s_nop 0
    v_add_f32 v2, 1.0, v2
    v_add_f32 v3, 1.0, v3
    v_rcp_f32 v2, v2
    v_rcp_f32 v3, v3
    s_nop 0
    v_mul_f32 v190, v190, v2
    v_mul_f32 v191, v191, v3
    v_cvt_pk_bf16_f32 v191, v190, v191
    v_lshlrev_b32 v190, 16, v191
    v_and_b32 v191, 0xffff0000, v191
    v_mul_f32 v190, v190, v206
    v_mul_f32 v191, v191, v207
    v_cvt_pk_bf16_f32 v27, v190, v191
    s_nop 1
    v_mfma_f32_16x16x32_bf16 v[216:219], v[32:35], v[24:27], 0
    v_mfma_f32_16x16x32_bf16 v[220:223], v[36:39], v[24:27], 0
    v_mfma_f32_16x16x32_bf16 v[224:227], v[40:43], v[24:27], 0
    v_mfma_f32_16x16x32_bf16 v[228:231], v[44:47], v[24:27], 0
    s_nop 7
    buffer_store_dwordx4 v[216:219], v20, s[8:11], s87 offen offset:0 sc1
    buffer_store_dwordx4 v[220:223], v20, s[8:11], s87 offen offset:64 sc1
    buffer_store_dwordx4 v[224:227], v20, s[8:11], s87 offen offset:128 sc1
    buffer_store_dwordx4 v[228:231], v20, s[8:11], s87 offen offset:192 sc1
    s_nop 1
    s_waitcnt vmcnt(4) lgkmcnt(0)
    s_call_b64 s[82:83], L_pend
    s_barrier
    s_call_b64 s[82:83], L_load
    s_add_i32 s62, s62, 1
    v_mfma_f32_16x16x32_bf16 v[216:219], v[240:243], v[24:27], 0
    v_mfma_f32_16x16x32_bf16 v[220:223], v[244:247], v[24:27], 0
    v_mfma_f32_16x16x32_bf16 v[224:227], v[248:251], v[24:27], 0
    v_mfma_f32_16x16x32_bf16 v[228:231], v[252:255], v[24:27], 0
    s_nop 7
    buffer_store_dwordx4 v[216:219], v20, s[8:11], s87 offen offset:1024 sc1
    buffer_store_dwordx4 v[220:223], v20, s[8:11], s87 offen offset:1088 sc1
    buffer_store_dwordx4 v[224:227], v20, s[8:11], s87 offen offset:1152 sc1
    buffer_store_dwordx4 v[228:231], v20, s[8:11], s87 offen offset:1216 sc1
    s_nop 1
    s_cmp_ge_u32 s3, 2
    s_cbranch_scc1 L_moe5b
    ds_read_b64_tr_b16 v[32:33], v19 offset:0
    ds_read_b64_tr_b16 v[34:35], v19 offset:2048
    ds_read_b64_tr_b16 v[36:37], v19 offset:32
    ds_read_b64_tr_b16 v[38:39], v19 offset:2080
    ds_read_b64_tr_b16 v[40:41], v19 offset:64
    ds_read_b64_tr_b16 v[42:43], v19 offset:2112
    ds_read_b64_tr_b16 v[44:45], v19 offset:96
    ds_read_b64_tr_b16 v[46:47], v19 offset:2144
    s_waitcnt lgkmcnt(0)
    v_mfma_f32_16x16x32_bf16 v[216:219], v[32:35], v[24:27], 0
    v_mfma_f32_16x16x32_bf16 v[220:223], v[36:39], v[24:27], 0
    v_mfma_f32_16x16x32_bf16 v[224:227], v[40:43], v[24:27], 0
    v_mfma_f32_16x16x32_bf16 v[228:231], v[44:47], v[24:27], 0
    s_nop 7
    buffer_store_dwordx4 v[216:219], v20, s[8:11], s87 offen offset:2048 sc1
    buffer_store_dwordx4 v[220:223], v20, s[8:11], s87 offen offset:2112 sc1
    buffer_store_dwordx4 v[224:227], v20, s[8:11], s87 offen offset:2176 sc1
    buffer_store_dwordx4 v[228:231], v20, s[8:11], s87 offen offset:2240 sc1
    s_nop 1
L_moe5b:
    s_waitcnt vmcnt(4) lgkmcnt(0)
    s_call_b64 s[82:83], L_pend
    s_barrier
    s_waitcnt vmcnt(0)
    s_lshl_b32 s6, s61, 5
    s_add_u32 s6, s6, s3
    s_lshl_b32 s6, s6, 2
    s_add_u32 s6, s6, 15859712
    v_mov_b32 v2, 1
    v_mov_b32 v3, 0x5000000
    v_writelane_b32 v3, s6, 0
    buffer_store_dword v2, v3, s[8:11], 0 offen sc1
    s_call_b64 s[82:83], L_load
    s_add_i32 s62, s62, 1
    s_branch L_idle
L_top:
    s_mov_b32 s6, 0x280000
    v_lshrrev_b32 v2, 1, v1
    v_and_b32 v3, 1, v1
    v_lshlrev_b32 v3, 4, v3
    v_lshl_add_u32 v2, v2, 7, v3
    buffer_load_dwordx4 v[64:67], v2, s[8:11], s6 offen sc1
    s_add_u32 s6, s6, 4096
    buffer_load_dwordx4 v[68:71], v2, s[8:11], s6 offen sc1
    s_add_u32 s6, s6, 4096
    buffer_load_dwordx4 v[72:75], v2, s[8:11], s6 offen sc1
    s_add_u32 s6, s6, 4096
    buffer_load_dwordx4 v[76:79], v2, s[8:11], s6 offen sc1
    s_add_u32 s6, s6, 4096
    buffer_load_dwordx4 v[80:83], v2, s[8:11], s6 offen sc1
    s_add_u32 s6, s6, 4096
    buffer_load_dwordx4 v[84:87], v2, s[8:11], s6 offen sc1
    s_add_u32 s6, s6, 4096
    buffer_load_dwordx4 v[88:91], v2, s[8:11], s6 offen sc1
    s_add_u32 s6, s6, 4096
    buffer_load_dwordx4 v[92:95], v2, s[8:11], s6 offen sc1
    s_add_u32 s6, s6, 4096
    s_waitcnt vmcnt(0)
    v_mov_b32 v24, 0
    s_mov_b32 s7, 0
    s_mov_b32 s84, 0
L_top_l:
    v_max3_u32 v4, v64, v65, v66
    v_max3_u32 v5, v67, v68, v69
    v_max3_u32 v4, v4, v70, v71
    v_max3_u32 v5, v5, v72, v73
    v_max3_u32 v4, v4, v74, v75
    v_max3_u32 v5, v5, v76, v77
    v_max3_u32 v4, v4, v78, v79
    v_max3_u32 v5, v5, v80, v81
    v_max3_u32 v4, v4, v82, v83
    v_max3_u32 v5, v5, v84, v85
    v_max3_u32 v4, v4, v86, v87
    v_max3_u32 v5, v5, v88, v89
    v_max3_u32 v4, v4, v90, v91
    v_max3_u32 v5, v5, v92, v93
    v_max3_u32 v4, v4, v94, v95
    v_max_u32 v4, v4, v5
    s_nop 1
    v_max_u32_dpp v4, v4, v4 quad_perm:[1,0,3,2] row_mask:0xf bank_mask:0xf
    s_nop 1
    v_max_u32_dpp v4, v4, v4 quad_perm:[2,3,0,1] row_mask:0xf bank_mask:0xf
    s_nop 1
    v_max_u32_dpp v4, v4, v4 row_half_mirror row_mask:0xf bank_mask:0xf
    s_nop 1
    v_max_u32_dpp v4, v4, v4 row_mirror row_mask:0xf bank_mask:0xf
    s_nop 1
    v_max_u32_dpp v4, v4, v4 row_bcast:15 row_mask:0xa bank_mask:0xf
    s_nop 1
    v_max_u32_dpp v4, v4, v4 row_bcast:31 row_mask:0xc bank_mask:0xf
    s_nop 1
    v_readlane_b32 s6, v4, 63
    s_mov_b32 m0, s7
    s_nop 3
    s_add_u32 s84, s84, s6
    v_writelane_b32 v24, s84, m0
    v_subrev_u32 v64, s6, v64
    v_subrev_u32 v65, s6, v65
    v_subrev_u32 v66, s6, v66
    v_subrev_u32 v67, s6, v67
    v_subrev_u32 v68, s6, v68
    v_subrev_u32 v69, s6, v69
    v_subrev_u32 v70, s6, v70
    v_subrev_u32 v71, s6, v71
    v_subrev_u32 v72, s6, v72
    v_subrev_u32 v73, s6, v73
    v_subrev_u32 v74, s6, v74
    v_subrev_u32 v75, s6, v75
    v_subrev_u32 v76, s6, v76
    v_subrev_u32 v77, s6, v77
    v_subrev_u32 v78, s6, v78
    v_subrev_u32 v79, s6, v79
    v_subrev_u32 v80, s6, v80
    v_subrev_u32 v81, s6, v81
    v_subrev_u32 v82, s6, v82
    v_subrev_u32 v83, s6, v83
    v_subrev_u32 v84, s6, v84
    v_subrev_u32 v85, s6, v85
    v_subrev_u32 v86, s6, v86
    v_subrev_u32 v87, s6, v87
    v_subrev_u32 v88, s6, v88
    v_subrev_u32 v89, s6, v89
    v_subrev_u32 v90, s6, v90
    v_subrev_u32 v91, s6, v91
    v_subrev_u32 v92, s6, v92
    v_subrev_u32 v93, s6, v93
    v_subrev_u32 v94, s6, v94
    v_subrev_u32 v95, s6, v95
    s_add_u32 s7, s7, 1
    s_cmp_lt_u32 s7, 8
    s_cbranch_scc1 L_top_l
    v_and_b32 v2, 7, v1
    v_lshlrev_b32 v2, 2, v2
    ds_bpermute_b32 v4, v2, v24
    s_waitcnt lgkmcnt(0)
    v_and_b32 v4, 0x7ff, v4
    v_sub_u32 v4, 0x7ff, v4
    v_lshrrev_b32 v5, 4, v4
    v_mul_u32_u24 v5, 20480, v5
    v_and_b32 v4, 15, v4
    v_lshl_add_u32 v5, v4, 4, v5
    v_lshrrev_b32 v7, 4, v1
    v_lshl_add_u32 v5, v7, 8, v5
    v_mov_b32 v6, 0x5000000
    v_and_b32 v2, 8, v1
    v_cmp_eq_u32 vcc, 0, v2
    s_mov_b32 s6, 0
    s_nop 0
    v_cndmask_b32 v5, v6, v5, vcc
    buffer_load_dwordx4 v[64:67], v5, s[8:11], s6 offen offset:0 sc1
    buffer_load_dwordx4 v[68:71], v5, s[8:11], s6 offen offset:1024 sc1
    buffer_load_dwordx4 v[72:75], v5, s[8:11], s6 offen offset:2048 sc1
    buffer_load_dwordx4 v[76:79], v5, s[8:11], s6 offen offset:3072 sc1
    s_add_u32 s6, s6, 4096
    buffer_load_dwordx4 v[80:83], v5, s[8:11], s6 offen offset:0 sc1
    buffer_load_dwordx4 v[84:87], v5, s[8:11], s6 offen offset:1024 sc1
    buffer_load_dwordx4 v[88:91], v5, s[8:11], s6 offen offset:2048 sc1
    buffer_load_dwordx4 v[92:95], v5, s[8:11], s6 offen offset:3072 sc1
    s_add_u32 s6, s6, 4096
    buffer_load_dwordx4 v[96:99], v5, s[8:11], s6 offen offset:0 sc1
    buffer_load_dwordx4 v[100:103], v5, s[8:11], s6 offen offset:1024 sc1
    buffer_load_dwordx4 v[104:107], v5, s[8:11], s6 offen offset:2048 sc1
    buffer_load_dwordx4 v[108:111], v5, s[8:11], s6 offen offset:3072 sc1
    s_add_u32 s6, s6, 4096
    buffer_load_dwordx4 v[112:115], v5, s[8:11], s6 offen offset:0 sc1
    buffer_load_dwordx4 v[116:119], v5, s[8:11], s6 offen offset:1024 sc1
    buffer_load_dwordx4 v[120:123], v5, s[8:11], s6 offen offset:2048 sc1
    buffer_load_dwordx4 v[124:127], v5, s[8:11], s6 offen offset:3072 sc1
    s_add_u32 s6, s6, 4096
    buffer_load_dwordx4 v[128:131], v5, s[8:11], s6 offen offset:0 sc1
    buffer_load_dwordx4 v[132:135], v5, s[8:11], s6 offen offset:1024 sc1
    buffer_load_dwordx4 v[136:139], v5, s[8:11], s6 offen offset:2048 sc1
    buffer_load_dwordx4 v[140:143], v5, s[8:11], s6 offen offset:3072 sc1
    s_waitcnt vmcnt(20)
    s_call_b64 s[82:83], L_pend
    s_barrier
    s_waitcnt vmcnt(0)
    s_mov_b32 s6, 0xc00000
    buffer_store_dwordx4 v[64:67], v13, s[8:11], s6 offen offset:0 sc1
    buffer_store_dwordx4 v[68:71], v13, s[8:11], s6 offen offset:1024 sc1
    buffer_store_dwordx4 v[72:75], v13, s[8:11], s6 offen offset:2048 sc1
    buffer_store_dwordx4 v[76:79], v13, s[8:11], s6 offen offset:3072 sc1
    s_add_u32 s6, s6, 4096
    buffer_store_dwordx4 v[80:83], v13, s[8:11], s6 offen offset:0 sc1
    buffer_store_dwordx4 v[84:87], v13, s[8:11], s6 offen offset:1024 sc1
    buffer_store_dwordx4 v[88:91], v13, s[8:11], s6 offen offset:2048 sc1
    buffer_store_dwordx4 v[92:95], v13, s[8:11], s6 offen offset:3072 sc1
    s_add_u32 s6, s6, 4096
    buffer_store_dwordx4 v[96:99], v13, s[8:11], s6 offen offset:0 sc1
    buffer_store_dwordx4 v[100:103], v13, s[8:11], s6 offen offset:1024 sc1
    buffer_store_dwordx4 v[104:107], v13, s[8:11], s6 offen offset:2048 sc1
    buffer_store_dwordx4 v[108:111], v13, s[8:11], s6 offen offset:3072 sc1
    s_add_u32 s6, s6, 4096
    buffer_store_dwordx4 v[112:115], v13, s[8:11], s6 offen offset:0 sc1
    buffer_store_dwordx4 v[116:119], v13, s[8:11], s6 offen offset:1024 sc1
    buffer_store_dwordx4 v[120:123], v13, s[8:11], s6 offen offset:2048 sc1
    buffer_store_dwordx4 v[124:127], v13, s[8:11], s6 offen offset:3072 sc1
    s_add_u32 s6, s6, 4096
    buffer_store_dwordx4 v[128:131], v13, s[8:11], s6 offen offset:0 sc1
    buffer_store_dwordx4 v[132:135], v13, s[8:11], s6 offen offset:1024 sc1
    buffer_store_dwordx4 v[136:139], v13, s[8:11], s6 offen offset:2048 sc1
    buffer_store_dwordx4 v[140:143], v13, s[8:11], s6 offen offset:3072 sc1
    s_call_b64 s[82:83], L_load
    s_add_i32 s62, s62, 1
    s_waitcnt vmcnt(16)
    v_or_b32 v24, 0x80000000, v24
    v_lshlrev_b32 v5, 2, v1
    v_mov_b32 v6, 0x5000000
    v_cmp_gt_u32 vcc, 8, v1
    s_mov_b32 s6, 0x3a0000
    s_nop 0
    v_cndmask_b32 v5, v6, v5, vcc
    buffer_store_dword v24, v5, s[8:11], s6 offen sc1
    s_branch L_idle
L_back_9_h:
    v_cmp_ne_u32 vcc, 0, v62
    s_cbranch_vccz L_back_9_n
    s_call_b64 s[80:81], L_rare0
L_back_9_n:
    s_branch L_back_9
L_back_10_h:
    v_cmp_ne_u32 vcc, 0, v62
    s_cbranch_vccz L_back_10_n
    s_call_b64 s[80:81], L_rare1
    v_exp_f32 v58, v64
    v_exp_f32 v59, v65
L_back_10_n:
    s_cmp_lt_i32 s64, 0
    s_cbranch_scc1 L_tail1
    s_cmp_gt_i32 s64, 0
    s_cbranch_scc1 L_back_10
    s_call_b64 s[82:83], L_mask
    s_branch L_back_10
L_back_11_h:
    v_cmp_ne_u32 vcc, 0, v62
    s_cbranch_vccz L_back_11_n
    s_call_b64 s[80:81], L_rare0
    v_exp_f32 v58, v80
    v_exp_f32 v59, v81
L_back_11_n:
    s_cmp_lt_i32 s64, 0
    s_cbranch_scc1 L_tail2
    s_cmp_gt_i32 s64, 0
    s_cbranch_scc1 L_back_11
    s_call_b64 s[82:83], L_mask
    s_branch L_back_11
L_back_12_h:
    v_cmp_ne_u32 vcc, 0, v62
    s_cbranch_vccz L_back_12_n
    s_call_b64 s[80:81], L_rare1
    v_exp_f32 v58, v64
    v_exp_f32 v59, v65
L_back_12_n:
    s_cmp_lt_i32 s64, 0
    s_cbranch_scc1 L_tail3
    s_cmp_gt_i32 s64, 0
    s_cbranch_scc1 L_back_12
    s_call_b64 s[82:83], L_mask
    s_branch L_back_12
L_ldback_13_c:
    s_waitcnt vmcnt(0) lgkmcnt(0)
    s_call_b64 s[82:83], L_pend
    s_barrier
    s_call_b64 s[82:83], L_load
    s_branch L_ldback_13
L_back_14_h:
    v_cmp_ne_u32 vcc, 0, v62
    s_cbranch_vccz L_back_14_n
    s_call_b64 s[80:81], L_rare0
    v_exp_f32 v58, v80
    v_exp_f32 v59, v81
L_back_14_n:
    s_cmp_lt_i32 s64, 0
    s_cbranch_scc1 L_tail0
    s_cmp_gt_i32 s64, 0
    s_cbranch_scc1 L_st0
    s_call_b64 s[82:83], L_mask
    s_branch L_st0
L_back_15_h:
    v_cmp_ne_u32 vcc, 0, v62
    s_cbranch_vccz L_back_15_n
    s_call_b64 s[80:81], L_rare1
L_back_15_n:
    s_branch L_back_15
L_back_16_h:
    v_cmp_ne_u32 vcc, 0, v62
    s_cbranch_vccz L_back_16_n
    s_call_b64 s[80:81], L_rare0
L_back_16_n:
    s_branch L_back_16
L_back_17_h:
    v_cmp_ne_u32 vcc, 0, v62
    s_cbranch_vccz L_back_17_n
    s_call_b64 s[80:81], L_rare1
L_back_17_n:
    s_branch L_back_17
L_back_20_h:
    v_cmp_ne_u32 vcc, 0, v62
    s_cbranch_vccz L_back_20_n
    s_call_b64 s[80:81], L_rare0
L_back_20_n:
    s_branch L_back_20
L_load:
    s_bitcmp1_b32 s89, 0
    s_cbranch_scc0 L_load_r
    s_add_u32 s77, s77, 32768
    s_xor_b32 s78, s78, 0x10000
    s_add_i32 s73, s62, 1
    s_cmp_gt_i32 s73, s63
    s_cbranch_scc1 L_load_r
    s_cmp_eq_i32 s73, s63
    s_cbranch_scc1 L_load_v
    s_cmp_lg_i32 s73, 3
    s_cbranch_scc1 L_load_k
    v_cmp_gt_u32 vcc, 2, v12
    s_cbranch_vccz L_load_k
    s_lshl_b32 s7, s4, 10
    s_add_u32 s7, s7, 3866624
    v_lshrrev_b32 v2, 3, v1
    v_and_b32 v3, 7, v1
    v_lshlrev_b32 v3, 2, v3
    v_lshl_add_u32 v3, v2, 7, v3
    s_mov_b32 s79, 262144
L_poll_45:
    buffer_load_dword v2, v3, s[8:11], s7 offen sc1
    s_waitcnt vmcnt(0)
    v_cmp_gt_u32 vcc, 2, v2
    s_cbranch_vccz L_polldone_46
    s_sleep 2
    s_sub_u32 s79, s79, 1
    s_cmp_lg_u32 s79, 0
    s_cbranch_scc1 L_poll_45
L_polldone_46:
L_load_k:
    s_lshl_b32 s6, s76, 13
    s_add_u32 s6, s6, s78
    s_add_u32 m0, s6, 0
    s_add_u32 s7, s77, 0
    buffer_load_dwordx4 v49, s[8:11], s7 offen offset:0 sc1 lds
    buffer_load_dwordx4 v49, s[8:11], s7 offen offset:1024 sc1 lds
    buffer_load_dwordx4 v49, s[8:11], s7 offen offset:2048 sc1 lds
    buffer_load_dwordx4 v49, s[8:11], s7 offen offset:3072 sc1 lds
    s_lshl_b32 s6, s76, 13
    s_add_u32 s6, s6, s78
    s_add_u32 m0, s6, 4096
    s_add_u32 s7, s77, 4096
    buffer_load_dwordx4 v49, s[8:11], s7 offen offset:0 sc1 lds
    buffer_load_dwordx4 v49, s[8:11], s7 offen offset:1024 sc1 lds
    buffer_load_dwordx4 v49, s[8:11], s7 offen offset:2048 sc1 lds
    buffer_load_dwordx4 v49, s[8:11], s7 offen offset:3072 sc1 lds
    s_lshl_b32 s6, s76, 12
    s_add_u32 s6, s6, s78
    s_add_u32 m0, s6, 49152
    s_add_u32 s7, s77, 524288
    buffer_load_dwordx4 v50, s[8:11], s7 offen offset:0 sc1 lds
    buffer_load_dwordx4 v50, s[8:11], s7 offen offset:1024 sc1 lds
    buffer_load_dwordx4 v50, s[8:11], s7 offen offset:2048 sc1 lds
    buffer_load_dwordx4 v50, s[8:11], s7 offen offset:3072 sc1 lds
L_load_v:
    s_lshl_b32 s6, s76, 12
    s_add_u32 s6, s6, s78
    s_add_u32 m0, s6, 32768
    s_add_u32 s7, s77, 507904
    buffer_load_dwordx4 v50, s[8:11], s7 offen offset:0 sc1 lds
    buffer_load_dwordx4 v50, s[8:11], s7 offen offset:1024 sc1 lds
    buffer_load_dwordx4 v50, s[8:11], s7 offen offset:2048 sc1 lds
    buffer_load_dwordx4 v50, s[8:11], s7 offen offset:3072 sc1 lds
    s_cmp_eq_i32 s73, s63
    s_cbranch_scc1 L_xa
    s_cmp_lg_i32 s73, 2
    s_cbranch_scc1 L_nolook
    s_lshl_b32 s7, s4, 10
    s_add_u32 s7, s7, 3866624
    v_lshrrev_b32 v2, 3, v1
    v_and_b32 v3, 7, v1
    v_lshlrev_b32 v3, 2, v3
    v_lshl_add_u32 v3, v2, 7, v3
    buffer_load_dword v12, v3, s[8:11], s7 offen sc1
L_nolook:
    s_bitcmp1_b32 240, s5
    s_cbranch_scc0 L_wb
    s_sub_i32 s6, s62, 0
    s_cmp_gt_u32 s6, 4
    s_cbranch_scc0 L_wsel
L_wb:
    s_cmp_lt_u32 s5, 4
    s_cbranch_scc1 L_load_r
    s_sub_i32 s79, s73, 1
    s_cmp_lt_u32 s79, 2
    s_cbranch_scc1 L_x3
L_load_r:
    s_setpc_b64 s[82:83]
L_pend:
    s_bitcmp1_b32 s89, 1
    s_cbranch_scc0 L_load_a
    s_cmp_lt_i32 s62, 0
    s_cbranch_scc1 L_load_a
    s_lshl_b32 s6, s4, 3
    s_add_u32 s6, s6, s5
    s_lshl_b32 s6, s6, 5
    s_add_u32 s6, s6, s3
    s_lshl_b32 s6, s6, 2
    s_add_u32 s6, s6, 3866624
    v_mov_b32 v2, 2
    v_mov_b32 v3, 0x5000000
    v_writelane_b32 v3, s6, 0
    buffer_store_dword v2, v3, s[8:11], 0 offen sc1
    s_and_b32 s89, s89, 1
L_load_a:
    s_setpc_b64 s[82:83]
L_wsel:
    s_bfm_b32 s7, s5, 0
    s_and_b32 s7, s7, 240
    s_bcnt1_i32_b32 s7, s7
    s_lshl_b32 s7, s7, 5
    s_and_b32 s91, s2, 31
    s_add_u32 s91, s91, s7
    s_lshl_b32 s91, s91, 1
    s_lshr_b32 s7, s6, 1
    s_add_u32 s91, s91, s7
    s_cmp_eq_u32 s6, 4
    s_cbranch_scc1 L_w2
    s_bitcmp1_b32 s6, 0
    s_cbranch_scc1 L_w1
L_w0:
    s_mov_b32 s28, s42
    s_mov_b32 s29, s43
    s_mov_b32 s30, 0x500000
    s_mov_b32 s31, 0x20000
    s_lshr_b32 s75, s91, 1
    s_mul_i32 s75, s75, 40960
    s_and_b32 s6, s91, 1
    s_mul_i32 s6, s6, 640
    s_add_u32 s75, s75, s6
    s_movk_i32 s7, 1639
    s_mul_i32 s74, s76, 5120
    s_add_u32 s74, s74, 141312
    s_mul_i32 s6, s76, 320
    v_add_u32 v9, s6, v1
    v_add_u32 v2, 0, v9
    v_mul_lo_u32 v3, v2, s7
    v_lshrrev_b32 v3, 16, v3
    v_mul_u32_u24 v4, 40, v3
    v_sub_u32 v4, v2, v4
    v_mul_u32_u24 v3, 1280, v3
    v_lshl_add_u32 v3, v4, 4, v3
    s_add_u32 m0, s74, 0
    s_nop 0
    buffer_load_dwordx4 v3, s[28:31], s75 offen nt lds
    v_add_u32 v2, 64, v9
    v_mul_lo_u32 v3, v2, s7
    v_lshrrev_b32 v3, 16, v3
    v_mul_u32_u24 v4, 40, v3
    v_sub_u32 v4, v2, v4
    v_mul_u32_u24 v3, 1280, v3
    v_lshl_add_u32 v3, v4, 4, v3
    s_add_u32 m0, s74, 1024
    s_nop 0
    buffer_load_dwordx4 v3, s[28:31], s75 offen nt lds
    v_add_u32 v2, 128, v9
    v_mul_lo_u32 v3, v2, s7
    v_lshrrev_b32 v3, 16, v3
    v_mul_u32_u24 v4, 40, v3
    v_sub_u32 v4, v2, v4
    v_mul_u32_u24 v3, 1280, v3
    v_lshl_add_u32 v3, v4, 4, v3
    s_add_u32 m0, s74, 2048
    s_nop 0
    buffer_load_dwordx4 v3, s[28:31], s75 offen nt lds
    v_add_u32 v2, 192, v9
    v_mul_lo_u32 v3, v2, s7
    v_lshrrev_b32 v3, 16, v3
    v_mul_u32_u24 v4, 40, v3
    v_sub_u32 v4, v2, v4
    v_mul_u32_u24 v3, 1280, v3
    v_lshl_add_u32 v3, v4, 4, v3
    s_add_u32 m0, s74, 3072
    s_nop 0
    buffer_load_dwordx4 v3, s[28:31], s75 offen nt lds
    v_add_u32 v2, 256, v9
    v_mul_lo_u32 v3, v2, s7
    v_lshrrev_b32 v3, 16, v3
    v_mul_u32_u24 v4, 40, v3
    v_sub_u32 v4, v2, v4
    v_mul_u32_u24 v3, 1280, v3
    v_lshl_add_u32 v3, v4, 4, v3
    s_add_u32 m0, s74, 4096
    s_nop 0
    buffer_load_dwordx4 v3, s[28:31], s75 offen nt lds
    s_branch L_wb
L_w1:
    v_and_b32 v2, 15, v1
    v_lshrrev_b32 v3, 4, v1
    v_lshrrev_b32 v4, 2, v2
    v_lshl_add_u32 v4, v3, 2, v4
    v_mul_u32_u24 v4, 640, v4
    v_and_b32 v2, 3, v2
    v_lshl_add_u32 v4, v2, 3, v4
    s_mul_i32 s6, s76, 160
    s_add_u32 s6, s6, 141312
    v_add_u32 v4, s6, v4
    s_mul_i32 s6, s91, 20480
    s_mul_i32 s7, s76, 5120
    s_add_u32 s6, s6, s7
    s_add_u32 s6, s6, 4194304
    s_add_u32 s7, s6, 4096
    ds_read_b64_tr_b16 v[172:173], v4 offset:0
    ds_read_b64_tr_b16 v[174:175], v4 offset:10240
    ds_read_b64_tr_b16 v[176:177], v4 offset:32
    ds_read_b64_tr_b16 v[178:179], v4 offset:10272
    ds_read_b64_tr_b16 v[180:181], v4 offset:64
    ds_read_b64_tr_b16 v[182:183], v4 offset:10304
    ds_read_b64_tr_b16 v[184:185], v4 offset:96
    ds_read_b64_tr_b16 v[186:187], v4 offset:10336
    ds_read_b64_tr_b16 v[188:189], v4 offset:128
    ds_read_b64_tr_b16 v[190:191], v4 offset:10368
    s_waitcnt lgkmcnt(0)
    buffer_store_dwordx4 v[172:175], v13, s[8:11], s6 offen offset:0 sc1
    buffer_store_dwordx4 v[176:179], v13, s[8:11], s6 offen offset:1024 sc1
    buffer_store_dwordx4 v[180:183], v13, s[8:11], s6 offen offset:2048 sc1
    buffer_store_dwordx4 v[184:187], v13, s[8:11], s6 offen offset:3072 sc1
    buffer_store_dwordx4 v[188:191], v13, s[8:11], s7 offen offset:0 sc1
    s_branch L_wb
L_w2:
    s_cmp_lg_u32 s3, 0
    s_cbranch_scc1 L_wb
    s_mov_b32 s28, s56
    s_mov_b32 s29, s57
    s_mov_b32 s30, 0x100
    s_mov_b32 s31, 0x20000
    v_mov_b32 v2, 1
    v_lshlrev_b32 v3, 8, v1
    s_and_b32 s6, s2, 31
    s_lshl_b32 s6, s6, 2
    buffer_atomic_add v2, v3, s[28:31], s6 offen offset:128 sc1
    s_branch L_wb
L_xa:
    s_cmp_lg_u32 s90, 0
    s_cbranch_scc1 L_xa1
    s_mov_b32 s28, s56
    s_mov_b32 s29, s57
    s_mov_b32 s30, 0x100
    s_mov_b32 s31, 0x20000
    v_and_b32 v3, 31, v1
    v_lshlrev_b32 v3, 2, v3
    s_mov_b32 s79, 262144
L_poll_47:
    buffer_load_dword v2, v3, s[28:31], 0 offen offset:128 sc1
    s_waitcnt vmcnt(0)
    v_cmp_gt_u32 vcc, 4, v2
    s_cbranch_vccz L_polldone_48
    s_sleep 8
    s_sub_u32 s79, s79, 1
    s_cmp_lg_u32 s79, 0
    s_cbranch_scc1 L_poll_47
L_polldone_48:
L_xa1:
    s_lshr_b32 s74, s4, 3
    s_lshl_b32 s74, s74, 2
    s_add_u32 s74, s74, s76
    s_mul_i32 s74, s74, 327680
    s_and_b32 s7, s4, 3
    s_mul_i32 s7, s7, 10240
    s_add_u32 s74, s74, s7
    s_add_u32 s74, s74, 4199424
    s_add_u32 s6, s76, 0
    s_and_b32 s6, s6, 3
    s_lshl_b32 s6, s6, 10
    s_add_u32 s84, s6, s74
    s_add_u32 s6, s76, 1
    s_and_b32 s6, s6, 3
    s_lshl_b32 s6, s6, 10
    s_add_u32 s85, s6, s74
    s_add_u32 s6, s76, 2
    s_and_b32 s6, s6, 3
    s_lshl_b32 s6, s6, 10
    s_add_u32 s86, s6, s74
    s_add_u32 s6, s76, 3
    s_and_b32 s6, s6, 3
    s_lshl_b32 s6, s6, 10
    s_add_u32 s87, s6, s74
    s_add_u32 s88, s74, 4096
    s_lshl_b32 s73, s3, 13
    s_add_u32 s75, s73, s78
    s_add_u32 m0, s73, 131072
    s_add_u32 s7, s84, 0
    buffer_load_dwordx4 v13, s[8:11], s7 offen sc1 lds
    s_add_u32 m0, s73, 132096
    s_add_u32 s7, s85, 0
    buffer_load_dwordx4 v13, s[8:11], s7 offen sc1 lds
    s_add_u32 m0, s73, 133120
    s_add_u32 s7, s86, 0
    buffer_load_dwordx4 v13, s[8:11], s7 offen sc1 lds
    s_add_u32 m0, s73, 134144
    s_add_u32 s7, s87, 0
    buffer_load_dwordx4 v13, s[8:11], s7 offen sc1 lds
    s_add_u32 m0, s73, 135168
    s_add_u32 s7, s88, 0
    buffer_load_dwordx4 v13, s[8:11], s7 offen sc1 lds
    s_add_u32 m0, s73, 136192
    s_add_u32 s7, s84, 40960
    buffer_load_dwordx4 v13, s[8:11], s7 offen sc1 lds
    s_add_u32 m0, s73, 137216
    s_add_u32 s7, s85, 40960
    buffer_load_dwordx4 v13, s[8:11], s7 offen sc1 lds
    s_add_u32 m0, s73, 138240
    s_add_u32 s7, s86, 40960
    buffer_load_dwordx4 v13, s[8:11], s7 offen sc1 lds
    s_add_u32 m0, s75, 0
    s_add_u32 s7, s87, 40960
    buffer_load_dwordx4 v13, s[8:11], s7 offen sc1 lds
    s_add_u32 m0, s75, 1024
    s_add_u32 s7, s88, 40960
    buffer_load_dwordx4 v13, s[8:11], s7 offen sc1 lds
    s_add_u32 m0, s75, 2048
    s_add_u32 s7, s84, 81920
    buffer_load_dwordx4 v13, s[8:11], s7 offen sc1 lds
    s_add_u32 m0, s75, 3072
    s_add_u32 s7, s85, 81920
    buffer_load_dwordx4 v13, s[8:11], s7 offen sc1 lds
    s_add_u32 m0, s75, 4096
    s_add_u32 s7, s86, 81920
    buffer_load_dwordx4 v13, s[8:11], s7 offen sc1 lds
    s_add_u32 m0, s75, 5120
    s_add_u32 s7, s87, 81920
    buffer_load_dwordx4 v13, s[8:11], s7 offen sc1 lds
    s_add_u32 m0, s75, 6144
    s_add_u32 s7, s88, 81920
    buffer_load_dwordx4 v13, s[8:11], s7 offen sc1 lds
    s_add_u32 m0, s75, 7168
    s_add_u32 s7, s84, 122880
    buffer_load_dwordx4 v13, s[8:11], s7 offen sc1 lds
    s_lshl_b32 s75, s3, 12
    s_add_u32 s75, s75, s78
    s_add_u32 m0, s75, 49152
    s_add_u32 s7, s85, 122880
    buffer_load_dwordx4 v13, s[8:11], s7 offen sc1 lds
    s_add_u32 m0, s75, 50176
    s_add_u32 s7, s86, 122880
    buffer_load_dwordx4 v13, s[8:11], s7 offen sc1 lds
    s_add_u32 m0, s75, 51200
    s_add_u32 s7, s87, 122880
    buffer_load_dwordx4 v13, s[8:11], s7 offen sc1 lds
    s_add_u32 m0, s75, 52224
    s_add_u32 s7, s88, 122880
    buffer_load_dwordx4 v13, s[8:11], s7 offen sc1 lds
    s_setpc_b64 s[82:83]
L_x3:
    s_mov_b32 s12, s48
    s_mov_b32 s13, s49
    s_mov_b32 s14, 0x21c000
    s_mov_b32 s15, 0x20000
    s_cmp_eq_u32 s3, 3
    s_cbranch_scc1 L_load_r
    s_cmp_eq_u32 s3, 1
    s_cselect_b32 s12, s50, s12
    s_cselect_b32 s13, s51, s13
    s_cmp_eq_u32 s3, 2
    s_cselect_b32 s12, s52, s12
    s_cselect_b32 s13, s53, s13
    s_mov_b32 s73, 3456
    s_cmov_b32 s73, 256
    s_mov_b32 s75, 256
    s_cmov_b32 s75, 163840
    s_lshr_b32 s6, s2, 3
    s_sub_u32 s6, s6, 16
    s_mul_i32 s6, s6, 40
    v_lshrrev_b32 v2, 2, v1
    v_add_u32 v2, s6, v2
    v_mul_lo_u32 v2, v2, s73
    v_and_b32 v3, 3, v1
    v_lshl_add_u32 v2, v3, 6, v2
    s_xor_b32 s79, s79, 1
    s_lshl_b32 s6, s79, 3
    s_lshr_b32 s7, s4, 2
    s_add_u32 s6, s6, s7
    s_mul_i32 s6, s6, s75
    v_mov_b32 v3, 0x5000000
    v_cmp_gt_u32 vcc, 32, v1
    s_lshl_b32 s73, s73, 4
    s_nop 0
    v_cndmask_b32 v3, v3, v2, vcc
    buffer_load_dword v11, v2, s[12:15], s6 offen
    s_add_u32 s7, s6, s73
    buffer_load_dword v11, v2, s[12:15], s7 offen
    s_add_u32 s7, s7, s73
    buffer_load_dword v11, v3, s[12:15], s7 offen
    s_setpc_b64 s[82:83]
L_mask:
    v_and_b32 v2, 15, v1
    v_lshrrev_b32 v3, 4, v1
    v_lshlrev_b32 v3, 2, v3
    v_sub_u32 v2, v2, v3
    v_mov_b32 v3, 0xff800000
    v_cmp_gt_i32 vcc, 0, v2
    v_mov_b32 v152, v3
    s_nop 0
    v_cndmask_b32 v144, v144, v3, vcc
    v_cndmask_b32 v156, v156, v3, vcc
    v_cmp_gt_i32 vcc, 1, v2
    v_mov_b32 v153, v3
    s_nop 0
    v_cndmask_b32 v145, v145, v3, vcc
    v_cndmask_b32 v157, v157, v3, vcc
    v_cmp_gt_i32 vcc, 2, v2
    v_mov_b32 v154, v3
    s_nop 0
    v_cndmask_b32 v146, v146, v3, vcc
    v_cndmask_b32 v158, v158, v3, vcc
    v_cmp_gt_i32 vcc, 3, v2
    v_mov_b32 v155, v3
    s_nop 0
    v_cndmask_b32 v147, v147, v3, vcc
    v_cndmask_b32 v159, v159, v3, vcc
    s_nop 1
    s_setpc_b64 s[82:83]
L_rare0:
    s_nop 15
    v_max_f32 v62, v64, v65
    v_max3_f32 v62, v62, v66, v67
    v_max3_f32 v62, v62, v72, v73
    v_max3_f32 v62, v62, v74, v75
    v_mov_b32 v58, v62
    s_nop 1
    v_permlane16_swap_b32 v62, v58
    s_nop 1
    v_max_f32 v62, v62, v58
    v_mov_b32 v58, v62
    s_nop 1
    v_permlane32_swap_b32 v62, v58
    s_nop 1
    v_max_f32 v62, v62, v58
    v_add_f32 v62, 0x41c00000, v62
    v_max_f32 v62, 0, v62
    v_exp_f32 v58, -v62
    v_sub_f32 v64, v64, v62
    v_sub_f32 v80, v80, v62
    v_sub_f32 v144, v144, v62
    v_sub_f32 v65, v65, v62
    v_sub_f32 v81, v81, v62
    v_sub_f32 v145, v145, v62
    v_sub_f32 v66, v66, v62
    v_sub_f32 v82, v82, v62
    v_sub_f32 v146, v146, v62
    v_sub_f32 v67, v67, v62
    v_sub_f32 v83, v83, v62
    v_sub_f32 v147, v147, v62
    v_sub_f32 v72, v72, v62
    v_sub_f32 v88, v88, v62
    v_sub_f32 v152, v152, v62
    v_sub_f32 v73, v73, v62
    v_sub_f32 v89, v89, v62
    v_sub_f32 v153, v153, v62
    v_sub_f32 v74, v74, v62
    v_sub_f32 v90, v90, v62
    v_sub_f32 v154, v154, v62
    v_sub_f32 v75, v75, v62
    v_sub_f32 v91, v91, v62
    v_sub_f32 v155, v155, v62
    v_mul_f32 v160, v58, v160
    v_mul_f32 v161, v58, v161
    v_mul_f32 v162, v58, v162
    v_mul_f32 v163, v58, v163
    v_mul_f32 v192, v58, v192
    v_mul_f32 v193, v58, v193
    v_mul_f32 v194, v58, v194
    v_mul_f32 v195, v58, v195
    v_mul_f32 v200, v58, v200
    v_mul_f32 v201, v58, v201
    v_mul_f32 v202, v58, v202
    v_mul_f32 v203, v58, v203
    v_mul_f32 v208, v58, v208
    v_mul_f32 v209, v58, v209
    v_mul_f32 v210, v58, v210
    v_mul_f32 v211, v58, v211
    v_mul_f32 v216, v58, v216
    v_mul_f32 v217, v58, v217
    v_mul_f32 v218, v58, v218
    v_mul_f32 v219, v58, v219
    v_mul_f32 v224, v58, v224
    v_mul_f32 v225, v58, v225
    v_mul_f32 v226, v58, v226
    v_mul_f32 v227, v58, v227
    v_mul_f32 v232, v58, v232
    v_mul_f32 v233, v58, v233
    v_mul_f32 v234, v58, v234
    v_mul_f32 v235, v58, v235
    v_mul_f32 v240, v58, v240
    v_mul_f32 v241, v58, v241
    v_mul_f32 v242, v58, v242
    v_mul_f32 v243, v58, v243
    v_mul_f32 v248, v58, v248
    v_mul_f32 v249, v58, v249
    v_mul_f32 v250, v58, v250
    v_mul_f32 v251, v58, v251
    v_max_f32 v62, v68, v69
    v_max3_f32 v62, v62, v70, v71
    v_max3_f32 v62, v62, v76, v77
    v_max3_f32 v62, v62, v78, v79
    v_mov_b32 v58, v62
    s_nop 1
    v_permlane16_swap_b32 v62, v58
    s_nop 1
    v_max_f32 v62, v62, v58
    v_mov_b32 v58, v62
    s_nop 1
    v_permlane32_swap_b32 v62, v58
    s_nop 1
    v_max_f32 v62, v62, v58
    v_add_f32 v62, 0x41c00000, v62
    v_max_f32 v62, 0, v62
    v_exp_f32 v58, -v62
    v_sub_f32 v68, v68, v62
    v_sub_f32 v84, v84, v62
    v_sub_f32 v148, v148, v62
    v_sub_f32 v69, v69, v62
    v_sub_f32 v85, v85, v62
    v_sub_f32 v149, v149, v62
    v_sub_f32 v70, v70, v62
    v_sub_f32 v86, v86, v62
    v_sub_f32 v150, v150, v62
    v_sub_f32 v71, v71, v62
    v_sub_f32 v87, v87, v62
    v_sub_f32 v151, v151, v62
    v_sub_f32 v76, v76, v62
    v_sub_f32 v92, v92, v62
    v_sub_f32 v156, v156, v62
    v_sub_f32 v77, v77, v62
    v_sub_f32 v93, v93, v62
    v_sub_f32 v157, v157, v62
    v_sub_f32 v78, v78, v62
    v_sub_f32 v94, v94, v62
    v_sub_f32 v158, v158, v62
    v_sub_f32 v79, v79, v62
    v_sub_f32 v95, v95, v62
    v_sub_f32 v159, v159, v62
    v_mul_f32 v164, v58, v164
    v_mul_f32 v165, v58, v165
    v_mul_f32 v166, v58, v166
    v_mul_f32 v167, v58, v167
    v_mul_f32 v196, v58, v196
    v_mul_f32 v197, v58, v197
    v_mul_f32 v198, v58, v198
    v_mul_f32 v199, v58, v199
    v_mul_f32 v204, v58, v204
    v_mul_f32 v205, v58, v205
    v_mul_f32 v206, v58, v206
    v_mul_f32 v207, v58, v207
    v_mul_f32 v212, v58, v212
    v_mul_f32 v213, v58, v213
    v_mul_f32 v214, v58, v214
    v_mul_f32 v215, v58, v215
    v_mul_f32 v220, v58, v220
    v_mul_f32 v221, v58, v221
    v_mul_f32 v222, v58, v222
    v_mul_f32 v223, v58, v223
    v_mul_f32 v228, v58, v228
    v_mul_f32 v229, v58, v229
    v_mul_f32 v230, v58, v230
    v_mul_f32 v231, v58, v231
    v_mul_f32 v236, v58, v236
    v_mul_f32 v237, v58, v237
    v_mul_f32 v238, v58, v238
    v_mul_f32 v239, v58, v239
    v_mul_f32 v244, v58, v244
    v_mul_f32 v245, v58, v245
    v_mul_f32 v246, v58, v246
    v_mul_f32 v247, v58, v247
    v_mul_f32 v252, v58, v252
    v_mul_f32 v253, v58, v253
    v_mul_f32 v254, v58, v254
    v_mul_f32 v255, v58, v255
    v_exp_f32 v58, v64
    s_nop 0
    v_exp_f32 v59, v65
    s_nop 0
    v_cvt_pk_bf16_f32 v128, v58, v59
    v_exp_f32 v60, v66
    s_nop 0
    v_exp_f32 v61, v67
    s_nop 0
    v_cvt_pk_bf16_f32 v129, v60, v61
    v_exp_f32 v58, v68
    s_nop 0
    v_exp_f32 v59, v69
    s_nop 0
    v_cvt_pk_bf16_f32 v132, v58, v59
    v_exp_f32 v60, v70
    s_nop 0
    v_exp_f32 v61, v71
    s_nop 0
    v_cvt_pk_bf16_f32 v133, v60, v61
    v_exp_f32 v58, v72
    s_nop 0
    v_exp_f32 v59, v73
    s_nop 0
    v_cvt_pk_bf16_f32 v130, v58, v59
    v_exp_f32 v60, v74
    s_nop 0
    v_exp_f32 v61, v75
    s_nop 0
    v_cvt_pk_bf16_f32 v131, v60, v61
    v_exp_f32 v58, v76
    s_nop 0
    v_exp_f32 v59, v77
    s_nop 0
    v_cvt_pk_bf16_f32 v134, v58, v59
    v_exp_f32 v60, v78
    s_nop 0
    v_exp_f32 v61, v79
    s_nop 0
    v_cvt_pk_bf16_f32 v135, v60, v61
    s_nop 1
    s_setpc_b64 s[80:81]
L_rare1:
    s_nop 15
    v_max_f32 v62, v80, v81
    v_max3_f32 v62, v62, v82, v83
    v_max3_f32 v62, v62, v88, v89
    v_max3_f32 v62, v62, v90, v91
    v_mov_b32 v58, v62
    s_nop 1
    v_permlane16_swap_b32 v62, v58
    s_nop 1
    v_max_f32 v62, v62, v58
    v_mov_b32 v58, v62
    s_nop 1
    v_permlane32_swap_b32 v62, v58
    s_nop 1
    v_max_f32 v62, v62, v58
    v_add_f32 v62, 0x41c00000, v62
    v_max_f32 v62, 0, v62
    v_exp_f32 v58, -v62
    v_sub_f32 v64, v64, v62
    v_sub_f32 v80, v80, v62
    v_sub_f32 v144, v144, v62
    v_sub_f32 v65, v65, v62
    v_sub_f32 v81, v81, v62
    v_sub_f32 v145, v145, v62
    v_sub_f32 v66, v66, v62
    v_sub_f32 v82, v82, v62
    v_sub_f32 v146, v146, v62
    v_sub_f32 v67, v67, v62
    v_sub_f32 v83, v83, v62
    v_sub_f32 v147, v147, v62
    v_sub_f32 v72, v72, v62
    v_sub_f32 v88, v88, v62
    v_sub_f32 v152, v152, v62
    v_sub_f32 v73, v73, v62
    v_sub_f32 v89, v89, v62
    v_sub_f32 v153, v153, v62
    v_sub_f32 v74, v74, v62
    v_sub_f32 v90, v90, v62
    v_sub_f32 v154, v154, v62
    v_sub_f32 v75, v75, v62
    v_sub_f32 v91, v91, v62
    v_sub_f32 v155, v155, v62
    v_mul_f32 v160, v58, v160
    v_mul_f32 v161, v58, v161
    v_mul_f32 v162, v58, v162
    v_mul_f32 v163, v58, v163
    v_mul_f32 v192, v58, v192
    v_mul_f32 v193, v58, v193
    v_mul_f32 v194, v58, v194
    v_mul_f32 v195, v58, v195
    v_mul_f32 v200, v58, v200
    v_mul_f32 v201, v58, v201
    v_mul_f32 v202, v58, v202
    v_mul_f32 v203, v58, v203
    v_mul_f32 v208, v58, v208
    v_mul_f32 v209, v58, v209
    v_mul_f32 v210, v58, v210
    v_mul_f32 v211, v58, v211
    v_mul_f32 v216, v58, v216
    v_mul_f32 v217, v58, v217
    v_mul_f32 v218, v58, v218
    v_mul_f32 v219, v58, v219
    v_mul_f32 v224, v58, v224
    v_mul_f32 v225, v58, v225
    v_mul_f32 v226, v58, v226
    v_mul_f32 v227, v58, v227
    v_mul_f32 v232, v58, v232
    v_mul_f32 v233, v58, v233
    v_mul_f32 v234, v58, v234
    v_mul_f32 v235, v58, v235
    v_mul_f32 v240, v58, v240
    v_mul_f32 v241, v58, v241
    v_mul_f32 v242, v58, v242
    v_mul_f32 v243, v58, v243
    v_mul_f32 v248, v58, v248
    v_mul_f32 v249, v58, v249
    v_mul_f32 v250, v58, v250
    v_mul_f32 v251, v58, v251
    v_max_f32 v62, v84, v85
    v_max3_f32 v62, v62, v86, v87
    v_max3_f32 v62, v62, v92, v93
    v_max3_f32 v62, v62, v94, v95
    v_mov_b32 v58, v62
    s_nop 1
    v_permlane16_swap_b32 v62, v58
    s_nop 1
    v_max_f32 v62, v62, v58
    v_mov_b32 v58, v62
    s_nop 1
    v_permlane32_swap_b32 v62, v58
    s_nop 1
    v_max_f32 v62, v62, v58
    v_add_f32 v62, 0x41c00000, v62
    v_max_f32 v62, 0, v62
    v_exp_f32 v58, -v62
    v_sub_f32 v68, v68, v62
    v_sub_f32 v84, v84, v62
    v_sub_f32 v148, v148, v62
    v_sub_f32 v69, v69, v62
    v_sub_f32 v85, v85, v62
    v_sub_f32 v149, v149, v62
    v_sub_f32 v70, v70, v62
    v_sub_f32 v86, v86, v62
    v_sub_f32 v150, v150, v62
    v_sub_f32 v71, v71, v62
    v_sub_f32 v87, v87, v62
    v_sub_f32 v151, v151, v62
    v_sub_f32 v76, v76, v62
    v_sub_f32 v92, v92, v62
    v_sub_f32 v156, v156, v62
    v_sub_f32 v77, v77, v62
    v_sub_f32 v93, v93, v62
    v_sub_f32 v157, v157, v62
    v_sub_f32 v78, v78, v62
    v_sub_f32 v94, v94, v62
    v_sub_f32 v158, v158, v62
    v_sub_f32 v79, v79, v62
    v_sub_f32 v95, v95, v62
    v_sub_f32 v159, v159, v62
    v_mul_f32 v164, v58, v164
    v_mul_f32 v165, v58, v165
    v_mul_f32 v166, v58, v166
    v_mul_f32 v167, v58, v167
    v_mul_f32 v196, v58, v196
    v_mul_f32 v197, v58, v197
    v_mul_f32 v198, v58, v198
    v_mul_f32 v199, v58, v199
    v_mul_f32 v204, v58, v204
    v_mul_f32 v205, v58, v205
    v_mul_f32 v206, v58, v206
    v_mul_f32 v207, v58, v207
    v_mul_f32 v212, v58, v212
    v_mul_f32 v213, v58, v213
    v_mul_f32 v214, v58, v214
    v_mul_f32 v215, v58, v215
    v_mul_f32 v220, v58, v220
    v_mul_f32 v221, v58, v221
    v_mul_f32 v222, v58, v222
    v_mul_f32 v223, v58, v223
    v_mul_f32 v228, v58, v228
    v_mul_f32 v229, v58, v229
    v_mul_f32 v230, v58, v230
    v_mul_f32 v231, v58, v231
    v_mul_f32 v236, v58, v236
    v_mul_f32 v237, v58, v237
    v_mul_f32 v238, v58, v238
    v_mul_f32 v239, v58, v239
    v_mul_f32 v244, v58, v244
    v_mul_f32 v245, v58, v245
    v_mul_f32 v246, v58, v246
    v_mul_f32 v247, v58, v247
    v_mul_f32 v252, v58, v252
    v_mul_f32 v253, v58, v253
    v_mul_f32 v254, v58, v254
    v_mul_f32 v255, v58, v255
    v_exp_f32 v58, v80
    s_nop 0
    v_exp_f32 v59, v81
    s_nop 0
    v_cvt_pk_bf16_f32 v136, v58, v59
    v_exp_f32 v60, v82
    s_nop 0
    v_exp_f32 v61, v83
    s_nop 0
    v_cvt_pk_bf16_f32 v137, v60, v61
    v_exp_f32 v58, v84
    s_nop 0
    v_exp_f32 v59, v85
    s_nop 0
    v_cvt_pk_bf16_f32 v140, v58, v59
    v_exp_f32 v60, v86
    s_nop 0
    v_exp_f32 v61, v87
    s_nop 0
    v_cvt_pk_bf16_f32 v141, v60, v61
    v_exp_f32 v58, v88
    s_nop 0
    v_exp_f32 v59, v89
    s_nop 0
    v_cvt_pk_bf16_f32 v138, v58, v59
    v_exp_f32 v60, v90
    s_nop 0
    v_exp_f32 v61, v91
    s_nop 0
    v_cvt_pk_bf16_f32 v139, v60, v61
    v_exp_f32 v58, v92
    s_nop 0
    v_exp_f32 v59, v93
    s_nop 0
    v_cvt_pk_bf16_f32 v142, v58, v59
    v_exp_f32 v60, v94
    s_nop 0
    v_exp_f32 v61, v95
    s_nop 0
    v_cvt_pk_bf16_f32 v143, v60, v61
    s_nop 1
    s_setpc_b64 s[80:81]
L_adone:
    ds_read_b128 v[16:19], v4 offset:0
    ds_read_b128 v[20:23], v4 offset:1024
    ds_read_b128 v[24:27], v4 offset:2048
    ds_read_b128 v[28:31], v4 offset:3072
    s_waitcnt lgkmcnt(3)
    v_mfma_f32_16x16x32_bf16 v[56:59], v[96:99], v[16:19], 0
    s_lshr_b32 s6, s3, 2
    s_mul_i32 s67, s6, 15360
    s_add_u32 s67, s67, 98304
    v_mfma_f32_16x16x32_bf16 v[60:63], v[100:103], v[16:19], 0
    v_add_u32 v6, s67, v44
    s_mul_i32 s73, s6, 5120
    s_add_u32 s73, s73, 67108864
    v_mfma_f32_16x16x32_bf16 v[64:67], v[104:107], v[16:19], 0
    s_lshl_b32 s6, s6, 1
    s_sub_u32 s71, s76, s6
    s_and_b32 s71, s71, 3
    v_mfma_f32_16x16x32_bf16 v[68:71], v[108:111], v[16:19], 0
    s_waitcnt lgkmcnt(2)
    v_mov_b32 v11, 0x5000000
    s_lshl_b32 s74, s3, 2
    s_add_u32 s74, s74, 15728640
    v_mfma_f32_16x16x32_bf16 v[72:75], v[112:115], v[16:19], 0
    ds_read_b128 v[16:19], v4 offset:4096
    s_and_b32 s72, s4, 7
    s_lshl_b32 s7, s5, 3
    s_add_u32 s72, s72, s7
    v_mfma_f32_16x16x32_bf16 v[56:59], v[116:119], v[20:23], v[56:59]
    s_mul_i32 s72, s72, 12
    s_lshr_b32 s75, s4, 3
    s_mul_i32 s7, s75, 3
    v_mfma_f32_16x16x32_bf16 v[60:63], v[120:123], v[20:23], v[60:63]
    s_add_u32 s7, s7, s72
    s_mul_i32 s62, s7, 20480
    s_add_u32 s62, s62, 67108864
    v_mfma_f32_16x16x32_bf16 v[64:67], v[124:127], v[20:23], v[64:67]
    s_lshl_b32 s7, s7, 7
    s_add_u32 s63, s7, 15728640
    s_add_u32 s6, s75, 1
    v_mfma_f32_16x16x32_bf16 v[68:71], v[128:131], v[20:23], v[68:71]
    s_waitcnt lgkmcnt(2)
    s_and_b32 s6, s6, 3
    s_mul_i32 s6, s6, 3
    s_add_u32 s6, s6, s72
    v_mfma_f32_16x16x32_bf16 v[72:75], v[132:135], v[20:23], v[72:75]
    ds_read_b128 v[20:23], v4 offset:5120
    s_add_u32 s6, s6, 0
    s_mul_i32 s7, s6, 20480
    s_add_u32 s96, s7, s73
    v_mfma_f32_16x16x32_bf16 v[72:75], v[152:155], v[24:27], v[72:75]
    s_lshl_b32 s6, s6, 7
    s_add_u32 s6, s6, s74
    v_writelane_b32 v11, s6, 0
    v_mfma_f32_16x16x32_bf16 v[68:71], v[148:151], v[24:27], v[68:71]
    s_add_u32 s6, s75, 2
    s_and_b32 s6, s6, 3
    s_mul_i32 s6, s6, 3
    v_mfma_f32_16x16x32_bf16 v[64:67], v[144:147], v[24:27], v[64:67]
    s_add_u32 s6, s6, s72
    s_add_u32 s6, s6, 1
    s_mul_i32 s7, s6, 20480
    v_mfma_f32_16x16x32_bf16 v[60:63], v[140:143], v[24:27], v[60:63]
    s_waitcnt lgkmcnt(2)
    s_add_u32 s97, s7, s73
    s_lshl_b32 s6, s6, 7
    s_add_u32 s6, s6, s74
    v_mfma_f32_16x16x32_bf16 v[56:59], v[136:139], v[24:27], v[56:59]
    ds_read_b128 v[24:27], v4 offset:6144
    v_writelane_b32 v11, s6, 1
    s_add_u32 s6, s75, 3
    s_and_b32 s6, s6, 3
    v_mfma_f32_16x16x32_bf16 v[56:59], v[156:159], v[28:31], v[56:59]
    s_mul_i32 s6, s6, 3
    s_add_u32 s6, s6, s72
    s_add_u32 s6, s6, 2
    v_mfma_f32_16x16x32_bf16 v[60:63], v[160:163], v[28:31], v[60:63]
    s_mul_i32 s7, s6, 20480
    s_add_u32 s98, s7, s73
    s_lshl_b32 s6, s6, 7
    v_mfma_f32_16x16x32_bf16 v[64:67], v[164:167], v[28:31], v[64:67]
    s_add_u32 s6, s6, s74
    v_writelane_b32 v11, s6, 2
    v_mfma_f32_16x16x32_bf16 v[68:71], v[168:171], v[28:31], v[68:71]
    s_waitcnt lgkmcnt(2)
    v_mfma_f32_16x16x32_bf16 v[72:75], v[172:175], v[28:31], v[72:75]
    ds_read_b128 v[28:31], v4 offset:7168
    s_waitcnt vmcnt(0)
    v_mfma_f32_16x16x32_bf16 v[72:75], v[192:195], v[16:19], v[72:75]
    v_mfma_f32_16x16x32_bf16 v[68:71], v[188:191], v[16:19], v[68:71]
    s_add_u32 s65, s68, 3
    s_and_b32 s65, s65, 3
    s_andn2_b32 s7, s68, 3
    v_mfma_f32_16x16x32_bf16 v[64:67], v[184:187], v[16:19], v[64:67]
    s_add_u32 s65, s65, s7
    s_lshl_b32 s65, s65, 17
    s_add_u32 s65, s65, s66
    v_mfma_f32_16x16x32_bf16 v[60:63], v[180:183], v[16:19], v[60:63]
    s_waitcnt lgkmcnt(2)
    s_add_u32 m0, s99, 65536
    v_mfma_f32_16x16x32_bf16 v[56:59], v[176:179], v[16:19], v[56:59]
    s_cmp_ge_u32 s3, 4
    s_cbranch_scc1 L_o0
    s_waitcnt vmcnt(0)
    s_barrier
L_o0:
    ds_read_b128 v[16:19], v4 offset:32768
    v_mfma_f32_16x16x32_bf16 v[56:59], v[196:199], v[20:23], v[56:59]
    buffer_load_dwordx4 v13, s[8:11], s65 offen offset:0 sc1 lds
    v_mfma_f32_16x16x32_bf16 v[60:63], v[200:203], v[20:23], v[60:63]
    buffer_load_dwordx4 v13, s[8:11], s65 offen offset:1024 sc1 lds
    v_mfma_f32_16x16x32_bf16 v[64:67], v[204:207], v[20:23], v[64:67]
    v_mfma_f32_16x16x32_bf16 v[68:71], v[208:211], v[20:23], v[68:71]
    buffer_load_dwordx4 v13, s[8:11], s65 offen offset:2048 sc1 lds
    s_waitcnt lgkmcnt(2)
    v_mfma_f32_16x16x32_bf16 v[72:75], v[212:215], v[20:23], v[72:75]
    ds_read_b128 v[20:23], v4 offset:33792
    v_mfma_f32_16x16x32_bf16 v[72:75], v[232:235], v[24:27], v[72:75]
    buffer_load_dwordx4 v13, s[8:11], s65 offen offset:3072 sc1 lds
    v_mfma_f32_16x16x32_bf16 v[68:71], v[228:231], v[24:27], v[68:71]
    v_mfma_f32_16x16x32_bf16 v[64:67], v[224:227], v[24:27], v[64:67]
    v_mfma_f32_16x16x32_bf16 v[60:63], v[220:223], v[24:27], v[60:63]
    s_waitcnt lgkmcnt(2)
    v_mfma_f32_16x16x32_bf16 v[56:59], v[216:219], v[24:27], v[56:59]
    ds_read_b128 v[24:27], v4 offset:34816
    v_mfma_f32_16x16x32_bf16 v[56:59], v[236:239], v[28:31], v[56:59]
    v_mfma_f32_16x16x32_bf16 v[60:63], v[240:243], v[28:31], v[60:63]
    v_mfma_f32_16x16x32_bf16 v[64:67], v[244:247], v[28:31], v[64:67]
    v_mfma_f32_16x16x32_bf16 v[68:71], v[248:251], v[28:31], v[68:71]
    s_waitcnt lgkmcnt(2)
    v_mfma_f32_16x16x32_bf16 v[72:75], v[252:255], v[28:31], v[72:75]
    ds_read_b128 v[28:31], v4 offset:35840
    v_mfma_f32_16x16x32_bf16 v[76:79], v[96:99], v[16:19], 0
    s_sub_u32 s6, s71, 1
    s_and_b32 s6, s6, 3
    s_mul_i32 s7, s6, 5120
    v_mfma_f32_16x16x32_bf16 v[80:83], v[100:103], v[16:19], 0
    s_add_u32 s7, s7, s67
    s_cmp_eq_u32 s6, 3
    s_cselect_b32 s7, 155648, s7
    v_mfma_f32_16x16x32_bf16 v[84:87], v[104:107], v[16:19], 0
    v_add_u32 v12, s7, v52
    v_add_u32 v5, s67, v45
    v_mfma_f32_16x16x32_bf16 v[88:91], v[108:111], v[16:19], 0
    s_waitcnt lgkmcnt(2)
    v_mfma_f32_16x16x32_bf16 v[92:95], v[112:115], v[16:19], 0
    ds_read_b128 v[16:19], v4 offset:36864
    v_mfma_f32_16x16x32_bf16 v[76:79], v[116:119], v[20:23], v[76:79]
    ds_write_b128 v5, v[60:63] offset:0
    v_add_u32 v5, s67, v46
    v_mfma_f32_16x16x32_bf16 v[80:83], v[120:123], v[20:23], v[80:83]
    v_mfma_f32_16x16x32_bf16 v[84:87], v[124:127], v[20:23], v[84:87]
    v_mfma_f32_16x16x32_bf16 v[88:91], v[128:131], v[20:23], v[88:91]
    s_waitcnt lgkmcnt(3)
    v_mfma_f32_16x16x32_bf16 v[92:95], v[132:135], v[20:23], v[92:95]
    ds_read_b128 v[20:23], v4 offset:37888
    v_mfma_f32_16x16x32_bf16 v[92:95], v[152:155], v[24:27], v[92:95]
    ds_write_b128 v5, v[64:67] offset:5120
    v_add_u32 v5, s67, v47
    v_mfma_f32_16x16x32_bf16 v[88:91], v[148:151], v[24:27], v[88:91]
    v_mfma_f32_16x16x32_bf16 v[84:87], v[144:147], v[24:27], v[84:87]
    v_mfma_f32_16x16x32_bf16 v[80:83], v[140:143], v[24:27], v[80:83]
    s_waitcnt lgkmcnt(4)
    v_mfma_f32_16x16x32_bf16 v[76:79], v[136:139], v[24:27], v[76:79]
    ds_read_b128 v[24:27], v4 offset:38912
    v_mfma_f32_16x16x32_bf16 v[76:79], v[156:159], v[28:31], v[76:79]
    ds_write_b128 v5, v[68:71] offset:10240
    v_add_u32 v5, s67, v52
    v_mfma_f32_16x16x32_bf16 v[80:83], v[160:163], v[28:31], v[80:83]
    v_mfma_f32_16x16x32_bf16 v[84:87], v[164:167], v[28:31], v[84:87]
    v_mfma_f32_16x16x32_bf16 v[88:91], v[168:171], v[28:31], v[88:91]
    s_waitcnt lgkmcnt(5)
    v_mfma_f32_16x16x32_bf16 v[92:95], v[172:175], v[28:31], v[92:95]
    ds_read_b128 v[28:31], v4 offset:39936
    v_mfma_f32_16x16x32_bf16 v[92:95], v[192:195], v[16:19], v[92:95]
    ds_write_b128 v12, v[72:75] offset:0
    v_mfma_f32_16x16x32_bf16 v[88:91], v[188:191], v[16:19], v[88:91]
    v_mfma_f32_16x16x32_bf16 v[84:87], v[184:187], v[16:19], v[84:87]
    v_and_b32 v3, 1, v1
    v_lshlrev_b32 v3, 12, v3
    s_lshr_b32 s72, s61, 2
    s_lshl_b32 s72, s72, 6
    s_andn2_b32 s6, s4, 7
    s_add_u32 s72, s72, s6
    s_add_u32 s72, s72, s3
    s_lshl_b32 s72, s72, 7
    s_add_u32 s72, s72, 3932160
    v_mfma_f32_16x16x32_bf16 v[80:83], v[180:183], v[16:19], v[80:83]
    s_waitcnt lgkmcnt(5)
    v_mfma_f32_16x16x32_bf16 v[76:79], v[176:179], v[16:19], v[76:79]
    s_waitcnt vmcnt(0)
    s_waitcnt lgkmcnt(0)
    s_barrier
    ds_read_b128 v[32:35], v6 offset:0
    ds_read_b128 v[36:39], v6 offset:5120
    ds_read_b128 v[40:43], v6 offset:10240
    ds_read_b128 v[16:19], v7 offset:0
    v_mfma_f32_16x16x32_bf16 v[76:79], v[196:199], v[20:23], v[76:79]
    v_mfma_f32_16x16x32_bf16 v[80:83], v[200:203], v[20:23], v[80:83]
    v_mfma_f32_16x16x32_bf16 v[84:87], v[204:207], v[20:23], v[84:87]
    s_waitcnt lgkmcnt(3)
    v_add_f32 v56, v56, v32
    v_add_f32 v57, v57, v33
    v_mfma_f32_16x16x32_bf16 v[88:91], v[208:211], v[20:23], v[88:91]
    v_add_f32 v58, v58, v34
    v_add_f32 v59, v59, v35
    v_mfma_f32_16x16x32_bf16 v[92:95], v[212:215], v[20:23], v[92:95]
    s_waitcnt lgkmcnt(2)
    ds_read_b128 v[32:35], v5 offset:0
    ds_read_b128 v[20:23], v7 offset:1024
    v_add_f32 v56, v56, v36
    v_add_f32 v57, v57, v37
    v_mfma_f32_16x16x32_bf16 v[92:95], v[232:235], v[24:27], v[92:95]
    buffer_load_dword v50, v3, s[8:11], s72 offen sc1
    v_add_f32 v58, v58, v38
    v_add_f32 v59, v59, v39
    v_mfma_f32_16x16x32_bf16 v[88:91], v[228:231], v[24:27], v[88:91]
    s_waitcnt lgkmcnt(3)
    ds_read_b128 v[36:39], v5 offset:5120
    v_add_f32 v56, v56, v40
    v_add_f32 v57, v57, v41
    v_mfma_f32_16x16x32_bf16 v[84:87], v[224:227], v[24:27], v[84:87]
    v_add_f32 v58, v58, v42
    v_add_f32 v59, v59, v43
    v_mfma_f32_16x16x32_bf16 v[80:83], v[220:223], v[24:27], v[80:83]
    ds_read_b128 v[40:43], v5 offset:10240
    s_waitcnt lgkmcnt(3)
    v_add_f32 v72, v72, v32
    v_add_f32 v73, v73, v33
    s_add_u32 s6, s96, 0
    v_mfma_f32_16x16x32_bf16 v[76:79], v[216:219], v[24:27], v[76:79]
    ds_read_b128 v[24:27], v7 offset:2048
    v_add_f32 v74, v74, v34
    v_add_f32 v75, v75, v35
    v_mfma_f32_16x16x32_bf16 v[76:79], v[236:239], v[28:31], v[76:79]
    buffer_store_dwordx4 v[56:59], v44, s[8:11], s6 offen sc1
    s_waitcnt lgkmcnt(2)
    v_add_f32 v72, v72, v36
    v_add_f32 v73, v73, v37
    v_mfma_f32_16x16x32_bf16 v[80:83], v[240:243], v[28:31], v[80:83]
    v_add_f32 v74, v74, v38
    v_add_f32 v75, v75, v39
    v_mfma_f32_16x16x32_bf16 v[84:87], v[244:247], v[28:31], v[84:87]
    s_waitcnt lgkmcnt(1)
    v_add_f32 v72, v72, v40
    v_add_f32 v73, v73, v41
    v_mfma_f32_16x16x32_bf16 v[88:91], v[248:251], v[28:31], v[88:91]
    v_add_f32 v74, v74, v42
    v_add_f32 v75, v75, v43
    s_cmp_lg_u32 s71, 0
    v_mfma_f32_16x16x32_bf16 v[92:95], v[252:255], v[28:31], v[92:95]
    s_cbranch_scc1 L_nost_49
    buffer_store_dwordx4 v[72:75], v52, s[8:11], s6 offen sc1
L_nost_49:
    ds_read_b128 v[28:31], v7 offset:3072
    v_mfma_f32_16x16x32_bf16 v[56:59], v[96:99], v[16:19], 0
    s_sub_u32 s6, s71, 2
    s_and_b32 s6, s6, 3
    s_mul_i32 s7, s6, 5120
    v_mfma_f32_16x16x32_bf16 v[60:63], v[100:103], v[16:19], 0
    s_add_u32 s7, s7, s67
    s_cmp_eq_u32 s6, 3
    s_cselect_b32 s7, 124928, s7
    v_mfma_f32_16x16x32_bf16 v[64:67], v[104:107], v[16:19], 0
    v_add_u32 v12, s7, v52
    v_add_u32 v5, s67, v45
    s_waitcnt vmcnt(1)
    v_cmp_ne_u32 vcc, 1, v50
    s_cbranch_vccz L_o1
    s_mov_b32 s79, 262144
L_poll_51:
    buffer_load_dword v2, v3, s[8:11], s72 offen sc1
    s_waitcnt vmcnt(0)
    v_cmp_ne_u32 vcc, 1, v2
    s_cbranch_vccz L_polldone_52
    s_sleep 1
    s_sub_u32 s79, s79, 1
    s_cmp_lg_u32 s79, 0
    s_cbranch_scc1 L_poll_51
L_polldone_52:
L_o1:
    v_mfma_f32_16x16x32_bf16 v[68:71], v[108:111], v[16:19], 0
    s_add_u32 s65, s61, 1
    s_and_b32 s65, s65, 3
    s_andn2_b32 s7, s61, 3
    v_mfma_f32_16x16x32_bf16 v[72:75], v[112:115], v[16:19], 0
    ds_read_b128 v[16:19], v7 offset:4096
    s_add_u32 s65, s65, s7
    s_lshl_b32 s65, s65, 17
    s_add_u32 s65, s65, s66
    v_mfma_f32_16x16x32_bf16 v[56:59], v[116:119], v[20:23], v[56:59]
    ds_write_b128 v5, v[80:83] offset:30720
    v_add_u32 v5, s67, v46
    s_add_u32 m0, s99, 0
    v_mfma_f32_16x16x32_bf16 v[60:63], v[120:123], v[20:23], v[60:63]
    buffer_load_dwordx4 v13, s[8:11], s65 offen offset:1024 sc1 lds
    buffer_load_dwordx4 v13, s[8:11], s65 offen offset:0 sc1 lds
    v_mfma_f32_16x16x32_bf16 v[64:67], v[124:127], v[20:23], v[64:67]
    buffer_load_dwordx4 v13, s[8:11], s65 offen offset:3072 sc1 lds
    buffer_load_dwordx4 v13, s[8:11], s65 offen offset:2048 sc1 lds
    v_mfma_f32_16x16x32_bf16 v[68:71], v[128:131], v[20:23], v[68:71]
    s_waitcnt lgkmcnt(3)
    s_add_u32 s65, s61, 2
    s_and_b32 s65, s65, 3
    s_andn2_b32 s7, s61, 3
    v_mfma_f32_16x16x32_bf16 v[72:75], v[132:135], v[20:23], v[72:75]
    ds_read_b128 v[20:23], v7 offset:5120
    s_add_u32 s65, s65, s7
    s_lshl_b32 s65, s65, 17
    s_add_u32 s65, s65, s66
    v_mfma_f32_16x16x32_bf16 v[72:75], v[152:155], v[24:27], v[72:75]
    ds_write_b128 v5, v[84:87] offset:35840
    v_add_u32 v5, s67, v47
    s_add_u32 m0, s99, 32768
    v_mfma_f32_16x16x32_bf16 v[68:71], v[148:151], v[24:27], v[68:71]
    buffer_load_dwordx4 v13, s[8:11], s65 offen offset:0 sc1 lds
    v_mfma_f32_16x16x32_bf16 v[64:67], v[144:147], v[24:27], v[64:67]
    buffer_load_dwordx4 v13, s[8:11], s65 offen offset:1024 sc1 lds
    v_mfma_f32_16x16x32_bf16 v[60:63], v[140:143], v[24:27], v[60:63]
    buffer_load_dwordx4 v13, s[8:11], s65 offen offset:2048 sc1 lds
    s_waitcnt lgkmcnt(4)
    v_mfma_f32_16x16x32_bf16 v[56:59], v[136:139], v[24:27], v[56:59]
    ds_read_b128 v[24:27], v7 offset:6144
    v_mfma_f32_16x16x32_bf16 v[56:59], v[156:159], v[28:31], v[56:59]
    ds_write_b128 v5, v[88:91] offset:40960
    v_add_u32 v5, s67, v52
    v_mfma_f32_16x16x32_bf16 v[60:63], v[160:163], v[28:31], v[60:63]
    buffer_load_dwordx4 v13, s[8:11], s65 offen offset:3072 sc1 lds
    v_mfma_f32_16x16x32_bf16 v[64:67], v[164:167], v[28:31], v[64:67]
    v_mfma_f32_16x16x32_bf16 v[68:71], v[168:171], v[28:31], v[68:71]
    s_waitcnt lgkmcnt(5)
    v_mfma_f32_16x16x32_bf16 v[72:75], v[172:175], v[28:31], v[72:75]
    ds_read_b128 v[28:31], v7 offset:7168
    v_mfma_f32_16x16x32_bf16 v[72:75], v[192:195], v[16:19], v[72:75]
    ds_write_b128 v12, v[92:95] offset:30720
    v_mfma_f32_16x16x32_bf16 v[68:71], v[188:191], v[16:19], v[68:71]
    s_add_u32 s65, s61, 3
    s_and_b32 s65, s65, 3
    s_andn2_b32 s7, s61, 3
    v_mfma_f32_16x16x32_bf16 v[64:67], v[184:187], v[16:19], v[64:67]
    s_add_u32 s65, s65, s7
    s_lshl_b32 s65, s65, 17
    s_add_u32 s65, s65, s66
    v_mfma_f32_16x16x32_bf16 v[60:63], v[180:183], v[16:19], v[60:63]
    s_waitcnt lgkmcnt(5)
    s_add_u32 m0, s99, 65536
    v_mfma_f32_16x16x32_bf16 v[56:59], v[176:179], v[16:19], v[56:59]
    s_waitcnt vmcnt(4)
    s_waitcnt lgkmcnt(0)
    s_barrier
    ds_read_b128 v[32:35], v6 offset:30720
    ds_read_b128 v[36:39], v6 offset:35840
    ds_read_b128 v[40:43], v6 offset:40960
    ds_read_b128 v[16:19], v4 offset:0
    v_mfma_f32_16x16x32_bf16 v[56:59], v[196:199], v[20:23], v[56:59]
    buffer_load_dwordx4 v13, s[8:11], s65 offen offset:0 sc1 lds
    v_mfma_f32_16x16x32_bf16 v[60:63], v[200:203], v[20:23], v[60:63]
    buffer_load_dwordx4 v13, s[8:11], s65 offen offset:1024 sc1 lds
    v_mfma_f32_16x16x32_bf16 v[64:67], v[204:207], v[20:23], v[64:67]
    s_waitcnt lgkmcnt(3)
    v_add_f32 v76, v76, v32
    v_add_f32 v77, v77, v33
    v_mfma_f32_16x16x32_bf16 v[68:71], v[208:211], v[20:23], v[68:71]
    buffer_load_dwordx4 v13, s[8:11], s65 offen offset:2048 sc1 lds
    v_add_f32 v78, v78, v34
    v_add_f32 v79, v79, v35
    v_mfma_f32_16x16x32_bf16 v[72:75], v[212:215], v[20:23], v[72:75]
    s_waitcnt lgkmcnt(2)
    ds_read_b128 v[32:35], v5 offset:30720
    ds_read_b128 v[20:23], v4 offset:1024
    v_add_f32 v76, v76, v36
    v_add_f32 v77, v77, v37
    v_mfma_f32_16x16x32_bf16 v[72:75], v[232:235], v[24:27], v[72:75]
    buffer_load_dwordx4 v13, s[8:11], s65 offen offset:3072 sc1 lds
    v_add_f32 v78, v78, v38
    v_add_f32 v79, v79, v39
    v_mfma_f32_16x16x32_bf16 v[68:71], v[228:231], v[24:27], v[68:71]
    s_waitcnt lgkmcnt(3)
    ds_read_b128 v[36:39], v5 offset:35840
    v_add_f32 v76, v76, v40
    v_add_f32 v77, v77, v41
    v_mfma_f32_16x16x32_bf16 v[64:67], v[224:227], v[24:27], v[64:67]
    v_add_f32 v78, v78, v42
    v_add_f32 v79, v79, v43
    v_mfma_f32_16x16x32_bf16 v[60:63], v[220:223], v[24:27], v[60:63]
    ds_read_b128 v[40:43], v5 offset:40960
    s_waitcnt lgkmcnt(3)
    v_add_f32 v92, v92, v32
    v_add_f32 v93, v93, v33
    s_add_u32 s6, s97, 0
    v_mfma_f32_16x16x32_bf16 v[56:59], v[216:219], v[24:27], v[56:59]
    ds_read_b128 v[24:27], v4 offset:2048
    v_add_f32 v94, v94, v34
    v_add_f32 v95, v95, v35
    v_mfma_f32_16x16x32_bf16 v[56:59], v[236:239], v[28:31], v[56:59]
    buffer_store_dwordx4 v[76:79], v44, s[8:11], s6 offen sc1
    s_waitcnt lgkmcnt(2)
    v_add_f32 v92, v92, v36
    v_add_f32 v93, v93, v37
    v_mfma_f32_16x16x32_bf16 v[60:63], v[240:243], v[28:31], v[60:63]
    v_add_f32 v94, v94, v38
    v_add_f32 v95, v95, v39
    v_mfma_f32_16x16x32_bf16 v[64:67], v[244:247], v[28:31], v[64:67]
    s_waitcnt lgkmcnt(1)
    v_add_f32 v92, v92, v40
    v_add_f32 v93, v93, v41
    v_mfma_f32_16x16x32_bf16 v[68:71], v[248:251], v[28:31], v[68:71]
    v_add_f32 v94, v94, v42
    v_add_f32 v95, v95, v43
    s_cmp_lg_u32 s71, 1
    v_mfma_f32_16x16x32_bf16 v[72:75], v[252:255], v[28:31], v[72:75]
    s_cbranch_scc1 L_nost_50
    buffer_store_dwordx4 v[92:95], v52, s[8:11], s6 offen sc1
L_nost_50:
    ds_read_b128 v[28:31], v4 offset:3072
    v_mfma_f32_16x16x32_bf16 v[76:79], v[96:99], v[16:19], 0
    s_sub_u32 s6, s71, 3
    s_and_b32 s6, s6, 3
    s_mul_i32 s7, s6, 5120
    v_mfma_f32_16x16x32_bf16 v[80:83], v[100:103], v[16:19], 0
    s_add_u32 s7, s7, s67
    s_cmp_eq_u32 s6, 3
    s_cselect_b32 s7, 155648, s7
    v_mfma_f32_16x16x32_bf16 v[84:87], v[104:107], v[16:19], 0
    v_add_u32 v12, s7, v52
    v_add_u32 v5, s67, v45
    v_mfma_f32_16x16x32_bf16 v[88:91], v[108:111], v[16:19], 0
    s_mov_b32 s12, s32
    s_mov_b32 s13, s33
    s_mov_b32 s14, 0x280000
    s_mov_b32 s15, 0x20000
    v_mfma_f32_16x16x32_bf16 v[92:95], v[112:115], v[16:19], 0
    ds_read_b128 v[16:19], v4 offset:4096
    s_and_b32 s75, s4, 3
    s_mul_i32 s70, s75, 320
    s_add_u32 s73, s70, 3837952
    s_mul_i32 s72, s75, 5120
    v_mfma_f32_16x16x32_bf16 v[76:79], v[116:119], v[20:23], v[76:79]
    ds_write_b128 v5, v[60:63] offset:0
    v_add_u32 v5, s67, v46
    v_mfma_f32_16x16x32_bf16 v[80:83], v[120:123], v[20:23], v[80:83]
    v_lshrrev_b32 v2, 4, v1
    v_and_b32 v3, 15, v1
    v_mul_u32_u24 v54, 1280, v3
    v_lshl_add_u32 v54, v2, 4, v54
    v_mfma_f32_16x16x32_bf16 v[84:87], v[124:127], v[20:23], v[84:87]
    v_lshlrev_b32 v3, 4, v3
    v_lshl_add_u32 v9, v2, 9, v3
    s_lshr_b32 s100, s3, 2
    s_cselect_b32 s6, s61, s68
    v_mfma_f32_16x16x32_bf16 v[88:91], v[128:131], v[20:23], v[88:91]
    s_waitcnt lgkmcnt(3)
    s_mul_i32 s6, s6, 20480
    s_lshl_b32 s7, s76, 6
    s_add_u32 s7, s7, s6
    v_add_u32 v53, s7, v54
    v_mfma_f32_16x16x32_bf16 v[92:95], v[132:135], v[20:23], v[92:95]
    ds_read_b128 v[20:23], v4 offset:5120
    s_lshl_b32 s7, s76, 10
    s_add_u32 s7, s7, s6
    s_add_u32 s7, s7, s72
    v_add_u32 v48, s7, v13
    v_mfma_f32_16x16x32_bf16 v[92:95], v[152:155], v[24:27], v[92:95]
    ds_write_b128 v5, v[64:67] offset:5120
    v_add_u32 v5, s67, v47
    v_mfma_f32_16x16x32_bf16 v[88:91], v[148:151], v[24:27], v[88:91]
    s_mul_i32 s6, s100, 10240
    s_lshl_b32 s7, s76, 11
    s_add_u32 s6, s6, s7
    v_add_u32 v8, s6, v9
    v_mfma_f32_16x16x32_bf16 v[84:87], v[144:147], v[24:27], v[84:87]
    s_mul_i32 s6, s100, 75776
    s_sub_u32 s6, 65536, s6
    v_add_u32 v10, s6, v8
    s_lshl_b32 s7, s76, 2
    v_mfma_f32_16x16x32_bf16 v[80:83], v[140:143], v[24:27], v[80:83]
    s_waitcnt lgkmcnt(4)
    v_add_u32 v2, s7, v2
    v_cmp_lt_u32 vcc, 9, v2
    s_mul_i32 s6, s100, 86016
    s_add_u32 s6, s6, 15360
    v_mfma_f32_16x16x32_bf16 v[76:79], v[136:139], v[24:27], v[76:79]
    ds_read_b128 v[24:27], v4 offset:6144
    v_add_u32 v3, s6, v10
    v_cndmask_b32 v10, v10, v3, vcc
    s_and_b32 s100, s3, 1
    s_cselect_b32 s6, s61, s68
    v_mfma_f32_16x16x32_bf16 v[76:79], v[156:159], v[28:31], v[76:79]
    ds_write_b128 v5, v[68:71] offset:10240
    v_add_u32 v5, s67, v52
    v_mfma_f32_16x16x32_bf16 v[80:83], v[160:163], v[28:31], v[80:83]
    s_mul_i32 s6, s6, 20480
    s_add_u32 s7, s6, 256
    v_add_u32 v54, s7, v54
    s_add_u32 s7, s6, s72
    v_mfma_f32_16x16x32_bf16 v[84:87], v[164:167], v[28:31], v[84:87]
    s_add_u32 s7, s7, 4096
    v_add_u32 v49, s7, v13
    s_mul_i32 s6, s100, 10240
    s_add_u32 s6, s6, 8192
    v_mfma_f32_16x16x32_bf16 v[88:91], v[168:171], v[28:31], v[88:91]
    s_waitcnt lgkmcnt(5)
    v_add_u32 v9, s6, v9
    s_mul_i32 s6, s100, 10240
    s_add_u32 s6, s6, 80896
    v_add_u32 v55, s6, v9
    v_mfma_f32_16x16x32_bf16 v[92:95], v[172:175], v[28:31], v[92:95]
    ds_read_b128 v[28:31], v4 offset:7168
    v_mfma_f32_16x16x32_bf16 v[92:95], v[192:195], v[16:19], v[92:95]
    ds_write_b128 v12, v[72:75] offset:0
    v_mfma_f32_16x16x32_bf16 v[88:91], v[188:191], v[16:19], v[88:91]
    s_add_u32 s65, s68, 0
    s_and_b32 s65, s65, 3
    s_andn2_b32 s7, s68, 3
    v_mfma_f32_16x16x32_bf16 v[84:87], v[184:187], v[16:19], v[84:87]
    s_add_u32 s65, s65, s7
    s_lshl_b32 s65, s65, 17
    s_add_u32 s65, s65, s66
    v_mfma_f32_16x16x32_bf16 v[80:83], v[180:183], v[16:19], v[80:83]
    s_waitcnt lgkmcnt(5)
    s_add_u32 m0, s99, 0
    v_mfma_f32_16x16x32_bf16 v[76:79], v[176:179], v[16:19], v[76:79]
    s_waitcnt vmcnt(5)
    s_waitcnt lgkmcnt(0)
    s_barrier
    ds_read_b128 v[32:35], v6 offset:0
    ds_read_b128 v[36:39], v6 offset:5120
    ds_read_b128 v[40:43], v6 offset:10240
    ds_read_b128 v[16:19], v4 offset:32768
    v_mfma_f32_16x16x32_bf16 v[76:79], v[196:199], v[20:23], v[76:79]
    buffer_load_dwordx4 v13, s[8:11], s65 offen offset:0 sc1 lds
    v_mfma_f32_16x16x32_bf16 v[80:83], v[200:203], v[20:23], v[80:83]
    buffer_load_dwordx4 v13, s[8:11], s65 offen offset:1024 sc1 lds
    v_mfma_f32_16x16x32_bf16 v[84:87], v[204:207], v[20:23], v[84:87]
    s_waitcnt lgkmcnt(3)
    v_add_f32 v56, v56, v32
    v_add_f32 v57, v57, v33
    v_mfma_f32_16x16x32_bf16 v[88:91], v[208:211], v[20:23], v[88:91]
    buffer_load_dwordx4 v13, s[8:11], s65 offen offset:2048 sc1 lds
    v_add_f32 v58, v58, v34
    v_add_f32 v59, v59, v35
    v_mfma_f32_16x16x32_bf16 v[92:95], v[212:215], v[20:23], v[92:95]
    s_waitcnt lgkmcnt(2)
    ds_read_b128 v[32:35], v5 offset:0
    ds_read_b128 v[20:23], v4 offset:33792
    v_add_f32 v56, v56, v36
    v_add_f32 v57, v57, v37
    v_mfma_f32_16x16x32_bf16 v[92:95], v[232:235], v[24:27], v[92:95]
    buffer_load_dwordx4 v13, s[8:11], s65 offen offset:3072 sc1 lds
    v_add_f32 v58, v58, v38
    v_add_f32 v59, v59, v39
    v_mfma_f32_16x16x32_bf16 v[88:91], v[228:231], v[24:27], v[88:91]
    s_waitcnt lgkmcnt(3)
    ds_read_b128 v[36:39], v5 offset:5120
    v_add_f32 v56, v56, v40
    v_add_f32 v57, v57, v41
    v_mfma_f32_16x16x32_bf16 v[84:87], v[224:227], v[24:27], v[84:87]
    v_add_f32 v58, v58, v42
    v_add_f32 v59, v59, v43
    v_mfma_f32_16x16x32_bf16 v[80:83], v[220:223], v[24:27], v[80:83]
    ds_read_b128 v[40:43], v5 offset:10240
    s_waitcnt lgkmcnt(3)
    v_add_f32 v72, v72, v32
    v_add_f32 v73, v73, v33
    s_add_u32 s6, s98, 0
    v_mfma_f32_16x16x32_bf16 v[76:79], v[216:219], v[24:27], v[76:79]
    ds_read_b128 v[24:27], v4 offset:34816
    v_add_f32 v74, v74, v34
    v_add_f32 v75, v75, v35
    v_mfma_f32_16x16x32_bf16 v[76:79], v[236:239], v[28:31], v[76:79]
    buffer_store_dwordx4 v[56:59], v44, s[8:11], s6 offen sc1
    s_waitcnt lgkmcnt(2)
    v_add_f32 v72, v72, v36
    v_add_f32 v73, v73, v37
    v_mfma_f32_16x16x32_bf16 v[80:83], v[240:243], v[28:31], v[80:83]
    v_add_f32 v74, v74, v38
    v_add_f32 v75, v75, v39
    v_mfma_f32_16x16x32_bf16 v[84:87], v[244:247], v[28:31], v[84:87]
    s_waitcnt lgkmcnt(1)
    v_add_f32 v72, v72, v40
    v_add_f32 v73, v73, v41
    v_mfma_f32_16x16x32_bf16 v[88:91], v[248:251], v[28:31], v[88:91]
    v_add_f32 v74, v74, v42
    v_add_f32 v75, v75, v43
    s_cmp_lg_u32 s71, 2
    v_mfma_f32_16x16x32_bf16 v[92:95], v[252:255], v[28:31], v[92:95]
    s_cbranch_scc1 L_nost_53
    buffer_store_dwordx4 v[72:75], v52, s[8:11], s6 offen sc1
L_nost_53:
    ds_read_b128 v[28:31], v4 offset:35840
    v_mfma_f32_16x16x32_bf16 v[56:59], v[96:99], v[16:19], 0
    s_sub_u32 s6, s71, 4
    s_and_b32 s6, s6, 3
    s_mul_i32 s7, s6, 5120
    v_mfma_f32_16x16x32_bf16 v[60:63], v[100:103], v[16:19], 0
    s_add_u32 s7, s7, s67
    s_cmp_eq_u32 s6, 3
    s_cselect_b32 s7, 124928, s7
    v_mfma_f32_16x16x32_bf16 v[64:67], v[104:107], v[16:19], 0
    v_add_u32 v12, s7, v52
    v_add_u32 v5, s67, v45
    v_mfma_f32_16x16x32_bf16 v[68:71], v[108:111], v[16:19], 0
    v_mfma_f32_16x16x32_bf16 v[72:75], v[112:115], v[16:19], 0
    ds_read_b128 v[16:19], v4 offset:36864
    v_mfma_f32_16x16x32_bf16 v[56:59], v[116:119], v[20:23], v[56:59]
    ds_write_b128 v5, v[80:83] offset:30720
    v_add_u32 v5, s67, v46
    v_mfma_f32_16x16x32_bf16 v[60:63], v[120:123], v[20:23], v[60:63]
    v_mfma_f32_16x16x32_bf16 v[64:67], v[124:127], v[20:23], v[64:67]
    v_cmp_le_i32 vcc, 0, v51
    s_cbranch_vccz L_idx_okb
    v_and_b32 v3, 7, v1
    v_lshlrev_b32 v3, 2, v3
    s_mov_b32 s72, 0x3a0000
    s_mov_b32 s79, 262144
L_poll_55:
    buffer_load_dword v51, v3, s[8:11], s72 offen sc1
    s_waitcnt vmcnt(0)
    v_cmp_le_i32 vcc, 0, v51
    s_cbranch_vccz L_polldone_56
    s_sleep 2
    s_sub_u32 s79, s79, 1
    s_cmp_lg_u32 s79, 0
    s_cbranch_scc1 L_poll_55
L_polldone_56:
L_idx_okb:
    s_mov_b32 s64, 0
    v_and_b32 v2, 0x7ff, v51
    v_sub_u32 v2, 0x7ff, v2
    v_lshrrev_b32 v3, 4, v2
    v_cmp_eq_u32 vcc, s68, v3
    v_cmp_eq_u32 s[74:75], s61, v3
    s_nop 3
    s_or_b64 vcc, vcc, s[74:75]
    s_cbranch_scc0 L_notok_57
    v_readlane_b32 s84, v2, 0
    v_readlane_b32 s85, v2, 1
    v_readlane_b32 s86, v2, 2
    v_readlane_b32 s87, v2, 3
    v_readlane_b32 s88, v2, 4
    v_readlane_b32 s65, v2, 5
    v_readlane_b32 s91, v2, 6
    v_readlane_b32 s101, v2, 7
    s_lshl_b32 s7, s76, 6
    s_lshr_b32 s100, s3, 2
    s_cselect_b32 s6, s61, s68
    s_lshl_b32 s6, s6, 4
    v_and_b32 v2, 15, v1
    v_add_u32 v2, s6, v2
    s_add_u32 s7, s7, s73
    v_and_b32 v3, 48, v1
    v_add_u32 v3, s7, v3
    v_cmp_eq_u32 vcc, s84, v2
    s_nop 1
    v_cndmask_b32 v48, v48, v3, vcc
    v_add_u32 v3, 1280, v3
    v_cmp_eq_u32 vcc, s85, v2
    s_nop 1
    v_cndmask_b32 v48, v48, v3, vcc
    v_add_u32 v3, 1280, v3
    v_cmp_eq_u32 vcc, s86, v2
    s_nop 1
    v_cndmask_b32 v48, v48, v3, vcc
    v_add_u32 v3, 1280, v3
    v_cmp_eq_u32 vcc, s87, v2
    s_nop 1
    v_cndmask_b32 v48, v48, v3, vcc
    v_add_u32 v3, 1280, v3
    v_cmp_eq_u32 vcc, s88, v2
    s_nop 1
    v_cndmask_b32 v48, v48, v3, vcc
    v_add_u32 v3, 1280, v3
    v_cmp_eq_u32 vcc, s65, v2
    s_nop 1
    v_cndmask_b32 v48, v48, v3, vcc
    v_add_u32 v3, 1280, v3
    v_cmp_eq_u32 vcc, s91, v2
    s_nop 1
    v_cndmask_b32 v48, v48, v3, vcc
    v_add_u32 v3, 1280, v3
    v_cmp_eq_u32 vcc, s101, v2
    s_nop 1
    v_cndmask_b32 v48, v48, v3, vcc
    s_movk_i32 s7, 256
    s_and_b32 s100, s3, 1
    s_cselect_b32 s6, s61, s68
    s_lshl_b32 s6, s6, 4
    v_and_b32 v2, 15, v1
    v_add_u32 v2, s6, v2
    s_add_u32 s7, s7, s73
    v_and_b32 v3, 48, v1
    v_add_u32 v3, s7, v3
    v_cmp_eq_u32 vcc, s84, v2
    s_nop 1
    v_cndmask_b32 v49, v49, v3, vcc
    v_add_u32 v3, 1280, v3
    v_cmp_eq_u32 vcc, s85, v2
    s_nop 1
    v_cndmask_b32 v49, v49, v3, vcc
    v_add_u32 v3, 1280, v3
    v_cmp_eq_u32 vcc, s86, v2
    s_nop 1
    v_cndmask_b32 v49, v49, v3, vcc
    v_add_u32 v3, 1280, v3
    v_cmp_eq_u32 vcc, s87, v2
    s_nop 1
    v_cndmask_b32 v49, v49, v3, vcc
    v_add_u32 v3, 1280, v3
    v_cmp_eq_u32 vcc, s88, v2
    s_nop 1
    v_cndmask_b32 v49, v49, v3, vcc
    v_add_u32 v3, 1280, v3
    v_cmp_eq_u32 vcc, s65, v2
    s_nop 1
    v_cndmask_b32 v49, v49, v3, vcc
    v_add_u32 v3, 1280, v3
    v_cmp_eq_u32 vcc, s91, v2
    s_nop 1
    v_cndmask_b32 v49, v49, v3, vcc
    v_add_u32 v3, 1280, v3
    v_cmp_eq_u32 vcc, s101, v2
    s_nop 1
    v_cndmask_b32 v49, v49, v3, vcc
    s_mov_b32 s64, 1
L_notok_57:
    v_mfma_f32_16x16x32_bf16 v[68:71], v[128:131], v[20:23], v[68:71]
    s_waitcnt lgkmcnt(3)
    v_mfma_f32_16x16x32_bf16 v[72:75], v[132:135], v[20:23], v[72:75]
    ds_read_b128 v[20:23], v4 offset:37888
    v_mfma_f32_16x16x32_bf16 v[72:75], v[152:155], v[24:27], v[72:75]
    ds_write_b128 v5, v[84:87] offset:35840
    v_add_u32 v5, s67, v47
    v_mfma_f32_16x16x32_bf16 v[68:71], v[148:151], v[24:27], v[68:71]
    v_mfma_f32_16x16x32_bf16 v[64:67], v[144:147], v[24:27], v[64:67]
    v_mfma_f32_16x16x32_bf16 v[60:63], v[140:143], v[24:27], v[60:63]
    s_waitcnt lgkmcnt(4)
    v_mfma_f32_16x16x32_bf16 v[56:59], v[136:139], v[24:27], v[56:59]
    ds_read_b128 v[24:27], v4 offset:38912
    v_mfma_f32_16x16x32_bf16 v[56:59], v[156:159], v[28:31], v[56:59]
    ds_write_b128 v5, v[88:91] offset:40960
    v_add_u32 v5, s67, v52
    v_mfma_f32_16x16x32_bf16 v[60:63], v[160:163], v[28:31], v[60:63]
    v_mfma_f32_16x16x32_bf16 v[64:67], v[164:167], v[28:31], v[64:67]
    v_mfma_f32_16x16x32_bf16 v[68:71], v[168:171], v[28:31], v[68:71]
    s_waitcnt lgkmcnt(5)
    v_mfma_f32_16x16x32_bf16 v[72:75], v[172:175], v[28:31], v[72:75]
    ds_read_b128 v[28:31], v4 offset:39936
    v_mfma_f32_16x16x32_bf16 v[72:75], v[192:195], v[16:19], v[72:75]
    ds_write_b128 v12, v[92:95] offset:30720
    v_mfma_f32_16x16x32_bf16 v[68:71], v[188:191], v[16:19], v[68:71]
    s_add_u32 s65, s61, 0
    s_and_b32 s65, s65, 3
    s_andn2_b32 s7, s61, 3
    v_mfma_f32_16x16x32_bf16 v[64:67], v[184:187], v[16:19], v[64:67]
    s_add_u32 s65, s65, s7
    s_lshl_b32 s65, s65, 17
    s_add_u32 s65, s65, s66
    v_mfma_f32_16x16x32_bf16 v[60:63], v[180:183], v[16:19], v[60:63]
    s_waitcnt lgkmcnt(5)
    s_add_u32 m0, s99, 32768
    v_mfma_f32_16x16x32_bf16 v[56:59], v[176:179], v[16:19], v[56:59]
    s_waitcnt vmcnt(5)
    s_waitcnt lgkmcnt(0)
    s_barrier
    ds_read_b128 v[32:35], v6 offset:30720
    ds_read_b128 v[36:39], v6 offset:35840
    ds_read_b128 v[40:43], v6 offset:40960
    ds_read_b128 v[16:19], v7 offset:0
    v_mfma_f32_16x16x32_bf16 v[56:59], v[196:199], v[20:23], v[56:59]
    buffer_load_dwordx4 v13, s[8:11], s65 offen offset:0 sc1 lds
    v_mfma_f32_16x16x32_bf16 v[60:63], v[200:203], v[20:23], v[60:63]
    buffer_load_dwordx4 v13, s[8:11], s65 offen offset:1024 sc1 lds
    v_mfma_f32_16x16x32_bf16 v[64:67], v[204:207], v[20:23], v[64:67]
    s_waitcnt lgkmcnt(3)
    v_add_f32 v76, v76, v32
    v_add_f32 v77, v77, v33
    v_mfma_f32_16x16x32_bf16 v[68:71], v[208:211], v[20:23], v[68:71]
    buffer_load_dwordx4 v13, s[8:11], s65 offen offset:2048 sc1 lds
    v_add_f32 v78, v78, v34
    v_add_f32 v79, v79, v35
    v_mfma_f32_16x16x32_bf16 v[72:75], v[212:215], v[20:23], v[72:75]
    s_waitcnt lgkmcnt(2)
    ds_read_b128 v[32:35], v5 offset:30720
    ds_read_b128 v[20:23], v7 offset:1024
    v_add_f32 v76, v76, v36
    v_add_f32 v77, v77, v37
    v_mfma_f32_16x16x32_bf16 v[72:75], v[232:235], v[24:27], v[72:75]
    buffer_load_dwordx4 v13, s[8:11], s65 offen offset:3072 sc1 lds
    v_add_f32 v78, v78, v38
    v_add_f32 v79, v79, v39
    v_mfma_f32_16x16x32_bf16 v[68:71], v[228:231], v[24:27], v[68:71]
    s_waitcnt lgkmcnt(3)
    ds_read_b128 v[36:39], v5 offset:35840
    v_add_f32 v76, v76, v40
    v_add_f32 v77, v77, v41
    v_mfma_f32_16x16x32_bf16 v[64:67], v[224:227], v[24:27], v[64:67]
    v_add_f32 v78, v78, v42
    v_add_f32 v79, v79, v43
    v_mfma_f32_16x16x32_bf16 v[60:63], v[220:223], v[24:27], v[60:63]
    ds_read_b128 v[40:43], v5 offset:40960
    s_waitcnt lgkmcnt(3)
    v_add_f32 v92, v92, v32
    v_add_f32 v93, v93, v33
    s_add_u32 s6, s96, 10240
    v_mfma_f32_16x16x32_bf16 v[56:59], v[216:219], v[24:27], v[56:59]
    ds_read_b128 v[24:27], v7 offset:2048
    v_add_f32 v94, v94, v34
    v_add_f32 v95, v95, v35
    v_mfma_f32_16x16x32_bf16 v[56:59], v[236:239], v[28:31], v[56:59]
    buffer_store_dwordx4 v[76:79], v44, s[8:11], s6 offen sc1
    s_waitcnt lgkmcnt(2)
    v_add_f32 v92, v92, v36
    v_add_f32 v93, v93, v37
    v_mfma_f32_16x16x32_bf16 v[60:63], v[240:243], v[28:31], v[60:63]
    v_add_f32 v94, v94, v38
    v_add_f32 v95, v95, v39
    v_mfma_f32_16x16x32_bf16 v[64:67], v[244:247], v[28:31], v[64:67]
    s_waitcnt lgkmcnt(1)
    v_add_f32 v92, v92, v40
    v_add_f32 v93, v93, v41
    v_mfma_f32_16x16x32_bf16 v[68:71], v[248:251], v[28:31], v[68:71]
    v_add_f32 v94, v94, v42
    v_add_f32 v95, v95, v43
    s_cmp_lg_u32 s71, 3
    v_mfma_f32_16x16x32_bf16 v[72:75], v[252:255], v[28:31], v[72:75]
    s_cbranch_scc1 L_nost_54
    buffer_store_dwordx4 v[92:95], v52, s[8:11], s6 offen sc1
L_nost_54:
    ds_read_b128 v[28:31], v7 offset:3072
    v_mfma_f32_16x16x32_bf16 v[76:79], v[96:99], v[16:19], 0
    s_sub_u32 s6, s71, 5
    s_and_b32 s6, s6, 3
    s_mul_i32 s7, s6, 5120
    v_mfma_f32_16x16x32_bf16 v[80:83], v[100:103], v[16:19], 0
    s_add_u32 s7, s7, s67
    s_cmp_eq_u32 s6, 3
    s_cselect_b32 s7, 155648, s7
    v_mfma_f32_16x16x32_bf16 v[84:87], v[104:107], v[16:19], 0
    v_add_u32 v12, s7, v52
    v_add_u32 v5, s67, v45
    v_mfma_f32_16x16x32_bf16 v[88:91], v[108:111], v[16:19], 0
    v_mfma_f32_16x16x32_bf16 v[92:95], v[112:115], v[16:19], 0
    ds_read_b128 v[16:19], v7 offset:4096
    v_mfma_f32_16x16x32_bf16 v[76:79], v[116:119], v[20:23], v[76:79]
    ds_write_b128 v5, v[60:63] offset:0
    v_add_u32 v5, s67, v46
    v_mfma_f32_16x16x32_bf16 v[80:83], v[120:123], v[20:23], v[80:83]
    v_mfma_f32_16x16x32_bf16 v[84:87], v[124:127], v[20:23], v[84:87]
    v_mfma_f32_16x16x32_bf16 v[88:91], v[128:131], v[20:23], v[88:91]
    s_waitcnt lgkmcnt(3)
    v_mfma_f32_16x16x32_bf16 v[92:95], v[132:135], v[20:23], v[92:95]
    ds_read_b128 v[20:23], v7 offset:5120
    v_mfma_f32_16x16x32_bf16 v[92:95], v[152:155], v[24:27], v[92:95]
    ds_write_b128 v5, v[64:67] offset:5120
    v_add_u32 v5, s67, v47
    v_mfma_f32_16x16x32_bf16 v[88:91], v[148:151], v[24:27], v[88:91]
    v_mfma_f32_16x16x32_bf16 v[84:87], v[144:147], v[24:27], v[84:87]
    v_mfma_f32_16x16x32_bf16 v[80:83], v[140:143], v[24:27], v[80:83]
    s_waitcnt lgkmcnt(4)
    v_mfma_f32_16x16x32_bf16 v[76:79], v[136:139], v[24:27], v[76:79]
    ds_read_b128 v[24:27], v7 offset:6144
    v_mfma_f32_16x16x32_bf16 v[76:79], v[156:159], v[28:31], v[76:79]
    ds_write_b128 v5, v[68:71] offset:10240
    v_add_u32 v5, s67, v52
    v_mfma_f32_16x16x32_bf16 v[80:83], v[160:163], v[28:31], v[80:83]
    v_mfma_f32_16x16x32_bf16 v[84:87], v[164:167], v[28:31], v[84:87]
    v_mfma_f32_16x16x32_bf16 v[88:91], v[168:171], v[28:31], v[88:91]
    s_waitcnt lgkmcnt(5)
    v_mfma_f32_16x16x32_bf16 v[92:95], v[172:175], v[28:31], v[92:95]
    ds_read_b128 v[28:31], v7 offset:7168
    v_mfma_f32_16x16x32_bf16 v[92:95], v[192:195], v[16:19], v[92:95]
    ds_write_b128 v12, v[72:75] offset:0
    v_mfma_f32_16x16x32_bf16 v[88:91], v[188:191], v[16:19], v[88:91]
    v_mfma_f32_16x16x32_bf16 v[84:87], v[184:187], v[16:19], v[84:87]
    v_mfma_f32_16x16x32_bf16 v[80:83], v[180:183], v[16:19], v[80:83]
    s_waitcnt lgkmcnt(5)
    v_mfma_f32_16x16x32_bf16 v[76:79], v[176:179], v[16:19], v[76:79]
    s_waitcnt vmcnt(5)
    s_waitcnt lgkmcnt(0)
    s_barrier
    ds_read_b128 v[32:35], v6 offset:0
    ds_read_b128 v[36:39], v6 offset:5120
    ds_read_b128 v[40:43], v6 offset:10240
    ds_read_b128 v[16:19], v4 offset:0
    v_mfma_f32_16x16x32_bf16 v[76:79], v[196:199], v[20:23], v[76:79]
    v_mfma_f32_16x16x32_bf16 v[80:83], v[200:203], v[20:23], v[80:83]
    v_mfma_f32_16x16x32_bf16 v[84:87], v[204:207], v[20:23], v[84:87]
    s_waitcnt lgkmcnt(3)
    v_add_f32 v56, v56, v32
    v_add_f32 v57, v57, v33
    v_mfma_f32_16x16x32_bf16 v[88:91], v[208:211], v[20:23], v[88:91]
    v_add_f32 v58, v58, v34
    v_add_f32 v59, v59, v35
    v_mfma_f32_16x16x32_bf16 v[92:95], v[212:215], v[20:23], v[92:95]
    s_waitcnt lgkmcnt(2)
    ds_read_b128 v[32:35], v5 offset:0
    ds_read_b128 v[20:23], v4 offset:1024
    v_add_f32 v56, v56, v36
    v_add_f32 v57, v57, v37
    v_mfma_f32_16x16x32_bf16 v[92:95], v[232:235], v[24:27], v[92:95]
    v_add_f32 v58, v58, v38
    v_add_f32 v59, v59, v39
    v_mfma_f32_16x16x32_bf16 v[88:91], v[228:231], v[24:27], v[88:91]
    s_waitcnt lgkmcnt(3)
    ds_read_b128 v[36:39], v5 offset:5120
    v_add_f32 v56, v56, v40
    v_add_f32 v57, v57, v41
    v_mfma_f32_16x16x32_bf16 v[84:87], v[224:227], v[24:27], v[84:87]
    v_add_f32 v58, v58, v42
    v_add_f32 v59, v59, v43
    v_mfma_f32_16x16x32_bf16 v[80:83], v[220:223], v[24:27], v[80:83]
    ds_read_b128 v[40:43], v5 offset:10240
    s_waitcnt lgkmcnt(3)
    v_add_f32 v72, v72, v32
    v_add_f32 v73, v73, v33
    s_add_u32 s6, s97, 10240
    v_mfma_f32_16x16x32_bf16 v[76:79], v[216:219], v[24:27], v[76:79]
    ds_read_b128 v[24:27], v4 offset:2048
    v_add_f32 v74, v74, v34
    v_add_f32 v75, v75, v35
    v_mfma_f32_16x16x32_bf16 v[76:79], v[236:239], v[28:31], v[76:79]
    buffer_store_dwordx4 v[56:59], v44, s[8:11], s6 offen sc1
    s_waitcnt lgkmcnt(2)
    v_add_f32 v72, v72, v36
    v_add_f32 v73, v73, v37
    v_mfma_f32_16x16x32_bf16 v[80:83], v[240:243], v[28:31], v[80:83]
    v_add_f32 v74, v74, v38
    v_add_f32 v75, v75, v39
    v_mfma_f32_16x16x32_bf16 v[84:87], v[244:247], v[28:31], v[84:87]
    s_waitcnt lgkmcnt(1)
    v_add_f32 v72, v72, v40
    v_add_f32 v73, v73, v41
    v_mfma_f32_16x16x32_bf16 v[88:91], v[248:251], v[28:31], v[88:91]
    v_add_f32 v74, v74, v42
    v_add_f32 v75, v75, v43
    s_cmp_lg_u32 s71, 0
    v_mfma_f32_16x16x32_bf16 v[92:95], v[252:255], v[28:31], v[92:95]
    s_cbranch_scc1 L_nost_58
    buffer_store_dwordx4 v[72:75], v52, s[8:11], s6 offen sc1
L_nost_58:
    ds_read_b128 v[28:31], v4 offset:3072
    v_mfma_f32_16x16x32_bf16 v[56:59], v[96:99], v[16:19], 0
    s_sub_u32 s6, s71, 6
    s_and_b32 s6, s6, 3
    s_mul_i32 s7, s6, 5120
    v_mfma_f32_16x16x32_bf16 v[60:63], v[100:103], v[16:19], 0
    s_add_u32 s7, s7, s67
    s_cmp_eq_u32 s6, 3
    s_cselect_b32 s7, 124928, s7
    v_mfma_f32_16x16x32_bf16 v[64:67], v[104:107], v[16:19], 0
    v_add_u32 v12, s7, v52
    v_add_u32 v5, s67, v45
    v_mfma_f32_16x16x32_bf16 v[68:71], v[108:111], v[16:19], 0
    v_mfma_f32_16x16x32_bf16 v[72:75], v[112:115], v[16:19], 0
    ds_read_b128 v[16:19], v4 offset:4096
    v_mfma_f32_16x16x32_bf16 v[56:59], v[116:119], v[20:23], v[56:59]
    ds_write_b128 v5, v[80:83] offset:30720
    v_add_u32 v5, s67, v46
    v_mfma_f32_16x16x32_bf16 v[60:63], v[120:123], v[20:23], v[60:63]
    v_mfma_f32_16x16x32_bf16 v[64:67], v[124:127], v[20:23], v[64:67]
    v_mfma_f32_16x16x32_bf16 v[68:71], v[128:131], v[20:23], v[68:71]
    s_waitcnt lgkmcnt(3)
    v_mfma_f32_16x16x32_bf16 v[72:75], v[132:135], v[20:23], v[72:75]
    ds_read_b128 v[20:23], v4 offset:5120
    v_mfma_f32_16x16x32_bf16 v[72:75], v[152:155], v[24:27], v[72:75]
    ds_write_b128 v5, v[84:87] offset:35840
    v_add_u32 v5, s67, v47
    v_mfma_f32_16x16x32_bf16 v[68:71], v[148:151], v[24:27], v[68:71]
    v_mfma_f32_16x16x32_bf16 v[64:67], v[144:147], v[24:27], v[64:67]
    v_mfma_f32_16x16x32_bf16 v[60:63], v[140:143], v[24:27], v[60:63]
    s_waitcnt lgkmcnt(4)
    v_mfma_f32_16x16x32_bf16 v[56:59], v[136:139], v[24:27], v[56:59]
    ds_read_b128 v[24:27], v4 offset:6144
    v_mfma_f32_16x16x32_bf16 v[56:59], v[156:159], v[28:31], v[56:59]
    ds_write_b128 v5, v[88:91] offset:40960
    v_add_u32 v5, s67, v52
    v_mfma_f32_16x16x32_bf16 v[60:63], v[160:163], v[28:31], v[60:63]
    v_mfma_f32_16x16x32_bf16 v[64:67], v[164:167], v[28:31], v[64:67]
    v_mfma_f32_16x16x32_bf16 v[68:71], v[168:171], v[28:31], v[68:71]
    s_waitcnt lgkmcnt(5)
    v_mfma_f32_16x16x32_bf16 v[72:75], v[172:175], v[28:31], v[72:75]
    ds_read_b128 v[28:31], v4 offset:7168
    v_mfma_f32_16x16x32_bf16 v[72:75], v[192:195], v[16:19], v[72:75]
    ds_write_b128 v12, v[92:95] offset:30720
    v_mfma_f32_16x16x32_bf16 v[68:71], v[188:191], v[16:19], v[68:71]
    v_mfma_f32_16x16x32_bf16 v[64:67], v[184:187], v[16:19], v[64:67]
    v_mov_b32 v2, 1
    v_writelane_b32 v2, 2, 0
    v_mfma_f32_16x16x32_bf16 v[60:63], v[180:183], v[16:19], v[60:63]
    s_waitcnt lgkmcnt(5)
    v_mfma_f32_16x16x32_bf16 v[56:59], v[176:179], v[16:19], v[56:59]
    s_waitcnt vmcnt(1)
    buffer_store_dword v2, v11, s[8:11], 0 offen sc1
    s_waitcnt lgkmcnt(0)
    s_barrier
    ds_read_b128 v[32:35], v6 offset:30720
    ds_read_b128 v[36:39], v6 offset:35840
    ds_read_b128 v[40:43], v6 offset:40960
    ds_read_b128 v[16:19], v4 offset:32768
    v_mfma_f32_16x16x32_bf16 v[56:59], v[196:199], v[20:23], v[56:59]
    v_mfma_f32_16x16x32_bf16 v[60:63], v[200:203], v[20:23], v[60:63]
    v_mfma_f32_16x16x32_bf16 v[64:67], v[204:207], v[20:23], v[64:67]
    s_waitcnt lgkmcnt(3)
    v_add_f32 v76, v76, v32
    v_add_f32 v77, v77, v33
    v_mfma_f32_16x16x32_bf16 v[68:71], v[208:211], v[20:23], v[68:71]
    v_add_f32 v78, v78, v34
    v_add_f32 v79, v79, v35
    v_mfma_f32_16x16x32_bf16 v[72:75], v[212:215], v[20:23], v[72:75]
    s_waitcnt lgkmcnt(2)
    ds_read_b128 v[32:35], v5 offset:30720
    ds_read_b128 v[20:23], v4 offset:33792
    v_add_f32 v76, v76, v36
    v_add_f32 v77, v77, v37
    v_mfma_f32_16x16x32_bf16 v[72:75], v[232:235], v[24:27], v[72:75]
    v_add_f32 v78, v78, v38
    v_add_f32 v79, v79, v39
    v_mfma_f32_16x16x32_bf16 v[68:71], v[228:231], v[24:27], v[68:71]
    s_waitcnt lgkmcnt(3)
    ds_read_b128 v[36:39], v5 offset:35840
    v_add_f32 v76, v76, v40
    v_add_f32 v77, v77, v41
    v_mfma_f32_16x16x32_bf16 v[64:67], v[224:227], v[24:27], v[64:67]
    v_add_f32 v78, v78, v42
    v_add_f32 v79, v79, v43
    v_mfma_f32_16x16x32_bf16 v[60:63], v[220:223], v[24:27], v[60:63]
    ds_read_b128 v[40:43], v5 offset:40960
    s_waitcnt lgkmcnt(3)
    v_add_f32 v92, v92, v32
    v_add_f32 v93, v93, v33
    s_add_u32 s6, s98, 10240
    v_mfma_f32_16x16x32_bf16 v[56:59], v[216:219], v[24:27], v[56:59]
    ds_read_b128 v[24:27], v4 offset:34816
    v_add_f32 v94, v94, v34
    v_add_f32 v95, v95, v35
    v_mfma_f32_16x16x32_bf16 v[56:59], v[236:239], v[28:31], v[56:59]
    buffer_store_dwordx4 v[76:79], v44, s[8:11], s6 offen sc1
    s_waitcnt lgkmcnt(2)
    v_add_f32 v92, v92, v36
    v_add_f32 v93, v93, v37
    v_mfma_f32_16x16x32_bf16 v[60:63], v[240:243], v[28:31], v[60:63]
    v_add_f32 v94, v94, v38
    v_add_f32 v95, v95, v39
    v_mfma_f32_16x16x32_bf16 v[64:67], v[244:247], v[28:31], v[64:67]
    s_waitcnt lgkmcnt(1)
    v_add_f32 v92, v92, v40
    v_add_f32 v93, v93, v41
    v_mfma_f32_16x16x32_bf16 v[68:71], v[248:251], v[28:31], v[68:71]
    v_add_f32 v94, v94, v42
    v_add_f32 v95, v95, v43
    s_cmp_lg_u32 s71, 1
    v_mfma_f32_16x16x32_bf16 v[72:75], v[252:255], v[28:31], v[72:75]
    s_cbranch_scc1 L_nost_59
    buffer_store_dwordx4 v[92:95], v52, s[8:11], s6 offen sc1
L_nost_59:
    ds_read_b128 v[28:31], v4 offset:35840
    v_mfma_f32_16x16x32_bf16 v[76:79], v[96:99], v[16:19], 0
    v_mfma_f32_16x16x32_bf16 v[80:83], v[100:103], v[16:19], 0
    v_mfma_f32_16x16x32_bf16 v[84:87], v[104:107], v[16:19], 0
    s_mul_i32 s73, s3, 5120
    s_add_u32 s6, s73, 65536
    v_mfma_f32_16x16x32_bf16 v[88:91], v[108:111], v[16:19], 0
    v_add_u32 v5, s6, v44
    v_mfma_f32_16x16x32_bf16 v[92:95], v[112:115], v[16:19], 0
    ds_read_b128 v[16:19], v4 offset:36864
    v_mfma_f32_16x16x32_bf16 v[76:79], v[116:119], v[20:23], v[76:79]
    ds_write_b128 v5, v[56:59]
    s_add_u32 s6, s73, 65536
    v_add_u32 v5, s6, v45
    v_mfma_f32_16x16x32_bf16 v[80:83], v[120:123], v[20:23], v[80:83]
    v_mfma_f32_16x16x32_bf16 v[84:87], v[124:127], v[20:23], v[84:87]
    v_mfma_f32_16x16x32_bf16 v[88:91], v[128:131], v[20:23], v[88:91]
    s_waitcnt lgkmcnt(3)
    v_mfma_f32_16x16x32_bf16 v[92:95], v[132:135], v[20:23], v[92:95]
    ds_read_b128 v[20:23], v4 offset:37888
    v_mfma_f32_16x16x32_bf16 v[92:95], v[152:155], v[24:27], v[92:95]
    ds_write_b128 v5, v[60:63]
    s_add_u32 s6, s73, 65536
    v_add_u32 v5, s6, v46
    v_mfma_f32_16x16x32_bf16 v[88:91], v[148:151], v[24:27], v[88:91]
    v_mfma_f32_16x16x32_bf16 v[84:87], v[144:147], v[24:27], v[84:87]
    v_mfma_f32_16x16x32_bf16 v[80:83], v[140:143], v[24:27], v[80:83]
    s_waitcnt lgkmcnt(4)
    v_mfma_f32_16x16x32_bf16 v[76:79], v[136:139], v[24:27], v[76:79]
    ds_read_b128 v[24:27], v4 offset:38912
    v_mfma_f32_16x16x32_bf16 v[76:79], v[156:159], v[28:31], v[76:79]
    ds_write_b128 v5, v[64:67]
    s_add_u32 s6, s73, 65536
    v_add_u32 v5, s6, v47
    v_mfma_f32_16x16x32_bf16 v[80:83], v[160:163], v[28:31], v[80:83]
    v_mov_b32 v2, 2
    s_waitcnt vmcnt(0)
    buffer_store_dword v2, v11, s[8:11], 0 offen sc1
    v_mfma_f32_16x16x32_bf16 v[84:87], v[164:167], v[28:31], v[84:87]
    v_mfma_f32_16x16x32_bf16 v[88:91], v[168:171], v[28:31], v[88:91]
    s_waitcnt lgkmcnt(5)
    s_cmp_eq_u32 s64, 0
    s_cbranch_scc1 L_nb
    v_bfe_u32 v2, v1, 1, 3
    v_and_b32 v3, 1, v1
    v_lshl_add_u32 v3, v2, 7, v3
    v_lshlrev_b32 v3, 2, v3
    s_and_b32 s6, s4, 3
    s_lshl_b32 s6, s6, 7
    s_add_u32 s6, s6, 3911680
    s_mov_b32 s79, 262144
L_poll_60:
    buffer_load_dword v2, v3, s[8:11], s6 offen sc1
    s_waitcnt vmcnt(0)
    v_cmp_ne_u32 vcc, 1, v2
    s_cbranch_vccz L_polldone_61
    s_sleep 2
    s_sub_u32 s79, s79, 1
    s_cmp_lg_u32 s79, 0
    s_cbranch_scc1 L_poll_60
L_polldone_61:
L_nb:
    buffer_load_dwordx4 v[96:99], v53, s[12:15], s70 offen
    buffer_load_dwordx4 v[100:103], v48, s[8:11], 0 offen sc1
    s_cmp_ge_u32 s3, 2
    s_cbranch_scc1 L_itskip_62
    buffer_load_dwordx4 v[104:107], v54, s[12:15], s70 offen
    buffer_load_dwordx4 v[108:111], v49, s[8:11], 0 offen sc1
L_itskip_62:
    v_mfma_f32_16x16x32_bf16 v[92:95], v[172:175], v[28:31], v[92:95]
    ds_read_b128 v[28:31], v4 offset:39936
    v_mfma_f32_16x16x32_bf16 v[92:95], v[192:195], v[16:19], v[92:95]
    ds_write_b128 v5, v[68:71]
    s_add_u32 s6, s73, 65536
    v_add_u32 v5, s6, v52
    v_mfma_f32_16x16x32_bf16 v[88:91], v[188:191], v[16:19], v[88:91]
    v_mfma_f32_16x16x32_bf16 v[84:87], v[184:187], v[16:19], v[84:87]
    v_mfma_f32_16x16x32_bf16 v[80:83], v[180:183], v[16:19], v[80:83]
    s_waitcnt lgkmcnt(5)
    v_mfma_f32_16x16x32_bf16 v[76:79], v[176:179], v[16:19], v[76:79]
    v_mfma_f32_16x16x32_bf16 v[76:79], v[196:199], v[20:23], v[76:79]
    ds_write_b128 v5, v[72:75]
    v_mfma_f32_16x16x32_bf16 v[80:83], v[200:203], v[20:23], v[80:83]
    v_mfma_f32_16x16x32_bf16 v[84:87], v[204:207], v[20:23], v[84:87]
    v_mfma_f32_16x16x32_bf16 v[88:91], v[208:211], v[20:23], v[88:91]
    s_waitcnt lgkmcnt(4)
    v_mfma_f32_16x16x32_bf16 v[92:95], v[212:215], v[20:23], v[92:95]
    v_mfma_f32_16x16x32_bf16 v[92:95], v[232:235], v[24:27], v[92:95]
    v_bfe_u32 v2, v1, 3, 2
    v_min_u32 v2, 2, v2
    v_and_b32 v3, 7, v1
    v_lshlrev_b32 v3, 2, v3
    v_lshl_add_u32 v3, v2, 7, v3
    v_mfma_f32_16x16x32_bf16 v[88:91], v[228:231], v[24:27], v[88:91]
    s_bitcmp1_b32 13, s3
    s_cselect_b32 s77, 1, 2
    buffer_load_dword v50, v3, s[8:11], s63 offen sc1
    v_mfma_f32_16x16x32_bf16 v[84:87], v[224:227], v[24:27], v[84:87]
    v_mfma_f32_16x16x32_bf16 v[80:83], v[220:223], v[24:27], v[80:83]
    s_waitcnt lgkmcnt(2)
    s_add_u32 s6, s73, 86016
    s_cmp_lt_u32 s3, 4
    s_cselect_b32 s73, s73, s6
    v_mfma_f32_16x16x32_bf16 v[76:79], v[216:219], v[24:27], v[76:79]
    v_mfma_f32_16x16x32_bf16 v[76:79], v[236:239], v[28:31], v[76:79]
    v_mfma_f32_16x16x32_bf16 v[80:83], v[240:243], v[28:31], v[80:83]
    v_mfma_f32_16x16x32_bf16 v[84:87], v[244:247], v[28:31], v[84:87]
    v_mfma_f32_16x16x32_bf16 v[88:91], v[248:251], v[28:31], v[88:91]
    v_mfma_f32_16x16x32_bf16 v[92:95], v[252:255], v[28:31], v[92:95]
    s_nop 4
    v_add_u32 v5, s73, v44
    ds_write_b128 v5, v[76:79]
    v_add_u32 v5, s73, v45
    ds_write_b128 v5, v[80:83]
    v_add_u32 v5, s73, v46
    ds_write_b128 v5, v[84:87]
    v_add_u32 v5, s73, v47
    ds_write_b128 v5, v[88:91]
    v_add_u32 v5, s73, v52
    ds_write_b128 v5, v[92:95]
    s_waitcnt vmcnt(0)
    v_cmp_gt_u32 s[78:79], s77, v50
    s_nop 3
    s_cmp_lg_u64 s[78:79], 0
    s_cbranch_scc1 L_x2a
    s_add_u32 s6, s62, 0
    buffer_load_dwordx4 v[112:115], v8, s[8:11], s6 offen offset:0 sc1
    buffer_load_dwordx4 v[116:119], v8, s[8:11], s6 offen offset:256 sc1
    s_add_u32 s6, s62, 20480
    buffer_load_dwordx4 v[120:123], v8, s[8:11], s6 offen offset:0 sc1
    buffer_load_dwordx4 v[124:127], v8, s[8:11], s6 offen offset:256 sc1
    s_add_u32 s6, s62, 40960
    buffer_load_dwordx4 v[128:131], v8, s[8:11], s6 offen offset:0 sc1
    buffer_load_dwordx4 v[132:135], v8, s[8:11], s6 offen offset:256 sc1
    s_cmp_ge_u32 s3, 2
    s_cbranch_scc1 L_xi_63
    s_add_u32 s6, s62, 0
    buffer_load_dwordx4 v[136:139], v9, s[8:11], s6 offen offset:0 sc1
    buffer_load_dwordx4 v[140:143], v9, s[8:11], s6 offen offset:256 sc1
    s_add_u32 s6, s62, 20480
    buffer_load_dwordx4 v[144:147], v9, s[8:11], s6 offen offset:0 sc1
    buffer_load_dwordx4 v[148:151], v9, s[8:11], s6 offen offset:256 sc1
    s_add_u32 s6, s62, 40960
    buffer_load_dwordx4 v[152:155], v9, s[8:11], s6 offen offset:0 sc1
    buffer_load_dwordx4 v[156:159], v9, s[8:11], s6 offen offset:256 sc1
L_xi_63:
L_x2a:
    s_waitcnt lgkmcnt(0)
    s_barrier
    ds_read_b128 v[160:163], v10 offset:0
    ds_read_b128 v[164:167], v10 offset:256
    ds_read_b128 v[168:171], v10 offset:5120
    ds_read_b128 v[172:175], v10 offset:5376
    ds_read_b128 v[176:179], v10 offset:10240
    ds_read_b128 v[180:183], v10 offset:10496
    ds_read_b128 v[184:187], v10 offset:15360
    ds_read_b128 v[188:191], v10 offset:15616
    ds_read_b128 v[192:195], v55 offset:0
    ds_read_b128 v[196:199], v55 offset:256
    ds_read_b128 v[200:203], v55 offset:5120
    ds_read_b128 v[204:207], v55 offset:5376
    ds_read_b128 v[208:211], v55 offset:10240
    ds_read_b128 v[212:215], v55 offset:10496
    ds_read_b128 v[216:219], v55 offset:15360
    ds_read_b128 v[220:223], v55 offset:15616
    s_cmp_eq_u64 s[78:79], 0
    s_cbranch_scc1 L_x2b
    s_mov_b32 s79, 262144
L_poll_64:
    buffer_load_dword v2, v3, s[8:11], s63 offen sc1
    s_waitcnt vmcnt(0)
    v_cmp_gt_u32 vcc, s77, v2
    s_cbranch_vccz L_polldone_65
    s_sleep 1
    s_sub_u32 s79, s79, 1
    s_cmp_lg_u32 s79, 0
    s_cbranch_scc1 L_poll_64
L_polldone_65:
    s_add_u32 s6, s62, 0
    buffer_load_dwordx4 v[112:115], v8, s[8:11], s6 offen offset:0 sc1
    buffer_load_dwordx4 v[116:119], v8, s[8:11], s6 offen offset:256 sc1
    s_add_u32 s6, s62, 20480
    buffer_load_dwordx4 v[120:123], v8, s[8:11], s6 offen offset:0 sc1
    buffer_load_dwordx4 v[124:127], v8, s[8:11], s6 offen offset:256 sc1
    s_add_u32 s6, s62, 40960
    buffer_load_dwordx4 v[128:131], v8, s[8:11], s6 offen offset:0 sc1
    buffer_load_dwordx4 v[132:135], v8, s[8:11], s6 offen offset:256 sc1
    s_cmp_ge_u32 s3, 2
    s_cbranch_scc1 L_xi_66
    s_add_u32 s6, s62, 0
    buffer_load_dwordx4 v[136:139], v9, s[8:11], s6 offen offset:0 sc1
    buffer_load_dwordx4 v[140:143], v9, s[8:11], s6 offen offset:256 sc1
    s_add_u32 s6, s62, 20480
    buffer_load_dwordx4 v[144:147], v9, s[8:11], s6 offen offset:0 sc1
    buffer_load_dwordx4 v[148:151], v9, s[8:11], s6 offen offset:256 sc1
    s_add_u32 s6, s62, 40960
    buffer_load_dwordx4 v[152:155], v9, s[8:11], s6 offen offset:0 sc1
    buffer_load_dwordx4 v[156:159], v9, s[8:11], s6 offen offset:256 sc1
L_xi_66:
L_x2b:
    s_mov_b32 s16, s54
    s_mov_b32 s17, s55
    s_mov_b32 s18, 0x280000
    s_mov_b32 s19, 0x20000
    s_waitcnt lgkmcnt(8)
    v_pk_add_f32 v[160:161], v[160:161], v[168:169]
    v_pk_add_f32 v[162:163], v[162:163], v[170:171]
    v_pk_add_f32 v[164:165], v[164:165], v[172:173]
    v_pk_add_f32 v[166:167], v[166:167], v[174:175]
    v_pk_add_f32 v[160:161], v[160:161], v[176:177]
    v_pk_add_f32 v[162:163], v[162:163], v[178:179]
    v_pk_add_f32 v[164:165], v[164:165], v[180:181]
    v_pk_add_f32 v[166:167], v[166:167], v[182:183]
    v_pk_add_f32 v[160:161], v[160:161], v[184:185]
    v_pk_add_f32 v[162:163], v[162:163], v[186:187]
    v_pk_add_f32 v[164:165], v[164:165], v[188:189]
    v_pk_add_f32 v[166:167], v[166:167], v[190:191]
    s_waitcnt vmcnt(0)
    v_pk_add_f32 v[160:161], v[160:161], v[112:113]
    v_pk_add_f32 v[162:163], v[162:163], v[114:115]
    v_pk_add_f32 v[164:165], v[164:165], v[116:117]
    v_pk_add_f32 v[166:167], v[166:167], v[118:119]
    v_pk_add_f32 v[160:161], v[160:161], v[120:121]
    v_pk_add_f32 v[162:163], v[162:163], v[122:123]
    v_pk_add_f32 v[164:165], v[164:165], v[124:125]
    v_pk_add_f32 v[166:167], v[166:167], v[126:127]
    v_pk_add_f32 v[160:161], v[160:161], v[128:129]
    v_pk_add_f32 v[162:163], v[162:163], v[130:131]
    v_pk_add_f32 v[164:165], v[164:165], v[132:133]
    v_pk_add_f32 v[166:167], v[166:167], v[134:135]
    v_cvt_pk_bf16_f32 v2, v160, v161
    v_lshlrev_b32 v160, 16, v2
    v_and_b32 v161, 0xffff0000, v2
    v_lshlrev_b32 v2, 16, v96
    v_and_b32 v3, 0xffff0000, v96
    v_pk_add_f32 v[160:161], v[160:161], v[2:3]
    v_cvt_pk_bf16_f32 v2, v160, v161
    v_lshlrev_b32 v160, 16, v2
    v_and_b32 v161, 0xffff0000, v2
    v_lshlrev_b32 v2, 16, v100
    v_and_b32 v3, 0xffff0000, v100
    v_pk_add_f32 v[160:161], v[160:161], v[2:3]
    v_cvt_pk_bf16_f32 v224, v160, v161
    v_cvt_pk_bf16_f32 v2, v162, v163
    v_lshlrev_b32 v162, 16, v2
    v_and_b32 v163, 0xffff0000, v2
    v_lshlrev_b32 v2, 16, v97
    v_and_b32 v3, 0xffff0000, v97
    v_pk_add_f32 v[162:163], v[162:163], v[2:3]
    v_cvt_pk_bf16_f32 v2, v162, v163
    v_lshlrev_b32 v162, 16, v2
    v_and_b32 v163, 0xffff0000, v2
    v_lshlrev_b32 v2, 16, v101
    v_and_b32 v3, 0xffff0000, v101
    v_pk_add_f32 v[162:163], v[162:163], v[2:3]
    v_cvt_pk_bf16_f32 v225, v162, v163
    v_cvt_pk_bf16_f32 v2, v164, v165
    v_lshlrev_b32 v164, 16, v2
    v_and_b32 v165, 0xffff0000, v2
    v_lshlrev_b32 v2, 16, v98
    v_and_b32 v3, 0xffff0000, v98
    v_pk_add_f32 v[164:165], v[164:165], v[2:3]
    v_cvt_pk_bf16_f32 v2, v164, v165
    v_lshlrev_b32 v164, 16, v2
    v_and_b32 v165, 0xffff0000, v2
    v_lshlrev_b32 v2, 16, v102
    v_and_b32 v3, 0xffff0000, v102
    v_pk_add_f32 v[164:165], v[164:165], v[2:3]
    v_cvt_pk_bf16_f32 v226, v164, v165
    v_cvt_pk_bf16_f32 v2, v166, v167
    v_lshlrev_b32 v166, 16, v2
    v_and_b32 v167, 0xffff0000, v2
    v_lshlrev_b32 v2, 16, v99
    v_and_b32 v3, 0xffff0000, v99
    v_pk_add_f32 v[166:167], v[166:167], v[2:3]
    v_cvt_pk_bf16_f32 v2, v166, v167
    v_lshlrev_b32 v166, 16, v2
    v_and_b32 v167, 0xffff0000, v2
    v_lshlrev_b32 v2, 16, v103
    v_and_b32 v3, 0xffff0000, v103
    v_pk_add_f32 v[166:167], v[166:167], v[2:3]
    v_cvt_pk_bf16_f32 v227, v166, v167
    buffer_store_dwordx4 v[224:227], v53, s[16:19], s70 offen
    s_cmp_ge_u32 s3, 2
    s_cbranch_scc1 L_end
    s_waitcnt lgkmcnt(0)
    v_pk_add_f32 v[192:193], v[192:193], v[200:201]
    v_pk_add_f32 v[194:195], v[194:195], v[202:203]
    v_pk_add_f32 v[196:197], v[196:197], v[204:205]
    v_pk_add_f32 v[198:199], v[198:199], v[206:207]
    v_pk_add_f32 v[192:193], v[192:193], v[208:209]
    v_pk_add_f32 v[194:195], v[194:195], v[210:211]
    v_pk_add_f32 v[196:197], v[196:197], v[212:213]
    v_pk_add_f32 v[198:199], v[198:199], v[214:215]
    v_pk_add_f32 v[192:193], v[192:193], v[216:217]
    v_pk_add_f32 v[194:195], v[194:195], v[218:219]
    v_pk_add_f32 v[196:197], v[196:197], v[220:221]
    v_pk_add_f32 v[198:199], v[198:199], v[222:223]
    s_nop 0
    v_pk_add_f32 v[192:193], v[192:193], v[136:137]
    v_pk_add_f32 v[194:195], v[194:195], v[138:139]
    v_pk_add_f32 v[196:197], v[196:197], v[140:141]
    v_pk_add_f32 v[198:199], v[198:199], v[142:143]
    v_pk_add_f32 v[192:193], v[192:193], v[144:145]
    v_pk_add_f32 v[194:195], v[194:195], v[146:147]
    v_pk_add_f32 v[196:197], v[196:197], v[148:149]
    v_pk_add_f32 v[198:199], v[198:199], v[150:151]
    v_pk_add_f32 v[192:193], v[192:193], v[152:153]
    v_pk_add_f32 v[194:195], v[194:195], v[154:155]
    v_pk_add_f32 v[196:197], v[196:197], v[156:157]
    v_pk_add_f32 v[198:199], v[198:199], v[158:159]
    v_cvt_pk_bf16_f32 v2, v192, v193
    v_lshlrev_b32 v192, 16, v2
    v_and_b32 v193, 0xffff0000, v2
    v_lshlrev_b32 v2, 16, v104
    v_and_b32 v3, 0xffff0000, v104
    v_pk_add_f32 v[192:193], v[192:193], v[2:3]
    v_cvt_pk_bf16_f32 v2, v192, v193
    v_lshlrev_b32 v192, 16, v2
    v_and_b32 v193, 0xffff0000, v2
    v_lshlrev_b32 v2, 16, v108
    v_and_b32 v3, 0xffff0000, v108
    v_pk_add_f32 v[192:193], v[192:193], v[2:3]
    v_cvt_pk_bf16_f32 v228, v192, v193
    v_cvt_pk_bf16_f32 v2, v194, v195
    v_lshlrev_b32 v194, 16, v2
    v_and_b32 v195, 0xffff0000, v2
    v_lshlrev_b32 v2, 16, v105
    v_and_b32 v3, 0xffff0000, v105
    v_pk_add_f32 v[194:195], v[194:195], v[2:3]
    v_cvt_pk_bf16_f32 v2, v194, v195
    v_lshlrev_b32 v194, 16, v2
    v_and_b32 v195, 0xffff0000, v2
    v_lshlrev_b32 v2, 16, v109
    v_and_b32 v3, 0xffff0000, v109
    v_pk_add_f32 v[194:195], v[194:195], v[2:3]
    v_cvt_pk_bf16_f32 v229, v194, v195
    v_cvt_pk_bf16_f32 v2, v196, v197
    v_lshlrev_b32 v196, 16, v2
    v_and_b32 v197, 0xffff0000, v2
    v_lshlrev_b32 v2, 16, v106
    v_and_b32 v3, 0xffff0000, v106
    v_pk_add_f32 v[196:197], v[196:197], v[2:3]
    v_cvt_pk_bf16_f32 v2, v196, v197
    v_lshlrev_b32 v196, 16, v2
    v_and_b32 v197, 0xffff0000, v2
    v_lshlrev_b32 v2, 16, v110
    v_and_b32 v3, 0xffff0000, v110
    v_pk_add_f32 v[196:197], v[196:197], v[2:3]
    v_cvt_pk_bf16_f32 v230, v196, v197
    v_cvt_pk_bf16_f32 v2, v198, v199
    v_lshlrev_b32 v198, 16, v2
    v_and_b32 v199, 0xffff0000, v2
    v_lshlrev_b32 v2, 16, v107
    v_and_b32 v3, 0xffff0000, v107
    v_pk_add_f32 v[198:199], v[198:199], v[2:3]
    v_cvt_pk_bf16_f32 v2, v198, v199
    v_lshlrev_b32 v198, 16, v2
    v_and_b32 v199, 0xffff0000, v2
    v_lshlrev_b32 v2, 16, v111
    v_and_b32 v3, 0xffff0000, v111
    v_pk_add_f32 v[198:199], v[198:199], v[2:3]
    v_cvt_pk_bf16_f32 v231, v198, v199
    buffer_store_dwordx4 v[228:231], v54, s[16:19], s70 offen
L_end:
L_exit:
    s_endpgm
.section .rodata,"a"
.p2align 6
.amdhsa_kernel parallel_sum__compressed_kv_cla__moe_arch_mod__prompt_kernel
  .amdhsa_next_free_vgpr 256
  .amdhsa_next_free_sgpr 102
  .amdhsa_accum_offset 256
  .amdhsa_group_segment_fixed_size 0
  .amdhsa_kernarg_size 112
  .amdhsa_user_sgpr_count 2
  .amdhsa_user_sgpr_kernarg_segment_ptr 1
  .amdhsa_system_sgpr_workgroup_id_x 1
  .amdhsa_float_denorm_mode_32 3
.end_amdhsa_kernel
```

```asm
; @launch grid=(256,1,1) block=(512,1,1) lds=163840
.amdgcn_target "amdgcn-amd-amdhsa--gfx950"
.text
.globl parallel_sum__compressed_kv_cla__moe_arch_mod__prompt_kernel
.p2align 8
.type parallel_sum__compressed_kv_cla__moe_arch_mod__prompt_kernel,@function
parallel_sum__compressed_kv_cla__moe_arch_mod__prompt_kernel:
    s_cmp_ge_u32 s2, 256
    s_cbranch_scc1 L_exit
    s_load_dwordx16 s[32:47], s[0:1], 0
    s_load_dwordx8 s[48:55], s[0:1], 64
    s_load_dwordx4 s[56:59], s[0:1], 96
    v_lshrrev_b32 v2, 6, v0
    v_and_b32 v1, 63, v0
    v_readfirstlane_b32 s3, v2
    s_getpc_b64 s[80:81]
L_pc:
    s_lshr_b32 s6, s2, 3
    s_and_b32 s6, s6, 15
    s_lshl_b32 s6, s6, 12
    s_cmp_lt_u32 s3, 2
    s_cselect_b32 s6, 0, s6
    v_lshl_add_u32 v3, v0, 6, s6
    v_min_u32 v3, L_exit-L_pc, v3
    s_cmp_ge_u32 s3, 3
    s_cbranch_scc1 L_noct
    global_load_dword v11, v3, s[80:81]
L_noct:
    v_lshrrev_b32 v62, 5, v0
    v_and_b32 v62, 7, v62
    v_and_b32 v2, 31, v0
    v_lshlrev_b32 v2, 3, v2
    v_mul_u32_u24 v63, 1280, v62
    v_add_u32 v63, v63, v2
    s_mul_i32 s6, s2, 10240
    v_add_u32 v10, s6, v63
    s_cmp_lt_u32 s3, 4
    s_cbranch_scc1 L_st_k0
    s_waitcnt lgkmcnt(0)
    global_load_dwordx2 v[16:17], v10, s[32:33] offset:0
    global_load_dwordx2 v[18:19], v10, s[32:33] offset:256
    global_load_dwordx2 v[20:21], v10, s[32:33] offset:512
    global_load_dwordx2 v[22:23], v10, s[32:33] offset:768
    global_load_dwordx2 v[24:25], v10, s[32:33] offset:1024
    global_load_dwordx2 v[26:27], v2, s[46:47] offset:0
    global_load_dwordx2 v[28:29], v2, s[46:47] offset:256
    global_load_dwordx2 v[30:31], v2, s[46:47] offset:512
    global_load_dwordx2 v[32:33], v2, s[46:47] offset:768
    global_load_dwordx2 v[34:35], v2, s[46:47] offset:1024
    s_barrier
L_st_k0:
    s_and_b32 s6, s2, 7
    s_lshl_b32 s6, s6, 2
    s_lshr_b32 s7, s2, 3
    s_and_b32 s7, s7, 3
    s_add_u32 s4, s6, s7
    s_lshr_b32 s5, s2, 5
    s_and_b32 s76, s3, 3
    v_lshrrev_b32 v2, 3, v1
    v_and_b32 v3, 7, v1
    v_lshrrev_b32 v4, 4, v1
    v_xor_b32 v5, v3, v4
    v_lshlrev_b32 v5, 4, v5
    v_lshl_add_u32 v40, v2, 10, v5
    v_xor_b32 v5, 64, v40
    v_add_u32 v41, 7168, v5
    v_add_u32 v42, 14336, v40
    v_add_u32 v43, 14336, v41
    v_and_b32 v6, 15, v1
    s_lshl_b32 s6, s76, 4
    v_add_u32 v7, s6, v4
    v_lshlrev_b32 v5, 1, v4
    v_xor_b32 v5, v6, v5
    v_lshlrev_b32 v5, 4, v5
    v_lshl_add_u32 v44, v7, 13, v5
    v_add_u32 v45, 31744, v44
    v_xor_b32 v5, 0x80, v44
    v_add_u32 v46, 63488, v5
    v_add_u32 v47, 31744, v46
    s_and_b32 s6, s76, 1
    s_lshl_b32 s6, s6, 20
    s_lshr_b32 s7, s76, 1
    s_lshl_b32 s7, s7, 18
    s_add_u32 s6, s6, s7
    s_lshl_b32 s62, s5, 15
    s_add_u32 s62, s62, s6
    s_lshl_b32 s63, s4, 8
    s_lshl_b32 s64, s76, 13
    s_lshl_b32 s73, s76, 12
    s_add_u32 s73, s73, 32768
    s_andn2_b32 s100, 1, s5
    s_lshl_b32 s100, s100, 16
    s_add_u32 s64, s64, s100
    s_add_u32 s73, s73, s100
    s_waitcnt lgkmcnt(0)
    s_mov_b32 s12, s34
    s_mov_b32 s13, s35
    s_mov_b32 s14, 0x200000
    s_mov_b32 s15, 0x20000
    s_mov_b32 s16, s38
    s_mov_b32 s17, s39
    s_mov_b32 s18, 0x400000
    s_mov_b32 s19, 0x20000
    s_mov_b32 s20, s40
    s_mov_b32 s21, s41
    s_mov_b32 s22, 0x400000
    s_mov_b32 s23, 0x20000
    s_cmp_ge_u32 s3, 4
    s_cbranch_scc1 L_st_v0
    s_barrier
    s_mov_b32 m0, s64
    s_add_u32 s72, s62, 524288
    buffer_load_dwordx4 v40, s[12:15], s62 offen offset:0 lds
    buffer_load_dwordx4 v41, s[12:15], s62 offen offset:1024 lds
    buffer_load_dwordx4 v42, s[12:15], s62 offen offset:2048 lds
    buffer_load_dwordx4 v43, s[12:15], s62 offen offset:3072 lds
    s_add_u32 m0, s64, 4096
    s_add_u32 s62, s62, 128
    s_bitset0_b32 s62, 10
    buffer_load_dwordx4 v40, s[12:15], s72 offen offset:0 lds
    buffer_load_dwordx4 v41, s[12:15], s72 offen offset:1024 lds
    buffer_load_dwordx4 v42, s[12:15], s72 offen offset:2048 lds
    buffer_load_dwordx4 v43, s[12:15], s72 offen offset:3072 lds
    s_mov_b32 m0, s73
    s_xor_b32 s64, s64, 0x10000
    buffer_load_dwordx4 v44, s[16:19], s63 offen offset:0 lds
    buffer_load_dwordx4 v45, s[16:19], s63 offen offset:1024 lds
    buffer_load_dwordx4 v46, s[16:19], s63 offen offset:2048 lds
    buffer_load_dwordx4 v47, s[16:19], s63 offen offset:3072 lds
    s_add_u32 m0, s73, 16384
    s_xor_b32 s73, s73, 0x10000
    buffer_load_dwordx4 v44, s[20:23], s63 offen offset:0 lds
    buffer_load_dwordx4 v45, s[20:23], s63 offen offset:1024 lds
    buffer_load_dwordx4 v46, s[20:23], s63 offen offset:2048 lds
    buffer_load_dwordx4 v47, s[20:23], s63 offen offset:3072 lds
    s_add_u32 s63, s63, 524288
    s_bitset0_b32 s63, 22
    s_setprio 1
L_st_v0:
    s_mov_b32 s8, s58
    s_mov_b32 s9, s59
    s_mov_b32 s10, 0x5000000
    s_mov_b32 s11, 0x20000
    s_mov_b32 s24, s36
    s_mov_b32 s25, s37
    s_mov_b32 s26, 0x500000
    s_mov_b32 s27, 0x20000
    v_lshlrev_b32 v13, 4, v1
    s_lshl_b32 s6, s5, 2
    s_add_u32 s7, s6, s3
    s_sub_u32 s6, 56, s6
    s_add_u32 s6, s6, s3
    s_cmp_lt_u32 s3, 4
    s_cselect_b32 s60, s7, s6
    s_sub_u32 s6, 2, s5
    s_and_b32 s6, s6, 7
    s_lshl_b32 s6, s6, 5
    s_add_u32 s61, s6, s4
    v_and_b32 v2, 15, v1
    v_lshrrev_b32 v3, 4, v1
    s_and_b32 s6, s3, 1
    s_lshl_b32 s6, s6, 7
    v_add_u32 v4, s6, v2
    v_lshlrev_b32 v4, 7, v4
    v_add_u32 v4, s100, v4
    v_lshrrev_b32 v5, 1, v2
    v_add_u32 v6, 0, v3
    v_xor_b32 v6, v6, v5
    v_lshl_add_u32 v48, v6, 4, v4
    v_add_u32 v6, 4, v3
    v_xor_b32 v6, v6, v5
    v_lshl_add_u32 v49, v6, 4, v4
    v_lshrrev_b32 v4, 2, v2
    v_lshl_add_u32 v5, v3, 3, v4
    v_lshlrev_b32 v5, 8, v5
    v_and_b32 v6, 1, v2
    v_lshl_add_u32 v5, v6, 3, v5
    v_and_b32 v6, 1, v3
    v_lshl_or_b32 v4, v6, 2, v4
    v_lshlrev_b32 v4, 1, v4
    v_bfe_u32 v6, v2, 1, 1
    v_add_u32 v8, 131072, v5
    v_add_u32 v7, 0, v6
    v_xor_b32 v7, v7, v4
    v_lshl_add_u32 v54, v7, 4, v8
    v_add_u32 v7, 2, v6
    v_xor_b32 v7, v7, v4
    v_lshl_add_u32 v55, v7, 4, v8
    v_add_u32 v7, 4, v6
    v_xor_b32 v7, v7, v4
    v_lshl_add_u32 v56, v7, 4, v8
    v_add_u32 v7, 6, v6
    v_xor_b32 v7, v7, v4
    v_lshl_add_u32 v57, v7, 4, v8
    v_add_u32 v7, 8, v6
    v_xor_b32 v7, v7, v4
    v_lshl_add_u32 v58, v7, 4, v8
    v_add_u32 v7, 10, v6
    v_xor_b32 v7, v7, v4
    v_lshl_add_u32 v59, v7, 4, v8
    v_add_u32 v7, 12, v6
    v_xor_b32 v7, v7, v4
    v_lshl_add_u32 v60, v7, 4, v8
    v_add_u32 v7, 14, v6
    v_xor_b32 v7, v7, v4
    v_lshl_add_u32 v61, v7, 4, v8
    s_lshr_b32 s6, s3, 2
    s_lshl_b32 s6, s6, 14
    s_add_u32 s6, s6, 32768
    s_add_u32 s6, s6, s100
    v_add_u32 v5, s6, v5
    s_lshr_b32 s7, s3, 1
    s_and_b32 s7, s7, 1
    s_lshl_b32 s7, s7, 3
    s_add_u32 s6, s7, 0
    v_add_u32 v7, s6, v6
    v_xor_b32 v7, v7, v4
    v_lshl_add_u32 v50, v7, 4, v5
    s_add_u32 s6, s7, 2
    v_add_u32 v7, s6, v6
    v_xor_b32 v7, v7, v4
    v_lshl_add_u32 v51, v7, 4, v5
    s_add_u32 s6, s7, 4
    v_add_u32 v7, s6, v6
    v_xor_b32 v7, v7, v4
    v_lshl_add_u32 v52, v7, 4, v5
    s_add_u32 s6, s7, 6
    v_add_u32 v7, s6, v6
    v_xor_b32 v7, v7, v4
    v_lshl_add_u32 v53, v7, 4, v5
    v_mov_b64 v[128:129], 0
    v_mov_b64 v[130:131], 0
    v_mov_b64 v[132:133], 0
    v_mov_b64 v[134:135], 0
    v_mov_b64 v[136:137], 0
    v_mov_b64 v[138:139], 0
    v_mov_b64 v[140:141], 0
    v_mov_b64 v[142:143], 0
    v_mov_b64 v[144:145], 0
    v_mov_b64 v[146:147], 0
    v_mov_b64 v[148:149], 0
    v_mov_b64 v[150:151], 0
    v_mov_b64 v[152:153], 0
    v_mov_b64 v[154:155], 0
    v_mov_b64 v[156:157], 0
    v_mov_b64 v[158:159], 0
    v_mov_b64 v[160:161], 0
    v_mov_b64 v[162:163], 0
    v_mov_b64 v[164:165], 0
    v_mov_b64 v[166:167], 0
    v_mov_b64 v[168:169], 0
    v_mov_b64 v[170:171], 0
    v_mov_b64 v[172:173], 0
    v_mov_b64 v[174:175], 0
    v_mov_b64 v[176:177], 0
    v_mov_b64 v[178:179], 0
    v_mov_b64 v[180:181], 0
    v_mov_b64 v[182:183], 0
    v_mov_b64 v[184:185], 0
    v_mov_b64 v[186:187], 0
    v_mov_b64 v[188:189], 0
    v_mov_b64 v[190:191], 0
    v_mov_b64 v[192:193], 0
    v_mov_b64 v[194:195], 0
    v_mov_b64 v[196:197], 0
    v_mov_b64 v[198:199], 0
    v_mov_b64 v[200:201], 0
    v_mov_b64 v[202:203], 0
    v_mov_b64 v[204:205], 0
    v_mov_b64 v[206:207], 0
    v_mov_b64 v[208:209], 0
    v_mov_b64 v[210:211], 0
    v_mov_b64 v[212:213], 0
    v_mov_b64 v[214:215], 0
    v_mov_b64 v[216:217], 0
    v_mov_b64 v[218:219], 0
    v_mov_b64 v[220:221], 0
    v_mov_b64 v[222:223], 0
    v_mov_b64 v[224:225], 0
    v_mov_b64 v[226:227], 0
    v_mov_b64 v[228:229], 0
    v_mov_b64 v[230:231], 0
    v_mov_b64 v[232:233], 0
    v_mov_b64 v[234:235], 0
    v_mov_b64 v[236:237], 0
    v_mov_b64 v[238:239], 0
    v_mov_b64 v[240:241], 0
    v_mov_b64 v[242:243], 0
    v_mov_b64 v[244:245], 0
    v_mov_b64 v[246:247], 0
    v_mov_b64 v[248:249], 0
    v_mov_b64 v[250:251], 0
    v_mov_b64 v[252:253], 0
    v_mov_b64 v[254:255], 0
    v_add_u32 v12, 20480, v13
    s_mul_i32 s70, s60, 40960
    s_mov_b32 s65, 0
    s_lshl_b32 s6, s4, 20
    s_lshl_b32 s7, s5, 13
    s_add_u32 s6, s6, s7
    s_and_b32 s7, s3, 1
    s_lshl_b32 s7, s7, 16
    s_add_u32 s6, s6, s7
    s_add_u32 s67, s6, 16777216
    s_and_b32 s6, s4, 3
    s_add_u32 s6, s6, s5
    s_sub_u32 s7, s6, 5
    s_cselect_b32 s6, s6, s7
    s_sub_u32 s7, s6, 5
    s_cselect_b32 s6, s6, s7
    s_lshl_b32 s71, s6, 20
    s_lshl_b32 s7, s4, 8
    s_add_u32 s71, s71, s7
    s_lshl_b32 s7, s6, 12
    s_add_u32 s84, s70, s7
    s_add_u32 s6, s6, 1
    s_cmp_eq_u32 s6, 5
    s_cselect_b32 s6, 0, s6
    s_lshl_b32 s7, s6, 12
    s_add_u32 s85, s70, s7
    s_add_u32 s6, s6, 1
    s_cmp_eq_u32 s6, 5
    s_cselect_b32 s6, 0, s6
    s_lshl_b32 s7, s6, 12
    s_add_u32 s86, s70, s7
    s_add_u32 s6, s6, 1
    s_cmp_eq_u32 s6, 5
    s_cselect_b32 s6, 0, s6
    s_lshl_b32 s7, s6, 12
    s_add_u32 s87, s70, s7
    s_add_u32 s6, s6, 1
    s_cmp_eq_u32 s6, 5
    s_cselect_b32 s6, 0, s6
    s_lshl_b32 s7, s6, 12
    s_add_u32 s88, s70, s7
    s_lshr_b32 s7, s3, 1
    s_and_b32 s7, s7, 1
    s_cmp_ge_u32 s3, 4
    s_cbranch_scc1 L_c_v
    s_lshl_b32 s7, s7, 11
    s_add_u32 s67, s67, s7
    s_movk_i32 s68, 3072
    s_mov_b32 s69, 125952
    s_add_u32 s71, s71, 1048576
    s_sub_u32 s75, s71, 5242880
    s_cselect_b32 s71, s71, s75
    s_lshl_b32 s74, s76, 12
    s_add_u32 s74, s74, s100
    s_branch L_c_j
L_c_v:
    s_lshl_b32 s7, s7, 12
    s_add_u32 s67, s67, s7
    s_add_u32 s67, s67, 0x80000
    s_movk_i32 s68, 1024
    s_mov_b32 s69, 128000
L_c_j:
    s_cmp_ge_u32 s3, 4
    s_cbranch_scc1 L_st_v1
    s_mov_b32 m0, s64
    s_add_u32 s72, s62, 524288
    buffer_load_dwordx4 v40, s[12:15], s62 offen offset:0 lds
    buffer_load_dwordx4 v41, s[12:15], s62 offen offset:1024 lds
    buffer_load_dwordx4 v42, s[12:15], s62 offen offset:2048 lds
    buffer_load_dwordx4 v43, s[12:15], s62 offen offset:3072 lds
    s_add_u32 m0, s64, 4096
    s_add_u32 s62, s62, 128
    s_bitset0_b32 s62, 10
    buffer_load_dwordx4 v40, s[12:15], s72 offen offset:0 lds
    buffer_load_dwordx4 v41, s[12:15], s72 offen offset:1024 lds
    buffer_load_dwordx4 v42, s[12:15], s72 offen offset:2048 lds
    buffer_load_dwordx4 v43, s[12:15], s72 offen offset:3072 lds
    s_waitcnt vmcnt(8)
    s_branch L_st_j1
L_st_v1:
    s_waitcnt vmcnt(0)
    v_lshlrev_b32 v64, 16, v16
    v_and_b32 v65, 0xffff0000, v16
    v_lshlrev_b32 v66, 16, v17
    v_and_b32 v67, 0xffff0000, v17
    v_lshlrev_b32 v68, 16, v18
    v_and_b32 v69, 0xffff0000, v18
    v_lshlrev_b32 v70, 16, v19
    v_and_b32 v71, 0xffff0000, v19
    v_lshlrev_b32 v72, 16, v20
    v_and_b32 v73, 0xffff0000, v20
    v_lshlrev_b32 v74, 16, v21
    v_and_b32 v75, 0xffff0000, v21
    v_lshlrev_b32 v76, 16, v22
    v_and_b32 v77, 0xffff0000, v22
    v_lshlrev_b32 v78, 16, v23
    v_and_b32 v79, 0xffff0000, v23
    v_lshlrev_b32 v80, 16, v24
    v_and_b32 v81, 0xffff0000, v24
    v_lshlrev_b32 v82, 16, v25
    v_and_b32 v83, 0xffff0000, v25
    v_pk_add_f32 v[2:3], v[64:65], v[66:67]
    v_pk_add_f32 v[2:3], v[2:3], v[68:69]
    v_pk_add_f32 v[2:3], v[2:3], v[70:71]
    v_pk_add_f32 v[2:3], v[2:3], v[72:73]
    v_pk_add_f32 v[2:3], v[2:3], v[74:75]
    v_pk_add_f32 v[2:3], v[2:3], v[76:77]
    v_pk_add_f32 v[2:3], v[2:3], v[78:79]
    v_pk_add_f32 v[2:3], v[2:3], v[80:81]
    v_pk_add_f32 v[2:3], v[2:3], v[82:83]
    v_add_f32 v2, v2, v3
    s_nop 1
    v_add_f32_dpp v2, v2, v2 quad_perm:[1,0,3,2] row_mask:0xf bank_mask:0xf
    s_nop 1
    v_add_f32_dpp v2, v2, v2 quad_perm:[2,3,0,1] row_mask:0xf bank_mask:0xf
    s_nop 1
    v_add_f32_dpp v2, v2, v2 row_half_mirror row_mask:0xf bank_mask:0xf
    s_nop 1
    v_add_f32_dpp v2, v2, v2 row_mirror row_mask:0xf bank_mask:0xf
    v_mov_b32 v8, v2
    s_nop 1
    v_permlane16_swap_b32 v2, v8
    s_nop 1
    v_add_f32 v2, v2, v8
    s_mov_b32 s7, 0x3acccccd
    v_mul_f32 v2, s7, v2
    v_mov_b64 v[4:5], 0
    v_pk_add_f32 v[6:7], v[64:65], v[2:3] op_sel_hi:[1,0] neg_lo:[0,1] neg_hi:[0,1]
    v_pk_fma_f32 v[4:5], v[6:7], v[6:7], v[4:5]
    v_pk_add_f32 v[6:7], v[66:67], v[2:3] op_sel_hi:[1,0] neg_lo:[0,1] neg_hi:[0,1]
    v_pk_fma_f32 v[4:5], v[6:7], v[6:7], v[4:5]
    v_pk_add_f32 v[6:7], v[68:69], v[2:3] op_sel_hi:[1,0] neg_lo:[0,1] neg_hi:[0,1]
    v_pk_fma_f32 v[4:5], v[6:7], v[6:7], v[4:5]
    v_pk_add_f32 v[6:7], v[70:71], v[2:3] op_sel_hi:[1,0] neg_lo:[0,1] neg_hi:[0,1]
    v_pk_fma_f32 v[4:5], v[6:7], v[6:7], v[4:5]
    v_pk_add_f32 v[6:7], v[72:73], v[2:3] op_sel_hi:[1,0] neg_lo:[0,1] neg_hi:[0,1]
    v_pk_fma_f32 v[4:5], v[6:7], v[6:7], v[4:5]
    v_pk_add_f32 v[6:7], v[74:75], v[2:3] op_sel_hi:[1,0] neg_lo:[0,1] neg_hi:[0,1]
    v_pk_fma_f32 v[4:5], v[6:7], v[6:7], v[4:5]
    v_pk_add_f32 v[6:7], v[76:77], v[2:3] op_sel_hi:[1,0] neg_lo:[0,1] neg_hi:[0,1]
    v_pk_fma_f32 v[4:5], v[6:7], v[6:7], v[4:5]
    v_pk_add_f32 v[6:7], v[78:79], v[2:3] op_sel_hi:[1,0] neg_lo:[0,1] neg_hi:[0,1]
    v_pk_fma_f32 v[4:5], v[6:7], v[6:7], v[4:5]
    v_pk_add_f32 v[6:7], v[80:81], v[2:3] op_sel_hi:[1,0] neg_lo:[0,1] neg_hi:[0,1]
    v_pk_fma_f32 v[4:5], v[6:7], v[6:7], v[4:5]
    v_pk_add_f32 v[6:7], v[82:83], v[2:3] op_sel_hi:[1,0] neg_lo:[0,1] neg_hi:[0,1]
    v_pk_fma_f32 v[4:5], v[6:7], v[6:7], v[4:5]
    v_add_f32 v4, v4, v5
    s_nop 1
    v_add_f32_dpp v4, v4, v4 quad_perm:[1,0,3,2] row_mask:0xf bank_mask:0xf
    s_nop 1
    v_add_f32_dpp v4, v4, v4 quad_perm:[2,3,0,1] row_mask:0xf bank_mask:0xf
    s_nop 1
    v_add_f32_dpp v4, v4, v4 row_half_mirror row_mask:0xf bank_mask:0xf
    s_nop 1
    v_add_f32_dpp v4, v4, v4 row_mirror row_mask:0xf bank_mask:0xf
    v_mov_b32 v8, v4
    s_nop 1
    v_permlane16_swap_b32 v4, v8
    s_nop 1
    v_add_f32 v4, v4, v8
    v_mul_f32 v4, s7, v4
    v_cvt_pk_bf16_f32 v2, v2, v2
    v_lshlrev_b32 v2, 16, v2
    v_cvt_pk_bf16_f32 v4, v4, v4
    v_lshlrev_b32 v4, 16, v4
    v_add_f32 v4, 0x3727c5ac, v4
    v_cvt_pk_bf16_f32 v4, v4, v4
    v_lshlrev_b32 v4, 16, v4
    v_sqrt_f32 v4, v4
    s_nop 0
    v_cvt_pk_bf16_f32 v4, v4, v4
    v_lshlrev_b32 v4, 16, v4
    v_rcp_f32 v6, v4
    s_nop 0
    v_fma_f32 v5, -v4, v6, 1.0
    v_fmac_f32 v6, v5, v6
    v_mov_b32 v9, 0
    v_pk_add_f32 v[64:65], v[64:65], v[2:3] op_sel_hi:[1,0] neg_lo:[0,1] neg_hi:[0,1]
    v_cvt_pk_bf16_f32 v5, v64, v65
    v_lshlrev_b32 v64, 16, v5
    v_and_b32 v65, 0xffff0000, v5
    v_pk_mul_f32 v[64:65], v[64:65], v[6:7] op_sel_hi:[1,0]
    v_cvt_pk_bf16_f32 v16, v64, v65
    v_pk_add_f32 v[66:67], v[66:67], v[2:3] op_sel_hi:[1,0] neg_lo:[0,1] neg_hi:[0,1]
    v_cvt_pk_bf16_f32 v5, v66, v67
    v_lshlrev_b32 v66, 16, v5
    v_and_b32 v67, 0xffff0000, v5
    v_pk_mul_f32 v[66:67], v[66:67], v[6:7] op_sel_hi:[1,0]
    v_cvt_pk_bf16_f32 v17, v66, v67
    v_pk_add_f32 v[68:69], v[68:69], v[2:3] op_sel_hi:[1,0] neg_lo:[0,1] neg_hi:[0,1]
    v_cvt_pk_bf16_f32 v5, v68, v69
    v_lshlrev_b32 v68, 16, v5
    v_and_b32 v69, 0xffff0000, v5
    v_pk_mul_f32 v[68:69], v[68:69], v[6:7] op_sel_hi:[1,0]
    v_cvt_pk_bf16_f32 v18, v68, v69
    v_pk_add_f32 v[70:71], v[70:71], v[2:3] op_sel_hi:[1,0] neg_lo:[0,1] neg_hi:[0,1]
    v_cvt_pk_bf16_f32 v5, v70, v71
    v_lshlrev_b32 v70, 16, v5
    v_and_b32 v71, 0xffff0000, v5
    v_pk_mul_f32 v[70:71], v[70:71], v[6:7] op_sel_hi:[1,0]
    v_cvt_pk_bf16_f32 v19, v70, v71
    v_pk_add_f32 v[72:73], v[72:73], v[2:3] op_sel_hi:[1,0] neg_lo:[0,1] neg_hi:[0,1]
    v_cvt_pk_bf16_f32 v5, v72, v73
    v_lshlrev_b32 v72, 16, v5
    v_and_b32 v73, 0xffff0000, v5
    v_pk_mul_f32 v[72:73], v[72:73], v[6:7] op_sel_hi:[1,0]
    v_cvt_pk_bf16_f32 v20, v72, v73
    v_pk_add_f32 v[74:75], v[74:75], v[2:3] op_sel_hi:[1,0] neg_lo:[0,1] neg_hi:[0,1]
    v_cvt_pk_bf16_f32 v5, v74, v75
    v_lshlrev_b32 v74, 16, v5
    v_and_b32 v75, 0xffff0000, v5
    v_pk_mul_f32 v[74:75], v[74:75], v[6:7] op_sel_hi:[1,0]
    v_cvt_pk_bf16_f32 v21, v74, v75
    v_pk_add_f32 v[76:77], v[76:77], v[2:3] op_sel_hi:[1,0] neg_lo:[0,1] neg_hi:[0,1]
    v_cvt_pk_bf16_f32 v5, v76, v77
    v_lshlrev_b32 v76, 16, v5
    v_and_b32 v77, 0xffff0000, v5
    v_pk_mul_f32 v[76:77], v[76:77], v[6:7] op_sel_hi:[1,0]
    v_cvt_pk_bf16_f32 v22, v76, v77
    v_pk_add_f32 v[78:79], v[78:79], v[2:3] op_sel_hi:[1,0] neg_lo:[0,1] neg_hi:[0,1]
    v_cvt_pk_bf16_f32 v5, v78, v79
    v_lshlrev_b32 v78, 16, v5
    v_and_b32 v79, 0xffff0000, v5
    v_pk_mul_f32 v[78:79], v[78:79], v[6:7] op_sel_hi:[1,0]
    v_cvt_pk_bf16_f32 v23, v78, v79
    v_pk_add_f32 v[80:81], v[80:81], v[2:3] op_sel_hi:[1,0] neg_lo:[0,1] neg_hi:[0,1]
    v_cvt_pk_bf16_f32 v5, v80, v81
    v_lshlrev_b32 v80, 16, v5
    v_and_b32 v81, 0xffff0000, v5
    v_pk_mul_f32 v[80:81], v[80:81], v[6:7] op_sel_hi:[1,0]
    v_cvt_pk_bf16_f32 v24, v80, v81
    v_pk_add_f32 v[82:83], v[82:83], v[2:3] op_sel_hi:[1,0] neg_lo:[0,1] neg_hi:[0,1]
    v_cvt_pk_bf16_f32 v5, v82, v83
    v_lshlrev_b32 v82, 16, v5
    v_and_b32 v83, 0xffff0000, v5
    v_pk_mul_f32 v[82:83], v[82:83], v[6:7] op_sel_hi:[1,0]
    v_cvt_pk_bf16_f32 v25, v82, v83
    v_add_u32 v10, 131072, v63
    ds_write_b64 v10, v[16:17] offset:0
    ds_write_b64 v10, v[18:19] offset:256
    ds_write_b64 v10, v[20:21] offset:512
    ds_write_b64 v10, v[22:23] offset:768
    ds_write_b64 v10, v[24:25] offset:1024
    s_waitcnt lgkmcnt(0)
    v_mov_b32 v2, 0
    v_lshlrev_b32 v4, 16, v16
    v_lshlrev_b32 v5, 16, v26
    v_fmac_f32 v2, v4, v5
    v_and_b32 v4, 0xffff0000, v16
    v_and_b32 v5, 0xffff0000, v26
    v_fmac_f32 v2, v4, v5
    v_lshlrev_b32 v4, 16, v17
    v_lshlrev_b32 v5, 16, v27
    v_fmac_f32 v2, v4, v5
    v_and_b32 v4, 0xffff0000, v17
    v_and_b32 v5, 0xffff0000, v27
    v_fmac_f32 v2, v4, v5
    v_lshlrev_b32 v4, 16, v18
    v_lshlrev_b32 v5, 16, v28
    v_fmac_f32 v2, v4, v5
    v_and_b32 v4, 0xffff0000, v18
    v_and_b32 v5, 0xffff0000, v28
    v_fmac_f32 v2, v4, v5
    v_lshlrev_b32 v4, 16, v19
    v_lshlrev_b32 v5, 16, v29
    v_fmac_f32 v2, v4, v5
    v_and_b32 v4, 0xffff0000, v19
    v_and_b32 v5, 0xffff0000, v29
    v_fmac_f32 v2, v4, v5
    v_lshlrev_b32 v4, 16, v20
    v_lshlrev_b32 v5, 16, v30
    v_fmac_f32 v2, v4, v5
    v_and_b32 v4, 0xffff0000, v20
    v_and_b32 v5, 0xffff0000, v30
    v_fmac_f32 v2, v4, v5
    v_lshlrev_b32 v4, 16, v21
    v_lshlrev_b32 v5, 16, v31
    v_fmac_f32 v2, v4, v5
    v_and_b32 v4, 0xffff0000, v21
    v_and_b32 v5, 0xffff0000, v31
    v_fmac_f32 v2, v4, v5
    v_lshlrev_b32 v4, 16, v22
    v_lshlrev_b32 v5, 16, v32
    v_fmac_f32 v2, v4, v5
    v_and_b32 v4, 0xffff0000, v22
    v_and_b32 v5, 0xffff0000, v32
    v_fmac_f32 v2, v4, v5
    v_lshlrev_b32 v4, 16, v23
    v_lshlrev_b32 v5, 16, v33
    v_fmac_f32 v2, v4, v5
    v_and_b32 v4, 0xffff0000, v23
    v_and_b32 v5, 0xffff0000, v33
    v_fmac_f32 v2, v4, v5
    v_lshlrev_b32 v4, 16, v24
    v_lshlrev_b32 v5, 16, v34
    v_fmac_f32 v2, v4, v5
    v_and_b32 v4, 0xffff0000, v24
    v_and_b32 v5, 0xffff0000, v34
    v_fmac_f32 v2, v4, v5
    v_lshlrev_b32 v4, 16, v25
    v_lshlrev_b32 v5, 16, v35
    v_fmac_f32 v2, v4, v5
    v_and_b32 v4, 0xffff0000, v25
    v_and_b32 v5, 0xffff0000, v35
    v_fmac_f32 v2, v4, v5
    s_nop 1
    v_add_f32_dpp v2, v2, v2 quad_perm:[1,0,3,2] row_mask:0xf bank_mask:0xf
    s_nop 1
    v_add_f32_dpp v2, v2, v2 quad_perm:[2,3,0,1] row_mask:0xf bank_mask:0xf
    s_nop 1
    v_add_f32_dpp v2, v2, v2 row_half_mirror row_mask:0xf bank_mask:0xf
    s_nop 1
    v_add_f32_dpp v2, v2, v2 row_mirror row_mask:0xf bank_mask:0xf
    v_mov_b32 v8, v2
    s_nop 1
    v_permlane16_swap_b32 v2, v8
    s_nop 1
    v_add_f32 v2, v2, v8
    v_cvt_pk_bf16_f32 v2, v2, v2
    v_and_b32 v2, 0xffff, v2
    v_bfe_i32 v3, v2, 15, 1
    v_and_b32 v3, 0x7fff, v3
    v_or_b32 v3, 0x8000, v3
    v_xor_b32 v2, v2, v3
    s_lshl_b32 s7, s2, 3
    s_sub_u32 s6, 2047, s7
    v_sub_u32 v3, s6, v62
    v_lshl_or_b32 v2, v2, 11, v3
    v_lshlrev_b32 v3, 2, v62
    v_add_u32 v3, 161792, v3
    ds_write_b32 v3, v2
    s_waitcnt lgkmcnt(0)
L_st_j1:
    s_barrier
    s_cmp_ge_u32 s3, 4
    s_cbranch_scc1 L_kv_v
    ds_read_b128 v[64:67], v48 offset:0
    ds_read_b128 v[68:71], v48 offset:2048
    ds_read_b64_tr_b16 v[96:97], v50 offset:0
    ds_read_b64_tr_b16 v[98:99], v50 offset:1024
    ds_read_b64_tr_b16 v[100:101], v51 offset:0
    ds_read_b64_tr_b16 v[102:103], v51 offset:1024
    ds_read_b128 v[72:75], v48 offset:4096
    ds_read_b64_tr_b16 v[104:105], v52 offset:0
    ds_read_b64_tr_b16 v[106:107], v52 offset:1024
    ds_read_b64_tr_b16 v[108:109], v53 offset:0
    ds_read_b64_tr_b16 v[110:111], v53 offset:1024
    ds_read_b128 v[76:79], v48 offset:6144
    ds_read_b128 v[80:83], v48 offset:8192
    ds_read_b128 v[84:87], v48 offset:10240
    ds_read_b128 v[88:91], v48 offset:12288
    ds_read_b128 v[92:95], v48 offset:14336
    s_mov_b32 m0, s73
    s_xor_b32 s64, s64, 0x10000
    buffer_load_dwordx4 v44, s[16:19], s63 offen offset:0 lds
    buffer_load_dwordx4 v45, s[16:19], s63 offen offset:1024 lds
    buffer_load_dwordx4 v46, s[16:19], s63 offen offset:2048 lds
    buffer_load_dwordx4 v47, s[16:19], s63 offen offset:3072 lds
    s_add_u32 m0, s73, 16384
    s_xor_b32 s73, s73, 0x10000
    buffer_load_dwordx4 v44, s[20:23], s63 offen offset:0 lds
    buffer_load_dwordx4 v45, s[20:23], s63 offen offset:1024 lds
    buffer_load_dwordx4 v46, s[20:23], s63 offen offset:2048 lds
    buffer_load_dwordx4 v47, s[20:23], s63 offen offset:3072 lds
    s_add_u32 s63, s63, 524288
    s_bitset0_b32 s63, 22
.p2align 4
L_kloopA:
    s_waitcnt lgkmcnt(12)
    v_mfma_f32_16x16x32_bf16 v[128:131], v[96:99], v[64:67], v[128:131]
    ds_read_b64_tr_b16 v[112:113], v50 offset:8192
    s_waitcnt lgkmcnt(11)
    v_mfma_f32_16x16x32_bf16 v[132:135], v[100:103], v[64:67], v[132:135]
    ds_read_b64_tr_b16 v[114:115], v50 offset:9216
    s_waitcnt lgkmcnt(9)
    v_mfma_f32_16x16x32_bf16 v[136:139], v[104:107], v[64:67], v[136:139]
    ds_read_b64_tr_b16 v[116:117], v51 offset:8192
    s_waitcnt lgkmcnt(8)
    v_mfma_f32_16x16x32_bf16 v[140:143], v[108:111], v[64:67], v[140:143]
    ds_read_b64_tr_b16 v[118:119], v51 offset:9216
    ds_read_b128 v[64:67], v49 offset:0
    v_mfma_f32_16x16x32_bf16 v[156:159], v[108:111], v[68:71], v[156:159]
    ds_read_b64_tr_b16 v[120:121], v52 offset:8192
    v_mfma_f32_16x16x32_bf16 v[152:155], v[104:107], v[68:71], v[152:155]
    ds_read_b64_tr_b16 v[122:123], v52 offset:9216
    v_mfma_f32_16x16x32_bf16 v[148:151], v[100:103], v[68:71], v[148:151]
    ds_read_b64_tr_b16 v[124:125], v53 offset:8192
    v_mfma_f32_16x16x32_bf16 v[144:147], v[96:99], v[68:71], v[144:147]
    ds_read_b64_tr_b16 v[126:127], v53 offset:9216
    ds_read_b128 v[68:71], v49 offset:2048
    v_mfma_f32_16x16x32_bf16 v[160:163], v[96:99], v[72:75], v[160:163]
    v_mfma_f32_16x16x32_bf16 v[164:167], v[100:103], v[72:75], v[164:167]
    v_mfma_f32_16x16x32_bf16 v[168:171], v[104:107], v[72:75], v[168:171]
    v_mfma_f32_16x16x32_bf16 v[172:175], v[108:111], v[72:75], v[172:175]
    ds_read_b128 v[72:75], v49 offset:4096
    s_waitcnt lgkmcnt(15)
    v_mfma_f32_16x16x32_bf16 v[188:191], v[108:111], v[76:79], v[188:191]
    v_mfma_f32_16x16x32_bf16 v[184:187], v[104:107], v[76:79], v[184:187]
    v_mfma_f32_16x16x32_bf16 v[180:183], v[100:103], v[76:79], v[180:183]
    v_mfma_f32_16x16x32_bf16 v[176:179], v[96:99], v[76:79], v[176:179]
    ds_read_b128 v[76:79], v49 offset:6144
    s_waitcnt lgkmcnt(15)
    v_mfma_f32_16x16x32_bf16 v[192:195], v[96:99], v[80:83], v[192:195]
    v_mfma_f32_16x16x32_bf16 v[196:199], v[100:103], v[80:83], v[196:199]
    v_mfma_f32_16x16x32_bf16 v[200:203], v[104:107], v[80:83], v[200:203]
    v_mfma_f32_16x16x32_bf16 v[204:207], v[108:111], v[80:83], v[204:207]
    ds_read_b128 v[80:83], v49 offset:8192
    s_waitcnt lgkmcnt(15)
    v_mfma_f32_16x16x32_bf16 v[220:223], v[108:111], v[84:87], v[220:223]
    v_mfma_f32_16x16x32_bf16 v[216:219], v[104:107], v[84:87], v[216:219]
    v_mfma_f32_16x16x32_bf16 v[212:215], v[100:103], v[84:87], v[212:215]
    v_mfma_f32_16x16x32_bf16 v[208:211], v[96:99], v[84:87], v[208:211]
    ds_read_b128 v[84:87], v49 offset:10240
    s_waitcnt lgkmcnt(15)
    v_mfma_f32_16x16x32_bf16 v[224:227], v[96:99], v[88:91], v[224:227]
    v_mfma_f32_16x16x32_bf16 v[228:231], v[100:103], v[88:91], v[228:231]
    v_mfma_f32_16x16x32_bf16 v[232:235], v[104:107], v[88:91], v[232:235]
    v_mfma_f32_16x16x32_bf16 v[236:239], v[108:111], v[88:91], v[236:239]
    ds_read_b128 v[88:91], v49 offset:12288
    s_waitcnt lgkmcnt(15)
    v_mfma_f32_16x16x32_bf16 v[252:255], v[108:111], v[92:95], v[252:255]
    v_mfma_f32_16x16x32_bf16 v[248:251], v[104:107], v[92:95], v[248:251]
    v_mfma_f32_16x16x32_bf16 v[244:247], v[100:103], v[92:95], v[244:247]
    v_mfma_f32_16x16x32_bf16 v[240:243], v[96:99], v[92:95], v[240:243]
    ds_read_b128 v[92:95], v49 offset:14336
    s_waitcnt lgkmcnt(11)
    v_mfma_f32_16x16x32_bf16 v[128:131], v[112:115], v[64:67], v[128:131]
    v_mfma_f32_16x16x32_bf16 v[132:135], v[116:119], v[64:67], v[132:135]
    s_waitcnt lgkmcnt(9)
    v_mfma_f32_16x16x32_bf16 v[136:139], v[120:123], v[64:67], v[136:139]
    s_waitcnt lgkmcnt(7)
    v_mfma_f32_16x16x32_bf16 v[140:143], v[124:127], v[64:67], v[140:143]
    s_waitcnt lgkmcnt(6)
    v_mfma_f32_16x16x32_bf16 v[156:159], v[124:127], v[68:71], v[156:159]
    v_mfma_f32_16x16x32_bf16 v[152:155], v[120:123], v[68:71], v[152:155]
    v_mfma_f32_16x16x32_bf16 v[148:151], v[116:119], v[68:71], v[148:151]
    v_mfma_f32_16x16x32_bf16 v[144:147], v[112:115], v[68:71], v[144:147]
    v_xor_b32 v48, 0x10000, v48
    v_xor_b32 v49, 0x10000, v49
    v_xor_b32 v50, 0x10000, v50
    v_xor_b32 v51, 0x10000, v51
    v_xor_b32 v52, 0x10000, v52
    v_xor_b32 v53, 0x10000, v53
    s_waitcnt vmcnt(0) lgkmcnt(0)
    s_barrier
    ds_read_b128 v[64:67], v48 offset:0
    ds_read_b128 v[68:71], v48 offset:2048
    v_mfma_f32_16x16x32_bf16 v[160:163], v[112:115], v[72:75], v[160:163]
    ds_read_b64_tr_b16 v[96:97], v50 offset:0
    s_mov_b32 m0, s64
    s_add_u32 s72, s62, 524288
    v_mfma_f32_16x16x32_bf16 v[164:167], v[116:119], v[72:75], v[164:167]
    ds_read_b64_tr_b16 v[98:99], v50 offset:1024
    buffer_load_dwordx4 v40, s[12:15], s62 offen offset:0 lds
    v_mfma_f32_16x16x32_bf16 v[168:171], v[120:123], v[72:75], v[168:171]
    ds_read_b64_tr_b16 v[100:101], v51 offset:0
    buffer_load_dwordx4 v41, s[12:15], s62 offen offset:1024 lds
    v_mfma_f32_16x16x32_bf16 v[172:175], v[124:127], v[72:75], v[172:175]
    ds_read_b64_tr_b16 v[102:103], v51 offset:1024
    buffer_load_dwordx4 v42, s[12:15], s62 offen offset:2048 lds
    ds_read_b128 v[72:75], v48 offset:4096
    v_mfma_f32_16x16x32_bf16 v[188:191], v[124:127], v[76:79], v[188:191]
    ds_read_b64_tr_b16 v[104:105], v52 offset:0
    buffer_load_dwordx4 v43, s[12:15], s62 offen offset:3072 lds
    v_mfma_f32_16x16x32_bf16 v[184:187], v[120:123], v[76:79], v[184:187]
    ds_read_b64_tr_b16 v[106:107], v52 offset:1024
    s_add_u32 m0, s64, 4096
    s_add_u32 s62, s62, 128
    s_bitset0_b32 s62, 10
    v_mfma_f32_16x16x32_bf16 v[180:183], v[116:119], v[76:79], v[180:183]
    ds_read_b64_tr_b16 v[108:109], v53 offset:0
    buffer_load_dwordx4 v40, s[12:15], s72 offen offset:0 lds
    v_mfma_f32_16x16x32_bf16 v[176:179], v[112:115], v[76:79], v[176:179]
    ds_read_b64_tr_b16 v[110:111], v53 offset:1024
    buffer_load_dwordx4 v41, s[12:15], s72 offen offset:1024 lds
    ds_read_b128 v[76:79], v48 offset:6144
    v_mfma_f32_16x16x32_bf16 v[192:195], v[112:115], v[80:83], v[192:195]
    buffer_load_dwordx4 v42, s[12:15], s72 offen offset:2048 lds
    v_mfma_f32_16x16x32_bf16 v[196:199], v[116:119], v[80:83], v[196:199]
    buffer_load_dwordx4 v43, s[12:15], s72 offen offset:3072 lds
    v_mfma_f32_16x16x32_bf16 v[200:203], v[120:123], v[80:83], v[200:203]
    s_mov_b32 m0, s73
    s_xor_b32 s64, s64, 0x10000
    v_mfma_f32_16x16x32_bf16 v[204:207], v[124:127], v[80:83], v[204:207]
    buffer_load_dwordx4 v44, s[16:19], s63 offen offset:0 lds
    ds_read_b128 v[80:83], v48 offset:8192
    v_mfma_f32_16x16x32_bf16 v[220:223], v[124:127], v[84:87], v[220:223]
    buffer_load_dwordx4 v45, s[16:19], s63 offen offset:1024 lds
    v_mfma_f32_16x16x32_bf16 v[216:219], v[120:123], v[84:87], v[216:219]
    buffer_load_dwordx4 v46, s[16:19], s63 offen offset:2048 lds
    v_mfma_f32_16x16x32_bf16 v[212:215], v[116:119], v[84:87], v[212:215]
    buffer_load_dwordx4 v47, s[16:19], s63 offen offset:3072 lds
    v_mfma_f32_16x16x32_bf16 v[208:211], v[112:115], v[84:87], v[208:211]
    s_add_u32 m0, s73, 16384
    s_xor_b32 s73, s73, 0x10000
    ds_read_b128 v[84:87], v48 offset:10240
    v_mfma_f32_16x16x32_bf16 v[224:227], v[112:115], v[88:91], v[224:227]
    buffer_load_dwordx4 v44, s[20:23], s63 offen offset:0 lds
    v_mfma_f32_16x16x32_bf16 v[228:231], v[116:119], v[88:91], v[228:231]
    buffer_load_dwordx4 v45, s[20:23], s63 offen offset:1024 lds
    v_mfma_f32_16x16x32_bf16 v[232:235], v[120:123], v[88:91], v[232:235]
    buffer_load_dwordx4 v46, s[20:23], s63 offen offset:2048 lds
    v_mfma_f32_16x16x32_bf16 v[236:239], v[124:127], v[88:91], v[236:239]
    buffer_load_dwordx4 v47, s[20:23], s63 offen offset:3072 lds
    ds_read_b128 v[88:91], v48 offset:12288
    v_mfma_f32_16x16x32_bf16 v[252:255], v[124:127], v[92:95], v[252:255]
    s_add_u32 s63, s63, 524288
    s_bitset0_b32 s63, 22
    v_mfma_f32_16x16x32_bf16 v[248:251], v[120:123], v[92:95], v[248:251]
    v_mfma_f32_16x16x32_bf16 v[244:247], v[116:119], v[92:95], v[244:247]
    v_mfma_f32_16x16x32_bf16 v[240:243], v[112:115], v[92:95], v[240:243]
    ds_read_b128 v[92:95], v48 offset:14336
    s_add_u32 s65, s65, 1
    s_cmp_lt_u32 s65, 6
    s_cbranch_scc1 L_kloopA
.p2align 4
L_kloopB:
    s_bitcmp1_b32 128, s65
    s_cbranch_scc1 L_khook
L_khook_back:
    s_waitcnt lgkmcnt(12)
    v_mfma_f32_16x16x32_bf16 v[128:131], v[96:99], v[64:67], v[128:131]
    ds_read_b64_tr_b16 v[112:113], v50 offset:8192
    s_waitcnt lgkmcnt(11)
    v_mfma_f32_16x16x32_bf16 v[132:135], v[100:103], v[64:67], v[132:135]
    ds_read_b64_tr_b16 v[114:115], v50 offset:9216
    s_waitcnt lgkmcnt(9)
    v_mfma_f32_16x16x32_bf16 v[136:139], v[104:107], v[64:67], v[136:139]
    ds_read_b64_tr_b16 v[116:117], v51 offset:8192
    s_waitcnt lgkmcnt(8)
    v_mfma_f32_16x16x32_bf16 v[140:143], v[108:111], v[64:67], v[140:143]
    ds_read_b64_tr_b16 v[118:119], v51 offset:9216
    ds_read_b128 v[64:67], v49 offset:0
    v_mfma_f32_16x16x32_bf16 v[156:159], v[108:111], v[68:71], v[156:159]
    ds_read_b64_tr_b16 v[120:121], v52 offset:8192
    v_mfma_f32_16x16x32_bf16 v[152:155], v[104:107], v[68:71], v[152:155]
    ds_read_b64_tr_b16 v[122:123], v52 offset:9216
    v_mfma_f32_16x16x32_bf16 v[148:151], v[100:103], v[68:71], v[148:151]
    ds_read_b64_tr_b16 v[124:125], v53 offset:8192
    v_mfma_f32_16x16x32_bf16 v[144:147], v[96:99], v[68:71], v[144:147]
    ds_read_b64_tr_b16 v[126:127], v53 offset:9216
    ds_read_b128 v[68:71], v49 offset:2048
    v_mfma_f32_16x16x32_bf16 v[160:163], v[96:99], v[72:75], v[160:163]
    v_mfma_f32_16x16x32_bf16 v[164:167], v[100:103], v[72:75], v[164:167]
    v_mfma_f32_16x16x32_bf16 v[168:171], v[104:107], v[72:75], v[168:171]
    v_mfma_f32_16x16x32_bf16 v[172:175], v[108:111], v[72:75], v[172:175]
    ds_read_b128 v[72:75], v49 offset:4096
    s_waitcnt lgkmcnt(15)
    v_mfma_f32_16x16x32_bf16 v[188:191], v[108:111], v[76:79], v[188:191]
    v_mfma_f32_16x16x32_bf16 v[184:187], v[104:107], v[76:79], v[184:187]
    v_mfma_f32_16x16x32_bf16 v[180:183], v[100:103], v[76:79], v[180:183]
    v_mfma_f32_16x16x32_bf16 v[176:179], v[96:99], v[76:79], v[176:179]
    ds_read_b128 v[76:79], v49 offset:6144
    s_waitcnt lgkmcnt(15)
    v_mfma_f32_16x16x32_bf16 v[192:195], v[96:99], v[80:83], v[192:195]
    v_mfma_f32_16x16x32_bf16 v[196:199], v[100:103], v[80:83], v[196:199]
    v_mfma_f32_16x16x32_bf16 v[200:203], v[104:107], v[80:83], v[200:203]
    v_mfma_f32_16x16x32_bf16 v[204:207], v[108:111], v[80:83], v[204:207]
    ds_read_b128 v[80:83], v49 offset:8192
    s_waitcnt lgkmcnt(15)
    v_mfma_f32_16x16x32_bf16 v[220:223], v[108:111], v[84:87], v[220:223]
    v_mfma_f32_16x16x32_bf16 v[216:219], v[104:107], v[84:87], v[216:219]
    v_mfma_f32_16x16x32_bf16 v[212:215], v[100:103], v[84:87], v[212:215]
    v_mfma_f32_16x16x32_bf16 v[208:211], v[96:99], v[84:87], v[208:211]
    ds_read_b128 v[84:87], v49 offset:10240
    s_waitcnt lgkmcnt(15)
    v_mfma_f32_16x16x32_bf16 v[224:227], v[96:99], v[88:91], v[224:227]
    v_mfma_f32_16x16x32_bf16 v[228:231], v[100:103], v[88:91], v[228:231]
    v_mfma_f32_16x16x32_bf16 v[232:235], v[104:107], v[88:91], v[232:235]
    v_mfma_f32_16x16x32_bf16 v[236:239], v[108:111], v[88:91], v[236:239]
    ds_read_b128 v[88:91], v49 offset:12288
    s_waitcnt lgkmcnt(15)
    v_mfma_f32_16x16x32_bf16 v[252:255], v[108:111], v[92:95], v[252:255]
    v_mfma_f32_16x16x32_bf16 v[248:251], v[104:107], v[92:95], v[248:251]
    v_mfma_f32_16x16x32_bf16 v[244:247], v[100:103], v[92:95], v[244:247]
    v_mfma_f32_16x16x32_bf16 v[240:243], v[96:99], v[92:95], v[240:243]
    ds_read_b128 v[92:95], v49 offset:14336
    s_waitcnt lgkmcnt(11)
    v_mfma_f32_16x16x32_bf16 v[128:131], v[112:115], v[64:67], v[128:131]
    v_mfma_f32_16x16x32_bf16 v[132:135], v[116:119], v[64:67], v[132:135]
    s_waitcnt lgkmcnt(9)
    v_mfma_f32_16x16x32_bf16 v[136:139], v[120:123], v[64:67], v[136:139]
    s_waitcnt lgkmcnt(7)
    v_mfma_f32_16x16x32_bf16 v[140:143], v[124:127], v[64:67], v[140:143]
    s_waitcnt lgkmcnt(6)
    v_mfma_f32_16x16x32_bf16 v[156:159], v[124:127], v[68:71], v[156:159]
    v_mfma_f32_16x16x32_bf16 v[152:155], v[120:123], v[68:71], v[152:155]
    v_mfma_f32_16x16x32_bf16 v[148:151], v[116:119], v[68:71], v[148:151]
    v_mfma_f32_16x16x32_bf16 v[144:147], v[112:115], v[68:71], v[144:147]
    v_xor_b32 v48, 0x10000, v48
    v_xor_b32 v49, 0x10000, v49
    v_xor_b32 v50, 0x10000, v50
    v_xor_b32 v51, 0x10000, v51
    v_xor_b32 v52, 0x10000, v52
    v_xor_b32 v53, 0x10000, v53
    s_waitcnt vmcnt(0) lgkmcnt(0)
    s_barrier
    ds_read_b128 v[64:67], v48 offset:0
    ds_read_b128 v[68:71], v48 offset:2048
    v_mfma_f32_16x16x32_bf16 v[160:163], v[112:115], v[72:75], v[160:163]
    ds_read_b64_tr_b16 v[96:97], v50 offset:0
    s_mov_b32 m0, s74
    s_add_u32 s74, s74, 16384
    s_bitset0_b32 s74, 17
    v_mfma_f32_16x16x32_bf16 v[164:167], v[116:119], v[72:75], v[164:167]
    ds_read_b64_tr_b16 v[98:99], v50 offset:1024
    buffer_load_dwordx4 v44, s[24:27], s71 offen offset:0 lds
    v_mfma_f32_16x16x32_bf16 v[168:171], v[120:123], v[72:75], v[168:171]
    ds_read_b64_tr_b16 v[100:101], v51 offset:0
    buffer_load_dwordx4 v45, s[24:27], s71 offen offset:1024 lds
    v_mfma_f32_16x16x32_bf16 v[172:175], v[124:127], v[72:75], v[172:175]
    ds_read_b64_tr_b16 v[102:103], v51 offset:1024
    buffer_load_dwordx4 v46, s[24:27], s71 offen offset:2048 lds
    ds_read_b128 v[72:75], v48 offset:4096
    v_mfma_f32_16x16x32_bf16 v[188:191], v[124:127], v[76:79], v[188:191]
    ds_read_b64_tr_b16 v[104:105], v52 offset:0
    buffer_load_dwordx4 v47, s[24:27], s71 offen offset:3072 lds
    v_mfma_f32_16x16x32_bf16 v[184:187], v[120:123], v[76:79], v[184:187]
    ds_read_b64_tr_b16 v[106:107], v52 offset:1024
    s_add_u32 s71, s71, 524288
    s_sub_u32 s75, s71, 5242880
    s_cselect_b32 s71, s71, s75
    v_mfma_f32_16x16x32_bf16 v[180:183], v[116:119], v[76:79], v[180:183]
    ds_read_b64_tr_b16 v[108:109], v53 offset:0
    s_mov_b32 m0, s74
    s_add_u32 s74, s74, 16384
    s_bitset0_b32 s74, 17
    v_mfma_f32_16x16x32_bf16 v[176:179], v[112:115], v[76:79], v[176:179]
    ds_read_b64_tr_b16 v[110:111], v53 offset:1024
    buffer_load_dwordx4 v44, s[24:27], s71 offen offset:0 lds
    ds_read_b128 v[76:79], v48 offset:6144
    v_mfma_f32_16x16x32_bf16 v[192:195], v[112:115], v[80:83], v[192:195]
    buffer_load_dwordx4 v45, s[24:27], s71 offen offset:1024 lds
    v_mfma_f32_16x16x32_bf16 v[196:199], v[116:119], v[80:83], v[196:199]
    buffer_load_dwordx4 v46, s[24:27], s71 offen offset:2048 lds
    v_mfma_f32_16x16x32_bf16 v[200:203], v[120:123], v[80:83], v[200:203]
    buffer_load_dwordx4 v47, s[24:27], s71 offen offset:3072 lds
    v_mfma_f32_16x16x32_bf16 v[204:207], v[124:127], v[80:83], v[204:207]
    s_add_u32 s71, s71, 524288
    s_sub_u32 s75, s71, 5242880
    s_cselect_b32 s71, s71, s75
    ds_read_b128 v[80:83], v48 offset:8192
    v_mfma_f32_16x16x32_bf16 v[220:223], v[124:127], v[84:87], v[220:223]
    s_mov_b32 m0, s74
    s_add_u32 s74, s74, 16384
    s_bitset0_b32 s74, 17
    v_mfma_f32_16x16x32_bf16 v[216:219], v[120:123], v[84:87], v[216:219]
    buffer_load_dwordx4 v44, s[24:27], s71 offen offset:0 lds
    v_mfma_f32_16x16x32_bf16 v[212:215], v[116:119], v[84:87], v[212:215]
    buffer_load_dwordx4 v45, s[24:27], s71 offen offset:1024 lds
    v_mfma_f32_16x16x32_bf16 v[208:211], v[112:115], v[84:87], v[208:211]
    buffer_load_dwordx4 v46, s[24:27], s71 offen offset:2048 lds
    ds_read_b128 v[84:87], v48 offset:10240
    v_mfma_f32_16x16x32_bf16 v[224:227], v[112:115], v[88:91], v[224:227]
    buffer_load_dwordx4 v47, s[24:27], s71 offen offset:3072 lds
    v_mfma_f32_16x16x32_bf16 v[228:231], v[116:119], v[88:91], v[228:231]
    s_add_u32 s71, s71, 524288
    s_sub_u32 s75, s71, 5242880
    s_cselect_b32 s71, s71, s75
    v_mfma_f32_16x16x32_bf16 v[232:235], v[120:123], v[88:91], v[232:235]
    s_mov_b32 m0, s74
    s_add_u32 s74, s74, 16384
    s_bitset0_b32 s74, 17
    v_mfma_f32_16x16x32_bf16 v[236:239], v[124:127], v[88:91], v[236:239]
    buffer_load_dwordx4 v44, s[24:27], s71 offen offset:0 lds
    ds_read_b128 v[88:91], v48 offset:12288
    v_mfma_f32_16x16x32_bf16 v[252:255], v[124:127], v[92:95], v[252:255]
    buffer_load_dwordx4 v45, s[24:27], s71 offen offset:1024 lds
    v_mfma_f32_16x16x32_bf16 v[248:251], v[120:123], v[92:95], v[248:251]
    buffer_load_dwordx4 v46, s[24:27], s71 offen offset:2048 lds
    v_mfma_f32_16x16x32_bf16 v[244:247], v[116:119], v[92:95], v[244:247]
    buffer_load_dwordx4 v47, s[24:27], s71 offen offset:3072 lds
    v_mfma_f32_16x16x32_bf16 v[240:243], v[112:115], v[92:95], v[240:243]
    s_add_u32 s71, s71, 524288
    s_sub_u32 s75, s71, 5242880
    s_cselect_b32 s71, s71, s75
    ds_read_b128 v[92:95], v48 offset:14336
    s_add_u32 s65, s65, 1
    s_cmp_lt_u32 s65, 8
    s_cbranch_scc1 L_kloopB
    s_waitcnt lgkmcnt(0)
    s_nop 7
    v_cvt_pk_bf16_f32 v128, v128, v129
    v_cvt_pk_bf16_f32 v129, v130, v131
    v_cvt_pk_bf16_f32 v130, v132, v133
    v_cvt_pk_bf16_f32 v131, v134, v135
    v_cvt_pk_bf16_f32 v132, v136, v137
    v_cvt_pk_bf16_f32 v133, v138, v139
    v_cvt_pk_bf16_f32 v134, v140, v141
    v_cvt_pk_bf16_f32 v135, v142, v143
    v_cvt_pk_bf16_f32 v136, v144, v145
    v_cvt_pk_bf16_f32 v137, v146, v147
    v_cvt_pk_bf16_f32 v138, v148, v149
    v_cvt_pk_bf16_f32 v139, v150, v151
    v_cvt_pk_bf16_f32 v140, v152, v153
    v_cvt_pk_bf16_f32 v141, v154, v155
    v_cvt_pk_bf16_f32 v142, v156, v157
    v_cvt_pk_bf16_f32 v143, v158, v159
    v_cvt_pk_bf16_f32 v144, v160, v161
    v_cvt_pk_bf16_f32 v145, v162, v163
    v_cvt_pk_bf16_f32 v146, v164, v165
    v_cvt_pk_bf16_f32 v147, v166, v167
    v_cvt_pk_bf16_f32 v148, v168, v169
    v_cvt_pk_bf16_f32 v149, v170, v171
    v_cvt_pk_bf16_f32 v150, v172, v173
    v_cvt_pk_bf16_f32 v151, v174, v175
    v_cvt_pk_bf16_f32 v152, v176, v177
    v_cvt_pk_bf16_f32 v153, v178, v179
    v_cvt_pk_bf16_f32 v154, v180, v181
    v_cvt_pk_bf16_f32 v155, v182, v183
    v_cvt_pk_bf16_f32 v156, v184, v185
    v_cvt_pk_bf16_f32 v157, v186, v187
    v_cvt_pk_bf16_f32 v158, v188, v189
    v_cvt_pk_bf16_f32 v159, v190, v191
    v_cvt_pk_bf16_f32 v160, v192, v193
    v_cvt_pk_bf16_f32 v161, v194, v195
    v_cvt_pk_bf16_f32 v162, v196, v197
    v_cvt_pk_bf16_f32 v163, v198, v199
    v_cvt_pk_bf16_f32 v164, v200, v201
    v_cvt_pk_bf16_f32 v165, v202, v203
    v_cvt_pk_bf16_f32 v166, v204, v205
    v_cvt_pk_bf16_f32 v167, v206, v207
    v_cvt_pk_bf16_f32 v168, v208, v209
    v_cvt_pk_bf16_f32 v169, v210, v211
    v_cvt_pk_bf16_f32 v170, v212, v213
    v_cvt_pk_bf16_f32 v171, v214, v215
    v_cvt_pk_bf16_f32 v172, v216, v217
    v_cvt_pk_bf16_f32 v173, v218, v219
    v_cvt_pk_bf16_f32 v174, v220, v221
    v_cvt_pk_bf16_f32 v175, v222, v223
    v_cvt_pk_bf16_f32 v176, v224, v225
    v_cvt_pk_bf16_f32 v177, v226, v227
    v_cvt_pk_bf16_f32 v178, v228, v229
    v_cvt_pk_bf16_f32 v179, v230, v231
    v_cvt_pk_bf16_f32 v180, v232, v233
    v_cvt_pk_bf16_f32 v181, v234, v235
    v_cvt_pk_bf16_f32 v182, v236, v237
    v_cvt_pk_bf16_f32 v183, v238, v239
    v_cvt_pk_bf16_f32 v184, v240, v241
    v_cvt_pk_bf16_f32 v185, v242, v243
    v_cvt_pk_bf16_f32 v186, v244, v245
    v_cvt_pk_bf16_f32 v187, v246, v247
    v_cvt_pk_bf16_f32 v188, v248, v249
    v_cvt_pk_bf16_f32 v189, v250, v251
    v_cvt_pk_bf16_f32 v190, v252, v253
    v_cvt_pk_bf16_f32 v191, v254, v255
    s_waitcnt vmcnt(16)
    s_branch L_q
L_hook:
    s_cmp_eq_u32 s65, 1
    s_cbranch_scc1 L_hook1
    s_cmp_eq_u32 s65, 2
    s_cbranch_scc1 L_hook2
    s_cmp_eq_u32 s65, 4
    s_cbranch_scc1 L_hook4
    s_cmp_eq_u32 s65, 6
    s_cbranch_scc1 L_hook6
    s_cmp_lg_u32 s65, 7
    s_cbranch_scc1 L_hook_back
    buffer_load_dwordx4 v[16:19], v13, s[8:11], s84 offen offset:0 sc1
    buffer_load_dwordx4 v[20:23], v12, s[8:11], s84 offen offset:0 sc1
    buffer_load_dwordx4 v[24:27], v13, s[8:11], s84 offen offset:1024 sc1
    buffer_load_dwordx4 v[28:31], v12, s[8:11], s84 offen offset:1024 sc1
    buffer_load_dwordx4 v[32:35], v13, s[8:11], s84 offen offset:2048 sc1
    buffer_load_dwordx4 v[36:39], v12, s[8:11], s84 offen offset:2048 sc1
    s_branch L_hook_back
L_hook1:
    s_cmp_ge_u32 s76, 2
    s_cbranch_scc1 L_tch_1a
    s_and_b32 s6, s4, 3
    s_lshl_b32 s6, s6, 19
    s_lshl_b32 s7, s5, 15
    s_add_u32 s6, s6, s7
    s_lshl_b32 s7, s76, 7
    s_add_u32 s6, s6, s7
    s_add_u32 s6, s6, 512
    v_lshrrev_b32 v6, 1, v1
    v_lshlrev_b32 v6, 10, v6
    v_and_b32 v7, 1, v1
    v_lshl_add_u32 v6, v7, 6, v6
    buffer_load_dword v11, v6, s[12:15], s6 offen
    s_add_u32 s6, s6, 262144
    buffer_load_dword v11, v6, s[12:15], s6 offen
    s_branch L_tch_1c
L_tch_1a:
    v_lshrrev_b32 v6, 5, v1
    v_lshlrev_b32 v6, 6, v6
    v_bfe_u32 v7, v1, 2, 3
    v_add_u32 v6, v6, v7
    v_lshlrev_b32 v6, 13, v6
    v_and_b32 v7, 3, v1
    v_lshl_add_u32 v6, v7, 6, v6
    s_lshl_b32 s6, s4, 8
    s_lshl_b32 s7, s5, 16
    s_add_u32 s6, s6, s7
    s_add_u32 s6, s6, 2097152
    s_cmp_lg_u32 s76, 2
    s_cbranch_scc1 L_tch_1b
    buffer_load_dword v11, v6, s[16:19], s6 offen
    s_branch L_tch_1c
L_tch_1b:
    buffer_load_dword v11, v6, s[20:23], s6 offen
L_tch_1c:
    s_branch L_hook_back
L_hook2:
    s_lshr_b32 s72, s2, 1
    s_mul_i32 s72, s72, 20480
    s_and_b32 s7, s2, 1
    s_lshl_b32 s7, s7, 7
    s_add_u32 s72, s72, s7
    v_add_u32 v2, -256, v0
    v_lshrrev_b32 v3, 3, v2
    v_and_b32 v4, 7, v2
    v_mul_u32_u24 v5, 1280, v4
    v_lshl_add_u32 v5, v3, 4, v5
    v_add_u32 v5, 131072, v5
    ds_read_b128 v[16:19], v5
    v_lshlrev_b32 v5, 8, v3
    v_lshl_add_u32 v6, v4, 4, v5
    v_add_u32 v2, 0, v0
    v_lshrrev_b32 v3, 3, v2
    v_and_b32 v4, 7, v2
    v_mul_u32_u24 v5, 1280, v4
    v_lshl_add_u32 v5, v3, 4, v5
    v_add_u32 v5, 131072, v5
    ds_read_b128 v[24:27], v5
    v_lshlrev_b32 v5, 8, v3
    v_lshl_add_u32 v7, v4, 4, v5
    v_add_u32 v2, 256, v0
    v_lshrrev_b32 v3, 3, v2
    v_and_b32 v4, 7, v2
    v_mul_u32_u24 v5, 1280, v4
    v_lshl_add_u32 v5, v3, 4, v5
    v_add_u32 v5, 131072, v5
    ds_read_b128 v[32:35], v5
    v_lshlrev_b32 v5, 8, v3
    v_lshl_add_u32 v8, v4, 4, v5
    s_waitcnt lgkmcnt(0)
    buffer_store_dwordx4 v[16:19], v6, s[8:11], s72 offen sc1
    buffer_store_dwordx4 v[24:27], v7, s[8:11], s72 offen sc1
    s_cmp_ge_u32 s3, 6
    s_cbranch_scc1 L_lns
    buffer_store_dwordx4 v[32:35], v8, s[8:11], s72 offen sc1
L_lns:
    s_cmp_lt_u32 s3, 6
    s_cbranch_scc1 L_zd
    v_mov_b64 v[36:37], 0
    v_mov_b64 v[38:39], 0
    v_lshrrev_b32 v2, 3, v1
    s_cmp_eq_u32 s3, 6
    s_cbranch_scc1 L_z6
    s_lshl_b32 s6, s5, 2
    s_sub_u32 s7, 56, s6
    v_mov_b32 v3, s6
    v_mov_b32 v4, s7
    v_cmp_gt_u32 vcc, 4, v2
    s_lshl_b32 s6, s4, 7
    s_add_u32 s6, s6, 3932160
    v_cndmask_b32 v3, v4, v3, vcc
    v_add_u32 v3, v3, v2
    v_lshl_add_u32 v3, v3, 12, s6
    s_branch L_z7
L_z6:
    v_mov_b32 v3, 0x5000000
    s_lshl_b32 s6, s4, 3
    s_add_u32 s6, s6, s5
    s_lshl_b32 s6, s6, 5
    s_add_u32 s6, s6, s3
    s_lshl_b32 s6, s6, 2
    s_add_u32 s6, s6, 3866624
    s_andn2_b32 s6, s6, 127
    v_cmp_eq_u32 vcc, 0, v2
    v_mov_b32 v4, s6
    s_nop 0
    v_cndmask_b32 v3, v3, v4, vcc
    s_lshl_b32 s6, s61, 5
    s_add_u32 s6, s6, s3
    s_lshl_b32 s6, s6, 2
    s_add_u32 s6, s6, 15859712
    s_andn2_b32 s6, s6, 127
    v_cmp_eq_u32 vcc, 1, v2
    v_mov_b32 v4, s6
    s_nop 0
    v_cndmask_b32 v3, v3, v4, vcc
    s_lshl_b32 s6, s5, 5
    s_add_u32 s6, s6, s4
    s_lshl_b32 s6, s6, 5
    s_add_u32 s6, s6, s3
    s_lshl_b32 s6, s6, 2
    s_add_u32 s6, s6, 3899392
    s_andn2_b32 s6, s6, 127
    v_cmp_eq_u32 vcc, 2, v2
    v_mov_b32 v4, s6
    s_nop 0
    v_cndmask_b32 v3, v3, v4, vcc
    s_and_b32 s6, s4, 7
    s_lshl_b32 s7, s5, 3
    s_add_u32 s6, s6, s7
    s_lshr_b32 s7, s4, 3
    s_add_u32 s7, s7, 0
    s_add_u32 s7, s7, 1
    s_and_b32 s7, s7, 3
    s_lshl_b32 s6, s6, 2
    s_add_u32 s6, s6, s7
    s_mul_i32 s6, s6, 3
    s_add_u32 s6, s6, 0
    s_lshl_b32 s6, s6, 5
    s_add_u32 s6, s6, s3
    s_lshl_b32 s6, s6, 2
    s_add_u32 s6, s6, 15728640
    s_andn2_b32 s6, s6, 127
    v_cmp_eq_u32 vcc, 3, v2
    v_mov_b32 v4, s6
    s_nop 0
    v_cndmask_b32 v3, v3, v4, vcc
    s_and_b32 s6, s4, 7
    s_lshl_b32 s7, s5, 3
    s_add_u32 s6, s6, s7
    s_lshr_b32 s7, s4, 3
    s_add_u32 s7, s7, 1
    s_add_u32 s7, s7, 1
    s_and_b32 s7, s7, 3
    s_lshl_b32 s6, s6, 2
    s_add_u32 s6, s6, s7
    s_mul_i32 s6, s6, 3
    s_add_u32 s6, s6, 1
    s_lshl_b32 s6, s6, 5
    s_add_u32 s6, s6, s3
    s_lshl_b32 s6, s6, 2
    s_add_u32 s6, s6, 15728640
    s_andn2_b32 s6, s6, 127
    v_cmp_eq_u32 vcc, 4, v2
    v_mov_b32 v4, s6
    s_nop 0
    v_cndmask_b32 v3, v3, v4, vcc
    s_and_b32 s6, s4, 7
    s_lshl_b32 s7, s5, 3
    s_add_u32 s6, s6, s7
    s_lshr_b32 s7, s4, 3
    s_add_u32 s7, s7, 2
    s_add_u32 s7, s7, 1
    s_and_b32 s7, s7, 3
    s_lshl_b32 s6, s6, 2
    s_add_u32 s6, s6, s7
    s_mul_i32 s6, s6, 3
    s_add_u32 s6, s6, 2
    s_lshl_b32 s6, s6, 5
    s_add_u32 s6, s6, s3
    s_lshl_b32 s6, s6, 2
    s_add_u32 s6, s6, 15728640
    s_andn2_b32 s6, s6, 127
    v_cmp_eq_u32 vcc, 5, v2
    v_mov_b32 v4, s6
    s_nop 0
    v_cndmask_b32 v3, v3, v4, vcc
    s_mov_b32 s6, 0x5000000
    s_cmp_eq_u32 s2, 31
    s_cmov_b32 s6, 3801088
    s_andn2_b32 s6, s6, 127
    v_cmp_eq_u32 vcc, 6, v2
    v_mov_b32 v4, s6
    s_nop 0
    v_cndmask_b32 v3, v3, v4, vcc
    s_lshl_b32 s6, s2, 7
    s_add_u32 s6, s6, 2621440
    s_andn2_b32 s6, s6, 127
    v_cmp_eq_u32 vcc, 7, v2
    v_mov_b32 v4, s6
    s_nop 0
    v_cndmask_b32 v3, v3, v4, vcc
    v_add_u32 v4, 160896, v13
    s_mov_b32 exec_lo, 0
    s_mov_b32 exec_hi, 0x03000000
    ds_read_b128 v[36:39], v4
    s_mov_b64 exec, -1
    s_waitcnt lgkmcnt(0)
L_z7:
    v_and_b32 v2, 7, v1
    v_lshl_add_u32 v3, v2, 4, v3
    buffer_store_dwordx4 v[36:39], v3, s[8:11], 0 offen sc1
L_zd:
    s_cmp_ge_u32 s76, 2
    s_cbranch_scc1 L_tch_2a
    s_and_b32 s6, s4, 3
    s_lshl_b32 s6, s6, 19
    s_lshl_b32 s7, s5, 15
    s_add_u32 s6, s6, s7
    s_lshl_b32 s7, s76, 7
    s_add_u32 s6, s6, s7
    s_add_u32 s6, s6, 768
    v_lshrrev_b32 v6, 1, v1
    v_lshlrev_b32 v6, 10, v6
    v_and_b32 v7, 1, v1
    v_lshl_add_u32 v6, v7, 6, v6
    buffer_load_dword v11, v6, s[12:15], s6 offen
    s_add_u32 s6, s6, 262144
    buffer_load_dword v11, v6, s[12:15], s6 offen
    s_branch L_tch_2c
L_tch_2a:
    v_lshrrev_b32 v6, 5, v1
    v_lshlrev_b32 v6, 6, v6
    v_bfe_u32 v7, v1, 2, 3
    v_add_u32 v6, v6, v7
    v_lshlrev_b32 v6, 13, v6
    v_and_b32 v7, 3, v1
    v_lshl_add_u32 v6, v7, 6, v6
    s_lshl_b32 s6, s4, 8
    s_lshl_b32 s7, s5, 16
    s_add_u32 s6, s6, s7
    s_add_u32 s6, s6, 3145728
    s_cmp_lg_u32 s76, 2
    s_cbranch_scc1 L_tch_2b
    buffer_load_dword v11, v6, s[16:19], s6 offen
    s_branch L_tch_2c
L_tch_2b:
    buffer_load_dword v11, v6, s[20:23], s6 offen
L_tch_2c:
    s_branch L_hook_back
L_hook4:
    s_cmp_lg_u32 s3, 4
    s_cbranch_scc1 L_hook4b
    s_mov_b32 s28, s56
    s_mov_b32 s29, s57
    s_mov_b32 s30, 0x100
    s_mov_b32 s31, 0x20000
    v_mov_b32 v2, 1
    v_lshlrev_b32 v3, 8, v1
    s_and_b32 s6, s2, 31
    s_lshl_b32 s6, s6, 2
    buffer_atomic_add v2, v3, s[28:31], s6 offen offset:0 sc1
L_hook4b:
    s_lshl_b32 s74, s76, 12
    s_add_u32 s74, s74, 131072
    s_mov_b32 m0, s74
    s_add_u32 s74, s74, 16384
    buffer_load_dwordx4 v44, s[24:27], s71 offen offset:0 lds
    buffer_load_dwordx4 v45, s[24:27], s71 offen offset:1024 lds
    buffer_load_dwordx4 v46, s[24:27], s71 offen offset:2048 lds
    buffer_load_dwordx4 v47, s[24:27], s71 offen offset:3072 lds
    s_add_u32 s71, s71, 524288
    s_sub_u32 s75, s71, 5242880
    s_cselect_b32 s71, s71, s75
    s_mov_b32 m0, s74
    s_add_u32 s74, s74, 16384
    buffer_load_dwordx4 v44, s[24:27], s71 offen offset:0 lds
    buffer_load_dwordx4 v45, s[24:27], s71 offen offset:1024 lds
    buffer_load_dwordx4 v46, s[24:27], s71 offen offset:2048 lds
    buffer_load_dwordx4 v47, s[24:27], s71 offen offset:3072 lds
    s_add_u32 s71, s71, 524288
    s_sub_u32 s75, s71, 5242880
    s_cselect_b32 s71, s71, s75
    s_branch L_hook_back
L_hook6:
    s_cmp_lg_u32 s3, 5
    s_cbranch_scc1 L_hook_back
    s_mov_b32 s28, s56
    s_mov_b32 s29, s57
    s_mov_b32 s30, 0x100
    s_mov_b32 s31, 0x20000
    v_and_b32 v3, 31, v1
    v_lshlrev_b32 v3, 2, v3
    buffer_load_dword v62, v3, s[28:31], 0 offen offset:0 sc1
    s_branch L_hook_back
L_vpre:
    s_waitcnt vmcnt(0)
    s_lshl_b32 s6, s65, 4
    s_add_u32 s6, s6, s3
    s_cmp_lg_u32 s6, 0x65
    s_cbranch_scc1 L_vnow
    v_cmp_gt_u32 vcc, 8, v62
    s_cbranch_vccz L_cntok_3
    s_mov_b32 s28, s56
    s_mov_b32 s29, s57
    s_mov_b32 s30, 0x100
    s_mov_b32 s31, 0x20000
    v_and_b32 v3, 31, v1
    v_lshlrev_b32 v3, 2, v3
    s_mov_b32 s79, 262144
L_poll_4:
    buffer_load_dword v2, v3, s[28:31], 0 offen offset:0 sc1
    s_waitcnt vmcnt(0)
    v_cmp_gt_u32 vcc, 8, v2
    s_cbranch_vccz L_polldone_5
    s_sleep 8
    s_sub_u32 s79, s79, 1
    s_cmp_lg_u32 s79, 0
    s_cbranch_scc1 L_poll_4
L_polldone_5:
L_cntok_3:
    s_branch L_vnow
L_khook:
    s_cmp_lg_u32 s65, 7
    s_cbranch_scc1 L_khook_back
    buffer_load_dwordx4 v[16:19], v13, s[8:11], s84 offen offset:0 sc1
    buffer_load_dwordx4 v[20:23], v12, s[8:11], s84 offen offset:0 sc1
    buffer_load_dwordx4 v[24:27], v13, s[8:11], s84 offen offset:1024 sc1
    buffer_load_dwordx4 v[28:31], v12, s[8:11], s84 offen offset:1024 sc1
    buffer_load_dwordx4 v[32:35], v13, s[8:11], s84 offen offset:2048 sc1
    buffer_load_dwordx4 v[36:39], v12, s[8:11], s84 offen offset:2048 sc1
    s_branch L_khook_back
L_kv_v:
    ds_read_b128 v[64:67], v48 offset:0
    ds_read_b128 v[68:71], v48 offset:2048
    ds_read_b64_tr_b16 v[96:97], v50 offset:0
    ds_read_b64_tr_b16 v[98:99], v50 offset:1024
    ds_read_b64_tr_b16 v[100:101], v51 offset:0
    ds_read_b64_tr_b16 v[102:103], v51 offset:1024
    ds_read_b128 v[72:75], v48 offset:4096
    ds_read_b64_tr_b16 v[104:105], v52 offset:0
    ds_read_b64_tr_b16 v[106:107], v52 offset:1024
    ds_read_b64_tr_b16 v[108:109], v53 offset:0
    ds_read_b64_tr_b16 v[110:111], v53 offset:1024
    ds_read_b128 v[76:79], v48 offset:6144
    ds_read_b128 v[80:83], v48 offset:8192
    ds_read_b128 v[84:87], v48 offset:10240
    ds_read_b128 v[88:91], v48 offset:12288
    ds_read_b128 v[92:95], v48 offset:14336
    s_cmp_ge_u32 s76, 2
    s_cbranch_scc1 L_tch_6a
    s_and_b32 s6, s4, 3
    s_lshl_b32 s6, s6, 19
    s_lshl_b32 s7, s5, 15
    s_add_u32 s6, s6, s7
    s_lshl_b32 s7, s76, 7
    s_add_u32 s6, s6, s7
    s_add_u32 s6, s6, 256
    v_lshrrev_b32 v6, 1, v1
    v_lshlrev_b32 v6, 10, v6
    v_and_b32 v7, 1, v1
    v_lshl_add_u32 v6, v7, 6, v6
    buffer_load_dword v11, v6, s[12:15], s6 offen
    s_add_u32 s6, s6, 262144
    buffer_load_dword v11, v6, s[12:15], s6 offen
    s_branch L_tch_6c
L_tch_6a:
    v_lshrrev_b32 v6, 5, v1
    v_lshlrev_b32 v6, 6, v6
    v_bfe_u32 v7, v1, 2, 3
    v_add_u32 v6, v6, v7
    v_lshlrev_b32 v6, 13, v6
    v_and_b32 v7, 3, v1
    v_lshl_add_u32 v6, v7, 6, v6
    s_lshl_b32 s6, s4, 8
    s_lshl_b32 s7, s5, 16
    s_add_u32 s6, s6, s7
    s_add_u32 s6, s6, 1048576
    s_cmp_lg_u32 s76, 2
    s_cbranch_scc1 L_tch_6b
    buffer_load_dword v11, v6, s[16:19], s6 offen
    s_branch L_tch_6c
L_tch_6b:
    buffer_load_dword v11, v6, s[20:23], s6 offen
L_tch_6c:
.p2align 4
L_vloop:
    s_bitcmp1_b32 214, s65
    s_cbranch_scc1 L_hook
L_hook_back:
    s_waitcnt lgkmcnt(12)
    v_mfma_f32_16x16x32_bf16 v[128:131], v[64:67], v[96:99], v[128:131]
    ds_read_b64_tr_b16 v[112:113], v50 offset:8192
    s_waitcnt lgkmcnt(11)
    v_mfma_f32_16x16x32_bf16 v[132:135], v[64:67], v[100:103], v[132:135]
    ds_read_b64_tr_b16 v[114:115], v50 offset:9216
    s_waitcnt lgkmcnt(9)
    v_mfma_f32_16x16x32_bf16 v[136:139], v[64:67], v[104:107], v[136:139]
    ds_read_b64_tr_b16 v[116:117], v51 offset:8192
    s_waitcnt lgkmcnt(8)
    v_mfma_f32_16x16x32_bf16 v[140:143], v[64:67], v[108:111], v[140:143]
    ds_read_b64_tr_b16 v[118:119], v51 offset:9216
    ds_read_b128 v[64:67], v49 offset:0
    v_mfma_f32_16x16x32_bf16 v[156:159], v[68:71], v[108:111], v[156:159]
    ds_read_b64_tr_b16 v[120:121], v52 offset:8192
    v_mfma_f32_16x16x32_bf16 v[152:155], v[68:71], v[104:107], v[152:155]
    ds_read_b64_tr_b16 v[122:123], v52 offset:9216
    v_mfma_f32_16x16x32_bf16 v[148:151], v[68:71], v[100:103], v[148:151]
    ds_read_b64_tr_b16 v[124:125], v53 offset:8192
    v_mfma_f32_16x16x32_bf16 v[144:147], v[68:71], v[96:99], v[144:147]
    ds_read_b64_tr_b16 v[126:127], v53 offset:9216
    ds_read_b128 v[68:71], v49 offset:2048
    v_mfma_f32_16x16x32_bf16 v[160:163], v[72:75], v[96:99], v[160:163]
    v_mfma_f32_16x16x32_bf16 v[164:167], v[72:75], v[100:103], v[164:167]
    v_mfma_f32_16x16x32_bf16 v[168:171], v[72:75], v[104:107], v[168:171]
    v_mfma_f32_16x16x32_bf16 v[172:175], v[72:75], v[108:111], v[172:175]
    ds_read_b128 v[72:75], v49 offset:4096
    s_waitcnt lgkmcnt(15)
    v_mfma_f32_16x16x32_bf16 v[188:191], v[76:79], v[108:111], v[188:191]
    v_mfma_f32_16x16x32_bf16 v[184:187], v[76:79], v[104:107], v[184:187]
    v_mfma_f32_16x16x32_bf16 v[180:183], v[76:79], v[100:103], v[180:183]
    v_mfma_f32_16x16x32_bf16 v[176:179], v[76:79], v[96:99], v[176:179]
    ds_read_b128 v[76:79], v49 offset:6144
    s_waitcnt lgkmcnt(15)
    v_mfma_f32_16x16x32_bf16 v[192:195], v[80:83], v[96:99], v[192:195]
    v_mfma_f32_16x16x32_bf16 v[196:199], v[80:83], v[100:103], v[196:199]
    v_mfma_f32_16x16x32_bf16 v[200:203], v[80:83], v[104:107], v[200:203]
    v_mfma_f32_16x16x32_bf16 v[204:207], v[80:83], v[108:111], v[204:207]
    ds_read_b128 v[80:83], v49 offset:8192
    s_waitcnt lgkmcnt(15)
    v_mfma_f32_16x16x32_bf16 v[220:223], v[84:87], v[108:111], v[220:223]
    v_mfma_f32_16x16x32_bf16 v[216:219], v[84:87], v[104:107], v[216:219]
    v_mfma_f32_16x16x32_bf16 v[212:215], v[84:87], v[100:103], v[212:215]
    v_mfma_f32_16x16x32_bf16 v[208:211], v[84:87], v[96:99], v[208:211]
    ds_read_b128 v[84:87], v49 offset:10240
    s_waitcnt lgkmcnt(15)
    v_mfma_f32_16x16x32_bf16 v[224:227], v[88:91], v[96:99], v[224:227]
    v_mfma_f32_16x16x32_bf16 v[228:231], v[88:91], v[100:103], v[228:231]
    v_mfma_f32_16x16x32_bf16 v[232:235], v[88:91], v[104:107], v[232:235]
    v_mfma_f32_16x16x32_bf16 v[236:239], v[88:91], v[108:111], v[236:239]
    ds_read_b128 v[88:91], v49 offset:12288
    s_waitcnt lgkmcnt(15)
    v_mfma_f32_16x16x32_bf16 v[252:255], v[92:95], v[108:111], v[252:255]
    v_mfma_f32_16x16x32_bf16 v[248:251], v[92:95], v[104:107], v[248:251]
    v_mfma_f32_16x16x32_bf16 v[244:247], v[92:95], v[100:103], v[244:247]
    v_mfma_f32_16x16x32_bf16 v[240:243], v[92:95], v[96:99], v[240:243]
    ds_read_b128 v[92:95], v49 offset:14336
    s_waitcnt lgkmcnt(11)
    v_mfma_f32_16x16x32_bf16 v[128:131], v[64:67], v[112:115], v[128:131]
    v_mfma_f32_16x16x32_bf16 v[132:135], v[64:67], v[116:119], v[132:135]
    s_waitcnt lgkmcnt(9)
    v_mfma_f32_16x16x32_bf16 v[136:139], v[64:67], v[120:123], v[136:139]
    s_waitcnt lgkmcnt(7)
    v_mfma_f32_16x16x32_bf16 v[140:143], v[64:67], v[124:127], v[140:143]
    s_waitcnt lgkmcnt(6)
    v_mfma_f32_16x16x32_bf16 v[156:159], v[68:71], v[124:127], v[156:159]
    v_mfma_f32_16x16x32_bf16 v[152:155], v[68:71], v[120:123], v[152:155]
    v_mfma_f32_16x16x32_bf16 v[148:151], v[68:71], v[116:119], v[148:151]
    v_mfma_f32_16x16x32_bf16 v[144:147], v[68:71], v[112:115], v[144:147]
    v_xor_b32 v48, 0x10000, v48
    v_xor_b32 v49, 0x10000, v49
    v_xor_b32 v50, 0x10000, v50
    v_xor_b32 v51, 0x10000, v51
    v_xor_b32 v52, 0x10000, v52
    v_xor_b32 v53, 0x10000, v53
    s_bitcmp1_b32 0x48, s65
    s_cbranch_scc1 L_vpre
L_vnow:
    s_waitcnt lgkmcnt(0)
    s_barrier
    ds_read_b128 v[64:67], v48 offset:0
    ds_read_b128 v[68:71], v48 offset:2048
    v_mfma_f32_16x16x32_bf16 v[160:163], v[72:75], v[112:115], v[160:163]
    ds_read_b64_tr_b16 v[96:97], v50 offset:0
    v_mfma_f32_16x16x32_bf16 v[164:167], v[72:75], v[116:119], v[164:167]
    ds_read_b64_tr_b16 v[98:99], v50 offset:1024
    v_mfma_f32_16x16x32_bf16 v[168:171], v[72:75], v[120:123], v[168:171]
    ds_read_b64_tr_b16 v[100:101], v51 offset:0
    v_mfma_f32_16x16x32_bf16 v[172:175], v[72:75], v[124:127], v[172:175]
    ds_read_b64_tr_b16 v[102:103], v51 offset:1024
    ds_read_b128 v[72:75], v48 offset:4096
    v_mfma_f32_16x16x32_bf16 v[188:191], v[76:79], v[124:127], v[188:191]
    ds_read_b64_tr_b16 v[104:105], v52 offset:0
    v_mfma_f32_16x16x32_bf16 v[184:187], v[76:79], v[120:123], v[184:187]
    ds_read_b64_tr_b16 v[106:107], v52 offset:1024
    v_mfma_f32_16x16x32_bf16 v[180:183], v[76:79], v[116:119], v[180:183]
    ds_read_b64_tr_b16 v[108:109], v53 offset:0
    v_mfma_f32_16x16x32_bf16 v[176:179], v[76:79], v[112:115], v[176:179]
    ds_read_b64_tr_b16 v[110:111], v53 offset:1024
    ds_read_b128 v[76:79], v48 offset:6144
    v_mfma_f32_16x16x32_bf16 v[192:195], v[80:83], v[112:115], v[192:195]
    v_mfma_f32_16x16x32_bf16 v[196:199], v[80:83], v[116:119], v[196:199]
    v_mfma_f32_16x16x32_bf16 v[200:203], v[80:83], v[120:123], v[200:203]
    v_mfma_f32_16x16x32_bf16 v[204:207], v[80:83], v[124:127], v[204:207]
    ds_read_b128 v[80:83], v48 offset:8192
    v_mfma_f32_16x16x32_bf16 v[220:223], v[84:87], v[124:127], v[220:223]
    v_mfma_f32_16x16x32_bf16 v[216:219], v[84:87], v[120:123], v[216:219]
    v_mfma_f32_16x16x32_bf16 v[212:215], v[84:87], v[116:119], v[212:215]
    v_mfma_f32_16x16x32_bf16 v[208:211], v[84:87], v[112:115], v[208:211]
    ds_read_b128 v[84:87], v48 offset:10240
    v_mfma_f32_16x16x32_bf16 v[224:227], v[88:91], v[112:115], v[224:227]
    v_mfma_f32_16x16x32_bf16 v[228:231], v[88:91], v[116:119], v[228:231]
    v_mfma_f32_16x16x32_bf16 v[232:235], v[88:91], v[120:123], v[232:235]
    v_mfma_f32_16x16x32_bf16 v[236:239], v[88:91], v[124:127], v[236:239]
    ds_read_b128 v[88:91], v48 offset:12288
    v_mfma_f32_16x16x32_bf16 v[252:255], v[92:95], v[124:127], v[252:255]
    v_mfma_f32_16x16x32_bf16 v[248:251], v[92:95], v[120:123], v[248:251]
    v_mfma_f32_16x16x32_bf16 v[244:247], v[92:95], v[116:119], v[244:247]
    v_mfma_f32_16x16x32_bf16 v[240:243], v[92:95], v[112:115], v[240:243]
    ds_read_b128 v[92:95], v48 offset:14336
    s_add_u32 s65, s65, 1
    s_cmp_lt_u32 s65, 8
    s_cbranch_scc1 L_vloop
    s_waitcnt lgkmcnt(0)
    s_nop 7
    v_cvt_pk_bf16_f32 v128, v128, v129
    v_cvt_pk_bf16_f32 v129, v130, v131
    v_cvt_pk_bf16_f32 v130, v144, v145
    v_cvt_pk_bf16_f32 v131, v146, v147
    v_cvt_pk_bf16_f32 v132, v132, v133
    v_cvt_pk_bf16_f32 v133, v134, v135
    v_cvt_pk_bf16_f32 v134, v148, v149
    v_cvt_pk_bf16_f32 v135, v150, v151
    v_cvt_pk_bf16_f32 v136, v136, v137
    v_cvt_pk_bf16_f32 v137, v138, v139
    v_cvt_pk_bf16_f32 v138, v152, v153
    v_cvt_pk_bf16_f32 v139, v154, v155
    v_cvt_pk_bf16_f32 v140, v140, v141
    v_cvt_pk_bf16_f32 v141, v142, v143
    v_cvt_pk_bf16_f32 v142, v156, v157
    v_cvt_pk_bf16_f32 v143, v158, v159
    v_cvt_pk_bf16_f32 v144, v160, v161
    v_cvt_pk_bf16_f32 v145, v162, v163
    v_cvt_pk_bf16_f32 v146, v176, v177
    v_cvt_pk_bf16_f32 v147, v178, v179
    v_cvt_pk_bf16_f32 v148, v164, v165
    v_cvt_pk_bf16_f32 v149, v166, v167
    v_cvt_pk_bf16_f32 v150, v180, v181
    v_cvt_pk_bf16_f32 v151, v182, v183
    v_cvt_pk_bf16_f32 v152, v168, v169
    v_cvt_pk_bf16_f32 v153, v170, v171
    v_cvt_pk_bf16_f32 v154, v184, v185
    v_cvt_pk_bf16_f32 v155, v186, v187
    v_cvt_pk_bf16_f32 v156, v172, v173
    v_cvt_pk_bf16_f32 v157, v174, v175
    v_cvt_pk_bf16_f32 v158, v188, v189
    v_cvt_pk_bf16_f32 v159, v190, v191
    v_cvt_pk_bf16_f32 v160, v192, v193
    v_cvt_pk_bf16_f32 v161, v194, v195
    v_cvt_pk_bf16_f32 v162, v208, v209
    v_cvt_pk_bf16_f32 v163, v210, v211
    v_cvt_pk_bf16_f32 v164, v196, v197
    v_cvt_pk_bf16_f32 v165, v198, v199
    v_cvt_pk_bf16_f32 v166, v212, v213
    v_cvt_pk_bf16_f32 v167, v214, v215
    v_cvt_pk_bf16_f32 v168, v200, v201
    v_cvt_pk_bf16_f32 v169, v202, v203
    v_cvt_pk_bf16_f32 v170, v216, v217
    v_cvt_pk_bf16_f32 v171, v218, v219
    v_cvt_pk_bf16_f32 v172, v204, v205
    v_cvt_pk_bf16_f32 v173, v206, v207
    v_cvt_pk_bf16_f32 v174, v220, v221
    v_cvt_pk_bf16_f32 v175, v222, v223
    v_cvt_pk_bf16_f32 v176, v224, v225
    v_cvt_pk_bf16_f32 v177, v226, v227
    v_cvt_pk_bf16_f32 v178, v240, v241
    v_cvt_pk_bf16_f32 v179, v242, v243
    v_cvt_pk_bf16_f32 v180, v228, v229
    v_cvt_pk_bf16_f32 v181, v230, v231
    v_cvt_pk_bf16_f32 v182, v244, v245
    v_cvt_pk_bf16_f32 v183, v246, v247
    v_cvt_pk_bf16_f32 v184, v232, v233
    v_cvt_pk_bf16_f32 v185, v234, v235
    v_cvt_pk_bf16_f32 v186, v248, v249
    v_cvt_pk_bf16_f32 v187, v250, v251
    v_cvt_pk_bf16_f32 v188, v236, v237
    v_cvt_pk_bf16_f32 v189, v238, v239
    v_cvt_pk_bf16_f32 v190, v252, v253
    v_cvt_pk_bf16_f32 v191, v254, v255
    s_waitcnt vmcnt(0)
L_q:
    s_mov_b32 s28, s56
    s_mov_b32 s29, s57
    s_mov_b32 s30, 0x100
    s_mov_b32 s31, 0x20000
    s_lshl_b32 s6, s76, 13
    v_add_u32 v49, s6, v13
    s_lshl_b32 s6, s76, 12
    v_add_u32 v50, s6, v13
    s_lshl_b32 s77, s4, 20
    s_add_u32 s77, s77, 16777216
    s_mov_b32 s78, s100
    s_sub_u32 s101, s100, 131072
    s_mov_b32 s90, 0
    s_cmp_lt_u32 s3, 4
    s_cselect_b32 s89, 3, 2
    ds_read_b64_tr_b16 v[96:97], v54 offset:0
    ds_read_b64_tr_b16 v[98:99], v54 offset:1024
    ds_read_b64_tr_b16 v[100:101], v55 offset:0
    ds_read_b64_tr_b16 v[102:103], v55 offset:1024
    ds_read_b64_tr_b16 v[104:105], v56 offset:0
    ds_read_b64_tr_b16 v[106:107], v56 offset:1024
    ds_read_b64_tr_b16 v[108:109], v57 offset:0
    ds_read_b64_tr_b16 v[110:111], v57 offset:1024
    ds_read_b64_tr_b16 v[112:113], v58 offset:0
    ds_read_b64_tr_b16 v[114:115], v58 offset:1024
    ds_read_b64_tr_b16 v[116:117], v59 offset:0
    ds_read_b64_tr_b16 v[118:119], v59 offset:1024
    ds_read_b64_tr_b16 v[120:121], v60 offset:0
    ds_read_b64_tr_b16 v[122:123], v60 offset:1024
    ds_read_b64_tr_b16 v[124:125], v61 offset:0
    ds_read_b64_tr_b16 v[126:127], v61 offset:1024
    buffer_load_dwordx4 v[64:67], v13, s[8:11], s84 offen offset:3072 sc1
    buffer_load_dwordx4 v[68:71], v12, s[8:11], s84 offen offset:3072 sc1
    buffer_load_dwordx4 v[72:75], v13, s[8:11], s85 offen offset:0 sc1
    buffer_load_dwordx4 v[76:79], v12, s[8:11], s85 offen offset:0 sc1
    buffer_load_dwordx4 v[80:83], v13, s[8:11], s85 offen offset:1024 sc1
    buffer_load_dwordx4 v[84:87], v12, s[8:11], s85 offen offset:1024 sc1
    buffer_load_dwordx4 v[88:91], v13, s[8:11], s85 offen offset:2048 sc1
    buffer_load_dwordx4 v[92:95], v12, s[8:11], s85 offen offset:2048 sc1
    s_waitcnt lgkmcnt(14)
    v_mfma_f32_16x16x32_bf16 v[192:195], v[96:99], v[16:19], 0
    v_mfma_f32_16x16x32_bf16 v[196:199], v[96:99], v[20:23], 0
    ds_read_b64_tr_b16 v[96:97], v54 offset:8192
    s_waitcnt lgkmcnt(13)
    v_mfma_f32_16x16x32_bf16 v[204:207], v[100:103], v[20:23], 0
    ds_read_b64_tr_b16 v[98:99], v54 offset:9216
    v_mfma_f32_16x16x32_bf16 v[200:203], v[100:103], v[16:19], 0
    ds_read_b64_tr_b16 v[100:101], v55 offset:8192
    s_waitcnt lgkmcnt(13)
    v_mfma_f32_16x16x32_bf16 v[208:211], v[104:107], v[16:19], 0
    ds_read_b64_tr_b16 v[102:103], v55 offset:9216
    v_mfma_f32_16x16x32_bf16 v[212:215], v[104:107], v[20:23], 0
    ds_read_b64_tr_b16 v[104:105], v56 offset:8192
    s_waitcnt lgkmcnt(13)
    v_mfma_f32_16x16x32_bf16 v[220:223], v[108:111], v[20:23], 0
    ds_read_b64_tr_b16 v[106:107], v56 offset:9216
    buffer_store_dwordx4 v[128:131], v13, s[8:11], s67 offen sc1
    s_add_u32 s67, s67, 1024
    v_mfma_f32_16x16x32_bf16 v[216:219], v[108:111], v[16:19], 0
    ds_read_b64_tr_b16 v[108:109], v57 offset:8192
    s_waitcnt lgkmcnt(13)
    v_mfma_f32_16x16x32_bf16 v[224:227], v[112:115], v[16:19], 0
    ds_read_b64_tr_b16 v[110:111], v57 offset:9216
    v_mfma_f32_16x16x32_bf16 v[228:231], v[112:115], v[20:23], 0
    ds_read_b64_tr_b16 v[112:113], v58 offset:8192
    s_waitcnt lgkmcnt(13)
    v_mfma_f32_16x16x32_bf16 v[236:239], v[116:119], v[20:23], 0
    ds_read_b64_tr_b16 v[114:115], v58 offset:9216
    v_mfma_f32_16x16x32_bf16 v[232:235], v[116:119], v[16:19], 0
    ds_read_b64_tr_b16 v[116:117], v59 offset:8192
    s_waitcnt lgkmcnt(13)
    v_mfma_f32_16x16x32_bf16 v[240:243], v[120:123], v[16:19], 0
    ds_read_b64_tr_b16 v[118:119], v59 offset:9216
    v_mfma_f32_16x16x32_bf16 v[244:247], v[120:123], v[20:23], 0
    ds_read_b64_tr_b16 v[120:121], v60 offset:8192
    s_waitcnt lgkmcnt(13)
    v_mfma_f32_16x16x32_bf16 v[252:255], v[124:127], v[20:23], 0
    ds_read_b64_tr_b16 v[122:123], v60 offset:9216
    v_mfma_f32_16x16x32_bf16 v[248:251], v[124:127], v[16:19], 0
    ds_read_b64_tr_b16 v[124:125], v61 offset:8192
    ds_read_b64_tr_b16 v[126:127], v61 offset:9216
    buffer_load_dwordx4 v[16:19], v13, s[8:11], s85 offen offset:3072 sc1
    buffer_load_dwordx4 v[20:23], v12, s[8:11], s85 offen offset:3072 sc1
    s_waitcnt lgkmcnt(14)
    v_mfma_f32_16x16x32_bf16 v[192:195], v[96:99], v[24:27], v[192:195]
    v_mfma_f32_16x16x32_bf16 v[196:199], v[96:99], v[28:31], v[196:199]
    ds_read_b64_tr_b16 v[96:97], v54 offset:16384
    s_waitcnt lgkmcnt(13)
    v_mfma_f32_16x16x32_bf16 v[204:207], v[100:103], v[28:31], v[204:207]
    ds_read_b64_tr_b16 v[98:99], v54 offset:17408
    v_mfma_f32_16x16x32_bf16 v[200:203], v[100:103], v[24:27], v[200:203]
    ds_read_b64_tr_b16 v[100:101], v55 offset:16384
    s_waitcnt lgkmcnt(13)
    v_mfma_f32_16x16x32_bf16 v[208:211], v[104:107], v[24:27], v[208:211]
    ds_read_b64_tr_b16 v[102:103], v55 offset:17408
    v_mfma_f32_16x16x32_bf16 v[212:215], v[104:107], v[28:31], v[212:215]
    ds_read_b64_tr_b16 v[104:105], v56 offset:16384
    s_waitcnt lgkmcnt(13)
    v_mfma_f32_16x16x32_bf16 v[220:223], v[108:111], v[28:31], v[220:223]
    ds_read_b64_tr_b16 v[106:107], v56 offset:17408
    buffer_store_dwordx4 v[132:135], v13, s[8:11], s67 offen sc1
    s_add_u32 s67, s67, s68
    v_mfma_f32_16x16x32_bf16 v[216:219], v[108:111], v[24:27], v[216:219]
    ds_read_b64_tr_b16 v[108:109], v57 offset:16384
    s_waitcnt lgkmcnt(13)
    v_mfma_f32_16x16x32_bf16 v[224:227], v[112:115], v[24:27], v[224:227]
    ds_read_b64_tr_b16 v[110:111], v57 offset:17408
    v_mfma_f32_16x16x32_bf16 v[228:231], v[112:115], v[28:31], v[228:231]
    ds_read_b64_tr_b16 v[112:113], v58 offset:16384
    s_waitcnt lgkmcnt(13)
    v_mfma_f32_16x16x32_bf16 v[236:239], v[116:119], v[28:31], v[236:239]
    ds_read_b64_tr_b16 v[114:115], v58 offset:17408
    v_mfma_f32_16x16x32_bf16 v[232:235], v[116:119], v[24:27], v[232:235]
    ds_read_b64_tr_b16 v[116:117], v59 offset:16384
    s_waitcnt lgkmcnt(13)
    v_mfma_f32_16x16x32_bf16 v[240:243], v[120:123], v[24:27], v[240:243]
    ds_read_b64_tr_b16 v[118:119], v59 offset:17408
    v_mfma_f32_16x16x32_bf16 v[244:247], v[120:123], v[28:31], v[244:247]
    ds_read_b64_tr_b16 v[120:121], v60 offset:16384
    s_waitcnt lgkmcnt(13)
    v_mfma_f32_16x16x32_bf16 v[252:255], v[124:127], v[28:31], v[252:255]
    ds_read_b64_tr_b16 v[122:123], v60 offset:17408
    v_mfma_f32_16x16x32_bf16 v[248:251], v[124:127], v[24:27], v[248:251]
    ds_read_b64_tr_b16 v[124:125], v61 offset:16384
    ds_read_b64_tr_b16 v[126:127], v61 offset:17408
    buffer_load_dwordx4 v[24:27], v13, s[8:11], s86 offen offset:0 sc1
    buffer_load_dwordx4 v[28:31], v12, s[8:11], s86 offen offset:0 sc1
    s_waitcnt lgkmcnt(14)
    v_mfma_f32_16x16x32_bf16 v[192:195], v[96:99], v[32:35], v[192:195]
    v_mfma_f32_16x16x32_bf16 v[196:199], v[96:99], v[36:39], v[196:199]
    ds_read_b64_tr_b16 v[96:97], v54 offset:24576
    s_waitcnt lgkmcnt(13)
    v_mfma_f32_16x16x32_bf16 v[204:207], v[100:103], v[36:39], v[204:207]
    ds_read_b64_tr_b16 v[98:99], v54 offset:25600
    v_mfma_f32_16x16x32_bf16 v[200:203], v[100:103], v[32:35], v[200:203]
    ds_read_b64_tr_b16 v[100:101], v55 offset:24576
    s_waitcnt lgkmcnt(13)
    v_mfma_f32_16x16x32_bf16 v[208:211], v[104:107], v[32:35], v[208:211]
    ds_read_b64_tr_b16 v[102:103], v55 offset:25600
    v_mfma_f32_16x16x32_bf16 v[212:215], v[104:107], v[36:39], v[212:215]
    ds_read_b64_tr_b16 v[104:105], v56 offset:24576
    s_waitcnt lgkmcnt(13)
    v_mfma_f32_16x16x32_bf16 v[220:223], v[108:111], v[36:39], v[220:223]
    ds_read_b64_tr_b16 v[106:107], v56 offset:25600
    buffer_store_dwordx4 v[136:139], v13, s[8:11], s67 offen sc1
    s_add_u32 s67, s67, 1024
    v_mfma_f32_16x16x32_bf16 v[216:219], v[108:111], v[32:35], v[216:219]
    ds_read_b64_tr_b16 v[108:109], v57 offset:24576
    s_waitcnt lgkmcnt(13)
    v_mfma_f32_16x16x32_bf16 v[224:227], v[112:115], v[32:35], v[224:227]
    ds_read_b64_tr_b16 v[110:111], v57 offset:25600
    v_mfma_f32_16x16x32_bf16 v[228:231], v[112:115], v[36:39], v[228:231]
    ds_read_b64_tr_b16 v[112:113], v58 offset:24576
    s_waitcnt lgkmcnt(13)
    v_mfma_f32_16x16x32_bf16 v[236:239], v[116:119], v[36:39], v[236:239]
    ds_read_b64_tr_b16 v[114:115], v58 offset:25600
    v_mfma_f32_16x16x32_bf16 v[232:235], v[116:119], v[32:35], v[232:235]
    ds_read_b64_tr_b16 v[116:117], v59 offset:24576
    s_waitcnt lgkmcnt(13)
    v_mfma_f32_16x16x32_bf16 v[240:243], v[120:123], v[32:35], v[240:243]
    ds_read_b64_tr_b16 v[118:119], v59 offset:25600
    v_mfma_f32_16x16x32_bf16 v[244:247], v[120:123], v[36:39], v[244:247]
    ds_read_b64_tr_b16 v[120:121], v60 offset:24576
    s_waitcnt lgkmcnt(13)
    v_mfma_f32_16x16x32_bf16 v[252:255], v[124:127], v[36:39], v[252:255]
    ds_read_b64_tr_b16 v[122:123], v60 offset:25600
    v_mfma_f32_16x16x32_bf16 v[248:251], v[124:127], v[32:35], v[248:251]
    ds_read_b64_tr_b16 v[124:125], v61 offset:24576
    ds_read_b64_tr_b16 v[126:127], v61 offset:25600
    buffer_load_dwordx4 v[32:35], v13, s[8:11], s86 offen offset:1024 sc1
    buffer_load_dwordx4 v[36:39], v12, s[8:11], s86 offen offset:1024 sc1
    s_waitcnt vmcnt(15)
    s_waitcnt lgkmcnt(14)
    v_mfma_f32_16x16x32_bf16 v[192:195], v[96:99], v[64:67], v[192:195]
    v_add_u32 v54, s101, v54
    v_mfma_f32_16x16x32_bf16 v[196:199], v[96:99], v[68:71], v[196:199]
    ds_read_b64_tr_b16 v[96:97], v54 offset:0
    s_waitcnt lgkmcnt(13)
    v_mfma_f32_16x16x32_bf16 v[204:207], v[100:103], v[68:71], v[204:207]
    ds_read_b64_tr_b16 v[98:99], v54 offset:1024
    v_add_u32 v55, s101, v55
    v_mfma_f32_16x16x32_bf16 v[200:203], v[100:103], v[64:67], v[200:203]
    ds_read_b64_tr_b16 v[100:101], v55 offset:0
    s_waitcnt lgkmcnt(13)
    v_mfma_f32_16x16x32_bf16 v[208:211], v[104:107], v[64:67], v[208:211]
    ds_read_b64_tr_b16 v[102:103], v55 offset:1024
    v_add_u32 v56, s101, v56
    v_mfma_f32_16x16x32_bf16 v[212:215], v[104:107], v[68:71], v[212:215]
    ds_read_b64_tr_b16 v[104:105], v56 offset:0
    s_waitcnt lgkmcnt(13)
    v_mfma_f32_16x16x32_bf16 v[220:223], v[108:111], v[68:71], v[220:223]
    ds_read_b64_tr_b16 v[106:107], v56 offset:1024
    v_add_u32 v57, s101, v57
    buffer_store_dwordx4 v[140:143], v13, s[8:11], s67 offen sc1
    s_add_u32 s67, s67, s69
    v_mfma_f32_16x16x32_bf16 v[216:219], v[108:111], v[64:67], v[216:219]
    ds_read_b64_tr_b16 v[108:109], v57 offset:0
    s_waitcnt lgkmcnt(13)
    v_mfma_f32_16x16x32_bf16 v[224:227], v[112:115], v[64:67], v[224:227]
    ds_read_b64_tr_b16 v[110:111], v57 offset:1024
    v_add_u32 v58, s101, v58
    v_mfma_f32_16x16x32_bf16 v[228:231], v[112:115], v[68:71], v[228:231]
    ds_read_b64_tr_b16 v[112:113], v58 offset:0
    s_waitcnt lgkmcnt(13)
    v_mfma_f32_16x16x32_bf16 v[236:239], v[116:119], v[68:71], v[236:239]
    ds_read_b64_tr_b16 v[114:115], v58 offset:1024
    v_add_u32 v59, s101, v59
    v_mfma_f32_16x16x32_bf16 v[232:235], v[116:119], v[64:67], v[232:235]
    ds_read_b64_tr_b16 v[116:117], v59 offset:0
    s_waitcnt lgkmcnt(13)
    v_mfma_f32_16x16x32_bf16 v[240:243], v[120:123], v[64:67], v[240:243]
    ds_read_b64_tr_b16 v[118:119], v59 offset:1024
    v_add_u32 v60, s101, v60
    v_mfma_f32_16x16x32_bf16 v[244:247], v[120:123], v[68:71], v[244:247]
    ds_read_b64_tr_b16 v[120:121], v60 offset:0
    s_waitcnt lgkmcnt(13)
    v_mfma_f32_16x16x32_bf16 v[252:255], v[124:127], v[68:71], v[252:255]
    ds_read_b64_tr_b16 v[122:123], v60 offset:1024
    v_add_u32 v61, s101, v61
    v_mfma_f32_16x16x32_bf16 v[248:251], v[124:127], v[64:67], v[248:251]
    ds_read_b64_tr_b16 v[124:125], v61 offset:0
    ds_read_b64_tr_b16 v[126:127], v61 offset:1024
    buffer_load_dwordx4 v[64:67], v13, s[8:11], s86 offen offset:2048 sc1
    buffer_load_dwordx4 v[68:71], v12, s[8:11], s86 offen offset:2048 sc1
    s_waitcnt vmcnt(16)
    s_waitcnt lgkmcnt(14)
    v_mfma_f32_16x16x32_bf16 v[192:195], v[96:99], v[72:75], v[192:195]
    v_mfma_f32_16x16x32_bf16 v[196:199], v[96:99], v[76:79], v[196:199]
    ds_read_b64_tr_b16 v[96:97], v54 offset:8192
    s_waitcnt lgkmcnt(13)
    v_mfma_f32_16x16x32_bf16 v[204:207], v[100:103], v[76:79], v[204:207]
    ds_read_b64_tr_b16 v[98:99], v54 offset:9216
    v_mfma_f32_16x16x32_bf16 v[200:203], v[100:103], v[72:75], v[200:203]
    ds_read_b64_tr_b16 v[100:101], v55 offset:8192
    s_waitcnt lgkmcnt(13)
    v_mfma_f32_16x16x32_bf16 v[208:211], v[104:107], v[72:75], v[208:211]
    ds_read_b64_tr_b16 v[102:103], v55 offset:9216
    v_mfma_f32_16x16x32_bf16 v[212:215], v[104:107], v[76:79], v[212:215]
    ds_read_b64_tr_b16 v[104:105], v56 offset:8192
    s_waitcnt lgkmcnt(13)
    v_mfma_f32_16x16x32_bf16 v[220:223], v[108:111], v[76:79], v[220:223]
    ds_read_b64_tr_b16 v[106:107], v56 offset:9216
    v_mfma_f32_16x16x32_bf16 v[216:219], v[108:111], v[72:75], v[216:219]
    ds_read_b64_tr_b16 v[108:109], v57 offset:8192
    s_waitcnt lgkmcnt(13)
    v_mfma_f32_16x16x32_bf16 v[224:227], v[112:115], v[72:75], v[224:227]
    ds_read_b64_tr_b16 v[110:111], v57 offset:9216
    v_mfma_f32_16x16x32_bf16 v[228:231], v[112:115], v[76:79], v[228:231]
    ds_read_b64_tr_b16 v[112:113], v58 offset:8192
    s_waitcnt lgkmcnt(13)
    v_mfma_f32_16x16x32_bf16 v[236:239], v[116:119], v[76:79], v[236:239]
    ds_read_b64_tr_b16 v[114:115], v58 offset:9216
    v_mfma_f32_16x16x32_bf16 v[232:235], v[116:119], v[72:75], v[232:235]
    ds_read_b64_tr_b16 v[116:117], v59 offset:8192
    s_waitcnt lgkmcnt(13)
    v_mfma_f32_16x16x32_bf16 v[240:243], v[120:123], v[72:75], v[240:243]
    ds_read_b64_tr_b16 v[118:119], v59 offset:9216
    v_mfma_f32_16x16x32_bf16 v[244:247], v[120:123], v[76:79], v[244:247]
    ds_read_b64_tr_b16 v[120:121], v60 offset:8192
    s_waitcnt lgkmcnt(13)
    v_mfma_f32_16x16x32_bf16 v[252:255], v[124:127], v[76:79], v[252:255]
    ds_read_b64_tr_b16 v[122:123], v60 offset:9216
    v_mfma_f32_16x16x32_bf16 v[248:251], v[124:127], v[72:75], v[248:251]
    ds_read_b64_tr_b16 v[124:125], v61 offset:8192
    ds_read_b64_tr_b16 v[126:127], v61 offset:9216
    buffer_load_dwordx4 v[72:75], v13, s[8:11], s86 offen offset:3072 sc1
    buffer_load_dwordx4 v[76:79], v12, s[8:11], s86 offen offset:3072 sc1
    s_waitcnt vmcnt(16)
    s_waitcnt lgkmcnt(14)
    v_mfma_f32_16x16x32_bf16 v[192:195], v[96:99], v[80:83], v[192:195]
    v_mfma_f32_16x16x32_bf16 v[196:199], v[96:99], v[84:87], v[196:199]
    ds_read_b64_tr_b16 v[96:97], v54 offset:16384
    s_waitcnt lgkmcnt(13)
    v_mfma_f32_16x16x32_bf16 v[204:207], v[100:103], v[84:87], v[204:207]
    ds_read_b64_tr_b16 v[98:99], v54 offset:17408
    v_mfma_f32_16x16x32_bf16 v[200:203], v[100:103], v[80:83], v[200:203]
    ds_read_b64_tr_b16 v[100:101], v55 offset:16384
    s_waitcnt lgkmcnt(13)
    v_mfma_f32_16x16x32_bf16 v[208:211], v[104:107], v[80:83], v[208:211]
    ds_read_b64_tr_b16 v[102:103], v55 offset:17408
    v_mfma_f32_16x16x32_bf16 v[212:215], v[104:107], v[84:87], v[212:215]
    ds_read_b64_tr_b16 v[104:105], v56 offset:16384
    s_waitcnt lgkmcnt(13)
    v_mfma_f32_16x16x32_bf16 v[220:223], v[108:111], v[84:87], v[220:223]
    ds_read_b64_tr_b16 v[106:107], v56 offset:17408
    v_mfma_f32_16x16x32_bf16 v[216:219], v[108:111], v[80:83], v[216:219]
    ds_read_b64_tr_b16 v[108:109], v57 offset:16384
    s_waitcnt lgkmcnt(13)
    v_mfma_f32_16x16x32_bf16 v[224:227], v[112:115], v[80:83], v[224:227]
    ds_read_b64_tr_b16 v[110:111], v57 offset:17408
    v_mfma_f32_16x16x32_bf16 v[228:231], v[112:115], v[84:87], v[228:231]
    ds_read_b64_tr_b16 v[112:113], v58 offset:16384
    s_waitcnt lgkmcnt(13)
    v_mfma_f32_16x16x32_bf16 v[236:239], v[116:119], v[84:87], v[236:239]
    ds_read_b64_tr_b16 v[114:115], v58 offset:17408
    v_mfma_f32_16x16x32_bf16 v[232:235], v[116:119], v[80:83], v[232:235]
    ds_read_b64_tr_b16 v[116:117], v59 offset:16384
    s_waitcnt lgkmcnt(13)
    v_mfma_f32_16x16x32_bf16 v[240:243], v[120:123], v[80:83], v[240:243]
    ds_read_b64_tr_b16 v[118:119], v59 offset:17408
    v_mfma_f32_16x16x32_bf16 v[244:247], v[120:123], v[84:87], v[244:247]
    ds_read_b64_tr_b16 v[120:121], v60 offset:16384
    s_waitcnt lgkmcnt(13)
    v_mfma_f32_16x16x32_bf16 v[252:255], v[124:127], v[84:87], v[252:255]
    ds_read_b64_tr_b16 v[122:123], v60 offset:17408
    v_mfma_f32_16x16x32_bf16 v[248:251], v[124:127], v[80:83], v[248:251]
    ds_read_b64_tr_b16 v[124:125], v61 offset:16384
    ds_read_b64_tr_b16 v[126:127], v61 offset:17408
    buffer_load_dwordx4 v[80:83], v13, s[8:11], s87 offen offset:0 sc1
    buffer_load_dwordx4 v[84:87], v12, s[8:11], s87 offen offset:0 sc1
    s_waitcnt vmcnt(16)
    s_waitcnt lgkmcnt(14)
    v_mfma_f32_16x16x32_bf16 v[192:195], v[96:99], v[88:91], v[192:195]
    v_mfma_f32_16x16x32_bf16 v[196:199], v[96:99], v[92:95], v[196:199]
    ds_read_b64_tr_b16 v[96:97], v54 offset:24576
    s_waitcnt lgkmcnt(13)
    v_mfma_f32_16x16x32_bf16 v[204:207], v[100:103], v[92:95], v[204:207]
    ds_read_b64_tr_b16 v[98:99], v54 offset:25600
    v_mfma_f32_16x16x32_bf16 v[200:203], v[100:103], v[88:91], v[200:203]
    ds_read_b64_tr_b16 v[100:101], v55 offset:24576
    s_waitcnt lgkmcnt(13)
    v_mfma_f32_16x16x32_bf16 v[208:211], v[104:107], v[88:91], v[208:211]
    ds_read_b64_tr_b16 v[102:103], v55 offset:25600
    v_mfma_f32_16x16x32_bf16 v[212:215], v[104:107], v[92:95], v[212:215]
    ds_read_b64_tr_b16 v[104:105], v56 offset:24576
    s_waitcnt lgkmcnt(13)
    v_mfma_f32_16x16x32_bf16 v[220:223], v[108:111], v[92:95], v[220:223]
    ds_read_b64_tr_b16 v[106:107], v56 offset:25600
    v_mfma_f32_16x16x32_bf16 v[216:219], v[108:111], v[88:91], v[216:219]
    ds_read_b64_tr_b16 v[108:109], v57 offset:24576
    s_waitcnt lgkmcnt(13)
    v_mfma_f32_16x16x32_bf16 v[224:227], v[112:115], v[88:91], v[224:227]
    ds_read_b64_tr_b16 v[110:111], v57 offset:25600
    v_mfma_f32_16x16x32_bf16 v[228:231], v[112:115], v[92:95], v[228:231]
    ds_read_b64_tr_b16 v[112:113], v58 offset:24576
    s_waitcnt lgkmcnt(13)
    v_mfma_f32_16x16x32_bf16 v[236:239], v[116:119], v[92:95], v[236:239]
    ds_read_b64_tr_b16 v[114:115], v58 offset:25600
    v_mfma_f32_16x16x32_bf16 v[232:235], v[116:119], v[88:91], v[232:235]
    ds_read_b64_tr_b16 v[116:117], v59 offset:24576
    s_waitcnt lgkmcnt(13)
    v_mfma_f32_16x16x32_bf16 v[240:243], v[120:123], v[88:91], v[240:243]
    ds_read_b64_tr_b16 v[118:119], v59 offset:25600
    v_mfma_f32_16x16x32_bf16 v[244:247], v[120:123], v[92:95], v[244:247]
    ds_read_b64_tr_b16 v[120:121], v60 offset:24576
    s_waitcnt lgkmcnt(13)
    v_mfma_f32_16x16x32_bf16 v[252:255], v[124:127], v[92:95], v[252:255]
    ds_read_b64_tr_b16 v[122:123], v60 offset:25600
    v_mfma_f32_16x16x32_bf16 v[248:251], v[124:127], v[88:91], v[248:251]
    ds_read_b64_tr_b16 v[124:125], v61 offset:24576
    ds_read_b64_tr_b16 v[126:127], v61 offset:25600
    buffer_load_dwordx4 v[88:91], v13, s[8:11], s87 offen offset:1024 sc1
    buffer_load_dwordx4 v[92:95], v12, s[8:11], s87 offen offset:1024 sc1
    s_waitcnt vmcnt(8)
    s_lshl_b32 s6, s4, 3
    s_add_u32 s6, s6, s5
    s_lshl_b32 s6, s6, 5
    s_add_u32 s6, s6, s3
    s_lshl_b32 s6, s6, 2
    s_add_u32 s6, s6, 3866624
    v_mov_b32 v2, 1
    v_mov_b32 v3, 0x5000000
    v_writelane_b32 v3, s6, 0
    buffer_store_dword v2, v3, s[8:11], 0 offen sc1
    s_waitcnt lgkmcnt(14)
    v_mfma_f32_16x16x32_bf16 v[192:195], v[96:99], v[16:19], v[192:195]
    v_mfma_f32_16x16x32_bf16 v[196:199], v[96:99], v[20:23], v[196:199]
    ds_read_b64_tr_b16 v[96:97], v54 offset:32768
    s_waitcnt lgkmcnt(13)
    v_mfma_f32_16x16x32_bf16 v[204:207], v[100:103], v[20:23], v[204:207]
    ds_read_b64_tr_b16 v[98:99], v54 offset:33792
    v_mfma_f32_16x16x32_bf16 v[200:203], v[100:103], v[16:19], v[200:203]
    ds_read_b64_tr_b16 v[100:101], v55 offset:32768
    s_waitcnt lgkmcnt(13)
    v_mfma_f32_16x16x32_bf16 v[208:211], v[104:107], v[16:19], v[208:211]
    ds_read_b64_tr_b16 v[102:103], v55 offset:33792
    v_mfma_f32_16x16x32_bf16 v[212:215], v[104:107], v[20:23], v[212:215]
    ds_read_b64_tr_b16 v[104:105], v56 offset:32768
    s_waitcnt lgkmcnt(13)
    v_mfma_f32_16x16x32_bf16 v[220:223], v[108:111], v[20:23], v[220:223]
    ds_read_b64_tr_b16 v[106:107], v56 offset:33792
    v_mfma_f32_16x16x32_bf16 v[216:219], v[108:111], v[16:19], v[216:219]
    ds_read_b64_tr_b16 v[108:109], v57 offset:32768
    s_waitcnt lgkmcnt(13)
    v_mfma_f32_16x16x32_bf16 v[224:227], v[112:115], v[16:19], v[224:227]
    ds_read_b64_tr_b16 v[110:111], v57 offset:33792
    v_mfma_f32_16x16x32_bf16 v[228:231], v[112:115], v[20:23], v[228:231]
    ds_read_b64_tr_b16 v[112:113], v58 offset:32768
    s_waitcnt lgkmcnt(13)
    v_mfma_f32_16x16x32_bf16 v[236:239], v[116:119], v[20:23], v[236:239]
    ds_read_b64_tr_b16 v[114:115], v58 offset:33792
    v_mfma_f32_16x16x32_bf16 v[232:235], v[116:119], v[16:19], v[232:235]
    ds_read_b64_tr_b16 v[116:117], v59 offset:32768
    s_waitcnt lgkmcnt(13)
    v_mfma_f32_16x16x32_bf16 v[240:243], v[120:123], v[16:19], v[240:243]
    ds_read_b64_tr_b16 v[118:119], v59 offset:33792
    v_mfma_f32_16x16x32_bf16 v[244:247], v[120:123], v[20:23], v[244:247]
    ds_read_b64_tr_b16 v[120:121], v60 offset:32768
    s_waitcnt lgkmcnt(13)
    v_mfma_f32_16x16x32_bf16 v[252:255], v[124:127], v[20:23], v[252:255]
    ds_read_b64_tr_b16 v[122:123], v60 offset:33792
    v_mfma_f32_16x16x32_bf16 v[248:251], v[124:127], v[16:19], v[248:251]
    ds_read_b64_tr_b16 v[124:125], v61 offset:32768
    ds_read_b64_tr_b16 v[126:127], v61 offset:33792
    buffer_load_dwordx4 v[16:19], v13, s[8:11], s87 offen offset:2048 sc1
    buffer_load_dwordx4 v[20:23], v12, s[8:11], s87 offen offset:2048 sc1
    s_waitcnt lgkmcnt(14)
    v_mfma_f32_16x16x32_bf16 v[192:195], v[96:99], v[24:27], v[192:195]
    v_mfma_f32_16x16x32_bf16 v[196:199], v[96:99], v[28:31], v[196:199]
    ds_read_b64_tr_b16 v[96:97], v54 offset:40960
    s_waitcnt lgkmcnt(13)
    v_mfma_f32_16x16x32_bf16 v[204:207], v[100:103], v[28:31], v[204:207]
    ds_read_b64_tr_b16 v[98:99], v54 offset:41984
    v_mfma_f32_16x16x32_bf16 v[200:203], v[100:103], v[24:27], v[200:203]
    ds_read_b64_tr_b16 v[100:101], v55 offset:40960
    s_waitcnt lgkmcnt(13)
    v_mfma_f32_16x16x32_bf16 v[208:211], v[104:107], v[24:27], v[208:211]
    ds_read_b64_tr_b16 v[102:103], v55 offset:41984
    v_mfma_f32_16x16x32_bf16 v[212:215], v[104:107], v[28:31], v[212:215]
    ds_read_b64_tr_b16 v[104:105], v56 offset:40960
    s_waitcnt lgkmcnt(13)
    v_mfma_f32_16x16x32_bf16 v[220:223], v[108:111], v[28:31], v[220:223]
    ds_read_b64_tr_b16 v[106:107], v56 offset:41984
    v_mfma_f32_16x16x32_bf16 v[216:219], v[108:111], v[24:27], v[216:219]
    ds_read_b64_tr_b16 v[108:109], v57 offset:40960
    s_waitcnt lgkmcnt(13)
    v_mfma_f32_16x16x32_bf16 v[224:227], v[112:115], v[24:27], v[224:227]
    ds_read_b64_tr_b16 v[110:111], v57 offset:41984
    v_mfma_f32_16x16x32_bf16 v[228:231], v[112:115], v[28:31], v[228:231]
    ds_read_b64_tr_b16 v[112:113], v58 offset:40960
    s_waitcnt lgkmcnt(13)
    v_mfma_f32_16x16x32_bf16 v[236:239], v[116:119], v[28:31], v[236:239]
    ds_read_b64_tr_b16 v[114:115], v58 offset:41984
    v_mfma_f32_16x16x32_bf16 v[232:235], v[116:119], v[24:27], v[232:235]
    ds_read_b64_tr_b16 v[116:117], v59 offset:40960
    s_waitcnt lgkmcnt(13)
    v_mfma_f32_16x16x32_bf16 v[240:243], v[120:123], v[24:27], v[240:243]
    ds_read_b64_tr_b16 v[118:119], v59 offset:41984
    v_mfma_f32_16x16x32_bf16 v[244:247], v[120:123], v[28:31], v[244:247]
    ds_read_b64_tr_b16 v[120:121], v60 offset:40960
    s_waitcnt lgkmcnt(13)
    v_mfma_f32_16x16x32_bf16 v[252:255], v[124:127], v[28:31], v[252:255]
    ds_read_b64_tr_b16 v[122:123], v60 offset:41984
    v_mfma_f32_16x16x32_bf16 v[248:251], v[124:127], v[24:27], v[248:251]
    ds_read_b64_tr_b16 v[124:125], v61 offset:40960
    ds_read_b64_tr_b16 v[126:127], v61 offset:41984
    buffer_load_dwordx4 v[24:27], v13, s[8:11], s87 offen offset:3072 sc1
    buffer_load_dwordx4 v[28:31], v12, s[8:11], s87 offen offset:3072 sc1
    s_waitcnt lgkmcnt(14)
    v_mfma_f32_16x16x32_bf16 v[192:195], v[96:99], v[32:35], v[192:195]
    v_mfma_f32_16x16x32_bf16 v[196:199], v[96:99], v[36:39], v[196:199]
    ds_read_b64_tr_b16 v[96:97], v54 offset:49152
    s_waitcnt lgkmcnt(13)
    v_mfma_f32_16x16x32_bf16 v[204:207], v[100:103], v[36:39], v[204:207]
    ds_read_b64_tr_b16 v[98:99], v54 offset:50176
    v_mfma_f32_16x16x32_bf16 v[200:203], v[100:103], v[32:35], v[200:203]
    ds_read_b64_tr_b16 v[100:101], v55 offset:49152
    s_waitcnt lgkmcnt(13)
    v_mfma_f32_16x16x32_bf16 v[208:211], v[104:107], v[32:35], v[208:211]
    ds_read_b64_tr_b16 v[102:103], v55 offset:50176
    v_mfma_f32_16x16x32_bf16 v[212:215], v[104:107], v[36:39], v[212:215]
    ds_read_b64_tr_b16 v[104:105], v56 offset:49152
    s_waitcnt lgkmcnt(13)
    v_mfma_f32_16x16x32_bf16 v[220:223], v[108:111], v[36:39], v[220:223]
    ds_read_b64_tr_b16 v[106:107], v56 offset:50176
    v_mfma_f32_16x16x32_bf16 v[216:219], v[108:111], v[32:35], v[216:219]
    ds_read_b64_tr_b16 v[108:109], v57 offset:49152
    s_waitcnt lgkmcnt(13)
    v_mfma_f32_16x16x32_bf16 v[224:227], v[112:115], v[32:35], v[224:227]
    ds_read_b64_tr_b16 v[110:111], v57 offset:50176
    v_mfma_f32_16x16x32_bf16 v[228:231], v[112:115], v[36:39], v[228:231]
    ds_read_b64_tr_b16 v[112:113], v58 offset:49152
    s_waitcnt lgkmcnt(13)
    v_mfma_f32_16x16x32_bf16 v[236:239], v[116:119], v[36:39], v[236:239]
    ds_read_b64_tr_b16 v[114:115], v58 offset:50176
    v_mfma_f32_16x16x32_bf16 v[232:235], v[116:119], v[32:35], v[232:235]
    ds_read_b64_tr_b16 v[116:117], v59 offset:49152
    s_waitcnt lgkmcnt(13)
    v_mfma_f32_16x16x32_bf16 v[240:243], v[120:123], v[32:35], v[240:243]
    ds_read_b64_tr_b16 v[118:119], v59 offset:50176
    v_mfma_f32_16x16x32_bf16 v[244:247], v[120:123], v[36:39], v[244:247]
    ds_read_b64_tr_b16 v[120:121], v60 offset:49152
    s_waitcnt lgkmcnt(13)
    v_mfma_f32_16x16x32_bf16 v[252:255], v[124:127], v[36:39], v[252:255]
    ds_read_b64_tr_b16 v[122:123], v60 offset:50176
    v_mfma_f32_16x16x32_bf16 v[248:251], v[124:127], v[32:35], v[248:251]
    ds_read_b64_tr_b16 v[124:125], v61 offset:49152
    ds_read_b64_tr_b16 v[126:127], v61 offset:50176
    buffer_load_dwordx4 v[32:35], v13, s[8:11], s88 offen offset:0 sc1
    buffer_load_dwordx4 v[36:39], v12, s[8:11], s88 offen offset:0 sc1
    s_waitcnt vmcnt(13)
    s_waitcnt lgkmcnt(14)
    v_mfma_f32_16x16x32_bf16 v[192:195], v[96:99], v[64:67], v[192:195]
    v_mfma_f32_16x16x32_bf16 v[196:199], v[96:99], v[68:71], v[196:199]
    ds_read_b64_tr_b16 v[96:97], v54 offset:57344
    s_waitcnt lgkmcnt(13)
    v_mfma_f32_16x16x32_bf16 v[204:207], v[100:103], v[68:71], v[204:207]
    ds_read_b64_tr_b16 v[98:99], v54 offset:58368
    v_mfma_f32_16x16x32_bf16 v[200:203], v[100:103], v[64:67], v[200:203]
    ds_read_b64_tr_b16 v[100:101], v55 offset:57344
    s_waitcnt lgkmcnt(13)
    v_mfma_f32_16x16x32_bf16 v[208:211], v[104:107], v[64:67], v[208:211]
    ds_read_b64_tr_b16 v[102:103], v55 offset:58368
    v_mfma_f32_16x16x32_bf16 v[212:215], v[104:107], v[68:71], v[212:215]
    ds_read_b64_tr_b16 v[104:105], v56 offset:57344
    s_waitcnt lgkmcnt(13)
    v_mfma_f32_16x16x32_bf16 v[220:223], v[108:111], v[68:71], v[220:223]
    ds_read_b64_tr_b16 v[106:107], v56 offset:58368
    v_mfma_f32_16x16x32_bf16 v[216:219], v[108:111], v[64:67], v[216:219]
    ds_read_b64_tr_b16 v[108:109], v57 offset:57344
    s_waitcnt lgkmcnt(13)
    v_mfma_f32_16x16x32_bf16 v[224:227], v[112:115], v[64:67], v[224:227]
    ds_read_b64_tr_b16 v[110:111], v57 offset:58368
    v_mfma_f32_16x16x32_bf16 v[228:231], v[112:115], v[68:71], v[228:231]
    ds_read_b64_tr_b16 v[112:113], v58 offset:57344
    s_waitcnt lgkmcnt(13)
    v_mfma_f32_16x16x32_bf16 v[236:239], v[116:119], v[68:71], v[236:239]
    ds_read_b64_tr_b16 v[114:115], v58 offset:58368
    v_mfma_f32_16x16x32_bf16 v[232:235], v[116:119], v[64:67], v[232:235]
    ds_read_b64_tr_b16 v[116:117], v59 offset:57344
    s_waitcnt lgkmcnt(13)
    v_mfma_f32_16x16x32_bf16 v[240:243], v[120:123], v[64:67], v[240:243]
    ds_read_b64_tr_b16 v[118:119], v59 offset:58368
    v_mfma_f32_16x16x32_bf16 v[244:247], v[120:123], v[68:71], v[244:247]
    ds_read_b64_tr_b16 v[120:121], v60 offset:57344
    s_waitcnt lgkmcnt(13)
    v_mfma_f32_16x16x32_bf16 v[252:255], v[124:127], v[68:71], v[252:255]
    ds_read_b64_tr_b16 v[122:123], v60 offset:58368
    v_mfma_f32_16x16x32_bf16 v[248:251], v[124:127], v[64:67], v[248:251]
    ds_read_b64_tr_b16 v[124:125], v61 offset:57344
    ds_read_b64_tr_b16 v[126:127], v61 offset:58368
    buffer_load_dwordx4 v[64:67], v13, s[8:11], s88 offen offset:1024 sc1
    buffer_load_dwordx4 v[68:71], v12, s[8:11], s88 offen offset:1024 sc1
    s_waitcnt vmcnt(13)
    s_waitcnt lgkmcnt(14)
    v_mfma_f32_16x16x32_bf16 v[192:195], v[96:99], v[72:75], v[192:195]
    v_xor_b32 v54, 0x10000, v54
    v_mfma_f32_16x16x32_bf16 v[196:199], v[96:99], v[76:79], v[196:199]
    s_waitcnt lgkmcnt(12)
    v_mfma_f32_16x16x32_bf16 v[204:207], v[100:103], v[76:79], v[204:207]
    v_xor_b32 v55, 0x10000, v55
    v_mfma_f32_16x16x32_bf16 v[200:203], v[100:103], v[72:75], v[200:203]
    s_waitcnt lgkmcnt(0)
    s_barrier
    ds_read_b64_tr_b16 v[96:97], v54 offset:0
    ds_read_b64_tr_b16 v[98:99], v54 offset:1024
    ds_read_b64_tr_b16 v[100:101], v55 offset:0
    v_mfma_f32_16x16x32_bf16 v[208:211], v[104:107], v[72:75], v[208:211]
    ds_read_b64_tr_b16 v[102:103], v55 offset:1024
    v_xor_b32 v56, 0x10000, v56
    v_mfma_f32_16x16x32_bf16 v[212:215], v[104:107], v[76:79], v[212:215]
    ds_read_b64_tr_b16 v[104:105], v56 offset:0
    v_mfma_f32_16x16x32_bf16 v[220:223], v[108:111], v[76:79], v[220:223]
    ds_read_b64_tr_b16 v[106:107], v56 offset:1024
    v_xor_b32 v57, 0x10000, v57
    v_mfma_f32_16x16x32_bf16 v[216:219], v[108:111], v[72:75], v[216:219]
    ds_read_b64_tr_b16 v[108:109], v57 offset:0
    v_mfma_f32_16x16x32_bf16 v[224:227], v[112:115], v[72:75], v[224:227]
    ds_read_b64_tr_b16 v[110:111], v57 offset:1024
    v_xor_b32 v58, 0x10000, v58
    v_mfma_f32_16x16x32_bf16 v[228:231], v[112:115], v[76:79], v[228:231]
    ds_read_b64_tr_b16 v[112:113], v58 offset:0
    v_mfma_f32_16x16x32_bf16 v[236:239], v[116:119], v[76:79], v[236:239]
    ds_read_b64_tr_b16 v[114:115], v58 offset:1024
    v_xor_b32 v59, 0x10000, v59
    v_mfma_f32_16x16x32_bf16 v[232:235], v[116:119], v[72:75], v[232:235]
    ds_read_b64_tr_b16 v[116:117], v59 offset:0
    v_mfma_f32_16x16x32_bf16 v[240:243], v[120:123], v[72:75], v[240:243]
    ds_read_b64_tr_b16 v[118:119], v59 offset:1024
    v_xor_b32 v60, 0x10000, v60
    v_mfma_f32_16x16x32_bf16 v[244:247], v[120:123], v[76:79], v[244:247]
    ds_read_b64_tr_b16 v[120:121], v60 offset:0
    v_mfma_f32_16x16x32_bf16 v[252:255], v[124:127], v[76:79], v[252:255]
    ds_read_b64_tr_b16 v[122:123], v60 offset:1024
    v_xor_b32 v61, 0x10000, v61
    v_mfma_f32_16x16x32_bf16 v[248:251], v[124:127], v[72:75], v[248:251]
    ds_read_b64_tr_b16 v[124:125], v61 offset:0
    ds_read_b64_tr_b16 v[126:127], v61 offset:1024
    buffer_load_dwordx4 v[72:75], v13, s[8:11], s88 offen offset:2048 sc1
    buffer_load_dwordx4 v[76:79], v12, s[8:11], s88 offen offset:2048 sc1
    s_waitcnt vmcnt(13)
    s_waitcnt lgkmcnt(14)
    v_mfma_f32_16x16x32_bf16 v[192:195], v[96:99], v[80:83], v[192:195]
    v_mfma_f32_16x16x32_bf16 v[196:199], v[96:99], v[84:87], v[196:199]
    ds_read_b64_tr_b16 v[96:97], v54 offset:8192
    s_waitcnt lgkmcnt(13)
    v_mfma_f32_16x16x32_bf16 v[204:207], v[100:103], v[84:87], v[204:207]
    ds_read_b64_tr_b16 v[98:99], v54 offset:9216
    v_mfma_f32_16x16x32_bf16 v[200:203], v[100:103], v[80:83], v[200:203]
    ds_read_b64_tr_b16 v[100:101], v55 offset:8192
    s_waitcnt lgkmcnt(13)
    v_mfma_f32_16x16x32_bf16 v[208:211], v[104:107], v[80:83], v[208:211]
    ds_read_b64_tr_b16 v[102:103], v55 offset:9216
    v_mfma_f32_16x16x32_bf16 v[212:215], v[104:107], v[84:87], v[212:215]
    ds_read_b64_tr_b16 v[104:105], v56 offset:8192
    s_waitcnt lgkmcnt(13)
    v_mfma_f32_16x16x32_bf16 v[220:223], v[108:111], v[84:87], v[220:223]
    ds_read_b64_tr_b16 v[106:107], v56 offset:9216
    v_mfma_f32_16x16x32_bf16 v[216:219], v[108:111], v[80:83], v[216:219]
    ds_read_b64_tr_b16 v[108:109], v57 offset:8192
    s_waitcnt lgkmcnt(13)
    v_mfma_f32_16x16x32_bf16 v[224:227], v[112:115], v[80:83], v[224:227]
    ds_read_b64_tr_b16 v[110:111], v57 offset:9216
    v_mfma_f32_16x16x32_bf16 v[228:231], v[112:115], v[84:87], v[228:231]
    ds_read_b64_tr_b16 v[112:113], v58 offset:8192
    s_waitcnt lgkmcnt(13)
    v_mfma_f32_16x16x32_bf16 v[236:239], v[116:119], v[84:87], v[236:239]
    ds_read_b64_tr_b16 v[114:115], v58 offset:9216
    v_mfma_f32_16x16x32_bf16 v[232:235], v[116:119], v[80:83], v[232:235]
    ds_read_b64_tr_b16 v[116:117], v59 offset:8192
    s_waitcnt lgkmcnt(13)
    v_mfma_f32_16x16x32_bf16 v[240:243], v[120:123], v[80:83], v[240:243]
    ds_read_b64_tr_b16 v[118:119], v59 offset:9216
    v_mfma_f32_16x16x32_bf16 v[244:247], v[120:123], v[84:87], v[244:247]
    ds_read_b64_tr_b16 v[120:121], v60 offset:8192
    s_waitcnt lgkmcnt(13)
    v_mfma_f32_16x16x32_bf16 v[252:255], v[124:127], v[84:87], v[252:255]
    ds_read_b64_tr_b16 v[122:123], v60 offset:9216
    v_mfma_f32_16x16x32_bf16 v[248:251], v[124:127], v[80:83], v[248:251]
    ds_read_b64_tr_b16 v[124:125], v61 offset:8192
    ds_read_b64_tr_b16 v[126:127], v61 offset:9216
    buffer_load_dwordx4 v[80:83], v13, s[8:11], s88 offen offset:3072 sc1
    buffer_load_dwordx4 v[84:87], v12, s[8:11], s88 offen offset:3072 sc1
    s_waitcnt vmcnt(13)
    s_waitcnt lgkmcnt(14)
    v_mfma_f32_16x16x32_bf16 v[192:195], v[96:99], v[88:91], v[192:195]
    v_mfma_f32_16x16x32_bf16 v[196:199], v[96:99], v[92:95], v[196:199]
    ds_read_b64_tr_b16 v[96:97], v54 offset:16384
    s_waitcnt lgkmcnt(13)
    v_mfma_f32_16x16x32_bf16 v[204:207], v[100:103], v[92:95], v[204:207]
    ds_read_b64_tr_b16 v[98:99], v54 offset:17408
    v_mfma_f32_16x16x32_bf16 v[200:203], v[100:103], v[88:91], v[200:203]
    ds_read_b64_tr_b16 v[100:101], v55 offset:16384
    s_waitcnt lgkmcnt(13)
    v_mfma_f32_16x16x32_bf16 v[208:211], v[104:107], v[88:91], v[208:211]
    ds_read_b64_tr_b16 v[102:103], v55 offset:17408
    v_mfma_f32_16x16x32_bf16 v[212:215], v[104:107], v[92:95], v[212:215]
    ds_read_b64_tr_b16 v[104:105], v56 offset:16384
    s_waitcnt lgkmcnt(13)
    v_mfma_f32_16x16x32_bf16 v[220:223], v[108:111], v[92:95], v[220:223]
    ds_read_b64_tr_b16 v[106:107], v56 offset:17408
    v_mfma_f32_16x16x32_bf16 v[216:219], v[108:111], v[88:91], v[216:219]
    ds_read_b64_tr_b16 v[108:109], v57 offset:16384
    s_waitcnt lgkmcnt(13)
    v_mfma_f32_16x16x32_bf16 v[224:227], v[112:115], v[88:91], v[224:227]
    ds_read_b64_tr_b16 v[110:111], v57 offset:17408
    v_mfma_f32_16x16x32_bf16 v[228:231], v[112:115], v[92:95], v[228:231]
    ds_read_b64_tr_b16 v[112:113], v58 offset:16384
    s_waitcnt lgkmcnt(13)
    v_mfma_f32_16x16x32_bf16 v[236:239], v[116:119], v[92:95], v[236:239]
    ds_read_b64_tr_b16 v[114:115], v58 offset:17408
    v_mfma_f32_16x16x32_bf16 v[232:235], v[116:119], v[88:91], v[232:235]
    ds_read_b64_tr_b16 v[116:117], v59 offset:16384
    s_waitcnt lgkmcnt(13)
    v_mfma_f32_16x16x32_bf16 v[240:243], v[120:123], v[88:91], v[240:243]
    ds_read_b64_tr_b16 v[118:119], v59 offset:17408
    v_mfma_f32_16x16x32_bf16 v[244:247], v[120:123], v[92:95], v[244:247]
    ds_read_b64_tr_b16 v[120:121], v60 offset:16384
    s_waitcnt lgkmcnt(13)
    v_mfma_f32_16x16x32_bf16 v[252:255], v[124:127], v[92:95], v[252:255]
    ds_read_b64_tr_b16 v[122:123], v60 offset:17408
    v_mfma_f32_16x16x32_bf16 v[248:251], v[124:127], v[88:91], v[248:251]
    ds_read_b64_tr_b16 v[124:125], v61 offset:16384
    ds_read_b64_tr_b16 v[126:127], v61 offset:17408
    s_waitcnt vmcnt(10)
    s_waitcnt lgkmcnt(14)
    v_mfma_f32_16x16x32_bf16 v[192:195], v[96:99], v[16:19], v[192:195]
    v_mfma_f32_16x16x32_bf16 v[196:199], v[96:99], v[20:23], v[196:199]
    ds_read_b64_tr_b16 v[96:97], v54 offset:24576
    s_waitcnt lgkmcnt(13)
    v_mfma_f32_16x16x32_bf16 v[204:207], v[100:103], v[20:23], v[204:207]
    ds_read_b64_tr_b16 v[98:99], v54 offset:25600
    v_mfma_f32_16x16x32_bf16 v[200:203], v[100:103], v[16:19], v[200:203]
    ds_read_b64_tr_b16 v[100:101], v55 offset:24576
    s_waitcnt lgkmcnt(13)
    v_mfma_f32_16x16x32_bf16 v[208:211], v[104:107], v[16:19], v[208:211]
    ds_read_b64_tr_b16 v[102:103], v55 offset:25600
    v_mfma_f32_16x16x32_bf16 v[212:215], v[104:107], v[20:23], v[212:215]
    ds_read_b64_tr_b16 v[104:105], v56 offset:24576
    s_waitcnt lgkmcnt(13)
    v_mfma_f32_16x16x32_bf16 v[220:223], v[108:111], v[20:23], v[220:223]
    ds_read_b64_tr_b16 v[106:107], v56 offset:25600
    v_mfma_f32_16x16x32_bf16 v[216:219], v[108:111], v[16:19], v[216:219]
    ds_read_b64_tr_b16 v[108:109], v57 offset:24576
    s_waitcnt lgkmcnt(13)
    v_mfma_f32_16x16x32_bf16 v[224:227], v[112:115], v[16:19], v[224:227]
    ds_read_b64_tr_b16 v[110:111], v57 offset:25600
    v_mfma_f32_16x16x32_bf16 v[228:231], v[112:115], v[20:23], v[228:231]
    ds_read_b64_tr_b16 v[112:113], v58 offset:24576
    s_waitcnt lgkmcnt(13)
    v_mfma_f32_16x16x32_bf16 v[236:239], v[116:119], v[20:23], v[236:239]
    ds_read_b64_tr_b16 v[114:115], v58 offset:25600
    v_mfma_f32_16x16x32_bf16 v[232:235], v[116:119], v[16:19], v[232:235]
    ds_read_b64_tr_b16 v[116:117], v59 offset:24576
    s_waitcnt lgkmcnt(13)
    v_mfma_f32_16x16x32_bf16 v[240:243], v[120:123], v[16:19], v[240:243]
    ds_read_b64_tr_b16 v[118:119], v59 offset:25600
    v_mfma_f32_16x16x32_bf16 v[244:247], v[120:123], v[20:23], v[244:247]
    ds_read_b64_tr_b16 v[120:121], v60 offset:24576
    s_waitcnt lgkmcnt(13)
    v_mfma_f32_16x16x32_bf16 v[252:255], v[124:127], v[20:23], v[252:255]
    ds_read_b64_tr_b16 v[122:123], v60 offset:25600
    v_mfma_f32_16x16x32_bf16 v[248:251], v[124:127], v[16:19], v[248:251]
    ds_read_b64_tr_b16 v[124:125], v61 offset:24576
    ds_read_b64_tr_b16 v[126:127], v61 offset:25600
    s_waitcnt vmcnt(8)
    s_waitcnt lgkmcnt(14)
    v_mfma_f32_16x16x32_bf16 v[192:195], v[96:99], v[24:27], v[192:195]
    v_mfma_f32_16x16x32_bf16 v[196:199], v[96:99], v[28:31], v[196:199]
    ds_read_b64_tr_b16 v[96:97], v54 offset:32768
    s_waitcnt lgkmcnt(13)
    v_mfma_f32_16x16x32_bf16 v[204:207], v[100:103], v[28:31], v[204:207]
    ds_read_b64_tr_b16 v[98:99], v54 offset:33792
    v_mfma_f32_16x16x32_bf16 v[200:203], v[100:103], v[24:27], v[200:203]
    ds_read_b64_tr_b16 v[100:101], v55 offset:32768
    s_waitcnt lgkmcnt(13)
    v_mfma_f32_16x16x32_bf16 v[208:211], v[104:107], v[24:27], v[208:211]
    ds_read_b64_tr_b16 v[102:103], v55 offset:33792
    v_mfma_f32_16x16x32_bf16 v[212:215], v[104:107], v[28:31], v[212:215]
    ds_read_b64_tr_b16 v[104:105], v56 offset:32768
    s_waitcnt lgkmcnt(13)
    v_mfma_f32_16x16x32_bf16 v[220:223], v[108:111], v[28:31], v[220:223]
    ds_read_b64_tr_b16 v[106:107], v56 offset:33792
    v_mfma_f32_16x16x32_bf16 v[216:219], v[108:111], v[24:27], v[216:219]
    ds_read_b64_tr_b16 v[108:109], v57 offset:32768
    s_waitcnt lgkmcnt(13)
    v_mfma_f32_16x16x32_bf16 v[224:227], v[112:115], v[24:27], v[224:227]
    ds_read_b64_tr_b16 v[110:111], v57 offset:33792
    v_mfma_f32_16x16x32_bf16 v[228:231], v[112:115], v[28:31], v[228:231]
    ds_read_b64_tr_b16 v[112:113], v58 offset:32768
    s_waitcnt lgkmcnt(13)
    v_mfma_f32_16x16x32_bf16 v[236:239], v[116:119], v[28:31], v[236:239]
    ds_read_b64_tr_b16 v[114:115], v58 offset:33792
    v_mfma_f32_16x16x32_bf16 v[232:235], v[116:119], v[24:27], v[232:235]
    ds_read_b64_tr_b16 v[116:117], v59 offset:32768
    s_waitcnt lgkmcnt(13)
    v_mfma_f32_16x16x32_bf16 v[240:243], v[120:123], v[24:27], v[240:243]
    ds_read_b64_tr_b16 v[118:119], v59 offset:33792
    v_mfma_f32_16x16x32_bf16 v[244:247], v[120:123], v[28:31], v[244:247]
    ds_read_b64_tr_b16 v[120:121], v60 offset:32768
    s_waitcnt lgkmcnt(13)
    v_mfma_f32_16x16x32_bf16 v[252:255], v[124:127], v[28:31], v[252:255]
    ds_read_b64_tr_b16 v[122:123], v60 offset:33792
    v_mfma_f32_16x16x32_bf16 v[248:251], v[124:127], v[24:27], v[248:251]
    ds_read_b64_tr_b16 v[124:125], v61 offset:32768
    ds_read_b64_tr_b16 v[126:127], v61 offset:33792
    s_waitcnt vmcnt(0)
    s_cmp_ge_u32 s3, 4
    s_cbranch_scc1 L_q_nold
    s_lshl_b32 s7, s4, 10
    s_add_u32 s7, s7, 3866624
    v_lshrrev_b32 v2, 3, v1
    v_and_b32 v3, 7, v1
    v_lshlrev_b32 v3, 2, v3
    v_lshl_add_u32 v3, v2, 7, v3
    s_mov_b32 s79, 262144
L_poll_7:
    buffer_load_dword v2, v3, s[8:11], s7 offen sc1
    s_waitcnt vmcnt(0)
    v_cmp_gt_u32 vcc, 1, v2
    s_cbranch_vccz L_polldone_8
    s_sleep 2
    s_sub_u32 s79, s79, 1
    s_cmp_lg_u32 s79, 0
    s_cbranch_scc1 L_poll_7
L_polldone_8:
    s_lshl_b32 s6, s76, 13
    s_add_u32 s6, s6, s78
    s_add_u32 m0, s6, 0
    s_add_u32 s7, s77, 0
    buffer_load_dwordx4 v49, s[8:11], s7 offen offset:0 sc1 lds
    buffer_load_dwordx4 v49, s[8:11], s7 offen offset:1024 sc1 lds
    buffer_load_dwordx4 v49, s[8:11], s7 offen offset:2048 sc1 lds
    buffer_load_dwordx4 v49, s[8:11], s7 offen offset:3072 sc1 lds
    s_lshl_b32 s6, s76, 13
    s_add_u32 s6, s6, s78
    s_add_u32 m0, s6, 4096
    s_add_u32 s7, s77, 4096
    buffer_load_dwordx4 v49, s[8:11], s7 offen offset:0 sc1 lds
    buffer_load_dwordx4 v49, s[8:11], s7 offen offset:1024 sc1 lds
    buffer_load_dwordx4 v49, s[8:11], s7 offen offset:2048 sc1 lds
    buffer_load_dwordx4 v49, s[8:11], s7 offen offset:3072 sc1 lds
    s_lshl_b32 s6, s76, 12
    s_add_u32 s6, s6, s78
    s_add_u32 m0, s6, 49152
    s_add_u32 s7, s77, 524288
    buffer_load_dwordx4 v50, s[8:11], s7 offen offset:0 sc1 lds
    buffer_load_dwordx4 v50, s[8:11], s7 offen offset:1024 sc1 lds
    buffer_load_dwordx4 v50, s[8:11], s7 offen offset:2048 sc1 lds
    buffer_load_dwordx4 v50, s[8:11], s7 offen offset:3072 sc1 lds
L_q_nold:
    s_waitcnt lgkmcnt(14)
    v_mfma_f32_16x16x32_bf16 v[192:195], v[96:99], v[32:35], v[192:195]
    v_mfma_f32_16x16x32_bf16 v[196:199], v[96:99], v[36:39], v[196:199]
    ds_read_b64_tr_b16 v[96:97], v54 offset:40960
    s_waitcnt lgkmcnt(13)
    v_mfma_f32_16x16x32_bf16 v[204:207], v[100:103], v[36:39], v[204:207]
    ds_read_b64_tr_b16 v[98:99], v54 offset:41984
    v_mfma_f32_16x16x32_bf16 v[200:203], v[100:103], v[32:35], v[200:203]
    ds_read_b64_tr_b16 v[100:101], v55 offset:40960
    s_waitcnt lgkmcnt(13)
    v_mfma_f32_16x16x32_bf16 v[208:211], v[104:107], v[32:35], v[208:211]
    ds_read_b64_tr_b16 v[102:103], v55 offset:41984
    v_mfma_f32_16x16x32_bf16 v[212:215], v[104:107], v[36:39], v[212:215]
    ds_read_b64_tr_b16 v[104:105], v56 offset:40960
    s_waitcnt lgkmcnt(13)
    v_mfma_f32_16x16x32_bf16 v[220:223], v[108:111], v[36:39], v[220:223]
    ds_read_b64_tr_b16 v[106:107], v56 offset:41984
    buffer_store_dwordx4 v[144:147], v13, s[8:11], s67 offen sc1
    s_add_u32 s67, s67, 1024
    v_mfma_f32_16x16x32_bf16 v[216:219], v[108:111], v[32:35], v[216:219]
    ds_read_b64_tr_b16 v[108:109], v57 offset:40960
    s_waitcnt lgkmcnt(13)
    v_mfma_f32_16x16x32_bf16 v[224:227], v[112:115], v[32:35], v[224:227]
    ds_read_b64_tr_b16 v[110:111], v57 offset:41984
    v_mfma_f32_16x16x32_bf16 v[228:231], v[112:115], v[36:39], v[228:231]
    ds_read_b64_tr_b16 v[112:113], v58 offset:40960
    s_waitcnt lgkmcnt(13)
    v_mfma_f32_16x16x32_bf16 v[236:239], v[116:119], v[36:39], v[236:239]
    ds_read_b64_tr_b16 v[114:115], v58 offset:41984
    v_mfma_f32_16x16x32_bf16 v[232:235], v[116:119], v[32:35], v[232:235]
    ds_read_b64_tr_b16 v[116:117], v59 offset:40960
    s_waitcnt lgkmcnt(13)
    v_mfma_f32_16x16x32_bf16 v[240:243], v[120:123], v[32:35], v[240:243]
    ds_read_b64_tr_b16 v[118:119], v59 offset:41984
    v_mfma_f32_16x16x32_bf16 v[244:247], v[120:123], v[36:39], v[244:247]
    ds_read_b64_tr_b16 v[120:121], v60 offset:40960
    s_waitcnt lgkmcnt(13)
    v_mfma_f32_16x16x32_bf16 v[252:255], v[124:127], v[36:39], v[252:255]
    ds_read_b64_tr_b16 v[122:123], v60 offset:41984
    v_mfma_f32_16x16x32_bf16 v[248:251], v[124:127], v[32:35], v[248:251]
    ds_read_b64_tr_b16 v[124:125], v61 offset:40960
    ds_read_b64_tr_b16 v[126:127], v61 offset:41984
    s_waitcnt lgkmcnt(14)
    v_mfma_f32_16x16x32_bf16 v[192:195], v[96:99], v[64:67], v[192:195]
    v_mfma_f32_16x16x32_bf16 v[196:199], v[96:99], v[68:71], v[196:199]
    ds_read_b64_tr_b16 v[96:97], v54 offset:49152
    s_waitcnt lgkmcnt(13)
    v_mfma_f32_16x16x32_bf16 v[204:207], v[100:103], v[68:71], v[204:207]
    ds_read_b64_tr_b16 v[98:99], v54 offset:50176
    v_mfma_f32_16x16x32_bf16 v[200:203], v[100:103], v[64:67], v[200:203]
    ds_read_b64_tr_b16 v[100:101], v55 offset:49152
    s_waitcnt lgkmcnt(13)
    v_mfma_f32_16x16x32_bf16 v[208:211], v[104:107], v[64:67], v[208:211]
    ds_read_b64_tr_b16 v[102:103], v55 offset:50176
    v_mfma_f32_16x16x32_bf16 v[212:215], v[104:107], v[68:71], v[212:215]
    ds_read_b64_tr_b16 v[104:105], v56 offset:49152
    s_waitcnt lgkmcnt(13)
    v_mfma_f32_16x16x32_bf16 v[220:223], v[108:111], v[68:71], v[220:223]
    ds_read_b64_tr_b16 v[106:107], v56 offset:50176
    buffer_store_dwordx4 v[148:151], v13, s[8:11], s67 offen sc1
    s_add_u32 s67, s67, s68
    v_mfma_f32_16x16x32_bf16 v[216:219], v[108:111], v[64:67], v[216:219]
    ds_read_b64_tr_b16 v[108:109], v57 offset:49152
    s_waitcnt lgkmcnt(13)
    v_mfma_f32_16x16x32_bf16 v[224:227], v[112:115], v[64:67], v[224:227]
    ds_read_b64_tr_b16 v[110:111], v57 offset:50176
    v_mfma_f32_16x16x32_bf16 v[228:231], v[112:115], v[68:71], v[228:231]
    ds_read_b64_tr_b16 v[112:113], v58 offset:49152
    s_waitcnt lgkmcnt(13)
    v_mfma_f32_16x16x32_bf16 v[236:239], v[116:119], v[68:71], v[236:239]
    ds_read_b64_tr_b16 v[114:115], v58 offset:50176
    v_mfma_f32_16x16x32_bf16 v[232:235], v[116:119], v[64:67], v[232:235]
    ds_read_b64_tr_b16 v[116:117], v59 offset:49152
    s_waitcnt lgkmcnt(13)
    v_mfma_f32_16x16x32_bf16 v[240:243], v[120:123], v[64:67], v[240:243]
    ds_read_b64_tr_b16 v[118:119], v59 offset:50176
    v_mfma_f32_16x16x32_bf16 v[244:247], v[120:123], v[68:71], v[244:247]
    ds_read_b64_tr_b16 v[120:121], v60 offset:49152
    s_waitcnt lgkmcnt(13)
    v_mfma_f32_16x16x32_bf16 v[252:255], v[124:127], v[68:71], v[252:255]
    ds_read_b64_tr_b16 v[122:123], v60 offset:50176
    v_mfma_f32_16x16x32_bf16 v[248:251], v[124:127], v[64:67], v[248:251]
    ds_read_b64_tr_b16 v[124:125], v61 offset:49152
    ds_read_b64_tr_b16 v[126:127], v61 offset:50176
    s_waitcnt lgkmcnt(14)
    v_mfma_f32_16x16x32_bf16 v[192:195], v[96:99], v[72:75], v[192:195]
    v_mfma_f32_16x16x32_bf16 v[196:199], v[96:99], v[76:79], v[196:199]
    ds_read_b64_tr_b16 v[96:97], v54 offset:57344
    s_waitcnt lgkmcnt(13)
    v_mfma_f32_16x16x32_bf16 v[204:207], v[100:103], v[76:79], v[204:207]
    ds_read_b64_tr_b16 v[98:99], v54 offset:58368
    v_mfma_f32_16x16x32_bf16 v[200:203], v[100:103], v[72:75], v[200:203]
    ds_read_b64_tr_b16 v[100:101], v55 offset:57344
    s_waitcnt lgkmcnt(13)
    v_mfma_f32_16x16x32_bf16 v[208:211], v[104:107], v[72:75], v[208:211]
    ds_read_b64_tr_b16 v[102:103], v55 offset:58368
    v_mfma_f32_16x16x32_bf16 v[212:215], v[104:107], v[76:79], v[212:215]
    ds_read_b64_tr_b16 v[104:105], v56 offset:57344
    s_waitcnt lgkmcnt(13)
    v_mfma_f32_16x16x32_bf16 v[220:223], v[108:111], v[76:79], v[220:223]
    ds_read_b64_tr_b16 v[106:107], v56 offset:58368
    buffer_store_dwordx4 v[152:155], v13, s[8:11], s67 offen sc1
    s_add_u32 s67, s67, 1024
    v_mfma_f32_16x16x32_bf16 v[216:219], v[108:111], v[72:75], v[216:219]
    ds_read_b64_tr_b16 v[108:109], v57 offset:57344
    s_waitcnt lgkmcnt(13)
    v_mfma_f32_16x16x32_bf16 v[224:227], v[112:115], v[72:75], v[224:227]
    ds_read_b64_tr_b16 v[110:111], v57 offset:58368
    v_mfma_f32_16x16x32_bf16 v[228:231], v[112:115], v[76:79], v[228:231]
    ds_read_b64_tr_b16 v[112:113], v58 offset:57344
    s_waitcnt lgkmcnt(13)
    v_mfma_f32_16x16x32_bf16 v[236:239], v[116:119], v[76:79], v[236:239]
    ds_read_b64_tr_b16 v[114:115], v58 offset:58368
    v_mfma_f32_16x16x32_bf16 v[232:235], v[116:119], v[72:75], v[232:235]
    ds_read_b64_tr_b16 v[116:117], v59 offset:57344
    s_waitcnt lgkmcnt(13)
    v_mfma_f32_16x16x32_bf16 v[240:243], v[120:123], v[72:75], v[240:243]
    ds_read_b64_tr_b16 v[118:119], v59 offset:58368
    v_mfma_f32_16x16x32_bf16 v[244:247], v[120:123], v[76:79], v[244:247]
    ds_read_b64_tr_b16 v[120:121], v60 offset:57344
    s_waitcnt lgkmcnt(13)
    v_mfma_f32_16x16x32_bf16 v[252:255], v[124:127], v[76:79], v[252:255]
    ds_read_b64_tr_b16 v[122:123], v60 offset:58368
    v_mfma_f32_16x16x32_bf16 v[248:251], v[124:127], v[72:75], v[248:251]
    ds_read_b64_tr_b16 v[124:125], v61 offset:57344
    ds_read_b64_tr_b16 v[126:127], v61 offset:58368
    s_waitcnt lgkmcnt(14)
    v_mfma_f32_16x16x32_bf16 v[192:195], v[96:99], v[80:83], v[192:195]
    v_mfma_f32_16x16x32_bf16 v[196:199], v[96:99], v[84:87], v[196:199]
    s_waitcnt lgkmcnt(12)
    v_mfma_f32_16x16x32_bf16 v[204:207], v[100:103], v[84:87], v[204:207]
    v_mfma_f32_16x16x32_bf16 v[200:203], v[100:103], v[80:83], v[200:203]
    s_waitcnt lgkmcnt(10)
    v_mfma_f32_16x16x32_bf16 v[208:211], v[104:107], v[80:83], v[208:211]
    v_mfma_f32_16x16x32_bf16 v[212:215], v[104:107], v[84:87], v[212:215]
    s_waitcnt lgkmcnt(8)
    v_mfma_f32_16x16x32_bf16 v[220:223], v[108:111], v[84:87], v[220:223]
    buffer_store_dwordx4 v[156:159], v13, s[8:11], s67 offen sc1
    s_add_u32 s67, s67, s69
    v_mfma_f32_16x16x32_bf16 v[216:219], v[108:111], v[80:83], v[216:219]
    s_waitcnt lgkmcnt(6)
    v_mfma_f32_16x16x32_bf16 v[224:227], v[112:115], v[80:83], v[224:227]
    v_mfma_f32_16x16x32_bf16 v[228:231], v[112:115], v[84:87], v[228:231]
    s_waitcnt lgkmcnt(4)
    v_mfma_f32_16x16x32_bf16 v[236:239], v[116:119], v[84:87], v[236:239]
    v_mfma_f32_16x16x32_bf16 v[232:235], v[116:119], v[80:83], v[232:235]
    s_waitcnt lgkmcnt(2)
    v_mfma_f32_16x16x32_bf16 v[240:243], v[120:123], v[80:83], v[240:243]
    v_mfma_f32_16x16x32_bf16 v[244:247], v[120:123], v[84:87], v[244:247]
    s_waitcnt lgkmcnt(0)
    v_mfma_f32_16x16x32_bf16 v[252:255], v[124:127], v[84:87], v[252:255]
    v_mfma_f32_16x16x32_bf16 v[248:251], v[124:127], v[80:83], v[248:251]
    s_cmp_lt_u32 s3, 4
    s_cbranch_scc1 L_qb
    s_barrier
L_qb:
    s_mov_b32 s6, 0x3e0293ee
    s_nop 7
    buffer_store_dwordx4 v[160:163], v13, s[8:11], s67 offen sc1
    s_add_u32 s67, s67, 1024
    buffer_store_dwordx4 v[164:167], v13, s[8:11], s67 offen sc1
    s_add_u32 s67, s67, s68
    buffer_store_dwordx4 v[168:171], v13, s[8:11], s67 offen sc1
    s_add_u32 s67, s67, 1024
    buffer_store_dwordx4 v[172:175], v13, s[8:11], s67 offen sc1
    s_add_u32 s67, s67, s69
    v_mul_f32 v192, s6, v192
    v_mul_f32 v193, s6, v193
    v_mul_f32 v194, s6, v194
    v_mul_f32 v195, s6, v195
    v_cvt_pk_bf16_f32 v16, v192, v193
    v_cvt_pk_bf16_f32 v17, v194, v195
    v_mul_f32 v200, s6, v200
    v_mul_f32 v201, s6, v201
    v_mul_f32 v202, s6, v202
    v_mul_f32 v203, s6, v203
    v_cvt_pk_bf16_f32 v18, v200, v201
    v_cvt_pk_bf16_f32 v19, v202, v203
    v_mul_f32 v208, s6, v208
    v_mul_f32 v209, s6, v209
    v_mul_f32 v210, s6, v210
    v_mul_f32 v211, s6, v211
    v_cvt_pk_bf16_f32 v20, v208, v209
    v_cvt_pk_bf16_f32 v21, v210, v211
    v_mul_f32 v216, s6, v216
    v_mul_f32 v217, s6, v217
    v_mul_f32 v218, s6, v218
    v_mul_f32 v219, s6, v219
    v_cvt_pk_bf16_f32 v22, v216, v217
    v_cvt_pk_bf16_f32 v23, v218, v219
    v_mul_f32 v224, s6, v224
    v_mul_f32 v225, s6, v225
    v_mul_f32 v226, s6, v226
    v_mul_f32 v227, s6, v227
    v_cvt_pk_bf16_f32 v24, v224, v225
    v_cvt_pk_bf16_f32 v25, v226, v227
    v_mul_f32 v232, s6, v232
    v_mul_f32 v233, s6, v233
    v_mul_f32 v234, s6, v234
    v_mul_f32 v235, s6, v235
    v_cvt_pk_bf16_f32 v26, v232, v233
    v_cvt_pk_bf16_f32 v27, v234, v235
    v_mul_f32 v240, s6, v240
    v_mul_f32 v241, s6, v241
    v_mul_f32 v242, s6, v242
    v_mul_f32 v243, s6, v243
    v_cvt_pk_bf16_f32 v28, v240, v241
    v_cvt_pk_bf16_f32 v29, v242, v243
    v_mul_f32 v248, s6, v248
    v_mul_f32 v249, s6, v249
    v_mul_f32 v250, s6, v250
    v_mul_f32 v251, s6, v251
    v_cvt_pk_bf16_f32 v30, v248, v249
    v_cvt_pk_bf16_f32 v31, v250, v251
    v_mul_f32 v196, s6, v196
    v_mul_f32 v197, s6, v197
    v_mul_f32 v198, s6, v198
    v_mul_f32 v199, s6, v199
    v_cvt_pk_bf16_f32 v32, v196, v197
    v_cvt_pk_bf16_f32 v33, v198, v199
    v_mul_f32 v204, s6, v204
    v_mul_f32 v205, s6, v205
    v_mul_f32 v206, s6, v206
    v_mul_f32 v207, s6, v207
    v_cvt_pk_bf16_f32 v34, v204, v205
    v_cvt_pk_bf16_f32 v35, v206, v207
    v_mul_f32 v212, s6, v212
    v_mul_f32 v213, s6, v213
    v_mul_f32 v214, s6, v214
    v_mul_f32 v215, s6, v215
    v_cvt_pk_bf16_f32 v36, v212, v213
    v_cvt_pk_bf16_f32 v37, v214, v215
    v_mul_f32 v220, s6, v220
    v_mul_f32 v221, s6, v221
    v_mul_f32 v222, s6, v222
    v_mul_f32 v223, s6, v223
    v_cvt_pk_bf16_f32 v38, v220, v221
    v_cvt_pk_bf16_f32 v39, v222, v223
    v_mul_f32 v228, s6, v228
    v_mul_f32 v229, s6, v229
    v_mul_f32 v230, s6, v230
    v_mul_f32 v231, s6, v231
    v_cvt_pk_bf16_f32 v40, v228, v229
    v_cvt_pk_bf16_f32 v41, v230, v231
    v_mul_f32 v236, s6, v236
    v_mul_f32 v237, s6, v237
    v_mul_f32 v238, s6, v238
    v_mul_f32 v239, s6, v239
    v_cvt_pk_bf16_f32 v42, v236, v237
    v_cvt_pk_bf16_f32 v43, v238, v239
    v_mul_f32 v244, s6, v244
    v_mul_f32 v245, s6, v245
    v_mul_f32 v246, s6, v246
    v_mul_f32 v247, s6, v247
    v_cvt_pk_bf16_f32 v44, v244, v245
    v_cvt_pk_bf16_f32 v45, v246, v247
    v_mul_f32 v252, s6, v252
    v_mul_f32 v253, s6, v253
    v_mul_f32 v254, s6, v254
    v_mul_f32 v255, s6, v255
    v_cvt_pk_bf16_f32 v46, v252, v253
    v_cvt_pk_bf16_f32 v47, v254, v255
    v_mov_b64 v[192:193], 0
    v_mov_b64 v[194:195], 0
    v_mov_b64 v[196:197], 0
    v_mov_b64 v[198:199], 0
    v_mov_b64 v[200:201], 0
    v_mov_b64 v[202:203], 0
    v_mov_b64 v[204:205], 0
    v_mov_b64 v[206:207], 0
    v_mov_b64 v[208:209], 0
    v_mov_b64 v[210:211], 0
    v_mov_b64 v[212:213], 0
    v_mov_b64 v[214:215], 0
    v_mov_b64 v[216:217], 0
    v_mov_b64 v[218:219], 0
    v_mov_b64 v[220:221], 0
    v_mov_b64 v[222:223], 0
    v_mov_b64 v[224:225], 0
    v_mov_b64 v[226:227], 0
    v_mov_b64 v[228:229], 0
    v_mov_b64 v[230:231], 0
    v_mov_b64 v[232:233], 0
    v_mov_b64 v[234:235], 0
    v_mov_b64 v[236:237], 0
    v_mov_b64 v[238:239], 0
    v_mov_b64 v[240:241], 0
    v_mov_b64 v[242:243], 0
    v_mov_b64 v[244:245], 0
    v_mov_b64 v[246:247], 0
    v_mov_b64 v[248:249], 0
    v_mov_b64 v[250:251], 0
    v_mov_b64 v[252:253], 0
    v_mov_b64 v[254:255], 0
    v_mov_b64 v[144:145], 0
    v_mov_b64 v[146:147], 0
    v_mov_b64 v[148:149], 0
    v_mov_b64 v[150:151], 0
    v_mov_b64 v[152:153], 0
    v_mov_b64 v[154:155], 0
    v_mov_b64 v[156:157], 0
    v_mov_b64 v[158:159], 0
    v_mov_b64 v[160:161], 0
    v_mov_b64 v[162:163], 0
    v_bfe_u32 v2, v1, 1, 1
    v_lshrrev_b32 v3, 5, v1
    v_cmp_eq_u32 vcc, v2, v3
    v_mov_b32 v2, 0x3f803f80
    v_and_b32 v3, 1, v1
    v_mul_u32_u24 v3, 0xaaaa, v3
    v_add_u32 v168, 0x4444, v3
    v_cndmask_b32 v164, 0, v2, vcc
    v_cndmask_b32 v165, 0, v2, vcc
    v_cndmask_b32 v166, 0, v2, vcc
    v_cndmask_b32 v167, 0, v2, vcc
    v_add_u32 v48, s100, v13
    s_waitcnt vmcnt(8)
    s_mov_b32 s72, 0x40004000
    s_mov_b32 s65, 0
    s_sub_u32 s63, 15, s5
    s_mov_b32 s62, -1
    s_cmp_ge_u32 s3, 4
    s_cbranch_scc1 L_qb2
    s_barrier
L_qb2:
    ds_read_b128 v[96:99], v48 offset:0
    ds_read_b128 v[100:103], v48 offset:1024
    ds_read_b128 v[104:107], v48 offset:2048
    ds_read_b128 v[108:111], v48 offset:3072
    ds_read_b128 v[112:115], v48 offset:4096
    ds_read_b128 v[116:119], v48 offset:5120
    ds_read_b128 v[120:123], v48 offset:6144
    ds_read_b128 v[124:127], v48 offset:7168
    s_cmp_lg_u32 s60, 0
    s_cbranch_scc1 L_nm0
    s_call_b64 s[82:83], L_mask
L_nm0:
    s_waitcnt lgkmcnt(7)
    v_mfma_f32_16x16x32_bf16 v[64:67], v[96:99], v[16:19], v[144:147]
    v_mfma_f32_16x16x32_bf16 v[68:71], v[96:99], v[32:35], v[148:151]
    ds_read_b128 v[96:99], v48 offset:8192
    s_waitcnt lgkmcnt(7)
    v_mfma_f32_16x16x32_bf16 v[64:67], v[100:103], v[20:23], v[64:67]
    v_mfma_f32_16x16x32_bf16 v[68:71], v[100:103], v[36:39], v[68:71]
    ds_read_b128 v[100:103], v48 offset:9216
    s_waitcnt lgkmcnt(7)
    v_mfma_f32_16x16x32_bf16 v[64:67], v[104:107], v[24:27], v[64:67]
    v_mfma_f32_16x16x32_bf16 v[68:71], v[104:107], v[40:43], v[68:71]
    ds_read_b128 v[104:107], v48 offset:10240
    s_waitcnt lgkmcnt(7)
    v_mfma_f32_16x16x32_bf16 v[64:67], v[108:111], v[28:31], v[64:67]
    v_mfma_f32_16x16x32_bf16 v[68:71], v[108:111], v[44:47], v[68:71]
    ds_read_b128 v[108:111], v48 offset:11264
    s_waitcnt lgkmcnt(7)
    v_mfma_f32_16x16x32_bf16 v[72:75], v[112:115], v[16:19], v[152:155]
    v_mfma_f32_16x16x32_bf16 v[76:79], v[112:115], v[32:35], v[156:159]
    ds_read_b128 v[112:115], v48 offset:12288
    s_waitcnt lgkmcnt(7)
    v_mfma_f32_16x16x32_bf16 v[72:75], v[116:119], v[20:23], v[72:75]
    v_mfma_f32_16x16x32_bf16 v[76:79], v[116:119], v[36:39], v[76:79]
    ds_read_b128 v[116:119], v48 offset:13312
    s_waitcnt lgkmcnt(7)
    v_mfma_f32_16x16x32_bf16 v[72:75], v[120:123], v[24:27], v[72:75]
    v_mfma_f32_16x16x32_bf16 v[76:79], v[120:123], v[40:43], v[76:79]
    ds_read_b128 v[120:123], v48 offset:14336
    s_waitcnt lgkmcnt(7)
    v_mfma_f32_16x16x32_bf16 v[72:75], v[124:127], v[28:31], v[72:75]
    v_mfma_f32_16x16x32_bf16 v[76:79], v[124:127], v[44:47], v[76:79]
    ds_read_b128 v[124:127], v48 offset:15360
    s_nop 7
    v_max3_f32 v58, v64, v65, v66
    v_max3_f32 v58, v58, v67, v72
    v_max3_f32 v58, v58, v73, v74
    v_max_f32 v58, v58, v75
    v_mov_b32 v60, v58
    s_nop 1
    v_permlane16_swap_b32 v58, v60
    s_nop 1
    v_max_f32 v58, v58, v60
    v_mov_b32 v60, v58
    s_nop 1
    v_permlane32_swap_b32 v58, v60
    s_nop 1
    v_max_f32 v58, v58, v60
    v_add_f32 v58, 0x41c00000, v58
    v_sub_f32 v64, v64, v58
    v_sub_f32 v144, 0, v58
    v_sub_f32 v65, v65, v58
    v_sub_f32 v145, 0, v58
    v_sub_f32 v66, v66, v58
    v_sub_f32 v146, 0, v58
    v_sub_f32 v67, v67, v58
    v_sub_f32 v147, 0, v58
    v_sub_f32 v72, v72, v58
    v_sub_f32 v152, 0, v58
    v_sub_f32 v73, v73, v58
    v_sub_f32 v153, 0, v58
    v_sub_f32 v74, v74, v58
    v_sub_f32 v154, 0, v58
    v_sub_f32 v75, v75, v58
    v_sub_f32 v155, 0, v58
    v_max3_f32 v59, v68, v69, v70
    v_max3_f32 v59, v59, v71, v76
    v_max3_f32 v59, v59, v77, v78
    v_max_f32 v59, v59, v79
    v_mov_b32 v60, v59
    s_nop 1
    v_permlane16_swap_b32 v59, v60
    s_nop 1
    v_max_f32 v59, v59, v60
    v_mov_b32 v60, v59
    s_nop 1
    v_permlane32_swap_b32 v59, v60
    s_nop 1
    v_max_f32 v59, v59, v60
    v_add_f32 v59, 0x41c00000, v59
    v_sub_f32 v68, v68, v59
    v_sub_f32 v148, 0, v59
    v_sub_f32 v69, v69, v59
    v_sub_f32 v149, 0, v59
    v_sub_f32 v70, v70, v59
    v_sub_f32 v150, 0, v59
    v_sub_f32 v71, v71, v59
    v_sub_f32 v151, 0, v59
    v_sub_f32 v76, v76, v59
    v_sub_f32 v156, 0, v59
    v_sub_f32 v77, v77, v59
    v_sub_f32 v157, 0, v59
    v_sub_f32 v78, v78, v59
    v_sub_f32 v158, 0, v59
    v_sub_f32 v79, v79, v59
    v_sub_f32 v159, 0, v59
    s_cmp_lg_u32 s60, 1
    s_cbranch_scc1 L_nm1
    s_call_b64 s[82:83], L_mask
L_nm1:
    v_exp_f32 v58, v64
    v_exp_f32 v59, v65
    s_waitcnt lgkmcnt(7)
    v_mfma_f32_16x16x32_bf16 v[80:83], v[96:99], v[16:19], v[144:147]
    s_waitcnt lgkmcnt(6)
    v_exp_f32 v60, v66
    v_exp_f32 v61, v67
    v_mfma_f32_16x16x32_bf16 v[84:87], v[96:99], v[32:35], v[148:151]
    ds_read_b128 v[96:99], v48 offset:49152
    v_cvt_pk_bf16_f32 v128, v58, v59
    v_cvt_pk_bf16_f32 v129, v60, v61
    v_mfma_f32_16x16x32_bf16 v[84:87], v[100:103], v[36:39], v[84:87]
    s_waitcnt lgkmcnt(6)
    v_exp_f32 v58, v68
    v_exp_f32 v59, v69
    v_mfma_f32_16x16x32_bf16 v[80:83], v[100:103], v[20:23], v[80:83]
    ds_read_b128 v[100:103], v48 offset:50176
    v_cvt_pk_bf16_f32 v132, v58, v59
    v_mfma_f32_16x16x32_bf16 v[80:83], v[104:107], v[24:27], v[80:83]
    s_waitcnt lgkmcnt(6)
    v_exp_f32 v60, v70
    v_exp_f32 v61, v71
    v_mfma_f32_16x16x32_bf16 v[84:87], v[104:107], v[40:43], v[84:87]
    ds_read_b128 v[104:107], v48 offset:51200
    v_cvt_pk_bf16_f32 v133, v60, v61
    v_mfma_f32_16x16x32_bf16 v[84:87], v[108:111], v[44:47], v[84:87]
    s_waitcnt lgkmcnt(6)
    v_exp_f32 v58, v72
    v_exp_f32 v59, v73
    v_mfma_f32_16x16x32_bf16 v[80:83], v[108:111], v[28:31], v[80:83]
    ds_read_b128 v[108:111], v48 offset:52224
    v_cvt_pk_bf16_f32 v130, v58, v59
    v_mfma_f32_16x16x32_bf16 v[88:91], v[112:115], v[16:19], v[152:155]
    s_waitcnt lgkmcnt(6)
    v_exp_f32 v60, v74
    v_exp_f32 v61, v75
    v_mfma_f32_16x16x32_bf16 v[92:95], v[112:115], v[32:35], v[156:159]
    ds_read_b128 v[112:115], v48 offset:53248
    v_cvt_pk_bf16_f32 v131, v60, v61
    v_mfma_f32_16x16x32_bf16 v[92:95], v[116:119], v[36:39], v[92:95]
    s_waitcnt lgkmcnt(6)
    v_exp_f32 v58, v76
    v_exp_f32 v59, v77
    v_mfma_f32_16x16x32_bf16 v[88:91], v[116:119], v[20:23], v[88:91]
    ds_read_b128 v[116:119], v48 offset:54272
    v_cvt_pk_bf16_f32 v134, v58, v59
    v_mfma_f32_16x16x32_bf16 v[88:91], v[120:123], v[24:27], v[88:91]
    s_waitcnt lgkmcnt(6)
    v_exp_f32 v60, v78
    v_exp_f32 v61, v79
    v_mfma_f32_16x16x32_bf16 v[92:95], v[120:123], v[40:43], v[92:95]
    ds_read_b128 v[120:123], v48 offset:55296
    v_cvt_pk_bf16_f32 v135, v60, v61
    v_mfma_f32_16x16x32_bf16 v[92:95], v[124:127], v[44:47], v[92:95]
    s_waitcnt lgkmcnt(6)
    v_or3_b32 v62, v128, v129, v132
    v_or3_b32 v62, v62, v133, v130
    v_or3_b32 v62, v62, v131, v134
    v_bitop3_b32 v62, v62, v135, s72 bitop3:0xa8
    v_cmp_ne_u32 vcc, s65, v62
    v_mfma_f32_16x16x32_bf16 v[88:91], v[124:127], v[28:31], v[88:91]
    ds_read_b128 v[124:127], v48 offset:56320
    s_cbranch_vccnz L_back_9_h
L_back_9:
    s_nop 7
    v_exp_f32 v58, v80
    v_exp_f32 v59, v81
    s_call_b64 s[82:83], L_load
    s_mov_b32 s62, 0
    buffer_store_dwordx4 v[176:179], v13, s[8:11], s67 offen sc1
    s_add_u32 s67, s67, 1024
    buffer_store_dwordx4 v[180:183], v13, s[8:11], s67 offen sc1
    s_add_u32 s67, s67, s68
    buffer_store_dwordx4 v[184:187], v13, s[8:11], s67 offen sc1
    s_add_u32 s67, s67, 1024
    buffer_store_dwordx4 v[188:191], v13, s[8:11], s67 offen sc1
    s_add_u32 s67, s67, s69
    s_sub_i32 s64, s60, 2
    s_cmp_eq_u32 s60, 0
    s_cbranch_scc1 L_pv2
    s_cmp_eq_u32 s60, 1
    s_cbranch_scc1 L_tail2
    s_cmp_lg_u32 s60, 2
    s_cbranch_scc1 L_st2
    s_call_b64 s[82:83], L_mask
    s_branch L_st2
.p2align 6
L_st0:
    v_mfma_f32_16x16x32_bf16 v[192:195], v[96:99], v[128:131], v[192:195]
    s_waitcnt lgkmcnt(6)
    v_exp_f32 v60, v82
    v_mfma_f32_16x16x32_bf16 v[196:199], v[96:99], v[132:135], v[196:199]
    ds_read_b128 v[96:99], v48 offset:0
    v_cvt_pk_bf16_f32 v136, v58, v59
    v_mfma_f32_16x16x32_bf16 v[204:207], v[100:103], v[132:135], v[204:207]
    s_waitcnt lgkmcnt(6)
    v_exp_f32 v61, v83
    v_mfma_f32_16x16x32_bf16 v[200:203], v[100:103], v[128:131], v[200:203]
    s_sub_i32 s64, s64, 1
    ds_read_b128 v[100:103], v48 offset:1024
    v_cvt_pk_bf16_f32 v137, v60, v61
    v_mfma_f32_16x16x32_bf16 v[208:211], v[104:107], v[128:131], v[208:211]
    s_waitcnt lgkmcnt(6)
    v_exp_f32 v58, v84
    v_mfma_f32_16x16x32_bf16 v[212:215], v[104:107], v[132:135], v[212:215]
    ds_read_b128 v[104:107], v48 offset:2048
    v_mfma_f32_16x16x32_bf16 v[220:223], v[108:111], v[132:135], v[220:223]
    s_waitcnt lgkmcnt(6)
    v_exp_f32 v59, v85
    v_mfma_f32_16x16x32_bf16 v[216:219], v[108:111], v[128:131], v[216:219]
    s_cmp_gt_i32 s64, 0
    ds_read_b128 v[108:111], v48 offset:3072
    v_cvt_pk_bf16_f32 v140, v58, v59
    v_mfma_f32_16x16x32_bf16 v[224:227], v[112:115], v[128:131], v[224:227]
    s_waitcnt lgkmcnt(6)
    v_exp_f32 v60, v86
    v_mfma_f32_16x16x32_bf16 v[228:231], v[112:115], v[132:135], v[228:231]
    ds_read_b128 v[112:115], v48 offset:4096
    v_or3_b32 v62, v136, v137, v140
    v_mfma_f32_16x16x32_bf16 v[236:239], v[116:119], v[132:135], v[236:239]
    s_waitcnt lgkmcnt(6)
    v_exp_f32 v61, v87
    v_mfma_f32_16x16x32_bf16 v[232:235], v[116:119], v[128:131], v[232:235]
    s_cselect_b32 s65, 0, 1
    ds_read_b128 v[116:119], v48 offset:5120
    v_cvt_pk_bf16_f32 v141, v60, v61
    v_mfma_f32_16x16x32_bf16 v[240:243], v[120:123], v[128:131], v[240:243]
    s_waitcnt lgkmcnt(6)
    v_exp_f32 v58, v88
    v_mfma_f32_16x16x32_bf16 v[244:247], v[120:123], v[132:135], v[244:247]
    ds_read_b128 v[120:123], v48 offset:6144
    v_mfma_f32_16x16x32_bf16 v[252:255], v[124:127], v[132:135], v[252:255]
    s_waitcnt lgkmcnt(6)
    v_exp_f32 v59, v89
    v_mfma_f32_16x16x32_bf16 v[248:251], v[124:127], v[128:131], v[248:251]
    ds_read_b128 v[124:127], v48 offset:7168
    v_cvt_pk_bf16_f32 v138, v58, v59
    v_mfma_f32_16x16x32_bf16 v[64:67], v[96:99], v[16:19], v[144:147]
    s_waitcnt lgkmcnt(6)
    v_exp_f32 v60, v90
    v_mfma_f32_16x16x32_bf16 v[68:71], v[96:99], v[32:35], v[148:151]
    ds_read_b128 v[96:99], v48 offset:40960
    v_or3_b32 v62, v62, v141, v138
    v_mfma_f32_16x16x32_bf16 v[68:71], v[100:103], v[36:39], v[68:71]
    s_waitcnt lgkmcnt(6)
    v_exp_f32 v61, v91
    v_mfma_f32_16x16x32_bf16 v[64:67], v[100:103], v[20:23], v[64:67]
    ds_read_b128 v[100:103], v48 offset:41984
    v_cvt_pk_bf16_f32 v139, v60, v61
    v_mfma_f32_16x16x32_bf16 v[64:67], v[104:107], v[24:27], v[64:67]
    s_waitcnt lgkmcnt(6)
    v_exp_f32 v58, v92
    v_mfma_f32_16x16x32_bf16 v[68:71], v[104:107], v[40:43], v[68:71]
    ds_read_b128 v[104:107], v48 offset:43008
    v_mfma_f32_16x16x32_bf16 v[68:71], v[108:111], v[44:47], v[68:71]
    s_waitcnt lgkmcnt(6)
    v_exp_f32 v59, v93
    v_mfma_f32_16x16x32_bf16 v[64:67], v[108:111], v[28:31], v[64:67]
    ds_read_b128 v[108:111], v48 offset:44032
    v_cvt_pk_bf16_f32 v142, v58, v59
    v_mfma_f32_16x16x32_bf16 v[72:75], v[112:115], v[16:19], v[152:155]
    s_waitcnt lgkmcnt(6)
    v_exp_f32 v60, v94
    v_mfma_f32_16x16x32_bf16 v[76:79], v[112:115], v[32:35], v[156:159]
    ds_read_b128 v[112:115], v48 offset:45056
    v_or3_b32 v62, v62, v139, v142
    v_mfma_f32_16x16x32_bf16 v[76:79], v[116:119], v[36:39], v[76:79]
    s_waitcnt lgkmcnt(6)
    v_exp_f32 v61, v95
    v_mfma_f32_16x16x32_bf16 v[72:75], v[116:119], v[20:23], v[72:75]
    ds_read_b128 v[116:119], v48 offset:46080
    v_cvt_pk_bf16_f32 v143, v60, v61
    v_smfmac_f32_16x16x64_bf16 v[160:163], v[164:167], v[128:135], v168
    v_bitop3_b32 v62, v62, v143, s72 bitop3:0xa8
    v_mfma_f32_16x16x32_bf16 v[72:75], v[120:123], v[24:27], v[72:75]
    s_waitcnt lgkmcnt(6)
    v_exp_f32 v58, v64
    v_mfma_f32_16x16x32_bf16 v[76:79], v[120:123], v[40:43], v[76:79]
    ds_read_b128 v[120:123], v48 offset:47104
    v_cmp_ne_u32 vcc, s65, v62
    v_mfma_f32_16x16x32_bf16 v[76:79], v[124:127], v[44:47], v[76:79]
    s_waitcnt lgkmcnt(6)
    v_exp_f32 v59, v65
    v_mfma_f32_16x16x32_bf16 v[72:75], v[124:127], v[28:31], v[72:75]
    ds_read_b128 v[124:127], v48 offset:48128
    s_cbranch_vccnz L_back_10_h
L_back_10:
    v_mfma_f32_16x16x32_bf16 v[192:195], v[96:99], v[136:139], v[192:195]
    s_waitcnt lgkmcnt(6)
    v_exp_f32 v60, v66
    v_mfma_f32_16x16x32_bf16 v[196:199], v[96:99], v[140:143], v[196:199]
    ds_read_b128 v[96:99], v48 offset:8192
    v_cvt_pk_bf16_f32 v128, v58, v59
    v_mfma_f32_16x16x32_bf16 v[204:207], v[100:103], v[140:143], v[204:207]
    s_waitcnt lgkmcnt(6)
    v_exp_f32 v61, v67
    v_mfma_f32_16x16x32_bf16 v[200:203], v[100:103], v[136:139], v[200:203]
    s_sub_i32 s64, s64, 1
    ds_read_b128 v[100:103], v48 offset:9216
    v_cvt_pk_bf16_f32 v129, v60, v61
    v_mfma_f32_16x16x32_bf16 v[208:211], v[104:107], v[136:139], v[208:211]
    s_waitcnt lgkmcnt(6)
    v_exp_f32 v58, v68
    v_mfma_f32_16x16x32_bf16 v[212:215], v[104:107], v[140:143], v[212:215]
    ds_read_b128 v[104:107], v48 offset:10240
    v_mfma_f32_16x16x32_bf16 v[220:223], v[108:111], v[140:143], v[220:223]
    s_waitcnt lgkmcnt(6)
    v_exp_f32 v59, v69
    v_mfma_f32_16x16x32_bf16 v[216:219], v[108:111], v[136:139], v[216:219]
    s_cmp_gt_i32 s64, 0
    ds_read_b128 v[108:111], v48 offset:11264
    v_cvt_pk_bf16_f32 v132, v58, v59
    v_mfma_f32_16x16x32_bf16 v[224:227], v[112:115], v[136:139], v[224:227]
    s_waitcnt lgkmcnt(6)
    v_exp_f32 v60, v70
    v_mfma_f32_16x16x32_bf16 v[228:231], v[112:115], v[140:143], v[228:231]
    ds_read_b128 v[112:115], v48 offset:12288
    v_or3_b32 v62, v128, v129, v132
    v_mfma_f32_16x16x32_bf16 v[236:239], v[116:119], v[140:143], v[236:239]
    s_waitcnt lgkmcnt(6)
    v_exp_f32 v61, v71
    v_mfma_f32_16x16x32_bf16 v[232:235], v[116:119], v[136:139], v[232:235]
    s_cselect_b32 s65, 0, 1
    ds_read_b128 v[116:119], v48 offset:13312
    v_cvt_pk_bf16_f32 v133, v60, v61
    v_mfma_f32_16x16x32_bf16 v[240:243], v[120:123], v[136:139], v[240:243]
    s_waitcnt lgkmcnt(6)
    v_exp_f32 v58, v72
    v_mfma_f32_16x16x32_bf16 v[244:247], v[120:123], v[140:143], v[244:247]
    ds_read_b128 v[120:123], v48 offset:14336
    v_mfma_f32_16x16x32_bf16 v[252:255], v[124:127], v[140:143], v[252:255]
    s_waitcnt lgkmcnt(6)
    v_exp_f32 v59, v73
    v_mfma_f32_16x16x32_bf16 v[248:251], v[124:127], v[136:139], v[248:251]
    ds_read_b128 v[124:127], v48 offset:15360
    v_cvt_pk_bf16_f32 v130, v58, v59
    v_mfma_f32_16x16x32_bf16 v[80:83], v[96:99], v[16:19], v[144:147]
    s_waitcnt lgkmcnt(6)
    v_exp_f32 v60, v74
    v_mfma_f32_16x16x32_bf16 v[84:87], v[96:99], v[32:35], v[148:151]
    ds_read_b128 v[96:99], v48 offset:49152
    v_or3_b32 v62, v62, v133, v130
    v_mfma_f32_16x16x32_bf16 v[84:87], v[100:103], v[36:39], v[84:87]
    s_waitcnt lgkmcnt(6)
    v_exp_f32 v61, v75
    v_mfma_f32_16x16x32_bf16 v[80:83], v[100:103], v[20:23], v[80:83]
    ds_read_b128 v[100:103], v48 offset:50176
    v_cvt_pk_bf16_f32 v131, v60, v61
    v_mfma_f32_16x16x32_bf16 v[80:83], v[104:107], v[24:27], v[80:83]
    s_waitcnt lgkmcnt(6)
    v_exp_f32 v58, v76
    v_mfma_f32_16x16x32_bf16 v[84:87], v[104:107], v[40:43], v[84:87]
    ds_read_b128 v[104:107], v48 offset:51200
    v_mfma_f32_16x16x32_bf16 v[84:87], v[108:111], v[44:47], v[84:87]
    s_waitcnt lgkmcnt(6)
    v_exp_f32 v59, v77
    v_mfma_f32_16x16x32_bf16 v[80:83], v[108:111], v[28:31], v[80:83]
    ds_read_b128 v[108:111], v48 offset:52224
    v_cvt_pk_bf16_f32 v134, v58, v59
    v_mfma_f32_16x16x32_bf16 v[88:91], v[112:115], v[16:19], v[152:155]
    s_waitcnt lgkmcnt(6)
    v_exp_f32 v60, v78
    v_mfma_f32_16x16x32_bf16 v[92:95], v[112:115], v[32:35], v[156:159]
    ds_read_b128 v[112:115], v48 offset:53248
    v_or3_b32 v62, v62, v131, v134
    v_mfma_f32_16x16x32_bf16 v[92:95], v[116:119], v[36:39], v[92:95]
    s_waitcnt lgkmcnt(6)
    v_exp_f32 v61, v79
    v_mfma_f32_16x16x32_bf16 v[88:91], v[116:119], v[20:23], v[88:91]
    ds_read_b128 v[116:119], v48 offset:54272
    v_cvt_pk_bf16_f32 v135, v60, v61
    v_smfmac_f32_16x16x64_bf16 v[160:163], v[164:167], v[136:143], v168
    v_bitop3_b32 v62, v62, v135, s72 bitop3:0xa8
    v_mfma_f32_16x16x32_bf16 v[88:91], v[120:123], v[24:27], v[88:91]
    s_waitcnt lgkmcnt(6)
    v_exp_f32 v58, v80
    v_mfma_f32_16x16x32_bf16 v[92:95], v[120:123], v[40:43], v[92:95]
    ds_read_b128 v[120:123], v48 offset:55296
    v_cmp_ne_u32 vcc, s65, v62
    v_mfma_f32_16x16x32_bf16 v[92:95], v[124:127], v[44:47], v[92:95]
    s_waitcnt lgkmcnt(6)
    v_exp_f32 v59, v81
    v_mfma_f32_16x16x32_bf16 v[88:91], v[124:127], v[28:31], v[88:91]
    ds_read_b128 v[124:127], v48 offset:56320
    s_cbranch_vccnz L_back_11_h
L_back_11:
L_st2:
    v_mfma_f32_16x16x32_bf16 v[192:195], v[96:99], v[128:131], v[192:195]
    s_waitcnt lgkmcnt(6)
    v_exp_f32 v60, v82
    v_mfma_f32_16x16x32_bf16 v[196:199], v[96:99], v[132:135], v[196:199]
    ds_read_b128 v[96:99], v48 offset:16384
    v_cvt_pk_bf16_f32 v136, v58, v59
    v_mfma_f32_16x16x32_bf16 v[204:207], v[100:103], v[132:135], v[204:207]
    s_waitcnt lgkmcnt(6)
    v_exp_f32 v61, v83
    v_mfma_f32_16x16x32_bf16 v[200:203], v[100:103], v[128:131], v[200:203]
    s_sub_i32 s64, s64, 1
    ds_read_b128 v[100:103], v48 offset:17408
    v_cvt_pk_bf16_f32 v137, v60, v61
    v_mfma_f32_16x16x32_bf16 v[208:211], v[104:107], v[128:131], v[208:211]
    s_waitcnt lgkmcnt(6)
    v_exp_f32 v58, v84
    v_mfma_f32_16x16x32_bf16 v[212:215], v[104:107], v[132:135], v[212:215]
    ds_read_b128 v[104:107], v48 offset:18432
    v_mfma_f32_16x16x32_bf16 v[220:223], v[108:111], v[132:135], v[220:223]
    s_waitcnt lgkmcnt(6)
    v_exp_f32 v59, v85
    v_mfma_f32_16x16x32_bf16 v[216:219], v[108:111], v[128:131], v[216:219]
    s_cmp_gt_i32 s64, 0
    ds_read_b128 v[108:111], v48 offset:19456
    v_cvt_pk_bf16_f32 v140, v58, v59
    v_mfma_f32_16x16x32_bf16 v[224:227], v[112:115], v[128:131], v[224:227]
    s_waitcnt lgkmcnt(6)
    v_exp_f32 v60, v86
    v_mfma_f32_16x16x32_bf16 v[228:231], v[112:115], v[132:135], v[228:231]
    ds_read_b128 v[112:115], v48 offset:20480
    v_or3_b32 v62, v136, v137, v140
    v_mfma_f32_16x16x32_bf16 v[236:239], v[116:119], v[132:135], v[236:239]
    s_waitcnt lgkmcnt(6)
    v_exp_f32 v61, v87
    v_mfma_f32_16x16x32_bf16 v[232:235], v[116:119], v[128:131], v[232:235]
    s_cselect_b32 s65, 0, 1
    ds_read_b128 v[116:119], v48 offset:21504
    v_cvt_pk_bf16_f32 v141, v60, v61
    v_mfma_f32_16x16x32_bf16 v[240:243], v[120:123], v[128:131], v[240:243]
    s_waitcnt lgkmcnt(6)
    v_exp_f32 v58, v88
    v_mfma_f32_16x16x32_bf16 v[244:247], v[120:123], v[132:135], v[244:247]
    ds_read_b128 v[120:123], v48 offset:22528
    v_mfma_f32_16x16x32_bf16 v[252:255], v[124:127], v[132:135], v[252:255]
    s_waitcnt lgkmcnt(6)
    v_exp_f32 v59, v89
    v_mfma_f32_16x16x32_bf16 v[248:251], v[124:127], v[128:131], v[248:251]
    ds_read_b128 v[124:127], v48 offset:23552
    v_cvt_pk_bf16_f32 v138, v58, v59
    v_mfma_f32_16x16x32_bf16 v[64:67], v[96:99], v[16:19], v[144:147]
    s_waitcnt lgkmcnt(6)
    v_exp_f32 v60, v90
    v_mfma_f32_16x16x32_bf16 v[68:71], v[96:99], v[32:35], v[148:151]
    ds_read_b128 v[96:99], v48 offset:57344
    v_or3_b32 v62, v62, v141, v138
    v_mfma_f32_16x16x32_bf16 v[68:71], v[100:103], v[36:39], v[68:71]
    s_waitcnt lgkmcnt(6)
    v_exp_f32 v61, v91
    v_mfma_f32_16x16x32_bf16 v[64:67], v[100:103], v[20:23], v[64:67]
    ds_read_b128 v[100:103], v48 offset:58368
    v_cvt_pk_bf16_f32 v139, v60, v61
    v_mfma_f32_16x16x32_bf16 v[64:67], v[104:107], v[24:27], v[64:67]
    s_waitcnt lgkmcnt(6)
    v_exp_f32 v58, v92
    v_mfma_f32_16x16x32_bf16 v[68:71], v[104:107], v[40:43], v[68:71]
    ds_read_b128 v[104:107], v48 offset:59392
    v_mfma_f32_16x16x32_bf16 v[68:71], v[108:111], v[44:47], v[68:71]
    s_waitcnt lgkmcnt(6)
    v_exp_f32 v59, v93
    v_mfma_f32_16x16x32_bf16 v[64:67], v[108:111], v[28:31], v[64:67]
    ds_read_b128 v[108:111], v48 offset:60416
    v_cvt_pk_bf16_f32 v142, v58, v59
    v_mfma_f32_16x16x32_bf16 v[72:75], v[112:115], v[16:19], v[152:155]
    s_waitcnt lgkmcnt(6)
    v_exp_f32 v60, v94
    v_mfma_f32_16x16x32_bf16 v[76:79], v[112:115], v[32:35], v[156:159]
    ds_read_b128 v[112:115], v48 offset:61440
    v_or3_b32 v62, v62, v139, v142
    v_mfma_f32_16x16x32_bf16 v[76:79], v[116:119], v[36:39], v[76:79]
    s_waitcnt lgkmcnt(6)
    v_exp_f32 v61, v95
    v_mfma_f32_16x16x32_bf16 v[72:75], v[116:119], v[20:23], v[72:75]
    ds_read_b128 v[116:119], v48 offset:62464
    v_cvt_pk_bf16_f32 v143, v60, v61
    v_smfmac_f32_16x16x64_bf16 v[160:163], v[164:167], v[128:135], v168
    v_bitop3_b32 v62, v62, v143, s72 bitop3:0xa8
    v_mfma_f32_16x16x32_bf16 v[72:75], v[120:123], v[24:27], v[72:75]
    s_waitcnt lgkmcnt(6)
    v_exp_f32 v58, v64
    v_mfma_f32_16x16x32_bf16 v[76:79], v[120:123], v[40:43], v[76:79]
    ds_read_b128 v[120:123], v48 offset:63488
    v_cmp_ne_u32 vcc, s65, v62
    v_mfma_f32_16x16x32_bf16 v[76:79], v[124:127], v[44:47], v[76:79]
    s_waitcnt lgkmcnt(6)
    v_exp_f32 v59, v65
    v_mfma_f32_16x16x32_bf16 v[72:75], v[124:127], v[28:31], v[72:75]
    ds_read_b128 v[124:127], v48 offset:64512
    s_cbranch_vccnz L_back_12_h
L_back_12:
    v_mfma_f32_16x16x32_bf16 v[192:195], v[96:99], v[136:139], v[192:195]
    s_waitcnt lgkmcnt(6)
    v_exp_f32 v60, v66
    v_mfma_f32_16x16x32_bf16 v[196:199], v[96:99], v[140:143], v[196:199]
    ds_read_b128 v[96:99], v48 offset:24576
    v_cvt_pk_bf16_f32 v128, v58, v59
    v_mfma_f32_16x16x32_bf16 v[204:207], v[100:103], v[140:143], v[204:207]
    s_waitcnt lgkmcnt(6)
    v_exp_f32 v61, v67
    v_mfma_f32_16x16x32_bf16 v[200:203], v[100:103], v[136:139], v[200:203]
    s_sub_i32 s64, s64, 1
    ds_read_b128 v[100:103], v48 offset:25600
    v_cvt_pk_bf16_f32 v129, v60, v61
    v_mfma_f32_16x16x32_bf16 v[208:211], v[104:107], v[136:139], v[208:211]
    s_waitcnt lgkmcnt(6)
    v_exp_f32 v58, v68
    v_mfma_f32_16x16x32_bf16 v[212:215], v[104:107], v[140:143], v[212:215]
    ds_read_b128 v[104:107], v48 offset:26624
    v_mfma_f32_16x16x32_bf16 v[220:223], v[108:111], v[140:143], v[220:223]
    s_waitcnt lgkmcnt(6)
    v_exp_f32 v59, v69
    v_mfma_f32_16x16x32_bf16 v[216:219], v[108:111], v[136:139], v[216:219]
    s_cmp_gt_i32 s64, 0
    ds_read_b128 v[108:111], v48 offset:27648
    v_cvt_pk_bf16_f32 v132, v58, v59
    v_mfma_f32_16x16x32_bf16 v[224:227], v[112:115], v[136:139], v[224:227]
    s_waitcnt lgkmcnt(6)
    v_exp_f32 v60, v70
    v_mfma_f32_16x16x32_bf16 v[228:231], v[112:115], v[140:143], v[228:231]
    ds_read_b128 v[112:115], v48 offset:28672
    v_or3_b32 v62, v128, v129, v132
    v_mfma_f32_16x16x32_bf16 v[236:239], v[116:119], v[140:143], v[236:239]
    s_waitcnt lgkmcnt(6)
    v_exp_f32 v61, v71
    v_mfma_f32_16x16x32_bf16 v[232:235], v[116:119], v[136:139], v[232:235]
    s_cselect_b32 s65, 0, 1
    ds_read_b128 v[116:119], v48 offset:29696
    v_cvt_pk_bf16_f32 v133, v60, v61
    v_mfma_f32_16x16x32_bf16 v[240:243], v[120:123], v[136:139], v[240:243]
    s_waitcnt lgkmcnt(6)
    v_exp_f32 v58, v72
    v_mfma_f32_16x16x32_bf16 v[244:247], v[120:123], v[140:143], v[244:247]
    ds_read_b128 v[120:123], v48 offset:30720
    v_mfma_f32_16x16x32_bf16 v[252:255], v[124:127], v[140:143], v[252:255]
    s_waitcnt lgkmcnt(6)
    v_exp_f32 v59, v73
    v_mfma_f32_16x16x32_bf16 v[248:251], v[124:127], v[136:139], v[248:251]
    ds_read_b128 v[124:127], v48 offset:31744
    v_cvt_pk_bf16_f32 v130, v58, v59
    v_mfma_f32_16x16x32_bf16 v[80:83], v[96:99], v[16:19], v[144:147]
    s_waitcnt lgkmcnt(6)
    v_exp_f32 v60, v74
    v_mfma_f32_16x16x32_bf16 v[84:87], v[96:99], v[32:35], v[148:151]
    s_cmp_lg_u32 s89, 0
    v_or3_b32 v62, v62, v133, v130
    v_xor_b32 v48, 0x10000, v48
    v_mfma_f32_16x16x32_bf16 v[84:87], v[100:103], v[36:39], v[84:87]
    s_waitcnt lgkmcnt(5)
    v_exp_f32 v61, v75
    v_mfma_f32_16x16x32_bf16 v[80:83], v[100:103], v[20:23], v[80:83]
    s_waitcnt lgkmcnt(0)
    v_cvt_pk_bf16_f32 v131, v60, v61
    v_smfmac_f32_16x16x64_bf16 v[160:163], v[164:167], v[136:143], v168
    s_cbranch_scc1 L_ldback_13_c
    s_barrier
L_ldback_13:
    s_add_i32 s62, s62, 1
    ds_read_b128 v[96:99], v48 offset:32768
    ds_read_b128 v[100:103], v48 offset:33792
    v_mfma_f32_16x16x32_bf16 v[80:83], v[104:107], v[24:27], v[80:83]
    v_exp_f32 v58, v76
    v_mfma_f32_16x16x32_bf16 v[84:87], v[104:107], v[40:43], v[84:87]
    ds_read_b128 v[104:107], v48 offset:34816
    v_mfma_f32_16x16x32_bf16 v[84:87], v[108:111], v[44:47], v[84:87]
    v_exp_f32 v59, v77
    v_mfma_f32_16x16x32_bf16 v[80:83], v[108:111], v[28:31], v[80:83]
    ds_read_b128 v[108:111], v48 offset:35840
    v_cvt_pk_bf16_f32 v134, v58, v59
    v_mfma_f32_16x16x32_bf16 v[88:91], v[112:115], v[16:19], v[152:155]
    v_exp_f32 v60, v78
    v_mfma_f32_16x16x32_bf16 v[92:95], v[112:115], v[32:35], v[156:159]
    ds_read_b128 v[112:115], v48 offset:36864
    v_or3_b32 v62, v62, v131, v134
    v_mfma_f32_16x16x32_bf16 v[92:95], v[116:119], v[36:39], v[92:95]
    v_exp_f32 v61, v79
    v_mfma_f32_16x16x32_bf16 v[88:91], v[116:119], v[20:23], v[88:91]
    ds_read_b128 v[116:119], v48 offset:37888
    v_cvt_pk_bf16_f32 v135, v60, v61
    v_mfma_f32_16x16x32_bf16 v[88:91], v[120:123], v[24:27], v[88:91]
    v_exp_f32 v58, v80
    v_mfma_f32_16x16x32_bf16 v[92:95], v[120:123], v[40:43], v[92:95]
    ds_read_b128 v[120:123], v48 offset:38912
    v_bitop3_b32 v62, v62, v135, s72 bitop3:0xa8
    v_cmp_ne_u32 vcc, s65, v62
    v_mfma_f32_16x16x32_bf16 v[92:95], v[124:127], v[44:47], v[92:95]
    s_waitcnt lgkmcnt(6)
    v_exp_f32 v59, v81
    v_mfma_f32_16x16x32_bf16 v[88:91], v[124:127], v[28:31], v[88:91]
    ds_read_b128 v[124:127], v48 offset:39936
    s_cbranch_vccz L_st0
    s_branch L_back_14_h
L_tail0:
    s_mov_b32 s65, 0
    v_mfma_f32_16x16x32_bf16 v[192:195], v[96:99], v[128:131], v[192:195]
    s_waitcnt lgkmcnt(6)
    v_exp_f32 v60, v82
    v_exp_f32 v61, v83
    v_mfma_f32_16x16x32_bf16 v[196:199], v[96:99], v[132:135], v[196:199]
    ds_read_b128 v[96:99], v48 offset:40960
    v_cvt_pk_bf16_f32 v136, v58, v59
    v_cvt_pk_bf16_f32 v137, v60, v61
    v_mfma_f32_16x16x32_bf16 v[204:207], v[100:103], v[132:135], v[204:207]
    s_waitcnt lgkmcnt(6)
    v_exp_f32 v58, v84
    v_exp_f32 v59, v85
    v_mfma_f32_16x16x32_bf16 v[200:203], v[100:103], v[128:131], v[200:203]
    ds_read_b128 v[100:103], v48 offset:41984
    v_cvt_pk_bf16_f32 v140, v58, v59
    v_smfmac_f32_16x16x64_bf16 v[160:163], v[164:167], v[128:135], v168
    v_mfma_f32_16x16x32_bf16 v[208:211], v[104:107], v[128:131], v[208:211]
    s_waitcnt lgkmcnt(6)
    v_exp_f32 v60, v86
    v_exp_f32 v61, v87
    v_mfma_f32_16x16x32_bf16 v[212:215], v[104:107], v[132:135], v[212:215]
    ds_read_b128 v[104:107], v48 offset:43008
    v_cvt_pk_bf16_f32 v141, v60, v61
    v_mfma_f32_16x16x32_bf16 v[220:223], v[108:111], v[132:135], v[220:223]
    s_waitcnt lgkmcnt(6)
    v_exp_f32 v58, v88
    v_exp_f32 v59, v89
    v_mfma_f32_16x16x32_bf16 v[216:219], v[108:111], v[128:131], v[216:219]
    ds_read_b128 v[108:111], v48 offset:44032
    v_cvt_pk_bf16_f32 v138, v58, v59
    v_mfma_f32_16x16x32_bf16 v[224:227], v[112:115], v[128:131], v[224:227]
    s_waitcnt lgkmcnt(6)
    v_exp_f32 v60, v90
    v_exp_f32 v61, v91
    v_mfma_f32_16x16x32_bf16 v[228:231], v[112:115], v[132:135], v[228:231]
    ds_read_b128 v[112:115], v48 offset:45056
    v_cvt_pk_bf16_f32 v139, v60, v61
    v_mfma_f32_16x16x32_bf16 v[236:239], v[116:119], v[132:135], v[236:239]
    s_waitcnt lgkmcnt(6)
    v_exp_f32 v58, v92
    v_exp_f32 v59, v93
    v_mfma_f32_16x16x32_bf16 v[232:235], v[116:119], v[128:131], v[232:235]
    ds_read_b128 v[116:119], v48 offset:46080
    v_cvt_pk_bf16_f32 v142, v58, v59
    v_mfma_f32_16x16x32_bf16 v[240:243], v[120:123], v[128:131], v[240:243]
    s_waitcnt lgkmcnt(6)
    v_exp_f32 v60, v94
    v_exp_f32 v61, v95
    v_mfma_f32_16x16x32_bf16 v[244:247], v[120:123], v[132:135], v[244:247]
    ds_read_b128 v[120:123], v48 offset:47104
    v_cvt_pk_bf16_f32 v143, v60, v61
    v_mfma_f32_16x16x32_bf16 v[252:255], v[124:127], v[132:135], v[252:255]
    s_waitcnt lgkmcnt(6)
    v_or3_b32 v62, v136, v137, v140
    v_or3_b32 v62, v62, v141, v138
    v_or3_b32 v62, v62, v139, v142
    v_bitop3_b32 v62, v62, v143, s72 bitop3:0xa8
    v_cmp_ne_u32 vcc, s65, v62
    v_mfma_f32_16x16x32_bf16 v[248:251], v[124:127], v[128:131], v[248:251]
    ds_read_b128 v[124:127], v48 offset:48128
    s_cbranch_vccnz L_back_15_h
L_back_15:
L_pv1:
    v_mfma_f32_16x16x32_bf16 v[192:195], v[96:99], v[136:139], v[192:195]
    s_waitcnt lgkmcnt(6)
    v_mfma_f32_16x16x32_bf16 v[196:199], v[96:99], v[140:143], v[196:199]
    v_mfma_f32_16x16x32_bf16 v[204:207], v[100:103], v[140:143], v[204:207]
    s_waitcnt lgkmcnt(5)
    v_mfma_f32_16x16x32_bf16 v[200:203], v[100:103], v[136:139], v[200:203]
    v_smfmac_f32_16x16x64_bf16 v[160:163], v[164:167], v[136:143], v168
    v_mfma_f32_16x16x32_bf16 v[208:211], v[104:107], v[136:139], v[208:211]
    s_waitcnt lgkmcnt(4)
    v_mfma_f32_16x16x32_bf16 v[212:215], v[104:107], v[140:143], v[212:215]
    v_mfma_f32_16x16x32_bf16 v[220:223], v[108:111], v[140:143], v[220:223]
    s_waitcnt lgkmcnt(3)
    v_mfma_f32_16x16x32_bf16 v[216:219], v[108:111], v[136:139], v[216:219]
    v_mfma_f32_16x16x32_bf16 v[224:227], v[112:115], v[136:139], v[224:227]
    s_waitcnt lgkmcnt(2)
    v_mfma_f32_16x16x32_bf16 v[228:231], v[112:115], v[140:143], v[228:231]
    v_mfma_f32_16x16x32_bf16 v[236:239], v[116:119], v[140:143], v[236:239]
    s_waitcnt lgkmcnt(1)
    v_mfma_f32_16x16x32_bf16 v[232:235], v[116:119], v[136:139], v[232:235]
    v_mfma_f32_16x16x32_bf16 v[240:243], v[120:123], v[136:139], v[240:243]
    s_waitcnt lgkmcnt(0)
    v_mfma_f32_16x16x32_bf16 v[244:247], v[120:123], v[140:143], v[244:247]
    v_mfma_f32_16x16x32_bf16 v[252:255], v[124:127], v[140:143], v[252:255]
    v_mfma_f32_16x16x32_bf16 v[248:251], v[124:127], v[136:139], v[248:251]
    s_branch L_fin
L_tail1:
    s_mov_b32 s65, 0
    v_mfma_f32_16x16x32_bf16 v[192:195], v[96:99], v[136:139], v[192:195]
    s_waitcnt lgkmcnt(6)
    v_exp_f32 v60, v66
    v_exp_f32 v61, v67
    v_mfma_f32_16x16x32_bf16 v[196:199], v[96:99], v[140:143], v[196:199]
    ds_read_b128 v[96:99], v48 offset:49152
    v_cvt_pk_bf16_f32 v128, v58, v59
    v_cvt_pk_bf16_f32 v129, v60, v61
    v_mfma_f32_16x16x32_bf16 v[204:207], v[100:103], v[140:143], v[204:207]
    s_waitcnt lgkmcnt(6)
    v_exp_f32 v58, v68
    v_exp_f32 v59, v69
    v_mfma_f32_16x16x32_bf16 v[200:203], v[100:103], v[136:139], v[200:203]
    ds_read_b128 v[100:103], v48 offset:50176
    v_cvt_pk_bf16_f32 v132, v58, v59
    v_smfmac_f32_16x16x64_bf16 v[160:163], v[164:167], v[136:143], v168
    v_mfma_f32_16x16x32_bf16 v[208:211], v[104:107], v[136:139], v[208:211]
    s_waitcnt lgkmcnt(6)
    v_exp_f32 v60, v70
    v_exp_f32 v61, v71
    v_mfma_f32_16x16x32_bf16 v[212:215], v[104:107], v[140:143], v[212:215]
    ds_read_b128 v[104:107], v48 offset:51200
    v_cvt_pk_bf16_f32 v133, v60, v61
    v_mfma_f32_16x16x32_bf16 v[220:223], v[108:111], v[140:143], v[220:223]
    s_waitcnt lgkmcnt(6)
    v_exp_f32 v58, v72
    v_exp_f32 v59, v73
    v_mfma_f32_16x16x32_bf16 v[216:219], v[108:111], v[136:139], v[216:219]
    ds_read_b128 v[108:111], v48 offset:52224
    v_cvt_pk_bf16_f32 v130, v58, v59
    v_mfma_f32_16x16x32_bf16 v[224:227], v[112:115], v[136:139], v[224:227]
    s_waitcnt lgkmcnt(6)
    v_exp_f32 v60, v74
    v_exp_f32 v61, v75
    v_mfma_f32_16x16x32_bf16 v[228:231], v[112:115], v[140:143], v[228:231]
    ds_read_b128 v[112:115], v48 offset:53248
    v_cvt_pk_bf16_f32 v131, v60, v61
    v_mfma_f32_16x16x32_bf16 v[236:239], v[116:119], v[140:143], v[236:239]
    s_waitcnt lgkmcnt(6)
    v_exp_f32 v58, v76
    v_exp_f32 v59, v77
    v_mfma_f32_16x16x32_bf16 v[232:235], v[116:119], v[136:139], v[232:235]
    ds_read_b128 v[116:119], v48 offset:54272
    v_cvt_pk_bf16_f32 v134, v58, v59
    v_mfma_f32_16x16x32_bf16 v[240:243], v[120:123], v[136:139], v[240:243]
    s_waitcnt lgkmcnt(6)
    v_exp_f32 v60, v78
    v_exp_f32 v61, v79
    v_mfma_f32_16x16x32_bf16 v[244:247], v[120:123], v[140:143], v[244:247]
    ds_read_b128 v[120:123], v48 offset:55296
    v_cvt_pk_bf16_f32 v135, v60, v61
    v_mfma_f32_16x16x32_bf16 v[252:255], v[124:127], v[140:143], v[252:255]
    s_waitcnt lgkmcnt(6)
    v_or3_b32 v62, v128, v129, v132
    v_or3_b32 v62, v62, v133, v130
    v_or3_b32 v62, v62, v131, v134
    v_bitop3_b32 v62, v62, v135, s72 bitop3:0xa8
    v_cmp_ne_u32 vcc, s65, v62
    v_mfma_f32_16x16x32_bf16 v[248:251], v[124:127], v[136:139], v[248:251]
    ds_read_b128 v[124:127], v48 offset:56320
    s_cbranch_vccnz L_back_16_h
L_back_16:
L_pv2:
    v_mfma_f32_16x16x32_bf16 v[192:195], v[96:99], v[128:131], v[192:195]
    s_waitcnt lgkmcnt(6)
    v_mfma_f32_16x16x32_bf16 v[196:199], v[96:99], v[132:135], v[196:199]
    v_mfma_f32_16x16x32_bf16 v[204:207], v[100:103], v[132:135], v[204:207]
    s_waitcnt lgkmcnt(5)
    v_mfma_f32_16x16x32_bf16 v[200:203], v[100:103], v[128:131], v[200:203]
    v_smfmac_f32_16x16x64_bf16 v[160:163], v[164:167], v[128:135], v168
    v_mfma_f32_16x16x32_bf16 v[208:211], v[104:107], v[128:131], v[208:211]
    s_waitcnt lgkmcnt(4)
    v_mfma_f32_16x16x32_bf16 v[212:215], v[104:107], v[132:135], v[212:215]
    v_mfma_f32_16x16x32_bf16 v[220:223], v[108:111], v[132:135], v[220:223]
    s_waitcnt lgkmcnt(3)
    v_mfma_f32_16x16x32_bf16 v[216:219], v[108:111], v[128:131], v[216:219]
    v_mfma_f32_16x16x32_bf16 v[224:227], v[112:115], v[128:131], v[224:227]
    s_waitcnt lgkmcnt(2)
    v_mfma_f32_16x16x32_bf16 v[228:231], v[112:115], v[132:135], v[228:231]
    v_mfma_f32_16x16x32_bf16 v[236:239], v[116:119], v[132:135], v[236:239]
    s_waitcnt lgkmcnt(1)
    v_mfma_f32_16x16x32_bf16 v[232:235], v[116:119], v[128:131], v[232:235]
    v_mfma_f32_16x16x32_bf16 v[240:243], v[120:123], v[128:131], v[240:243]
    s_waitcnt lgkmcnt(0)
    v_mfma_f32_16x16x32_bf16 v[244:247], v[120:123], v[132:135], v[244:247]
    v_mfma_f32_16x16x32_bf16 v[252:255], v[124:127], v[132:135], v[252:255]
    v_mfma_f32_16x16x32_bf16 v[248:251], v[124:127], v[128:131], v[248:251]
    s_cmp_eq_u32 s60, 0
    s_cbranch_scc1 L_fin
    s_waitcnt vmcnt(0) lgkmcnt(0)
    s_call_b64 s[82:83], L_pend
    s_barrier
    s_call_b64 s[82:83], L_load
    s_add_i32 s62, s62, 1
    s_branch L_fin
L_tail2:
    s_mov_b32 s65, 0
    v_mfma_f32_16x16x32_bf16 v[192:195], v[96:99], v[128:131], v[192:195]
    s_waitcnt lgkmcnt(6)
    v_exp_f32 v60, v82
    v_exp_f32 v61, v83
    v_mfma_f32_16x16x32_bf16 v[196:199], v[96:99], v[132:135], v[196:199]
    ds_read_b128 v[96:99], v48 offset:57344
    v_cvt_pk_bf16_f32 v136, v58, v59
    v_cvt_pk_bf16_f32 v137, v60, v61
    v_mfma_f32_16x16x32_bf16 v[204:207], v[100:103], v[132:135], v[204:207]
    s_waitcnt lgkmcnt(6)
    v_exp_f32 v58, v84
    v_exp_f32 v59, v85
    v_mfma_f32_16x16x32_bf16 v[200:203], v[100:103], v[128:131], v[200:203]
    ds_read_b128 v[100:103], v48 offset:58368
    v_cvt_pk_bf16_f32 v140, v58, v59
    v_smfmac_f32_16x16x64_bf16 v[160:163], v[164:167], v[128:135], v168
    v_mfma_f32_16x16x32_bf16 v[208:211], v[104:107], v[128:131], v[208:211]
    s_waitcnt lgkmcnt(6)
    v_exp_f32 v60, v86
    v_exp_f32 v61, v87
    v_mfma_f32_16x16x32_bf16 v[212:215], v[104:107], v[132:135], v[212:215]
    ds_read_b128 v[104:107], v48 offset:59392
    v_cvt_pk_bf16_f32 v141, v60, v61
    v_mfma_f32_16x16x32_bf16 v[220:223], v[108:111], v[132:135], v[220:223]
    s_waitcnt lgkmcnt(6)
    v_exp_f32 v58, v88
    v_exp_f32 v59, v89
    v_mfma_f32_16x16x32_bf16 v[216:219], v[108:111], v[128:131], v[216:219]
    ds_read_b128 v[108:111], v48 offset:60416
    v_cvt_pk_bf16_f32 v138, v58, v59
    v_mfma_f32_16x16x32_bf16 v[224:227], v[112:115], v[128:131], v[224:227]
    s_waitcnt lgkmcnt(6)
    v_exp_f32 v60, v90
    v_exp_f32 v61, v91
    v_mfma_f32_16x16x32_bf16 v[228:231], v[112:115], v[132:135], v[228:231]
    ds_read_b128 v[112:115], v48 offset:61440
    v_cvt_pk_bf16_f32 v139, v60, v61
    v_mfma_f32_16x16x32_bf16 v[236:239], v[116:119], v[132:135], v[236:239]
    s_waitcnt lgkmcnt(6)
    v_exp_f32 v58, v92
    v_exp_f32 v59, v93
    v_mfma_f32_16x16x32_bf16 v[232:235], v[116:119], v[128:131], v[232:235]
    ds_read_b128 v[116:119], v48 offset:62464
    v_cvt_pk_bf16_f32 v142, v58, v59
    v_mfma_f32_16x16x32_bf16 v[240:243], v[120:123], v[128:131], v[240:243]
    s_waitcnt lgkmcnt(6)
    v_exp_f32 v60, v94
    v_exp_f32 v61, v95
    v_mfma_f32_16x16x32_bf16 v[244:247], v[120:123], v[132:135], v[244:247]
    ds_read_b128 v[120:123], v48 offset:63488
    v_cvt_pk_bf16_f32 v143, v60, v61
    v_mfma_f32_16x16x32_bf16 v[252:255], v[124:127], v[132:135], v[252:255]
    s_waitcnt lgkmcnt(6)
    v_or3_b32 v62, v136, v137, v140
    v_or3_b32 v62, v62, v141, v138
    v_or3_b32 v62, v62, v139, v142
    v_bitop3_b32 v62, v62, v143, s72 bitop3:0xa8
    v_cmp_ne_u32 vcc, s65, v62
    v_mfma_f32_16x16x32_bf16 v[248:251], v[124:127], v[128:131], v[248:251]
    ds_read_b128 v[124:127], v48 offset:64512
    s_cbranch_vccnz L_back_18_h
L_back_18:
L_pv3:
    v_mfma_f32_16x16x32_bf16 v[192:195], v[96:99], v[136:139], v[192:195]
    s_waitcnt lgkmcnt(6)
    v_mfma_f32_16x16x32_bf16 v[196:199], v[96:99], v[140:143], v[196:199]
    v_xor_b32 v48, 0x10000, v48
    v_mfma_f32_16x16x32_bf16 v[204:207], v[100:103], v[140:143], v[204:207]
    s_waitcnt lgkmcnt(5)
    v_mfma_f32_16x16x32_bf16 v[200:203], v[100:103], v[136:139], v[200:203]
    v_smfmac_f32_16x16x64_bf16 v[160:163], v[164:167], v[136:143], v168
    s_waitcnt vmcnt(0) lgkmcnt(0)
    s_call_b64 s[82:83], L_pend
    s_barrier
    s_call_b64 s[82:83], L_load
    s_add_i32 s62, s62, 1
    v_mfma_f32_16x16x32_bf16 v[208:211], v[104:107], v[136:139], v[208:211]
    v_mfma_f32_16x16x32_bf16 v[212:215], v[104:107], v[140:143], v[212:215]
    v_mfma_f32_16x16x32_bf16 v[220:223], v[108:111], v[140:143], v[220:223]
    v_mfma_f32_16x16x32_bf16 v[216:219], v[108:111], v[136:139], v[216:219]
    v_mfma_f32_16x16x32_bf16 v[224:227], v[112:115], v[136:139], v[224:227]
    v_mfma_f32_16x16x32_bf16 v[228:231], v[112:115], v[140:143], v[228:231]
    v_mfma_f32_16x16x32_bf16 v[236:239], v[116:119], v[140:143], v[236:239]
    v_mfma_f32_16x16x32_bf16 v[232:235], v[116:119], v[136:139], v[232:235]
    v_mfma_f32_16x16x32_bf16 v[240:243], v[120:123], v[136:139], v[240:243]
    v_mfma_f32_16x16x32_bf16 v[244:247], v[120:123], v[140:143], v[244:247]
    v_mfma_f32_16x16x32_bf16 v[252:255], v[124:127], v[140:143], v[252:255]
    v_mfma_f32_16x16x32_bf16 v[248:251], v[124:127], v[136:139], v[248:251]
    s_branch L_fin
L_tail3:
    s_mov_b32 s65, 0
    v_mfma_f32_16x16x32_bf16 v[192:195], v[96:99], v[136:139], v[192:195]
    s_waitcnt lgkmcnt(6)
    v_exp_f32 v60, v66
    v_exp_f32 v61, v67
    v_mfma_f32_16x16x32_bf16 v[196:199], v[96:99], v[140:143], v[196:199]
    v_cvt_pk_bf16_f32 v128, v58, v59
    v_cvt_pk_bf16_f32 v129, v60, v61
    v_xor_b32 v48, 0x10000, v48
    v_mfma_f32_16x16x32_bf16 v[204:207], v[100:103], v[140:143], v[204:207]
    s_waitcnt lgkmcnt(5)
    v_exp_f32 v58, v68
    v_exp_f32 v59, v69
    v_mfma_f32_16x16x32_bf16 v[200:203], v[100:103], v[136:139], v[200:203]
    v_cvt_pk_bf16_f32 v132, v58, v59
    v_smfmac_f32_16x16x64_bf16 v[160:163], v[164:167], v[136:143], v168
    s_waitcnt vmcnt(0) lgkmcnt(0)
    s_call_b64 s[82:83], L_pend
    s_barrier
    s_call_b64 s[82:83], L_load
    s_add_i32 s62, s62, 1
    ds_read_b128 v[96:99], v48 offset:32768
    ds_read_b128 v[100:103], v48 offset:33792
    v_mfma_f32_16x16x32_bf16 v[208:211], v[104:107], v[136:139], v[208:211]
    v_exp_f32 v60, v70
    v_exp_f32 v61, v71
    v_mfma_f32_16x16x32_bf16 v[212:215], v[104:107], v[140:143], v[212:215]
    ds_read_b128 v[104:107], v48 offset:34816
    v_cvt_pk_bf16_f32 v133, v60, v61
    v_mfma_f32_16x16x32_bf16 v[220:223], v[108:111], v[140:143], v[220:223]
    v_exp_f32 v58, v72
    v_exp_f32 v59, v73
    v_mfma_f32_16x16x32_bf16 v[216:219], v[108:111], v[136:139], v[216:219]
    ds_read_b128 v[108:111], v48 offset:35840
    v_cvt_pk_bf16_f32 v130, v58, v59
    v_mfma_f32_16x16x32_bf16 v[224:227], v[112:115], v[136:139], v[224:227]
    v_exp_f32 v60, v74
    v_exp_f32 v61, v75
    v_mfma_f32_16x16x32_bf16 v[228:231], v[112:115], v[140:143], v[228:231]
    ds_read_b128 v[112:115], v48 offset:36864
    v_cvt_pk_bf16_f32 v131, v60, v61
    v_mfma_f32_16x16x32_bf16 v[236:239], v[116:119], v[140:143], v[236:239]
    v_exp_f32 v58, v76
    v_exp_f32 v59, v77
    v_mfma_f32_16x16x32_bf16 v[232:235], v[116:119], v[136:139], v[232:235]
    ds_read_b128 v[116:119], v48 offset:37888
    v_cvt_pk_bf16_f32 v134, v58, v59
    v_mfma_f32_16x16x32_bf16 v[240:243], v[120:123], v[136:139], v[240:243]
    v_exp_f32 v60, v78
    v_exp_f32 v61, v79
    v_mfma_f32_16x16x32_bf16 v[244:247], v[120:123], v[140:143], v[244:247]
    ds_read_b128 v[120:123], v48 offset:38912
    v_cvt_pk_bf16_f32 v135, v60, v61
    v_mfma_f32_16x16x32_bf16 v[252:255], v[124:127], v[140:143], v[252:255]
    s_waitcnt lgkmcnt(6)
    v_or3_b32 v62, v128, v129, v132
    v_or3_b32 v62, v62, v133, v130
    v_or3_b32 v62, v62, v131, v134
    v_bitop3_b32 v62, v62, v135, s72 bitop3:0xa8
    v_cmp_ne_u32 vcc, s65, v62
    v_mfma_f32_16x16x32_bf16 v[248:251], v[124:127], v[136:139], v[248:251]
    ds_read_b128 v[124:127], v48 offset:39936
    s_cbranch_vccnz L_back_21_h
L_back_21:
L_pv0:
    v_mfma_f32_16x16x32_bf16 v[192:195], v[96:99], v[128:131], v[192:195]
    s_waitcnt lgkmcnt(6)
    v_mfma_f32_16x16x32_bf16 v[196:199], v[96:99], v[132:135], v[196:199]
    v_mfma_f32_16x16x32_bf16 v[204:207], v[100:103], v[132:135], v[204:207]
    s_waitcnt lgkmcnt(5)
    v_mfma_f32_16x16x32_bf16 v[200:203], v[100:103], v[128:131], v[200:203]
    v_smfmac_f32_16x16x64_bf16 v[160:163], v[164:167], v[128:135], v168
    v_mfma_f32_16x16x32_bf16 v[208:211], v[104:107], v[128:131], v[208:211]
    s_waitcnt lgkmcnt(4)
    v_mfma_f32_16x16x32_bf16 v[212:215], v[104:107], v[132:135], v[212:215]
    v_mfma_f32_16x16x32_bf16 v[220:223], v[108:111], v[132:135], v[220:223]
    s_waitcnt lgkmcnt(3)
    v_mfma_f32_16x16x32_bf16 v[216:219], v[108:111], v[128:131], v[216:219]
    v_mfma_f32_16x16x32_bf16 v[224:227], v[112:115], v[128:131], v[224:227]
    s_waitcnt lgkmcnt(2)
    v_mfma_f32_16x16x32_bf16 v[228:231], v[112:115], v[132:135], v[228:231]
    v_mfma_f32_16x16x32_bf16 v[236:239], v[116:119], v[132:135], v[236:239]
    s_waitcnt lgkmcnt(1)
    v_mfma_f32_16x16x32_bf16 v[232:235], v[116:119], v[128:131], v[232:235]
    v_mfma_f32_16x16x32_bf16 v[240:243], v[120:123], v[128:131], v[240:243]
    s_waitcnt lgkmcnt(0)
    v_mfma_f32_16x16x32_bf16 v[244:247], v[120:123], v[132:135], v[244:247]
    v_mfma_f32_16x16x32_bf16 v[252:255], v[124:127], v[132:135], v[252:255]
    v_mfma_f32_16x16x32_bf16 v[248:251], v[124:127], v[128:131], v[248:251]
L_fin:
    v_and_b32 v3, 7, v1
    v_lshlrev_b32 v3, 2, v3
    s_mov_b32 s72, 0x3a0000
    buffer_load_dword v51, v3, s[8:11], s72 offen sc1
    v_add_f32 v56, v160, v161
    v_rcp_f32 v56, v56
    v_add_f32 v57, v162, v163
    v_rcp_f32 v57, v57
    s_lshl_b32 s6, s60, 18
    s_lshl_b32 s7, s4, 12
    s_add_u32 s6, s6, s7
    s_add_u32 s6, s6, 50331648
    s_nop 4
    v_mul_f32 v192, v56, v192
    v_mul_f32 v193, v56, v193
    v_mul_f32 v194, v56, v194
    v_mul_f32 v195, v56, v195
    v_cvt_pk_bf16_f32 v16, v192, v193
    v_cvt_pk_bf16_f32 v17, v194, v195
    v_mul_f32 v200, v56, v200
    v_mul_f32 v201, v56, v201
    v_mul_f32 v202, v56, v202
    v_mul_f32 v203, v56, v203
    v_cvt_pk_bf16_f32 v18, v200, v201
    v_cvt_pk_bf16_f32 v19, v202, v203
    buffer_store_dwordx4 v[16:19], v13, s[8:11], s6 offen offset:0 sc1
    v_mul_f32 v208, v56, v208
    v_mul_f32 v209, v56, v209
    v_mul_f32 v210, v56, v210
    v_mul_f32 v211, v56, v211
    v_cvt_pk_bf16_f32 v20, v208, v209
    v_cvt_pk_bf16_f32 v21, v210, v211
    v_mul_f32 v216, v56, v216
    v_mul_f32 v217, v56, v217
    v_mul_f32 v218, v56, v218
    v_mul_f32 v219, v56, v219
    v_cvt_pk_bf16_f32 v22, v216, v217
    v_cvt_pk_bf16_f32 v23, v218, v219
    buffer_store_dwordx4 v[20:23], v13, s[8:11], s6 offen offset:1024 sc1
    v_mul_f32 v224, v56, v224
    v_mul_f32 v225, v56, v225
    v_mul_f32 v226, v56, v226
    v_mul_f32 v227, v56, v227
    v_cvt_pk_bf16_f32 v24, v224, v225
    v_cvt_pk_bf16_f32 v25, v226, v227
    v_mul_f32 v232, v56, v232
    v_mul_f32 v233, v56, v233
    v_mul_f32 v234, v56, v234
    v_mul_f32 v235, v56, v235
    v_cvt_pk_bf16_f32 v26, v232, v233
    v_cvt_pk_bf16_f32 v27, v234, v235
    buffer_store_dwordx4 v[24:27], v13, s[8:11], s6 offen offset:2048 sc1
    v_mul_f32 v240, v56, v240
    v_mul_f32 v241, v56, v241
    v_mul_f32 v242, v56, v242
    v_mul_f32 v243, v56, v243
    v_cvt_pk_bf16_f32 v28, v240, v241
    v_cvt_pk_bf16_f32 v29, v242, v243
    v_mul_f32 v248, v56, v248
    v_mul_f32 v249, v56, v249
    v_mul_f32 v250, v56, v250
    v_mul_f32 v251, v56, v251
    v_cvt_pk_bf16_f32 v30, v248, v249
    v_cvt_pk_bf16_f32 v31, v250, v251
    buffer_store_dwordx4 v[28:31], v13, s[8:11], s6 offen offset:3072 sc1
    s_add_u32 s6, s6, 0x20000
    v_mul_f32 v196, v57, v196
    v_mul_f32 v197, v57, v197
    v_mul_f32 v198, v57, v198
    v_mul_f32 v199, v57, v199
    v_cvt_pk_bf16_f32 v32, v196, v197
    v_cvt_pk_bf16_f32 v33, v198, v199
    v_mul_f32 v204, v57, v204
    v_mul_f32 v205, v57, v205
    v_mul_f32 v206, v57, v206
    v_mul_f32 v207, v57, v207
    v_cvt_pk_bf16_f32 v34, v204, v205
    v_cvt_pk_bf16_f32 v35, v206, v207
    buffer_store_dwordx4 v[32:35], v13, s[8:11], s6 offen offset:0 sc1
    v_mul_f32 v212, v57, v212
    v_mul_f32 v213, v57, v213
    v_mul_f32 v214, v57, v214
    v_mul_f32 v215, v57, v215
    v_cvt_pk_bf16_f32 v36, v212, v213
    v_cvt_pk_bf16_f32 v37, v214, v215
    v_mul_f32 v220, v57, v220
    v_mul_f32 v221, v57, v221
    v_mul_f32 v222, v57, v222
    v_mul_f32 v223, v57, v223
    v_cvt_pk_bf16_f32 v38, v220, v221
    v_cvt_pk_bf16_f32 v39, v222, v223
    buffer_store_dwordx4 v[36:39], v13, s[8:11], s6 offen offset:1024 sc1
    v_mul_f32 v228, v57, v228
    v_mul_f32 v229, v57, v229
    v_mul_f32 v230, v57, v230
    v_mul_f32 v231, v57, v231
    v_cvt_pk_bf16_f32 v40, v228, v229
    v_cvt_pk_bf16_f32 v41, v230, v231
    v_mul_f32 v236, v57, v236
    v_mul_f32 v237, v57, v237
    v_mul_f32 v238, v57, v238
    v_mul_f32 v239, v57, v239
    v_cvt_pk_bf16_f32 v42, v236, v237
    v_cvt_pk_bf16_f32 v43, v238, v239
    buffer_store_dwordx4 v[40:43], v13, s[8:11], s6 offen offset:2048 sc1
    v_mul_f32 v244, v57, v244
    v_mul_f32 v245, v57, v245
    v_mul_f32 v246, v57, v246
    v_mul_f32 v247, v57, v247
    v_cvt_pk_bf16_f32 v44, v244, v245
    v_cvt_pk_bf16_f32 v45, v246, v247
    v_mul_f32 v252, v57, v252
    v_mul_f32 v253, v57, v253
    v_mul_f32 v254, v57, v254
    v_mul_f32 v255, v57, v255
    v_cvt_pk_bf16_f32 v46, v252, v253
    v_cvt_pk_bf16_f32 v47, v254, v255
    buffer_store_dwordx4 v[44:47], v13, s[8:11], s6 offen offset:3072 sc1
    s_cmp_gt_i32 s62, s63
    s_cbranch_scc1 L_pre
    s_waitcnt vmcnt(8)
    s_call_b64 s[82:83], L_pend
    s_barrier
    s_waitcnt vmcnt(0)
    s_lshl_b32 s6, s60, 5
    s_add_u32 s6, s6, s4
    s_lshl_b32 s6, s6, 7
    s_add_u32 s6, s6, 3932160
    v_mov_b32 v2, 1
    v_mov_b32 v3, 0x5000000
    v_writelane_b32 v3, s6, 0
    buffer_store_dword v2, v3, s[8:11], 0 offen sc1
    s_call_b64 s[82:83], L_load
    s_add_i32 s62, s62, 1
    s_lshl_b32 s6, s3, 8
    s_add_u32 s6, s6, s2
    s_cmp_eq_u32 s6, 31
    s_cbranch_scc1 L_top
L_idle:
    s_sub_i32 s6, s63, 5
    s_cmp_gt_i32 s62, s6
    s_cbranch_scc1 L_pre
    s_waitcnt vmcnt(0) lgkmcnt(0)
    s_call_b64 s[82:83], L_pend
    s_barrier
    s_call_b64 s[82:83], L_load
    s_add_i32 s62, s62, 1
    s_cmp_lt_u32 s61, 54
    s_cbranch_scc1 L_moe
    s_branch L_idle
L_pre:
    s_cmp_lt_u32 s3, 4
    s_cbranch_scc1 L_pre1
    s_barrier
    s_lshl_b32 s7, s76, 13
    s_add_u32 s7, s7, 0x10000
    v_add_u32 v3, s7, v13
    v_add_u32 v2, 0x10000, v3
    s_lshl_b32 s7, s76, 12
    s_add_u32 s7, s7, 0x10000
    v_add_u32 v12, s7, v13
    ds_read_b128 v[96:99], v2 offset:0
    ds_read_b128 v[100:103], v2 offset:1024
    ds_read_b128 v[104:107], v2 offset:2048
    ds_read_b128 v[108:111], v2 offset:3072
    ds_read_b128 v[112:115], v2 offset:4096
    ds_read_b128 v[116:119], v2 offset:5120
    ds_read_b128 v[120:123], v2 offset:6144
    ds_read_b128 v[124:127], v2 offset:7168
    ds_read_b128 v[128:131], v3 offset:0
    ds_read_b128 v[132:135], v3 offset:1024
    ds_read_b128 v[136:139], v3 offset:2048
    ds_read_b128 v[140:143], v3 offset:3072
    s_add_u32 s6, s76, 0
    s_and_b32 s6, s6, 3
    s_lshl_b32 s6, s6, 10
    v_add_u32 v44, s6, v13
    s_add_u32 s6, s76, 1
    s_and_b32 s6, s6, 3
    s_lshl_b32 s6, s6, 10
    v_add_u32 v45, s6, v13
    s_add_u32 s6, s76, 2
    s_and_b32 s6, s6, 3
    s_lshl_b32 s6, s6, 10
    v_add_u32 v46, s6, v13
    s_add_u32 s6, s76, 3
    s_and_b32 s6, s6, 3
    s_lshl_b32 s6, s6, 10
    v_add_u32 v47, s6, v13
    v_add_u32 v52, 4096, v13
    s_lshr_b32 s69, s4, 3
    s_lshl_b32 s69, s69, 2
    s_add_u32 s69, s69, s76
    s_mul_i32 s69, s69, 327680
    s_and_b32 s7, s4, 3
    s_mul_i32 s7, s7, 10240
    s_add_u32 s69, s69, s7
    s_add_u32 s69, s69, 4199424
    s_and_b32 s6, s4, 4
    s_lshr_b32 s7, s4, 3
    s_add_u32 s6, s6, s7
    s_lshl_b32 s7, s5, 3
    s_add_u32 s68, s6, s7
    s_sub_u32 s7, 120, s7
    s_add_u32 s61, s6, s7
    s_lshr_b32 s6, s4, 3
    s_lshl_b32 s6, s6, 15
    s_lshl_b32 s99, s3, 12
    s_add_u32 s66, s6, s99
    s_add_u32 s66, s66, 50331648
    s_lshl_b32 s6, s76, 13
    v_add_u32 v4, s6, v13
    v_add_u32 v7, 65536, v4
    ds_read_b128 v[144:147], v3 offset:4096
    ds_read_b128 v[148:151], v3 offset:5120
    ds_read_b128 v[152:155], v3 offset:6144
    ds_read_b128 v[156:159], v3 offset:7168
    ds_read_b128 v[160:163], v12 offset:49152
    ds_read_b128 v[164:167], v12 offset:50176
    ds_read_b128 v[168:171], v12 offset:51200
    ds_read_b128 v[172:175], v12 offset:52224
    s_add_u32 s75, s69, 163840
    buffer_load_dwordx4 v[176:179], v44, s[8:11], s75 offen sc1
    buffer_load_dwordx4 v[180:183], v45, s[8:11], s75 offen sc1
    buffer_load_dwordx4 v[184:187], v46, s[8:11], s75 offen sc1
    buffer_load_dwordx4 v[188:191], v47, s[8:11], s75 offen sc1
    buffer_load_dwordx4 v[192:195], v52, s[8:11], s75 offen sc1
    s_waitcnt vmcnt(5)
    s_lshl_b32 s6, s60, 5
    s_add_u32 s6, s6, s4
    s_lshl_b32 s6, s6, 7
    s_add_u32 s6, s6, 3932160
    v_mov_b32 v2, 1
    v_mov_b32 v3, 0x5000000
    v_writelane_b32 v3, s6, 0
    buffer_store_dword v2, v3, s[8:11], 0 offen sc1
    s_add_u32 s75, s69, 204800
    buffer_load_dwordx4 v[196:199], v44, s[8:11], s75 offen sc1
    buffer_load_dwordx4 v[200:203], v45, s[8:11], s75 offen sc1
    buffer_load_dwordx4 v[204:207], v46, s[8:11], s75 offen sc1
    buffer_load_dwordx4 v[208:211], v47, s[8:11], s75 offen sc1
    buffer_load_dwordx4 v[212:215], v52, s[8:11], s75 offen sc1
    s_add_u32 s75, s69, 245760
    buffer_load_dwordx4 v[216:219], v44, s[8:11], s75 offen sc1
    buffer_load_dwordx4 v[220:223], v45, s[8:11], s75 offen sc1
    buffer_load_dwordx4 v[224:227], v46, s[8:11], s75 offen sc1
    buffer_load_dwordx4 v[228:231], v47, s[8:11], s75 offen sc1
    buffer_load_dwordx4 v[232:235], v52, s[8:11], s75 offen sc1
    s_add_u32 s75, s69, 286720
    buffer_load_dwordx4 v[236:239], v44, s[8:11], s75 offen sc1
    buffer_load_dwordx4 v[240:243], v45, s[8:11], s75 offen sc1
    buffer_load_dwordx4 v[244:247], v46, s[8:11], s75 offen sc1
    buffer_load_dwordx4 v[248:251], v47, s[8:11], s75 offen sc1
    buffer_load_dwordx4 v[252:255], v52, s[8:11], s75 offen sc1
    s_waitcnt lgkmcnt(0)
    s_barrier
    s_branch L_adone
L_pre1:
    s_mov_b32 s28, s56
    s_mov_b32 s29, s57
    s_mov_b32 s30, 0x100
    s_mov_b32 s31, 0x20000
    v_and_b32 v3, 31, v1
    v_lshlrev_b32 v3, 2, v3
    s_mov_b32 s79, 262144
L_poll_24:
    buffer_load_dword v2, v3, s[28:31], 0 offen offset:128 sc1
    s_waitcnt vmcnt(0)
    v_cmp_gt_u32 vcc, 4, v2
    s_cbranch_vccz L_polldone_25
    s_sleep 8
    s_sub_u32 s79, s79, 1
    s_cmp_lg_u32 s79, 0
    s_cbranch_scc1 L_poll_24
L_polldone_25:
    s_mov_b32 s90, 1
    v_and_b32 v3, 7, v1
    v_lshlrev_b32 v3, 2, v3
    s_mov_b32 s72, 0x3a0000
    buffer_load_dword v51, v3, s[8:11], s72 offen sc1
    s_add_u32 s6, s76, 0
    s_and_b32 s6, s6, 3
    s_lshl_b32 s6, s6, 10
    v_add_u32 v44, s6, v13
    s_add_u32 s6, s76, 1
    s_and_b32 s6, s6, 3
    s_lshl_b32 s6, s6, 10
    v_add_u32 v45, s6, v13
    s_add_u32 s6, s76, 2
    s_and_b32 s6, s6, 3
    s_lshl_b32 s6, s6, 10
    v_add_u32 v46, s6, v13
    s_add_u32 s6, s76, 3
    s_and_b32 s6, s6, 3
    s_lshl_b32 s6, s6, 10
    v_add_u32 v47, s6, v13
    v_add_u32 v52, 4096, v13
    s_lshr_b32 s69, s4, 3
    s_lshl_b32 s69, s69, 2
    s_add_u32 s69, s69, s76
    s_mul_i32 s69, s69, 327680
    s_and_b32 s7, s4, 3
    s_mul_i32 s7, s7, 10240
    s_add_u32 s69, s69, s7
    s_add_u32 s69, s69, 4194304
    s_and_b32 s6, s4, 4
    s_lshr_b32 s7, s4, 3
    s_add_u32 s6, s6, s7
    s_lshl_b32 s7, s5, 3
    s_add_u32 s68, s6, s7
    s_sub_u32 s7, 120, s7
    s_add_u32 s61, s6, s7
    s_sub_i32 s6, s63, 4
    s_cmp_gt_i32 s62, s6
    s_cbranch_scc1 L_e2
    s_cmp_eq_i32 s62, s63
    s_cbranch_scc1 L_lw0
    s_waitcnt vmcnt(1)
L_lw0:
    s_waitcnt vmcnt(20)
    s_call_b64 s[82:83], L_pend
    s_barrier
    s_call_b64 s[82:83], L_load
    s_add_i32 s62, s62, 1
L_e2:
    s_add_u32 s75, s69, 0
    buffer_load_dwordx4 v[96:99], v44, s[8:11], s75 offen sc1
    buffer_load_dwordx4 v[100:103], v45, s[8:11], s75 offen sc1
    buffer_load_dwordx4 v[104:107], v46, s[8:11], s75 offen sc1
    buffer_load_dwordx4 v[108:111], v47, s[8:11], s75 offen sc1
    buffer_load_dwordx4 v[112:115], v52, s[8:11], s75 offen sc1
    s_add_u32 s75, s69, 40960
    buffer_load_dwordx4 v[116:119], v44, s[8:11], s75 offen sc1
    buffer_load_dwordx4 v[120:123], v45, s[8:11], s75 offen sc1
    buffer_load_dwordx4 v[124:127], v46, s[8:11], s75 offen sc1
    buffer_load_dwordx4 v[128:131], v47, s[8:11], s75 offen sc1
    buffer_load_dwordx4 v[132:135], v52, s[8:11], s75 offen sc1
    s_add_u32 s75, s69, 81920
    buffer_load_dwordx4 v[136:139], v44, s[8:11], s75 offen sc1
    buffer_load_dwordx4 v[140:143], v45, s[8:11], s75 offen sc1
    buffer_load_dwordx4 v[144:147], v46, s[8:11], s75 offen sc1
    buffer_load_dwordx4 v[148:151], v47, s[8:11], s75 offen sc1
    buffer_load_dwordx4 v[152:155], v52, s[8:11], s75 offen sc1
    s_cmp_gt_i32 s62, s63
    s_cbranch_scc1 L_e3
    s_cmp_eq_i32 s62, s63
    s_cbranch_scc1 L_lw1
    s_waitcnt vmcnt(15)
L_lw1:
    s_waitcnt vmcnt(20)
    s_call_b64 s[82:83], L_pend
    s_barrier
    s_call_b64 s[82:83], L_load
    s_add_i32 s62, s62, 1
L_e3:
    s_add_u32 s75, s69, 122880
    buffer_load_dwordx4 v[156:159], v44, s[8:11], s75 offen sc1
    buffer_load_dwordx4 v[160:163], v45, s[8:11], s75 offen sc1
    buffer_load_dwordx4 v[164:167], v46, s[8:11], s75 offen sc1
    buffer_load_dwordx4 v[168:171], v47, s[8:11], s75 offen sc1
    buffer_load_dwordx4 v[172:175], v52, s[8:11], s75 offen sc1
    s_add_u32 s75, s69, 163840
    buffer_load_dwordx4 v[176:179], v44, s[8:11], s75 offen sc1
    buffer_load_dwordx4 v[180:183], v45, s[8:11], s75 offen sc1
    buffer_load_dwordx4 v[184:187], v46, s[8:11], s75 offen sc1
    buffer_load_dwordx4 v[188:191], v47, s[8:11], s75 offen sc1
    buffer_load_dwordx4 v[192:195], v52, s[8:11], s75 offen sc1
    s_add_u32 s75, s69, 204800
    buffer_load_dwordx4 v[196:199], v44, s[8:11], s75 offen sc1
    buffer_load_dwordx4 v[200:203], v45, s[8:11], s75 offen sc1
    buffer_load_dwordx4 v[204:207], v46, s[8:11], s75 offen sc1
    buffer_load_dwordx4 v[208:211], v47, s[8:11], s75 offen sc1
    buffer_load_dwordx4 v[212:215], v52, s[8:11], s75 offen sc1
    s_cmp_gt_i32 s62, s63
    s_cbranch_scc1 L_e4
    s_cmp_eq_i32 s62, s63
    s_cbranch_scc1 L_lw2
    s_waitcnt vmcnt(15)
L_lw2:
    s_waitcnt vmcnt(20)
    s_call_b64 s[82:83], L_pend
    s_barrier
    s_call_b64 s[82:83], L_load
    s_add_i32 s62, s62, 1
L_e4:
    s_lshr_b32 s7, s3, 1
    s_lshl_b32 s7, s7, 4
    s_add_u32 s6, s5, s7
    s_cmp_lg_u32 s6, 3
    s_cbranch_scc1 L_yl0
    v_min_u32 v3, 53, v1
    v_lshlrev_b32 v3, 7, v3
    s_mov_b32 s72, 0xf20000
    buffer_load_dwordx4 v[16:19], v3, s[8:11], s72 offen sc1
L_yl0:
    s_add_u32 s75, s69, 245760
    buffer_load_dwordx4 v[216:219], v44, s[8:11], s75 offen sc1
    buffer_load_dwordx4 v[220:223], v45, s[8:11], s75 offen sc1
    buffer_load_dwordx4 v[224:227], v46, s[8:11], s75 offen sc1
    buffer_load_dwordx4 v[228:231], v47, s[8:11], s75 offen sc1
    buffer_load_dwordx4 v[232:235], v52, s[8:11], s75 offen sc1
    s_add_u32 s75, s69, 286720
    buffer_load_dwordx4 v[236:239], v44, s[8:11], s75 offen sc1
    buffer_load_dwordx4 v[240:243], v45, s[8:11], s75 offen sc1
    buffer_load_dwordx4 v[244:247], v46, s[8:11], s75 offen sc1
    buffer_load_dwordx4 v[248:251], v47, s[8:11], s75 offen sc1
    buffer_load_dwordx4 v[252:255], v52, s[8:11], s75 offen sc1
    s_cmp_gt_i32 s62, s63
    s_cbranch_scc1 L_e5
    s_cmp_eq_i32 s62, s63
    s_cbranch_scc1 L_lw3
    s_waitcnt vmcnt(10)
L_lw3:
    s_waitcnt vmcnt(20)
    s_call_b64 s[82:83], L_pend
    s_barrier
    s_call_b64 s[82:83], L_load
    s_add_i32 s62, s62, 1
L_e5:
    s_mov_b32 s101, 0
    s_lshr_b32 s7, s3, 1
    s_lshl_b32 s7, s7, 4
    s_add_u32 s6, s5, s7
    s_cmp_lg_u32 s6, 3
    s_cbranch_scc1 L_yl1
    v_and_b32 v16, v16, v17
    v_and_b32 v16, v16, v18
    v_and_b32 v16, v16, v19
    v_cmp_ne_u32 vcc, 1, v16
    s_cbranch_vccnz L_yl1
    s_call_b64 s[80:81], L_yld
L_yl1:
    v_and_b32 v3, 1, v1
    v_lshlrev_b32 v3, 12, v3
    v_and_b32 v2, 2, v1
    v_lshl_add_u32 v3, v2, 8, v3
    s_lshr_b32 s72, s68, 2
    s_lshl_b32 s72, s72, 6
    s_andn2_b32 s6, s4, 7
    s_add_u32 s72, s72, s6
    s_add_u32 s72, s72, s3
    s_lshl_b32 s72, s72, 7
    s_add_u32 s72, s72, 3932160
    buffer_load_dword v50, v3, s[8:11], s72 offen sc1
    s_cmp_gt_i32 s62, s63
    s_cbranch_scc1 L_e6
    s_waitcnt vmcnt(20)
    s_call_b64 s[82:83], L_pend
    s_barrier
    s_call_b64 s[82:83], L_load
    s_add_i32 s62, s62, 1
L_e6:
    s_lshr_b32 s7, s3, 1
    s_lshl_b32 s7, s7, 4
    s_add_u32 s6, s5, s7
    s_cmp_lg_u32 s6, 3
    s_cbranch_scc1 L_yd
    s_cmp_lg_u32 s101, 0
    s_cbranch_scc1 L_yf
    v_min_u32 v3, 53, v1
    v_lshlrev_b32 v3, 7, v3
    s_mov_b32 s72, 0xf20000
    s_mov_b32 s79, 262144
L_poll_31:
    buffer_load_dwordx4 v[16:19], v3, s[8:11], s72 offen sc1
    s_waitcnt vmcnt(0)
    v_and_b32 v16, v16, v17
    v_and_b32 v16, v16, v18
    v_and_b32 v16, v16, v19
    v_cmp_ne_u32 vcc, 1, v16
    s_cbranch_vccz L_polldone_32
    s_sleep 16
    s_sub_u32 s79, s79, 1
    s_cmp_lg_u32 s79, 0
    s_cbranch_scc1 L_poll_31
L_polldone_32:
    s_call_b64 s[80:81], L_yld
L_yf:
    s_bfe_u32 s6, s98, 0x10000b
    s_xor_b32 s7, s6, 0xffff
    s_bitcmp1_b32 s6, 15
    s_bitset0_b32 s6, 15
    s_cselect_b32 s6, s6, s7
    s_lshl_b32 s6, s6, 16
    v_mov_b32 v9, s6
    v_mul_f32 v9, 0xbfb8aa3b, v9
    v_exp_f32 v9, v9
    s_nop 0
    v_add_f32 v9, 1.0, v9
    v_rcp_f32 v9, v9
    s_nop 0
    v_cvt_pk_bf16_f32 v9, v9, v9
    v_lshlrev_b32 v9, 16, v9
    v_lshlrev_b32 v10, 2, v1
    v_mov_b32 v3, 0x5000000
    s_waitcnt vmcnt(0)
    v_pk_add_f32 v[16:17], v[16:17], v[20:21]
    v_pk_add_f32 v[18:19], v[18:19], v[22:23]
    v_pk_add_f32 v[16:17], v[16:17], v[24:25]
    v_pk_add_f32 v[18:19], v[18:19], v[26:27]
    v_pk_add_f32 v[16:17], v[16:17], v[28:29]
    v_pk_add_f32 v[18:19], v[18:19], v[30:31]
    v_pk_add_f32 v[16:17], v[16:17], v[32:33]
    v_pk_add_f32 v[18:19], v[18:19], v[34:35]
    v_pk_add_f32 v[16:17], v[16:17], v[36:37]
    v_pk_add_f32 v[18:19], v[18:19], v[38:39]
    v_pk_add_f32 v[16:17], v[16:17], v[40:41]
    v_pk_add_f32 v[18:19], v[18:19], v[42:43]
    v_pk_add_f32 v[16:17], v[16:17], v[56:57]
    v_pk_add_f32 v[18:19], v[18:19], v[58:59]
    v_pk_add_f32 v[16:17], v[16:17], v[60:61]
    v_pk_add_f32 v[18:19], v[18:19], v[62:63]
    v_pk_add_f32 v[16:17], v[16:17], v[64:65]
    v_pk_add_f32 v[18:19], v[18:19], v[66:67]
    v_pk_add_f32 v[16:17], v[16:17], v[68:69]
    v_pk_add_f32 v[18:19], v[18:19], v[70:71]
    v_pk_add_f32 v[16:17], v[16:17], v[72:73]
    v_pk_add_f32 v[18:19], v[18:19], v[74:75]
    v_pk_add_f32 v[16:17], v[16:17], v[76:77]
    v_pk_add_f32 v[18:19], v[18:19], v[78:79]
    v_pk_add_f32 v[16:17], v[16:17], v[80:81]
    v_pk_add_f32 v[18:19], v[18:19], v[82:83]
    v_pk_add_f32 v[16:17], v[16:17], v[84:85]
    v_pk_add_f32 v[18:19], v[18:19], v[86:87]
    v_pk_add_f32 v[16:17], v[16:17], v[88:89]
    v_pk_add_f32 v[18:19], v[18:19], v[90:91]
    v_pk_add_f32 v[16:17], v[16:17], v[92:93]
    v_pk_add_f32 v[18:19], v[18:19], v[94:95]
    v_pk_add_f32 v[16:17], v[16:17], v[4:5]
    v_pk_add_f32 v[18:19], v[18:19], v[6:7]
    ds_bpermute_b32 v20, v10, v16 offset:80
    ds_bpermute_b32 v21, v10, v17 offset:80
    ds_bpermute_b32 v22, v10, v18 offset:80
    ds_bpermute_b32 v23, v10, v19 offset:80
    ds_bpermute_b32 v24, v10, v16 offset:160
    ds_bpermute_b32 v25, v10, v17 offset:160
    ds_bpermute_b32 v26, v10, v18 offset:160
    ds_bpermute_b32 v27, v10, v19 offset:160
    s_waitcnt lgkmcnt(0)
    v_add_f32 v16, v16, v20
    v_add_f32 v16, v16, v24
    v_cvt_pk_bf16_f32 v16, v16, v16
    v_lshlrev_b32 v16, 16, v16
    v_mul_f32 v16, v16, v9
    v_cvt_pk_bf16_f32 v16, v16, v16
    v_lshlrev_b32 v16, 16, v16
    v_lshlrev_b32 v8, 16, v54
    v_add_f32 v16, v16, v8
    v_add_f32 v17, v17, v21
    v_add_f32 v17, v17, v25
    v_cvt_pk_bf16_f32 v17, v17, v17
    v_lshlrev_b32 v17, 16, v17
    v_mul_f32 v17, v17, v9
    v_cvt_pk_bf16_f32 v17, v17, v17
    v_lshlrev_b32 v17, 16, v17
    v_and_b32 v8, 0xffff0000, v54
    v_add_f32 v17, v17, v8
    v_add_f32 v18, v18, v22
    v_add_f32 v18, v18, v26
    v_cvt_pk_bf16_f32 v18, v18, v18
    v_lshlrev_b32 v18, 16, v18
    v_mul_f32 v18, v18, v9
    v_cvt_pk_bf16_f32 v18, v18, v18
    v_lshlrev_b32 v18, 16, v18
    v_lshlrev_b32 v8, 16, v55
    v_add_f32 v18, v18, v8
    v_add_f32 v19, v19, v23
    v_add_f32 v19, v19, v27
    v_cvt_pk_bf16_f32 v19, v19, v19
    v_lshlrev_b32 v19, 16, v19
    v_mul_f32 v19, v19, v9
    v_cvt_pk_bf16_f32 v19, v19, v19
    v_lshlrev_b32 v19, 16, v19
    v_and_b32 v8, 0xffff0000, v55
    v_add_f32 v19, v19, v8
    v_cvt_pk_bf16_f32 v20, v16, v17
    v_cvt_pk_bf16_f32 v21, v18, v19
    v_lshlrev_b32 v2, 3, v1
    v_cmp_lt_u32 vcc, 19, v1
    s_mul_i32 s6, s96, 1280
    s_mul_i32 s7, s97, 160
    v_cndmask_b32 v2, v2, v3, vcc
    s_add_u32 s6, s6, s7
    s_add_u32 s6, s6, 3837952
    buffer_store_dwordx2 v[20:21], v2, s[8:11], s6 offen sc1
L_yd:
    s_lshr_b32 s6, s4, 3
    s_lshl_b32 s6, s6, 15
    s_lshl_b32 s99, s3, 12
    s_add_u32 s66, s6, s99
    s_add_u32 s66, s66, 50331648
    s_lshl_b32 s6, s76, 13
    v_add_u32 v4, s6, v13
    v_add_u32 v7, 65536, v4
    s_waitcnt vmcnt(0)
    v_cmp_ne_u32 vcc, 1, v50
    s_cbranch_vccz L_ce
    v_and_b32 v3, 1, v1
    v_lshlrev_b32 v3, 12, v3
    v_and_b32 v2, 2, v1
    v_lshl_add_u32 v3, v2, 8, v3
    s_lshr_b32 s72, s68, 2
    s_lshl_b32 s72, s72, 6
    s_andn2_b32 s6, s4, 7
    s_add_u32 s72, s72, s6
    s_add_u32 s72, s72, s3
    s_lshl_b32 s72, s72, 7
    s_add_u32 s72, s72, 3932160
    s_mov_b32 s79, 262144
L_poll_33:
    buffer_load_dword v2, v3, s[8:11], s72 offen sc1
    s_waitcnt vmcnt(0)
    v_cmp_ne_u32 vcc, 1, v2
    s_cbranch_vccz L_polldone_34
    s_sleep 4
    s_sub_u32 s79, s79, 1
    s_cmp_lg_u32 s79, 0
    s_cbranch_scc1 L_poll_33
L_polldone_34:
L_ce:
    s_add_u32 s65, s68, 1
    s_and_b32 s65, s65, 3
    s_andn2_b32 s7, s68, 3
    s_add_u32 s65, s65, s7
    s_lshl_b32 s65, s65, 17
    s_add_u32 s65, s65, s66
    s_add_u32 m0, s99, 0
    s_add_u32 s65, s65, 0
    buffer_load_dwordx4 v13, s[8:11], s65 offen offset:0 sc1 lds
    buffer_load_dwordx4 v13, s[8:11], s65 offen offset:1024 sc1 lds
    buffer_load_dwordx4 v13, s[8:11], s65 offen offset:2048 sc1 lds
    buffer_load_dwordx4 v13, s[8:11], s65 offen offset:3072 sc1 lds
    s_add_u32 s65, s68, 1
    s_and_b32 s65, s65, 3
    s_andn2_b32 s7, s68, 3
    s_add_u32 s65, s65, s7
    s_lshl_b32 s65, s65, 17
    s_add_u32 s65, s65, s66
    s_add_u32 m0, s99, 16384
    s_add_u32 s65, s65, 16384
    buffer_load_dwordx4 v13, s[8:11], s65 offen offset:0 sc1 lds
    buffer_load_dwordx4 v13, s[8:11], s65 offen offset:1024 sc1 lds
    buffer_load_dwordx4 v13, s[8:11], s65 offen offset:2048 sc1 lds
    buffer_load_dwordx4 v13, s[8:11], s65 offen offset:3072 sc1 lds
    s_add_u32 s65, s68, 2
    s_and_b32 s65, s65, 3
    s_andn2_b32 s7, s68, 3
    s_add_u32 s65, s65, s7
    s_lshl_b32 s65, s65, 17
    s_add_u32 s65, s65, s66
    s_add_u32 m0, s99, 32768
    s_add_u32 s65, s65, 0
    buffer_load_dwordx4 v13, s[8:11], s65 offen offset:0 sc1 lds
    buffer_load_dwordx4 v13, s[8:11], s65 offen offset:1024 sc1 lds
    buffer_load_dwordx4 v13, s[8:11], s65 offen offset:2048 sc1 lds
    buffer_load_dwordx4 v13, s[8:11], s65 offen offset:3072 sc1 lds
    s_add_u32 s65, s68, 2
    s_and_b32 s65, s65, 3
    s_andn2_b32 s7, s68, 3
    s_add_u32 s65, s65, s7
    s_lshl_b32 s65, s65, 17
    s_add_u32 s65, s65, s66
    s_add_u32 m0, s99, 49152
    s_add_u32 s65, s65, 16384
    buffer_load_dwordx4 v13, s[8:11], s65 offen offset:0 sc1 lds
    buffer_load_dwordx4 v13, s[8:11], s65 offen offset:1024 sc1 lds
    buffer_load_dwordx4 v13, s[8:11], s65 offen offset:2048 sc1 lds
    buffer_load_dwordx4 v13, s[8:11], s65 offen offset:3072 sc1 lds
    s_lshr_b32 s7, s3, 1
    s_lshl_b32 s7, s7, 4
    s_add_u32 s6, s5, s7
    s_cmp_lg_u32 s6, 3
    s_cbranch_scc1 L_yg
    s_lshl_b32 s6, s5, 5
    s_add_u32 s6, s6, s4
    s_lshl_b32 s6, s6, 5
    s_add_u32 s6, s6, s3
    s_lshl_b32 s6, s6, 2
    s_add_u32 s6, s6, 3899392
    v_mov_b32 v2, 1
    v_mov_b32 v3, 0x5000000
    v_writelane_b32 v3, s6, 0
    buffer_store_dword v2, v3, s[8:11], 0 offen sc1
    s_waitcnt vmcnt(1)
    s_branch L_ye
L_yg:
    s_waitcnt vmcnt(0)
L_ye:
    s_setprio 0
    s_barrier
    s_branch L_adone
L_yld:
    v_cmp_le_i32 vcc, 0, v51
    s_cbranch_vccz L_idx_oka
    v_and_b32 v3, 7, v1
    v_lshlrev_b32 v3, 2, v3
    s_mov_b32 s72, 0x3a0000
    s_mov_b32 s79, 262144
L_poll_35:
    buffer_load_dword v51, v3, s[8:11], s72 offen sc1
    s_waitcnt vmcnt(0)
    v_cmp_le_i32 vcc, 0, v51
    s_cbranch_vccz L_polldone_36
    s_sleep 2
    s_sub_u32 s79, s79, 1
    s_cmp_lg_u32 s79, 0
    s_cbranch_scc1 L_poll_35
L_polldone_36:
L_idx_oka:
    s_lshr_b32 s96, s4, 2
    s_and_b32 s97, s4, 3
    s_lshl_b32 s97, s97, 1
    s_add_u32 s97, s97, s3
    s_mov_b32 m0, s96
    s_nop 3
    v_readlane_b32 s98, v51, m0
    s_nop 3
    s_and_b32 s100, s98, 0x7ff
    s_sub_u32 s100, 0x7ff, s100
    v_mul_u32_u24 v2, 13, v1
    v_lshrrev_b32 v2, 8, v2
    v_mul_u32_u24 v3, 20, v2
    v_sub_u32 v8, v1, v3
    s_mov_b32 s6, 368640
    v_mul_lo_u32 v2, v2, s6
    v_lshl_add_u32 v2, v8, 4, v2
    v_cmp_lt_u32 vcc, 59, v1
    v_mov_b32 v3, 0x5000000
    s_nop 0
    v_cndmask_b32 v2, v2, v3, vcc
    s_mul_i32 s6, s96, 2560
    s_mul_i32 s7, s97, 320
    s_add_u32 s6, s6, s7
    s_add_u32 s6, s6, 2686976
    buffer_load_dwordx4 v[16:19], v2, s[8:11], s6 offen sc1
    s_add_u32 s6, s6, 20480
    buffer_load_dwordx4 v[20:23], v2, s[8:11], s6 offen sc1
    s_add_u32 s6, s6, 20480
    buffer_load_dwordx4 v[24:27], v2, s[8:11], s6 offen sc1
    s_add_u32 s6, s6, 20480
    buffer_load_dwordx4 v[28:31], v2, s[8:11], s6 offen sc1
    s_add_u32 s6, s6, 20480
    buffer_load_dwordx4 v[32:35], v2, s[8:11], s6 offen sc1
    s_add_u32 s6, s6, 20480
    buffer_load_dwordx4 v[36:39], v2, s[8:11], s6 offen sc1
    s_add_u32 s6, s6, 20480
    buffer_load_dwordx4 v[40:43], v2, s[8:11], s6 offen sc1
    s_add_u32 s6, s6, 20480
    buffer_load_dwordx4 v[56:59], v2, s[8:11], s6 offen sc1
    s_add_u32 s6, s6, 20480
    buffer_load_dwordx4 v[60:63], v2, s[8:11], s6 offen sc1
    s_add_u32 s6, s6, 20480
    buffer_load_dwordx4 v[64:67], v2, s[8:11], s6 offen sc1
    s_add_u32 s6, s6, 20480
    buffer_load_dwordx4 v[68:71], v2, s[8:11], s6 offen sc1
    s_add_u32 s6, s6, 20480
    buffer_load_dwordx4 v[72:75], v2, s[8:11], s6 offen sc1
    s_add_u32 s6, s6, 20480
    buffer_load_dwordx4 v[76:79], v2, s[8:11], s6 offen sc1
    s_add_u32 s6, s6, 20480
    buffer_load_dwordx4 v[80:83], v2, s[8:11], s6 offen sc1
    s_add_u32 s6, s6, 20480
    buffer_load_dwordx4 v[84:87], v2, s[8:11], s6 offen sc1
    s_add_u32 s6, s6, 20480
    buffer_load_dwordx4 v[88:91], v2, s[8:11], s6 offen sc1
    s_add_u32 s6, s6, 20480
    buffer_load_dwordx4 v[92:95], v2, s[8:11], s6 offen sc1
    s_add_u32 s6, s6, 20480
    buffer_load_dwordx4 v[4:7], v2, s[8:11], s6 offen sc1
    s_add_u32 s6, s6, 20480
    s_lshr_b32 s6, s100, 4
    s_mul_i32 s6, s6, 20480
    s_and_b32 s7, s100, 15
    s_lshl_b32 s7, s7, 4
    s_add_u32 s6, s6, s7
    s_mul_i32 s7, s97, 2560
    s_add_u32 s6, s6, s7
    v_lshrrev_b32 v9, 1, v8
    v_lshlrev_b32 v9, 8, v9
    v_and_b32 v10, 1, v8
    v_lshl_add_u32 v9, v10, 3, v9
    buffer_load_dwordx2 v[54:55], v9, s[8:11], s6 offen sc1
    s_mov_b32 s101, 1
    s_setpc_b64 s[80:81]
L_moe:
    s_sub_u32 s6, s62, s5
    s_cmp_lg_u32 s6, 3
    s_cbranch_scc1 L_idle
    s_mov_b32 s12, s48
    s_mov_b32 s13, s49
    s_mov_b32 s14, 0x21c000
    s_mov_b32 s15, 0x20000
    s_cmp_ge_u32 s3, 2
    s_cselect_b32 s12, s50, s12
    s_cselect_b32 s13, s51, s13
    s_mov_b32 s16, s52
    s_mov_b32 s17, s53
    s_mov_b32 s18, 0x21c000
    s_mov_b32 s19, 0x20000
    v_lshrrev_b32 v3, 2, v1
    v_mul_u32_u24 v3, 3456, v3
    v_and_b32 v4, 3, v1
    v_lshl_add_u32 v16, v4, 4, v3
    v_lshrrev_b32 v3, 3, v1
    v_mul_u32_u24 v3, 1280, v3
    v_and_b32 v4, 7, v1
    v_lshl_add_u32 v18, v4, 4, v3
    s_and_b32 s7, s3, 1
    s_mul_i32 s84, s7, 1105920
    s_lshl_b32 s6, s61, 6
    s_add_u32 s84, s84, s6
    s_lshl_b32 s85, s3, 13
    s_add_u32 s85, s85, 131072
    s_mul_i32 s86, s61, 40960
    s_lshl_b32 s6, s3, 7
    s_add_u32 s86, s86, s6
    s_add_u32 m0, s85, 0
    s_nop 0
    buffer_load_dwordx4 v16, s[12:15], s84 offen lds
    s_add_u32 s84, s84, 55296
    s_add_u32 m0, s85, 1024
    s_nop 0
    buffer_load_dwordx4 v16, s[12:15], s84 offen lds
    s_add_u32 s84, s84, 55296
    s_add_u32 m0, s85, 2048
    s_nop 0
    buffer_load_dwordx4 v16, s[12:15], s84 offen lds
    s_add_u32 s84, s84, 55296
    s_add_u32 m0, s85, 3072
    s_nop 0
    buffer_load_dwordx4 v16, s[12:15], s84 offen lds
    s_add_u32 s84, s84, 55296
    s_add_u32 m0, s85, 4096
    s_nop 0
    buffer_load_dwordx4 v16, s[12:15], s84 offen lds
    s_add_u32 s84, s84, 55296
    s_add_u32 m0, s85, 5120
    s_nop 0
    buffer_load_dwordx4 v16, s[12:15], s84 offen lds
    s_add_u32 s84, s84, 55296
    s_add_u32 m0, s85, 6144
    s_nop 0
    buffer_load_dwordx4 v16, s[12:15], s84 offen lds
    s_add_u32 s84, s84, 55296
    s_add_u32 m0, s85, 7168
    s_nop 0
    buffer_load_dwordx4 v16, s[12:15], s84 offen lds
    s_add_u32 s84, s84, 55296
    v_lshrrev_b32 v7, 4, v1
    v_and_b32 v2, 15, v1
    v_lshrrev_b32 v3, 2, v2
    v_lshl_add_u32 v8, v7, 3, v3
    v_lshlrev_b32 v8, 6, v8
    v_and_b32 v4, 3, v2
    v_lshl_add_u32 v8, v4, 3, v8
    v_add_u32 v17, s85, v8
    v_lshl_add_u32 v8, v7, 2, v3
    v_lshlrev_b32 v8, 7, v8
    v_lshl_add_u32 v8, v4, 3, v8
    s_add_u32 s6, s85, 4096
    v_add_u32 v19, s6, v8
    v_mul_u32_u24 v3, 2560, v2
    v_lshl_add_u32 v3, v7, 4, v3
    v_mov_b32 v4, 0x5000000
    v_cmp_gt_u32 vcc, 8, v2
    s_mul_i32 s87, s61, 20480
    s_lshl_b32 s7, s3, 8
    s_add_u32 s87, s87, s7
    s_add_u32 s87, s87, 2686976
    v_cndmask_b32 v20, v4, v3, vcc
    s_and_b32 s7, s3, 1
    s_mul_i32 s88, s7, 10240
    s_add_u32 s88, s88, 12582912
    s_waitcnt vmcnt(0) lgkmcnt(0)
    s_call_b64 s[82:83], L_pend
    s_barrier
    ds_read_b64_tr_b16 v[104:105], v17 offset:0
    ds_read_b64_tr_b16 v[106:107], v17 offset:256
    ds_read_b64_tr_b16 v[108:109], v17 offset:32
    ds_read_b64_tr_b16 v[110:111], v17 offset:288
    ds_read_b64_tr_b16 v[112:113], v17 offset:2048
    ds_read_b64_tr_b16 v[114:115], v17 offset:2304
    ds_read_b64_tr_b16 v[116:117], v17 offset:2080
    ds_read_b64_tr_b16 v[118:119], v17 offset:2336
    s_waitcnt lgkmcnt(0)
    ds_read_b64_tr_b16 v[120:121], v17 offset:4096
    ds_read_b64_tr_b16 v[122:123], v17 offset:4352
    ds_read_b64_tr_b16 v[124:125], v17 offset:4128
    ds_read_b64_tr_b16 v[126:127], v17 offset:4384
    ds_read_b64_tr_b16 v[128:129], v17 offset:6144
    ds_read_b64_tr_b16 v[130:131], v17 offset:6400
    ds_read_b64_tr_b16 v[132:133], v17 offset:6176
    ds_read_b64_tr_b16 v[134:135], v17 offset:6432
    s_waitcnt lgkmcnt(0)
    s_add_u32 m0, s85, 0
    s_nop 0
    buffer_load_dwordx4 v16, s[12:15], s84 offen lds
    s_add_u32 s84, s84, 55296
    s_add_u32 m0, s85, 1024
    s_nop 0
    buffer_load_dwordx4 v16, s[12:15], s84 offen lds
    s_add_u32 s84, s84, 55296
    s_add_u32 m0, s85, 2048
    s_nop 0
    buffer_load_dwordx4 v16, s[12:15], s84 offen lds
    s_add_u32 s84, s84, 55296
    s_add_u32 m0, s85, 3072
    s_nop 0
    buffer_load_dwordx4 v16, s[12:15], s84 offen lds
    s_add_u32 s84, s84, 55296
    s_add_u32 m0, s85, 4096
    s_nop 0
    buffer_load_dwordx4 v16, s[12:15], s84 offen lds
    s_add_u32 s84, s84, 55296
    s_add_u32 m0, s85, 5120
    s_nop 0
    buffer_load_dwordx4 v16, s[12:15], s84 offen lds
    s_add_u32 s84, s84, 55296
    s_add_u32 m0, s85, 6144
    s_nop 0
    buffer_load_dwordx4 v16, s[12:15], s84 offen lds
    s_add_u32 s84, s84, 55296
    s_add_u32 m0, s85, 7168
    s_nop 0
    buffer_load_dwordx4 v16, s[12:15], s84 offen lds
    s_add_u32 s84, s84, 55296
    s_call_b64 s[82:83], L_load
    s_add_i32 s62, s62, 1
    v_and_b32 v3, 7, v1
    v_lshlrev_b32 v3, 2, v3
    s_mov_b32 s72, 0x3a0000
    buffer_load_dword v51, v3, s[8:11], s72 offen sc1
    s_waitcnt vmcnt(0) lgkmcnt(0)
    s_call_b64 s[82:83], L_pend
    s_barrier
    ds_read_b64_tr_b16 v[136:137], v17 offset:0
    ds_read_b64_tr_b16 v[138:139], v17 offset:256
    ds_read_b64_tr_b16 v[140:141], v17 offset:32
    ds_read_b64_tr_b16 v[142:143], v17 offset:288
    ds_read_b64_tr_b16 v[144:145], v17 offset:2048
    ds_read_b64_tr_b16 v[146:147], v17 offset:2304
    ds_read_b64_tr_b16 v[148:149], v17 offset:2080
    ds_read_b64_tr_b16 v[150:151], v17 offset:2336
    s_waitcnt lgkmcnt(0)
    ds_read_b64_tr_b16 v[152:153], v17 offset:4096
    ds_read_b64_tr_b16 v[154:155], v17 offset:4352
    ds_read_b64_tr_b16 v[156:157], v17 offset:4128
    ds_read_b64_tr_b16 v[158:159], v17 offset:4384
    ds_read_b64_tr_b16 v[160:161], v17 offset:6144
    ds_read_b64_tr_b16 v[162:163], v17 offset:6400
    ds_read_b64_tr_b16 v[164:165], v17 offset:6176
    ds_read_b64_tr_b16 v[166:167], v17 offset:6432
    s_waitcnt lgkmcnt(0)
    s_add_u32 m0, s85, 0
    s_nop 0
    buffer_load_dwordx4 v16, s[12:15], s84 offen lds
    s_add_u32 s84, s84, 55296
    s_add_u32 m0, s85, 1024
    s_nop 0
    buffer_load_dwordx4 v16, s[12:15], s84 offen lds
    s_add_u32 s84, s84, 55296
    s_add_u32 m0, s85, 2048
    s_nop 0
    buffer_load_dwordx4 v16, s[12:15], s84 offen lds
    s_add_u32 s84, s84, 55296
    s_add_u32 m0, s85, 3072
    s_nop 0
    buffer_load_dwordx4 v16, s[12:15], s84 offen lds
    s_add_u32 s84, s84, 55296
    s_add_u32 m0, s85, 4096
    s_add_u32 s6, s86, 0
    buffer_load_dwordx4 v18, s[16:19], s6 offen lds
    s_add_u32 m0, s85, 5120
    s_add_u32 s6, s86, 10240
    buffer_load_dwordx4 v18, s[16:19], s6 offen lds
    s_add_u32 m0, s85, 6144
    s_add_u32 s6, s86, 20480
    buffer_load_dwordx4 v18, s[16:19], s6 offen lds
    s_add_u32 m0, s85, 7168
    s_add_u32 s6, s86, 30720
    buffer_load_dwordx4 v18, s[16:19], s6 offen lds
    s_add_u32 s86, s86, 512
    s_call_b64 s[82:83], L_load
    s_add_i32 s62, s62, 1
    v_cmp_le_i32 vcc, 0, v51
    s_cbranch_vccz L_idx_okm
    v_and_b32 v3, 7, v1
    v_lshlrev_b32 v3, 2, v3
    s_mov_b32 s72, 0x3a0000
    s_mov_b32 s79, 262144
L_poll_39:
    buffer_load_dword v51, v3, s[8:11], s72 offen sc1
    s_waitcnt vmcnt(0)
    v_cmp_le_i32 vcc, 0, v51
    s_cbranch_vccz L_polldone_40
    s_sleep 2
    s_sub_u32 s79, s79, 1
    s_cmp_lg_u32 s79, 0
    s_cbranch_scc1 L_poll_39
L_polldone_40:
L_idx_okm:
    buffer_load_dwordx4 v[64:67], v13, s[8:11], s88 offen sc1
    s_add_u32 s88, s88, 1024
    buffer_load_dwordx4 v[68:71], v13, s[8:11], s88 offen sc1
    s_add_u32 s88, s88, 1024
    buffer_load_dwordx4 v[72:75], v13, s[8:11], s88 offen sc1
    s_add_u32 s88, s88, 1024
    buffer_load_dwordx4 v[76:79], v13, s[8:11], s88 offen sc1
    s_add_u32 s88, s88, 1024
    buffer_load_dwordx4 v[80:83], v13, s[8:11], s88 offen sc1
    s_add_u32 s88, s88, 1024
    buffer_load_dwordx4 v[84:87], v13, s[8:11], s88 offen sc1
    s_add_u32 s88, s88, 1024
    buffer_load_dwordx4 v[88:91], v13, s[8:11], s88 offen sc1
    s_add_u32 s88, s88, 1024
    buffer_load_dwordx4 v[92:95], v13, s[8:11], s88 offen sc1
    s_add_u32 s88, s88, 1024
    buffer_load_dwordx4 v[96:99], v13, s[8:11], s88 offen sc1
    s_add_u32 s88, s88, 1024
    buffer_load_dwordx4 v[100:103], v13, s[8:11], s88 offen sc1
    s_add_u32 s88, s88, 1024
    s_waitcnt vmcnt(10) lgkmcnt(0)
    s_call_b64 s[82:83], L_pend
    s_barrier
    ds_read_b64_tr_b16 v[168:169], v17 offset:0
    ds_read_b64_tr_b16 v[170:171], v17 offset:256
    ds_read_b64_tr_b16 v[172:173], v17 offset:32
    ds_read_b64_tr_b16 v[174:175], v17 offset:288
    ds_read_b64_tr_b16 v[176:177], v17 offset:2048
    ds_read_b64_tr_b16 v[178:179], v17 offset:2304
    ds_read_b64_tr_b16 v[180:181], v17 offset:2080
    ds_read_b64_tr_b16 v[182:183], v17 offset:2336
    s_waitcnt lgkmcnt(0)
    ds_read_b64_tr_b16 v[32:33], v19 offset:0
    ds_read_b64_tr_b16 v[34:35], v19 offset:2048
    ds_read_b64_tr_b16 v[36:37], v19 offset:32
    ds_read_b64_tr_b16 v[38:39], v19 offset:2080
    ds_read_b64_tr_b16 v[40:41], v19 offset:64
    ds_read_b64_tr_b16 v[42:43], v19 offset:2112
    ds_read_b64_tr_b16 v[44:45], v19 offset:96
    ds_read_b64_tr_b16 v[46:47], v19 offset:2144
    s_waitcnt lgkmcnt(0)
    s_add_u32 m0, s85, 4096
    s_add_u32 s6, s86, 0
    buffer_load_dwordx4 v18, s[16:19], s6 offen lds
    s_add_u32 m0, s85, 5120
    s_add_u32 s6, s86, 10240
    buffer_load_dwordx4 v18, s[16:19], s6 offen lds
    s_add_u32 m0, s85, 6144
    s_add_u32 s6, s86, 20480
    buffer_load_dwordx4 v18, s[16:19], s6 offen lds
    s_add_u32 m0, s85, 7168
    s_add_u32 s6, s86, 30720
    buffer_load_dwordx4 v18, s[16:19], s6 offen lds
    s_add_u32 s86, s86, 512
    s_call_b64 s[82:83], L_load
    s_add_i32 s62, s62, 1
    s_waitcnt vmcnt(20)
    v_mfma_f32_16x16x32_bf16 v[24:27], v[104:107], v[64:67], 0
    v_mfma_f32_16x16x32_bf16 v[28:31], v[108:111], v[64:67], 0
    v_mfma_f32_16x16x32_bf16 v[24:27], v[112:115], v[68:71], v[24:27]
    v_mfma_f32_16x16x32_bf16 v[28:31], v[116:119], v[68:71], v[28:31]
    v_mfma_f32_16x16x32_bf16 v[24:27], v[120:123], v[72:75], v[24:27]
    v_mfma_f32_16x16x32_bf16 v[28:31], v[124:127], v[72:75], v[28:31]
    v_mfma_f32_16x16x32_bf16 v[24:27], v[128:131], v[76:79], v[24:27]
    v_mfma_f32_16x16x32_bf16 v[28:31], v[132:135], v[76:79], v[28:31]
    v_mfma_f32_16x16x32_bf16 v[24:27], v[136:139], v[80:83], v[24:27]
    v_mfma_f32_16x16x32_bf16 v[28:31], v[140:143], v[80:83], v[28:31]
    v_mfma_f32_16x16x32_bf16 v[24:27], v[144:147], v[84:87], v[24:27]
    v_mfma_f32_16x16x32_bf16 v[28:31], v[148:151], v[84:87], v[28:31]
    v_mfma_f32_16x16x32_bf16 v[24:27], v[152:155], v[88:91], v[24:27]
    v_mfma_f32_16x16x32_bf16 v[28:31], v[156:159], v[88:91], v[28:31]
    v_mfma_f32_16x16x32_bf16 v[24:27], v[160:163], v[92:95], v[24:27]
    v_mfma_f32_16x16x32_bf16 v[28:31], v[164:167], v[92:95], v[28:31]
    v_mfma_f32_16x16x32_bf16 v[24:27], v[168:171], v[96:99], v[24:27]
    v_mfma_f32_16x16x32_bf16 v[28:31], v[172:175], v[96:99], v[28:31]
    v_mfma_f32_16x16x32_bf16 v[24:27], v[176:179], v[100:103], v[24:27]
    v_mfma_f32_16x16x32_bf16 v[28:31], v[180:183], v[100:103], v[28:31]
    v_add_u32 v10, s85, v13
    s_nop 7
    ds_write_b128 v10, v[24:27]
    ds_write_b128 v10, v[28:31] offset:1024
    s_waitcnt vmcnt(0) lgkmcnt(0)
    s_call_b64 s[82:83], L_pend
    s_barrier
    ds_read_b64_tr_b16 v[240:241], v19 offset:0
    ds_read_b64_tr_b16 v[242:243], v19 offset:2048
    ds_read_b64_tr_b16 v[244:245], v19 offset:32
    ds_read_b64_tr_b16 v[246:247], v19 offset:2080
    ds_read_b64_tr_b16 v[248:249], v19 offset:64
    ds_read_b64_tr_b16 v[250:251], v19 offset:2112
    ds_read_b64_tr_b16 v[252:253], v19 offset:96
    ds_read_b64_tr_b16 v[254:255], v19 offset:2144
    v_add_u32 v10, 131072, v13
    s_waitcnt lgkmcnt(0)
    ds_read_b128 v[184:187], v10 offset:0
    ds_read_b128 v[188:191], v10 offset:1024
    ds_read_b128 v[192:195], v10 offset:8192
    ds_read_b128 v[196:199], v10 offset:9216
    ds_read_b128 v[200:203], v10 offset:16384
    ds_read_b128 v[204:207], v10 offset:17408
    ds_read_b128 v[208:211], v10 offset:24576
    ds_read_b128 v[212:215], v10 offset:25600
    s_cmp_ge_u32 s3, 2
    s_cbranch_scc1 L_moe4b
    s_add_u32 m0, s85, 4096
    s_add_u32 s6, s86, 0
    buffer_load_dwordx4 v18, s[16:19], s6 offen lds
    s_add_u32 m0, s85, 5120
    s_add_u32 s6, s86, 10240
    buffer_load_dwordx4 v18, s[16:19], s6 offen lds
    s_add_u32 m0, s85, 6144
    s_add_u32 s6, s86, 20480
    buffer_load_dwordx4 v18, s[16:19], s6 offen lds
    s_add_u32 m0, s85, 7168
    s_add_u32 s6, s86, 30720
    buffer_load_dwordx4 v18, s[16:19], s6 offen lds
    s_add_u32 s86, s86, 512
L_moe4b:
    s_call_b64 s[82:83], L_load
    s_add_i32 s62, s62, 1
    s_waitcnt lgkmcnt(0)
    s_mov_b32 s6, 0xbfb8aa3b
    v_add_f32 v184, v184, v192
    v_add_f32 v200, v200, v208
    v_add_f32 v185, v185, v193
    v_add_f32 v201, v201, v209
    v_cvt_pk_bf16_f32 v185, v184, v185
    v_lshlrev_b32 v184, 16, v185
    v_and_b32 v185, 0xffff0000, v185
    v_cvt_pk_bf16_f32 v201, v200, v201
    v_lshlrev_b32 v200, 16, v201
    v_and_b32 v201, 0xffff0000, v201
    v_mul_f32 v2, s6, v184
    v_mul_f32 v3, s6, v185
    v_exp_f32 v2, v2
    v_exp_f32 v3, v3
    s_nop 0
    v_add_f32 v2, 1.0, v2
    v_add_f32 v3, 1.0, v3
    v_rcp_f32 v2, v2
    v_rcp_f32 v3, v3
    s_nop 0
    v_mul_f32 v184, v184, v2
    v_mul_f32 v185, v185, v3
    v_cvt_pk_bf16_f32 v185, v184, v185
    v_lshlrev_b32 v184, 16, v185
    v_and_b32 v185, 0xffff0000, v185
    v_mul_f32 v184, v184, v200
    v_mul_f32 v185, v185, v201
    v_cvt_pk_bf16_f32 v24, v184, v185
    v_add_f32 v186, v186, v194
    v_add_f32 v202, v202, v210
    v_add_f32 v187, v187, v195
    v_add_f32 v203, v203, v211
    v_cvt_pk_bf16_f32 v187, v186, v187
    v_lshlrev_b32 v186, 16, v187
    v_and_b32 v187, 0xffff0000, v187
    v_cvt_pk_bf16_f32 v203, v202, v203
    v_lshlrev_b32 v202, 16, v203
    v_and_b32 v203, 0xffff0000, v203
    v_mul_f32 v2, s6, v186
    v_mul_f32 v3, s6, v187
    v_exp_f32 v2, v2
    v_exp_f32 v3, v3
    s_nop 0
    v_add_f32 v2, 1.0, v2
    v_add_f32 v3, 1.0, v3
    v_rcp_f32 v2, v2
    v_rcp_f32 v3, v3
    s_nop 0
    v_mul_f32 v186, v186, v2
    v_mul_f32 v187, v187, v3
    v_cvt_pk_bf16_f32 v187, v186, v187
    v_lshlrev_b32 v186, 16, v187
    v_and_b32 v187, 0xffff0000, v187
    v_mul_f32 v186, v186, v202
    v_mul_f32 v187, v187, v203
    v_cvt_pk_bf16_f32 v25, v186, v187
    v_add_f32 v188, v188, v196
    v_add_f32 v204, v204, v212
    v_add_f32 v189, v189, v197
    v_add_f32 v205, v205, v213
    v_cvt_pk_bf16_f32 v189, v188, v189
    v_lshlrev_b32 v188, 16, v189
    v_and_b32 v189, 0xffff0000, v189
    v_cvt_pk_bf16_f32 v205, v204, v205
    v_lshlrev_b32 v204, 16, v205
    v_and_b32 v205, 0xffff0000, v205
    v_mul_f32 v2, s6, v188
    v_mul_f32 v3, s6, v189
    v_exp_f32 v2, v2
    v_exp_f32 v3, v3
    s_nop 0
    v_add_f32 v2, 1.0, v2
    v_add_f32 v3, 1.0, v3
    v_rcp_f32 v2, v2
    v_rcp_f32 v3, v3
    s_nop 0
    v_mul_f32 v188, v188, v2
    v_mul_f32 v189, v189, v3
    v_cvt_pk_bf16_f32 v189, v188, v189
    v_lshlrev_b32 v188, 16, v189
    v_and_b32 v189, 0xffff0000, v189
    v_mul_f32 v188, v188, v204
    v_mul_f32 v189, v189, v205
    v_cvt_pk_bf16_f32 v26, v188, v189
    v_add_f32 v190, v190, v198
    v_add_f32 v206, v206, v214
    v_add_f32 v191, v191, v199
    v_add_f32 v207, v207, v215
    v_cvt_pk_bf16_f32 v191, v190, v191
    v_lshlrev_b32 v190, 16, v191
    v_and_b32 v191, 0xffff0000, v191
    v_cvt_pk_bf16_f32 v207, v206, v207
    v_lshlrev_b32 v206, 16, v207
    v_and_b32 v207, 0xffff0000, v207
    v_mul_f32 v2, s6, v190
    v_mul_f32 v3, s6, v191
    v_exp_f32 v2, v2
    v_exp_f32 v3, v3
    s_nop 0
    v_add_f32 v2, 1.0, v2
    v_add_f32 v3, 1.0, v3
    v_rcp_f32 v2, v2
    v_rcp_f32 v3, v3
    s_nop 0
    v_mul_f32 v190, v190, v2
    v_mul_f32 v191, v191, v3
    v_cvt_pk_bf16_f32 v191, v190, v191
    v_lshlrev_b32 v190, 16, v191
    v_and_b32 v191, 0xffff0000, v191
    v_mul_f32 v190, v190, v206
    v_mul_f32 v191, v191, v207
    v_cvt_pk_bf16_f32 v27, v190, v191
    s_nop 1
    v_mfma_f32_16x16x32_bf16 v[216:219], v[32:35], v[24:27], 0
    v_mfma_f32_16x16x32_bf16 v[220:223], v[36:39], v[24:27], 0
    v_mfma_f32_16x16x32_bf16 v[224:227], v[40:43], v[24:27], 0
    v_mfma_f32_16x16x32_bf16 v[228:231], v[44:47], v[24:27], 0
    s_nop 7
    buffer_store_dwordx4 v[216:219], v20, s[8:11], s87 offen offset:0 sc1
    buffer_store_dwordx4 v[220:223], v20, s[8:11], s87 offen offset:64 sc1
    buffer_store_dwordx4 v[224:227], v20, s[8:11], s87 offen offset:128 sc1
    buffer_store_dwordx4 v[228:231], v20, s[8:11], s87 offen offset:192 sc1
    s_nop 1
    s_waitcnt vmcnt(4) lgkmcnt(0)
    s_call_b64 s[82:83], L_pend
    s_barrier
    s_call_b64 s[82:83], L_load
    s_add_i32 s62, s62, 1
    v_mfma_f32_16x16x32_bf16 v[216:219], v[240:243], v[24:27], 0
    v_mfma_f32_16x16x32_bf16 v[220:223], v[244:247], v[24:27], 0
    v_mfma_f32_16x16x32_bf16 v[224:227], v[248:251], v[24:27], 0
    v_mfma_f32_16x16x32_bf16 v[228:231], v[252:255], v[24:27], 0
    s_nop 7
    buffer_store_dwordx4 v[216:219], v20, s[8:11], s87 offen offset:1024 sc1
    buffer_store_dwordx4 v[220:223], v20, s[8:11], s87 offen offset:1088 sc1
    buffer_store_dwordx4 v[224:227], v20, s[8:11], s87 offen offset:1152 sc1
    buffer_store_dwordx4 v[228:231], v20, s[8:11], s87 offen offset:1216 sc1
    s_nop 1
    s_cmp_ge_u32 s3, 2
    s_cbranch_scc1 L_moe5b
    ds_read_b64_tr_b16 v[32:33], v19 offset:0
    ds_read_b64_tr_b16 v[34:35], v19 offset:2048
    ds_read_b64_tr_b16 v[36:37], v19 offset:32
    ds_read_b64_tr_b16 v[38:39], v19 offset:2080
    ds_read_b64_tr_b16 v[40:41], v19 offset:64
    ds_read_b64_tr_b16 v[42:43], v19 offset:2112
    ds_read_b64_tr_b16 v[44:45], v19 offset:96
    ds_read_b64_tr_b16 v[46:47], v19 offset:2144
    s_waitcnt lgkmcnt(0)
    v_mfma_f32_16x16x32_bf16 v[216:219], v[32:35], v[24:27], 0
    v_mfma_f32_16x16x32_bf16 v[220:223], v[36:39], v[24:27], 0
    v_mfma_f32_16x16x32_bf16 v[224:227], v[40:43], v[24:27], 0
    v_mfma_f32_16x16x32_bf16 v[228:231], v[44:47], v[24:27], 0
    s_nop 7
    buffer_store_dwordx4 v[216:219], v20, s[8:11], s87 offen offset:2048 sc1
    buffer_store_dwordx4 v[220:223], v20, s[8:11], s87 offen offset:2112 sc1
    buffer_store_dwordx4 v[224:227], v20, s[8:11], s87 offen offset:2176 sc1
    buffer_store_dwordx4 v[228:231], v20, s[8:11], s87 offen offset:2240 sc1
    s_nop 1
L_moe5b:
    s_waitcnt vmcnt(4) lgkmcnt(0)
    s_call_b64 s[82:83], L_pend
    s_barrier
    s_waitcnt vmcnt(0)
    s_lshl_b32 s6, s61, 5
    s_add_u32 s6, s6, s3
    s_lshl_b32 s6, s6, 2
    s_add_u32 s6, s6, 15859712
    v_mov_b32 v2, 1
    v_mov_b32 v3, 0x5000000
    v_writelane_b32 v3, s6, 0
    buffer_store_dword v2, v3, s[8:11], 0 offen sc1
    s_call_b64 s[82:83], L_load
    s_add_i32 s62, s62, 1
    s_branch L_idle
L_top:
    s_mov_b32 s6, 0x280000
    v_lshrrev_b32 v2, 1, v1
    v_and_b32 v3, 1, v1
    v_lshlrev_b32 v3, 4, v3
    v_lshl_add_u32 v2, v2, 7, v3
    buffer_load_dwordx4 v[64:67], v2, s[8:11], s6 offen sc1
    s_add_u32 s6, s6, 4096
    buffer_load_dwordx4 v[68:71], v2, s[8:11], s6 offen sc1
    s_add_u32 s6, s6, 4096
    buffer_load_dwordx4 v[72:75], v2, s[8:11], s6 offen sc1
    s_add_u32 s6, s6, 4096
    buffer_load_dwordx4 v[76:79], v2, s[8:11], s6 offen sc1
    s_add_u32 s6, s6, 4096
    buffer_load_dwordx4 v[80:83], v2, s[8:11], s6 offen sc1
    s_add_u32 s6, s6, 4096
    buffer_load_dwordx4 v[84:87], v2, s[8:11], s6 offen sc1
    s_add_u32 s6, s6, 4096
    buffer_load_dwordx4 v[88:91], v2, s[8:11], s6 offen sc1
    s_add_u32 s6, s6, 4096
    buffer_load_dwordx4 v[92:95], v2, s[8:11], s6 offen sc1
    s_add_u32 s6, s6, 4096
    s_waitcnt vmcnt(0)
    v_mov_b32 v24, 0
    s_mov_b32 s7, 0
    s_mov_b32 s84, 0
L_top_l:
    v_max3_u32 v4, v64, v65, v66
    v_max3_u32 v5, v67, v68, v69
    v_max3_u32 v4, v4, v70, v71
    v_max3_u32 v5, v5, v72, v73
    v_max3_u32 v4, v4, v74, v75
    v_max3_u32 v5, v5, v76, v77
    v_max3_u32 v4, v4, v78, v79
    v_max3_u32 v5, v5, v80, v81
    v_max3_u32 v4, v4, v82, v83
    v_max3_u32 v5, v5, v84, v85
    v_max3_u32 v4, v4, v86, v87
    v_max3_u32 v5, v5, v88, v89
    v_max3_u32 v4, v4, v90, v91
    v_max3_u32 v5, v5, v92, v93
    v_max3_u32 v4, v4, v94, v95
    v_max_u32 v4, v4, v5
    s_nop 1
    v_max_u32_dpp v4, v4, v4 quad_perm:[1,0,3,2] row_mask:0xf bank_mask:0xf
    s_nop 1
    v_max_u32_dpp v4, v4, v4 quad_perm:[2,3,0,1] row_mask:0xf bank_mask:0xf
    s_nop 1
    v_max_u32_dpp v4, v4, v4 row_half_mirror row_mask:0xf bank_mask:0xf
    s_nop 1
    v_max_u32_dpp v4, v4, v4 row_mirror row_mask:0xf bank_mask:0xf
    s_nop 1
    v_max_u32_dpp v4, v4, v4 row_bcast:15 row_mask:0xa bank_mask:0xf
    s_nop 1
    v_max_u32_dpp v4, v4, v4 row_bcast:31 row_mask:0xc bank_mask:0xf
    s_nop 1
    v_readlane_b32 s6, v4, 63
    s_mov_b32 m0, s7
    s_nop 3
    s_add_u32 s84, s84, s6
    v_writelane_b32 v24, s84, m0
    v_subrev_u32 v64, s6, v64
    v_subrev_u32 v65, s6, v65
    v_subrev_u32 v66, s6, v66
    v_subrev_u32 v67, s6, v67
    v_subrev_u32 v68, s6, v68
    v_subrev_u32 v69, s6, v69
    v_subrev_u32 v70, s6, v70
    v_subrev_u32 v71, s6, v71
    v_subrev_u32 v72, s6, v72
    v_subrev_u32 v73, s6, v73
    v_subrev_u32 v74, s6, v74
    v_subrev_u32 v75, s6, v75
    v_subrev_u32 v76, s6, v76
    v_subrev_u32 v77, s6, v77
    v_subrev_u32 v78, s6, v78
    v_subrev_u32 v79, s6, v79
    v_subrev_u32 v80, s6, v80
    v_subrev_u32 v81, s6, v81
    v_subrev_u32 v82, s6, v82
    v_subrev_u32 v83, s6, v83
    v_subrev_u32 v84, s6, v84
    v_subrev_u32 v85, s6, v85
    v_subrev_u32 v86, s6, v86
    v_subrev_u32 v87, s6, v87
    v_subrev_u32 v88, s6, v88
    v_subrev_u32 v89, s6, v89
    v_subrev_u32 v90, s6, v90
    v_subrev_u32 v91, s6, v91
    v_subrev_u32 v92, s6, v92
    v_subrev_u32 v93, s6, v93
    v_subrev_u32 v94, s6, v94
    v_subrev_u32 v95, s6, v95
    s_add_u32 s7, s7, 1
    s_cmp_lt_u32 s7, 8
    s_cbranch_scc1 L_top_l
    v_and_b32 v2, 7, v1
    v_lshlrev_b32 v2, 2, v2
    ds_bpermute_b32 v4, v2, v24
    s_waitcnt lgkmcnt(0)
    v_and_b32 v4, 0x7ff, v4
    v_sub_u32 v4, 0x7ff, v4
    v_lshrrev_b32 v5, 4, v4
    v_mul_u32_u24 v5, 20480, v5
    v_and_b32 v4, 15, v4
    v_lshl_add_u32 v5, v4, 4, v5
    v_lshrrev_b32 v7, 4, v1
    v_lshl_add_u32 v5, v7, 8, v5
    v_mov_b32 v6, 0x5000000
    v_and_b32 v2, 8, v1
    v_cmp_eq_u32 vcc, 0, v2
    s_mov_b32 s6, 0
    s_nop 0
    v_cndmask_b32 v5, v6, v5, vcc
    buffer_load_dwordx4 v[64:67], v5, s[8:11], s6 offen offset:0 sc1
    buffer_load_dwordx4 v[68:71], v5, s[8:11], s6 offen offset:1024 sc1
    buffer_load_dwordx4 v[72:75], v5, s[8:11], s6 offen offset:2048 sc1
    buffer_load_dwordx4 v[76:79], v5, s[8:11], s6 offen offset:3072 sc1
    s_add_u32 s6, s6, 4096
    buffer_load_dwordx4 v[80:83], v5, s[8:11], s6 offen offset:0 sc1
    buffer_load_dwordx4 v[84:87], v5, s[8:11], s6 offen offset:1024 sc1
    buffer_load_dwordx4 v[88:91], v5, s[8:11], s6 offen offset:2048 sc1
    buffer_load_dwordx4 v[92:95], v5, s[8:11], s6 offen offset:3072 sc1
    s_add_u32 s6, s6, 4096
    buffer_load_dwordx4 v[96:99], v5, s[8:11], s6 offen offset:0 sc1
    buffer_load_dwordx4 v[100:103], v5, s[8:11], s6 offen offset:1024 sc1
    buffer_load_dwordx4 v[104:107], v5, s[8:11], s6 offen offset:2048 sc1
    buffer_load_dwordx4 v[108:111], v5, s[8:11], s6 offen offset:3072 sc1
    s_add_u32 s6, s6, 4096
    buffer_load_dwordx4 v[112:115], v5, s[8:11], s6 offen offset:0 sc1
    buffer_load_dwordx4 v[116:119], v5, s[8:11], s6 offen offset:1024 sc1
    buffer_load_dwordx4 v[120:123], v5, s[8:11], s6 offen offset:2048 sc1
    buffer_load_dwordx4 v[124:127], v5, s[8:11], s6 offen offset:3072 sc1
    s_add_u32 s6, s6, 4096
    buffer_load_dwordx4 v[128:131], v5, s[8:11], s6 offen offset:0 sc1
    buffer_load_dwordx4 v[132:135], v5, s[8:11], s6 offen offset:1024 sc1
    buffer_load_dwordx4 v[136:139], v5, s[8:11], s6 offen offset:2048 sc1
    buffer_load_dwordx4 v[140:143], v5, s[8:11], s6 offen offset:3072 sc1
    s_waitcnt vmcnt(20)
    s_call_b64 s[82:83], L_pend
    s_barrier
    s_waitcnt vmcnt(0)
    s_mov_b32 s6, 0xc00000
    buffer_store_dwordx4 v[64:67], v13, s[8:11], s6 offen offset:0 sc1
    buffer_store_dwordx4 v[68:71], v13, s[8:11], s6 offen offset:1024 sc1
    buffer_store_dwordx4 v[72:75], v13, s[8:11], s6 offen offset:2048 sc1
    buffer_store_dwordx4 v[76:79], v13, s[8:11], s6 offen offset:3072 sc1
    s_add_u32 s6, s6, 4096
    buffer_store_dwordx4 v[80:83], v13, s[8:11], s6 offen offset:0 sc1
    buffer_store_dwordx4 v[84:87], v13, s[8:11], s6 offen offset:1024 sc1
    buffer_store_dwordx4 v[88:91], v13, s[8:11], s6 offen offset:2048 sc1
    buffer_store_dwordx4 v[92:95], v13, s[8:11], s6 offen offset:3072 sc1
    s_add_u32 s6, s6, 4096
    buffer_store_dwordx4 v[96:99], v13, s[8:11], s6 offen offset:0 sc1
    buffer_store_dwordx4 v[100:103], v13, s[8:11], s6 offen offset:1024 sc1
    buffer_store_dwordx4 v[104:107], v13, s[8:11], s6 offen offset:2048 sc1
    buffer_store_dwordx4 v[108:111], v13, s[8:11], s6 offen offset:3072 sc1
    s_add_u32 s6, s6, 4096
    buffer_store_dwordx4 v[112:115], v13, s[8:11], s6 offen offset:0 sc1
    buffer_store_dwordx4 v[116:119], v13, s[8:11], s6 offen offset:1024 sc1
    buffer_store_dwordx4 v[120:123], v13, s[8:11], s6 offen offset:2048 sc1
    buffer_store_dwordx4 v[124:127], v13, s[8:11], s6 offen offset:3072 sc1
    s_add_u32 s6, s6, 4096
    buffer_store_dwordx4 v[128:131], v13, s[8:11], s6 offen offset:0 sc1
    buffer_store_dwordx4 v[132:135], v13, s[8:11], s6 offen offset:1024 sc1
    buffer_store_dwordx4 v[136:139], v13, s[8:11], s6 offen offset:2048 sc1
    buffer_store_dwordx4 v[140:143], v13, s[8:11], s6 offen offset:3072 sc1
    s_call_b64 s[82:83], L_load
    s_add_i32 s62, s62, 1
    s_waitcnt vmcnt(16)
    v_or_b32 v24, 0x80000000, v24
    v_lshlrev_b32 v5, 2, v1
    v_mov_b32 v6, 0x5000000
    v_cmp_gt_u32 vcc, 8, v1
    s_mov_b32 s6, 0x3a0000
    s_nop 0
    v_cndmask_b32 v5, v6, v5, vcc
    buffer_store_dword v24, v5, s[8:11], s6 offen sc1
    s_branch L_idle
L_back_9_h:
    v_cmp_ne_u32 vcc, 0, v62
    s_cbranch_vccz L_back_9_n
    s_call_b64 s[80:81], L_rare0
L_back_9_n:
    s_branch L_back_9
L_back_10_h:
    v_cmp_ne_u32 vcc, 0, v62
    s_cbranch_vccz L_back_10_n
    s_call_b64 s[80:81], L_rare1
    v_exp_f32 v58, v64
    v_exp_f32 v59, v65
L_back_10_n:
    s_cmp_lt_i32 s64, 0
    s_cbranch_scc1 L_tail1
    s_cmp_gt_i32 s64, 0
    s_cbranch_scc1 L_back_10
    s_call_b64 s[82:83], L_mask
    s_branch L_back_10
L_back_11_h:
    v_cmp_ne_u32 vcc, 0, v62
    s_cbranch_vccz L_back_11_n
    s_call_b64 s[80:81], L_rare0
    v_exp_f32 v58, v80
    v_exp_f32 v59, v81
L_back_11_n:
    s_cmp_lt_i32 s64, 0
    s_cbranch_scc1 L_tail2
    s_cmp_gt_i32 s64, 0
    s_cbranch_scc1 L_back_11
    s_call_b64 s[82:83], L_mask
    s_branch L_back_11
L_back_12_h:
    v_cmp_ne_u32 vcc, 0, v62
    s_cbranch_vccz L_back_12_n
    s_call_b64 s[80:81], L_rare1
    v_exp_f32 v58, v64
    v_exp_f32 v59, v65
L_back_12_n:
    s_cmp_lt_i32 s64, 0
    s_cbranch_scc1 L_tail3
    s_cmp_gt_i32 s64, 0
    s_cbranch_scc1 L_back_12
    s_call_b64 s[82:83], L_mask
    s_branch L_back_12
L_ldback_13_c:
    s_waitcnt vmcnt(0) lgkmcnt(0)
    s_call_b64 s[82:83], L_pend
    s_barrier
    s_call_b64 s[82:83], L_load
    s_branch L_ldback_13
L_back_14_h:
    v_cmp_ne_u32 vcc, 0, v62
    s_cbranch_vccz L_back_14_n
    s_call_b64 s[80:81], L_rare0
    v_exp_f32 v58, v80
    v_exp_f32 v59, v81
L_back_14_n:
    s_cmp_lt_i32 s64, 0
    s_cbranch_scc1 L_tail0
    s_cmp_gt_i32 s64, 0
    s_cbranch_scc1 L_st0
    s_call_b64 s[82:83], L_mask
    s_branch L_st0
L_back_15_h:
    v_cmp_ne_u32 vcc, 0, v62
    s_cbranch_vccz L_back_15_n
    s_call_b64 s[80:81], L_rare1
L_back_15_n:
    s_branch L_back_15
L_back_16_h:
    v_cmp_ne_u32 vcc, 0, v62
    s_cbranch_vccz L_back_16_n
    s_call_b64 s[80:81], L_rare0
L_back_16_n:
    s_branch L_back_16
L_back_18_h:
    v_cmp_ne_u32 vcc, 0, v62
    s_cbranch_vccz L_back_18_n
    s_call_b64 s[80:81], L_rare1
L_back_18_n:
    s_branch L_back_18
L_back_21_h:
    v_cmp_ne_u32 vcc, 0, v62
    s_cbranch_vccz L_back_21_n
    s_call_b64 s[80:81], L_rare0
L_back_21_n:
    s_branch L_back_21
L_load:
    s_bitcmp1_b32 s89, 0
    s_cbranch_scc0 L_load_r
    s_add_u32 s77, s77, 32768
    s_xor_b32 s78, s78, 0x10000
    s_add_i32 s73, s62, 1
    s_cmp_gt_i32 s73, s63
    s_cbranch_scc1 L_load_r
    s_cmp_eq_i32 s73, s63
    s_cbranch_scc1 L_load_v
    s_cmp_lg_i32 s73, 3
    s_cbranch_scc1 L_load_k
    v_cmp_gt_u32 vcc, 2, v12
    s_cbranch_vccz L_load_k
    s_lshl_b32 s7, s4, 10
    s_add_u32 s7, s7, 3866624
    v_lshrrev_b32 v2, 3, v1
    v_and_b32 v3, 7, v1
    v_lshlrev_b32 v3, 2, v3
    v_lshl_add_u32 v3, v2, 7, v3
    s_mov_b32 s79, 262144
L_poll_46:
    buffer_load_dword v2, v3, s[8:11], s7 offen sc1
    s_waitcnt vmcnt(0)
    v_cmp_gt_u32 vcc, 2, v2
    s_cbranch_vccz L_polldone_47
    s_sleep 2
    s_sub_u32 s79, s79, 1
    s_cmp_lg_u32 s79, 0
    s_cbranch_scc1 L_poll_46
L_polldone_47:
L_load_k:
    s_lshl_b32 s6, s76, 13
    s_add_u32 s6, s6, s78
    s_add_u32 m0, s6, 0
    s_add_u32 s7, s77, 0
    buffer_load_dwordx4 v49, s[8:11], s7 offen offset:0 sc1 lds
    buffer_load_dwordx4 v49, s[8:11], s7 offen offset:1024 sc1 lds
    buffer_load_dwordx4 v49, s[8:11], s7 offen offset:2048 sc1 lds
    buffer_load_dwordx4 v49, s[8:11], s7 offen offset:3072 sc1 lds
    s_lshl_b32 s6, s76, 13
    s_add_u32 s6, s6, s78
    s_add_u32 m0, s6, 4096
    s_add_u32 s7, s77, 4096
    buffer_load_dwordx4 v49, s[8:11], s7 offen offset:0 sc1 lds
    buffer_load_dwordx4 v49, s[8:11], s7 offen offset:1024 sc1 lds
    buffer_load_dwordx4 v49, s[8:11], s7 offen offset:2048 sc1 lds
    buffer_load_dwordx4 v49, s[8:11], s7 offen offset:3072 sc1 lds
    s_lshl_b32 s6, s76, 12
    s_add_u32 s6, s6, s78
    s_add_u32 m0, s6, 49152
    s_add_u32 s7, s77, 524288
    buffer_load_dwordx4 v50, s[8:11], s7 offen offset:0 sc1 lds
    buffer_load_dwordx4 v50, s[8:11], s7 offen offset:1024 sc1 lds
    buffer_load_dwordx4 v50, s[8:11], s7 offen offset:2048 sc1 lds
    buffer_load_dwordx4 v50, s[8:11], s7 offen offset:3072 sc1 lds
L_load_v:
    s_lshl_b32 s6, s76, 12
    s_add_u32 s6, s6, s78
    s_add_u32 m0, s6, 32768
    s_add_u32 s7, s77, 507904
    buffer_load_dwordx4 v50, s[8:11], s7 offen offset:0 sc1 lds
    buffer_load_dwordx4 v50, s[8:11], s7 offen offset:1024 sc1 lds
    buffer_load_dwordx4 v50, s[8:11], s7 offen offset:2048 sc1 lds
    buffer_load_dwordx4 v50, s[8:11], s7 offen offset:3072 sc1 lds
    s_cmp_eq_i32 s73, s63
    s_cbranch_scc1 L_xa
    s_cmp_lg_i32 s73, 2
    s_cbranch_scc1 L_nolook
    s_lshl_b32 s7, s4, 10
    s_add_u32 s7, s7, 3866624
    v_lshrrev_b32 v2, 3, v1
    v_and_b32 v3, 7, v1
    v_lshlrev_b32 v3, 2, v3
    v_lshl_add_u32 v3, v2, 7, v3
    buffer_load_dword v12, v3, s[8:11], s7 offen sc1
L_nolook:
    s_bitcmp1_b32 240, s5
    s_cbranch_scc0 L_wb
    s_sub_i32 s6, s62, 0
    s_cmp_gt_u32 s6, 4
    s_cbranch_scc0 L_wsel
L_wb:
    s_cmp_lt_u32 s5, 4
    s_cbranch_scc1 L_load_r
    s_sub_i32 s79, s73, 1
    s_cmp_lt_u32 s79, 2
    s_cbranch_scc1 L_x3
L_load_r:
    s_setpc_b64 s[82:83]
L_pend:
    s_bitcmp1_b32 s89, 1
    s_cbranch_scc0 L_load_a
    s_cmp_lt_i32 s62, 0
    s_cbranch_scc1 L_load_a
    s_lshl_b32 s6, s4, 3
    s_add_u32 s6, s6, s5
    s_lshl_b32 s6, s6, 5
    s_add_u32 s6, s6, s3
    s_lshl_b32 s6, s6, 2
    s_add_u32 s6, s6, 3866624
    v_mov_b32 v2, 2
    v_mov_b32 v3, 0x5000000
    v_writelane_b32 v3, s6, 0
    buffer_store_dword v2, v3, s[8:11], 0 offen sc1
    s_and_b32 s89, s89, 1
L_load_a:
    s_setpc_b64 s[82:83]
L_wsel:
    s_bfm_b32 s7, s5, 0
    s_and_b32 s7, s7, 240
    s_bcnt1_i32_b32 s7, s7
    s_lshl_b32 s7, s7, 5
    s_and_b32 s91, s2, 31
    s_add_u32 s91, s91, s7
    s_lshl_b32 s91, s91, 1
    s_lshr_b32 s7, s6, 1
    s_add_u32 s91, s91, s7
    s_cmp_eq_u32 s6, 4
    s_cbranch_scc1 L_w2
    s_bitcmp1_b32 s6, 0
    s_cbranch_scc1 L_w1
L_w0:
    s_mov_b32 s28, s42
    s_mov_b32 s29, s43
    s_mov_b32 s30, 0x500000
    s_mov_b32 s31, 0x20000
    s_lshr_b32 s75, s91, 1
    s_mul_i32 s75, s75, 40960
    s_and_b32 s6, s91, 1
    s_mul_i32 s6, s6, 640
    s_add_u32 s75, s75, s6
    s_movk_i32 s7, 1639
    s_mul_i32 s74, s76, 5120
    s_add_u32 s74, s74, 141312
    s_mul_i32 s6, s76, 320
    v_add_u32 v9, s6, v1
    v_add_u32 v2, 0, v9
    v_mul_lo_u32 v3, v2, s7
    v_lshrrev_b32 v3, 16, v3
    v_mul_u32_u24 v4, 40, v3
    v_sub_u32 v4, v2, v4
    v_mul_u32_u24 v3, 1280, v3
    v_lshl_add_u32 v3, v4, 4, v3
    s_add_u32 m0, s74, 0
    s_nop 0
    buffer_load_dwordx4 v3, s[28:31], s75 offen nt lds
    v_add_u32 v2, 64, v9
    v_mul_lo_u32 v3, v2, s7
    v_lshrrev_b32 v3, 16, v3
    v_mul_u32_u24 v4, 40, v3
    v_sub_u32 v4, v2, v4
    v_mul_u32_u24 v3, 1280, v3
    v_lshl_add_u32 v3, v4, 4, v3
    s_add_u32 m0, s74, 1024
    s_nop 0
    buffer_load_dwordx4 v3, s[28:31], s75 offen nt lds
    v_add_u32 v2, 128, v9
    v_mul_lo_u32 v3, v2, s7
    v_lshrrev_b32 v3, 16, v3
    v_mul_u32_u24 v4, 40, v3
    v_sub_u32 v4, v2, v4
    v_mul_u32_u24 v3, 1280, v3
    v_lshl_add_u32 v3, v4, 4, v3
    s_add_u32 m0, s74, 2048
    s_nop 0
    buffer_load_dwordx4 v3, s[28:31], s75 offen nt lds
    v_add_u32 v2, 192, v9
    v_mul_lo_u32 v3, v2, s7
    v_lshrrev_b32 v3, 16, v3
    v_mul_u32_u24 v4, 40, v3
    v_sub_u32 v4, v2, v4
    v_mul_u32_u24 v3, 1280, v3
    v_lshl_add_u32 v3, v4, 4, v3
    s_add_u32 m0, s74, 3072
    s_nop 0
    buffer_load_dwordx4 v3, s[28:31], s75 offen nt lds
    v_add_u32 v2, 256, v9
    v_mul_lo_u32 v3, v2, s7
    v_lshrrev_b32 v3, 16, v3
    v_mul_u32_u24 v4, 40, v3
    v_sub_u32 v4, v2, v4
    v_mul_u32_u24 v3, 1280, v3
    v_lshl_add_u32 v3, v4, 4, v3
    s_add_u32 m0, s74, 4096
    s_nop 0
    buffer_load_dwordx4 v3, s[28:31], s75 offen nt lds
    s_branch L_wb
L_w1:
    v_and_b32 v2, 15, v1
    v_lshrrev_b32 v3, 4, v1
    v_lshrrev_b32 v4, 2, v2
    v_lshl_add_u32 v4, v3, 2, v4
    v_mul_u32_u24 v4, 640, v4
    v_and_b32 v2, 3, v2
    v_lshl_add_u32 v4, v2, 3, v4
    s_mul_i32 s6, s76, 160
    s_add_u32 s6, s6, 141312
    v_add_u32 v4, s6, v4
    s_mul_i32 s6, s91, 20480
    s_mul_i32 s7, s76, 5120
    s_add_u32 s6, s6, s7
    s_add_u32 s6, s6, 4194304
    s_add_u32 s7, s6, 4096
    ds_read_b64_tr_b16 v[172:173], v4 offset:0
    ds_read_b64_tr_b16 v[174:175], v4 offset:10240
    ds_read_b64_tr_b16 v[176:177], v4 offset:32
    ds_read_b64_tr_b16 v[178:179], v4 offset:10272
    ds_read_b64_tr_b16 v[180:181], v4 offset:64
    ds_read_b64_tr_b16 v[182:183], v4 offset:10304
    ds_read_b64_tr_b16 v[184:185], v4 offset:96
    ds_read_b64_tr_b16 v[186:187], v4 offset:10336
    ds_read_b64_tr_b16 v[188:189], v4 offset:128
    ds_read_b64_tr_b16 v[190:191], v4 offset:10368
    s_waitcnt lgkmcnt(0)
    buffer_store_dwordx4 v[172:175], v13, s[8:11], s6 offen offset:0 sc1
    buffer_store_dwordx4 v[176:179], v13, s[8:11], s6 offen offset:1024 sc1
    buffer_store_dwordx4 v[180:183], v13, s[8:11], s6 offen offset:2048 sc1
    buffer_store_dwordx4 v[184:187], v13, s[8:11], s6 offen offset:3072 sc1
    buffer_store_dwordx4 v[188:191], v13, s[8:11], s7 offen offset:0 sc1
    s_branch L_wb
L_w2:
    s_cmp_lg_u32 s3, 0
    s_cbranch_scc1 L_wb
    s_mov_b32 s28, s56
    s_mov_b32 s29, s57
    s_mov_b32 s30, 0x100
    s_mov_b32 s31, 0x20000
    v_mov_b32 v2, 1
    v_lshlrev_b32 v3, 8, v1
    s_and_b32 s6, s2, 31
    s_lshl_b32 s6, s6, 2
    buffer_atomic_add v2, v3, s[28:31], s6 offen offset:128 sc1
    s_branch L_wb
L_xa:
    s_cmp_lg_u32 s90, 0
    s_cbranch_scc1 L_xa1
    s_mov_b32 s28, s56
    s_mov_b32 s29, s57
    s_mov_b32 s30, 0x100
    s_mov_b32 s31, 0x20000
    v_and_b32 v3, 31, v1
    v_lshlrev_b32 v3, 2, v3
    s_mov_b32 s79, 262144
L_poll_48:
    buffer_load_dword v2, v3, s[28:31], 0 offen offset:128 sc1
    s_waitcnt vmcnt(0)
    v_cmp_gt_u32 vcc, 4, v2
    s_cbranch_vccz L_polldone_49
    s_sleep 8
    s_sub_u32 s79, s79, 1
    s_cmp_lg_u32 s79, 0
    s_cbranch_scc1 L_poll_48
L_polldone_49:
L_xa1:
    s_lshr_b32 s74, s4, 3
    s_lshl_b32 s74, s74, 2
    s_add_u32 s74, s74, s76
    s_mul_i32 s74, s74, 327680
    s_and_b32 s7, s4, 3
    s_mul_i32 s7, s7, 10240
    s_add_u32 s74, s74, s7
    s_add_u32 s74, s74, 4199424
    s_add_u32 s6, s76, 0
    s_and_b32 s6, s6, 3
    s_lshl_b32 s6, s6, 10
    s_add_u32 s84, s6, s74
    s_add_u32 s6, s76, 1
    s_and_b32 s6, s6, 3
    s_lshl_b32 s6, s6, 10
    s_add_u32 s85, s6, s74
    s_add_u32 s6, s76, 2
    s_and_b32 s6, s6, 3
    s_lshl_b32 s6, s6, 10
    s_add_u32 s86, s6, s74
    s_add_u32 s6, s76, 3
    s_and_b32 s6, s6, 3
    s_lshl_b32 s6, s6, 10
    s_add_u32 s87, s6, s74
    s_add_u32 s88, s74, 4096
    s_lshl_b32 s73, s3, 13
    s_add_u32 s75, s73, s78
    s_add_u32 m0, s73, 131072
    s_add_u32 s7, s84, 0
    buffer_load_dwordx4 v13, s[8:11], s7 offen sc1 lds
    s_add_u32 m0, s73, 132096
    s_add_u32 s7, s85, 0
    buffer_load_dwordx4 v13, s[8:11], s7 offen sc1 lds
    s_add_u32 m0, s73, 133120
    s_add_u32 s7, s86, 0
    buffer_load_dwordx4 v13, s[8:11], s7 offen sc1 lds
    s_add_u32 m0, s73, 134144
    s_add_u32 s7, s87, 0
    buffer_load_dwordx4 v13, s[8:11], s7 offen sc1 lds
    s_add_u32 m0, s73, 135168
    s_add_u32 s7, s88, 0
    buffer_load_dwordx4 v13, s[8:11], s7 offen sc1 lds
    s_add_u32 m0, s73, 136192
    s_add_u32 s7, s84, 40960
    buffer_load_dwordx4 v13, s[8:11], s7 offen sc1 lds
    s_add_u32 m0, s73, 137216
    s_add_u32 s7, s85, 40960
    buffer_load_dwordx4 v13, s[8:11], s7 offen sc1 lds
    s_add_u32 m0, s73, 138240
    s_add_u32 s7, s86, 40960
    buffer_load_dwordx4 v13, s[8:11], s7 offen sc1 lds
    s_add_u32 m0, s75, 0
    s_add_u32 s7, s87, 40960
    buffer_load_dwordx4 v13, s[8:11], s7 offen sc1 lds
    s_add_u32 m0, s75, 1024
    s_add_u32 s7, s88, 40960
    buffer_load_dwordx4 v13, s[8:11], s7 offen sc1 lds
    s_add_u32 m0, s75, 2048
    s_add_u32 s7, s84, 81920
    buffer_load_dwordx4 v13, s[8:11], s7 offen sc1 lds
    s_add_u32 m0, s75, 3072
    s_add_u32 s7, s85, 81920
    buffer_load_dwordx4 v13, s[8:11], s7 offen sc1 lds
    s_add_u32 m0, s75, 4096
    s_add_u32 s7, s86, 81920
    buffer_load_dwordx4 v13, s[8:11], s7 offen sc1 lds
    s_add_u32 m0, s75, 5120
    s_add_u32 s7, s87, 81920
    buffer_load_dwordx4 v13, s[8:11], s7 offen sc1 lds
    s_add_u32 m0, s75, 6144
    s_add_u32 s7, s88, 81920
    buffer_load_dwordx4 v13, s[8:11], s7 offen sc1 lds
    s_add_u32 m0, s75, 7168
    s_add_u32 s7, s84, 122880
    buffer_load_dwordx4 v13, s[8:11], s7 offen sc1 lds
    s_lshl_b32 s75, s3, 12
    s_add_u32 s75, s75, s78
    s_add_u32 m0, s75, 49152
    s_add_u32 s7, s85, 122880
    buffer_load_dwordx4 v13, s[8:11], s7 offen sc1 lds
    s_add_u32 m0, s75, 50176
    s_add_u32 s7, s86, 122880
    buffer_load_dwordx4 v13, s[8:11], s7 offen sc1 lds
    s_add_u32 m0, s75, 51200
    s_add_u32 s7, s87, 122880
    buffer_load_dwordx4 v13, s[8:11], s7 offen sc1 lds
    s_add_u32 m0, s75, 52224
    s_add_u32 s7, s88, 122880
    buffer_load_dwordx4 v13, s[8:11], s7 offen sc1 lds
    s_setpc_b64 s[82:83]
L_x3:
    s_mov_b32 s12, s48
    s_mov_b32 s13, s49
    s_mov_b32 s14, 0x21c000
    s_mov_b32 s15, 0x20000
    s_cmp_eq_u32 s3, 3
    s_cbranch_scc1 L_load_r
    s_cmp_eq_u32 s3, 1
    s_cselect_b32 s12, s50, s12
    s_cselect_b32 s13, s51, s13
    s_cmp_eq_u32 s3, 2
    s_cselect_b32 s12, s52, s12
    s_cselect_b32 s13, s53, s13
    s_mov_b32 s73, 3456
    s_cmov_b32 s73, 256
    s_mov_b32 s75, 256
    s_cmov_b32 s75, 163840
    s_lshr_b32 s6, s2, 3
    s_sub_u32 s6, s6, 16
    s_mul_i32 s6, s6, 40
    v_lshrrev_b32 v2, 2, v1
    v_add_u32 v2, s6, v2
    v_mul_lo_u32 v2, v2, s73
    v_and_b32 v3, 3, v1
    v_lshl_add_u32 v2, v3, 6, v2
    s_xor_b32 s79, s79, 1
    s_lshl_b32 s6, s79, 3
    s_lshr_b32 s7, s4, 2
    s_add_u32 s6, s6, s7
    s_mul_i32 s6, s6, s75
    v_mov_b32 v3, 0x5000000
    v_cmp_gt_u32 vcc, 32, v1
    s_lshl_b32 s73, s73, 4
    s_nop 0
    v_cndmask_b32 v3, v3, v2, vcc
    buffer_load_dword v11, v2, s[12:15], s6 offen
    s_add_u32 s7, s6, s73
    buffer_load_dword v11, v2, s[12:15], s7 offen
    s_add_u32 s7, s7, s73
    buffer_load_dword v11, v3, s[12:15], s7 offen
    s_setpc_b64 s[82:83]
L_mask:
    v_and_b32 v2, 15, v1
    v_lshrrev_b32 v3, 4, v1
    v_lshlrev_b32 v3, 2, v3
    v_sub_u32 v2, v2, v3
    v_mov_b32 v3, 0xff800000
    v_cmp_gt_i32 vcc, 0, v2
    v_mov_b32 v152, v3
    s_nop 0
    v_cndmask_b32 v144, v144, v3, vcc
    v_cndmask_b32 v156, v156, v3, vcc
    v_cmp_gt_i32 vcc, 1, v2
    v_mov_b32 v153, v3
    s_nop 0
    v_cndmask_b32 v145, v145, v3, vcc
    v_cndmask_b32 v157, v157, v3, vcc
    v_cmp_gt_i32 vcc, 2, v2
    v_mov_b32 v154, v3
    s_nop 0
    v_cndmask_b32 v146, v146, v3, vcc
    v_cndmask_b32 v158, v158, v3, vcc
    v_cmp_gt_i32 vcc, 3, v2
    v_mov_b32 v155, v3
    s_nop 0
    v_cndmask_b32 v147, v147, v3, vcc
    v_cndmask_b32 v159, v159, v3, vcc
    s_nop 1
    s_setpc_b64 s[82:83]
L_rare0:
    s_nop 15
    v_max_f32 v62, v64, v65
    v_max3_f32 v62, v62, v66, v67
    v_max3_f32 v62, v62, v72, v73
    v_max3_f32 v62, v62, v74, v75
    v_mov_b32 v58, v62
    s_nop 1
    v_permlane16_swap_b32 v62, v58
    s_nop 1
    v_max_f32 v62, v62, v58
    v_mov_b32 v58, v62
    s_nop 1
    v_permlane32_swap_b32 v62, v58
    s_nop 1
    v_max_f32 v62, v62, v58
    v_add_f32 v62, 0x41c00000, v62
    v_max_f32 v62, 0, v62
    v_exp_f32 v58, -v62
    v_sub_f32 v64, v64, v62
    v_sub_f32 v80, v80, v62
    v_sub_f32 v144, v144, v62
    v_sub_f32 v65, v65, v62
    v_sub_f32 v81, v81, v62
    v_sub_f32 v145, v145, v62
    v_sub_f32 v66, v66, v62
    v_sub_f32 v82, v82, v62
    v_sub_f32 v146, v146, v62
    v_sub_f32 v67, v67, v62
    v_sub_f32 v83, v83, v62
    v_sub_f32 v147, v147, v62
    v_sub_f32 v72, v72, v62
    v_sub_f32 v88, v88, v62
    v_sub_f32 v152, v152, v62
    v_sub_f32 v73, v73, v62
    v_sub_f32 v89, v89, v62
    v_sub_f32 v153, v153, v62
    v_sub_f32 v74, v74, v62
    v_sub_f32 v90, v90, v62
    v_sub_f32 v154, v154, v62
    v_sub_f32 v75, v75, v62
    v_sub_f32 v91, v91, v62
    v_sub_f32 v155, v155, v62
    v_mul_f32 v160, v58, v160
    v_mul_f32 v161, v58, v161
    v_mul_f32 v192, v58, v192
    v_mul_f32 v193, v58, v193
    v_mul_f32 v194, v58, v194
    v_mul_f32 v195, v58, v195
    v_mul_f32 v200, v58, v200
    v_mul_f32 v201, v58, v201
    v_mul_f32 v202, v58, v202
    v_mul_f32 v203, v58, v203
    v_mul_f32 v208, v58, v208
    v_mul_f32 v209, v58, v209
    v_mul_f32 v210, v58, v210
    v_mul_f32 v211, v58, v211
    v_mul_f32 v216, v58, v216
    v_mul_f32 v217, v58, v217
    v_mul_f32 v218, v58, v218
    v_mul_f32 v219, v58, v219
    v_mul_f32 v224, v58, v224
    v_mul_f32 v225, v58, v225
    v_mul_f32 v226, v58, v226
    v_mul_f32 v227, v58, v227
    v_mul_f32 v232, v58, v232
    v_mul_f32 v233, v58, v233
    v_mul_f32 v234, v58, v234
    v_mul_f32 v235, v58, v235
    v_mul_f32 v240, v58, v240
    v_mul_f32 v241, v58, v241
    v_mul_f32 v242, v58, v242
    v_mul_f32 v243, v58, v243
    v_mul_f32 v248, v58, v248
    v_mul_f32 v249, v58, v249
    v_mul_f32 v250, v58, v250
    v_mul_f32 v251, v58, v251
    v_max_f32 v62, v68, v69
    v_max3_f32 v62, v62, v70, v71
    v_max3_f32 v62, v62, v76, v77
    v_max3_f32 v62, v62, v78, v79
    v_mov_b32 v58, v62
    s_nop 1
    v_permlane16_swap_b32 v62, v58
    s_nop 1
    v_max_f32 v62, v62, v58
    v_mov_b32 v58, v62
    s_nop 1
    v_permlane32_swap_b32 v62, v58
    s_nop 1
    v_max_f32 v62, v62, v58
    v_add_f32 v62, 0x41c00000, v62
    v_max_f32 v62, 0, v62
    v_exp_f32 v58, -v62
    v_sub_f32 v68, v68, v62
    v_sub_f32 v84, v84, v62
    v_sub_f32 v148, v148, v62
    v_sub_f32 v69, v69, v62
    v_sub_f32 v85, v85, v62
    v_sub_f32 v149, v149, v62
    v_sub_f32 v70, v70, v62
    v_sub_f32 v86, v86, v62
    v_sub_f32 v150, v150, v62
    v_sub_f32 v71, v71, v62
    v_sub_f32 v87, v87, v62
    v_sub_f32 v151, v151, v62
    v_sub_f32 v76, v76, v62
    v_sub_f32 v92, v92, v62
    v_sub_f32 v156, v156, v62
    v_sub_f32 v77, v77, v62
    v_sub_f32 v93, v93, v62
    v_sub_f32 v157, v157, v62
    v_sub_f32 v78, v78, v62
    v_sub_f32 v94, v94, v62
    v_sub_f32 v158, v158, v62
    v_sub_f32 v79, v79, v62
    v_sub_f32 v95, v95, v62
    v_sub_f32 v159, v159, v62
    v_mul_f32 v162, v58, v162
    v_mul_f32 v163, v58, v163
    v_mul_f32 v196, v58, v196
    v_mul_f32 v197, v58, v197
    v_mul_f32 v198, v58, v198
    v_mul_f32 v199, v58, v199
    v_mul_f32 v204, v58, v204
    v_mul_f32 v205, v58, v205
    v_mul_f32 v206, v58, v206
    v_mul_f32 v207, v58, v207
    v_mul_f32 v212, v58, v212
    v_mul_f32 v213, v58, v213
    v_mul_f32 v214, v58, v214
    v_mul_f32 v215, v58, v215
    v_mul_f32 v220, v58, v220
    v_mul_f32 v221, v58, v221
    v_mul_f32 v222, v58, v222
    v_mul_f32 v223, v58, v223
    v_mul_f32 v228, v58, v228
    v_mul_f32 v229, v58, v229
    v_mul_f32 v230, v58, v230
    v_mul_f32 v231, v58, v231
    v_mul_f32 v236, v58, v236
    v_mul_f32 v237, v58, v237
    v_mul_f32 v238, v58, v238
    v_mul_f32 v239, v58, v239
    v_mul_f32 v244, v58, v244
    v_mul_f32 v245, v58, v245
    v_mul_f32 v246, v58, v246
    v_mul_f32 v247, v58, v247
    v_mul_f32 v252, v58, v252
    v_mul_f32 v253, v58, v253
    v_mul_f32 v254, v58, v254
    v_mul_f32 v255, v58, v255
    v_exp_f32 v58, v64
    s_nop 0
    v_exp_f32 v59, v65
    s_nop 0
    v_cvt_pk_bf16_f32 v128, v58, v59
    v_exp_f32 v60, v66
    s_nop 0
    v_exp_f32 v61, v67
    s_nop 0
    v_cvt_pk_bf16_f32 v129, v60, v61
    v_exp_f32 v58, v68
    s_nop 0
    v_exp_f32 v59, v69
    s_nop 0
    v_cvt_pk_bf16_f32 v132, v58, v59
    v_exp_f32 v60, v70
    s_nop 0
    v_exp_f32 v61, v71
    s_nop 0
    v_cvt_pk_bf16_f32 v133, v60, v61
    v_exp_f32 v58, v72
    s_nop 0
    v_exp_f32 v59, v73
    s_nop 0
    v_cvt_pk_bf16_f32 v130, v58, v59
    v_exp_f32 v60, v74
    s_nop 0
    v_exp_f32 v61, v75
    s_nop 0
    v_cvt_pk_bf16_f32 v131, v60, v61
    v_exp_f32 v58, v76
    s_nop 0
    v_exp_f32 v59, v77
    s_nop 0
    v_cvt_pk_bf16_f32 v134, v58, v59
    v_exp_f32 v60, v78
    s_nop 0
    v_exp_f32 v61, v79
    s_nop 0
    v_cvt_pk_bf16_f32 v135, v60, v61
    s_nop 1
    s_setpc_b64 s[80:81]
L_rare1:
    s_nop 15
    v_max_f32 v62, v80, v81
    v_max3_f32 v62, v62, v82, v83
    v_max3_f32 v62, v62, v88, v89
    v_max3_f32 v62, v62, v90, v91
    v_mov_b32 v58, v62
    s_nop 1
    v_permlane16_swap_b32 v62, v58
    s_nop 1
    v_max_f32 v62, v62, v58
    v_mov_b32 v58, v62
    s_nop 1
    v_permlane32_swap_b32 v62, v58
    s_nop 1
    v_max_f32 v62, v62, v58
    v_add_f32 v62, 0x41c00000, v62
    v_max_f32 v62, 0, v62
    v_exp_f32 v58, -v62
    v_sub_f32 v64, v64, v62
    v_sub_f32 v80, v80, v62
    v_sub_f32 v144, v144, v62
    v_sub_f32 v65, v65, v62
    v_sub_f32 v81, v81, v62
    v_sub_f32 v145, v145, v62
    v_sub_f32 v66, v66, v62
    v_sub_f32 v82, v82, v62
    v_sub_f32 v146, v146, v62
    v_sub_f32 v67, v67, v62
    v_sub_f32 v83, v83, v62
    v_sub_f32 v147, v147, v62
    v_sub_f32 v72, v72, v62
    v_sub_f32 v88, v88, v62
    v_sub_f32 v152, v152, v62
    v_sub_f32 v73, v73, v62
    v_sub_f32 v89, v89, v62
    v_sub_f32 v153, v153, v62
    v_sub_f32 v74, v74, v62
    v_sub_f32 v90, v90, v62
    v_sub_f32 v154, v154, v62
    v_sub_f32 v75, v75, v62
    v_sub_f32 v91, v91, v62
    v_sub_f32 v155, v155, v62
    v_mul_f32 v160, v58, v160
    v_mul_f32 v161, v58, v161
    v_mul_f32 v192, v58, v192
    v_mul_f32 v193, v58, v193
    v_mul_f32 v194, v58, v194
    v_mul_f32 v195, v58, v195
    v_mul_f32 v200, v58, v200
    v_mul_f32 v201, v58, v201
    v_mul_f32 v202, v58, v202
    v_mul_f32 v203, v58, v203
    v_mul_f32 v208, v58, v208
    v_mul_f32 v209, v58, v209
    v_mul_f32 v210, v58, v210
    v_mul_f32 v211, v58, v211
    v_mul_f32 v216, v58, v216
    v_mul_f32 v217, v58, v217
    v_mul_f32 v218, v58, v218
    v_mul_f32 v219, v58, v219
    v_mul_f32 v224, v58, v224
    v_mul_f32 v225, v58, v225
    v_mul_f32 v226, v58, v226
    v_mul_f32 v227, v58, v227
    v_mul_f32 v232, v58, v232
    v_mul_f32 v233, v58, v233
    v_mul_f32 v234, v58, v234
    v_mul_f32 v235, v58, v235
    v_mul_f32 v240, v58, v240
    v_mul_f32 v241, v58, v241
    v_mul_f32 v242, v58, v242
    v_mul_f32 v243, v58, v243
    v_mul_f32 v248, v58, v248
    v_mul_f32 v249, v58, v249
    v_mul_f32 v250, v58, v250
    v_mul_f32 v251, v58, v251
    v_max_f32 v62, v84, v85
    v_max3_f32 v62, v62, v86, v87
    v_max3_f32 v62, v62, v92, v93
    v_max3_f32 v62, v62, v94, v95
    v_mov_b32 v58, v62
    s_nop 1
    v_permlane16_swap_b32 v62, v58
    s_nop 1
    v_max_f32 v62, v62, v58
    v_mov_b32 v58, v62
    s_nop 1
    v_permlane32_swap_b32 v62, v58
    s_nop 1
    v_max_f32 v62, v62, v58
    v_add_f32 v62, 0x41c00000, v62
    v_max_f32 v62, 0, v62
    v_exp_f32 v58, -v62
    v_sub_f32 v68, v68, v62
    v_sub_f32 v84, v84, v62
    v_sub_f32 v148, v148, v62
    v_sub_f32 v69, v69, v62
    v_sub_f32 v85, v85, v62
    v_sub_f32 v149, v149, v62
    v_sub_f32 v70, v70, v62
    v_sub_f32 v86, v86, v62
    v_sub_f32 v150, v150, v62
    v_sub_f32 v71, v71, v62
    v_sub_f32 v87, v87, v62
    v_sub_f32 v151, v151, v62
    v_sub_f32 v76, v76, v62
    v_sub_f32 v92, v92, v62
    v_sub_f32 v156, v156, v62
    v_sub_f32 v77, v77, v62
    v_sub_f32 v93, v93, v62
    v_sub_f32 v157, v157, v62
    v_sub_f32 v78, v78, v62
    v_sub_f32 v94, v94, v62
    v_sub_f32 v158, v158, v62
    v_sub_f32 v79, v79, v62
    v_sub_f32 v95, v95, v62
    v_sub_f32 v159, v159, v62
    v_mul_f32 v162, v58, v162
    v_mul_f32 v163, v58, v163
    v_mul_f32 v196, v58, v196
    v_mul_f32 v197, v58, v197
    v_mul_f32 v198, v58, v198
    v_mul_f32 v199, v58, v199
    v_mul_f32 v204, v58, v204
    v_mul_f32 v205, v58, v205
    v_mul_f32 v206, v58, v206
    v_mul_f32 v207, v58, v207
    v_mul_f32 v212, v58, v212
    v_mul_f32 v213, v58, v213
    v_mul_f32 v214, v58, v214
    v_mul_f32 v215, v58, v215
    v_mul_f32 v220, v58, v220
    v_mul_f32 v221, v58, v221
    v_mul_f32 v222, v58, v222
    v_mul_f32 v223, v58, v223
    v_mul_f32 v228, v58, v228
    v_mul_f32 v229, v58, v229
    v_mul_f32 v230, v58, v230
    v_mul_f32 v231, v58, v231
    v_mul_f32 v236, v58, v236
    v_mul_f32 v237, v58, v237
    v_mul_f32 v238, v58, v238
    v_mul_f32 v239, v58, v239
    v_mul_f32 v244, v58, v244
    v_mul_f32 v245, v58, v245
    v_mul_f32 v246, v58, v246
    v_mul_f32 v247, v58, v247
    v_mul_f32 v252, v58, v252
    v_mul_f32 v253, v58, v253
    v_mul_f32 v254, v58, v254
    v_mul_f32 v255, v58, v255
    v_exp_f32 v58, v80
    s_nop 0
    v_exp_f32 v59, v81
    s_nop 0
    v_cvt_pk_bf16_f32 v136, v58, v59
    v_exp_f32 v60, v82
    s_nop 0
    v_exp_f32 v61, v83
    s_nop 0
    v_cvt_pk_bf16_f32 v137, v60, v61
    v_exp_f32 v58, v84
    s_nop 0
    v_exp_f32 v59, v85
    s_nop 0
    v_cvt_pk_bf16_f32 v140, v58, v59
    v_exp_f32 v60, v86
    s_nop 0
    v_exp_f32 v61, v87
    s_nop 0
    v_cvt_pk_bf16_f32 v141, v60, v61
    v_exp_f32 v58, v88
    s_nop 0
    v_exp_f32 v59, v89
    s_nop 0
    v_cvt_pk_bf16_f32 v138, v58, v59
    v_exp_f32 v60, v90
    s_nop 0
    v_exp_f32 v61, v91
    s_nop 0
    v_cvt_pk_bf16_f32 v139, v60, v61
    v_exp_f32 v58, v92
    s_nop 0
    v_exp_f32 v59, v93
    s_nop 0
    v_cvt_pk_bf16_f32 v142, v58, v59
    v_exp_f32 v60, v94
    s_nop 0
    v_exp_f32 v61, v95
    s_nop 0
    v_cvt_pk_bf16_f32 v143, v60, v61
    s_nop 1
    s_setpc_b64 s[80:81]
L_adone:
    ds_read_b128 v[16:19], v4 offset:0
    ds_read_b128 v[20:23], v4 offset:1024
    ds_read_b128 v[24:27], v4 offset:2048
    ds_read_b128 v[28:31], v4 offset:3072
    s_waitcnt lgkmcnt(3)
    v_mfma_f32_16x16x32_bf16 v[56:59], v[96:99], v[16:19], 0
    s_lshr_b32 s6, s3, 2
    s_mul_i32 s67, s6, 15360
    s_add_u32 s67, s67, 98304
    v_mfma_f32_16x16x32_bf16 v[60:63], v[100:103], v[16:19], 0
    v_add_u32 v6, s67, v44
    s_mul_i32 s73, s6, 5120
    s_add_u32 s73, s73, 67108864
    v_mfma_f32_16x16x32_bf16 v[64:67], v[104:107], v[16:19], 0
    s_lshl_b32 s6, s6, 1
    s_sub_u32 s71, s76, s6
    s_and_b32 s71, s71, 3
    v_mfma_f32_16x16x32_bf16 v[68:71], v[108:111], v[16:19], 0
    s_waitcnt lgkmcnt(2)
    v_mov_b32 v11, 0x5000000
    s_lshl_b32 s74, s3, 2
    s_add_u32 s74, s74, 15728640
    v_mfma_f32_16x16x32_bf16 v[72:75], v[112:115], v[16:19], 0
    ds_read_b128 v[16:19], v4 offset:4096
    s_and_b32 s72, s4, 7
    s_lshl_b32 s7, s5, 3
    s_add_u32 s72, s72, s7
    v_mfma_f32_16x16x32_bf16 v[56:59], v[116:119], v[20:23], v[56:59]
    s_mul_i32 s72, s72, 12
    s_lshr_b32 s75, s4, 3
    s_mul_i32 s7, s75, 3
    v_mfma_f32_16x16x32_bf16 v[60:63], v[120:123], v[20:23], v[60:63]
    s_add_u32 s7, s7, s72
    s_mul_i32 s62, s7, 20480
    s_add_u32 s62, s62, 67108864
    v_mfma_f32_16x16x32_bf16 v[64:67], v[124:127], v[20:23], v[64:67]
    s_lshl_b32 s7, s7, 7
    s_add_u32 s63, s7, 15728640
    s_add_u32 s6, s75, 1
    v_mfma_f32_16x16x32_bf16 v[68:71], v[128:131], v[20:23], v[68:71]
    s_waitcnt lgkmcnt(2)
    s_and_b32 s6, s6, 3
    s_mul_i32 s6, s6, 3
    s_add_u32 s6, s6, s72
    v_mfma_f32_16x16x32_bf16 v[72:75], v[132:135], v[20:23], v[72:75]
    ds_read_b128 v[20:23], v4 offset:5120
    s_add_u32 s6, s6, 0
    s_mul_i32 s7, s6, 20480
    s_add_u32 s96, s7, s73
    v_mfma_f32_16x16x32_bf16 v[72:75], v[152:155], v[24:27], v[72:75]
    s_lshl_b32 s6, s6, 7
    s_add_u32 s6, s6, s74
    v_writelane_b32 v11, s6, 0
    v_mfma_f32_16x16x32_bf16 v[68:71], v[148:151], v[24:27], v[68:71]
    s_add_u32 s6, s75, 2
    s_and_b32 s6, s6, 3
    s_mul_i32 s6, s6, 3
    v_mfma_f32_16x16x32_bf16 v[64:67], v[144:147], v[24:27], v[64:67]
    s_add_u32 s6, s6, s72
    s_add_u32 s6, s6, 1
    s_mul_i32 s7, s6, 20480
    v_mfma_f32_16x16x32_bf16 v[60:63], v[140:143], v[24:27], v[60:63]
    s_waitcnt lgkmcnt(2)
    s_add_u32 s97, s7, s73
    s_lshl_b32 s6, s6, 7
    s_add_u32 s6, s6, s74
    v_mfma_f32_16x16x32_bf16 v[56:59], v[136:139], v[24:27], v[56:59]
    ds_read_b128 v[24:27], v4 offset:6144
    v_writelane_b32 v11, s6, 1
    s_add_u32 s6, s75, 3
    s_and_b32 s6, s6, 3
    v_mfma_f32_16x16x32_bf16 v[56:59], v[156:159], v[28:31], v[56:59]
    s_mul_i32 s6, s6, 3
    s_add_u32 s6, s6, s72
    s_add_u32 s6, s6, 2
    v_mfma_f32_16x16x32_bf16 v[60:63], v[160:163], v[28:31], v[60:63]
    s_mul_i32 s7, s6, 20480
    s_add_u32 s98, s7, s73
    s_lshl_b32 s6, s6, 7
    v_mfma_f32_16x16x32_bf16 v[64:67], v[164:167], v[28:31], v[64:67]
    s_add_u32 s6, s6, s74
    v_writelane_b32 v11, s6, 2
    v_mfma_f32_16x16x32_bf16 v[68:71], v[168:171], v[28:31], v[68:71]
    s_waitcnt lgkmcnt(2)
    v_mfma_f32_16x16x32_bf16 v[72:75], v[172:175], v[28:31], v[72:75]
    ds_read_b128 v[28:31], v4 offset:7168
    s_waitcnt vmcnt(0)
    v_mfma_f32_16x16x32_bf16 v[72:75], v[192:195], v[16:19], v[72:75]
    v_mfma_f32_16x16x32_bf16 v[68:71], v[188:191], v[16:19], v[68:71]
    s_add_u32 s65, s68, 3
    s_and_b32 s65, s65, 3
    s_andn2_b32 s7, s68, 3
    v_mfma_f32_16x16x32_bf16 v[64:67], v[184:187], v[16:19], v[64:67]
    s_add_u32 s65, s65, s7
    s_lshl_b32 s65, s65, 17
    s_add_u32 s65, s65, s66
    v_mfma_f32_16x16x32_bf16 v[60:63], v[180:183], v[16:19], v[60:63]
    s_waitcnt lgkmcnt(2)
    s_add_u32 m0, s99, 65536
    v_mfma_f32_16x16x32_bf16 v[56:59], v[176:179], v[16:19], v[56:59]
    s_cmp_ge_u32 s3, 4
    s_cbranch_scc1 L_o0
    s_waitcnt vmcnt(0)
    s_barrier
L_o0:
    ds_read_b128 v[16:19], v4 offset:32768
    v_mfma_f32_16x16x32_bf16 v[56:59], v[196:199], v[20:23], v[56:59]
    buffer_load_dwordx4 v13, s[8:11], s65 offen offset:0 sc1 lds
    v_mfma_f32_16x16x32_bf16 v[60:63], v[200:203], v[20:23], v[60:63]
    buffer_load_dwordx4 v13, s[8:11], s65 offen offset:1024 sc1 lds
    v_mfma_f32_16x16x32_bf16 v[64:67], v[204:207], v[20:23], v[64:67]
    v_mfma_f32_16x16x32_bf16 v[68:71], v[208:211], v[20:23], v[68:71]
    buffer_load_dwordx4 v13, s[8:11], s65 offen offset:2048 sc1 lds
    s_waitcnt lgkmcnt(2)
    v_mfma_f32_16x16x32_bf16 v[72:75], v[212:215], v[20:23], v[72:75]
    ds_read_b128 v[20:23], v4 offset:33792
    v_mfma_f32_16x16x32_bf16 v[72:75], v[232:235], v[24:27], v[72:75]
    buffer_load_dwordx4 v13, s[8:11], s65 offen offset:3072 sc1 lds
    v_mfma_f32_16x16x32_bf16 v[68:71], v[228:231], v[24:27], v[68:71]
    v_mfma_f32_16x16x32_bf16 v[64:67], v[224:227], v[24:27], v[64:67]
    v_mfma_f32_16x16x32_bf16 v[60:63], v[220:223], v[24:27], v[60:63]
    s_waitcnt lgkmcnt(2)
    v_mfma_f32_16x16x32_bf16 v[56:59], v[216:219], v[24:27], v[56:59]
    ds_read_b128 v[24:27], v4 offset:34816
    v_mfma_f32_16x16x32_bf16 v[56:59], v[236:239], v[28:31], v[56:59]
    v_mfma_f32_16x16x32_bf16 v[60:63], v[240:243], v[28:31], v[60:63]
    v_mfma_f32_16x16x32_bf16 v[64:67], v[244:247], v[28:31], v[64:67]
    v_mfma_f32_16x16x32_bf16 v[68:71], v[248:251], v[28:31], v[68:71]
    s_waitcnt lgkmcnt(2)
    v_mfma_f32_16x16x32_bf16 v[72:75], v[252:255], v[28:31], v[72:75]
    ds_read_b128 v[28:31], v4 offset:35840
    v_mfma_f32_16x16x32_bf16 v[76:79], v[96:99], v[16:19], 0
    s_sub_u32 s6, s71, 1
    s_and_b32 s6, s6, 3
    s_mul_i32 s7, s6, 5120
    v_mfma_f32_16x16x32_bf16 v[80:83], v[100:103], v[16:19], 0
    s_add_u32 s7, s7, s67
    s_cmp_eq_u32 s6, 3
    s_cselect_b32 s7, 155648, s7
    v_mfma_f32_16x16x32_bf16 v[84:87], v[104:107], v[16:19], 0
    v_add_u32 v12, s7, v52
    v_add_u32 v5, s67, v45
    v_mfma_f32_16x16x32_bf16 v[88:91], v[108:111], v[16:19], 0
    s_waitcnt lgkmcnt(2)
    v_mfma_f32_16x16x32_bf16 v[92:95], v[112:115], v[16:19], 0
    ds_read_b128 v[16:19], v4 offset:36864
    v_mfma_f32_16x16x32_bf16 v[76:79], v[116:119], v[20:23], v[76:79]
    ds_write_b128 v5, v[60:63] offset:0
    v_add_u32 v5, s67, v46
    v_mfma_f32_16x16x32_bf16 v[80:83], v[120:123], v[20:23], v[80:83]
    v_mfma_f32_16x16x32_bf16 v[84:87], v[124:127], v[20:23], v[84:87]
    v_mfma_f32_16x16x32_bf16 v[88:91], v[128:131], v[20:23], v[88:91]
    s_waitcnt lgkmcnt(3)
    v_mfma_f32_16x16x32_bf16 v[92:95], v[132:135], v[20:23], v[92:95]
    ds_read_b128 v[20:23], v4 offset:37888
    v_mfma_f32_16x16x32_bf16 v[92:95], v[152:155], v[24:27], v[92:95]
    ds_write_b128 v5, v[64:67] offset:5120
    v_add_u32 v5, s67, v47
    v_mfma_f32_16x16x32_bf16 v[88:91], v[148:151], v[24:27], v[88:91]
    v_mfma_f32_16x16x32_bf16 v[84:87], v[144:147], v[24:27], v[84:87]
    v_mfma_f32_16x16x32_bf16 v[80:83], v[140:143], v[24:27], v[80:83]
    s_waitcnt lgkmcnt(4)
    v_mfma_f32_16x16x32_bf16 v[76:79], v[136:139], v[24:27], v[76:79]
    ds_read_b128 v[24:27], v4 offset:38912
    v_mfma_f32_16x16x32_bf16 v[76:79], v[156:159], v[28:31], v[76:79]
    ds_write_b128 v5, v[68:71] offset:10240
    v_add_u32 v5, s67, v52
    v_mfma_f32_16x16x32_bf16 v[80:83], v[160:163], v[28:31], v[80:83]
    v_mfma_f32_16x16x32_bf16 v[84:87], v[164:167], v[28:31], v[84:87]
    v_mfma_f32_16x16x32_bf16 v[88:91], v[168:171], v[28:31], v[88:91]
    s_waitcnt lgkmcnt(5)
    v_mfma_f32_16x16x32_bf16 v[92:95], v[172:175], v[28:31], v[92:95]
    ds_read_b128 v[28:31], v4 offset:39936
    v_mfma_f32_16x16x32_bf16 v[92:95], v[192:195], v[16:19], v[92:95]
    ds_write_b128 v12, v[72:75] offset:0
    v_mfma_f32_16x16x32_bf16 v[88:91], v[188:191], v[16:19], v[88:91]
    v_mfma_f32_16x16x32_bf16 v[84:87], v[184:187], v[16:19], v[84:87]
    v_and_b32 v3, 1, v1
    v_lshlrev_b32 v3, 12, v3
    s_lshr_b32 s72, s61, 2
    s_lshl_b32 s72, s72, 6
    s_andn2_b32 s6, s4, 7
    s_add_u32 s72, s72, s6
    s_add_u32 s72, s72, s3
    s_lshl_b32 s72, s72, 7
    s_add_u32 s72, s72, 3932160
    v_mfma_f32_16x16x32_bf16 v[80:83], v[180:183], v[16:19], v[80:83]
    s_waitcnt lgkmcnt(5)
    v_mfma_f32_16x16x32_bf16 v[76:79], v[176:179], v[16:19], v[76:79]
    s_waitcnt vmcnt(0)
    s_waitcnt lgkmcnt(0)
    s_barrier
    ds_read_b128 v[32:35], v6 offset:0
    ds_read_b128 v[36:39], v6 offset:5120
    ds_read_b128 v[40:43], v6 offset:10240
    ds_read_b128 v[16:19], v7 offset:0
    v_mfma_f32_16x16x32_bf16 v[76:79], v[196:199], v[20:23], v[76:79]
    v_mfma_f32_16x16x32_bf16 v[80:83], v[200:203], v[20:23], v[80:83]
    v_mfma_f32_16x16x32_bf16 v[84:87], v[204:207], v[20:23], v[84:87]
    s_waitcnt lgkmcnt(3)
    v_add_f32 v56, v56, v32
    v_add_f32 v57, v57, v33
    v_mfma_f32_16x16x32_bf16 v[88:91], v[208:211], v[20:23], v[88:91]
    v_add_f32 v58, v58, v34
    v_add_f32 v59, v59, v35
    v_mfma_f32_16x16x32_bf16 v[92:95], v[212:215], v[20:23], v[92:95]
    s_waitcnt lgkmcnt(2)
    ds_read_b128 v[32:35], v5 offset:0
    ds_read_b128 v[20:23], v7 offset:1024
    v_add_f32 v56, v56, v36
    v_add_f32 v57, v57, v37
    v_mfma_f32_16x16x32_bf16 v[92:95], v[232:235], v[24:27], v[92:95]
    buffer_load_dword v50, v3, s[8:11], s72 offen sc1
    v_add_f32 v58, v58, v38
    v_add_f32 v59, v59, v39
    v_mfma_f32_16x16x32_bf16 v[88:91], v[228:231], v[24:27], v[88:91]
    s_waitcnt lgkmcnt(3)
    ds_read_b128 v[36:39], v5 offset:5120
    v_add_f32 v56, v56, v40
    v_add_f32 v57, v57, v41
    v_mfma_f32_16x16x32_bf16 v[84:87], v[224:227], v[24:27], v[84:87]
    v_add_f32 v58, v58, v42
    v_add_f32 v59, v59, v43
    v_mfma_f32_16x16x32_bf16 v[80:83], v[220:223], v[24:27], v[80:83]
    ds_read_b128 v[40:43], v5 offset:10240
    s_waitcnt lgkmcnt(3)
    v_add_f32 v72, v72, v32
    v_add_f32 v73, v73, v33
    s_add_u32 s6, s96, 0
    v_mfma_f32_16x16x32_bf16 v[76:79], v[216:219], v[24:27], v[76:79]
    ds_read_b128 v[24:27], v7 offset:2048
    v_add_f32 v74, v74, v34
    v_add_f32 v75, v75, v35
    v_mfma_f32_16x16x32_bf16 v[76:79], v[236:239], v[28:31], v[76:79]
    buffer_store_dwordx4 v[56:59], v44, s[8:11], s6 offen sc1
    s_waitcnt lgkmcnt(2)
    v_add_f32 v72, v72, v36
    v_add_f32 v73, v73, v37
    v_mfma_f32_16x16x32_bf16 v[80:83], v[240:243], v[28:31], v[80:83]
    v_add_f32 v74, v74, v38
    v_add_f32 v75, v75, v39
    v_mfma_f32_16x16x32_bf16 v[84:87], v[244:247], v[28:31], v[84:87]
    s_waitcnt lgkmcnt(1)
    v_add_f32 v72, v72, v40
    v_add_f32 v73, v73, v41
    v_mfma_f32_16x16x32_bf16 v[88:91], v[248:251], v[28:31], v[88:91]
    v_add_f32 v74, v74, v42
    v_add_f32 v75, v75, v43
    s_cmp_lg_u32 s71, 0
    v_mfma_f32_16x16x32_bf16 v[92:95], v[252:255], v[28:31], v[92:95]
    s_cbranch_scc1 L_nost_50
    buffer_store_dwordx4 v[72:75], v52, s[8:11], s6 offen sc1
L_nost_50:
    ds_read_b128 v[28:31], v7 offset:3072
    v_mfma_f32_16x16x32_bf16 v[56:59], v[96:99], v[16:19], 0
    s_sub_u32 s6, s71, 2
    s_and_b32 s6, s6, 3
    s_mul_i32 s7, s6, 5120
    v_mfma_f32_16x16x32_bf16 v[60:63], v[100:103], v[16:19], 0
    s_add_u32 s7, s7, s67
    s_cmp_eq_u32 s6, 3
    s_cselect_b32 s7, 124928, s7
    v_mfma_f32_16x16x32_bf16 v[64:67], v[104:107], v[16:19], 0
    v_add_u32 v12, s7, v52
    v_add_u32 v5, s67, v45
    s_waitcnt vmcnt(1)
    v_cmp_ne_u32 vcc, 1, v50
    s_cbranch_vccz L_o1
    s_mov_b32 s79, 262144
L_poll_52:
    buffer_load_dword v2, v3, s[8:11], s72 offen sc1
    s_waitcnt vmcnt(0)
    v_cmp_ne_u32 vcc, 1, v2
    s_cbranch_vccz L_polldone_53
    s_sleep 1
    s_sub_u32 s79, s79, 1
    s_cmp_lg_u32 s79, 0
    s_cbranch_scc1 L_poll_52
L_polldone_53:
L_o1:
    v_mfma_f32_16x16x32_bf16 v[68:71], v[108:111], v[16:19], 0
    s_add_u32 s65, s61, 1
    s_and_b32 s65, s65, 3
    s_andn2_b32 s7, s61, 3
    v_mfma_f32_16x16x32_bf16 v[72:75], v[112:115], v[16:19], 0
    ds_read_b128 v[16:19], v7 offset:4096
    s_add_u32 s65, s65, s7
    s_lshl_b32 s65, s65, 17
    s_add_u32 s65, s65, s66
    v_mfma_f32_16x16x32_bf16 v[56:59], v[116:119], v[20:23], v[56:59]
    ds_write_b128 v5, v[80:83] offset:30720
    v_add_u32 v5, s67, v46
    s_add_u32 m0, s99, 0
    v_mfma_f32_16x16x32_bf16 v[60:63], v[120:123], v[20:23], v[60:63]
    buffer_load_dwordx4 v13, s[8:11], s65 offen offset:1024 sc1 lds
    buffer_load_dwordx4 v13, s[8:11], s65 offen offset:0 sc1 lds
    v_mfma_f32_16x16x32_bf16 v[64:67], v[124:127], v[20:23], v[64:67]
    buffer_load_dwordx4 v13, s[8:11], s65 offen offset:3072 sc1 lds
    buffer_load_dwordx4 v13, s[8:11], s65 offen offset:2048 sc1 lds
    v_mfma_f32_16x16x32_bf16 v[68:71], v[128:131], v[20:23], v[68:71]
    s_waitcnt lgkmcnt(3)
    s_add_u32 s65, s61, 2
    s_and_b32 s65, s65, 3
    s_andn2_b32 s7, s61, 3
    v_mfma_f32_16x16x32_bf16 v[72:75], v[132:135], v[20:23], v[72:75]
    ds_read_b128 v[20:23], v7 offset:5120
    s_add_u32 s65, s65, s7
    s_lshl_b32 s65, s65, 17
    s_add_u32 s65, s65, s66
    v_mfma_f32_16x16x32_bf16 v[72:75], v[152:155], v[24:27], v[72:75]
    ds_write_b128 v5, v[84:87] offset:35840
    v_add_u32 v5, s67, v47
    s_add_u32 m0, s99, 32768
    v_mfma_f32_16x16x32_bf16 v[68:71], v[148:151], v[24:27], v[68:71]
    buffer_load_dwordx4 v13, s[8:11], s65 offen offset:0 sc1 lds
    v_mfma_f32_16x16x32_bf16 v[64:67], v[144:147], v[24:27], v[64:67]
    buffer_load_dwordx4 v13, s[8:11], s65 offen offset:1024 sc1 lds
    v_mfma_f32_16x16x32_bf16 v[60:63], v[140:143], v[24:27], v[60:63]
    buffer_load_dwordx4 v13, s[8:11], s65 offen offset:2048 sc1 lds
    s_waitcnt lgkmcnt(4)
    v_mfma_f32_16x16x32_bf16 v[56:59], v[136:139], v[24:27], v[56:59]
    ds_read_b128 v[24:27], v7 offset:6144
    v_mfma_f32_16x16x32_bf16 v[56:59], v[156:159], v[28:31], v[56:59]
    ds_write_b128 v5, v[88:91] offset:40960
    v_add_u32 v5, s67, v52
    v_mfma_f32_16x16x32_bf16 v[60:63], v[160:163], v[28:31], v[60:63]
    buffer_load_dwordx4 v13, s[8:11], s65 offen offset:3072 sc1 lds
    v_mfma_f32_16x16x32_bf16 v[64:67], v[164:167], v[28:31], v[64:67]
    v_mfma_f32_16x16x32_bf16 v[68:71], v[168:171], v[28:31], v[68:71]
    s_waitcnt lgkmcnt(5)
    v_mfma_f32_16x16x32_bf16 v[72:75], v[172:175], v[28:31], v[72:75]
    ds_read_b128 v[28:31], v7 offset:7168
    v_mfma_f32_16x16x32_bf16 v[72:75], v[192:195], v[16:19], v[72:75]
    ds_write_b128 v12, v[92:95] offset:30720
    v_mfma_f32_16x16x32_bf16 v[68:71], v[188:191], v[16:19], v[68:71]
    s_add_u32 s65, s61, 3
    s_and_b32 s65, s65, 3
    s_andn2_b32 s7, s61, 3
    v_mfma_f32_16x16x32_bf16 v[64:67], v[184:187], v[16:19], v[64:67]
    s_add_u32 s65, s65, s7
    s_lshl_b32 s65, s65, 17
    s_add_u32 s65, s65, s66
    v_mfma_f32_16x16x32_bf16 v[60:63], v[180:183], v[16:19], v[60:63]
    s_waitcnt lgkmcnt(5)
    s_add_u32 m0, s99, 65536
    v_mfma_f32_16x16x32_bf16 v[56:59], v[176:179], v[16:19], v[56:59]
    s_waitcnt vmcnt(4)
    s_waitcnt lgkmcnt(0)
    s_barrier
    ds_read_b128 v[32:35], v6 offset:30720
    ds_read_b128 v[36:39], v6 offset:35840
    ds_read_b128 v[40:43], v6 offset:40960
    ds_read_b128 v[16:19], v4 offset:0
    v_mfma_f32_16x16x32_bf16 v[56:59], v[196:199], v[20:23], v[56:59]
    buffer_load_dwordx4 v13, s[8:11], s65 offen offset:0 sc1 lds
    v_mfma_f32_16x16x32_bf16 v[60:63], v[200:203], v[20:23], v[60:63]
    buffer_load_dwordx4 v13, s[8:11], s65 offen offset:1024 sc1 lds
    v_mfma_f32_16x16x32_bf16 v[64:67], v[204:207], v[20:23], v[64:67]
    s_waitcnt lgkmcnt(3)
    v_add_f32 v76, v76, v32
    v_add_f32 v77, v77, v33
    v_mfma_f32_16x16x32_bf16 v[68:71], v[208:211], v[20:23], v[68:71]
    buffer_load_dwordx4 v13, s[8:11], s65 offen offset:2048 sc1 lds
    v_add_f32 v78, v78, v34
    v_add_f32 v79, v79, v35
    v_mfma_f32_16x16x32_bf16 v[72:75], v[212:215], v[20:23], v[72:75]
    s_waitcnt lgkmcnt(2)
    ds_read_b128 v[32:35], v5 offset:30720
    ds_read_b128 v[20:23], v4 offset:1024
    v_add_f32 v76, v76, v36
    v_add_f32 v77, v77, v37
    v_mfma_f32_16x16x32_bf16 v[72:75], v[232:235], v[24:27], v[72:75]
    buffer_load_dwordx4 v13, s[8:11], s65 offen offset:3072 sc1 lds
    v_add_f32 v78, v78, v38
    v_add_f32 v79, v79, v39
    v_mfma_f32_16x16x32_bf16 v[68:71], v[228:231], v[24:27], v[68:71]
    s_waitcnt lgkmcnt(3)
    ds_read_b128 v[36:39], v5 offset:35840
    v_add_f32 v76, v76, v40
    v_add_f32 v77, v77, v41
    v_mfma_f32_16x16x32_bf16 v[64:67], v[224:227], v[24:27], v[64:67]
    v_add_f32 v78, v78, v42
    v_add_f32 v79, v79, v43
    v_mfma_f32_16x16x32_bf16 v[60:63], v[220:223], v[24:27], v[60:63]
    ds_read_b128 v[40:43], v5 offset:40960
    s_waitcnt lgkmcnt(3)
    v_add_f32 v92, v92, v32
    v_add_f32 v93, v93, v33
    s_add_u32 s6, s97, 0
    v_mfma_f32_16x16x32_bf16 v[56:59], v[216:219], v[24:27], v[56:59]
    ds_read_b128 v[24:27], v4 offset:2048
    v_add_f32 v94, v94, v34
    v_add_f32 v95, v95, v35
    v_mfma_f32_16x16x32_bf16 v[56:59], v[236:239], v[28:31], v[56:59]
    buffer_store_dwordx4 v[76:79], v44, s[8:11], s6 offen sc1
    s_waitcnt lgkmcnt(2)
    v_add_f32 v92, v92, v36
    v_add_f32 v93, v93, v37
    v_mfma_f32_16x16x32_bf16 v[60:63], v[240:243], v[28:31], v[60:63]
    v_add_f32 v94, v94, v38
    v_add_f32 v95, v95, v39
    v_mfma_f32_16x16x32_bf16 v[64:67], v[244:247], v[28:31], v[64:67]
    s_waitcnt lgkmcnt(1)
    v_add_f32 v92, v92, v40
    v_add_f32 v93, v93, v41
    v_mfma_f32_16x16x32_bf16 v[68:71], v[248:251], v[28:31], v[68:71]
    v_add_f32 v94, v94, v42
    v_add_f32 v95, v95, v43
    s_cmp_lg_u32 s71, 1
    v_mfma_f32_16x16x32_bf16 v[72:75], v[252:255], v[28:31], v[72:75]
    s_cbranch_scc1 L_nost_51
    buffer_store_dwordx4 v[92:95], v52, s[8:11], s6 offen sc1
L_nost_51:
    ds_read_b128 v[28:31], v4 offset:3072
    v_mfma_f32_16x16x32_bf16 v[76:79], v[96:99], v[16:19], 0
    s_sub_u32 s6, s71, 3
    s_and_b32 s6, s6, 3
    s_mul_i32 s7, s6, 5120
    v_mfma_f32_16x16x32_bf16 v[80:83], v[100:103], v[16:19], 0
    s_add_u32 s7, s7, s67
    s_cmp_eq_u32 s6, 3
    s_cselect_b32 s7, 155648, s7
    v_mfma_f32_16x16x32_bf16 v[84:87], v[104:107], v[16:19], 0
    v_add_u32 v12, s7, v52
    v_add_u32 v5, s67, v45
    v_mfma_f32_16x16x32_bf16 v[88:91], v[108:111], v[16:19], 0
    s_mov_b32 s12, s32
    s_mov_b32 s13, s33
    s_mov_b32 s14, 0x280000
    s_mov_b32 s15, 0x20000
    v_mfma_f32_16x16x32_bf16 v[92:95], v[112:115], v[16:19], 0
    ds_read_b128 v[16:19], v4 offset:4096
    s_and_b32 s75, s4, 3
    s_mul_i32 s70, s75, 320
    s_add_u32 s73, s70, 3837952
    s_mul_i32 s72, s75, 5120
    v_mfma_f32_16x16x32_bf16 v[76:79], v[116:119], v[20:23], v[76:79]
    ds_write_b128 v5, v[60:63] offset:0
    v_add_u32 v5, s67, v46
    v_mfma_f32_16x16x32_bf16 v[80:83], v[120:123], v[20:23], v[80:83]
    v_lshrrev_b32 v2, 4, v1
    v_and_b32 v3, 15, v1
    v_mul_u32_u24 v54, 1280, v3
    v_lshl_add_u32 v54, v2, 4, v54
    v_mfma_f32_16x16x32_bf16 v[84:87], v[124:127], v[20:23], v[84:87]
    v_lshlrev_b32 v3, 4, v3
    v_lshl_add_u32 v9, v2, 9, v3
    s_lshr_b32 s100, s3, 2
    s_cselect_b32 s6, s61, s68
    v_mfma_f32_16x16x32_bf16 v[88:91], v[128:131], v[20:23], v[88:91]
    s_waitcnt lgkmcnt(3)
    s_mul_i32 s6, s6, 20480
    s_lshl_b32 s7, s76, 6
    s_add_u32 s7, s7, s6
    v_add_u32 v53, s7, v54
    v_mfma_f32_16x16x32_bf16 v[92:95], v[132:135], v[20:23], v[92:95]
    ds_read_b128 v[20:23], v4 offset:5120
    s_lshl_b32 s7, s76, 10
    s_add_u32 s7, s7, s6
    s_add_u32 s7, s7, s72
    v_add_u32 v48, s7, v13
    v_mfma_f32_16x16x32_bf16 v[92:95], v[152:155], v[24:27], v[92:95]
    ds_write_b128 v5, v[64:67] offset:5120
    v_add_u32 v5, s67, v47
    v_mfma_f32_16x16x32_bf16 v[88:91], v[148:151], v[24:27], v[88:91]
    s_mul_i32 s6, s100, 10240
    s_lshl_b32 s7, s76, 11
    s_add_u32 s6, s6, s7
    v_add_u32 v8, s6, v9
    v_mfma_f32_16x16x32_bf16 v[84:87], v[144:147], v[24:27], v[84:87]
    s_mul_i32 s6, s100, 75776
    s_sub_u32 s6, 65536, s6
    v_add_u32 v10, s6, v8
    s_lshl_b32 s7, s76, 2
    v_mfma_f32_16x16x32_bf16 v[80:83], v[140:143], v[24:27], v[80:83]
    s_waitcnt lgkmcnt(4)
    v_add_u32 v2, s7, v2
    v_cmp_lt_u32 vcc, 9, v2
    s_mul_i32 s6, s100, 86016
    s_add_u32 s6, s6, 15360
    v_mfma_f32_16x16x32_bf16 v[76:79], v[136:139], v[24:27], v[76:79]
    ds_read_b128 v[24:27], v4 offset:6144
    v_add_u32 v3, s6, v10
    v_cndmask_b32 v10, v10, v3, vcc
    s_and_b32 s100, s3, 1
    s_cselect_b32 s6, s61, s68
    v_mfma_f32_16x16x32_bf16 v[76:79], v[156:159], v[28:31], v[76:79]
    ds_write_b128 v5, v[68:71] offset:10240
    v_add_u32 v5, s67, v52
    v_mfma_f32_16x16x32_bf16 v[80:83], v[160:163], v[28:31], v[80:83]
    s_mul_i32 s6, s6, 20480
    s_add_u32 s7, s6, 256
    v_add_u32 v54, s7, v54
    s_add_u32 s7, s6, s72
    v_mfma_f32_16x16x32_bf16 v[84:87], v[164:167], v[28:31], v[84:87]
    s_add_u32 s7, s7, 4096
    v_add_u32 v49, s7, v13
    s_mul_i32 s6, s100, 10240
    s_add_u32 s6, s6, 8192
    v_mfma_f32_16x16x32_bf16 v[88:91], v[168:171], v[28:31], v[88:91]
    s_waitcnt lgkmcnt(5)
    v_add_u32 v9, s6, v9
    s_mul_i32 s6, s100, 10240
    s_add_u32 s6, s6, 80896
    v_add_u32 v55, s6, v9
    v_mfma_f32_16x16x32_bf16 v[92:95], v[172:175], v[28:31], v[92:95]
    ds_read_b128 v[28:31], v4 offset:7168
    v_mfma_f32_16x16x32_bf16 v[92:95], v[192:195], v[16:19], v[92:95]
    ds_write_b128 v12, v[72:75] offset:0
    v_mfma_f32_16x16x32_bf16 v[88:91], v[188:191], v[16:19], v[88:91]
    s_add_u32 s65, s68, 0
    s_and_b32 s65, s65, 3
    s_andn2_b32 s7, s68, 3
    v_mfma_f32_16x16x32_bf16 v[84:87], v[184:187], v[16:19], v[84:87]
    s_add_u32 s65, s65, s7
    s_lshl_b32 s65, s65, 17
    s_add_u32 s65, s65, s66
    v_mfma_f32_16x16x32_bf16 v[80:83], v[180:183], v[16:19], v[80:83]
    s_waitcnt lgkmcnt(5)
    s_add_u32 m0, s99, 0
    v_mfma_f32_16x16x32_bf16 v[76:79], v[176:179], v[16:19], v[76:79]
    s_waitcnt vmcnt(5)
    s_waitcnt lgkmcnt(0)
    s_barrier
    ds_read_b128 v[32:35], v6 offset:0
    ds_read_b128 v[36:39], v6 offset:5120
    ds_read_b128 v[40:43], v6 offset:10240
    ds_read_b128 v[16:19], v4 offset:32768
    v_mfma_f32_16x16x32_bf16 v[76:79], v[196:199], v[20:23], v[76:79]
    buffer_load_dwordx4 v13, s[8:11], s65 offen offset:0 sc1 lds
    v_mfma_f32_16x16x32_bf16 v[80:83], v[200:203], v[20:23], v[80:83]
    buffer_load_dwordx4 v13, s[8:11], s65 offen offset:1024 sc1 lds
    v_mfma_f32_16x16x32_bf16 v[84:87], v[204:207], v[20:23], v[84:87]
    s_waitcnt lgkmcnt(3)
    v_add_f32 v56, v56, v32
    v_add_f32 v57, v57, v33
    v_mfma_f32_16x16x32_bf16 v[88:91], v[208:211], v[20:23], v[88:91]
    buffer_load_dwordx4 v13, s[8:11], s65 offen offset:2048 sc1 lds
    v_add_f32 v58, v58, v34
    v_add_f32 v59, v59, v35
    v_mfma_f32_16x16x32_bf16 v[92:95], v[212:215], v[20:23], v[92:95]
    s_waitcnt lgkmcnt(2)
    ds_read_b128 v[32:35], v5 offset:0
    ds_read_b128 v[20:23], v4 offset:33792
    v_add_f32 v56, v56, v36
    v_add_f32 v57, v57, v37
    v_mfma_f32_16x16x32_bf16 v[92:95], v[232:235], v[24:27], v[92:95]
    buffer_load_dwordx4 v13, s[8:11], s65 offen offset:3072 sc1 lds
    v_add_f32 v58, v58, v38
    v_add_f32 v59, v59, v39
    v_mfma_f32_16x16x32_bf16 v[88:91], v[228:231], v[24:27], v[88:91]
    s_waitcnt lgkmcnt(3)
    ds_read_b128 v[36:39], v5 offset:5120
    v_add_f32 v56, v56, v40
    v_add_f32 v57, v57, v41
    v_mfma_f32_16x16x32_bf16 v[84:87], v[224:227], v[24:27], v[84:87]
    v_add_f32 v58, v58, v42
    v_add_f32 v59, v59, v43
    v_mfma_f32_16x16x32_bf16 v[80:83], v[220:223], v[24:27], v[80:83]
    ds_read_b128 v[40:43], v5 offset:10240
    s_waitcnt lgkmcnt(3)
    v_add_f32 v72, v72, v32
    v_add_f32 v73, v73, v33
    s_add_u32 s6, s98, 0
    v_mfma_f32_16x16x32_bf16 v[76:79], v[216:219], v[24:27], v[76:79]
    ds_read_b128 v[24:27], v4 offset:34816
    v_add_f32 v74, v74, v34
    v_add_f32 v75, v75, v35
    v_mfma_f32_16x16x32_bf16 v[76:79], v[236:239], v[28:31], v[76:79]
    buffer_store_dwordx4 v[56:59], v44, s[8:11], s6 offen sc1
    s_waitcnt lgkmcnt(2)
    v_add_f32 v72, v72, v36
    v_add_f32 v73, v73, v37
    v_mfma_f32_16x16x32_bf16 v[80:83], v[240:243], v[28:31], v[80:83]
    v_add_f32 v74, v74, v38
    v_add_f32 v75, v75, v39
    v_mfma_f32_16x16x32_bf16 v[84:87], v[244:247], v[28:31], v[84:87]
    s_waitcnt lgkmcnt(1)
    v_add_f32 v72, v72, v40
    v_add_f32 v73, v73, v41
    v_mfma_f32_16x16x32_bf16 v[88:91], v[248:251], v[28:31], v[88:91]
    v_add_f32 v74, v74, v42
    v_add_f32 v75, v75, v43
    s_cmp_lg_u32 s71, 2
    v_mfma_f32_16x16x32_bf16 v[92:95], v[252:255], v[28:31], v[92:95]
    s_cbranch_scc1 L_nost_54
    buffer_store_dwordx4 v[72:75], v52, s[8:11], s6 offen sc1
L_nost_54:
    ds_read_b128 v[28:31], v4 offset:35840
    v_mfma_f32_16x16x32_bf16 v[56:59], v[96:99], v[16:19], 0
    s_sub_u32 s6, s71, 4
    s_and_b32 s6, s6, 3
    s_mul_i32 s7, s6, 5120
    v_mfma_f32_16x16x32_bf16 v[60:63], v[100:103], v[16:19], 0
    s_add_u32 s7, s7, s67
    s_cmp_eq_u32 s6, 3
    s_cselect_b32 s7, 124928, s7
    v_mfma_f32_16x16x32_bf16 v[64:67], v[104:107], v[16:19], 0
    v_add_u32 v12, s7, v52
    v_add_u32 v5, s67, v45
    v_mfma_f32_16x16x32_bf16 v[68:71], v[108:111], v[16:19], 0
    v_mfma_f32_16x16x32_bf16 v[72:75], v[112:115], v[16:19], 0
    ds_read_b128 v[16:19], v4 offset:36864
    v_mfma_f32_16x16x32_bf16 v[56:59], v[116:119], v[20:23], v[56:59]
    ds_write_b128 v5, v[80:83] offset:30720
    v_add_u32 v5, s67, v46
    v_mfma_f32_16x16x32_bf16 v[60:63], v[120:123], v[20:23], v[60:63]
    v_mfma_f32_16x16x32_bf16 v[64:67], v[124:127], v[20:23], v[64:67]
    v_cmp_le_i32 vcc, 0, v51
    s_cbranch_vccz L_idx_okb
    v_and_b32 v3, 7, v1
    v_lshlrev_b32 v3, 2, v3
    s_mov_b32 s72, 0x3a0000
    s_mov_b32 s79, 262144
L_poll_56:
    buffer_load_dword v51, v3, s[8:11], s72 offen sc1
    s_waitcnt vmcnt(0)
    v_cmp_le_i32 vcc, 0, v51
    s_cbranch_vccz L_polldone_57
    s_sleep 2
    s_sub_u32 s79, s79, 1
    s_cmp_lg_u32 s79, 0
    s_cbranch_scc1 L_poll_56
L_polldone_57:
L_idx_okb:
    s_mov_b32 s64, 0
    v_and_b32 v2, 0x7ff, v51
    v_sub_u32 v2, 0x7ff, v2
    v_lshrrev_b32 v3, 4, v2
    v_cmp_eq_u32 vcc, s68, v3
    v_cmp_eq_u32 s[74:75], s61, v3
    s_nop 3
    s_or_b64 vcc, vcc, s[74:75]
    s_cbranch_scc0 L_notok_58
    v_readlane_b32 s84, v2, 0
    v_readlane_b32 s85, v2, 1
    v_readlane_b32 s86, v2, 2
    v_readlane_b32 s87, v2, 3
    v_readlane_b32 s88, v2, 4
    v_readlane_b32 s65, v2, 5
    v_readlane_b32 s91, v2, 6
    v_readlane_b32 s101, v2, 7
    s_lshl_b32 s7, s76, 6
    s_lshr_b32 s100, s3, 2
    s_cselect_b32 s6, s61, s68
    s_lshl_b32 s6, s6, 4
    v_and_b32 v2, 15, v1
    v_add_u32 v2, s6, v2
    s_add_u32 s7, s7, s73
    v_and_b32 v3, 48, v1
    v_add_u32 v3, s7, v3
    v_cmp_eq_u32 vcc, s84, v2
    s_nop 1
    v_cndmask_b32 v48, v48, v3, vcc
    v_add_u32 v3, 1280, v3
    v_cmp_eq_u32 vcc, s85, v2
    s_nop 1
    v_cndmask_b32 v48, v48, v3, vcc
    v_add_u32 v3, 1280, v3
    v_cmp_eq_u32 vcc, s86, v2
    s_nop 1
    v_cndmask_b32 v48, v48, v3, vcc
    v_add_u32 v3, 1280, v3
    v_cmp_eq_u32 vcc, s87, v2
    s_nop 1
    v_cndmask_b32 v48, v48, v3, vcc
    v_add_u32 v3, 1280, v3
    v_cmp_eq_u32 vcc, s88, v2
    s_nop 1
    v_cndmask_b32 v48, v48, v3, vcc
    v_add_u32 v3, 1280, v3
    v_cmp_eq_u32 vcc, s65, v2
    s_nop 1
    v_cndmask_b32 v48, v48, v3, vcc
    v_add_u32 v3, 1280, v3
    v_cmp_eq_u32 vcc, s91, v2
    s_nop 1
    v_cndmask_b32 v48, v48, v3, vcc
    v_add_u32 v3, 1280, v3
    v_cmp_eq_u32 vcc, s101, v2
    s_nop 1
    v_cndmask_b32 v48, v48, v3, vcc
    s_movk_i32 s7, 256
    s_and_b32 s100, s3, 1
    s_cselect_b32 s6, s61, s68
    s_lshl_b32 s6, s6, 4
    v_and_b32 v2, 15, v1
    v_add_u32 v2, s6, v2
    s_add_u32 s7, s7, s73
    v_and_b32 v3, 48, v1
    v_add_u32 v3, s7, v3
    v_cmp_eq_u32 vcc, s84, v2
    s_nop 1
    v_cndmask_b32 v49, v49, v3, vcc
    v_add_u32 v3, 1280, v3
    v_cmp_eq_u32 vcc, s85, v2
    s_nop 1
    v_cndmask_b32 v49, v49, v3, vcc
    v_add_u32 v3, 1280, v3
    v_cmp_eq_u32 vcc, s86, v2
    s_nop 1
    v_cndmask_b32 v49, v49, v3, vcc
    v_add_u32 v3, 1280, v3
    v_cmp_eq_u32 vcc, s87, v2
    s_nop 1
    v_cndmask_b32 v49, v49, v3, vcc
    v_add_u32 v3, 1280, v3
    v_cmp_eq_u32 vcc, s88, v2
    s_nop 1
    v_cndmask_b32 v49, v49, v3, vcc
    v_add_u32 v3, 1280, v3
    v_cmp_eq_u32 vcc, s65, v2
    s_nop 1
    v_cndmask_b32 v49, v49, v3, vcc
    v_add_u32 v3, 1280, v3
    v_cmp_eq_u32 vcc, s91, v2
    s_nop 1
    v_cndmask_b32 v49, v49, v3, vcc
    v_add_u32 v3, 1280, v3
    v_cmp_eq_u32 vcc, s101, v2
    s_nop 1
    v_cndmask_b32 v49, v49, v3, vcc
    s_mov_b32 s64, 1
L_notok_58:
    v_mfma_f32_16x16x32_bf16 v[68:71], v[128:131], v[20:23], v[68:71]
    s_waitcnt lgkmcnt(3)
    v_mfma_f32_16x16x32_bf16 v[72:75], v[132:135], v[20:23], v[72:75]
    ds_read_b128 v[20:23], v4 offset:37888
    v_mfma_f32_16x16x32_bf16 v[72:75], v[152:155], v[24:27], v[72:75]
    ds_write_b128 v5, v[84:87] offset:35840
    v_add_u32 v5, s67, v47
    v_mfma_f32_16x16x32_bf16 v[68:71], v[148:151], v[24:27], v[68:71]
    v_mfma_f32_16x16x32_bf16 v[64:67], v[144:147], v[24:27], v[64:67]
    v_mfma_f32_16x16x32_bf16 v[60:63], v[140:143], v[24:27], v[60:63]
    s_waitcnt lgkmcnt(4)
    v_mfma_f32_16x16x32_bf16 v[56:59], v[136:139], v[24:27], v[56:59]
    ds_read_b128 v[24:27], v4 offset:38912
    v_mfma_f32_16x16x32_bf16 v[56:59], v[156:159], v[28:31], v[56:59]
    ds_write_b128 v5, v[88:91] offset:40960
    v_add_u32 v5, s67, v52
    v_mfma_f32_16x16x32_bf16 v[60:63], v[160:163], v[28:31], v[60:63]
    v_mfma_f32_16x16x32_bf16 v[64:67], v[164:167], v[28:31], v[64:67]
    v_mfma_f32_16x16x32_bf16 v[68:71], v[168:171], v[28:31], v[68:71]
    s_waitcnt lgkmcnt(5)
    v_mfma_f32_16x16x32_bf16 v[72:75], v[172:175], v[28:31], v[72:75]
    ds_read_b128 v[28:31], v4 offset:39936
    v_mfma_f32_16x16x32_bf16 v[72:75], v[192:195], v[16:19], v[72:75]
    ds_write_b128 v12, v[92:95] offset:30720
    v_mfma_f32_16x16x32_bf16 v[68:71], v[188:191], v[16:19], v[68:71]
    s_add_u32 s65, s61, 0
    s_and_b32 s65, s65, 3
    s_andn2_b32 s7, s61, 3
    v_mfma_f32_16x16x32_bf16 v[64:67], v[184:187], v[16:19], v[64:67]
    s_add_u32 s65, s65, s7
    s_lshl_b32 s65, s65, 17
    s_add_u32 s65, s65, s66
    v_mfma_f32_16x16x32_bf16 v[60:63], v[180:183], v[16:19], v[60:63]
    s_waitcnt lgkmcnt(5)
    s_add_u32 m0, s99, 32768
    v_mfma_f32_16x16x32_bf16 v[56:59], v[176:179], v[16:19], v[56:59]
    s_waitcnt vmcnt(5)
    s_waitcnt lgkmcnt(0)
    s_barrier
    ds_read_b128 v[32:35], v6 offset:30720
    ds_read_b128 v[36:39], v6 offset:35840
    ds_read_b128 v[40:43], v6 offset:40960
    ds_read_b128 v[16:19], v7 offset:0
    v_mfma_f32_16x16x32_bf16 v[56:59], v[196:199], v[20:23], v[56:59]
    buffer_load_dwordx4 v13, s[8:11], s65 offen offset:0 sc1 lds
    v_mfma_f32_16x16x32_bf16 v[60:63], v[200:203], v[20:23], v[60:63]
    buffer_load_dwordx4 v13, s[8:11], s65 offen offset:1024 sc1 lds
    v_mfma_f32_16x16x32_bf16 v[64:67], v[204:207], v[20:23], v[64:67]
    s_waitcnt lgkmcnt(3)
    v_add_f32 v76, v76, v32
    v_add_f32 v77, v77, v33
    v_mfma_f32_16x16x32_bf16 v[68:71], v[208:211], v[20:23], v[68:71]
    buffer_load_dwordx4 v13, s[8:11], s65 offen offset:2048 sc1 lds
    v_add_f32 v78, v78, v34
    v_add_f32 v79, v79, v35
    v_mfma_f32_16x16x32_bf16 v[72:75], v[212:215], v[20:23], v[72:75]
    s_waitcnt lgkmcnt(2)
    ds_read_b128 v[32:35], v5 offset:30720
    ds_read_b128 v[20:23], v7 offset:1024
    v_add_f32 v76, v76, v36
    v_add_f32 v77, v77, v37
    v_mfma_f32_16x16x32_bf16 v[72:75], v[232:235], v[24:27], v[72:75]
    buffer_load_dwordx4 v13, s[8:11], s65 offen offset:3072 sc1 lds
    v_add_f32 v78, v78, v38
    v_add_f32 v79, v79, v39
    v_mfma_f32_16x16x32_bf16 v[68:71], v[228:231], v[24:27], v[68:71]
    s_waitcnt lgkmcnt(3)
    ds_read_b128 v[36:39], v5 offset:35840
    v_add_f32 v76, v76, v40
    v_add_f32 v77, v77, v41
    v_mfma_f32_16x16x32_bf16 v[64:67], v[224:227], v[24:27], v[64:67]
    v_add_f32 v78, v78, v42
    v_add_f32 v79, v79, v43
    v_mfma_f32_16x16x32_bf16 v[60:63], v[220:223], v[24:27], v[60:63]
    ds_read_b128 v[40:43], v5 offset:40960
    s_waitcnt lgkmcnt(3)
    v_add_f32 v92, v92, v32
    v_add_f32 v93, v93, v33
    s_add_u32 s6, s96, 10240
    v_mfma_f32_16x16x32_bf16 v[56:59], v[216:219], v[24:27], v[56:59]
    ds_read_b128 v[24:27], v7 offset:2048
    v_add_f32 v94, v94, v34
    v_add_f32 v95, v95, v35
    v_mfma_f32_16x16x32_bf16 v[56:59], v[236:239], v[28:31], v[56:59]
    buffer_store_dwordx4 v[76:79], v44, s[8:11], s6 offen sc1
    s_waitcnt lgkmcnt(2)
    v_add_f32 v92, v92, v36
    v_add_f32 v93, v93, v37
    v_mfma_f32_16x16x32_bf16 v[60:63], v[240:243], v[28:31], v[60:63]
    v_add_f32 v94, v94, v38
    v_add_f32 v95, v95, v39
    v_mfma_f32_16x16x32_bf16 v[64:67], v[244:247], v[28:31], v[64:67]
    s_waitcnt lgkmcnt(1)
    v_add_f32 v92, v92, v40
    v_add_f32 v93, v93, v41
    v_mfma_f32_16x16x32_bf16 v[68:71], v[248:251], v[28:31], v[68:71]
    v_add_f32 v94, v94, v42
    v_add_f32 v95, v95, v43
    s_cmp_lg_u32 s71, 3
    v_mfma_f32_16x16x32_bf16 v[72:75], v[252:255], v[28:31], v[72:75]
    s_cbranch_scc1 L_nost_55
    buffer_store_dwordx4 v[92:95], v52, s[8:11], s6 offen sc1
L_nost_55:
    ds_read_b128 v[28:31], v7 offset:3072
    v_mfma_f32_16x16x32_bf16 v[76:79], v[96:99], v[16:19], 0
    s_sub_u32 s6, s71, 5
    s_and_b32 s6, s6, 3
    s_mul_i32 s7, s6, 5120
    v_mfma_f32_16x16x32_bf16 v[80:83], v[100:103], v[16:19], 0
    s_add_u32 s7, s7, s67
    s_cmp_eq_u32 s6, 3
    s_cselect_b32 s7, 155648, s7
    v_mfma_f32_16x16x32_bf16 v[84:87], v[104:107], v[16:19], 0
    v_add_u32 v12, s7, v52
    v_add_u32 v5, s67, v45
    v_mfma_f32_16x16x32_bf16 v[88:91], v[108:111], v[16:19], 0
    v_mfma_f32_16x16x32_bf16 v[92:95], v[112:115], v[16:19], 0
    ds_read_b128 v[16:19], v7 offset:4096
    v_mfma_f32_16x16x32_bf16 v[76:79], v[116:119], v[20:23], v[76:79]
    ds_write_b128 v5, v[60:63] offset:0
    v_add_u32 v5, s67, v46
    v_mfma_f32_16x16x32_bf16 v[80:83], v[120:123], v[20:23], v[80:83]
    v_mfma_f32_16x16x32_bf16 v[84:87], v[124:127], v[20:23], v[84:87]
    v_mfma_f32_16x16x32_bf16 v[88:91], v[128:131], v[20:23], v[88:91]
    s_waitcnt lgkmcnt(3)
    v_mfma_f32_16x16x32_bf16 v[92:95], v[132:135], v[20:23], v[92:95]
    ds_read_b128 v[20:23], v7 offset:5120
    v_mfma_f32_16x16x32_bf16 v[92:95], v[152:155], v[24:27], v[92:95]
    ds_write_b128 v5, v[64:67] offset:5120
    v_add_u32 v5, s67, v47
    v_mfma_f32_16x16x32_bf16 v[88:91], v[148:151], v[24:27], v[88:91]
    v_mfma_f32_16x16x32_bf16 v[84:87], v[144:147], v[24:27], v[84:87]
    v_mfma_f32_16x16x32_bf16 v[80:83], v[140:143], v[24:27], v[80:83]
    s_waitcnt lgkmcnt(4)
    v_mfma_f32_16x16x32_bf16 v[76:79], v[136:139], v[24:27], v[76:79]
    ds_read_b128 v[24:27], v7 offset:6144
    v_mfma_f32_16x16x32_bf16 v[76:79], v[156:159], v[28:31], v[76:79]
    ds_write_b128 v5, v[68:71] offset:10240
    v_add_u32 v5, s67, v52
    v_mfma_f32_16x16x32_bf16 v[80:83], v[160:163], v[28:31], v[80:83]
    v_mfma_f32_16x16x32_bf16 v[84:87], v[164:167], v[28:31], v[84:87]
    v_mfma_f32_16x16x32_bf16 v[88:91], v[168:171], v[28:31], v[88:91]
    s_waitcnt lgkmcnt(5)
    v_mfma_f32_16x16x32_bf16 v[92:95], v[172:175], v[28:31], v[92:95]
    ds_read_b128 v[28:31], v7 offset:7168
    v_mfma_f32_16x16x32_bf16 v[92:95], v[192:195], v[16:19], v[92:95]
    ds_write_b128 v12, v[72:75] offset:0
    v_mfma_f32_16x16x32_bf16 v[88:91], v[188:191], v[16:19], v[88:91]
    v_mfma_f32_16x16x32_bf16 v[84:87], v[184:187], v[16:19], v[84:87]
    v_mfma_f32_16x16x32_bf16 v[80:83], v[180:183], v[16:19], v[80:83]
    s_waitcnt lgkmcnt(5)
    v_mfma_f32_16x16x32_bf16 v[76:79], v[176:179], v[16:19], v[76:79]
    s_waitcnt vmcnt(5)
    s_waitcnt lgkmcnt(0)
    s_barrier
    ds_read_b128 v[32:35], v6 offset:0
    ds_read_b128 v[36:39], v6 offset:5120
    ds_read_b128 v[40:43], v6 offset:10240
    ds_read_b128 v[16:19], v4 offset:0
    v_mfma_f32_16x16x32_bf16 v[76:79], v[196:199], v[20:23], v[76:79]
    v_mfma_f32_16x16x32_bf16 v[80:83], v[200:203], v[20:23], v[80:83]
    v_mfma_f32_16x16x32_bf16 v[84:87], v[204:207], v[20:23], v[84:87]
    s_waitcnt lgkmcnt(3)
    v_add_f32 v56, v56, v32
    v_add_f32 v57, v57, v33
    v_mfma_f32_16x16x32_bf16 v[88:91], v[208:211], v[20:23], v[88:91]
    v_add_f32 v58, v58, v34
    v_add_f32 v59, v59, v35
    v_mfma_f32_16x16x32_bf16 v[92:95], v[212:215], v[20:23], v[92:95]
    s_waitcnt lgkmcnt(2)
    ds_read_b128 v[32:35], v5 offset:0
    ds_read_b128 v[20:23], v4 offset:1024
    v_add_f32 v56, v56, v36
    v_add_f32 v57, v57, v37
    v_mfma_f32_16x16x32_bf16 v[92:95], v[232:235], v[24:27], v[92:95]
    v_add_f32 v58, v58, v38
    v_add_f32 v59, v59, v39
    v_mfma_f32_16x16x32_bf16 v[88:91], v[228:231], v[24:27], v[88:91]
    s_waitcnt lgkmcnt(3)
    ds_read_b128 v[36:39], v5 offset:5120
    v_add_f32 v56, v56, v40
    v_add_f32 v57, v57, v41
    v_mfma_f32_16x16x32_bf16 v[84:87], v[224:227], v[24:27], v[84:87]
    v_add_f32 v58, v58, v42
    v_add_f32 v59, v59, v43
    v_mfma_f32_16x16x32_bf16 v[80:83], v[220:223], v[24:27], v[80:83]
    ds_read_b128 v[40:43], v5 offset:10240
    s_waitcnt lgkmcnt(3)
    v_add_f32 v72, v72, v32
    v_add_f32 v73, v73, v33
    s_add_u32 s6, s97, 10240
    v_mfma_f32_16x16x32_bf16 v[76:79], v[216:219], v[24:27], v[76:79]
    ds_read_b128 v[24:27], v4 offset:2048
    v_add_f32 v74, v74, v34
    v_add_f32 v75, v75, v35
    v_mfma_f32_16x16x32_bf16 v[76:79], v[236:239], v[28:31], v[76:79]
    buffer_store_dwordx4 v[56:59], v44, s[8:11], s6 offen sc1
    s_waitcnt lgkmcnt(2)
    v_add_f32 v72, v72, v36
    v_add_f32 v73, v73, v37
    v_mfma_f32_16x16x32_bf16 v[80:83], v[240:243], v[28:31], v[80:83]
    v_add_f32 v74, v74, v38
    v_add_f32 v75, v75, v39
    v_mfma_f32_16x16x32_bf16 v[84:87], v[244:247], v[28:31], v[84:87]
    s_waitcnt lgkmcnt(1)
    v_add_f32 v72, v72, v40
    v_add_f32 v73, v73, v41
    v_mfma_f32_16x16x32_bf16 v[88:91], v[248:251], v[28:31], v[88:91]
    v_add_f32 v74, v74, v42
    v_add_f32 v75, v75, v43
    s_cmp_lg_u32 s71, 0
    v_mfma_f32_16x16x32_bf16 v[92:95], v[252:255], v[28:31], v[92:95]
    s_cbranch_scc1 L_nost_59
    buffer_store_dwordx4 v[72:75], v52, s[8:11], s6 offen sc1
L_nost_59:
    ds_read_b128 v[28:31], v4 offset:3072
    v_mfma_f32_16x16x32_bf16 v[56:59], v[96:99], v[16:19], 0
    s_sub_u32 s6, s71, 6
    s_and_b32 s6, s6, 3
    s_mul_i32 s7, s6, 5120
    v_mfma_f32_16x16x32_bf16 v[60:63], v[100:103], v[16:19], 0
    s_add_u32 s7, s7, s67
    s_cmp_eq_u32 s6, 3
    s_cselect_b32 s7, 124928, s7
    v_mfma_f32_16x16x32_bf16 v[64:67], v[104:107], v[16:19], 0
    v_add_u32 v12, s7, v52
    v_add_u32 v5, s67, v45
    v_mfma_f32_16x16x32_bf16 v[68:71], v[108:111], v[16:19], 0
    v_mfma_f32_16x16x32_bf16 v[72:75], v[112:115], v[16:19], 0
    ds_read_b128 v[16:19], v4 offset:4096
    v_mfma_f32_16x16x32_bf16 v[56:59], v[116:119], v[20:23], v[56:59]
    ds_write_b128 v5, v[80:83] offset:30720
    v_add_u32 v5, s67, v46
    v_mfma_f32_16x16x32_bf16 v[60:63], v[120:123], v[20:23], v[60:63]
    v_mfma_f32_16x16x32_bf16 v[64:67], v[124:127], v[20:23], v[64:67]
    v_mfma_f32_16x16x32_bf16 v[68:71], v[128:131], v[20:23], v[68:71]
    s_waitcnt lgkmcnt(3)
    v_mfma_f32_16x16x32_bf16 v[72:75], v[132:135], v[20:23], v[72:75]
    ds_read_b128 v[20:23], v4 offset:5120
    v_mfma_f32_16x16x32_bf16 v[72:75], v[152:155], v[24:27], v[72:75]
    ds_write_b128 v5, v[84:87] offset:35840
    v_add_u32 v5, s67, v47
    v_mfma_f32_16x16x32_bf16 v[68:71], v[148:151], v[24:27], v[68:71]
    v_mfma_f32_16x16x32_bf16 v[64:67], v[144:147], v[24:27], v[64:67]
    v_mfma_f32_16x16x32_bf16 v[60:63], v[140:143], v[24:27], v[60:63]
    s_waitcnt lgkmcnt(4)
    v_mfma_f32_16x16x32_bf16 v[56:59], v[136:139], v[24:27], v[56:59]
    ds_read_b128 v[24:27], v4 offset:6144
    v_mfma_f32_16x16x32_bf16 v[56:59], v[156:159], v[28:31], v[56:59]
    ds_write_b128 v5, v[88:91] offset:40960
    v_add_u32 v5, s67, v52
    v_mfma_f32_16x16x32_bf16 v[60:63], v[160:163], v[28:31], v[60:63]
    v_mfma_f32_16x16x32_bf16 v[64:67], v[164:167], v[28:31], v[64:67]
    v_mfma_f32_16x16x32_bf16 v[68:71], v[168:171], v[28:31], v[68:71]
    s_waitcnt lgkmcnt(5)
    v_mfma_f32_16x16x32_bf16 v[72:75], v[172:175], v[28:31], v[72:75]
    ds_read_b128 v[28:31], v4 offset:7168
    v_mfma_f32_16x16x32_bf16 v[72:75], v[192:195], v[16:19], v[72:75]
    ds_write_b128 v12, v[92:95] offset:30720
    v_mfma_f32_16x16x32_bf16 v[68:71], v[188:191], v[16:19], v[68:71]
    v_mfma_f32_16x16x32_bf16 v[64:67], v[184:187], v[16:19], v[64:67]
    v_mov_b32 v2, 1
    v_writelane_b32 v2, 2, 0
    v_mfma_f32_16x16x32_bf16 v[60:63], v[180:183], v[16:19], v[60:63]
    s_waitcnt lgkmcnt(5)
    v_mfma_f32_16x16x32_bf16 v[56:59], v[176:179], v[16:19], v[56:59]
    s_waitcnt vmcnt(1)
    buffer_store_dword v2, v11, s[8:11], 0 offen sc1
    s_waitcnt lgkmcnt(0)
    s_barrier
    ds_read_b128 v[32:35], v6 offset:30720
    ds_read_b128 v[36:39], v6 offset:35840
    ds_read_b128 v[40:43], v6 offset:40960
    ds_read_b128 v[16:19], v4 offset:32768
    v_mfma_f32_16x16x32_bf16 v[56:59], v[196:199], v[20:23], v[56:59]
    v_mfma_f32_16x16x32_bf16 v[60:63], v[200:203], v[20:23], v[60:63]
    v_mfma_f32_16x16x32_bf16 v[64:67], v[204:207], v[20:23], v[64:67]
    s_waitcnt lgkmcnt(3)
    v_add_f32 v76, v76, v32
    v_add_f32 v77, v77, v33
    v_mfma_f32_16x16x32_bf16 v[68:71], v[208:211], v[20:23], v[68:71]
    v_add_f32 v78, v78, v34
    v_add_f32 v79, v79, v35
    v_mfma_f32_16x16x32_bf16 v[72:75], v[212:215], v[20:23], v[72:75]
    s_waitcnt lgkmcnt(2)
    ds_read_b128 v[32:35], v5 offset:30720
    ds_read_b128 v[20:23], v4 offset:33792
    v_add_f32 v76, v76, v36
    v_add_f32 v77, v77, v37
    v_mfma_f32_16x16x32_bf16 v[72:75], v[232:235], v[24:27], v[72:75]
    v_add_f32 v78, v78, v38
    v_add_f32 v79, v79, v39
    v_mfma_f32_16x16x32_bf16 v[68:71], v[228:231], v[24:27], v[68:71]
    s_waitcnt lgkmcnt(3)
    ds_read_b128 v[36:39], v5 offset:35840
    v_add_f32 v76, v76, v40
    v_add_f32 v77, v77, v41
    v_mfma_f32_16x16x32_bf16 v[64:67], v[224:227], v[24:27], v[64:67]
    v_add_f32 v78, v78, v42
    v_add_f32 v79, v79, v43
    v_mfma_f32_16x16x32_bf16 v[60:63], v[220:223], v[24:27], v[60:63]
    ds_read_b128 v[40:43], v5 offset:40960
    s_waitcnt lgkmcnt(3)
    v_add_f32 v92, v92, v32
    v_add_f32 v93, v93, v33
    s_add_u32 s6, s98, 10240
    v_mfma_f32_16x16x32_bf16 v[56:59], v[216:219], v[24:27], v[56:59]
    ds_read_b128 v[24:27], v4 offset:34816
    v_add_f32 v94, v94, v34
    v_add_f32 v95, v95, v35
    v_mfma_f32_16x16x32_bf16 v[56:59], v[236:239], v[28:31], v[56:59]
    buffer_store_dwordx4 v[76:79], v44, s[8:11], s6 offen sc1
    s_waitcnt lgkmcnt(2)
    v_add_f32 v92, v92, v36
    v_add_f32 v93, v93, v37
    v_mfma_f32_16x16x32_bf16 v[60:63], v[240:243], v[28:31], v[60:63]
    v_add_f32 v94, v94, v38
    v_add_f32 v95, v95, v39
    v_mfma_f32_16x16x32_bf16 v[64:67], v[244:247], v[28:31], v[64:67]
    s_waitcnt lgkmcnt(1)
    v_add_f32 v92, v92, v40
    v_add_f32 v93, v93, v41
    v_mfma_f32_16x16x32_bf16 v[68:71], v[248:251], v[28:31], v[68:71]
    v_add_f32 v94, v94, v42
    v_add_f32 v95, v95, v43
    s_cmp_lg_u32 s71, 1
    v_mfma_f32_16x16x32_bf16 v[72:75], v[252:255], v[28:31], v[72:75]
    s_cbranch_scc1 L_nost_60
    buffer_store_dwordx4 v[92:95], v52, s[8:11], s6 offen sc1
L_nost_60:
    ds_read_b128 v[28:31], v4 offset:35840
    v_mfma_f32_16x16x32_bf16 v[76:79], v[96:99], v[16:19], 0
    v_mfma_f32_16x16x32_bf16 v[80:83], v[100:103], v[16:19], 0
    v_mfma_f32_16x16x32_bf16 v[84:87], v[104:107], v[16:19], 0
    s_mul_i32 s73, s3, 5120
    s_add_u32 s6, s73, 65536
    v_mfma_f32_16x16x32_bf16 v[88:91], v[108:111], v[16:19], 0
    v_add_u32 v5, s6, v44
    v_mfma_f32_16x16x32_bf16 v[92:95], v[112:115], v[16:19], 0
    ds_read_b128 v[16:19], v4 offset:36864
    v_mfma_f32_16x16x32_bf16 v[76:79], v[116:119], v[20:23], v[76:79]
    ds_write_b128 v5, v[56:59]
    s_add_u32 s6, s73, 65536
    v_add_u32 v5, s6, v45
    v_mfma_f32_16x16x32_bf16 v[80:83], v[120:123], v[20:23], v[80:83]
    v_mfma_f32_16x16x32_bf16 v[84:87], v[124:127], v[20:23], v[84:87]
    v_mfma_f32_16x16x32_bf16 v[88:91], v[128:131], v[20:23], v[88:91]
    s_waitcnt lgkmcnt(3)
    v_mfma_f32_16x16x32_bf16 v[92:95], v[132:135], v[20:23], v[92:95]
    ds_read_b128 v[20:23], v4 offset:37888
    v_mfma_f32_16x16x32_bf16 v[92:95], v[152:155], v[24:27], v[92:95]
    ds_write_b128 v5, v[60:63]
    s_add_u32 s6, s73, 65536
    v_add_u32 v5, s6, v46
    v_mfma_f32_16x16x32_bf16 v[88:91], v[148:151], v[24:27], v[88:91]
    v_mfma_f32_16x16x32_bf16 v[84:87], v[144:147], v[24:27], v[84:87]
    v_mfma_f32_16x16x32_bf16 v[80:83], v[140:143], v[24:27], v[80:83]
    s_waitcnt lgkmcnt(4)
    v_mfma_f32_16x16x32_bf16 v[76:79], v[136:139], v[24:27], v[76:79]
    ds_read_b128 v[24:27], v4 offset:38912
    v_mfma_f32_16x16x32_bf16 v[76:79], v[156:159], v[28:31], v[76:79]
    ds_write_b128 v5, v[64:67]
    s_add_u32 s6, s73, 65536
    v_add_u32 v5, s6, v47
    v_mfma_f32_16x16x32_bf16 v[80:83], v[160:163], v[28:31], v[80:83]
    v_mov_b32 v2, 2
    s_waitcnt vmcnt(0)
    buffer_store_dword v2, v11, s[8:11], 0 offen sc1
    v_mfma_f32_16x16x32_bf16 v[84:87], v[164:167], v[28:31], v[84:87]
    v_mfma_f32_16x16x32_bf16 v[88:91], v[168:171], v[28:31], v[88:91]
    s_waitcnt lgkmcnt(5)
    s_cmp_eq_u32 s64, 0
    s_cbranch_scc1 L_nb
    v_bfe_u32 v2, v1, 1, 3
    v_and_b32 v3, 1, v1
    v_lshl_add_u32 v3, v2, 7, v3
    v_lshlrev_b32 v3, 2, v3
    s_and_b32 s6, s4, 3
    s_lshl_b32 s6, s6, 7
    s_add_u32 s6, s6, 3911680
    s_mov_b32 s79, 262144
L_poll_61:
    buffer_load_dword v2, v3, s[8:11], s6 offen sc1
    s_waitcnt vmcnt(0)
    v_cmp_ne_u32 vcc, 1, v2
    s_cbranch_vccz L_polldone_62
    s_sleep 2
    s_sub_u32 s79, s79, 1
    s_cmp_lg_u32 s79, 0
    s_cbranch_scc1 L_poll_61
L_polldone_62:
L_nb:
    buffer_load_dwordx4 v[96:99], v53, s[12:15], s70 offen
    buffer_load_dwordx4 v[100:103], v48, s[8:11], 0 offen sc1
    s_cmp_ge_u32 s3, 2
    s_cbranch_scc1 L_itskip_63
    buffer_load_dwordx4 v[104:107], v54, s[12:15], s70 offen
    buffer_load_dwordx4 v[108:111], v49, s[8:11], 0 offen sc1
L_itskip_63:
    v_mfma_f32_16x16x32_bf16 v[92:95], v[172:175], v[28:31], v[92:95]
    ds_read_b128 v[28:31], v4 offset:39936
    v_mfma_f32_16x16x32_bf16 v[92:95], v[192:195], v[16:19], v[92:95]
    ds_write_b128 v5, v[68:71]
    s_add_u32 s6, s73, 65536
    v_add_u32 v5, s6, v52
    v_mfma_f32_16x16x32_bf16 v[88:91], v[188:191], v[16:19], v[88:91]
    v_mfma_f32_16x16x32_bf16 v[84:87], v[184:187], v[16:19], v[84:87]
    v_mfma_f32_16x16x32_bf16 v[80:83], v[180:183], v[16:19], v[80:83]
    s_waitcnt lgkmcnt(5)
    v_mfma_f32_16x16x32_bf16 v[76:79], v[176:179], v[16:19], v[76:79]
    v_mfma_f32_16x16x32_bf16 v[76:79], v[196:199], v[20:23], v[76:79]
    ds_write_b128 v5, v[72:75]
    v_mfma_f32_16x16x32_bf16 v[80:83], v[200:203], v[20:23], v[80:83]
    v_mfma_f32_16x16x32_bf16 v[84:87], v[204:207], v[20:23], v[84:87]
    v_mfma_f32_16x16x32_bf16 v[88:91], v[208:211], v[20:23], v[88:91]
    s_waitcnt lgkmcnt(4)
    v_mfma_f32_16x16x32_bf16 v[92:95], v[212:215], v[20:23], v[92:95]
    v_mfma_f32_16x16x32_bf16 v[92:95], v[232:235], v[24:27], v[92:95]
    v_bfe_u32 v2, v1, 3, 2
    v_min_u32 v2, 2, v2
    v_and_b32 v3, 7, v1
    v_lshlrev_b32 v3, 2, v3
    v_lshl_add_u32 v3, v2, 7, v3
    v_mfma_f32_16x16x32_bf16 v[88:91], v[228:231], v[24:27], v[88:91]
    s_bitcmp1_b32 13, s3
    s_cselect_b32 s77, 1, 2
    buffer_load_dword v50, v3, s[8:11], s63 offen sc1
    v_mfma_f32_16x16x32_bf16 v[84:87], v[224:227], v[24:27], v[84:87]
    v_mfma_f32_16x16x32_bf16 v[80:83], v[220:223], v[24:27], v[80:83]
    s_waitcnt lgkmcnt(2)
    s_add_u32 s6, s73, 86016
    s_cmp_lt_u32 s3, 4
    s_cselect_b32 s73, s73, s6
    v_mfma_f32_16x16x32_bf16 v[76:79], v[216:219], v[24:27], v[76:79]
    v_mfma_f32_16x16x32_bf16 v[76:79], v[236:239], v[28:31], v[76:79]
    v_mfma_f32_16x16x32_bf16 v[80:83], v[240:243], v[28:31], v[80:83]
    v_mfma_f32_16x16x32_bf16 v[84:87], v[244:247], v[28:31], v[84:87]
    v_mfma_f32_16x16x32_bf16 v[88:91], v[248:251], v[28:31], v[88:91]
    v_mfma_f32_16x16x32_bf16 v[92:95], v[252:255], v[28:31], v[92:95]
    s_nop 4
    v_add_u32 v5, s73, v44
    ds_write_b128 v5, v[76:79]
    v_add_u32 v5, s73, v45
    ds_write_b128 v5, v[80:83]
    v_add_u32 v5, s73, v46
    ds_write_b128 v5, v[84:87]
    v_add_u32 v5, s73, v47
    ds_write_b128 v5, v[88:91]
    v_add_u32 v5, s73, v52
    ds_write_b128 v5, v[92:95]
    s_waitcnt vmcnt(0)
    v_cmp_gt_u32 s[78:79], s77, v50
    s_nop 3
    s_cmp_lg_u64 s[78:79], 0
    s_cbranch_scc1 L_x2a
    s_add_u32 s6, s62, 0
    buffer_load_dwordx4 v[112:115], v8, s[8:11], s6 offen offset:0 sc1
    buffer_load_dwordx4 v[116:119], v8, s[8:11], s6 offen offset:256 sc1
    s_add_u32 s6, s62, 20480
    buffer_load_dwordx4 v[120:123], v8, s[8:11], s6 offen offset:0 sc1
    buffer_load_dwordx4 v[124:127], v8, s[8:11], s6 offen offset:256 sc1
    s_add_u32 s6, s62, 40960
    buffer_load_dwordx4 v[128:131], v8, s[8:11], s6 offen offset:0 sc1
    buffer_load_dwordx4 v[132:135], v8, s[8:11], s6 offen offset:256 sc1
    s_cmp_ge_u32 s3, 2
    s_cbranch_scc1 L_xi_64
    s_add_u32 s6, s62, 0
    buffer_load_dwordx4 v[136:139], v9, s[8:11], s6 offen offset:0 sc1
    buffer_load_dwordx4 v[140:143], v9, s[8:11], s6 offen offset:256 sc1
    s_add_u32 s6, s62, 20480
    buffer_load_dwordx4 v[144:147], v9, s[8:11], s6 offen offset:0 sc1
    buffer_load_dwordx4 v[148:151], v9, s[8:11], s6 offen offset:256 sc1
    s_add_u32 s6, s62, 40960
    buffer_load_dwordx4 v[152:155], v9, s[8:11], s6 offen offset:0 sc1
    buffer_load_dwordx4 v[156:159], v9, s[8:11], s6 offen offset:256 sc1
L_xi_64:
L_x2a:
    s_waitcnt lgkmcnt(0)
    s_barrier
    ds_read_b128 v[160:163], v10 offset:0
    ds_read_b128 v[164:167], v10 offset:256
    ds_read_b128 v[168:171], v10 offset:5120
    ds_read_b128 v[172:175], v10 offset:5376
    ds_read_b128 v[176:179], v10 offset:10240
    ds_read_b128 v[180:183], v10 offset:10496
    ds_read_b128 v[184:187], v10 offset:15360
    ds_read_b128 v[188:191], v10 offset:15616
    ds_read_b128 v[192:195], v55 offset:0
    ds_read_b128 v[196:199], v55 offset:256
    ds_read_b128 v[200:203], v55 offset:5120
    ds_read_b128 v[204:207], v55 offset:5376
    ds_read_b128 v[208:211], v55 offset:10240
    ds_read_b128 v[212:215], v55 offset:10496
    ds_read_b128 v[216:219], v55 offset:15360
    ds_read_b128 v[220:223], v55 offset:15616
    s_cmp_eq_u64 s[78:79], 0
    s_cbranch_scc1 L_x2b
    s_mov_b32 s79, 262144
L_poll_65:
    buffer_load_dword v2, v3, s[8:11], s63 offen sc1
    s_waitcnt vmcnt(0)
    v_cmp_gt_u32 vcc, s77, v2
    s_cbranch_vccz L_polldone_66
    s_sleep 1
    s_sub_u32 s79, s79, 1
    s_cmp_lg_u32 s79, 0
    s_cbranch_scc1 L_poll_65
L_polldone_66:
    s_add_u32 s6, s62, 0
    buffer_load_dwordx4 v[112:115], v8, s[8:11], s6 offen offset:0 sc1
    buffer_load_dwordx4 v[116:119], v8, s[8:11], s6 offen offset:256 sc1
    s_add_u32 s6, s62, 20480
    buffer_load_dwordx4 v[120:123], v8, s[8:11], s6 offen offset:0 sc1
    buffer_load_dwordx4 v[124:127], v8, s[8:11], s6 offen offset:256 sc1
    s_add_u32 s6, s62, 40960
    buffer_load_dwordx4 v[128:131], v8, s[8:11], s6 offen offset:0 sc1
    buffer_load_dwordx4 v[132:135], v8, s[8:11], s6 offen offset:256 sc1
    s_cmp_ge_u32 s3, 2
    s_cbranch_scc1 L_xi_67
    s_add_u32 s6, s62, 0
    buffer_load_dwordx4 v[136:139], v9, s[8:11], s6 offen offset:0 sc1
    buffer_load_dwordx4 v[140:143], v9, s[8:11], s6 offen offset:256 sc1
    s_add_u32 s6, s62, 20480
    buffer_load_dwordx4 v[144:147], v9, s[8:11], s6 offen offset:0 sc1
    buffer_load_dwordx4 v[148:151], v9, s[8:11], s6 offen offset:256 sc1
    s_add_u32 s6, s62, 40960
    buffer_load_dwordx4 v[152:155], v9, s[8:11], s6 offen offset:0 sc1
    buffer_load_dwordx4 v[156:159], v9, s[8:11], s6 offen offset:256 sc1
L_xi_67:
L_x2b:
    s_mov_b32 s16, s54
    s_mov_b32 s17, s55
    s_mov_b32 s18, 0x280000
    s_mov_b32 s19, 0x20000
    s_waitcnt lgkmcnt(8)
    v_pk_add_f32 v[160:161], v[160:161], v[168:169]
    v_pk_add_f32 v[162:163], v[162:163], v[170:171]
    v_pk_add_f32 v[164:165], v[164:165], v[172:173]
    v_pk_add_f32 v[166:167], v[166:167], v[174:175]
    v_pk_add_f32 v[160:161], v[160:161], v[176:177]
    v_pk_add_f32 v[162:163], v[162:163], v[178:179]
    v_pk_add_f32 v[164:165], v[164:165], v[180:181]
    v_pk_add_f32 v[166:167], v[166:167], v[182:183]
    v_pk_add_f32 v[160:161], v[160:161], v[184:185]
    v_pk_add_f32 v[162:163], v[162:163], v[186:187]
    v_pk_add_f32 v[164:165], v[164:165], v[188:189]
    v_pk_add_f32 v[166:167], v[166:167], v[190:191]
    s_waitcnt vmcnt(0)
    v_pk_add_f32 v[160:161], v[160:161], v[112:113]
    v_pk_add_f32 v[162:163], v[162:163], v[114:115]
    v_pk_add_f32 v[164:165], v[164:165], v[116:117]
    v_pk_add_f32 v[166:167], v[166:167], v[118:119]
    v_pk_add_f32 v[160:161], v[160:161], v[120:121]
    v_pk_add_f32 v[162:163], v[162:163], v[122:123]
    v_pk_add_f32 v[164:165], v[164:165], v[124:125]
    v_pk_add_f32 v[166:167], v[166:167], v[126:127]
    v_pk_add_f32 v[160:161], v[160:161], v[128:129]
    v_pk_add_f32 v[162:163], v[162:163], v[130:131]
    v_pk_add_f32 v[164:165], v[164:165], v[132:133]
    v_pk_add_f32 v[166:167], v[166:167], v[134:135]
    v_cvt_pk_bf16_f32 v2, v160, v161
    v_lshlrev_b32 v160, 16, v2
    v_and_b32 v161, 0xffff0000, v2
    v_lshlrev_b32 v2, 16, v96
    v_and_b32 v3, 0xffff0000, v96
    v_pk_add_f32 v[160:161], v[160:161], v[2:3]
    v_cvt_pk_bf16_f32 v2, v160, v161
    v_lshlrev_b32 v160, 16, v2
    v_and_b32 v161, 0xffff0000, v2
    v_lshlrev_b32 v2, 16, v100
    v_and_b32 v3, 0xffff0000, v100
    v_pk_add_f32 v[160:161], v[160:161], v[2:3]
    v_cvt_pk_bf16_f32 v224, v160, v161
    v_cvt_pk_bf16_f32 v2, v162, v163
    v_lshlrev_b32 v162, 16, v2
    v_and_b32 v163, 0xffff0000, v2
    v_lshlrev_b32 v2, 16, v97
    v_and_b32 v3, 0xffff0000, v97
    v_pk_add_f32 v[162:163], v[162:163], v[2:3]
    v_cvt_pk_bf16_f32 v2, v162, v163
    v_lshlrev_b32 v162, 16, v2
    v_and_b32 v163, 0xffff0000, v2
    v_lshlrev_b32 v2, 16, v101
    v_and_b32 v3, 0xffff0000, v101
    v_pk_add_f32 v[162:163], v[162:163], v[2:3]
    v_cvt_pk_bf16_f32 v225, v162, v163
    v_cvt_pk_bf16_f32 v2, v164, v165
    v_lshlrev_b32 v164, 16, v2
    v_and_b32 v165, 0xffff0000, v2
    v_lshlrev_b32 v2, 16, v98
    v_and_b32 v3, 0xffff0000, v98
    v_pk_add_f32 v[164:165], v[164:165], v[2:3]
    v_cvt_pk_bf16_f32 v2, v164, v165
    v_lshlrev_b32 v164, 16, v2
    v_and_b32 v165, 0xffff0000, v2
    v_lshlrev_b32 v2, 16, v102
    v_and_b32 v3, 0xffff0000, v102
    v_pk_add_f32 v[164:165], v[164:165], v[2:3]
    v_cvt_pk_bf16_f32 v226, v164, v165
    v_cvt_pk_bf16_f32 v2, v166, v167
    v_lshlrev_b32 v166, 16, v2
    v_and_b32 v167, 0xffff0000, v2
    v_lshlrev_b32 v2, 16, v99
    v_and_b32 v3, 0xffff0000, v99
    v_pk_add_f32 v[166:167], v[166:167], v[2:3]
    v_cvt_pk_bf16_f32 v2, v166, v167
    v_lshlrev_b32 v166, 16, v2
    v_and_b32 v167, 0xffff0000, v2
    v_lshlrev_b32 v2, 16, v103
    v_and_b32 v3, 0xffff0000, v103
    v_pk_add_f32 v[166:167], v[166:167], v[2:3]
    v_cvt_pk_bf16_f32 v227, v166, v167
    buffer_store_dwordx4 v[224:227], v53, s[16:19], s70 offen
    s_cmp_ge_u32 s3, 2
    s_cbranch_scc1 L_end
    s_waitcnt lgkmcnt(0)
    v_pk_add_f32 v[192:193], v[192:193], v[200:201]
    v_pk_add_f32 v[194:195], v[194:195], v[202:203]
    v_pk_add_f32 v[196:197], v[196:197], v[204:205]
    v_pk_add_f32 v[198:199], v[198:199], v[206:207]
    v_pk_add_f32 v[192:193], v[192:193], v[208:209]
    v_pk_add_f32 v[194:195], v[194:195], v[210:211]
    v_pk_add_f32 v[196:197], v[196:197], v[212:213]
    v_pk_add_f32 v[198:199], v[198:199], v[214:215]
    v_pk_add_f32 v[192:193], v[192:193], v[216:217]
    v_pk_add_f32 v[194:195], v[194:195], v[218:219]
    v_pk_add_f32 v[196:197], v[196:197], v[220:221]
    v_pk_add_f32 v[198:199], v[198:199], v[222:223]
    s_nop 0
    v_pk_add_f32 v[192:193], v[192:193], v[136:137]
    v_pk_add_f32 v[194:195], v[194:195], v[138:139]
    v_pk_add_f32 v[196:197], v[196:197], v[140:141]
    v_pk_add_f32 v[198:199], v[198:199], v[142:143]
    v_pk_add_f32 v[192:193], v[192:193], v[144:145]
    v_pk_add_f32 v[194:195], v[194:195], v[146:147]
    v_pk_add_f32 v[196:197], v[196:197], v[148:149]
    v_pk_add_f32 v[198:199], v[198:199], v[150:151]
    v_pk_add_f32 v[192:193], v[192:193], v[152:153]
    v_pk_add_f32 v[194:195], v[194:195], v[154:155]
    v_pk_add_f32 v[196:197], v[196:197], v[156:157]
    v_pk_add_f32 v[198:199], v[198:199], v[158:159]
    v_cvt_pk_bf16_f32 v2, v192, v193
    v_lshlrev_b32 v192, 16, v2
    v_and_b32 v193, 0xffff0000, v2
    v_lshlrev_b32 v2, 16, v104
    v_and_b32 v3, 0xffff0000, v104
    v_pk_add_f32 v[192:193], v[192:193], v[2:3]
    v_cvt_pk_bf16_f32 v2, v192, v193
    v_lshlrev_b32 v192, 16, v2
    v_and_b32 v193, 0xffff0000, v2
    v_lshlrev_b32 v2, 16, v108
    v_and_b32 v3, 0xffff0000, v108
    v_pk_add_f32 v[192:193], v[192:193], v[2:3]
    v_cvt_pk_bf16_f32 v228, v192, v193
    v_cvt_pk_bf16_f32 v2, v194, v195
    v_lshlrev_b32 v194, 16, v2
    v_and_b32 v195, 0xffff0000, v2
    v_lshlrev_b32 v2, 16, v105
    v_and_b32 v3, 0xffff0000, v105
    v_pk_add_f32 v[194:195], v[194:195], v[2:3]
    v_cvt_pk_bf16_f32 v2, v194, v195
    v_lshlrev_b32 v194, 16, v2
    v_and_b32 v195, 0xffff0000, v2
    v_lshlrev_b32 v2, 16, v109
    v_and_b32 v3, 0xffff0000, v109
    v_pk_add_f32 v[194:195], v[194:195], v[2:3]
    v_cvt_pk_bf16_f32 v229, v194, v195
    v_cvt_pk_bf16_f32 v2, v196, v197
    v_lshlrev_b32 v196, 16, v2
    v_and_b32 v197, 0xffff0000, v2
    v_lshlrev_b32 v2, 16, v106
    v_and_b32 v3, 0xffff0000, v106
    v_pk_add_f32 v[196:197], v[196:197], v[2:3]
    v_cvt_pk_bf16_f32 v2, v196, v197
    v_lshlrev_b32 v196, 16, v2
    v_and_b32 v197, 0xffff0000, v2
    v_lshlrev_b32 v2, 16, v110
    v_and_b32 v3, 0xffff0000, v110
    v_pk_add_f32 v[196:197], v[196:197], v[2:3]
    v_cvt_pk_bf16_f32 v230, v196, v197
    v_cvt_pk_bf16_f32 v2, v198, v199
    v_lshlrev_b32 v198, 16, v2
    v_and_b32 v199, 0xffff0000, v2
    v_lshlrev_b32 v2, 16, v107
    v_and_b32 v3, 0xffff0000, v107
    v_pk_add_f32 v[198:199], v[198:199], v[2:3]
    v_cvt_pk_bf16_f32 v2, v198, v199
    v_lshlrev_b32 v198, 16, v2
    v_and_b32 v199, 0xffff0000, v2
    v_lshlrev_b32 v2, 16, v111
    v_and_b32 v3, 0xffff0000, v111
    v_pk_add_f32 v[198:199], v[198:199], v[2:3]
    v_cvt_pk_bf16_f32 v231, v198, v199
    buffer_store_dwordx4 v[228:231], v54, s[16:19], s70 offen
L_end:
L_exit:
    s_endpgm
.section .rodata,"a"
.p2align 6
.amdhsa_kernel parallel_sum__compressed_kv_cla__moe_arch_mod__prompt_kernel
  .amdhsa_next_free_vgpr 256
  .amdhsa_next_free_sgpr 102
  .amdhsa_accum_offset 256
  .amdhsa_group_segment_fixed_size 0
  .amdhsa_kernarg_size 112
  .amdhsa_user_sgpr_count 2
  .amdhsa_user_sgpr_kernarg_segment_ptr 1
  .amdhsa_system_sgpr_workgroup_id_x 1
  .amdhsa_float_denorm_mode_32 3
.end_amdhsa_kernel
```

```asm
; @launch grid=(256,1,1) block=(512,1,1) lds=163840
.amdgcn_target "amdgcn-amd-amdhsa--gfx950"
.text
.globl parallel_sum__compressed_kv_cla__moe_arch_mod__prompt_kernel
.p2align 8
.type parallel_sum__compressed_kv_cla__moe_arch_mod__prompt_kernel,@function
parallel_sum__compressed_kv_cla__moe_arch_mod__prompt_kernel:
    s_cmp_ge_u32 s2, 256
    s_cbranch_scc1 L_exit
    s_load_dwordx16 s[32:47], s[0:1], 0
    s_load_dwordx8 s[48:55], s[0:1], 64
    s_load_dwordx4 s[56:59], s[0:1], 96
    v_lshrrev_b32 v2, 6, v0
    v_and_b32 v1, 63, v0
    v_readfirstlane_b32 s3, v2
    s_getpc_b64 s[80:81]
L_pc:
    s_lshr_b32 s6, s2, 3
    s_and_b32 s6, s6, 15
    s_lshl_b32 s6, s6, 12
    s_cmp_lt_u32 s3, 2
    s_cselect_b32 s6, 0, s6
    v_lshl_add_u32 v3, v0, 6, s6
    v_min_u32 v3, L_exit-L_pc, v3
    s_cmp_ge_u32 s3, 3
    s_cbranch_scc1 L_noct
    global_load_dword v11, v3, s[80:81]
L_noct:
    v_lshrrev_b32 v62, 5, v0
    v_and_b32 v62, 7, v62
    v_and_b32 v2, 31, v0
    v_lshlrev_b32 v2, 3, v2
    v_mul_u32_u24 v63, 1280, v62
    v_add_u32 v63, v63, v2
    s_mul_i32 s6, s2, 10240
    v_add_u32 v10, s6, v63
    s_cmp_lt_u32 s3, 4
    s_cbranch_scc1 L_st_k0
    s_waitcnt lgkmcnt(0)
    global_load_dwordx2 v[16:17], v10, s[32:33] offset:0
    global_load_dwordx2 v[18:19], v10, s[32:33] offset:256
    global_load_dwordx2 v[20:21], v10, s[32:33] offset:512
    global_load_dwordx2 v[22:23], v10, s[32:33] offset:768
    global_load_dwordx2 v[24:25], v10, s[32:33] offset:1024
    global_load_dwordx2 v[26:27], v2, s[46:47] offset:0
    global_load_dwordx2 v[28:29], v2, s[46:47] offset:256
    global_load_dwordx2 v[30:31], v2, s[46:47] offset:512
    global_load_dwordx2 v[32:33], v2, s[46:47] offset:768
    global_load_dwordx2 v[34:35], v2, s[46:47] offset:1024
    s_barrier
L_st_k0:
    s_and_b32 s6, s2, 7
    s_lshl_b32 s6, s6, 2
    s_lshr_b32 s7, s2, 3
    s_and_b32 s7, s7, 3
    s_add_u32 s4, s6, s7
    s_lshr_b32 s5, s2, 5
    s_and_b32 s76, s3, 3
    v_lshrrev_b32 v2, 3, v1
    v_and_b32 v3, 7, v1
    v_lshrrev_b32 v4, 4, v1
    v_xor_b32 v5, v3, v4
    v_lshlrev_b32 v5, 4, v5
    v_lshl_add_u32 v40, v2, 10, v5
    v_xor_b32 v5, 64, v40
    v_add_u32 v41, 7168, v5
    v_add_u32 v42, 14336, v40
    v_add_u32 v43, 14336, v41
    v_and_b32 v6, 15, v1
    s_lshl_b32 s6, s76, 4
    v_add_u32 v7, s6, v4
    v_lshlrev_b32 v5, 1, v4
    v_xor_b32 v5, v6, v5
    v_lshlrev_b32 v5, 4, v5
    v_lshl_add_u32 v44, v7, 13, v5
    v_add_u32 v45, 31744, v44
    v_xor_b32 v5, 0x80, v44
    v_add_u32 v46, 63488, v5
    v_add_u32 v47, 31744, v46
    s_and_b32 s6, s76, 1
    s_lshl_b32 s6, s6, 20
    s_lshr_b32 s7, s76, 1
    s_lshl_b32 s7, s7, 18
    s_add_u32 s6, s6, s7
    s_lshl_b32 s62, s5, 15
    s_add_u32 s62, s62, s6
    s_lshl_b32 s63, s4, 8
    s_lshl_b32 s64, s76, 13
    s_lshl_b32 s73, s76, 12
    s_add_u32 s73, s73, 32768
    s_andn2_b32 s100, 1, s5
    s_lshl_b32 s100, s100, 16
    s_add_u32 s64, s64, s100
    s_add_u32 s73, s73, s100
    s_waitcnt lgkmcnt(0)
    s_mov_b32 s12, s34
    s_mov_b32 s13, s35
    s_mov_b32 s14, 0x200000
    s_mov_b32 s15, 0x20000
    s_mov_b32 s16, s38
    s_mov_b32 s17, s39
    s_mov_b32 s18, 0x400000
    s_mov_b32 s19, 0x20000
    s_mov_b32 s20, s40
    s_mov_b32 s21, s41
    s_mov_b32 s22, 0x400000
    s_mov_b32 s23, 0x20000
    s_cmp_ge_u32 s3, 4
    s_cbranch_scc1 L_st_v0
    s_barrier
    s_mov_b32 m0, s64
    s_add_u32 s72, s62, 524288
    buffer_load_dwordx4 v40, s[12:15], s62 offen offset:0 lds
    buffer_load_dwordx4 v41, s[12:15], s62 offen offset:1024 lds
    buffer_load_dwordx4 v42, s[12:15], s62 offen offset:2048 lds
    buffer_load_dwordx4 v43, s[12:15], s62 offen offset:3072 lds
    s_add_u32 m0, s64, 4096
    s_add_u32 s62, s62, 128
    s_bitset0_b32 s62, 10
    buffer_load_dwordx4 v40, s[12:15], s72 offen offset:0 lds
    buffer_load_dwordx4 v41, s[12:15], s72 offen offset:1024 lds
    buffer_load_dwordx4 v42, s[12:15], s72 offen offset:2048 lds
    buffer_load_dwordx4 v43, s[12:15], s72 offen offset:3072 lds
    s_mov_b32 m0, s73
    s_xor_b32 s64, s64, 0x10000
    buffer_load_dwordx4 v44, s[16:19], s63 offen offset:0 lds
    buffer_load_dwordx4 v45, s[16:19], s63 offen offset:1024 lds
    buffer_load_dwordx4 v46, s[16:19], s63 offen offset:2048 lds
    buffer_load_dwordx4 v47, s[16:19], s63 offen offset:3072 lds
    s_add_u32 m0, s73, 16384
    s_xor_b32 s73, s73, 0x10000
    buffer_load_dwordx4 v44, s[20:23], s63 offen offset:0 lds
    buffer_load_dwordx4 v45, s[20:23], s63 offen offset:1024 lds
    buffer_load_dwordx4 v46, s[20:23], s63 offen offset:2048 lds
    buffer_load_dwordx4 v47, s[20:23], s63 offen offset:3072 lds
    s_add_u32 s63, s63, 524288
    s_bitset0_b32 s63, 22
    s_setprio 1
L_st_v0:
    s_mov_b32 s8, s58
    s_mov_b32 s9, s59
    s_mov_b32 s10, 0x5000000
    s_mov_b32 s11, 0x20000
    s_mov_b32 s24, s36
    s_mov_b32 s25, s37
    s_mov_b32 s26, 0x500000
    s_mov_b32 s27, 0x20000
    v_lshlrev_b32 v13, 4, v1
    s_lshl_b32 s6, s5, 2
    s_add_u32 s7, s6, s3
    s_sub_u32 s6, 56, s6
    s_add_u32 s6, s6, s3
    s_cmp_lt_u32 s3, 4
    s_cselect_b32 s60, s7, s6
    s_sub_u32 s6, 2, s5
    s_and_b32 s6, s6, 7
    s_lshl_b32 s6, s6, 5
    s_add_u32 s61, s6, s4
    v_and_b32 v2, 15, v1
    v_lshrrev_b32 v3, 4, v1
    s_and_b32 s6, s3, 1
    s_lshl_b32 s6, s6, 7
    v_add_u32 v4, s6, v2
    v_lshlrev_b32 v4, 7, v4
    v_add_u32 v4, s100, v4
    v_lshrrev_b32 v5, 1, v2
    v_add_u32 v6, 0, v3
    v_xor_b32 v6, v6, v5
    v_lshl_add_u32 v48, v6, 4, v4
    v_add_u32 v6, 4, v3
    v_xor_b32 v6, v6, v5
    v_lshl_add_u32 v49, v6, 4, v4
    v_lshrrev_b32 v4, 2, v2
    v_lshl_add_u32 v5, v3, 3, v4
    v_lshlrev_b32 v5, 8, v5
    v_and_b32 v6, 1, v2
    v_lshl_add_u32 v5, v6, 3, v5
    v_and_b32 v6, 1, v3
    v_lshl_or_b32 v4, v6, 2, v4
    v_lshlrev_b32 v4, 1, v4
    v_bfe_u32 v6, v2, 1, 1
    v_add_u32 v8, 131072, v5
    v_add_u32 v7, 0, v6
    v_xor_b32 v7, v7, v4
    v_lshl_add_u32 v54, v7, 4, v8
    v_add_u32 v7, 2, v6
    v_xor_b32 v7, v7, v4
    v_lshl_add_u32 v55, v7, 4, v8
    v_add_u32 v7, 4, v6
    v_xor_b32 v7, v7, v4
    v_lshl_add_u32 v56, v7, 4, v8
    v_add_u32 v7, 6, v6
    v_xor_b32 v7, v7, v4
    v_lshl_add_u32 v57, v7, 4, v8
    v_add_u32 v7, 8, v6
    v_xor_b32 v7, v7, v4
    v_lshl_add_u32 v58, v7, 4, v8
    v_add_u32 v7, 10, v6
    v_xor_b32 v7, v7, v4
    v_lshl_add_u32 v59, v7, 4, v8
    v_add_u32 v7, 12, v6
    v_xor_b32 v7, v7, v4
    v_lshl_add_u32 v60, v7, 4, v8
    v_add_u32 v7, 14, v6
    v_xor_b32 v7, v7, v4
    v_lshl_add_u32 v61, v7, 4, v8
    s_lshr_b32 s6, s3, 2
    s_lshl_b32 s6, s6, 14
    s_add_u32 s6, s6, 32768
    s_add_u32 s6, s6, s100
    v_add_u32 v5, s6, v5
    s_lshr_b32 s7, s3, 1
    s_and_b32 s7, s7, 1
    s_lshl_b32 s7, s7, 3
    s_add_u32 s6, s7, 0
    v_add_u32 v7, s6, v6
    v_xor_b32 v7, v7, v4
    v_lshl_add_u32 v50, v7, 4, v5
    s_add_u32 s6, s7, 2
    v_add_u32 v7, s6, v6
    v_xor_b32 v7, v7, v4
    v_lshl_add_u32 v51, v7, 4, v5
    s_add_u32 s6, s7, 4
    v_add_u32 v7, s6, v6
    v_xor_b32 v7, v7, v4
    v_lshl_add_u32 v52, v7, 4, v5
    s_add_u32 s6, s7, 6
    v_add_u32 v7, s6, v6
    v_xor_b32 v7, v7, v4
    v_lshl_add_u32 v53, v7, 4, v5
    v_mov_b64 v[128:129], 0
    v_mov_b64 v[130:131], 0
    v_mov_b64 v[132:133], 0
    v_mov_b64 v[134:135], 0
    v_mov_b64 v[136:137], 0
    v_mov_b64 v[138:139], 0
    v_mov_b64 v[140:141], 0
    v_mov_b64 v[142:143], 0
    v_mov_b64 v[144:145], 0
    v_mov_b64 v[146:147], 0
    v_mov_b64 v[148:149], 0
    v_mov_b64 v[150:151], 0
    v_mov_b64 v[152:153], 0
    v_mov_b64 v[154:155], 0
    v_mov_b64 v[156:157], 0
    v_mov_b64 v[158:159], 0
    v_mov_b64 v[160:161], 0
    v_mov_b64 v[162:163], 0
    v_mov_b64 v[164:165], 0
    v_mov_b64 v[166:167], 0
    v_mov_b64 v[168:169], 0
    v_mov_b64 v[170:171], 0
    v_mov_b64 v[172:173], 0
    v_mov_b64 v[174:175], 0
    v_mov_b64 v[176:177], 0
    v_mov_b64 v[178:179], 0
    v_mov_b64 v[180:181], 0
    v_mov_b64 v[182:183], 0
    v_mov_b64 v[184:185], 0
    v_mov_b64 v[186:187], 0
    v_mov_b64 v[188:189], 0
    v_mov_b64 v[190:191], 0
    v_mov_b64 v[192:193], 0
    v_mov_b64 v[194:195], 0
    v_mov_b64 v[196:197], 0
    v_mov_b64 v[198:199], 0
    v_mov_b64 v[200:201], 0
    v_mov_b64 v[202:203], 0
    v_mov_b64 v[204:205], 0
    v_mov_b64 v[206:207], 0
    v_mov_b64 v[208:209], 0
    v_mov_b64 v[210:211], 0
    v_mov_b64 v[212:213], 0
    v_mov_b64 v[214:215], 0
    v_mov_b64 v[216:217], 0
    v_mov_b64 v[218:219], 0
    v_mov_b64 v[220:221], 0
    v_mov_b64 v[222:223], 0
    v_mov_b64 v[224:225], 0
    v_mov_b64 v[226:227], 0
    v_mov_b64 v[228:229], 0
    v_mov_b64 v[230:231], 0
    v_mov_b64 v[232:233], 0
    v_mov_b64 v[234:235], 0
    v_mov_b64 v[236:237], 0
    v_mov_b64 v[238:239], 0
    v_mov_b64 v[240:241], 0
    v_mov_b64 v[242:243], 0
    v_mov_b64 v[244:245], 0
    v_mov_b64 v[246:247], 0
    v_mov_b64 v[248:249], 0
    v_mov_b64 v[250:251], 0
    v_mov_b64 v[252:253], 0
    v_mov_b64 v[254:255], 0
    v_add_u32 v12, 20480, v13
    s_mul_i32 s70, s60, 40960
    s_mov_b32 s65, 0
    s_lshl_b32 s6, s4, 20
    s_lshl_b32 s7, s5, 13
    s_add_u32 s6, s6, s7
    s_and_b32 s7, s3, 1
    s_lshl_b32 s7, s7, 16
    s_add_u32 s6, s6, s7
    s_add_u32 s67, s6, 16777216
    s_and_b32 s6, s4, 3
    s_add_u32 s6, s6, s5
    s_sub_u32 s7, s6, 5
    s_cselect_b32 s6, s6, s7
    s_sub_u32 s7, s6, 5
    s_cselect_b32 s6, s6, s7
    s_lshl_b32 s71, s6, 20
    s_lshl_b32 s7, s4, 8
    s_add_u32 s71, s71, s7
    s_lshl_b32 s7, s6, 12
    s_add_u32 s84, s70, s7
    s_add_u32 s6, s6, 1
    s_cmp_eq_u32 s6, 5
    s_cselect_b32 s6, 0, s6
    s_lshl_b32 s7, s6, 12
    s_add_u32 s85, s70, s7
    s_add_u32 s6, s6, 1
    s_cmp_eq_u32 s6, 5
    s_cselect_b32 s6, 0, s6
    s_lshl_b32 s7, s6, 12
    s_add_u32 s86, s70, s7
    s_add_u32 s6, s6, 1
    s_cmp_eq_u32 s6, 5
    s_cselect_b32 s6, 0, s6
    s_lshl_b32 s7, s6, 12
    s_add_u32 s87, s70, s7
    s_add_u32 s6, s6, 1
    s_cmp_eq_u32 s6, 5
    s_cselect_b32 s6, 0, s6
    s_lshl_b32 s7, s6, 12
    s_add_u32 s88, s70, s7
    s_lshr_b32 s7, s3, 1
    s_and_b32 s7, s7, 1
    s_cmp_ge_u32 s3, 4
    s_cbranch_scc1 L_c_v
    s_lshl_b32 s7, s7, 11
    s_add_u32 s67, s67, s7
    s_movk_i32 s68, 3072
    s_mov_b32 s69, 125952
    s_add_u32 s71, s71, 1048576
    s_sub_u32 s75, s71, 5242880
    s_cselect_b32 s71, s71, s75
    s_lshl_b32 s74, s76, 12
    s_add_u32 s74, s74, s100
    s_branch L_c_j
L_c_v:
    s_lshl_b32 s7, s7, 12
    s_add_u32 s67, s67, s7
    s_add_u32 s67, s67, 0x80000
    s_movk_i32 s68, 1024
    s_mov_b32 s69, 128000
L_c_j:
    s_cmp_ge_u32 s3, 4
    s_cbranch_scc1 L_st_v1
    s_mov_b32 m0, s64
    s_add_u32 s72, s62, 524288
    buffer_load_dwordx4 v40, s[12:15], s62 offen offset:0 lds
    buffer_load_dwordx4 v41, s[12:15], s62 offen offset:1024 lds
    buffer_load_dwordx4 v42, s[12:15], s62 offen offset:2048 lds
    buffer_load_dwordx4 v43, s[12:15], s62 offen offset:3072 lds
    s_add_u32 m0, s64, 4096
    s_add_u32 s62, s62, 128
    s_bitset0_b32 s62, 10
    buffer_load_dwordx4 v40, s[12:15], s72 offen offset:0 lds
    buffer_load_dwordx4 v41, s[12:15], s72 offen offset:1024 lds
    buffer_load_dwordx4 v42, s[12:15], s72 offen offset:2048 lds
    buffer_load_dwordx4 v43, s[12:15], s72 offen offset:3072 lds
    s_waitcnt vmcnt(8)
    s_branch L_st_j1
L_st_v1:
    s_waitcnt vmcnt(0)
    v_lshlrev_b32 v64, 16, v16
    v_and_b32 v65, 0xffff0000, v16
    v_lshlrev_b32 v66, 16, v17
    v_and_b32 v67, 0xffff0000, v17
    v_lshlrev_b32 v68, 16, v18
    v_and_b32 v69, 0xffff0000, v18
    v_lshlrev_b32 v70, 16, v19
    v_and_b32 v71, 0xffff0000, v19
    v_lshlrev_b32 v72, 16, v20
    v_and_b32 v73, 0xffff0000, v20
    v_lshlrev_b32 v74, 16, v21
    v_and_b32 v75, 0xffff0000, v21
    v_lshlrev_b32 v76, 16, v22
    v_and_b32 v77, 0xffff0000, v22
    v_lshlrev_b32 v78, 16, v23
    v_and_b32 v79, 0xffff0000, v23
    v_lshlrev_b32 v80, 16, v24
    v_and_b32 v81, 0xffff0000, v24
    v_lshlrev_b32 v82, 16, v25
    v_and_b32 v83, 0xffff0000, v25
    v_pk_add_f32 v[2:3], v[64:65], v[66:67]
    v_pk_add_f32 v[2:3], v[2:3], v[68:69]
    v_pk_add_f32 v[2:3], v[2:3], v[70:71]
    v_pk_add_f32 v[2:3], v[2:3], v[72:73]
    v_pk_add_f32 v[2:3], v[2:3], v[74:75]
    v_pk_add_f32 v[2:3], v[2:3], v[76:77]
    v_pk_add_f32 v[2:3], v[2:3], v[78:79]
    v_pk_add_f32 v[2:3], v[2:3], v[80:81]
    v_pk_add_f32 v[2:3], v[2:3], v[82:83]
    v_add_f32 v2, v2, v3
    s_nop 1
    v_add_f32_dpp v2, v2, v2 quad_perm:[1,0,3,2] row_mask:0xf bank_mask:0xf
    s_nop 1
    v_add_f32_dpp v2, v2, v2 quad_perm:[2,3,0,1] row_mask:0xf bank_mask:0xf
    s_nop 1
    v_add_f32_dpp v2, v2, v2 row_half_mirror row_mask:0xf bank_mask:0xf
    s_nop 1
    v_add_f32_dpp v2, v2, v2 row_mirror row_mask:0xf bank_mask:0xf
    v_mov_b32 v8, v2
    s_nop 1
    v_permlane16_swap_b32 v2, v8
    s_nop 1
    v_add_f32 v2, v2, v8
    s_mov_b32 s7, 0x3acccccd
    v_mul_f32 v2, s7, v2
    v_mov_b64 v[4:5], 0
    v_pk_add_f32 v[6:7], v[64:65], v[2:3] op_sel_hi:[1,0] neg_lo:[0,1] neg_hi:[0,1]
    v_pk_fma_f32 v[4:5], v[6:7], v[6:7], v[4:5]
    v_pk_add_f32 v[6:7], v[66:67], v[2:3] op_sel_hi:[1,0] neg_lo:[0,1] neg_hi:[0,1]
    v_pk_fma_f32 v[4:5], v[6:7], v[6:7], v[4:5]
    v_pk_add_f32 v[6:7], v[68:69], v[2:3] op_sel_hi:[1,0] neg_lo:[0,1] neg_hi:[0,1]
    v_pk_fma_f32 v[4:5], v[6:7], v[6:7], v[4:5]
    v_pk_add_f32 v[6:7], v[70:71], v[2:3] op_sel_hi:[1,0] neg_lo:[0,1] neg_hi:[0,1]
    v_pk_fma_f32 v[4:5], v[6:7], v[6:7], v[4:5]
    v_pk_add_f32 v[6:7], v[72:73], v[2:3] op_sel_hi:[1,0] neg_lo:[0,1] neg_hi:[0,1]
    v_pk_fma_f32 v[4:5], v[6:7], v[6:7], v[4:5]
    v_pk_add_f32 v[6:7], v[74:75], v[2:3] op_sel_hi:[1,0] neg_lo:[0,1] neg_hi:[0,1]
    v_pk_fma_f32 v[4:5], v[6:7], v[6:7], v[4:5]
    v_pk_add_f32 v[6:7], v[76:77], v[2:3] op_sel_hi:[1,0] neg_lo:[0,1] neg_hi:[0,1]
    v_pk_fma_f32 v[4:5], v[6:7], v[6:7], v[4:5]
    v_pk_add_f32 v[6:7], v[78:79], v[2:3] op_sel_hi:[1,0] neg_lo:[0,1] neg_hi:[0,1]
    v_pk_fma_f32 v[4:5], v[6:7], v[6:7], v[4:5]
    v_pk_add_f32 v[6:7], v[80:81], v[2:3] op_sel_hi:[1,0] neg_lo:[0,1] neg_hi:[0,1]
    v_pk_fma_f32 v[4:5], v[6:7], v[6:7], v[4:5]
    v_pk_add_f32 v[6:7], v[82:83], v[2:3] op_sel_hi:[1,0] neg_lo:[0,1] neg_hi:[0,1]
    v_pk_fma_f32 v[4:5], v[6:7], v[6:7], v[4:5]
    v_add_f32 v4, v4, v5
    s_nop 1
    v_add_f32_dpp v4, v4, v4 quad_perm:[1,0,3,2] row_mask:0xf bank_mask:0xf
    s_nop 1
    v_add_f32_dpp v4, v4, v4 quad_perm:[2,3,0,1] row_mask:0xf bank_mask:0xf
    s_nop 1
    v_add_f32_dpp v4, v4, v4 row_half_mirror row_mask:0xf bank_mask:0xf
    s_nop 1
    v_add_f32_dpp v4, v4, v4 row_mirror row_mask:0xf bank_mask:0xf
    v_mov_b32 v8, v4
    s_nop 1
    v_permlane16_swap_b32 v4, v8
    s_nop 1
    v_add_f32 v4, v4, v8
    v_mul_f32 v4, s7, v4
    v_cvt_pk_bf16_f32 v2, v2, v2
    v_lshlrev_b32 v2, 16, v2
    v_cvt_pk_bf16_f32 v4, v4, v4
    v_lshlrev_b32 v4, 16, v4
    v_add_f32 v4, 0x3727c5ac, v4
    v_cvt_pk_bf16_f32 v4, v4, v4
    v_lshlrev_b32 v4, 16, v4
    v_sqrt_f32 v4, v4
    s_nop 0
    v_cvt_pk_bf16_f32 v4, v4, v4
    v_lshlrev_b32 v4, 16, v4
    v_rcp_f32 v6, v4
    s_nop 0
    v_fma_f32 v5, -v4, v6, 1.0
    v_fmac_f32 v6, v5, v6
    v_mov_b32 v9, 0
    v_pk_add_f32 v[64:65], v[64:65], v[2:3] op_sel_hi:[1,0] neg_lo:[0,1] neg_hi:[0,1]
    v_cvt_pk_bf16_f32 v5, v64, v65
    v_lshlrev_b32 v64, 16, v5
    v_and_b32 v65, 0xffff0000, v5
    v_pk_mul_f32 v[64:65], v[64:65], v[6:7] op_sel_hi:[1,0]
    v_cvt_pk_bf16_f32 v16, v64, v65
    v_pk_add_f32 v[66:67], v[66:67], v[2:3] op_sel_hi:[1,0] neg_lo:[0,1] neg_hi:[0,1]
    v_cvt_pk_bf16_f32 v5, v66, v67
    v_lshlrev_b32 v66, 16, v5
    v_and_b32 v67, 0xffff0000, v5
    v_pk_mul_f32 v[66:67], v[66:67], v[6:7] op_sel_hi:[1,0]
    v_cvt_pk_bf16_f32 v17, v66, v67
    v_pk_add_f32 v[68:69], v[68:69], v[2:3] op_sel_hi:[1,0] neg_lo:[0,1] neg_hi:[0,1]
    v_cvt_pk_bf16_f32 v5, v68, v69
    v_lshlrev_b32 v68, 16, v5
    v_and_b32 v69, 0xffff0000, v5
    v_pk_mul_f32 v[68:69], v[68:69], v[6:7] op_sel_hi:[1,0]
    v_cvt_pk_bf16_f32 v18, v68, v69
    v_pk_add_f32 v[70:71], v[70:71], v[2:3] op_sel_hi:[1,0] neg_lo:[0,1] neg_hi:[0,1]
    v_cvt_pk_bf16_f32 v5, v70, v71
    v_lshlrev_b32 v70, 16, v5
    v_and_b32 v71, 0xffff0000, v5
    v_pk_mul_f32 v[70:71], v[70:71], v[6:7] op_sel_hi:[1,0]
    v_cvt_pk_bf16_f32 v19, v70, v71
    v_pk_add_f32 v[72:73], v[72:73], v[2:3] op_sel_hi:[1,0] neg_lo:[0,1] neg_hi:[0,1]
    v_cvt_pk_bf16_f32 v5, v72, v73
    v_lshlrev_b32 v72, 16, v5
    v_and_b32 v73, 0xffff0000, v5
    v_pk_mul_f32 v[72:73], v[72:73], v[6:7] op_sel_hi:[1,0]
    v_cvt_pk_bf16_f32 v20, v72, v73
    v_pk_add_f32 v[74:75], v[74:75], v[2:3] op_sel_hi:[1,0] neg_lo:[0,1] neg_hi:[0,1]
    v_cvt_pk_bf16_f32 v5, v74, v75
    v_lshlrev_b32 v74, 16, v5
    v_and_b32 v75, 0xffff0000, v5
    v_pk_mul_f32 v[74:75], v[74:75], v[6:7] op_sel_hi:[1,0]
    v_cvt_pk_bf16_f32 v21, v74, v75
    v_pk_add_f32 v[76:77], v[76:77], v[2:3] op_sel_hi:[1,0] neg_lo:[0,1] neg_hi:[0,1]
    v_cvt_pk_bf16_f32 v5, v76, v77
    v_lshlrev_b32 v76, 16, v5
    v_and_b32 v77, 0xffff0000, v5
    v_pk_mul_f32 v[76:77], v[76:77], v[6:7] op_sel_hi:[1,0]
    v_cvt_pk_bf16_f32 v22, v76, v77
    v_pk_add_f32 v[78:79], v[78:79], v[2:3] op_sel_hi:[1,0] neg_lo:[0,1] neg_hi:[0,1]
    v_cvt_pk_bf16_f32 v5, v78, v79
    v_lshlrev_b32 v78, 16, v5
    v_and_b32 v79, 0xffff0000, v5
    v_pk_mul_f32 v[78:79], v[78:79], v[6:7] op_sel_hi:[1,0]
    v_cvt_pk_bf16_f32 v23, v78, v79
    v_pk_add_f32 v[80:81], v[80:81], v[2:3] op_sel_hi:[1,0] neg_lo:[0,1] neg_hi:[0,1]
    v_cvt_pk_bf16_f32 v5, v80, v81
    v_lshlrev_b32 v80, 16, v5
    v_and_b32 v81, 0xffff0000, v5
    v_pk_mul_f32 v[80:81], v[80:81], v[6:7] op_sel_hi:[1,0]
    v_cvt_pk_bf16_f32 v24, v80, v81
    v_pk_add_f32 v[82:83], v[82:83], v[2:3] op_sel_hi:[1,0] neg_lo:[0,1] neg_hi:[0,1]
    v_cvt_pk_bf16_f32 v5, v82, v83
    v_lshlrev_b32 v82, 16, v5
    v_and_b32 v83, 0xffff0000, v5
    v_pk_mul_f32 v[82:83], v[82:83], v[6:7] op_sel_hi:[1,0]
    v_cvt_pk_bf16_f32 v25, v82, v83
    v_add_u32 v10, 131072, v63
    ds_write_b64 v10, v[16:17] offset:0
    ds_write_b64 v10, v[18:19] offset:256
    ds_write_b64 v10, v[20:21] offset:512
    ds_write_b64 v10, v[22:23] offset:768
    ds_write_b64 v10, v[24:25] offset:1024
    s_waitcnt lgkmcnt(0)
    v_mov_b32 v2, 0
    v_lshlrev_b32 v4, 16, v16
    v_lshlrev_b32 v5, 16, v26
    v_fmac_f32 v2, v4, v5
    v_and_b32 v4, 0xffff0000, v16
    v_and_b32 v5, 0xffff0000, v26
    v_fmac_f32 v2, v4, v5
    v_lshlrev_b32 v4, 16, v17
    v_lshlrev_b32 v5, 16, v27
    v_fmac_f32 v2, v4, v5
    v_and_b32 v4, 0xffff0000, v17
    v_and_b32 v5, 0xffff0000, v27
    v_fmac_f32 v2, v4, v5
    v_lshlrev_b32 v4, 16, v18
    v_lshlrev_b32 v5, 16, v28
    v_fmac_f32 v2, v4, v5
    v_and_b32 v4, 0xffff0000, v18
    v_and_b32 v5, 0xffff0000, v28
    v_fmac_f32 v2, v4, v5
    v_lshlrev_b32 v4, 16, v19
    v_lshlrev_b32 v5, 16, v29
    v_fmac_f32 v2, v4, v5
    v_and_b32 v4, 0xffff0000, v19
    v_and_b32 v5, 0xffff0000, v29
    v_fmac_f32 v2, v4, v5
    v_lshlrev_b32 v4, 16, v20
    v_lshlrev_b32 v5, 16, v30
    v_fmac_f32 v2, v4, v5
    v_and_b32 v4, 0xffff0000, v20
    v_and_b32 v5, 0xffff0000, v30
    v_fmac_f32 v2, v4, v5
    v_lshlrev_b32 v4, 16, v21
    v_lshlrev_b32 v5, 16, v31
    v_fmac_f32 v2, v4, v5
    v_and_b32 v4, 0xffff0000, v21
    v_and_b32 v5, 0xffff0000, v31
    v_fmac_f32 v2, v4, v5
    v_lshlrev_b32 v4, 16, v22
    v_lshlrev_b32 v5, 16, v32
    v_fmac_f32 v2, v4, v5
    v_and_b32 v4, 0xffff0000, v22
    v_and_b32 v5, 0xffff0000, v32
    v_fmac_f32 v2, v4, v5
    v_lshlrev_b32 v4, 16, v23
    v_lshlrev_b32 v5, 16, v33
    v_fmac_f32 v2, v4, v5
    v_and_b32 v4, 0xffff0000, v23
    v_and_b32 v5, 0xffff0000, v33
    v_fmac_f32 v2, v4, v5
    v_lshlrev_b32 v4, 16, v24
    v_lshlrev_b32 v5, 16, v34
    v_fmac_f32 v2, v4, v5
    v_and_b32 v4, 0xffff0000, v24
    v_and_b32 v5, 0xffff0000, v34
    v_fmac_f32 v2, v4, v5
    v_lshlrev_b32 v4, 16, v25
    v_lshlrev_b32 v5, 16, v35
    v_fmac_f32 v2, v4, v5
    v_and_b32 v4, 0xffff0000, v25
    v_and_b32 v5, 0xffff0000, v35
    v_fmac_f32 v2, v4, v5
    s_nop 1
    v_add_f32_dpp v2, v2, v2 quad_perm:[1,0,3,2] row_mask:0xf bank_mask:0xf
    s_nop 1
    v_add_f32_dpp v2, v2, v2 quad_perm:[2,3,0,1] row_mask:0xf bank_mask:0xf
    s_nop 1
    v_add_f32_dpp v2, v2, v2 row_half_mirror row_mask:0xf bank_mask:0xf
    s_nop 1
    v_add_f32_dpp v2, v2, v2 row_mirror row_mask:0xf bank_mask:0xf
    v_mov_b32 v8, v2
    s_nop 1
    v_permlane16_swap_b32 v2, v8
    s_nop 1
    v_add_f32 v2, v2, v8
    v_cvt_pk_bf16_f32 v2, v2, v2
    v_and_b32 v2, 0xffff, v2
    v_bfe_i32 v3, v2, 15, 1
    v_and_b32 v3, 0x7fff, v3
    v_or_b32 v3, 0x8000, v3
    v_xor_b32 v2, v2, v3
    s_lshl_b32 s7, s2, 3
    s_sub_u32 s6, 2047, s7
    v_sub_u32 v3, s6, v62
    v_lshl_or_b32 v2, v2, 11, v3
    v_lshlrev_b32 v3, 2, v62
    v_add_u32 v3, 161792, v3
    ds_write_b32 v3, v2
    s_waitcnt lgkmcnt(0)
L_st_j1:
    s_barrier
    s_cmp_ge_u32 s3, 4
    s_cbranch_scc1 L_kv_v
    ds_read_b128 v[64:67], v48 offset:0
    ds_read_b128 v[68:71], v48 offset:2048
    ds_read_b64_tr_b16 v[96:97], v50 offset:0
    ds_read_b64_tr_b16 v[98:99], v50 offset:1024
    ds_read_b64_tr_b16 v[100:101], v51 offset:0
    ds_read_b64_tr_b16 v[102:103], v51 offset:1024
    ds_read_b128 v[72:75], v48 offset:4096
    ds_read_b64_tr_b16 v[104:105], v52 offset:0
    ds_read_b64_tr_b16 v[106:107], v52 offset:1024
    ds_read_b64_tr_b16 v[108:109], v53 offset:0
    ds_read_b64_tr_b16 v[110:111], v53 offset:1024
    ds_read_b128 v[76:79], v48 offset:6144
    ds_read_b128 v[80:83], v48 offset:8192
    ds_read_b128 v[84:87], v48 offset:10240
    ds_read_b128 v[88:91], v48 offset:12288
    ds_read_b128 v[92:95], v48 offset:14336
    s_mov_b32 m0, s73
    s_xor_b32 s64, s64, 0x10000
    buffer_load_dwordx4 v44, s[16:19], s63 offen offset:0 lds
    buffer_load_dwordx4 v45, s[16:19], s63 offen offset:1024 lds
    buffer_load_dwordx4 v46, s[16:19], s63 offen offset:2048 lds
    buffer_load_dwordx4 v47, s[16:19], s63 offen offset:3072 lds
    s_add_u32 m0, s73, 16384
    s_xor_b32 s73, s73, 0x10000
    buffer_load_dwordx4 v44, s[20:23], s63 offen offset:0 lds
    buffer_load_dwordx4 v45, s[20:23], s63 offen offset:1024 lds
    buffer_load_dwordx4 v46, s[20:23], s63 offen offset:2048 lds
    buffer_load_dwordx4 v47, s[20:23], s63 offen offset:3072 lds
    s_add_u32 s63, s63, 524288
    s_bitset0_b32 s63, 22
.p2align 4
L_kloopA:
    s_waitcnt lgkmcnt(12)
    v_mfma_f32_16x16x32_bf16 v[128:131], v[96:99], v[64:67], v[128:131]
    ds_read_b64_tr_b16 v[112:113], v50 offset:8192
    s_waitcnt lgkmcnt(11)
    v_mfma_f32_16x16x32_bf16 v[132:135], v[100:103], v[64:67], v[132:135]
    ds_read_b64_tr_b16 v[114:115], v50 offset:9216
    s_waitcnt lgkmcnt(9)
    v_mfma_f32_16x16x32_bf16 v[136:139], v[104:107], v[64:67], v[136:139]
    ds_read_b64_tr_b16 v[116:117], v51 offset:8192
    s_waitcnt lgkmcnt(8)
    v_mfma_f32_16x16x32_bf16 v[140:143], v[108:111], v[64:67], v[140:143]
    ds_read_b64_tr_b16 v[118:119], v51 offset:9216
    ds_read_b128 v[64:67], v49 offset:0
    v_mfma_f32_16x16x32_bf16 v[156:159], v[108:111], v[68:71], v[156:159]
    ds_read_b64_tr_b16 v[120:121], v52 offset:8192
    v_mfma_f32_16x16x32_bf16 v[152:155], v[104:107], v[68:71], v[152:155]
    ds_read_b64_tr_b16 v[122:123], v52 offset:9216
    v_mfma_f32_16x16x32_bf16 v[148:151], v[100:103], v[68:71], v[148:151]
    ds_read_b64_tr_b16 v[124:125], v53 offset:8192
    v_mfma_f32_16x16x32_bf16 v[144:147], v[96:99], v[68:71], v[144:147]
    ds_read_b64_tr_b16 v[126:127], v53 offset:9216
    ds_read_b128 v[68:71], v49 offset:2048
    v_mfma_f32_16x16x32_bf16 v[160:163], v[96:99], v[72:75], v[160:163]
    v_mfma_f32_16x16x32_bf16 v[164:167], v[100:103], v[72:75], v[164:167]
    v_mfma_f32_16x16x32_bf16 v[168:171], v[104:107], v[72:75], v[168:171]
    v_mfma_f32_16x16x32_bf16 v[172:175], v[108:111], v[72:75], v[172:175]
    ds_read_b128 v[72:75], v49 offset:4096
    s_waitcnt lgkmcnt(15)
    v_mfma_f32_16x16x32_bf16 v[188:191], v[108:111], v[76:79], v[188:191]
    v_mfma_f32_16x16x32_bf16 v[184:187], v[104:107], v[76:79], v[184:187]
    v_mfma_f32_16x16x32_bf16 v[180:183], v[100:103], v[76:79], v[180:183]
    v_mfma_f32_16x16x32_bf16 v[176:179], v[96:99], v[76:79], v[176:179]
    ds_read_b128 v[76:79], v49 offset:6144
    s_waitcnt lgkmcnt(15)
    v_mfma_f32_16x16x32_bf16 v[192:195], v[96:99], v[80:83], v[192:195]
    v_mfma_f32_16x16x32_bf16 v[196:199], v[100:103], v[80:83], v[196:199]
    v_mfma_f32_16x16x32_bf16 v[200:203], v[104:107], v[80:83], v[200:203]
    v_mfma_f32_16x16x32_bf16 v[204:207], v[108:111], v[80:83], v[204:207]
    ds_read_b128 v[80:83], v49 offset:8192
    s_waitcnt lgkmcnt(15)
    v_mfma_f32_16x16x32_bf16 v[220:223], v[108:111], v[84:87], v[220:223]
    v_mfma_f32_16x16x32_bf16 v[216:219], v[104:107], v[84:87], v[216:219]
    v_mfma_f32_16x16x32_bf16 v[212:215], v[100:103], v[84:87], v[212:215]
    v_mfma_f32_16x16x32_bf16 v[208:211], v[96:99], v[84:87], v[208:211]
    ds_read_b128 v[84:87], v49 offset:10240
    s_waitcnt lgkmcnt(15)
    v_mfma_f32_16x16x32_bf16 v[224:227], v[96:99], v[88:91], v[224:227]
    v_mfma_f32_16x16x32_bf16 v[228:231], v[100:103], v[88:91], v[228:231]
    v_mfma_f32_16x16x32_bf16 v[232:235], v[104:107], v[88:91], v[232:235]
    v_mfma_f32_16x16x32_bf16 v[236:239], v[108:111], v[88:91], v[236:239]
    ds_read_b128 v[88:91], v49 offset:12288
    s_waitcnt lgkmcnt(15)
    v_mfma_f32_16x16x32_bf16 v[252:255], v[108:111], v[92:95], v[252:255]
    v_mfma_f32_16x16x32_bf16 v[248:251], v[104:107], v[92:95], v[248:251]
    v_mfma_f32_16x16x32_bf16 v[244:247], v[100:103], v[92:95], v[244:247]
    v_mfma_f32_16x16x32_bf16 v[240:243], v[96:99], v[92:95], v[240:243]
    ds_read_b128 v[92:95], v49 offset:14336
    s_waitcnt lgkmcnt(11)
    v_mfma_f32_16x16x32_bf16 v[128:131], v[112:115], v[64:67], v[128:131]
    v_mfma_f32_16x16x32_bf16 v[132:135], v[116:119], v[64:67], v[132:135]
    s_waitcnt lgkmcnt(9)
    v_mfma_f32_16x16x32_bf16 v[136:139], v[120:123], v[64:67], v[136:139]
    s_waitcnt lgkmcnt(7)
    v_mfma_f32_16x16x32_bf16 v[140:143], v[124:127], v[64:67], v[140:143]
    s_waitcnt lgkmcnt(6)
    v_mfma_f32_16x16x32_bf16 v[156:159], v[124:127], v[68:71], v[156:159]
    v_mfma_f32_16x16x32_bf16 v[152:155], v[120:123], v[68:71], v[152:155]
    v_mfma_f32_16x16x32_bf16 v[148:151], v[116:119], v[68:71], v[148:151]
    v_mfma_f32_16x16x32_bf16 v[144:147], v[112:115], v[68:71], v[144:147]
    v_xor_b32 v48, 0x10000, v48
    v_xor_b32 v49, 0x10000, v49
    v_xor_b32 v50, 0x10000, v50
    v_xor_b32 v51, 0x10000, v51
    v_xor_b32 v52, 0x10000, v52
    v_xor_b32 v53, 0x10000, v53
    s_waitcnt vmcnt(0) lgkmcnt(0)
    s_barrier
    ds_read_b128 v[64:67], v48 offset:0
    ds_read_b128 v[68:71], v48 offset:2048
    v_mfma_f32_16x16x32_bf16 v[160:163], v[112:115], v[72:75], v[160:163]
    ds_read_b64_tr_b16 v[96:97], v50 offset:0
    s_mov_b32 m0, s64
    s_add_u32 s72, s62, 524288
    v_mfma_f32_16x16x32_bf16 v[164:167], v[116:119], v[72:75], v[164:167]
    ds_read_b64_tr_b16 v[98:99], v50 offset:1024
    buffer_load_dwordx4 v40, s[12:15], s62 offen offset:0 lds
    v_mfma_f32_16x16x32_bf16 v[168:171], v[120:123], v[72:75], v[168:171]
    ds_read_b64_tr_b16 v[100:101], v51 offset:0
    buffer_load_dwordx4 v41, s[12:15], s62 offen offset:1024 lds
    v_mfma_f32_16x16x32_bf16 v[172:175], v[124:127], v[72:75], v[172:175]
    ds_read_b64_tr_b16 v[102:103], v51 offset:1024
    buffer_load_dwordx4 v42, s[12:15], s62 offen offset:2048 lds
    ds_read_b128 v[72:75], v48 offset:4096
    v_mfma_f32_16x16x32_bf16 v[188:191], v[124:127], v[76:79], v[188:191]
    ds_read_b64_tr_b16 v[104:105], v52 offset:0
    buffer_load_dwordx4 v43, s[12:15], s62 offen offset:3072 lds
    v_mfma_f32_16x16x32_bf16 v[184:187], v[120:123], v[76:79], v[184:187]
    ds_read_b64_tr_b16 v[106:107], v52 offset:1024
    s_add_u32 m0, s64, 4096
    s_add_u32 s62, s62, 128
    s_bitset0_b32 s62, 10
    v_mfma_f32_16x16x32_bf16 v[180:183], v[116:119], v[76:79], v[180:183]
    ds_read_b64_tr_b16 v[108:109], v53 offset:0
    buffer_load_dwordx4 v40, s[12:15], s72 offen offset:0 lds
    v_mfma_f32_16x16x32_bf16 v[176:179], v[112:115], v[76:79], v[176:179]
    ds_read_b64_tr_b16 v[110:111], v53 offset:1024
    buffer_load_dwordx4 v41, s[12:15], s72 offen offset:1024 lds
    ds_read_b128 v[76:79], v48 offset:6144
    v_mfma_f32_16x16x32_bf16 v[192:195], v[112:115], v[80:83], v[192:195]
    buffer_load_dwordx4 v42, s[12:15], s72 offen offset:2048 lds
    v_mfma_f32_16x16x32_bf16 v[196:199], v[116:119], v[80:83], v[196:199]
    buffer_load_dwordx4 v43, s[12:15], s72 offen offset:3072 lds
    v_mfma_f32_16x16x32_bf16 v[200:203], v[120:123], v[80:83], v[200:203]
    s_mov_b32 m0, s73
    s_xor_b32 s64, s64, 0x10000
    v_mfma_f32_16x16x32_bf16 v[204:207], v[124:127], v[80:83], v[204:207]
    buffer_load_dwordx4 v44, s[16:19], s63 offen offset:0 lds
    ds_read_b128 v[80:83], v48 offset:8192
    v_mfma_f32_16x16x32_bf16 v[220:223], v[124:127], v[84:87], v[220:223]
    buffer_load_dwordx4 v45, s[16:19], s63 offen offset:1024 lds
    v_mfma_f32_16x16x32_bf16 v[216:219], v[120:123], v[84:87], v[216:219]
    buffer_load_dwordx4 v46, s[16:19], s63 offen offset:2048 lds
    v_mfma_f32_16x16x32_bf16 v[212:215], v[116:119], v[84:87], v[212:215]
    buffer_load_dwordx4 v47, s[16:19], s63 offen offset:3072 lds
    v_mfma_f32_16x16x32_bf16 v[208:211], v[112:115], v[84:87], v[208:211]
    s_add_u32 m0, s73, 16384
    s_xor_b32 s73, s73, 0x10000
    ds_read_b128 v[84:87], v48 offset:10240
    v_mfma_f32_16x16x32_bf16 v[224:227], v[112:115], v[88:91], v[224:227]
    buffer_load_dwordx4 v44, s[20:23], s63 offen offset:0 lds
    v_mfma_f32_16x16x32_bf16 v[228:231], v[116:119], v[88:91], v[228:231]
    buffer_load_dwordx4 v45, s[20:23], s63 offen offset:1024 lds
    v_mfma_f32_16x16x32_bf16 v[232:235], v[120:123], v[88:91], v[232:235]
    buffer_load_dwordx4 v46, s[20:23], s63 offen offset:2048 lds
    v_mfma_f32_16x16x32_bf16 v[236:239], v[124:127], v[88:91], v[236:239]
    buffer_load_dwordx4 v47, s[20:23], s63 offen offset:3072 lds
    ds_read_b128 v[88:91], v48 offset:12288
    v_mfma_f32_16x16x32_bf16 v[252:255], v[124:127], v[92:95], v[252:255]
    s_add_u32 s63, s63, 524288
    s_bitset0_b32 s63, 22
    v_mfma_f32_16x16x32_bf16 v[248:251], v[120:123], v[92:95], v[248:251]
    v_mfma_f32_16x16x32_bf16 v[244:247], v[116:119], v[92:95], v[244:247]
    v_mfma_f32_16x16x32_bf16 v[240:243], v[112:115], v[92:95], v[240:243]
    ds_read_b128 v[92:95], v48 offset:14336
    s_add_u32 s65, s65, 1
    s_cmp_lt_u32 s65, 6
    s_cbranch_scc1 L_kloopA
.p2align 4
L_kloopB:
    s_bitcmp1_b32 128, s65
    s_cbranch_scc1 L_khook
L_khook_back:
    s_waitcnt lgkmcnt(12)
    v_mfma_f32_16x16x32_bf16 v[128:131], v[96:99], v[64:67], v[128:131]
    ds_read_b64_tr_b16 v[112:113], v50 offset:8192
    s_waitcnt lgkmcnt(11)
    v_mfma_f32_16x16x32_bf16 v[132:135], v[100:103], v[64:67], v[132:135]
    ds_read_b64_tr_b16 v[114:115], v50 offset:9216
    s_waitcnt lgkmcnt(9)
    v_mfma_f32_16x16x32_bf16 v[136:139], v[104:107], v[64:67], v[136:139]
    ds_read_b64_tr_b16 v[116:117], v51 offset:8192
    s_waitcnt lgkmcnt(8)
    v_mfma_f32_16x16x32_bf16 v[140:143], v[108:111], v[64:67], v[140:143]
    ds_read_b64_tr_b16 v[118:119], v51 offset:9216
    ds_read_b128 v[64:67], v49 offset:0
    v_mfma_f32_16x16x32_bf16 v[156:159], v[108:111], v[68:71], v[156:159]
    ds_read_b64_tr_b16 v[120:121], v52 offset:8192
    v_mfma_f32_16x16x32_bf16 v[152:155], v[104:107], v[68:71], v[152:155]
    ds_read_b64_tr_b16 v[122:123], v52 offset:9216
    v_mfma_f32_16x16x32_bf16 v[148:151], v[100:103], v[68:71], v[148:151]
    ds_read_b64_tr_b16 v[124:125], v53 offset:8192
    v_mfma_f32_16x16x32_bf16 v[144:147], v[96:99], v[68:71], v[144:147]
    ds_read_b64_tr_b16 v[126:127], v53 offset:9216
    ds_read_b128 v[68:71], v49 offset:2048
    v_mfma_f32_16x16x32_bf16 v[160:163], v[96:99], v[72:75], v[160:163]
    v_mfma_f32_16x16x32_bf16 v[164:167], v[100:103], v[72:75], v[164:167]
    v_mfma_f32_16x16x32_bf16 v[168:171], v[104:107], v[72:75], v[168:171]
    v_mfma_f32_16x16x32_bf16 v[172:175], v[108:111], v[72:75], v[172:175]
    ds_read_b128 v[72:75], v49 offset:4096
    s_waitcnt lgkmcnt(15)
    v_mfma_f32_16x16x32_bf16 v[188:191], v[108:111], v[76:79], v[188:191]
    v_mfma_f32_16x16x32_bf16 v[184:187], v[104:107], v[76:79], v[184:187]
    v_mfma_f32_16x16x32_bf16 v[180:183], v[100:103], v[76:79], v[180:183]
    v_mfma_f32_16x16x32_bf16 v[176:179], v[96:99], v[76:79], v[176:179]
    ds_read_b128 v[76:79], v49 offset:6144
    s_waitcnt lgkmcnt(15)
    v_mfma_f32_16x16x32_bf16 v[192:195], v[96:99], v[80:83], v[192:195]
    v_mfma_f32_16x16x32_bf16 v[196:199], v[100:103], v[80:83], v[196:199]
    v_mfma_f32_16x16x32_bf16 v[200:203], v[104:107], v[80:83], v[200:203]
    v_mfma_f32_16x16x32_bf16 v[204:207], v[108:111], v[80:83], v[204:207]
    ds_read_b128 v[80:83], v49 offset:8192
    s_waitcnt lgkmcnt(15)
    v_mfma_f32_16x16x32_bf16 v[220:223], v[108:111], v[84:87], v[220:223]
    v_mfma_f32_16x16x32_bf16 v[216:219], v[104:107], v[84:87], v[216:219]
    v_mfma_f32_16x16x32_bf16 v[212:215], v[100:103], v[84:87], v[212:215]
    v_mfma_f32_16x16x32_bf16 v[208:211], v[96:99], v[84:87], v[208:211]
    ds_read_b128 v[84:87], v49 offset:10240
    s_waitcnt lgkmcnt(15)
    v_mfma_f32_16x16x32_bf16 v[224:227], v[96:99], v[88:91], v[224:227]
    v_mfma_f32_16x16x32_bf16 v[228:231], v[100:103], v[88:91], v[228:231]
    v_mfma_f32_16x16x32_bf16 v[232:235], v[104:107], v[88:91], v[232:235]
    v_mfma_f32_16x16x32_bf16 v[236:239], v[108:111], v[88:91], v[236:239]
    ds_read_b128 v[88:91], v49 offset:12288
    s_waitcnt lgkmcnt(15)
    v_mfma_f32_16x16x32_bf16 v[252:255], v[108:111], v[92:95], v[252:255]
    v_mfma_f32_16x16x32_bf16 v[248:251], v[104:107], v[92:95], v[248:251]
    v_mfma_f32_16x16x32_bf16 v[244:247], v[100:103], v[92:95], v[244:247]
    v_mfma_f32_16x16x32_bf16 v[240:243], v[96:99], v[92:95], v[240:243]
    ds_read_b128 v[92:95], v49 offset:14336
    s_waitcnt lgkmcnt(11)
    v_mfma_f32_16x16x32_bf16 v[128:131], v[112:115], v[64:67], v[128:131]
    v_mfma_f32_16x16x32_bf16 v[132:135], v[116:119], v[64:67], v[132:135]
    s_waitcnt lgkmcnt(9)
    v_mfma_f32_16x16x32_bf16 v[136:139], v[120:123], v[64:67], v[136:139]
    s_waitcnt lgkmcnt(7)
    v_mfma_f32_16x16x32_bf16 v[140:143], v[124:127], v[64:67], v[140:143]
    s_waitcnt lgkmcnt(6)
    v_mfma_f32_16x16x32_bf16 v[156:159], v[124:127], v[68:71], v[156:159]
    v_mfma_f32_16x16x32_bf16 v[152:155], v[120:123], v[68:71], v[152:155]
    v_mfma_f32_16x16x32_bf16 v[148:151], v[116:119], v[68:71], v[148:151]
    v_mfma_f32_16x16x32_bf16 v[144:147], v[112:115], v[68:71], v[144:147]
    v_xor_b32 v48, 0x10000, v48
    v_xor_b32 v49, 0x10000, v49
    v_xor_b32 v50, 0x10000, v50
    v_xor_b32 v51, 0x10000, v51
    v_xor_b32 v52, 0x10000, v52
    v_xor_b32 v53, 0x10000, v53
    s_waitcnt vmcnt(0) lgkmcnt(0)
    s_barrier
    ds_read_b128 v[64:67], v48 offset:0
    ds_read_b128 v[68:71], v48 offset:2048
    v_mfma_f32_16x16x32_bf16 v[160:163], v[112:115], v[72:75], v[160:163]
    ds_read_b64_tr_b16 v[96:97], v50 offset:0
    s_mov_b32 m0, s74
    s_add_u32 s74, s74, 16384
    s_bitset0_b32 s74, 17
    v_mfma_f32_16x16x32_bf16 v[164:167], v[116:119], v[72:75], v[164:167]
    ds_read_b64_tr_b16 v[98:99], v50 offset:1024
    buffer_load_dwordx4 v44, s[24:27], s71 offen offset:0 lds
    v_mfma_f32_16x16x32_bf16 v[168:171], v[120:123], v[72:75], v[168:171]
    ds_read_b64_tr_b16 v[100:101], v51 offset:0
    buffer_load_dwordx4 v45, s[24:27], s71 offen offset:1024 lds
    v_mfma_f32_16x16x32_bf16 v[172:175], v[124:127], v[72:75], v[172:175]
    ds_read_b64_tr_b16 v[102:103], v51 offset:1024
    buffer_load_dwordx4 v46, s[24:27], s71 offen offset:2048 lds
    ds_read_b128 v[72:75], v48 offset:4096
    v_mfma_f32_16x16x32_bf16 v[188:191], v[124:127], v[76:79], v[188:191]
    ds_read_b64_tr_b16 v[104:105], v52 offset:0
    buffer_load_dwordx4 v47, s[24:27], s71 offen offset:3072 lds
    v_mfma_f32_16x16x32_bf16 v[184:187], v[120:123], v[76:79], v[184:187]
    ds_read_b64_tr_b16 v[106:107], v52 offset:1024
    s_add_u32 s71, s71, 524288
    s_sub_u32 s75, s71, 5242880
    s_cselect_b32 s71, s71, s75
    v_mfma_f32_16x16x32_bf16 v[180:183], v[116:119], v[76:79], v[180:183]
    ds_read_b64_tr_b16 v[108:109], v53 offset:0
    s_mov_b32 m0, s74
    s_add_u32 s74, s74, 16384
    s_bitset0_b32 s74, 17
    v_mfma_f32_16x16x32_bf16 v[176:179], v[112:115], v[76:79], v[176:179]
    ds_read_b64_tr_b16 v[110:111], v53 offset:1024
    buffer_load_dwordx4 v44, s[24:27], s71 offen offset:0 lds
    ds_read_b128 v[76:79], v48 offset:6144
    v_mfma_f32_16x16x32_bf16 v[192:195], v[112:115], v[80:83], v[192:195]
    buffer_load_dwordx4 v45, s[24:27], s71 offen offset:1024 lds
    v_mfma_f32_16x16x32_bf16 v[196:199], v[116:119], v[80:83], v[196:199]
    buffer_load_dwordx4 v46, s[24:27], s71 offen offset:2048 lds
    v_mfma_f32_16x16x32_bf16 v[200:203], v[120:123], v[80:83], v[200:203]
    buffer_load_dwordx4 v47, s[24:27], s71 offen offset:3072 lds
    v_mfma_f32_16x16x32_bf16 v[204:207], v[124:127], v[80:83], v[204:207]
    s_add_u32 s71, s71, 524288
    s_sub_u32 s75, s71, 5242880
    s_cselect_b32 s71, s71, s75
    ds_read_b128 v[80:83], v48 offset:8192
    v_mfma_f32_16x16x32_bf16 v[220:223], v[124:127], v[84:87], v[220:223]
    s_mov_b32 m0, s74
    s_add_u32 s74, s74, 16384
    s_bitset0_b32 s74, 17
    v_mfma_f32_16x16x32_bf16 v[216:219], v[120:123], v[84:87], v[216:219]
    buffer_load_dwordx4 v44, s[24:27], s71 offen offset:0 lds
    v_mfma_f32_16x16x32_bf16 v[212:215], v[116:119], v[84:87], v[212:215]
    buffer_load_dwordx4 v45, s[24:27], s71 offen offset:1024 lds
    v_mfma_f32_16x16x32_bf16 v[208:211], v[112:115], v[84:87], v[208:211]
    buffer_load_dwordx4 v46, s[24:27], s71 offen offset:2048 lds
    ds_read_b128 v[84:87], v48 offset:10240
    v_mfma_f32_16x16x32_bf16 v[224:227], v[112:115], v[88:91], v[224:227]
    buffer_load_dwordx4 v47, s[24:27], s71 offen offset:3072 lds
    v_mfma_f32_16x16x32_bf16 v[228:231], v[116:119], v[88:91], v[228:231]
    s_add_u32 s71, s71, 524288
    s_sub_u32 s75, s71, 5242880
    s_cselect_b32 s71, s71, s75
    v_mfma_f32_16x16x32_bf16 v[232:235], v[120:123], v[88:91], v[232:235]
    s_mov_b32 m0, s74
    s_add_u32 s74, s74, 16384
    s_bitset0_b32 s74, 17
    v_mfma_f32_16x16x32_bf16 v[236:239], v[124:127], v[88:91], v[236:239]
    buffer_load_dwordx4 v44, s[24:27], s71 offen offset:0 lds
    ds_read_b128 v[88:91], v48 offset:12288
    v_mfma_f32_16x16x32_bf16 v[252:255], v[124:127], v[92:95], v[252:255]
    buffer_load_dwordx4 v45, s[24:27], s71 offen offset:1024 lds
    v_mfma_f32_16x16x32_bf16 v[248:251], v[120:123], v[92:95], v[248:251]
    buffer_load_dwordx4 v46, s[24:27], s71 offen offset:2048 lds
    v_mfma_f32_16x16x32_bf16 v[244:247], v[116:119], v[92:95], v[244:247]
    buffer_load_dwordx4 v47, s[24:27], s71 offen offset:3072 lds
    v_mfma_f32_16x16x32_bf16 v[240:243], v[112:115], v[92:95], v[240:243]
    s_add_u32 s71, s71, 524288
    s_sub_u32 s75, s71, 5242880
    s_cselect_b32 s71, s71, s75
    ds_read_b128 v[92:95], v48 offset:14336
    s_add_u32 s65, s65, 1
    s_cmp_lt_u32 s65, 8
    s_cbranch_scc1 L_kloopB
    s_waitcnt lgkmcnt(0)
    s_nop 7
    v_cvt_pk_bf16_f32 v128, v128, v129
    v_cvt_pk_bf16_f32 v129, v130, v131
    v_cvt_pk_bf16_f32 v130, v132, v133
    v_cvt_pk_bf16_f32 v131, v134, v135
    v_cvt_pk_bf16_f32 v132, v136, v137
    v_cvt_pk_bf16_f32 v133, v138, v139
    v_cvt_pk_bf16_f32 v134, v140, v141
    v_cvt_pk_bf16_f32 v135, v142, v143
    v_cvt_pk_bf16_f32 v136, v144, v145
    v_cvt_pk_bf16_f32 v137, v146, v147
    v_cvt_pk_bf16_f32 v138, v148, v149
    v_cvt_pk_bf16_f32 v139, v150, v151
    v_cvt_pk_bf16_f32 v140, v152, v153
    v_cvt_pk_bf16_f32 v141, v154, v155
    v_cvt_pk_bf16_f32 v142, v156, v157
    v_cvt_pk_bf16_f32 v143, v158, v159
    v_cvt_pk_bf16_f32 v144, v160, v161
    v_cvt_pk_bf16_f32 v145, v162, v163
    v_cvt_pk_bf16_f32 v146, v164, v165
    v_cvt_pk_bf16_f32 v147, v166, v167
    v_cvt_pk_bf16_f32 v148, v168, v169
    v_cvt_pk_bf16_f32 v149, v170, v171
    v_cvt_pk_bf16_f32 v150, v172, v173
    v_cvt_pk_bf16_f32 v151, v174, v175
    v_cvt_pk_bf16_f32 v152, v176, v177
    v_cvt_pk_bf16_f32 v153, v178, v179
    v_cvt_pk_bf16_f32 v154, v180, v181
    v_cvt_pk_bf16_f32 v155, v182, v183
    v_cvt_pk_bf16_f32 v156, v184, v185
    v_cvt_pk_bf16_f32 v157, v186, v187
    v_cvt_pk_bf16_f32 v158, v188, v189
    v_cvt_pk_bf16_f32 v159, v190, v191
    v_cvt_pk_bf16_f32 v160, v192, v193
    v_cvt_pk_bf16_f32 v161, v194, v195
    v_cvt_pk_bf16_f32 v162, v196, v197
    v_cvt_pk_bf16_f32 v163, v198, v199
    v_cvt_pk_bf16_f32 v164, v200, v201
    v_cvt_pk_bf16_f32 v165, v202, v203
    v_cvt_pk_bf16_f32 v166, v204, v205
    v_cvt_pk_bf16_f32 v167, v206, v207
    v_cvt_pk_bf16_f32 v168, v208, v209
    v_cvt_pk_bf16_f32 v169, v210, v211
    v_cvt_pk_bf16_f32 v170, v212, v213
    v_cvt_pk_bf16_f32 v171, v214, v215
    v_cvt_pk_bf16_f32 v172, v216, v217
    v_cvt_pk_bf16_f32 v173, v218, v219
    v_cvt_pk_bf16_f32 v174, v220, v221
    v_cvt_pk_bf16_f32 v175, v222, v223
    v_cvt_pk_bf16_f32 v176, v224, v225
    v_cvt_pk_bf16_f32 v177, v226, v227
    v_cvt_pk_bf16_f32 v178, v228, v229
    v_cvt_pk_bf16_f32 v179, v230, v231
    v_cvt_pk_bf16_f32 v180, v232, v233
    v_cvt_pk_bf16_f32 v181, v234, v235
    v_cvt_pk_bf16_f32 v182, v236, v237
    v_cvt_pk_bf16_f32 v183, v238, v239
    v_cvt_pk_bf16_f32 v184, v240, v241
    v_cvt_pk_bf16_f32 v185, v242, v243
    v_cvt_pk_bf16_f32 v186, v244, v245
    v_cvt_pk_bf16_f32 v187, v246, v247
    v_cvt_pk_bf16_f32 v188, v248, v249
    v_cvt_pk_bf16_f32 v189, v250, v251
    v_cvt_pk_bf16_f32 v190, v252, v253
    v_cvt_pk_bf16_f32 v191, v254, v255
    s_waitcnt vmcnt(16)
    s_branch L_q
L_hook:
    s_cmp_eq_u32 s65, 1
    s_cbranch_scc1 L_hook1
    s_cmp_eq_u32 s65, 2
    s_cbranch_scc1 L_hook2
    s_cmp_eq_u32 s65, 4
    s_cbranch_scc1 L_hook4
    s_cmp_eq_u32 s65, 6
    s_cbranch_scc1 L_hook6
    s_cmp_lg_u32 s65, 7
    s_cbranch_scc1 L_hook_back
    buffer_load_dwordx4 v[16:19], v13, s[8:11], s84 offen offset:0 sc1
    buffer_load_dwordx4 v[20:23], v12, s[8:11], s84 offen offset:0 sc1
    buffer_load_dwordx4 v[24:27], v13, s[8:11], s84 offen offset:1024 sc1
    buffer_load_dwordx4 v[28:31], v12, s[8:11], s84 offen offset:1024 sc1
    buffer_load_dwordx4 v[32:35], v13, s[8:11], s84 offen offset:2048 sc1
    buffer_load_dwordx4 v[36:39], v12, s[8:11], s84 offen offset:2048 sc1
    s_branch L_hook_back
L_hook1:
    s_cmp_ge_u32 s76, 2
    s_cbranch_scc1 L_tch_1a
    s_and_b32 s6, s4, 3
    s_lshl_b32 s6, s6, 19
    s_lshl_b32 s7, s5, 15
    s_add_u32 s6, s6, s7
    s_lshl_b32 s7, s76, 7
    s_add_u32 s6, s6, s7
    s_add_u32 s6, s6, 512
    v_lshrrev_b32 v6, 1, v1
    v_lshlrev_b32 v6, 10, v6
    v_and_b32 v7, 1, v1
    v_lshl_add_u32 v6, v7, 6, v6
    buffer_load_dword v11, v6, s[12:15], s6 offen
    s_add_u32 s6, s6, 262144
    buffer_load_dword v11, v6, s[12:15], s6 offen
    s_branch L_tch_1c
L_tch_1a:
    v_lshrrev_b32 v6, 5, v1
    v_lshlrev_b32 v6, 6, v6
    v_bfe_u32 v7, v1, 2, 3
    v_add_u32 v6, v6, v7
    v_lshlrev_b32 v6, 13, v6
    v_and_b32 v7, 3, v1
    v_lshl_add_u32 v6, v7, 6, v6
    s_lshl_b32 s6, s4, 8
    s_lshl_b32 s7, s5, 16
    s_add_u32 s6, s6, s7
    s_add_u32 s6, s6, 2097152
    s_cmp_lg_u32 s76, 2
    s_cbranch_scc1 L_tch_1b
    buffer_load_dword v11, v6, s[16:19], s6 offen
    s_branch L_tch_1c
L_tch_1b:
    buffer_load_dword v11, v6, s[20:23], s6 offen
L_tch_1c:
    s_branch L_hook_back
L_hook2:
    s_lshr_b32 s72, s2, 1
    s_mul_i32 s72, s72, 20480
    s_and_b32 s7, s2, 1
    s_lshl_b32 s7, s7, 7
    s_add_u32 s72, s72, s7
    v_add_u32 v2, -256, v0
    v_lshrrev_b32 v3, 3, v2
    v_and_b32 v4, 7, v2
    v_mul_u32_u24 v5, 1280, v4
    v_lshl_add_u32 v5, v3, 4, v5
    v_add_u32 v5, 131072, v5
    ds_read_b128 v[16:19], v5
    v_lshlrev_b32 v5, 8, v3
    v_lshl_add_u32 v6, v4, 4, v5
    v_add_u32 v2, 0, v0
    v_lshrrev_b32 v3, 3, v2
    v_and_b32 v4, 7, v2
    v_mul_u32_u24 v5, 1280, v4
    v_lshl_add_u32 v5, v3, 4, v5
    v_add_u32 v5, 131072, v5
    ds_read_b128 v[24:27], v5
    v_lshlrev_b32 v5, 8, v3
    v_lshl_add_u32 v7, v4, 4, v5
    v_add_u32 v2, 256, v0
    v_lshrrev_b32 v3, 3, v2
    v_and_b32 v4, 7, v2
    v_mul_u32_u24 v5, 1280, v4
    v_lshl_add_u32 v5, v3, 4, v5
    v_add_u32 v5, 131072, v5
    ds_read_b128 v[32:35], v5
    v_lshlrev_b32 v5, 8, v3
    v_lshl_add_u32 v8, v4, 4, v5
    s_waitcnt lgkmcnt(0)
    buffer_store_dwordx4 v[16:19], v6, s[8:11], s72 offen sc1
    buffer_store_dwordx4 v[24:27], v7, s[8:11], s72 offen sc1
    s_cmp_ge_u32 s3, 6
    s_cbranch_scc1 L_lns
    buffer_store_dwordx4 v[32:35], v8, s[8:11], s72 offen sc1
L_lns:
    s_cmp_lt_u32 s3, 6
    s_cbranch_scc1 L_zd
    v_mov_b64 v[36:37], 0
    v_mov_b64 v[38:39], 0
    v_lshrrev_b32 v2, 3, v1
    s_cmp_eq_u32 s3, 6
    s_cbranch_scc1 L_z6
    s_lshl_b32 s6, s5, 2
    s_sub_u32 s7, 56, s6
    v_mov_b32 v3, s6
    v_mov_b32 v4, s7
    v_cmp_gt_u32 vcc, 4, v2
    s_lshl_b32 s6, s4, 7
    s_add_u32 s6, s6, 3932160
    v_cndmask_b32 v3, v4, v3, vcc
    v_add_u32 v3, v3, v2
    v_lshl_add_u32 v3, v3, 12, s6
    s_branch L_z7
L_z6:
    v_mov_b32 v3, 0x5000000
    s_lshl_b32 s6, s4, 3
    s_add_u32 s6, s6, s5
    s_lshl_b32 s6, s6, 5
    s_add_u32 s6, s6, s3
    s_lshl_b32 s6, s6, 2
    s_add_u32 s6, s6, 3866624
    s_andn2_b32 s6, s6, 127
    v_cmp_eq_u32 vcc, 0, v2
    v_mov_b32 v4, s6
    s_nop 0
    v_cndmask_b32 v3, v3, v4, vcc
    s_lshl_b32 s6, s61, 5
    s_add_u32 s6, s6, s3
    s_lshl_b32 s6, s6, 2
    s_add_u32 s6, s6, 15859712
    s_andn2_b32 s6, s6, 127
    v_cmp_eq_u32 vcc, 1, v2
    v_mov_b32 v4, s6
    s_nop 0
    v_cndmask_b32 v3, v3, v4, vcc
    s_lshl_b32 s6, s5, 5
    s_add_u32 s6, s6, s4
    s_lshl_b32 s6, s6, 5
    s_add_u32 s6, s6, s3
    s_lshl_b32 s6, s6, 2
    s_add_u32 s6, s6, 3899392
    s_andn2_b32 s6, s6, 127
    v_cmp_eq_u32 vcc, 2, v2
    v_mov_b32 v4, s6
    s_nop 0
    v_cndmask_b32 v3, v3, v4, vcc
    s_and_b32 s6, s4, 7
    s_lshl_b32 s7, s5, 3
    s_add_u32 s6, s6, s7
    s_lshr_b32 s7, s4, 3
    s_add_u32 s7, s7, 0
    s_add_u32 s7, s7, 1
    s_and_b32 s7, s7, 3
    s_lshl_b32 s6, s6, 2
    s_add_u32 s6, s6, s7
    s_mul_i32 s6, s6, 3
    s_add_u32 s6, s6, 0
    s_lshl_b32 s6, s6, 5
    s_add_u32 s6, s6, s3
    s_lshl_b32 s6, s6, 2
    s_add_u32 s6, s6, 15728640
    s_andn2_b32 s6, s6, 127
    v_cmp_eq_u32 vcc, 3, v2
    v_mov_b32 v4, s6
    s_nop 0
    v_cndmask_b32 v3, v3, v4, vcc
    s_and_b32 s6, s4, 7
    s_lshl_b32 s7, s5, 3
    s_add_u32 s6, s6, s7
    s_lshr_b32 s7, s4, 3
    s_add_u32 s7, s7, 1
    s_add_u32 s7, s7, 1
    s_and_b32 s7, s7, 3
    s_lshl_b32 s6, s6, 2
    s_add_u32 s6, s6, s7
    s_mul_i32 s6, s6, 3
    s_add_u32 s6, s6, 1
    s_lshl_b32 s6, s6, 5
    s_add_u32 s6, s6, s3
    s_lshl_b32 s6, s6, 2
    s_add_u32 s6, s6, 15728640
    s_andn2_b32 s6, s6, 127
    v_cmp_eq_u32 vcc, 4, v2
    v_mov_b32 v4, s6
    s_nop 0
    v_cndmask_b32 v3, v3, v4, vcc
    s_and_b32 s6, s4, 7
    s_lshl_b32 s7, s5, 3
    s_add_u32 s6, s6, s7
    s_lshr_b32 s7, s4, 3
    s_add_u32 s7, s7, 2
    s_add_u32 s7, s7, 1
    s_and_b32 s7, s7, 3
    s_lshl_b32 s6, s6, 2
    s_add_u32 s6, s6, s7
    s_mul_i32 s6, s6, 3
    s_add_u32 s6, s6, 2
    s_lshl_b32 s6, s6, 5
    s_add_u32 s6, s6, s3
    s_lshl_b32 s6, s6, 2
    s_add_u32 s6, s6, 15728640
    s_andn2_b32 s6, s6, 127
    v_cmp_eq_u32 vcc, 5, v2
    v_mov_b32 v4, s6
    s_nop 0
    v_cndmask_b32 v3, v3, v4, vcc
    s_mov_b32 s6, 0x5000000
    s_cmp_eq_u32 s2, 31
    s_cmov_b32 s6, 3801088
    s_andn2_b32 s6, s6, 127
    v_cmp_eq_u32 vcc, 6, v2
    v_mov_b32 v4, s6
    s_nop 0
    v_cndmask_b32 v3, v3, v4, vcc
    s_lshl_b32 s6, s2, 7
    s_add_u32 s6, s6, 2621440
    s_andn2_b32 s6, s6, 127
    v_cmp_eq_u32 vcc, 7, v2
    v_mov_b32 v4, s6
    s_nop 0
    v_cndmask_b32 v3, v3, v4, vcc
    v_add_u32 v4, 160896, v13
    s_mov_b32 exec_lo, 0
    s_mov_b32 exec_hi, 0x03000000
    ds_read_b128 v[36:39], v4
    s_mov_b64 exec, -1
    s_waitcnt lgkmcnt(0)
L_z7:
    v_and_b32 v2, 7, v1
    v_lshl_add_u32 v3, v2, 4, v3
    buffer_store_dwordx4 v[36:39], v3, s[8:11], 0 offen sc1
L_zd:
    s_cmp_ge_u32 s76, 2
    s_cbranch_scc1 L_tch_2a
    s_and_b32 s6, s4, 3
    s_lshl_b32 s6, s6, 19
    s_lshl_b32 s7, s5, 15
    s_add_u32 s6, s6, s7
    s_lshl_b32 s7, s76, 7
    s_add_u32 s6, s6, s7
    s_add_u32 s6, s6, 768
    v_lshrrev_b32 v6, 1, v1
    v_lshlrev_b32 v6, 10, v6
    v_and_b32 v7, 1, v1
    v_lshl_add_u32 v6, v7, 6, v6
    buffer_load_dword v11, v6, s[12:15], s6 offen
    s_add_u32 s6, s6, 262144
    buffer_load_dword v11, v6, s[12:15], s6 offen
    s_branch L_tch_2c
L_tch_2a:
    v_lshrrev_b32 v6, 5, v1
    v_lshlrev_b32 v6, 6, v6
    v_bfe_u32 v7, v1, 2, 3
    v_add_u32 v6, v6, v7
    v_lshlrev_b32 v6, 13, v6
    v_and_b32 v7, 3, v1
    v_lshl_add_u32 v6, v7, 6, v6
    s_lshl_b32 s6, s4, 8
    s_lshl_b32 s7, s5, 16
    s_add_u32 s6, s6, s7
    s_add_u32 s6, s6, 3145728
    s_cmp_lg_u32 s76, 2
    s_cbranch_scc1 L_tch_2b
    buffer_load_dword v11, v6, s[16:19], s6 offen
    s_branch L_tch_2c
L_tch_2b:
    buffer_load_dword v11, v6, s[20:23], s6 offen
L_tch_2c:
    s_branch L_hook_back
L_hook4:
    s_cmp_lg_u32 s3, 4
    s_cbranch_scc1 L_hook4b
    s_mov_b32 s28, s56
    s_mov_b32 s29, s57
    s_mov_b32 s30, 0x100
    s_mov_b32 s31, 0x20000
    v_mov_b32 v2, 1
    v_lshlrev_b32 v3, 8, v1
    s_and_b32 s6, s2, 31
    s_lshl_b32 s6, s6, 2
    buffer_atomic_add v2, v3, s[28:31], s6 offen offset:0 sc1
L_hook4b:
    s_lshl_b32 s74, s76, 12
    s_add_u32 s74, s74, 131072
    s_mov_b32 m0, s74
    s_add_u32 s74, s74, 16384
    buffer_load_dwordx4 v44, s[24:27], s71 offen offset:0 lds
    buffer_load_dwordx4 v45, s[24:27], s71 offen offset:1024 lds
    buffer_load_dwordx4 v46, s[24:27], s71 offen offset:2048 lds
    buffer_load_dwordx4 v47, s[24:27], s71 offen offset:3072 lds
    s_add_u32 s71, s71, 524288
    s_sub_u32 s75, s71, 5242880
    s_cselect_b32 s71, s71, s75
    s_mov_b32 m0, s74
    s_add_u32 s74, s74, 16384
    buffer_load_dwordx4 v44, s[24:27], s71 offen offset:0 lds
    buffer_load_dwordx4 v45, s[24:27], s71 offen offset:1024 lds
    buffer_load_dwordx4 v46, s[24:27], s71 offen offset:2048 lds
    buffer_load_dwordx4 v47, s[24:27], s71 offen offset:3072 lds
    s_add_u32 s71, s71, 524288
    s_sub_u32 s75, s71, 5242880
    s_cselect_b32 s71, s71, s75
    s_branch L_hook_back
L_hook6:
    s_cmp_lg_u32 s3, 5
    s_cbranch_scc1 L_hook_back
    s_mov_b32 s28, s56
    s_mov_b32 s29, s57
    s_mov_b32 s30, 0x100
    s_mov_b32 s31, 0x20000
    v_and_b32 v3, 31, v1
    v_lshlrev_b32 v3, 2, v3
    buffer_load_dword v62, v3, s[28:31], 0 offen offset:0 sc1
    s_branch L_hook_back
L_vpre:
    s_waitcnt vmcnt(0)
    s_lshl_b32 s6, s65, 4
    s_add_u32 s6, s6, s3
    s_cmp_lg_u32 s6, 0x65
    s_cbranch_scc1 L_vnow
    v_cmp_gt_u32 vcc, 8, v62
    s_cbranch_vccz L_cntok_3
    s_mov_b32 s28, s56
    s_mov_b32 s29, s57
    s_mov_b32 s30, 0x100
    s_mov_b32 s31, 0x20000
    v_and_b32 v3, 31, v1
    v_lshlrev_b32 v3, 2, v3
    s_mov_b32 s79, 262144
L_poll_4:
    buffer_load_dword v2, v3, s[28:31], 0 offen offset:0 sc1
    s_waitcnt vmcnt(0)
    v_cmp_gt_u32 vcc, 8, v2
    s_cbranch_vccz L_polldone_5
    s_sleep 8
    s_sub_u32 s79, s79, 1
    s_cmp_lg_u32 s79, 0
    s_cbranch_scc1 L_poll_4
L_polldone_5:
L_cntok_3:
    s_branch L_vnow
L_khook:
    s_cmp_lg_u32 s65, 7
    s_cbranch_scc1 L_khook_back
    buffer_load_dwordx4 v[16:19], v13, s[8:11], s84 offen offset:0 sc1
    buffer_load_dwordx4 v[20:23], v12, s[8:11], s84 offen offset:0 sc1
    buffer_load_dwordx4 v[24:27], v13, s[8:11], s84 offen offset:1024 sc1
    buffer_load_dwordx4 v[28:31], v12, s[8:11], s84 offen offset:1024 sc1
    buffer_load_dwordx4 v[32:35], v13, s[8:11], s84 offen offset:2048 sc1
    buffer_load_dwordx4 v[36:39], v12, s[8:11], s84 offen offset:2048 sc1
    s_branch L_khook_back
L_kv_v:
    ds_read_b128 v[64:67], v48 offset:0
    ds_read_b128 v[68:71], v48 offset:2048
    ds_read_b64_tr_b16 v[96:97], v50 offset:0
    ds_read_b64_tr_b16 v[98:99], v50 offset:1024
    ds_read_b64_tr_b16 v[100:101], v51 offset:0
    ds_read_b64_tr_b16 v[102:103], v51 offset:1024
    ds_read_b128 v[72:75], v48 offset:4096
    ds_read_b64_tr_b16 v[104:105], v52 offset:0
    ds_read_b64_tr_b16 v[106:107], v52 offset:1024
    ds_read_b64_tr_b16 v[108:109], v53 offset:0
    ds_read_b64_tr_b16 v[110:111], v53 offset:1024
    ds_read_b128 v[76:79], v48 offset:6144
    ds_read_b128 v[80:83], v48 offset:8192
    ds_read_b128 v[84:87], v48 offset:10240
    ds_read_b128 v[88:91], v48 offset:12288
    ds_read_b128 v[92:95], v48 offset:14336
    s_cmp_ge_u32 s76, 2
    s_cbranch_scc1 L_tch_6a
    s_and_b32 s6, s4, 3
    s_lshl_b32 s6, s6, 19
    s_lshl_b32 s7, s5, 15
    s_add_u32 s6, s6, s7
    s_lshl_b32 s7, s76, 7
    s_add_u32 s6, s6, s7
    s_add_u32 s6, s6, 256
    v_lshrrev_b32 v6, 1, v1
    v_lshlrev_b32 v6, 10, v6
    v_and_b32 v7, 1, v1
    v_lshl_add_u32 v6, v7, 6, v6
    buffer_load_dword v11, v6, s[12:15], s6 offen
    s_add_u32 s6, s6, 262144
    buffer_load_dword v11, v6, s[12:15], s6 offen
    s_branch L_tch_6c
L_tch_6a:
    v_lshrrev_b32 v6, 5, v1
    v_lshlrev_b32 v6, 6, v6
    v_bfe_u32 v7, v1, 2, 3
    v_add_u32 v6, v6, v7
    v_lshlrev_b32 v6, 13, v6
    v_and_b32 v7, 3, v1
    v_lshl_add_u32 v6, v7, 6, v6
    s_lshl_b32 s6, s4, 8
    s_lshl_b32 s7, s5, 16
    s_add_u32 s6, s6, s7
    s_add_u32 s6, s6, 1048576
    s_cmp_lg_u32 s76, 2
    s_cbranch_scc1 L_tch_6b
    buffer_load_dword v11, v6, s[16:19], s6 offen
    s_branch L_tch_6c
L_tch_6b:
    buffer_load_dword v11, v6, s[20:23], s6 offen
L_tch_6c:
.p2align 4
L_vloop:
    s_bitcmp1_b32 214, s65
    s_cbranch_scc1 L_hook
L_hook_back:
    s_waitcnt lgkmcnt(12)
    v_mfma_f32_16x16x32_bf16 v[128:131], v[64:67], v[96:99], v[128:131]
    ds_read_b64_tr_b16 v[112:113], v50 offset:8192
    s_waitcnt lgkmcnt(11)
    v_mfma_f32_16x16x32_bf16 v[132:135], v[64:67], v[100:103], v[132:135]
    ds_read_b64_tr_b16 v[114:115], v50 offset:9216
    s_waitcnt lgkmcnt(9)
    v_mfma_f32_16x16x32_bf16 v[136:139], v[64:67], v[104:107], v[136:139]
    ds_read_b64_tr_b16 v[116:117], v51 offset:8192
    s_waitcnt lgkmcnt(8)
    v_mfma_f32_16x16x32_bf16 v[140:143], v[64:67], v[108:111], v[140:143]
    ds_read_b64_tr_b16 v[118:119], v51 offset:9216
    ds_read_b128 v[64:67], v49 offset:0
    v_mfma_f32_16x16x32_bf16 v[156:159], v[68:71], v[108:111], v[156:159]
    ds_read_b64_tr_b16 v[120:121], v52 offset:8192
    v_mfma_f32_16x16x32_bf16 v[152:155], v[68:71], v[104:107], v[152:155]
    ds_read_b64_tr_b16 v[122:123], v52 offset:9216
    v_mfma_f32_16x16x32_bf16 v[148:151], v[68:71], v[100:103], v[148:151]
    ds_read_b64_tr_b16 v[124:125], v53 offset:8192
    v_mfma_f32_16x16x32_bf16 v[144:147], v[68:71], v[96:99], v[144:147]
    ds_read_b64_tr_b16 v[126:127], v53 offset:9216
    ds_read_b128 v[68:71], v49 offset:2048
    v_mfma_f32_16x16x32_bf16 v[160:163], v[72:75], v[96:99], v[160:163]
    v_mfma_f32_16x16x32_bf16 v[164:167], v[72:75], v[100:103], v[164:167]
    v_mfma_f32_16x16x32_bf16 v[168:171], v[72:75], v[104:107], v[168:171]
    v_mfma_f32_16x16x32_bf16 v[172:175], v[72:75], v[108:111], v[172:175]
    ds_read_b128 v[72:75], v49 offset:4096
    s_waitcnt lgkmcnt(15)
    v_mfma_f32_16x16x32_bf16 v[188:191], v[76:79], v[108:111], v[188:191]
    v_mfma_f32_16x16x32_bf16 v[184:187], v[76:79], v[104:107], v[184:187]
    v_mfma_f32_16x16x32_bf16 v[180:183], v[76:79], v[100:103], v[180:183]
    v_mfma_f32_16x16x32_bf16 v[176:179], v[76:79], v[96:99], v[176:179]
    ds_read_b128 v[76:79], v49 offset:6144
    s_waitcnt lgkmcnt(15)
    v_mfma_f32_16x16x32_bf16 v[192:195], v[80:83], v[96:99], v[192:195]
    v_mfma_f32_16x16x32_bf16 v[196:199], v[80:83], v[100:103], v[196:199]
    v_mfma_f32_16x16x32_bf16 v[200:203], v[80:83], v[104:107], v[200:203]
    v_mfma_f32_16x16x32_bf16 v[204:207], v[80:83], v[108:111], v[204:207]
    ds_read_b128 v[80:83], v49 offset:8192
    s_waitcnt lgkmcnt(15)
    v_mfma_f32_16x16x32_bf16 v[220:223], v[84:87], v[108:111], v[220:223]
    v_mfma_f32_16x16x32_bf16 v[216:219], v[84:87], v[104:107], v[216:219]
    v_mfma_f32_16x16x32_bf16 v[212:215], v[84:87], v[100:103], v[212:215]
    v_mfma_f32_16x16x32_bf16 v[208:211], v[84:87], v[96:99], v[208:211]
    ds_read_b128 v[84:87], v49 offset:10240
    s_waitcnt lgkmcnt(15)
    v_mfma_f32_16x16x32_bf16 v[224:227], v[88:91], v[96:99], v[224:227]
    v_mfma_f32_16x16x32_bf16 v[228:231], v[88:91], v[100:103], v[228:231]
    v_mfma_f32_16x16x32_bf16 v[232:235], v[88:91], v[104:107], v[232:235]
    v_mfma_f32_16x16x32_bf16 v[236:239], v[88:91], v[108:111], v[236:239]
    ds_read_b128 v[88:91], v49 offset:12288
    s_waitcnt lgkmcnt(15)
    v_mfma_f32_16x16x32_bf16 v[252:255], v[92:95], v[108:111], v[252:255]
    v_mfma_f32_16x16x32_bf16 v[248:251], v[92:95], v[104:107], v[248:251]
    v_mfma_f32_16x16x32_bf16 v[244:247], v[92:95], v[100:103], v[244:247]
    v_mfma_f32_16x16x32_bf16 v[240:243], v[92:95], v[96:99], v[240:243]
    ds_read_b128 v[92:95], v49 offset:14336
    s_waitcnt lgkmcnt(11)
    v_mfma_f32_16x16x32_bf16 v[128:131], v[64:67], v[112:115], v[128:131]
    v_mfma_f32_16x16x32_bf16 v[132:135], v[64:67], v[116:119], v[132:135]
    s_waitcnt lgkmcnt(9)
    v_mfma_f32_16x16x32_bf16 v[136:139], v[64:67], v[120:123], v[136:139]
    s_waitcnt lgkmcnt(7)
    v_mfma_f32_16x16x32_bf16 v[140:143], v[64:67], v[124:127], v[140:143]
    s_waitcnt lgkmcnt(6)
    v_mfma_f32_16x16x32_bf16 v[156:159], v[68:71], v[124:127], v[156:159]
    v_mfma_f32_16x16x32_bf16 v[152:155], v[68:71], v[120:123], v[152:155]
    v_mfma_f32_16x16x32_bf16 v[148:151], v[68:71], v[116:119], v[148:151]
    v_mfma_f32_16x16x32_bf16 v[144:147], v[68:71], v[112:115], v[144:147]
    v_xor_b32 v48, 0x10000, v48
    v_xor_b32 v49, 0x10000, v49
    v_xor_b32 v50, 0x10000, v50
    v_xor_b32 v51, 0x10000, v51
    v_xor_b32 v52, 0x10000, v52
    v_xor_b32 v53, 0x10000, v53
    s_bitcmp1_b32 0x48, s65
    s_cbranch_scc1 L_vpre
L_vnow:
    s_waitcnt lgkmcnt(0)
    s_barrier
    ds_read_b128 v[64:67], v48 offset:0
    ds_read_b128 v[68:71], v48 offset:2048
    v_mfma_f32_16x16x32_bf16 v[160:163], v[72:75], v[112:115], v[160:163]
    ds_read_b64_tr_b16 v[96:97], v50 offset:0
    v_mfma_f32_16x16x32_bf16 v[164:167], v[72:75], v[116:119], v[164:167]
    ds_read_b64_tr_b16 v[98:99], v50 offset:1024
    v_mfma_f32_16x16x32_bf16 v[168:171], v[72:75], v[120:123], v[168:171]
    ds_read_b64_tr_b16 v[100:101], v51 offset:0
    v_mfma_f32_16x16x32_bf16 v[172:175], v[72:75], v[124:127], v[172:175]
    ds_read_b64_tr_b16 v[102:103], v51 offset:1024
    ds_read_b128 v[72:75], v48 offset:4096
    v_mfma_f32_16x16x32_bf16 v[188:191], v[76:79], v[124:127], v[188:191]
    ds_read_b64_tr_b16 v[104:105], v52 offset:0
    v_mfma_f32_16x16x32_bf16 v[184:187], v[76:79], v[120:123], v[184:187]
    ds_read_b64_tr_b16 v[106:107], v52 offset:1024
    v_mfma_f32_16x16x32_bf16 v[180:183], v[76:79], v[116:119], v[180:183]
    ds_read_b64_tr_b16 v[108:109], v53 offset:0
    v_mfma_f32_16x16x32_bf16 v[176:179], v[76:79], v[112:115], v[176:179]
    ds_read_b64_tr_b16 v[110:111], v53 offset:1024
    ds_read_b128 v[76:79], v48 offset:6144
    v_mfma_f32_16x16x32_bf16 v[192:195], v[80:83], v[112:115], v[192:195]
    v_mfma_f32_16x16x32_bf16 v[196:199], v[80:83], v[116:119], v[196:199]
    v_mfma_f32_16x16x32_bf16 v[200:203], v[80:83], v[120:123], v[200:203]
    v_mfma_f32_16x16x32_bf16 v[204:207], v[80:83], v[124:127], v[204:207]
    ds_read_b128 v[80:83], v48 offset:8192
    v_mfma_f32_16x16x32_bf16 v[220:223], v[84:87], v[124:127], v[220:223]
    v_mfma_f32_16x16x32_bf16 v[216:219], v[84:87], v[120:123], v[216:219]
    v_mfma_f32_16x16x32_bf16 v[212:215], v[84:87], v[116:119], v[212:215]
    v_mfma_f32_16x16x32_bf16 v[208:211], v[84:87], v[112:115], v[208:211]
    ds_read_b128 v[84:87], v48 offset:10240
    v_mfma_f32_16x16x32_bf16 v[224:227], v[88:91], v[112:115], v[224:227]
    v_mfma_f32_16x16x32_bf16 v[228:231], v[88:91], v[116:119], v[228:231]
    v_mfma_f32_16x16x32_bf16 v[232:235], v[88:91], v[120:123], v[232:235]
    v_mfma_f32_16x16x32_bf16 v[236:239], v[88:91], v[124:127], v[236:239]
    ds_read_b128 v[88:91], v48 offset:12288
    v_mfma_f32_16x16x32_bf16 v[252:255], v[92:95], v[124:127], v[252:255]
    v_mfma_f32_16x16x32_bf16 v[248:251], v[92:95], v[120:123], v[248:251]
    v_mfma_f32_16x16x32_bf16 v[244:247], v[92:95], v[116:119], v[244:247]
    v_mfma_f32_16x16x32_bf16 v[240:243], v[92:95], v[112:115], v[240:243]
    ds_read_b128 v[92:95], v48 offset:14336
    s_add_u32 s65, s65, 1
    s_cmp_lt_u32 s65, 8
    s_cbranch_scc1 L_vloop
    s_waitcnt lgkmcnt(0)
    s_nop 7
    v_cvt_pk_bf16_f32 v128, v128, v129
    v_cvt_pk_bf16_f32 v129, v130, v131
    v_cvt_pk_bf16_f32 v130, v144, v145
    v_cvt_pk_bf16_f32 v131, v146, v147
    v_cvt_pk_bf16_f32 v132, v132, v133
    v_cvt_pk_bf16_f32 v133, v134, v135
    v_cvt_pk_bf16_f32 v134, v148, v149
    v_cvt_pk_bf16_f32 v135, v150, v151
    v_cvt_pk_bf16_f32 v136, v136, v137
    v_cvt_pk_bf16_f32 v137, v138, v139
    v_cvt_pk_bf16_f32 v138, v152, v153
    v_cvt_pk_bf16_f32 v139, v154, v155
    v_cvt_pk_bf16_f32 v140, v140, v141
    v_cvt_pk_bf16_f32 v141, v142, v143
    v_cvt_pk_bf16_f32 v142, v156, v157
    v_cvt_pk_bf16_f32 v143, v158, v159
    v_cvt_pk_bf16_f32 v144, v160, v161
    v_cvt_pk_bf16_f32 v145, v162, v163
    v_cvt_pk_bf16_f32 v146, v176, v177
    v_cvt_pk_bf16_f32 v147, v178, v179
    v_cvt_pk_bf16_f32 v148, v164, v165
    v_cvt_pk_bf16_f32 v149, v166, v167
    v_cvt_pk_bf16_f32 v150, v180, v181
    v_cvt_pk_bf16_f32 v151, v182, v183
    v_cvt_pk_bf16_f32 v152, v168, v169
    v_cvt_pk_bf16_f32 v153, v170, v171
    v_cvt_pk_bf16_f32 v154, v184, v185
    v_cvt_pk_bf16_f32 v155, v186, v187
    v_cvt_pk_bf16_f32 v156, v172, v173
    v_cvt_pk_bf16_f32 v157, v174, v175
    v_cvt_pk_bf16_f32 v158, v188, v189
    v_cvt_pk_bf16_f32 v159, v190, v191
    v_cvt_pk_bf16_f32 v160, v192, v193
    v_cvt_pk_bf16_f32 v161, v194, v195
    v_cvt_pk_bf16_f32 v162, v208, v209
    v_cvt_pk_bf16_f32 v163, v210, v211
    v_cvt_pk_bf16_f32 v164, v196, v197
    v_cvt_pk_bf16_f32 v165, v198, v199
    v_cvt_pk_bf16_f32 v166, v212, v213
    v_cvt_pk_bf16_f32 v167, v214, v215
    v_cvt_pk_bf16_f32 v168, v200, v201
    v_cvt_pk_bf16_f32 v169, v202, v203
    v_cvt_pk_bf16_f32 v170, v216, v217
    v_cvt_pk_bf16_f32 v171, v218, v219
    v_cvt_pk_bf16_f32 v172, v204, v205
    v_cvt_pk_bf16_f32 v173, v206, v207
    v_cvt_pk_bf16_f32 v174, v220, v221
    v_cvt_pk_bf16_f32 v175, v222, v223
    v_cvt_pk_bf16_f32 v176, v224, v225
    v_cvt_pk_bf16_f32 v177, v226, v227
    v_cvt_pk_bf16_f32 v178, v240, v241
    v_cvt_pk_bf16_f32 v179, v242, v243
    v_cvt_pk_bf16_f32 v180, v228, v229
    v_cvt_pk_bf16_f32 v181, v230, v231
    v_cvt_pk_bf16_f32 v182, v244, v245
    v_cvt_pk_bf16_f32 v183, v246, v247
    v_cvt_pk_bf16_f32 v184, v232, v233
    v_cvt_pk_bf16_f32 v185, v234, v235
    v_cvt_pk_bf16_f32 v186, v248, v249
    v_cvt_pk_bf16_f32 v187, v250, v251
    v_cvt_pk_bf16_f32 v188, v236, v237
    v_cvt_pk_bf16_f32 v189, v238, v239
    v_cvt_pk_bf16_f32 v190, v252, v253
    v_cvt_pk_bf16_f32 v191, v254, v255
    s_waitcnt vmcnt(0)
L_q:
    s_mov_b32 s28, s56
    s_mov_b32 s29, s57
    s_mov_b32 s30, 0x100
    s_mov_b32 s31, 0x20000
    s_lshl_b32 s6, s76, 13
    v_add_u32 v49, s6, v13
    s_lshl_b32 s6, s76, 12
    v_add_u32 v50, s6, v13
    s_lshl_b32 s77, s4, 20
    s_add_u32 s77, s77, 16777216
    s_mov_b32 s78, s100
    s_sub_u32 s101, s100, 131072
    s_mov_b32 s90, 0
    s_cmp_lt_u32 s3, 4
    s_cselect_b32 s89, 3, 2
    ds_read_b64_tr_b16 v[96:97], v54 offset:0
    ds_read_b64_tr_b16 v[98:99], v54 offset:1024
    ds_read_b64_tr_b16 v[100:101], v55 offset:0
    ds_read_b64_tr_b16 v[102:103], v55 offset:1024
    ds_read_b64_tr_b16 v[104:105], v56 offset:0
    ds_read_b64_tr_b16 v[106:107], v56 offset:1024
    ds_read_b64_tr_b16 v[108:109], v57 offset:0
    ds_read_b64_tr_b16 v[110:111], v57 offset:1024
    ds_read_b64_tr_b16 v[112:113], v58 offset:0
    ds_read_b64_tr_b16 v[114:115], v58 offset:1024
    ds_read_b64_tr_b16 v[116:117], v59 offset:0
    ds_read_b64_tr_b16 v[118:119], v59 offset:1024
    ds_read_b64_tr_b16 v[120:121], v60 offset:0
    ds_read_b64_tr_b16 v[122:123], v60 offset:1024
    ds_read_b64_tr_b16 v[124:125], v61 offset:0
    ds_read_b64_tr_b16 v[126:127], v61 offset:1024
    buffer_load_dwordx4 v[64:67], v13, s[8:11], s84 offen offset:3072 sc1
    buffer_load_dwordx4 v[68:71], v12, s[8:11], s84 offen offset:3072 sc1
    buffer_load_dwordx4 v[72:75], v13, s[8:11], s85 offen offset:0 sc1
    buffer_load_dwordx4 v[76:79], v12, s[8:11], s85 offen offset:0 sc1
    buffer_load_dwordx4 v[80:83], v13, s[8:11], s85 offen offset:1024 sc1
    buffer_load_dwordx4 v[84:87], v12, s[8:11], s85 offen offset:1024 sc1
    buffer_load_dwordx4 v[88:91], v13, s[8:11], s85 offen offset:2048 sc1
    buffer_load_dwordx4 v[92:95], v12, s[8:11], s85 offen offset:2048 sc1
    s_waitcnt lgkmcnt(14)
    v_mfma_f32_16x16x32_bf16 v[192:195], v[96:99], v[16:19], 0
    v_mfma_f32_16x16x32_bf16 v[196:199], v[96:99], v[20:23], 0
    ds_read_b64_tr_b16 v[96:97], v54 offset:8192
    s_waitcnt lgkmcnt(13)
    v_mfma_f32_16x16x32_bf16 v[204:207], v[100:103], v[20:23], 0
    ds_read_b64_tr_b16 v[98:99], v54 offset:9216
    v_mfma_f32_16x16x32_bf16 v[200:203], v[100:103], v[16:19], 0
    ds_read_b64_tr_b16 v[100:101], v55 offset:8192
    s_waitcnt lgkmcnt(13)
    v_mfma_f32_16x16x32_bf16 v[208:211], v[104:107], v[16:19], 0
    ds_read_b64_tr_b16 v[102:103], v55 offset:9216
    v_mfma_f32_16x16x32_bf16 v[212:215], v[104:107], v[20:23], 0
    ds_read_b64_tr_b16 v[104:105], v56 offset:8192
    s_waitcnt lgkmcnt(13)
    v_mfma_f32_16x16x32_bf16 v[220:223], v[108:111], v[20:23], 0
    ds_read_b64_tr_b16 v[106:107], v56 offset:9216
    buffer_store_dwordx4 v[128:131], v13, s[8:11], s67 offen sc1
    s_add_u32 s67, s67, 1024
    v_mfma_f32_16x16x32_bf16 v[216:219], v[108:111], v[16:19], 0
    ds_read_b64_tr_b16 v[108:109], v57 offset:8192
    s_waitcnt lgkmcnt(13)
    v_mfma_f32_16x16x32_bf16 v[224:227], v[112:115], v[16:19], 0
    ds_read_b64_tr_b16 v[110:111], v57 offset:9216
    v_mfma_f32_16x16x32_bf16 v[228:231], v[112:115], v[20:23], 0
    ds_read_b64_tr_b16 v[112:113], v58 offset:8192
    s_waitcnt lgkmcnt(13)
    v_mfma_f32_16x16x32_bf16 v[236:239], v[116:119], v[20:23], 0
    ds_read_b64_tr_b16 v[114:115], v58 offset:9216
    v_mfma_f32_16x16x32_bf16 v[232:235], v[116:119], v[16:19], 0
    ds_read_b64_tr_b16 v[116:117], v59 offset:8192
    s_waitcnt lgkmcnt(13)
    v_mfma_f32_16x16x32_bf16 v[240:243], v[120:123], v[16:19], 0
    ds_read_b64_tr_b16 v[118:119], v59 offset:9216
    v_mfma_f32_16x16x32_bf16 v[244:247], v[120:123], v[20:23], 0
    ds_read_b64_tr_b16 v[120:121], v60 offset:8192
    s_waitcnt lgkmcnt(13)
    v_mfma_f32_16x16x32_bf16 v[252:255], v[124:127], v[20:23], 0
    ds_read_b64_tr_b16 v[122:123], v60 offset:9216
    v_mfma_f32_16x16x32_bf16 v[248:251], v[124:127], v[16:19], 0
    ds_read_b64_tr_b16 v[124:125], v61 offset:8192
    ds_read_b64_tr_b16 v[126:127], v61 offset:9216
    buffer_load_dwordx4 v[16:19], v13, s[8:11], s85 offen offset:3072 sc1
    buffer_load_dwordx4 v[20:23], v12, s[8:11], s85 offen offset:3072 sc1
    s_waitcnt lgkmcnt(14)
    v_mfma_f32_16x16x32_bf16 v[192:195], v[96:99], v[24:27], v[192:195]
    v_mfma_f32_16x16x32_bf16 v[196:199], v[96:99], v[28:31], v[196:199]
    ds_read_b64_tr_b16 v[96:97], v54 offset:16384
    s_waitcnt lgkmcnt(13)
    v_mfma_f32_16x16x32_bf16 v[204:207], v[100:103], v[28:31], v[204:207]
    ds_read_b64_tr_b16 v[98:99], v54 offset:17408
    v_mfma_f32_16x16x32_bf16 v[200:203], v[100:103], v[24:27], v[200:203]
    ds_read_b64_tr_b16 v[100:101], v55 offset:16384
    s_waitcnt lgkmcnt(13)
    v_mfma_f32_16x16x32_bf16 v[208:211], v[104:107], v[24:27], v[208:211]
    ds_read_b64_tr_b16 v[102:103], v55 offset:17408
    v_mfma_f32_16x16x32_bf16 v[212:215], v[104:107], v[28:31], v[212:215]
    ds_read_b64_tr_b16 v[104:105], v56 offset:16384
    s_waitcnt lgkmcnt(13)
    v_mfma_f32_16x16x32_bf16 v[220:223], v[108:111], v[28:31], v[220:223]
    ds_read_b64_tr_b16 v[106:107], v56 offset:17408
    buffer_store_dwordx4 v[132:135], v13, s[8:11], s67 offen sc1
    s_add_u32 s67, s67, s68
    v_mfma_f32_16x16x32_bf16 v[216:219], v[108:111], v[24:27], v[216:219]
    ds_read_b64_tr_b16 v[108:109], v57 offset:16384
    s_waitcnt lgkmcnt(13)
    v_mfma_f32_16x16x32_bf16 v[224:227], v[112:115], v[24:27], v[224:227]
    ds_read_b64_tr_b16 v[110:111], v57 offset:17408
    v_mfma_f32_16x16x32_bf16 v[228:231], v[112:115], v[28:31], v[228:231]
    ds_read_b64_tr_b16 v[112:113], v58 offset:16384
    s_waitcnt lgkmcnt(13)
    v_mfma_f32_16x16x32_bf16 v[236:239], v[116:119], v[28:31], v[236:239]
    ds_read_b64_tr_b16 v[114:115], v58 offset:17408
    v_mfma_f32_16x16x32_bf16 v[232:235], v[116:119], v[24:27], v[232:235]
    ds_read_b64_tr_b16 v[116:117], v59 offset:16384
    s_waitcnt lgkmcnt(13)
    v_mfma_f32_16x16x32_bf16 v[240:243], v[120:123], v[24:27], v[240:243]
    ds_read_b64_tr_b16 v[118:119], v59 offset:17408
    v_mfma_f32_16x16x32_bf16 v[244:247], v[120:123], v[28:31], v[244:247]
    ds_read_b64_tr_b16 v[120:121], v60 offset:16384
    s_waitcnt lgkmcnt(13)
    v_mfma_f32_16x16x32_bf16 v[252:255], v[124:127], v[28:31], v[252:255]
    ds_read_b64_tr_b16 v[122:123], v60 offset:17408
    v_mfma_f32_16x16x32_bf16 v[248:251], v[124:127], v[24:27], v[248:251]
    ds_read_b64_tr_b16 v[124:125], v61 offset:16384
    ds_read_b64_tr_b16 v[126:127], v61 offset:17408
    buffer_load_dwordx4 v[24:27], v13, s[8:11], s86 offen offset:0 sc1
    buffer_load_dwordx4 v[28:31], v12, s[8:11], s86 offen offset:0 sc1
    s_waitcnt lgkmcnt(14)
    v_mfma_f32_16x16x32_bf16 v[192:195], v[96:99], v[32:35], v[192:195]
    v_mfma_f32_16x16x32_bf16 v[196:199], v[96:99], v[36:39], v[196:199]
    ds_read_b64_tr_b16 v[96:97], v54 offset:24576
    s_waitcnt lgkmcnt(13)
    v_mfma_f32_16x16x32_bf16 v[204:207], v[100:103], v[36:39], v[204:207]
    ds_read_b64_tr_b16 v[98:99], v54 offset:25600
    v_mfma_f32_16x16x32_bf16 v[200:203], v[100:103], v[32:35], v[200:203]
    ds_read_b64_tr_b16 v[100:101], v55 offset:24576
    s_waitcnt lgkmcnt(13)
    v_mfma_f32_16x16x32_bf16 v[208:211], v[104:107], v[32:35], v[208:211]
    ds_read_b64_tr_b16 v[102:103], v55 offset:25600
    v_mfma_f32_16x16x32_bf16 v[212:215], v[104:107], v[36:39], v[212:215]
    ds_read_b64_tr_b16 v[104:105], v56 offset:24576
    s_waitcnt lgkmcnt(13)
    v_mfma_f32_16x16x32_bf16 v[220:223], v[108:111], v[36:39], v[220:223]
    ds_read_b64_tr_b16 v[106:107], v56 offset:25600
    buffer_store_dwordx4 v[136:139], v13, s[8:11], s67 offen sc1
    s_add_u32 s67, s67, 1024
    v_mfma_f32_16x16x32_bf16 v[216:219], v[108:111], v[32:35], v[216:219]
    ds_read_b64_tr_b16 v[108:109], v57 offset:24576
    s_waitcnt lgkmcnt(13)
    v_mfma_f32_16x16x32_bf16 v[224:227], v[112:115], v[32:35], v[224:227]
    ds_read_b64_tr_b16 v[110:111], v57 offset:25600
    v_mfma_f32_16x16x32_bf16 v[228:231], v[112:115], v[36:39], v[228:231]
    ds_read_b64_tr_b16 v[112:113], v58 offset:24576
    s_waitcnt lgkmcnt(13)
    v_mfma_f32_16x16x32_bf16 v[236:239], v[116:119], v[36:39], v[236:239]
    ds_read_b64_tr_b16 v[114:115], v58 offset:25600
    v_mfma_f32_16x16x32_bf16 v[232:235], v[116:119], v[32:35], v[232:235]
    ds_read_b64_tr_b16 v[116:117], v59 offset:24576
    s_waitcnt lgkmcnt(13)
    v_mfma_f32_16x16x32_bf16 v[240:243], v[120:123], v[32:35], v[240:243]
    ds_read_b64_tr_b16 v[118:119], v59 offset:25600
    v_mfma_f32_16x16x32_bf16 v[244:247], v[120:123], v[36:39], v[244:247]
    ds_read_b64_tr_b16 v[120:121], v60 offset:24576
    s_waitcnt lgkmcnt(13)
    v_mfma_f32_16x16x32_bf16 v[252:255], v[124:127], v[36:39], v[252:255]
    ds_read_b64_tr_b16 v[122:123], v60 offset:25600
    v_mfma_f32_16x16x32_bf16 v[248:251], v[124:127], v[32:35], v[248:251]
    ds_read_b64_tr_b16 v[124:125], v61 offset:24576
    ds_read_b64_tr_b16 v[126:127], v61 offset:25600
    buffer_load_dwordx4 v[32:35], v13, s[8:11], s86 offen offset:1024 sc1
    buffer_load_dwordx4 v[36:39], v12, s[8:11], s86 offen offset:1024 sc1
    s_waitcnt vmcnt(15)
    s_waitcnt lgkmcnt(14)
    v_mfma_f32_16x16x32_bf16 v[192:195], v[96:99], v[64:67], v[192:195]
    v_add_u32 v54, s101, v54
    v_mfma_f32_16x16x32_bf16 v[196:199], v[96:99], v[68:71], v[196:199]
    ds_read_b64_tr_b16 v[96:97], v54 offset:0
    s_waitcnt lgkmcnt(13)
    v_mfma_f32_16x16x32_bf16 v[204:207], v[100:103], v[68:71], v[204:207]
    ds_read_b64_tr_b16 v[98:99], v54 offset:1024
    v_add_u32 v55, s101, v55
    v_mfma_f32_16x16x32_bf16 v[200:203], v[100:103], v[64:67], v[200:203]
    ds_read_b64_tr_b16 v[100:101], v55 offset:0
    s_waitcnt lgkmcnt(13)
    v_mfma_f32_16x16x32_bf16 v[208:211], v[104:107], v[64:67], v[208:211]
    ds_read_b64_tr_b16 v[102:103], v55 offset:1024
    v_add_u32 v56, s101, v56
    v_mfma_f32_16x16x32_bf16 v[212:215], v[104:107], v[68:71], v[212:215]
    ds_read_b64_tr_b16 v[104:105], v56 offset:0
    s_waitcnt lgkmcnt(13)
    v_mfma_f32_16x16x32_bf16 v[220:223], v[108:111], v[68:71], v[220:223]
    ds_read_b64_tr_b16 v[106:107], v56 offset:1024
    v_add_u32 v57, s101, v57
    buffer_store_dwordx4 v[140:143], v13, s[8:11], s67 offen sc1
    s_add_u32 s67, s67, s69
    v_mfma_f32_16x16x32_bf16 v[216:219], v[108:111], v[64:67], v[216:219]
    ds_read_b64_tr_b16 v[108:109], v57 offset:0
    s_waitcnt lgkmcnt(13)
    v_mfma_f32_16x16x32_bf16 v[224:227], v[112:115], v[64:67], v[224:227]
    ds_read_b64_tr_b16 v[110:111], v57 offset:1024
    v_add_u32 v58, s101, v58
    v_mfma_f32_16x16x32_bf16 v[228:231], v[112:115], v[68:71], v[228:231]
    ds_read_b64_tr_b16 v[112:113], v58 offset:0
    s_waitcnt lgkmcnt(13)
    v_mfma_f32_16x16x32_bf16 v[236:239], v[116:119], v[68:71], v[236:239]
    ds_read_b64_tr_b16 v[114:115], v58 offset:1024
    v_add_u32 v59, s101, v59
    v_mfma_f32_16x16x32_bf16 v[232:235], v[116:119], v[64:67], v[232:235]
    ds_read_b64_tr_b16 v[116:117], v59 offset:0
    s_waitcnt lgkmcnt(13)
    v_mfma_f32_16x16x32_bf16 v[240:243], v[120:123], v[64:67], v[240:243]
    ds_read_b64_tr_b16 v[118:119], v59 offset:1024
    v_add_u32 v60, s101, v60
    v_mfma_f32_16x16x32_bf16 v[244:247], v[120:123], v[68:71], v[244:247]
    ds_read_b64_tr_b16 v[120:121], v60 offset:0
    s_waitcnt lgkmcnt(13)
    v_mfma_f32_16x16x32_bf16 v[252:255], v[124:127], v[68:71], v[252:255]
    ds_read_b64_tr_b16 v[122:123], v60 offset:1024
    v_add_u32 v61, s101, v61
    v_mfma_f32_16x16x32_bf16 v[248:251], v[124:127], v[64:67], v[248:251]
    ds_read_b64_tr_b16 v[124:125], v61 offset:0
    ds_read_b64_tr_b16 v[126:127], v61 offset:1024
    buffer_load_dwordx4 v[64:67], v13, s[8:11], s86 offen offset:2048 sc1
    buffer_load_dwordx4 v[68:71], v12, s[8:11], s86 offen offset:2048 sc1
    s_waitcnt vmcnt(16)
    s_waitcnt lgkmcnt(14)
    v_mfma_f32_16x16x32_bf16 v[192:195], v[96:99], v[72:75], v[192:195]
    v_mfma_f32_16x16x32_bf16 v[196:199], v[96:99], v[76:79], v[196:199]
    ds_read_b64_tr_b16 v[96:97], v54 offset:8192
    s_waitcnt lgkmcnt(13)
    v_mfma_f32_16x16x32_bf16 v[204:207], v[100:103], v[76:79], v[204:207]
    ds_read_b64_tr_b16 v[98:99], v54 offset:9216
    v_mfma_f32_16x16x32_bf16 v[200:203], v[100:103], v[72:75], v[200:203]
    ds_read_b64_tr_b16 v[100:101], v55 offset:8192
    s_waitcnt lgkmcnt(13)
    v_mfma_f32_16x16x32_bf16 v[208:211], v[104:107], v[72:75], v[208:211]
    ds_read_b64_tr_b16 v[102:103], v55 offset:9216
    v_mfma_f32_16x16x32_bf16 v[212:215], v[104:107], v[76:79], v[212:215]
    ds_read_b64_tr_b16 v[104:105], v56 offset:8192
    s_waitcnt lgkmcnt(13)
    v_mfma_f32_16x16x32_bf16 v[220:223], v[108:111], v[76:79], v[220:223]
    ds_read_b64_tr_b16 v[106:107], v56 offset:9216
    v_mfma_f32_16x16x32_bf16 v[216:219], v[108:111], v[72:75], v[216:219]
    ds_read_b64_tr_b16 v[108:109], v57 offset:8192
    s_waitcnt lgkmcnt(13)
    v_mfma_f32_16x16x32_bf16 v[224:227], v[112:115], v[72:75], v[224:227]
    ds_read_b64_tr_b16 v[110:111], v57 offset:9216
    v_mfma_f32_16x16x32_bf16 v[228:231], v[112:115], v[76:79], v[228:231]
    ds_read_b64_tr_b16 v[112:113], v58 offset:8192
    s_waitcnt lgkmcnt(13)
    v_mfma_f32_16x16x32_bf16 v[236:239], v[116:119], v[76:79], v[236:239]
    ds_read_b64_tr_b16 v[114:115], v58 offset:9216
    v_mfma_f32_16x16x32_bf16 v[232:235], v[116:119], v[72:75], v[232:235]
    ds_read_b64_tr_b16 v[116:117], v59 offset:8192
    s_waitcnt lgkmcnt(13)
    v_mfma_f32_16x16x32_bf16 v[240:243], v[120:123], v[72:75], v[240:243]
    ds_read_b64_tr_b16 v[118:119], v59 offset:9216
    v_mfma_f32_16x16x32_bf16 v[244:247], v[120:123], v[76:79], v[244:247]
    ds_read_b64_tr_b16 v[120:121], v60 offset:8192
    s_waitcnt lgkmcnt(13)
    v_mfma_f32_16x16x32_bf16 v[252:255], v[124:127], v[76:79], v[252:255]
    ds_read_b64_tr_b16 v[122:123], v60 offset:9216
    v_mfma_f32_16x16x32_bf16 v[248:251], v[124:127], v[72:75], v[248:251]
    ds_read_b64_tr_b16 v[124:125], v61 offset:8192
    ds_read_b64_tr_b16 v[126:127], v61 offset:9216
    buffer_load_dwordx4 v[72:75], v13, s[8:11], s86 offen offset:3072 sc1
    buffer_load_dwordx4 v[76:79], v12, s[8:11], s86 offen offset:3072 sc1
    s_waitcnt vmcnt(16)
    s_waitcnt lgkmcnt(14)
    v_mfma_f32_16x16x32_bf16 v[192:195], v[96:99], v[80:83], v[192:195]
    v_mfma_f32_16x16x32_bf16 v[196:199], v[96:99], v[84:87], v[196:199]
    ds_read_b64_tr_b16 v[96:97], v54 offset:16384
    s_waitcnt lgkmcnt(13)
    v_mfma_f32_16x16x32_bf16 v[204:207], v[100:103], v[84:87], v[204:207]
    ds_read_b64_tr_b16 v[98:99], v54 offset:17408
    v_mfma_f32_16x16x32_bf16 v[200:203], v[100:103], v[80:83], v[200:203]
    ds_read_b64_tr_b16 v[100:101], v55 offset:16384
    s_waitcnt lgkmcnt(13)
    v_mfma_f32_16x16x32_bf16 v[208:211], v[104:107], v[80:83], v[208:211]
    ds_read_b64_tr_b16 v[102:103], v55 offset:17408
    v_mfma_f32_16x16x32_bf16 v[212:215], v[104:107], v[84:87], v[212:215]
    ds_read_b64_tr_b16 v[104:105], v56 offset:16384
    s_waitcnt lgkmcnt(13)
    v_mfma_f32_16x16x32_bf16 v[220:223], v[108:111], v[84:87], v[220:223]
    ds_read_b64_tr_b16 v[106:107], v56 offset:17408
    v_mfma_f32_16x16x32_bf16 v[216:219], v[108:111], v[80:83], v[216:219]
    ds_read_b64_tr_b16 v[108:109], v57 offset:16384
    s_waitcnt lgkmcnt(13)
    v_mfma_f32_16x16x32_bf16 v[224:227], v[112:115], v[80:83], v[224:227]
    ds_read_b64_tr_b16 v[110:111], v57 offset:17408
    v_mfma_f32_16x16x32_bf16 v[228:231], v[112:115], v[84:87], v[228:231]
    ds_read_b64_tr_b16 v[112:113], v58 offset:16384
    s_waitcnt lgkmcnt(13)
    v_mfma_f32_16x16x32_bf16 v[236:239], v[116:119], v[84:87], v[236:239]
    ds_read_b64_tr_b16 v[114:115], v58 offset:17408
    v_mfma_f32_16x16x32_bf16 v[232:235], v[116:119], v[80:83], v[232:235]
    ds_read_b64_tr_b16 v[116:117], v59 offset:16384
    s_waitcnt lgkmcnt(13)
    v_mfma_f32_16x16x32_bf16 v[240:243], v[120:123], v[80:83], v[240:243]
    ds_read_b64_tr_b16 v[118:119], v59 offset:17408
    v_mfma_f32_16x16x32_bf16 v[244:247], v[120:123], v[84:87], v[244:247]
    ds_read_b64_tr_b16 v[120:121], v60 offset:16384
    s_waitcnt lgkmcnt(13)
    v_mfma_f32_16x16x32_bf16 v[252:255], v[124:127], v[84:87], v[252:255]
    ds_read_b64_tr_b16 v[122:123], v60 offset:17408
    v_mfma_f32_16x16x32_bf16 v[248:251], v[124:127], v[80:83], v[248:251]
    ds_read_b64_tr_b16 v[124:125], v61 offset:16384
    ds_read_b64_tr_b16 v[126:127], v61 offset:17408
    buffer_load_dwordx4 v[80:83], v13, s[8:11], s87 offen offset:0 sc1
    buffer_load_dwordx4 v[84:87], v12, s[8:11], s87 offen offset:0 sc1
    s_waitcnt vmcnt(16)
    s_waitcnt lgkmcnt(14)
    v_mfma_f32_16x16x32_bf16 v[192:195], v[96:99], v[88:91], v[192:195]
    v_mfma_f32_16x16x32_bf16 v[196:199], v[96:99], v[92:95], v[196:199]
    ds_read_b64_tr_b16 v[96:97], v54 offset:24576
    s_waitcnt lgkmcnt(13)
    v_mfma_f32_16x16x32_bf16 v[204:207], v[100:103], v[92:95], v[204:207]
    ds_read_b64_tr_b16 v[98:99], v54 offset:25600
    v_mfma_f32_16x16x32_bf16 v[200:203], v[100:103], v[88:91], v[200:203]
    ds_read_b64_tr_b16 v[100:101], v55 offset:24576
    s_waitcnt lgkmcnt(13)
    v_mfma_f32_16x16x32_bf16 v[208:211], v[104:107], v[88:91], v[208:211]
    ds_read_b64_tr_b16 v[102:103], v55 offset:25600
    v_mfma_f32_16x16x32_bf16 v[212:215], v[104:107], v[92:95], v[212:215]
    ds_read_b64_tr_b16 v[104:105], v56 offset:24576
    s_waitcnt lgkmcnt(13)
    v_mfma_f32_16x16x32_bf16 v[220:223], v[108:111], v[92:95], v[220:223]
    ds_read_b64_tr_b16 v[106:107], v56 offset:25600
    v_mfma_f32_16x16x32_bf16 v[216:219], v[108:111], v[88:91], v[216:219]
    ds_read_b64_tr_b16 v[108:109], v57 offset:24576
    s_waitcnt lgkmcnt(13)
    v_mfma_f32_16x16x32_bf16 v[224:227], v[112:115], v[88:91], v[224:227]
    ds_read_b64_tr_b16 v[110:111], v57 offset:25600
    v_mfma_f32_16x16x32_bf16 v[228:231], v[112:115], v[92:95], v[228:231]
    ds_read_b64_tr_b16 v[112:113], v58 offset:24576
    s_waitcnt lgkmcnt(13)
    v_mfma_f32_16x16x32_bf16 v[236:239], v[116:119], v[92:95], v[236:239]
    ds_read_b64_tr_b16 v[114:115], v58 offset:25600
    v_mfma_f32_16x16x32_bf16 v[232:235], v[116:119], v[88:91], v[232:235]
    ds_read_b64_tr_b16 v[116:117], v59 offset:24576
    s_waitcnt lgkmcnt(13)
    v_mfma_f32_16x16x32_bf16 v[240:243], v[120:123], v[88:91], v[240:243]
    ds_read_b64_tr_b16 v[118:119], v59 offset:25600
    v_mfma_f32_16x16x32_bf16 v[244:247], v[120:123], v[92:95], v[244:247]
    ds_read_b64_tr_b16 v[120:121], v60 offset:24576
    s_waitcnt lgkmcnt(13)
    v_mfma_f32_16x16x32_bf16 v[252:255], v[124:127], v[92:95], v[252:255]
    ds_read_b64_tr_b16 v[122:123], v60 offset:25600
    v_mfma_f32_16x16x32_bf16 v[248:251], v[124:127], v[88:91], v[248:251]
    ds_read_b64_tr_b16 v[124:125], v61 offset:24576
    ds_read_b64_tr_b16 v[126:127], v61 offset:25600
    buffer_load_dwordx4 v[88:91], v13, s[8:11], s87 offen offset:1024 sc1
    buffer_load_dwordx4 v[92:95], v12, s[8:11], s87 offen offset:1024 sc1
    s_waitcnt vmcnt(8)
    s_lshl_b32 s6, s4, 3
    s_add_u32 s6, s6, s5
    s_lshl_b32 s6, s6, 5
    s_add_u32 s6, s6, s3
    s_lshl_b32 s6, s6, 2
    s_add_u32 s6, s6, 3866624
    v_mov_b32 v2, 1
    v_mov_b32 v3, 0x5000000
    v_writelane_b32 v3, s6, 0
    buffer_store_dword v2, v3, s[8:11], 0 offen sc1
    s_waitcnt lgkmcnt(14)
    v_mfma_f32_16x16x32_bf16 v[192:195], v[96:99], v[16:19], v[192:195]
    v_mfma_f32_16x16x32_bf16 v[196:199], v[96:99], v[20:23], v[196:199]
    ds_read_b64_tr_b16 v[96:97], v54 offset:32768
    s_waitcnt lgkmcnt(13)
    v_mfma_f32_16x16x32_bf16 v[204:207], v[100:103], v[20:23], v[204:207]
    ds_read_b64_tr_b16 v[98:99], v54 offset:33792
    v_mfma_f32_16x16x32_bf16 v[200:203], v[100:103], v[16:19], v[200:203]
    ds_read_b64_tr_b16 v[100:101], v55 offset:32768
    s_waitcnt lgkmcnt(13)
    v_mfma_f32_16x16x32_bf16 v[208:211], v[104:107], v[16:19], v[208:211]
    ds_read_b64_tr_b16 v[102:103], v55 offset:33792
    v_mfma_f32_16x16x32_bf16 v[212:215], v[104:107], v[20:23], v[212:215]
    ds_read_b64_tr_b16 v[104:105], v56 offset:32768
    s_waitcnt lgkmcnt(13)
    v_mfma_f32_16x16x32_bf16 v[220:223], v[108:111], v[20:23], v[220:223]
    ds_read_b64_tr_b16 v[106:107], v56 offset:33792
    v_mfma_f32_16x16x32_bf16 v[216:219], v[108:111], v[16:19], v[216:219]
    ds_read_b64_tr_b16 v[108:109], v57 offset:32768
    s_waitcnt lgkmcnt(13)
    v_mfma_f32_16x16x32_bf16 v[224:227], v[112:115], v[16:19], v[224:227]
    ds_read_b64_tr_b16 v[110:111], v57 offset:33792
    v_mfma_f32_16x16x32_bf16 v[228:231], v[112:115], v[20:23], v[228:231]
    ds_read_b64_tr_b16 v[112:113], v58 offset:32768
    s_waitcnt lgkmcnt(13)
    v_mfma_f32_16x16x32_bf16 v[236:239], v[116:119], v[20:23], v[236:239]
    ds_read_b64_tr_b16 v[114:115], v58 offset:33792
    v_mfma_f32_16x16x32_bf16 v[232:235], v[116:119], v[16:19], v[232:235]
    ds_read_b64_tr_b16 v[116:117], v59 offset:32768
    s_waitcnt lgkmcnt(13)
    v_mfma_f32_16x16x32_bf16 v[240:243], v[120:123], v[16:19], v[240:243]
    ds_read_b64_tr_b16 v[118:119], v59 offset:33792
    v_mfma_f32_16x16x32_bf16 v[244:247], v[120:123], v[20:23], v[244:247]
    ds_read_b64_tr_b16 v[120:121], v60 offset:32768
    s_waitcnt lgkmcnt(13)
    v_mfma_f32_16x16x32_bf16 v[252:255], v[124:127], v[20:23], v[252:255]
    ds_read_b64_tr_b16 v[122:123], v60 offset:33792
    v_mfma_f32_16x16x32_bf16 v[248:251], v[124:127], v[16:19], v[248:251]
    ds_read_b64_tr_b16 v[124:125], v61 offset:32768
    ds_read_b64_tr_b16 v[126:127], v61 offset:33792
    buffer_load_dwordx4 v[16:19], v13, s[8:11], s87 offen offset:2048 sc1
    buffer_load_dwordx4 v[20:23], v12, s[8:11], s87 offen offset:2048 sc1
    s_waitcnt lgkmcnt(14)
    v_mfma_f32_16x16x32_bf16 v[192:195], v[96:99], v[24:27], v[192:195]
    v_mfma_f32_16x16x32_bf16 v[196:199], v[96:99], v[28:31], v[196:199]
    ds_read_b64_tr_b16 v[96:97], v54 offset:40960
    s_waitcnt lgkmcnt(13)
    v_mfma_f32_16x16x32_bf16 v[204:207], v[100:103], v[28:31], v[204:207]
    ds_read_b64_tr_b16 v[98:99], v54 offset:41984
    v_mfma_f32_16x16x32_bf16 v[200:203], v[100:103], v[24:27], v[200:203]
    ds_read_b64_tr_b16 v[100:101], v55 offset:40960
    s_waitcnt lgkmcnt(13)
    v_mfma_f32_16x16x32_bf16 v[208:211], v[104:107], v[24:27], v[208:211]
    ds_read_b64_tr_b16 v[102:103], v55 offset:41984
    v_mfma_f32_16x16x32_bf16 v[212:215], v[104:107], v[28:31], v[212:215]
    ds_read_b64_tr_b16 v[104:105], v56 offset:40960
    s_waitcnt lgkmcnt(13)
    v_mfma_f32_16x16x32_bf16 v[220:223], v[108:111], v[28:31], v[220:223]
    ds_read_b64_tr_b16 v[106:107], v56 offset:41984
    v_mfma_f32_16x16x32_bf16 v[216:219], v[108:111], v[24:27], v[216:219]
    ds_read_b64_tr_b16 v[108:109], v57 offset:40960
    s_waitcnt lgkmcnt(13)
    v_mfma_f32_16x16x32_bf16 v[224:227], v[112:115], v[24:27], v[224:227]
    ds_read_b64_tr_b16 v[110:111], v57 offset:41984
    v_mfma_f32_16x16x32_bf16 v[228:231], v[112:115], v[28:31], v[228:231]
    ds_read_b64_tr_b16 v[112:113], v58 offset:40960
    s_waitcnt lgkmcnt(13)
    v_mfma_f32_16x16x32_bf16 v[236:239], v[116:119], v[28:31], v[236:239]
    ds_read_b64_tr_b16 v[114:115], v58 offset:41984
    v_mfma_f32_16x16x32_bf16 v[232:235], v[116:119], v[24:27], v[232:235]
    ds_read_b64_tr_b16 v[116:117], v59 offset:40960
    s_waitcnt lgkmcnt(13)
    v_mfma_f32_16x16x32_bf16 v[240:243], v[120:123], v[24:27], v[240:243]
    ds_read_b64_tr_b16 v[118:119], v59 offset:41984
    v_mfma_f32_16x16x32_bf16 v[244:247], v[120:123], v[28:31], v[244:247]
    ds_read_b64_tr_b16 v[120:121], v60 offset:40960
    s_waitcnt lgkmcnt(13)
    v_mfma_f32_16x16x32_bf16 v[252:255], v[124:127], v[28:31], v[252:255]
    ds_read_b64_tr_b16 v[122:123], v60 offset:41984
    v_mfma_f32_16x16x32_bf16 v[248:251], v[124:127], v[24:27], v[248:251]
    ds_read_b64_tr_b16 v[124:125], v61 offset:40960
    ds_read_b64_tr_b16 v[126:127], v61 offset:41984
    buffer_load_dwordx4 v[24:27], v13, s[8:11], s87 offen offset:3072 sc1
    buffer_load_dwordx4 v[28:31], v12, s[8:11], s87 offen offset:3072 sc1
    s_waitcnt lgkmcnt(14)
    v_mfma_f32_16x16x32_bf16 v[192:195], v[96:99], v[32:35], v[192:195]
    v_mfma_f32_16x16x32_bf16 v[196:199], v[96:99], v[36:39], v[196:199]
    ds_read_b64_tr_b16 v[96:97], v54 offset:49152
    s_waitcnt lgkmcnt(13)
    v_mfma_f32_16x16x32_bf16 v[204:207], v[100:103], v[36:39], v[204:207]
    ds_read_b64_tr_b16 v[98:99], v54 offset:50176
    v_mfma_f32_16x16x32_bf16 v[200:203], v[100:103], v[32:35], v[200:203]
    ds_read_b64_tr_b16 v[100:101], v55 offset:49152
    s_waitcnt lgkmcnt(13)
    v_mfma_f32_16x16x32_bf16 v[208:211], v[104:107], v[32:35], v[208:211]
    ds_read_b64_tr_b16 v[102:103], v55 offset:50176
    v_mfma_f32_16x16x32_bf16 v[212:215], v[104:107], v[36:39], v[212:215]
    ds_read_b64_tr_b16 v[104:105], v56 offset:49152
    s_waitcnt lgkmcnt(13)
    v_mfma_f32_16x16x32_bf16 v[220:223], v[108:111], v[36:39], v[220:223]
    ds_read_b64_tr_b16 v[106:107], v56 offset:50176
    v_mfma_f32_16x16x32_bf16 v[216:219], v[108:111], v[32:35], v[216:219]
    ds_read_b64_tr_b16 v[108:109], v57 offset:49152
    s_waitcnt lgkmcnt(13)
    v_mfma_f32_16x16x32_bf16 v[224:227], v[112:115], v[32:35], v[224:227]
    ds_read_b64_tr_b16 v[110:111], v57 offset:50176
    v_mfma_f32_16x16x32_bf16 v[228:231], v[112:115], v[36:39], v[228:231]
    ds_read_b64_tr_b16 v[112:113], v58 offset:49152
    s_waitcnt lgkmcnt(13)
    v_mfma_f32_16x16x32_bf16 v[236:239], v[116:119], v[36:39], v[236:239]
    ds_read_b64_tr_b16 v[114:115], v58 offset:50176
    v_mfma_f32_16x16x32_bf16 v[232:235], v[116:119], v[32:35], v[232:235]
    ds_read_b64_tr_b16 v[116:117], v59 offset:49152
    s_waitcnt lgkmcnt(13)
    v_mfma_f32_16x16x32_bf16 v[240:243], v[120:123], v[32:35], v[240:243]
    ds_read_b64_tr_b16 v[118:119], v59 offset:50176
    v_mfma_f32_16x16x32_bf16 v[244:247], v[120:123], v[36:39], v[244:247]
    ds_read_b64_tr_b16 v[120:121], v60 offset:49152
    s_waitcnt lgkmcnt(13)
    v_mfma_f32_16x16x32_bf16 v[252:255], v[124:127], v[36:39], v[252:255]
    ds_read_b64_tr_b16 v[122:123], v60 offset:50176
    v_mfma_f32_16x16x32_bf16 v[248:251], v[124:127], v[32:35], v[248:251]
    ds_read_b64_tr_b16 v[124:125], v61 offset:49152
    ds_read_b64_tr_b16 v[126:127], v61 offset:50176
    buffer_load_dwordx4 v[32:35], v13, s[8:11], s88 offen offset:0 sc1
    buffer_load_dwordx4 v[36:39], v12, s[8:11], s88 offen offset:0 sc1
    s_waitcnt vmcnt(13)
    s_waitcnt lgkmcnt(14)
    v_mfma_f32_16x16x32_bf16 v[192:195], v[96:99], v[64:67], v[192:195]
    v_mfma_f32_16x16x32_bf16 v[196:199], v[96:99], v[68:71], v[196:199]
    ds_read_b64_tr_b16 v[96:97], v54 offset:57344
    s_waitcnt lgkmcnt(13)
    v_mfma_f32_16x16x32_bf16 v[204:207], v[100:103], v[68:71], v[204:207]
    ds_read_b64_tr_b16 v[98:99], v54 offset:58368
    v_mfma_f32_16x16x32_bf16 v[200:203], v[100:103], v[64:67], v[200:203]
    ds_read_b64_tr_b16 v[100:101], v55 offset:57344
    s_waitcnt lgkmcnt(13)
    v_mfma_f32_16x16x32_bf16 v[208:211], v[104:107], v[64:67], v[208:211]
    ds_read_b64_tr_b16 v[102:103], v55 offset:58368
    v_mfma_f32_16x16x32_bf16 v[212:215], v[104:107], v[68:71], v[212:215]
    ds_read_b64_tr_b16 v[104:105], v56 offset:57344
    s_waitcnt lgkmcnt(13)
    v_mfma_f32_16x16x32_bf16 v[220:223], v[108:111], v[68:71], v[220:223]
    ds_read_b64_tr_b16 v[106:107], v56 offset:58368
    v_mfma_f32_16x16x32_bf16 v[216:219], v[108:111], v[64:67], v[216:219]
    ds_read_b64_tr_b16 v[108:109], v57 offset:57344
    s_waitcnt lgkmcnt(13)
    v_mfma_f32_16x16x32_bf16 v[224:227], v[112:115], v[64:67], v[224:227]
    ds_read_b64_tr_b16 v[110:111], v57 offset:58368
    v_mfma_f32_16x16x32_bf16 v[228:231], v[112:115], v[68:71], v[228:231]
    ds_read_b64_tr_b16 v[112:113], v58 offset:57344
    s_waitcnt lgkmcnt(13)
    v_mfma_f32_16x16x32_bf16 v[236:239], v[116:119], v[68:71], v[236:239]
    ds_read_b64_tr_b16 v[114:115], v58 offset:58368
    v_mfma_f32_16x16x32_bf16 v[232:235], v[116:119], v[64:67], v[232:235]
    ds_read_b64_tr_b16 v[116:117], v59 offset:57344
    s_waitcnt lgkmcnt(13)
    v_mfma_f32_16x16x32_bf16 v[240:243], v[120:123], v[64:67], v[240:243]
    ds_read_b64_tr_b16 v[118:119], v59 offset:58368
    v_mfma_f32_16x16x32_bf16 v[244:247], v[120:123], v[68:71], v[244:247]
    ds_read_b64_tr_b16 v[120:121], v60 offset:57344
    s_waitcnt lgkmcnt(13)
    v_mfma_f32_16x16x32_bf16 v[252:255], v[124:127], v[68:71], v[252:255]
    ds_read_b64_tr_b16 v[122:123], v60 offset:58368
    v_mfma_f32_16x16x32_bf16 v[248:251], v[124:127], v[64:67], v[248:251]
    ds_read_b64_tr_b16 v[124:125], v61 offset:57344
    ds_read_b64_tr_b16 v[126:127], v61 offset:58368
    buffer_load_dwordx4 v[64:67], v13, s[8:11], s88 offen offset:1024 sc1
    buffer_load_dwordx4 v[68:71], v12, s[8:11], s88 offen offset:1024 sc1
    s_waitcnt vmcnt(13)
    s_waitcnt lgkmcnt(14)
    v_mfma_f32_16x16x32_bf16 v[192:195], v[96:99], v[72:75], v[192:195]
    v_xor_b32 v54, 0x10000, v54
    v_mfma_f32_16x16x32_bf16 v[196:199], v[96:99], v[76:79], v[196:199]
    s_waitcnt lgkmcnt(12)
    v_mfma_f32_16x16x32_bf16 v[204:207], v[100:103], v[76:79], v[204:207]
    v_xor_b32 v55, 0x10000, v55
    v_mfma_f32_16x16x32_bf16 v[200:203], v[100:103], v[72:75], v[200:203]
    s_waitcnt lgkmcnt(0)
    s_barrier
    ds_read_b64_tr_b16 v[96:97], v54 offset:0
    ds_read_b64_tr_b16 v[98:99], v54 offset:1024
    ds_read_b64_tr_b16 v[100:101], v55 offset:0
    v_mfma_f32_16x16x32_bf16 v[208:211], v[104:107], v[72:75], v[208:211]
    ds_read_b64_tr_b16 v[102:103], v55 offset:1024
    v_xor_b32 v56, 0x10000, v56
    v_mfma_f32_16x16x32_bf16 v[212:215], v[104:107], v[76:79], v[212:215]
    ds_read_b64_tr_b16 v[104:105], v56 offset:0
    v_mfma_f32_16x16x32_bf16 v[220:223], v[108:111], v[76:79], v[220:223]
    ds_read_b64_tr_b16 v[106:107], v56 offset:1024
    v_xor_b32 v57, 0x10000, v57
    v_mfma_f32_16x16x32_bf16 v[216:219], v[108:111], v[72:75], v[216:219]
    ds_read_b64_tr_b16 v[108:109], v57 offset:0
    v_mfma_f32_16x16x32_bf16 v[224:227], v[112:115], v[72:75], v[224:227]
    ds_read_b64_tr_b16 v[110:111], v57 offset:1024
    v_xor_b32 v58, 0x10000, v58
    v_mfma_f32_16x16x32_bf16 v[228:231], v[112:115], v[76:79], v[228:231]
    ds_read_b64_tr_b16 v[112:113], v58 offset:0
    v_mfma_f32_16x16x32_bf16 v[236:239], v[116:119], v[76:79], v[236:239]
    ds_read_b64_tr_b16 v[114:115], v58 offset:1024
    v_xor_b32 v59, 0x10000, v59
    v_mfma_f32_16x16x32_bf16 v[232:235], v[116:119], v[72:75], v[232:235]
    ds_read_b64_tr_b16 v[116:117], v59 offset:0
    v_mfma_f32_16x16x32_bf16 v[240:243], v[120:123], v[72:75], v[240:243]
    ds_read_b64_tr_b16 v[118:119], v59 offset:1024
    v_xor_b32 v60, 0x10000, v60
    v_mfma_f32_16x16x32_bf16 v[244:247], v[120:123], v[76:79], v[244:247]
    ds_read_b64_tr_b16 v[120:121], v60 offset:0
    v_mfma_f32_16x16x32_bf16 v[252:255], v[124:127], v[76:79], v[252:255]
    ds_read_b64_tr_b16 v[122:123], v60 offset:1024
    v_xor_b32 v61, 0x10000, v61
    v_mfma_f32_16x16x32_bf16 v[248:251], v[124:127], v[72:75], v[248:251]
    ds_read_b64_tr_b16 v[124:125], v61 offset:0
    ds_read_b64_tr_b16 v[126:127], v61 offset:1024
    buffer_load_dwordx4 v[72:75], v13, s[8:11], s88 offen offset:2048 sc1
    buffer_load_dwordx4 v[76:79], v12, s[8:11], s88 offen offset:2048 sc1
    s_waitcnt vmcnt(13)
    s_waitcnt lgkmcnt(14)
    v_mfma_f32_16x16x32_bf16 v[192:195], v[96:99], v[80:83], v[192:195]
    v_mfma_f32_16x16x32_bf16 v[196:199], v[96:99], v[84:87], v[196:199]
    ds_read_b64_tr_b16 v[96:97], v54 offset:8192
    s_waitcnt lgkmcnt(13)
    v_mfma_f32_16x16x32_bf16 v[204:207], v[100:103], v[84:87], v[204:207]
    ds_read_b64_tr_b16 v[98:99], v54 offset:9216
    v_mfma_f32_16x16x32_bf16 v[200:203], v[100:103], v[80:83], v[200:203]
    ds_read_b64_tr_b16 v[100:101], v55 offset:8192
    s_waitcnt lgkmcnt(13)
    v_mfma_f32_16x16x32_bf16 v[208:211], v[104:107], v[80:83], v[208:211]
    ds_read_b64_tr_b16 v[102:103], v55 offset:9216
    v_mfma_f32_16x16x32_bf16 v[212:215], v[104:107], v[84:87], v[212:215]
    ds_read_b64_tr_b16 v[104:105], v56 offset:8192
    s_waitcnt lgkmcnt(13)
    v_mfma_f32_16x16x32_bf16 v[220:223], v[108:111], v[84:87], v[220:223]
    ds_read_b64_tr_b16 v[106:107], v56 offset:9216
    v_mfma_f32_16x16x32_bf16 v[216:219], v[108:111], v[80:83], v[216:219]
    ds_read_b64_tr_b16 v[108:109], v57 offset:8192
    s_waitcnt lgkmcnt(13)
    v_mfma_f32_16x16x32_bf16 v[224:227], v[112:115], v[80:83], v[224:227]
    ds_read_b64_tr_b16 v[110:111], v57 offset:9216
    v_mfma_f32_16x16x32_bf16 v[228:231], v[112:115], v[84:87], v[228:231]
    ds_read_b64_tr_b16 v[112:113], v58 offset:8192
    s_waitcnt lgkmcnt(13)
    v_mfma_f32_16x16x32_bf16 v[236:239], v[116:119], v[84:87], v[236:239]
    ds_read_b64_tr_b16 v[114:115], v58 offset:9216
    v_mfma_f32_16x16x32_bf16 v[232:235], v[116:119], v[80:83], v[232:235]
    ds_read_b64_tr_b16 v[116:117], v59 offset:8192
    s_waitcnt lgkmcnt(13)
    v_mfma_f32_16x16x32_bf16 v[240:243], v[120:123], v[80:83], v[240:243]
    ds_read_b64_tr_b16 v[118:119], v59 offset:9216
    v_mfma_f32_16x16x32_bf16 v[244:247], v[120:123], v[84:87], v[244:247]
    ds_read_b64_tr_b16 v[120:121], v60 offset:8192
    s_waitcnt lgkmcnt(13)
    v_mfma_f32_16x16x32_bf16 v[252:255], v[124:127], v[84:87], v[252:255]
    ds_read_b64_tr_b16 v[122:123], v60 offset:9216
    v_mfma_f32_16x16x32_bf16 v[248:251], v[124:127], v[80:83], v[248:251]
    ds_read_b64_tr_b16 v[124:125], v61 offset:8192
    ds_read_b64_tr_b16 v[126:127], v61 offset:9216
    buffer_load_dwordx4 v[80:83], v13, s[8:11], s88 offen offset:3072 sc1
    buffer_load_dwordx4 v[84:87], v12, s[8:11], s88 offen offset:3072 sc1
    s_waitcnt vmcnt(13)
    s_waitcnt lgkmcnt(14)
    v_mfma_f32_16x16x32_bf16 v[192:195], v[96:99], v[88:91], v[192:195]
    v_mfma_f32_16x16x32_bf16 v[196:199], v[96:99], v[92:95], v[196:199]
    ds_read_b64_tr_b16 v[96:97], v54 offset:16384
    s_waitcnt lgkmcnt(13)
    v_mfma_f32_16x16x32_bf16 v[204:207], v[100:103], v[92:95], v[204:207]
    ds_read_b64_tr_b16 v[98:99], v54 offset:17408
    v_mfma_f32_16x16x32_bf16 v[200:203], v[100:103], v[88:91], v[200:203]
    ds_read_b64_tr_b16 v[100:101], v55 offset:16384
    s_waitcnt lgkmcnt(13)
    v_mfma_f32_16x16x32_bf16 v[208:211], v[104:107], v[88:91], v[208:211]
    ds_read_b64_tr_b16 v[102:103], v55 offset:17408
    v_mfma_f32_16x16x32_bf16 v[212:215], v[104:107], v[92:95], v[212:215]
    ds_read_b64_tr_b16 v[104:105], v56 offset:16384
    s_waitcnt lgkmcnt(13)
    v_mfma_f32_16x16x32_bf16 v[220:223], v[108:111], v[92:95], v[220:223]
    ds_read_b64_tr_b16 v[106:107], v56 offset:17408
    v_mfma_f32_16x16x32_bf16 v[216:219], v[108:111], v[88:91], v[216:219]
    ds_read_b64_tr_b16 v[108:109], v57 offset:16384
    s_waitcnt lgkmcnt(13)
    v_mfma_f32_16x16x32_bf16 v[224:227], v[112:115], v[88:91], v[224:227]
    ds_read_b64_tr_b16 v[110:111], v57 offset:17408
    v_mfma_f32_16x16x32_bf16 v[228:231], v[112:115], v[92:95], v[228:231]
    ds_read_b64_tr_b16 v[112:113], v58 offset:16384
    s_waitcnt lgkmcnt(13)
    v_mfma_f32_16x16x32_bf16 v[236:239], v[116:119], v[92:95], v[236:239]
    ds_read_b64_tr_b16 v[114:115], v58 offset:17408
    v_mfma_f32_16x16x32_bf16 v[232:235], v[116:119], v[88:91], v[232:235]
    ds_read_b64_tr_b16 v[116:117], v59 offset:16384
    s_waitcnt lgkmcnt(13)
    v_mfma_f32_16x16x32_bf16 v[240:243], v[120:123], v[88:91], v[240:243]
    ds_read_b64_tr_b16 v[118:119], v59 offset:17408
    v_mfma_f32_16x16x32_bf16 v[244:247], v[120:123], v[92:95], v[244:247]
    ds_read_b64_tr_b16 v[120:121], v60 offset:16384
    s_waitcnt lgkmcnt(13)
    v_mfma_f32_16x16x32_bf16 v[252:255], v[124:127], v[92:95], v[252:255]
    ds_read_b64_tr_b16 v[122:123], v60 offset:17408
    v_mfma_f32_16x16x32_bf16 v[248:251], v[124:127], v[88:91], v[248:251]
    ds_read_b64_tr_b16 v[124:125], v61 offset:16384
    ds_read_b64_tr_b16 v[126:127], v61 offset:17408
    s_waitcnt vmcnt(10)
    s_waitcnt lgkmcnt(14)
    v_mfma_f32_16x16x32_bf16 v[192:195], v[96:99], v[16:19], v[192:195]
    v_mfma_f32_16x16x32_bf16 v[196:199], v[96:99], v[20:23], v[196:199]
    ds_read_b64_tr_b16 v[96:97], v54 offset:24576
    s_waitcnt lgkmcnt(13)
    v_mfma_f32_16x16x32_bf16 v[204:207], v[100:103], v[20:23], v[204:207]
    ds_read_b64_tr_b16 v[98:99], v54 offset:25600
    v_mfma_f32_16x16x32_bf16 v[200:203], v[100:103], v[16:19], v[200:203]
    ds_read_b64_tr_b16 v[100:101], v55 offset:24576
    s_waitcnt lgkmcnt(13)
    v_mfma_f32_16x16x32_bf16 v[208:211], v[104:107], v[16:19], v[208:211]
    ds_read_b64_tr_b16 v[102:103], v55 offset:25600
    v_mfma_f32_16x16x32_bf16 v[212:215], v[104:107], v[20:23], v[212:215]
    ds_read_b64_tr_b16 v[104:105], v56 offset:24576
    s_waitcnt lgkmcnt(13)
    v_mfma_f32_16x16x32_bf16 v[220:223], v[108:111], v[20:23], v[220:223]
    ds_read_b64_tr_b16 v[106:107], v56 offset:25600
    v_mfma_f32_16x16x32_bf16 v[216:219], v[108:111], v[16:19], v[216:219]
    ds_read_b64_tr_b16 v[108:109], v57 offset:24576
    s_waitcnt lgkmcnt(13)
    v_mfma_f32_16x16x32_bf16 v[224:227], v[112:115], v[16:19], v[224:227]
    ds_read_b64_tr_b16 v[110:111], v57 offset:25600
    v_mfma_f32_16x16x32_bf16 v[228:231], v[112:115], v[20:23], v[228:231]
    ds_read_b64_tr_b16 v[112:113], v58 offset:24576
    s_waitcnt lgkmcnt(13)
    v_mfma_f32_16x16x32_bf16 v[236:239], v[116:119], v[20:23], v[236:239]
    ds_read_b64_tr_b16 v[114:115], v58 offset:25600
    v_mfma_f32_16x16x32_bf16 v[232:235], v[116:119], v[16:19], v[232:235]
    ds_read_b64_tr_b16 v[116:117], v59 offset:24576
    s_waitcnt lgkmcnt(13)
    v_mfma_f32_16x16x32_bf16 v[240:243], v[120:123], v[16:19], v[240:243]
    ds_read_b64_tr_b16 v[118:119], v59 offset:25600
    v_mfma_f32_16x16x32_bf16 v[244:247], v[120:123], v[20:23], v[244:247]
    ds_read_b64_tr_b16 v[120:121], v60 offset:24576
    s_waitcnt lgkmcnt(13)
    v_mfma_f32_16x16x32_bf16 v[252:255], v[124:127], v[20:23], v[252:255]
    ds_read_b64_tr_b16 v[122:123], v60 offset:25600
    v_mfma_f32_16x16x32_bf16 v[248:251], v[124:127], v[16:19], v[248:251]
    ds_read_b64_tr_b16 v[124:125], v61 offset:24576
    ds_read_b64_tr_b16 v[126:127], v61 offset:25600
    s_waitcnt vmcnt(8)
    s_waitcnt lgkmcnt(14)
    v_mfma_f32_16x16x32_bf16 v[192:195], v[96:99], v[24:27], v[192:195]
    v_mfma_f32_16x16x32_bf16 v[196:199], v[96:99], v[28:31], v[196:199]
    ds_read_b64_tr_b16 v[96:97], v54 offset:32768
    s_waitcnt lgkmcnt(13)
    v_mfma_f32_16x16x32_bf16 v[204:207], v[100:103], v[28:31], v[204:207]
    ds_read_b64_tr_b16 v[98:99], v54 offset:33792
    v_mfma_f32_16x16x32_bf16 v[200:203], v[100:103], v[24:27], v[200:203]
    ds_read_b64_tr_b16 v[100:101], v55 offset:32768
    s_waitcnt lgkmcnt(13)
    v_mfma_f32_16x16x32_bf16 v[208:211], v[104:107], v[24:27], v[208:211]
    ds_read_b64_tr_b16 v[102:103], v55 offset:33792
    v_mfma_f32_16x16x32_bf16 v[212:215], v[104:107], v[28:31], v[212:215]
    ds_read_b64_tr_b16 v[104:105], v56 offset:32768
    s_waitcnt lgkmcnt(13)
    v_mfma_f32_16x16x32_bf16 v[220:223], v[108:111], v[28:31], v[220:223]
    ds_read_b64_tr_b16 v[106:107], v56 offset:33792
    v_mfma_f32_16x16x32_bf16 v[216:219], v[108:111], v[24:27], v[216:219]
    ds_read_b64_tr_b16 v[108:109], v57 offset:32768
    s_waitcnt lgkmcnt(13)
    v_mfma_f32_16x16x32_bf16 v[224:227], v[112:115], v[24:27], v[224:227]
    ds_read_b64_tr_b16 v[110:111], v57 offset:33792
    v_mfma_f32_16x16x32_bf16 v[228:231], v[112:115], v[28:31], v[228:231]
    ds_read_b64_tr_b16 v[112:113], v58 offset:32768
    s_waitcnt lgkmcnt(13)
    v_mfma_f32_16x16x32_bf16 v[236:239], v[116:119], v[28:31], v[236:239]
    ds_read_b64_tr_b16 v[114:115], v58 offset:33792
    v_mfma_f32_16x16x32_bf16 v[232:235], v[116:119], v[24:27], v[232:235]
    ds_read_b64_tr_b16 v[116:117], v59 offset:32768
    s_waitcnt lgkmcnt(13)
    v_mfma_f32_16x16x32_bf16 v[240:243], v[120:123], v[24:27], v[240:243]
    ds_read_b64_tr_b16 v[118:119], v59 offset:33792
    v_mfma_f32_16x16x32_bf16 v[244:247], v[120:123], v[28:31], v[244:247]
    ds_read_b64_tr_b16 v[120:121], v60 offset:32768
    s_waitcnt lgkmcnt(13)
    v_mfma_f32_16x16x32_bf16 v[252:255], v[124:127], v[28:31], v[252:255]
    ds_read_b64_tr_b16 v[122:123], v60 offset:33792
    v_mfma_f32_16x16x32_bf16 v[248:251], v[124:127], v[24:27], v[248:251]
    ds_read_b64_tr_b16 v[124:125], v61 offset:32768
    ds_read_b64_tr_b16 v[126:127], v61 offset:33792
    s_waitcnt vmcnt(0)
    s_cmp_ge_u32 s3, 4
    s_cbranch_scc1 L_q_nold
    s_lshl_b32 s7, s4, 10
    s_add_u32 s7, s7, 3866624
    v_lshrrev_b32 v2, 3, v1
    v_and_b32 v3, 7, v1
    v_lshlrev_b32 v3, 2, v3
    v_lshl_add_u32 v3, v2, 7, v3
    s_mov_b32 s79, 262144
L_poll_7:
    buffer_load_dword v2, v3, s[8:11], s7 offen sc1
    s_waitcnt vmcnt(0)
    v_cmp_gt_u32 vcc, 1, v2
    s_cbranch_vccz L_polldone_8
    s_sleep 2
    s_sub_u32 s79, s79, 1
    s_cmp_lg_u32 s79, 0
    s_cbranch_scc1 L_poll_7
L_polldone_8:
    s_lshl_b32 s6, s76, 13
    s_add_u32 s6, s6, s78
    s_add_u32 m0, s6, 0
    s_add_u32 s7, s77, 0
    buffer_load_dwordx4 v49, s[8:11], s7 offen offset:0 sc1 lds
    buffer_load_dwordx4 v49, s[8:11], s7 offen offset:1024 sc1 lds
    buffer_load_dwordx4 v49, s[8:11], s7 offen offset:2048 sc1 lds
    buffer_load_dwordx4 v49, s[8:11], s7 offen offset:3072 sc1 lds
    s_lshl_b32 s6, s76, 13
    s_add_u32 s6, s6, s78
    s_add_u32 m0, s6, 4096
    s_add_u32 s7, s77, 4096
    buffer_load_dwordx4 v49, s[8:11], s7 offen offset:0 sc1 lds
    buffer_load_dwordx4 v49, s[8:11], s7 offen offset:1024 sc1 lds
    buffer_load_dwordx4 v49, s[8:11], s7 offen offset:2048 sc1 lds
    buffer_load_dwordx4 v49, s[8:11], s7 offen offset:3072 sc1 lds
    s_lshl_b32 s6, s76, 12
    s_add_u32 s6, s6, s78
    s_add_u32 m0, s6, 49152
    s_add_u32 s7, s77, 524288
    buffer_load_dwordx4 v50, s[8:11], s7 offen offset:0 sc1 lds
    buffer_load_dwordx4 v50, s[8:11], s7 offen offset:1024 sc1 lds
    buffer_load_dwordx4 v50, s[8:11], s7 offen offset:2048 sc1 lds
    buffer_load_dwordx4 v50, s[8:11], s7 offen offset:3072 sc1 lds
L_q_nold:
    s_waitcnt lgkmcnt(14)
    v_mfma_f32_16x16x32_bf16 v[192:195], v[96:99], v[32:35], v[192:195]
    v_mfma_f32_16x16x32_bf16 v[196:199], v[96:99], v[36:39], v[196:199]
    ds_read_b64_tr_b16 v[96:97], v54 offset:40960
    s_waitcnt lgkmcnt(13)
    v_mfma_f32_16x16x32_bf16 v[204:207], v[100:103], v[36:39], v[204:207]
    ds_read_b64_tr_b16 v[98:99], v54 offset:41984
    v_mfma_f32_16x16x32_bf16 v[200:203], v[100:103], v[32:35], v[200:203]
    ds_read_b64_tr_b16 v[100:101], v55 offset:40960
    s_waitcnt lgkmcnt(13)
    v_mfma_f32_16x16x32_bf16 v[208:211], v[104:107], v[32:35], v[208:211]
    ds_read_b64_tr_b16 v[102:103], v55 offset:41984
    v_mfma_f32_16x16x32_bf16 v[212:215], v[104:107], v[36:39], v[212:215]
    ds_read_b64_tr_b16 v[104:105], v56 offset:40960
    s_waitcnt lgkmcnt(13)
    v_mfma_f32_16x16x32_bf16 v[220:223], v[108:111], v[36:39], v[220:223]
    ds_read_b64_tr_b16 v[106:107], v56 offset:41984
    buffer_store_dwordx4 v[144:147], v13, s[8:11], s67 offen sc1
    s_add_u32 s67, s67, 1024
    v_mfma_f32_16x16x32_bf16 v[216:219], v[108:111], v[32:35], v[216:219]
    ds_read_b64_tr_b16 v[108:109], v57 offset:40960
    s_waitcnt lgkmcnt(13)
    v_mfma_f32_16x16x32_bf16 v[224:227], v[112:115], v[32:35], v[224:227]
    ds_read_b64_tr_b16 v[110:111], v57 offset:41984
    v_mfma_f32_16x16x32_bf16 v[228:231], v[112:115], v[36:39], v[228:231]
    ds_read_b64_tr_b16 v[112:113], v58 offset:40960
    s_waitcnt lgkmcnt(13)
    v_mfma_f32_16x16x32_bf16 v[236:239], v[116:119], v[36:39], v[236:239]
    ds_read_b64_tr_b16 v[114:115], v58 offset:41984
    v_mfma_f32_16x16x32_bf16 v[232:235], v[116:119], v[32:35], v[232:235]
    ds_read_b64_tr_b16 v[116:117], v59 offset:40960
    s_waitcnt lgkmcnt(13)
    v_mfma_f32_16x16x32_bf16 v[240:243], v[120:123], v[32:35], v[240:243]
    ds_read_b64_tr_b16 v[118:119], v59 offset:41984
    v_mfma_f32_16x16x32_bf16 v[244:247], v[120:123], v[36:39], v[244:247]
    ds_read_b64_tr_b16 v[120:121], v60 offset:40960
    s_waitcnt lgkmcnt(13)
    v_mfma_f32_16x16x32_bf16 v[252:255], v[124:127], v[36:39], v[252:255]
    ds_read_b64_tr_b16 v[122:123], v60 offset:41984
    v_mfma_f32_16x16x32_bf16 v[248:251], v[124:127], v[32:35], v[248:251]
    ds_read_b64_tr_b16 v[124:125], v61 offset:40960
    ds_read_b64_tr_b16 v[126:127], v61 offset:41984
    s_waitcnt lgkmcnt(14)
    v_mfma_f32_16x16x32_bf16 v[192:195], v[96:99], v[64:67], v[192:195]
    v_mfma_f32_16x16x32_bf16 v[196:199], v[96:99], v[68:71], v[196:199]
    ds_read_b64_tr_b16 v[96:97], v54 offset:49152
    s_waitcnt lgkmcnt(13)
    v_mfma_f32_16x16x32_bf16 v[204:207], v[100:103], v[68:71], v[204:207]
    ds_read_b64_tr_b16 v[98:99], v54 offset:50176
    v_mfma_f32_16x16x32_bf16 v[200:203], v[100:103], v[64:67], v[200:203]
    ds_read_b64_tr_b16 v[100:101], v55 offset:49152
    s_waitcnt lgkmcnt(13)
    v_mfma_f32_16x16x32_bf16 v[208:211], v[104:107], v[64:67], v[208:211]
    ds_read_b64_tr_b16 v[102:103], v55 offset:50176
    v_mfma_f32_16x16x32_bf16 v[212:215], v[104:107], v[68:71], v[212:215]
    ds_read_b64_tr_b16 v[104:105], v56 offset:49152
    s_waitcnt lgkmcnt(13)
    v_mfma_f32_16x16x32_bf16 v[220:223], v[108:111], v[68:71], v[220:223]
    ds_read_b64_tr_b16 v[106:107], v56 offset:50176
    buffer_store_dwordx4 v[148:151], v13, s[8:11], s67 offen sc1
    s_add_u32 s67, s67, s68
    v_mfma_f32_16x16x32_bf16 v[216:219], v[108:111], v[64:67], v[216:219]
    ds_read_b64_tr_b16 v[108:109], v57 offset:49152
    s_waitcnt lgkmcnt(13)
    v_mfma_f32_16x16x32_bf16 v[224:227], v[112:115], v[64:67], v[224:227]
    ds_read_b64_tr_b16 v[110:111], v57 offset:50176
    v_mfma_f32_16x16x32_bf16 v[228:231], v[112:115], v[68:71], v[228:231]
    ds_read_b64_tr_b16 v[112:113], v58 offset:49152
    s_waitcnt lgkmcnt(13)
    v_mfma_f32_16x16x32_bf16 v[236:239], v[116:119], v[68:71], v[236:239]
    ds_read_b64_tr_b16 v[114:115], v58 offset:50176
    v_mfma_f32_16x16x32_bf16 v[232:235], v[116:119], v[64:67], v[232:235]
    ds_read_b64_tr_b16 v[116:117], v59 offset:49152
    s_waitcnt lgkmcnt(13)
    v_mfma_f32_16x16x32_bf16 v[240:243], v[120:123], v[64:67], v[240:243]
    ds_read_b64_tr_b16 v[118:119], v59 offset:50176
    v_mfma_f32_16x16x32_bf16 v[244:247], v[120:123], v[68:71], v[244:247]
    ds_read_b64_tr_b16 v[120:121], v60 offset:49152
    s_waitcnt lgkmcnt(13)
    v_mfma_f32_16x16x32_bf16 v[252:255], v[124:127], v[68:71], v[252:255]
    ds_read_b64_tr_b16 v[122:123], v60 offset:50176
    v_mfma_f32_16x16x32_bf16 v[248:251], v[124:127], v[64:67], v[248:251]
    ds_read_b64_tr_b16 v[124:125], v61 offset:49152
    ds_read_b64_tr_b16 v[126:127], v61 offset:50176
    s_waitcnt lgkmcnt(14)
    v_mfma_f32_16x16x32_bf16 v[192:195], v[96:99], v[72:75], v[192:195]
    v_mfma_f32_16x16x32_bf16 v[196:199], v[96:99], v[76:79], v[196:199]
    ds_read_b64_tr_b16 v[96:97], v54 offset:57344
    s_waitcnt lgkmcnt(13)
    v_mfma_f32_16x16x32_bf16 v[204:207], v[100:103], v[76:79], v[204:207]
    ds_read_b64_tr_b16 v[98:99], v54 offset:58368
    v_mfma_f32_16x16x32_bf16 v[200:203], v[100:103], v[72:75], v[200:203]
    ds_read_b64_tr_b16 v[100:101], v55 offset:57344
    s_waitcnt lgkmcnt(13)
    v_mfma_f32_16x16x32_bf16 v[208:211], v[104:107], v[72:75], v[208:211]
    ds_read_b64_tr_b16 v[102:103], v55 offset:58368
    v_mfma_f32_16x16x32_bf16 v[212:215], v[104:107], v[76:79], v[212:215]
    ds_read_b64_tr_b16 v[104:105], v56 offset:57344
    s_waitcnt lgkmcnt(13)
    v_mfma_f32_16x16x32_bf16 v[220:223], v[108:111], v[76:79], v[220:223]
    ds_read_b64_tr_b16 v[106:107], v56 offset:58368
    buffer_store_dwordx4 v[152:155], v13, s[8:11], s67 offen sc1
    s_add_u32 s67, s67, 1024
    v_mfma_f32_16x16x32_bf16 v[216:219], v[108:111], v[72:75], v[216:219]
    ds_read_b64_tr_b16 v[108:109], v57 offset:57344
    s_waitcnt lgkmcnt(13)
    v_mfma_f32_16x16x32_bf16 v[224:227], v[112:115], v[72:75], v[224:227]
    ds_read_b64_tr_b16 v[110:111], v57 offset:58368
    v_mfma_f32_16x16x32_bf16 v[228:231], v[112:115], v[76:79], v[228:231]
    ds_read_b64_tr_b16 v[112:113], v58 offset:57344
    s_waitcnt lgkmcnt(13)
    v_mfma_f32_16x16x32_bf16 v[236:239], v[116:119], v[76:79], v[236:239]
    ds_read_b64_tr_b16 v[114:115], v58 offset:58368
    v_mfma_f32_16x16x32_bf16 v[232:235], v[116:119], v[72:75], v[232:235]
    ds_read_b64_tr_b16 v[116:117], v59 offset:57344
    s_waitcnt lgkmcnt(13)
    v_mfma_f32_16x16x32_bf16 v[240:243], v[120:123], v[72:75], v[240:243]
    ds_read_b64_tr_b16 v[118:119], v59 offset:58368
    v_mfma_f32_16x16x32_bf16 v[244:247], v[120:123], v[76:79], v[244:247]
    ds_read_b64_tr_b16 v[120:121], v60 offset:57344
    s_waitcnt lgkmcnt(13)
    v_mfma_f32_16x16x32_bf16 v[252:255], v[124:127], v[76:79], v[252:255]
    ds_read_b64_tr_b16 v[122:123], v60 offset:58368
    v_mfma_f32_16x16x32_bf16 v[248:251], v[124:127], v[72:75], v[248:251]
    ds_read_b64_tr_b16 v[124:125], v61 offset:57344
    ds_read_b64_tr_b16 v[126:127], v61 offset:58368
    s_waitcnt lgkmcnt(14)
    v_mfma_f32_16x16x32_bf16 v[192:195], v[96:99], v[80:83], v[192:195]
    v_mfma_f32_16x16x32_bf16 v[196:199], v[96:99], v[84:87], v[196:199]
    s_waitcnt lgkmcnt(12)
    v_mfma_f32_16x16x32_bf16 v[204:207], v[100:103], v[84:87], v[204:207]
    v_mfma_f32_16x16x32_bf16 v[200:203], v[100:103], v[80:83], v[200:203]
    s_waitcnt lgkmcnt(10)
    v_mfma_f32_16x16x32_bf16 v[208:211], v[104:107], v[80:83], v[208:211]
    v_mfma_f32_16x16x32_bf16 v[212:215], v[104:107], v[84:87], v[212:215]
    s_waitcnt lgkmcnt(8)
    v_mfma_f32_16x16x32_bf16 v[220:223], v[108:111], v[84:87], v[220:223]
    buffer_store_dwordx4 v[156:159], v13, s[8:11], s67 offen sc1
    s_add_u32 s67, s67, s69
    v_mfma_f32_16x16x32_bf16 v[216:219], v[108:111], v[80:83], v[216:219]
    s_waitcnt lgkmcnt(6)
    v_mfma_f32_16x16x32_bf16 v[224:227], v[112:115], v[80:83], v[224:227]
    v_mfma_f32_16x16x32_bf16 v[228:231], v[112:115], v[84:87], v[228:231]
    s_waitcnt lgkmcnt(4)
    v_mfma_f32_16x16x32_bf16 v[236:239], v[116:119], v[84:87], v[236:239]
    v_mfma_f32_16x16x32_bf16 v[232:235], v[116:119], v[80:83], v[232:235]
    s_waitcnt lgkmcnt(2)
    v_mfma_f32_16x16x32_bf16 v[240:243], v[120:123], v[80:83], v[240:243]
    v_mfma_f32_16x16x32_bf16 v[244:247], v[120:123], v[84:87], v[244:247]
    s_waitcnt lgkmcnt(0)
    v_mfma_f32_16x16x32_bf16 v[252:255], v[124:127], v[84:87], v[252:255]
    v_mfma_f32_16x16x32_bf16 v[248:251], v[124:127], v[80:83], v[248:251]
    s_cmp_lt_u32 s3, 4
    s_cbranch_scc1 L_qb
    s_barrier
L_qb:
    s_mov_b32 s6, 0x3e0293ee
    s_nop 7
    buffer_store_dwordx4 v[160:163], v13, s[8:11], s67 offen sc1
    s_add_u32 s67, s67, 1024
    buffer_store_dwordx4 v[164:167], v13, s[8:11], s67 offen sc1
    s_add_u32 s67, s67, s68
    buffer_store_dwordx4 v[168:171], v13, s[8:11], s67 offen sc1
    s_add_u32 s67, s67, 1024
    buffer_store_dwordx4 v[172:175], v13, s[8:11], s67 offen sc1
    s_add_u32 s67, s67, s69
    v_mul_f32 v192, s6, v192
    v_mul_f32 v193, s6, v193
    v_mul_f32 v194, s6, v194
    v_mul_f32 v195, s6, v195
    v_cvt_pk_bf16_f32 v16, v192, v193
    v_cvt_pk_bf16_f32 v17, v194, v195
    v_mul_f32 v200, s6, v200
    v_mul_f32 v201, s6, v201
    v_mul_f32 v202, s6, v202
    v_mul_f32 v203, s6, v203
    v_cvt_pk_bf16_f32 v18, v200, v201
    v_cvt_pk_bf16_f32 v19, v202, v203
    v_mul_f32 v208, s6, v208
    v_mul_f32 v209, s6, v209
    v_mul_f32 v210, s6, v210
    v_mul_f32 v211, s6, v211
    v_cvt_pk_bf16_f32 v20, v208, v209
    v_cvt_pk_bf16_f32 v21, v210, v211
    v_mul_f32 v216, s6, v216
    v_mul_f32 v217, s6, v217
    v_mul_f32 v218, s6, v218
    v_mul_f32 v219, s6, v219
    v_cvt_pk_bf16_f32 v22, v216, v217
    v_cvt_pk_bf16_f32 v23, v218, v219
    v_mul_f32 v224, s6, v224
    v_mul_f32 v225, s6, v225
    v_mul_f32 v226, s6, v226
    v_mul_f32 v227, s6, v227
    v_cvt_pk_bf16_f32 v24, v224, v225
    v_cvt_pk_bf16_f32 v25, v226, v227
    v_mul_f32 v232, s6, v232
    v_mul_f32 v233, s6, v233
    v_mul_f32 v234, s6, v234
    v_mul_f32 v235, s6, v235
    v_cvt_pk_bf16_f32 v26, v232, v233
    v_cvt_pk_bf16_f32 v27, v234, v235
    v_mul_f32 v240, s6, v240
    v_mul_f32 v241, s6, v241
    v_mul_f32 v242, s6, v242
    v_mul_f32 v243, s6, v243
    v_cvt_pk_bf16_f32 v28, v240, v241
    v_cvt_pk_bf16_f32 v29, v242, v243
    v_mul_f32 v248, s6, v248
    v_mul_f32 v249, s6, v249
    v_mul_f32 v250, s6, v250
    v_mul_f32 v251, s6, v251
    v_cvt_pk_bf16_f32 v30, v248, v249
    v_cvt_pk_bf16_f32 v31, v250, v251
    v_mul_f32 v196, s6, v196
    v_mul_f32 v197, s6, v197
    v_mul_f32 v198, s6, v198
    v_mul_f32 v199, s6, v199
    v_cvt_pk_bf16_f32 v32, v196, v197
    v_cvt_pk_bf16_f32 v33, v198, v199
    v_mul_f32 v204, s6, v204
    v_mul_f32 v205, s6, v205
    v_mul_f32 v206, s6, v206
    v_mul_f32 v207, s6, v207
    v_cvt_pk_bf16_f32 v34, v204, v205
    v_cvt_pk_bf16_f32 v35, v206, v207
    v_mul_f32 v212, s6, v212
    v_mul_f32 v213, s6, v213
    v_mul_f32 v214, s6, v214
    v_mul_f32 v215, s6, v215
    v_cvt_pk_bf16_f32 v36, v212, v213
    v_cvt_pk_bf16_f32 v37, v214, v215
    v_mul_f32 v220, s6, v220
    v_mul_f32 v221, s6, v221
    v_mul_f32 v222, s6, v222
    v_mul_f32 v223, s6, v223
    v_cvt_pk_bf16_f32 v38, v220, v221
    v_cvt_pk_bf16_f32 v39, v222, v223
    v_mul_f32 v228, s6, v228
    v_mul_f32 v229, s6, v229
    v_mul_f32 v230, s6, v230
    v_mul_f32 v231, s6, v231
    v_cvt_pk_bf16_f32 v40, v228, v229
    v_cvt_pk_bf16_f32 v41, v230, v231
    v_mul_f32 v236, s6, v236
    v_mul_f32 v237, s6, v237
    v_mul_f32 v238, s6, v238
    v_mul_f32 v239, s6, v239
    v_cvt_pk_bf16_f32 v42, v236, v237
    v_cvt_pk_bf16_f32 v43, v238, v239
    v_mul_f32 v244, s6, v244
    v_mul_f32 v245, s6, v245
    v_mul_f32 v246, s6, v246
    v_mul_f32 v247, s6, v247
    v_cvt_pk_bf16_f32 v44, v244, v245
    v_cvt_pk_bf16_f32 v45, v246, v247
    v_mul_f32 v252, s6, v252
    v_mul_f32 v253, s6, v253
    v_mul_f32 v254, s6, v254
    v_mul_f32 v255, s6, v255
    v_cvt_pk_bf16_f32 v46, v252, v253
    v_cvt_pk_bf16_f32 v47, v254, v255
    v_mov_b64 v[192:193], 0
    v_mov_b64 v[194:195], 0
    v_mov_b64 v[196:197], 0
    v_mov_b64 v[198:199], 0
    v_mov_b64 v[200:201], 0
    v_mov_b64 v[202:203], 0
    v_mov_b64 v[204:205], 0
    v_mov_b64 v[206:207], 0
    v_mov_b64 v[208:209], 0
    v_mov_b64 v[210:211], 0
    v_mov_b64 v[212:213], 0
    v_mov_b64 v[214:215], 0
    v_mov_b64 v[216:217], 0
    v_mov_b64 v[218:219], 0
    v_mov_b64 v[220:221], 0
    v_mov_b64 v[222:223], 0
    v_mov_b64 v[224:225], 0
    v_mov_b64 v[226:227], 0
    v_mov_b64 v[228:229], 0
    v_mov_b64 v[230:231], 0
    v_mov_b64 v[232:233], 0
    v_mov_b64 v[234:235], 0
    v_mov_b64 v[236:237], 0
    v_mov_b64 v[238:239], 0
    v_mov_b64 v[240:241], 0
    v_mov_b64 v[242:243], 0
    v_mov_b64 v[244:245], 0
    v_mov_b64 v[246:247], 0
    v_mov_b64 v[248:249], 0
    v_mov_b64 v[250:251], 0
    v_mov_b64 v[252:253], 0
    v_mov_b64 v[254:255], 0
    v_mov_b64 v[144:145], 0
    v_mov_b64 v[146:147], 0
    v_mov_b64 v[148:149], 0
    v_mov_b64 v[150:151], 0
    v_mov_b64 v[152:153], 0
    v_mov_b64 v[154:155], 0
    v_mov_b64 v[156:157], 0
    v_mov_b64 v[158:159], 0
    v_mov_b64 v[160:161], 0
    v_mov_b64 v[162:163], 0
    v_bfe_u32 v2, v1, 1, 1
    v_lshrrev_b32 v3, 5, v1
    v_cmp_eq_u32 vcc, v2, v3
    v_mov_b32 v2, 0x3f803f80
    v_and_b32 v3, 1, v1
    v_mul_u32_u24 v3, 0xaaaa, v3
    v_add_u32 v168, 0x4444, v3
    v_cndmask_b32 v164, 0, v2, vcc
    v_cndmask_b32 v165, 0, v2, vcc
    v_cndmask_b32 v166, 0, v2, vcc
    v_cndmask_b32 v167, 0, v2, vcc
    v_add_u32 v48, s100, v13
    s_waitcnt vmcnt(8)
    s_mov_b32 s72, 0x40004000
    s_mov_b32 s65, 0
    s_sub_u32 s63, 15, s5
    s_mov_b32 s62, -1
    s_cmp_ge_u32 s3, 4
    s_cbranch_scc1 L_qb2
    s_barrier
L_qb2:
    ds_read_b128 v[96:99], v48 offset:0
    ds_read_b128 v[100:103], v48 offset:1024
    ds_read_b128 v[104:107], v48 offset:2048
    ds_read_b128 v[108:111], v48 offset:3072
    ds_read_b128 v[112:115], v48 offset:4096
    ds_read_b128 v[116:119], v48 offset:5120
    ds_read_b128 v[120:123], v48 offset:6144
    ds_read_b128 v[124:127], v48 offset:7168
    s_cmp_lg_u32 s60, 0
    s_cbranch_scc1 L_nm0
    s_call_b64 s[82:83], L_mask
L_nm0:
    s_waitcnt lgkmcnt(7)
    v_mfma_f32_16x16x32_bf16 v[64:67], v[96:99], v[16:19], v[144:147]
    v_mfma_f32_16x16x32_bf16 v[68:71], v[96:99], v[32:35], v[148:151]
    ds_read_b128 v[96:99], v48 offset:8192
    s_waitcnt lgkmcnt(7)
    v_mfma_f32_16x16x32_bf16 v[64:67], v[100:103], v[20:23], v[64:67]
    v_mfma_f32_16x16x32_bf16 v[68:71], v[100:103], v[36:39], v[68:71]
    ds_read_b128 v[100:103], v48 offset:9216
    s_waitcnt lgkmcnt(7)
    v_mfma_f32_16x16x32_bf16 v[64:67], v[104:107], v[24:27], v[64:67]
    v_mfma_f32_16x16x32_bf16 v[68:71], v[104:107], v[40:43], v[68:71]
    ds_read_b128 v[104:107], v48 offset:10240
    s_waitcnt lgkmcnt(7)
    v_mfma_f32_16x16x32_bf16 v[64:67], v[108:111], v[28:31], v[64:67]
    v_mfma_f32_16x16x32_bf16 v[68:71], v[108:111], v[44:47], v[68:71]
    ds_read_b128 v[108:111], v48 offset:11264
    s_waitcnt lgkmcnt(7)
    v_mfma_f32_16x16x32_bf16 v[72:75], v[112:115], v[16:19], v[152:155]
    v_mfma_f32_16x16x32_bf16 v[76:79], v[112:115], v[32:35], v[156:159]
    ds_read_b128 v[112:115], v48 offset:12288
    s_waitcnt lgkmcnt(7)
    v_mfma_f32_16x16x32_bf16 v[72:75], v[116:119], v[20:23], v[72:75]
    v_mfma_f32_16x16x32_bf16 v[76:79], v[116:119], v[36:39], v[76:79]
    ds_read_b128 v[116:119], v48 offset:13312
    s_waitcnt lgkmcnt(7)
    v_mfma_f32_16x16x32_bf16 v[72:75], v[120:123], v[24:27], v[72:75]
    v_mfma_f32_16x16x32_bf16 v[76:79], v[120:123], v[40:43], v[76:79]
    ds_read_b128 v[120:123], v48 offset:14336
    s_waitcnt lgkmcnt(7)
    v_mfma_f32_16x16x32_bf16 v[72:75], v[124:127], v[28:31], v[72:75]
    v_mfma_f32_16x16x32_bf16 v[76:79], v[124:127], v[44:47], v[76:79]
    ds_read_b128 v[124:127], v48 offset:15360
    s_nop 7
    v_max3_f32 v58, v64, v65, v66
    v_max3_f32 v58, v58, v67, v72
    v_max3_f32 v58, v58, v73, v74
    v_max_f32 v58, v58, v75
    v_mov_b32 v60, v58
    s_nop 1
    v_permlane16_swap_b32 v58, v60
    s_nop 1
    v_max_f32 v58, v58, v60
    v_mov_b32 v60, v58
    s_nop 1
    v_permlane32_swap_b32 v58, v60
    s_nop 1
    v_max_f32 v58, v58, v60
    v_add_f32 v58, 0x41c00000, v58
    v_sub_f32 v64, v64, v58
    v_sub_f32 v144, 0, v58
    v_sub_f32 v65, v65, v58
    v_sub_f32 v145, 0, v58
    v_sub_f32 v66, v66, v58
    v_sub_f32 v146, 0, v58
    v_sub_f32 v67, v67, v58
    v_sub_f32 v147, 0, v58
    v_sub_f32 v72, v72, v58
    v_sub_f32 v152, 0, v58
    v_sub_f32 v73, v73, v58
    v_sub_f32 v153, 0, v58
    v_sub_f32 v74, v74, v58
    v_sub_f32 v154, 0, v58
    v_sub_f32 v75, v75, v58
    v_sub_f32 v155, 0, v58
    v_max3_f32 v59, v68, v69, v70
    v_max3_f32 v59, v59, v71, v76
    v_max3_f32 v59, v59, v77, v78
    v_max_f32 v59, v59, v79
    v_mov_b32 v60, v59
    s_nop 1
    v_permlane16_swap_b32 v59, v60
    s_nop 1
    v_max_f32 v59, v59, v60
    v_mov_b32 v60, v59
    s_nop 1
    v_permlane32_swap_b32 v59, v60
    s_nop 1
    v_max_f32 v59, v59, v60
    v_add_f32 v59, 0x41c00000, v59
    v_sub_f32 v68, v68, v59
    v_sub_f32 v148, 0, v59
    v_sub_f32 v69, v69, v59
    v_sub_f32 v149, 0, v59
    v_sub_f32 v70, v70, v59
    v_sub_f32 v150, 0, v59
    v_sub_f32 v71, v71, v59
    v_sub_f32 v151, 0, v59
    v_sub_f32 v76, v76, v59
    v_sub_f32 v156, 0, v59
    v_sub_f32 v77, v77, v59
    v_sub_f32 v157, 0, v59
    v_sub_f32 v78, v78, v59
    v_sub_f32 v158, 0, v59
    v_sub_f32 v79, v79, v59
    v_sub_f32 v159, 0, v59
    s_cmp_lg_u32 s60, 1
    s_cbranch_scc1 L_nm1
    s_call_b64 s[82:83], L_mask
L_nm1:
    v_exp_f32 v58, v64
    v_exp_f32 v59, v65
    s_waitcnt lgkmcnt(7)
    v_mfma_f32_16x16x32_bf16 v[80:83], v[96:99], v[16:19], v[144:147]
    s_waitcnt lgkmcnt(6)
    v_exp_f32 v60, v66
    v_exp_f32 v61, v67
    v_mfma_f32_16x16x32_bf16 v[84:87], v[96:99], v[32:35], v[148:151]
    ds_read_b128 v[96:99], v48 offset:49152
    v_cvt_pk_bf16_f32 v128, v58, v59
    v_cvt_pk_bf16_f32 v129, v60, v61
    v_mfma_f32_16x16x32_bf16 v[84:87], v[100:103], v[36:39], v[84:87]
    s_waitcnt lgkmcnt(6)
    v_exp_f32 v58, v68
    v_exp_f32 v59, v69
    v_mfma_f32_16x16x32_bf16 v[80:83], v[100:103], v[20:23], v[80:83]
    ds_read_b128 v[100:103], v48 offset:50176
    v_cvt_pk_bf16_f32 v132, v58, v59
    v_mfma_f32_16x16x32_bf16 v[80:83], v[104:107], v[24:27], v[80:83]
    s_waitcnt lgkmcnt(6)
    v_exp_f32 v60, v70
    v_exp_f32 v61, v71
    v_mfma_f32_16x16x32_bf16 v[84:87], v[104:107], v[40:43], v[84:87]
    ds_read_b128 v[104:107], v48 offset:51200
    v_cvt_pk_bf16_f32 v133, v60, v61
    v_mfma_f32_16x16x32_bf16 v[84:87], v[108:111], v[44:47], v[84:87]
    s_waitcnt lgkmcnt(6)
    v_exp_f32 v58, v72
    v_exp_f32 v59, v73
    v_mfma_f32_16x16x32_bf16 v[80:83], v[108:111], v[28:31], v[80:83]
    ds_read_b128 v[108:111], v48 offset:52224
    v_cvt_pk_bf16_f32 v130, v58, v59
    v_mfma_f32_16x16x32_bf16 v[88:91], v[112:115], v[16:19], v[152:155]
    s_waitcnt lgkmcnt(6)
    v_exp_f32 v60, v74
    v_exp_f32 v61, v75
    v_mfma_f32_16x16x32_bf16 v[92:95], v[112:115], v[32:35], v[156:159]
    ds_read_b128 v[112:115], v48 offset:53248
    v_cvt_pk_bf16_f32 v131, v60, v61
    v_mfma_f32_16x16x32_bf16 v[92:95], v[116:119], v[36:39], v[92:95]
    s_waitcnt lgkmcnt(6)
    v_exp_f32 v58, v76
    v_exp_f32 v59, v77
    v_mfma_f32_16x16x32_bf16 v[88:91], v[116:119], v[20:23], v[88:91]
    ds_read_b128 v[116:119], v48 offset:54272
    v_cvt_pk_bf16_f32 v134, v58, v59
    v_mfma_f32_16x16x32_bf16 v[88:91], v[120:123], v[24:27], v[88:91]
    s_waitcnt lgkmcnt(6)
    v_exp_f32 v60, v78
    v_exp_f32 v61, v79
    v_mfma_f32_16x16x32_bf16 v[92:95], v[120:123], v[40:43], v[92:95]
    ds_read_b128 v[120:123], v48 offset:55296
    v_cvt_pk_bf16_f32 v135, v60, v61
    v_mfma_f32_16x16x32_bf16 v[92:95], v[124:127], v[44:47], v[92:95]
    s_waitcnt lgkmcnt(6)
    v_or3_b32 v62, v128, v129, v132
    v_or3_b32 v62, v62, v133, v130
    v_or3_b32 v62, v62, v131, v134
    v_bitop3_b32 v62, v62, v135, s72 bitop3:0xa8
    v_cmp_ne_u32 vcc, s65, v62
    v_mfma_f32_16x16x32_bf16 v[88:91], v[124:127], v[28:31], v[88:91]
    ds_read_b128 v[124:127], v48 offset:56320
    s_cbranch_vccnz L_back_9_h
L_back_9:
    s_nop 7
    v_exp_f32 v58, v80
    v_exp_f32 v59, v81
    s_call_b64 s[82:83], L_load
    s_mov_b32 s62, 0
    buffer_store_dwordx4 v[176:179], v13, s[8:11], s67 offen sc1
    s_add_u32 s67, s67, 1024
    buffer_store_dwordx4 v[180:183], v13, s[8:11], s67 offen sc1
    s_add_u32 s67, s67, s68
    buffer_store_dwordx4 v[184:187], v13, s[8:11], s67 offen sc1
    s_add_u32 s67, s67, 1024
    buffer_store_dwordx4 v[188:191], v13, s[8:11], s67 offen sc1
    s_add_u32 s67, s67, s69
    s_sub_i32 s64, s60, 2
    s_cmp_eq_u32 s60, 0
    s_cbranch_scc1 L_pv2
    s_cmp_eq_u32 s60, 1
    s_cbranch_scc1 L_tail2
    s_cmp_lg_u32 s60, 2
    s_cbranch_scc1 L_st2
    s_call_b64 s[82:83], L_mask
    s_branch L_st2
.p2align 6
L_st0:
    v_mfma_f32_16x16x32_bf16 v[192:195], v[96:99], v[128:131], v[192:195]
    s_waitcnt lgkmcnt(6)
    v_exp_f32 v60, v82
    v_mfma_f32_16x16x32_bf16 v[196:199], v[96:99], v[132:135], v[196:199]
    ds_read_b128 v[96:99], v48 offset:0
    v_cvt_pk_bf16_f32 v136, v58, v59
    v_mfma_f32_16x16x32_bf16 v[204:207], v[100:103], v[132:135], v[204:207]
    s_waitcnt lgkmcnt(6)
    v_exp_f32 v61, v83
    v_mfma_f32_16x16x32_bf16 v[200:203], v[100:103], v[128:131], v[200:203]
    s_sub_i32 s64, s64, 1
    ds_read_b128 v[100:103], v48 offset:1024
    v_cvt_pk_bf16_f32 v137, v60, v61
    v_mfma_f32_16x16x32_bf16 v[208:211], v[104:107], v[128:131], v[208:211]
    s_waitcnt lgkmcnt(6)
    v_exp_f32 v58, v84
    v_mfma_f32_16x16x32_bf16 v[212:215], v[104:107], v[132:135], v[212:215]
    ds_read_b128 v[104:107], v48 offset:2048
    v_mfma_f32_16x16x32_bf16 v[220:223], v[108:111], v[132:135], v[220:223]
    s_waitcnt lgkmcnt(6)
    v_exp_f32 v59, v85
    v_mfma_f32_16x16x32_bf16 v[216:219], v[108:111], v[128:131], v[216:219]
    s_cmp_gt_i32 s64, 0
    ds_read_b128 v[108:111], v48 offset:3072
    v_cvt_pk_bf16_f32 v140, v58, v59
    v_mfma_f32_16x16x32_bf16 v[224:227], v[112:115], v[128:131], v[224:227]
    s_waitcnt lgkmcnt(6)
    v_exp_f32 v60, v86
    v_mfma_f32_16x16x32_bf16 v[228:231], v[112:115], v[132:135], v[228:231]
    ds_read_b128 v[112:115], v48 offset:4096
    v_or3_b32 v62, v136, v137, v140
    v_mfma_f32_16x16x32_bf16 v[236:239], v[116:119], v[132:135], v[236:239]
    s_waitcnt lgkmcnt(6)
    v_exp_f32 v61, v87
    v_mfma_f32_16x16x32_bf16 v[232:235], v[116:119], v[128:131], v[232:235]
    s_cselect_b32 s65, 0, 1
    ds_read_b128 v[116:119], v48 offset:5120
    v_cvt_pk_bf16_f32 v141, v60, v61
    v_mfma_f32_16x16x32_bf16 v[240:243], v[120:123], v[128:131], v[240:243]
    s_waitcnt lgkmcnt(6)
    v_exp_f32 v58, v88
    v_mfma_f32_16x16x32_bf16 v[244:247], v[120:123], v[132:135], v[244:247]
    ds_read_b128 v[120:123], v48 offset:6144
    v_mfma_f32_16x16x32_bf16 v[252:255], v[124:127], v[132:135], v[252:255]
    s_waitcnt lgkmcnt(6)
    v_exp_f32 v59, v89
    v_mfma_f32_16x16x32_bf16 v[248:251], v[124:127], v[128:131], v[248:251]
    ds_read_b128 v[124:127], v48 offset:7168
    v_cvt_pk_bf16_f32 v138, v58, v59
    v_mfma_f32_16x16x32_bf16 v[64:67], v[96:99], v[16:19], v[144:147]
    s_waitcnt lgkmcnt(6)
    v_exp_f32 v60, v90
    v_mfma_f32_16x16x32_bf16 v[68:71], v[96:99], v[32:35], v[148:151]
    ds_read_b128 v[96:99], v48 offset:40960
    v_or3_b32 v62, v62, v141, v138
    v_mfma_f32_16x16x32_bf16 v[68:71], v[100:103], v[36:39], v[68:71]
    s_waitcnt lgkmcnt(6)
    v_exp_f32 v61, v91
    v_mfma_f32_16x16x32_bf16 v[64:67], v[100:103], v[20:23], v[64:67]
    ds_read_b128 v[100:103], v48 offset:41984
    v_cvt_pk_bf16_f32 v139, v60, v61
    v_mfma_f32_16x16x32_bf16 v[64:67], v[104:107], v[24:27], v[64:67]
    s_waitcnt lgkmcnt(6)
    v_exp_f32 v58, v92
    v_mfma_f32_16x16x32_bf16 v[68:71], v[104:107], v[40:43], v[68:71]
    ds_read_b128 v[104:107], v48 offset:43008
    v_mfma_f32_16x16x32_bf16 v[68:71], v[108:111], v[44:47], v[68:71]
    s_waitcnt lgkmcnt(6)
    v_exp_f32 v59, v93
    v_mfma_f32_16x16x32_bf16 v[64:67], v[108:111], v[28:31], v[64:67]
    ds_read_b128 v[108:111], v48 offset:44032
    v_cvt_pk_bf16_f32 v142, v58, v59
    v_mfma_f32_16x16x32_bf16 v[72:75], v[112:115], v[16:19], v[152:155]
    s_waitcnt lgkmcnt(6)
    v_exp_f32 v60, v94
    v_mfma_f32_16x16x32_bf16 v[76:79], v[112:115], v[32:35], v[156:159]
    ds_read_b128 v[112:115], v48 offset:45056
    v_or3_b32 v62, v62, v139, v142
    v_mfma_f32_16x16x32_bf16 v[76:79], v[116:119], v[36:39], v[76:79]
    s_waitcnt lgkmcnt(6)
    v_exp_f32 v61, v95
    v_mfma_f32_16x16x32_bf16 v[72:75], v[116:119], v[20:23], v[72:75]
    ds_read_b128 v[116:119], v48 offset:46080
    v_cvt_pk_bf16_f32 v143, v60, v61
    v_smfmac_f32_16x16x64_bf16 v[160:163], v[164:167], v[128:135], v168
    v_bitop3_b32 v62, v62, v143, s72 bitop3:0xa8
    v_mfma_f32_16x16x32_bf16 v[72:75], v[120:123], v[24:27], v[72:75]
    s_waitcnt lgkmcnt(6)
    v_exp_f32 v58, v64
    v_mfma_f32_16x16x32_bf16 v[76:79], v[120:123], v[40:43], v[76:79]
    ds_read_b128 v[120:123], v48 offset:47104
    v_cmp_ne_u32 vcc, s65, v62
    v_mfma_f32_16x16x32_bf16 v[76:79], v[124:127], v[44:47], v[76:79]
    s_waitcnt lgkmcnt(6)
    v_exp_f32 v59, v65
    v_mfma_f32_16x16x32_bf16 v[72:75], v[124:127], v[28:31], v[72:75]
    ds_read_b128 v[124:127], v48 offset:48128
    s_cbranch_vccnz L_back_10_h
L_back_10:
    v_mfma_f32_16x16x32_bf16 v[192:195], v[96:99], v[136:139], v[192:195]
    s_waitcnt lgkmcnt(6)
    v_exp_f32 v60, v66
    v_mfma_f32_16x16x32_bf16 v[196:199], v[96:99], v[140:143], v[196:199]
    ds_read_b128 v[96:99], v48 offset:8192
    v_cvt_pk_bf16_f32 v128, v58, v59
    v_mfma_f32_16x16x32_bf16 v[204:207], v[100:103], v[140:143], v[204:207]
    s_waitcnt lgkmcnt(6)
    v_exp_f32 v61, v67
    v_mfma_f32_16x16x32_bf16 v[200:203], v[100:103], v[136:139], v[200:203]
    s_sub_i32 s64, s64, 1
    ds_read_b128 v[100:103], v48 offset:9216
    v_cvt_pk_bf16_f32 v129, v60, v61
    v_mfma_f32_16x16x32_bf16 v[208:211], v[104:107], v[136:139], v[208:211]
    s_waitcnt lgkmcnt(6)
    v_exp_f32 v58, v68
    v_mfma_f32_16x16x32_bf16 v[212:215], v[104:107], v[140:143], v[212:215]
    ds_read_b128 v[104:107], v48 offset:10240
    v_mfma_f32_16x16x32_bf16 v[220:223], v[108:111], v[140:143], v[220:223]
    s_waitcnt lgkmcnt(6)
    v_exp_f32 v59, v69
    v_mfma_f32_16x16x32_bf16 v[216:219], v[108:111], v[136:139], v[216:219]
    s_cmp_gt_i32 s64, 0
    ds_read_b128 v[108:111], v48 offset:11264
    v_cvt_pk_bf16_f32 v132, v58, v59
    v_mfma_f32_16x16x32_bf16 v[224:227], v[112:115], v[136:139], v[224:227]
    s_waitcnt lgkmcnt(6)
    v_exp_f32 v60, v70
    v_mfma_f32_16x16x32_bf16 v[228:231], v[112:115], v[140:143], v[228:231]
    ds_read_b128 v[112:115], v48 offset:12288
    v_or3_b32 v62, v128, v129, v132
    v_mfma_f32_16x16x32_bf16 v[236:239], v[116:119], v[140:143], v[236:239]
    s_waitcnt lgkmcnt(6)
    v_exp_f32 v61, v71
    v_mfma_f32_16x16x32_bf16 v[232:235], v[116:119], v[136:139], v[232:235]
    s_cselect_b32 s65, 0, 1
    ds_read_b128 v[116:119], v48 offset:13312
    v_cvt_pk_bf16_f32 v133, v60, v61
    v_mfma_f32_16x16x32_bf16 v[240:243], v[120:123], v[136:139], v[240:243]
    s_waitcnt lgkmcnt(6)
    v_exp_f32 v58, v72
    v_mfma_f32_16x16x32_bf16 v[244:247], v[120:123], v[140:143], v[244:247]
    ds_read_b128 v[120:123], v48 offset:14336
    v_mfma_f32_16x16x32_bf16 v[252:255], v[124:127], v[140:143], v[252:255]
    s_waitcnt lgkmcnt(6)
    v_exp_f32 v59, v73
    v_mfma_f32_16x16x32_bf16 v[248:251], v[124:127], v[136:139], v[248:251]
    ds_read_b128 v[124:127], v48 offset:15360
    v_cvt_pk_bf16_f32 v130, v58, v59
    v_mfma_f32_16x16x32_bf16 v[80:83], v[96:99], v[16:19], v[144:147]
    s_waitcnt lgkmcnt(6)
    v_exp_f32 v60, v74
    v_mfma_f32_16x16x32_bf16 v[84:87], v[96:99], v[32:35], v[148:151]
    ds_read_b128 v[96:99], v48 offset:49152
    v_or3_b32 v62, v62, v133, v130
    v_mfma_f32_16x16x32_bf16 v[84:87], v[100:103], v[36:39], v[84:87]
    s_waitcnt lgkmcnt(6)
    v_exp_f32 v61, v75
    v_mfma_f32_16x16x32_bf16 v[80:83], v[100:103], v[20:23], v[80:83]
    ds_read_b128 v[100:103], v48 offset:50176
    v_cvt_pk_bf16_f32 v131, v60, v61
    v_mfma_f32_16x16x32_bf16 v[80:83], v[104:107], v[24:27], v[80:83]
    s_waitcnt lgkmcnt(6)
    v_exp_f32 v58, v76
    v_mfma_f32_16x16x32_bf16 v[84:87], v[104:107], v[40:43], v[84:87]
    ds_read_b128 v[104:107], v48 offset:51200
    v_mfma_f32_16x16x32_bf16 v[84:87], v[108:111], v[44:47], v[84:87]
    s_waitcnt lgkmcnt(6)
    v_exp_f32 v59, v77
    v_mfma_f32_16x16x32_bf16 v[80:83], v[108:111], v[28:31], v[80:83]
    ds_read_b128 v[108:111], v48 offset:52224
    v_cvt_pk_bf16_f32 v134, v58, v59
    v_mfma_f32_16x16x32_bf16 v[88:91], v[112:115], v[16:19], v[152:155]
    s_waitcnt lgkmcnt(6)
    v_exp_f32 v60, v78
    v_mfma_f32_16x16x32_bf16 v[92:95], v[112:115], v[32:35], v[156:159]
    ds_read_b128 v[112:115], v48 offset:53248
    v_or3_b32 v62, v62, v131, v134
    v_mfma_f32_16x16x32_bf16 v[92:95], v[116:119], v[36:39], v[92:95]
    s_waitcnt lgkmcnt(6)
    v_exp_f32 v61, v79
    v_mfma_f32_16x16x32_bf16 v[88:91], v[116:119], v[20:23], v[88:91]
    ds_read_b128 v[116:119], v48 offset:54272
    v_cvt_pk_bf16_f32 v135, v60, v61
    v_smfmac_f32_16x16x64_bf16 v[160:163], v[164:167], v[136:143], v168
    v_bitop3_b32 v62, v62, v135, s72 bitop3:0xa8
    v_mfma_f32_16x16x32_bf16 v[88:91], v[120:123], v[24:27], v[88:91]
    s_waitcnt lgkmcnt(6)
    v_exp_f32 v58, v80
    v_mfma_f32_16x16x32_bf16 v[92:95], v[120:123], v[40:43], v[92:95]
    ds_read_b128 v[120:123], v48 offset:55296
    v_cmp_ne_u32 vcc, s65, v62
    v_mfma_f32_16x16x32_bf16 v[92:95], v[124:127], v[44:47], v[92:95]
    s_waitcnt lgkmcnt(6)
    v_exp_f32 v59, v81
    v_mfma_f32_16x16x32_bf16 v[88:91], v[124:127], v[28:31], v[88:91]
    ds_read_b128 v[124:127], v48 offset:56320
    s_cbranch_vccnz L_back_11_h
L_back_11:
L_st2:
    v_mfma_f32_16x16x32_bf16 v[192:195], v[96:99], v[128:131], v[192:195]
    s_waitcnt lgkmcnt(6)
    v_exp_f32 v60, v82
    v_mfma_f32_16x16x32_bf16 v[196:199], v[96:99], v[132:135], v[196:199]
    ds_read_b128 v[96:99], v48 offset:16384
    v_cvt_pk_bf16_f32 v136, v58, v59
    v_mfma_f32_16x16x32_bf16 v[204:207], v[100:103], v[132:135], v[204:207]
    s_waitcnt lgkmcnt(6)
    v_exp_f32 v61, v83
    v_mfma_f32_16x16x32_bf16 v[200:203], v[100:103], v[128:131], v[200:203]
    s_sub_i32 s64, s64, 1
    ds_read_b128 v[100:103], v48 offset:17408
    v_cvt_pk_bf16_f32 v137, v60, v61
    v_mfma_f32_16x16x32_bf16 v[208:211], v[104:107], v[128:131], v[208:211]
    s_waitcnt lgkmcnt(6)
    v_exp_f32 v58, v84
    v_mfma_f32_16x16x32_bf16 v[212:215], v[104:107], v[132:135], v[212:215]
    ds_read_b128 v[104:107], v48 offset:18432
    v_mfma_f32_16x16x32_bf16 v[220:223], v[108:111], v[132:135], v[220:223]
    s_waitcnt lgkmcnt(6)
    v_exp_f32 v59, v85
    v_mfma_f32_16x16x32_bf16 v[216:219], v[108:111], v[128:131], v[216:219]
    s_cmp_gt_i32 s64, 0
    ds_read_b128 v[108:111], v48 offset:19456
    v_cvt_pk_bf16_f32 v140, v58, v59
    v_mfma_f32_16x16x32_bf16 v[224:227], v[112:115], v[128:131], v[224:227]
    s_waitcnt lgkmcnt(6)
    v_exp_f32 v60, v86
    v_mfma_f32_16x16x32_bf16 v[228:231], v[112:115], v[132:135], v[228:231]
    ds_read_b128 v[112:115], v48 offset:20480
    v_or3_b32 v62, v136, v137, v140
    v_mfma_f32_16x16x32_bf16 v[236:239], v[116:119], v[132:135], v[236:239]
    s_waitcnt lgkmcnt(6)
    v_exp_f32 v61, v87
    v_mfma_f32_16x16x32_bf16 v[232:235], v[116:119], v[128:131], v[232:235]
    s_cselect_b32 s65, 0, 1
    ds_read_b128 v[116:119], v48 offset:21504
    v_cvt_pk_bf16_f32 v141, v60, v61
    v_mfma_f32_16x16x32_bf16 v[240:243], v[120:123], v[128:131], v[240:243]
    s_waitcnt lgkmcnt(6)
    v_exp_f32 v58, v88
    v_mfma_f32_16x16x32_bf16 v[244:247], v[120:123], v[132:135], v[244:247]
    ds_read_b128 v[120:123], v48 offset:22528
    v_mfma_f32_16x16x32_bf16 v[252:255], v[124:127], v[132:135], v[252:255]
    s_waitcnt lgkmcnt(6)
    v_exp_f32 v59, v89
    v_mfma_f32_16x16x32_bf16 v[248:251], v[124:127], v[128:131], v[248:251]
    ds_read_b128 v[124:127], v48 offset:23552
    v_cvt_pk_bf16_f32 v138, v58, v59
    v_mfma_f32_16x16x32_bf16 v[64:67], v[96:99], v[16:19], v[144:147]
    s_waitcnt lgkmcnt(6)
    v_exp_f32 v60, v90
    v_mfma_f32_16x16x32_bf16 v[68:71], v[96:99], v[32:35], v[148:151]
    ds_read_b128 v[96:99], v48 offset:57344
    v_or3_b32 v62, v62, v141, v138
    v_mfma_f32_16x16x32_bf16 v[68:71], v[100:103], v[36:39], v[68:71]
    s_waitcnt lgkmcnt(6)
    v_exp_f32 v61, v91
    v_mfma_f32_16x16x32_bf16 v[64:67], v[100:103], v[20:23], v[64:67]
    ds_read_b128 v[100:103], v48 offset:58368
    v_cvt_pk_bf16_f32 v139, v60, v61
    v_mfma_f32_16x16x32_bf16 v[64:67], v[104:107], v[24:27], v[64:67]
    s_waitcnt lgkmcnt(6)
    v_exp_f32 v58, v92
    v_mfma_f32_16x16x32_bf16 v[68:71], v[104:107], v[40:43], v[68:71]
    ds_read_b128 v[104:107], v48 offset:59392
    v_mfma_f32_16x16x32_bf16 v[68:71], v[108:111], v[44:47], v[68:71]
    s_waitcnt lgkmcnt(6)
    v_exp_f32 v59, v93
    v_mfma_f32_16x16x32_bf16 v[64:67], v[108:111], v[28:31], v[64:67]
    ds_read_b128 v[108:111], v48 offset:60416
    v_cvt_pk_bf16_f32 v142, v58, v59
    v_mfma_f32_16x16x32_bf16 v[72:75], v[112:115], v[16:19], v[152:155]
    s_waitcnt lgkmcnt(6)
    v_exp_f32 v60, v94
    v_mfma_f32_16x16x32_bf16 v[76:79], v[112:115], v[32:35], v[156:159]
    ds_read_b128 v[112:115], v48 offset:61440
    v_or3_b32 v62, v62, v139, v142
    v_mfma_f32_16x16x32_bf16 v[76:79], v[116:119], v[36:39], v[76:79]
    s_waitcnt lgkmcnt(6)
    v_exp_f32 v61, v95
    v_mfma_f32_16x16x32_bf16 v[72:75], v[116:119], v[20:23], v[72:75]
    ds_read_b128 v[116:119], v48 offset:62464
    v_cvt_pk_bf16_f32 v143, v60, v61
    v_smfmac_f32_16x16x64_bf16 v[160:163], v[164:167], v[128:135], v168
    v_bitop3_b32 v62, v62, v143, s72 bitop3:0xa8
    v_mfma_f32_16x16x32_bf16 v[72:75], v[120:123], v[24:27], v[72:75]
    s_waitcnt lgkmcnt(6)
    v_exp_f32 v58, v64
    v_mfma_f32_16x16x32_bf16 v[76:79], v[120:123], v[40:43], v[76:79]
    ds_read_b128 v[120:123], v48 offset:63488
    v_cmp_ne_u32 vcc, s65, v62
    v_mfma_f32_16x16x32_bf16 v[76:79], v[124:127], v[44:47], v[76:79]
    s_waitcnt lgkmcnt(6)
    v_exp_f32 v59, v65
    v_mfma_f32_16x16x32_bf16 v[72:75], v[124:127], v[28:31], v[72:75]
    ds_read_b128 v[124:127], v48 offset:64512
    s_cbranch_vccnz L_back_12_h
L_back_12:
    v_mfma_f32_16x16x32_bf16 v[192:195], v[96:99], v[136:139], v[192:195]
    s_waitcnt lgkmcnt(6)
    v_exp_f32 v60, v66
    v_mfma_f32_16x16x32_bf16 v[196:199], v[96:99], v[140:143], v[196:199]
    ds_read_b128 v[96:99], v48 offset:24576
    v_cvt_pk_bf16_f32 v128, v58, v59
    v_mfma_f32_16x16x32_bf16 v[204:207], v[100:103], v[140:143], v[204:207]
    s_waitcnt lgkmcnt(6)
    v_exp_f32 v61, v67
    v_mfma_f32_16x16x32_bf16 v[200:203], v[100:103], v[136:139], v[200:203]
    s_sub_i32 s64, s64, 1
    ds_read_b128 v[100:103], v48 offset:25600
    v_cvt_pk_bf16_f32 v129, v60, v61
    v_mfma_f32_16x16x32_bf16 v[208:211], v[104:107], v[136:139], v[208:211]
    s_waitcnt lgkmcnt(6)
    v_exp_f32 v58, v68
    v_mfma_f32_16x16x32_bf16 v[212:215], v[104:107], v[140:143], v[212:215]
    ds_read_b128 v[104:107], v48 offset:26624
    v_mfma_f32_16x16x32_bf16 v[220:223], v[108:111], v[140:143], v[220:223]
    s_waitcnt lgkmcnt(6)
    v_exp_f32 v59, v69
    v_mfma_f32_16x16x32_bf16 v[216:219], v[108:111], v[136:139], v[216:219]
    s_cmp_gt_i32 s64, 0
    ds_read_b128 v[108:111], v48 offset:27648
    v_cvt_pk_bf16_f32 v132, v58, v59
    v_mfma_f32_16x16x32_bf16 v[224:227], v[112:115], v[136:139], v[224:227]
    s_waitcnt lgkmcnt(6)
    v_exp_f32 v60, v70
    v_mfma_f32_16x16x32_bf16 v[228:231], v[112:115], v[140:143], v[228:231]
    ds_read_b128 v[112:115], v48 offset:28672
    v_or3_b32 v62, v128, v129, v132
    v_mfma_f32_16x16x32_bf16 v[236:239], v[116:119], v[140:143], v[236:239]
    s_waitcnt lgkmcnt(6)
    v_exp_f32 v61, v71
    v_mfma_f32_16x16x32_bf16 v[232:235], v[116:119], v[136:139], v[232:235]
    s_cselect_b32 s65, 0, 1
    ds_read_b128 v[116:119], v48 offset:29696
    v_cvt_pk_bf16_f32 v133, v60, v61
    v_mfma_f32_16x16x32_bf16 v[240:243], v[120:123], v[136:139], v[240:243]
    s_waitcnt lgkmcnt(6)
    v_exp_f32 v58, v72
    v_mfma_f32_16x16x32_bf16 v[244:247], v[120:123], v[140:143], v[244:247]
    ds_read_b128 v[120:123], v48 offset:30720
    v_mfma_f32_16x16x32_bf16 v[252:255], v[124:127], v[140:143], v[252:255]
    s_waitcnt lgkmcnt(6)
    v_exp_f32 v59, v73
    v_mfma_f32_16x16x32_bf16 v[248:251], v[124:127], v[136:139], v[248:251]
    ds_read_b128 v[124:127], v48 offset:31744
    v_cvt_pk_bf16_f32 v130, v58, v59
    v_mfma_f32_16x16x32_bf16 v[80:83], v[96:99], v[16:19], v[144:147]
    s_waitcnt lgkmcnt(6)
    v_exp_f32 v60, v74
    v_mfma_f32_16x16x32_bf16 v[84:87], v[96:99], v[32:35], v[148:151]
    s_cmp_lg_u32 s89, 0
    v_or3_b32 v62, v62, v133, v130
    v_xor_b32 v48, 0x10000, v48
    v_mfma_f32_16x16x32_bf16 v[84:87], v[100:103], v[36:39], v[84:87]
    s_waitcnt lgkmcnt(5)
    v_exp_f32 v61, v75
    v_mfma_f32_16x16x32_bf16 v[80:83], v[100:103], v[20:23], v[80:83]
    s_waitcnt lgkmcnt(0)
    v_cvt_pk_bf16_f32 v131, v60, v61
    v_smfmac_f32_16x16x64_bf16 v[160:163], v[164:167], v[136:143], v168
    s_cbranch_scc1 L_ldback_13_c
    s_barrier
L_ldback_13:
    s_add_i32 s62, s62, 1
    ds_read_b128 v[96:99], v48 offset:32768
    ds_read_b128 v[100:103], v48 offset:33792
    v_mfma_f32_16x16x32_bf16 v[80:83], v[104:107], v[24:27], v[80:83]
    v_exp_f32 v58, v76
    v_mfma_f32_16x16x32_bf16 v[84:87], v[104:107], v[40:43], v[84:87]
    ds_read_b128 v[104:107], v48 offset:34816
    v_mfma_f32_16x16x32_bf16 v[84:87], v[108:111], v[44:47], v[84:87]
    v_exp_f32 v59, v77
    v_mfma_f32_16x16x32_bf16 v[80:83], v[108:111], v[28:31], v[80:83]
    ds_read_b128 v[108:111], v48 offset:35840
    v_cvt_pk_bf16_f32 v134, v58, v59
    v_mfma_f32_16x16x32_bf16 v[88:91], v[112:115], v[16:19], v[152:155]
    v_exp_f32 v60, v78
    v_mfma_f32_16x16x32_bf16 v[92:95], v[112:115], v[32:35], v[156:159]
    ds_read_b128 v[112:115], v48 offset:36864
    v_or3_b32 v62, v62, v131, v134
    v_mfma_f32_16x16x32_bf16 v[92:95], v[116:119], v[36:39], v[92:95]
    v_exp_f32 v61, v79
    v_mfma_f32_16x16x32_bf16 v[88:91], v[116:119], v[20:23], v[88:91]
    ds_read_b128 v[116:119], v48 offset:37888
    v_cvt_pk_bf16_f32 v135, v60, v61
    v_mfma_f32_16x16x32_bf16 v[88:91], v[120:123], v[24:27], v[88:91]
    v_exp_f32 v58, v80
    v_mfma_f32_16x16x32_bf16 v[92:95], v[120:123], v[40:43], v[92:95]
    ds_read_b128 v[120:123], v48 offset:38912
    v_bitop3_b32 v62, v62, v135, s72 bitop3:0xa8
    v_cmp_ne_u32 vcc, s65, v62
    v_mfma_f32_16x16x32_bf16 v[92:95], v[124:127], v[44:47], v[92:95]
    s_waitcnt lgkmcnt(6)
    v_exp_f32 v59, v81
    v_mfma_f32_16x16x32_bf16 v[88:91], v[124:127], v[28:31], v[88:91]
    ds_read_b128 v[124:127], v48 offset:39936
    s_cbranch_vccz L_st0
    s_branch L_back_14_h
L_tail0:
    s_mov_b32 s65, 0
    v_mfma_f32_16x16x32_bf16 v[192:195], v[96:99], v[128:131], v[192:195]
    s_waitcnt lgkmcnt(6)
    v_exp_f32 v60, v82
    v_exp_f32 v61, v83
    v_mfma_f32_16x16x32_bf16 v[196:199], v[96:99], v[132:135], v[196:199]
    ds_read_b128 v[96:99], v48 offset:40960
    v_cvt_pk_bf16_f32 v136, v58, v59
    v_cvt_pk_bf16_f32 v137, v60, v61
    v_mfma_f32_16x16x32_bf16 v[204:207], v[100:103], v[132:135], v[204:207]
    s_waitcnt lgkmcnt(6)
    v_exp_f32 v58, v84
    v_exp_f32 v59, v85
    v_mfma_f32_16x16x32_bf16 v[200:203], v[100:103], v[128:131], v[200:203]
    ds_read_b128 v[100:103], v48 offset:41984
    v_cvt_pk_bf16_f32 v140, v58, v59
    v_smfmac_f32_16x16x64_bf16 v[160:163], v[164:167], v[128:135], v168
    v_mfma_f32_16x16x32_bf16 v[208:211], v[104:107], v[128:131], v[208:211]
    s_waitcnt lgkmcnt(6)
    v_exp_f32 v60, v86
    v_exp_f32 v61, v87
    v_mfma_f32_16x16x32_bf16 v[212:215], v[104:107], v[132:135], v[212:215]
    ds_read_b128 v[104:107], v48 offset:43008
    v_cvt_pk_bf16_f32 v141, v60, v61
    v_mfma_f32_16x16x32_bf16 v[220:223], v[108:111], v[132:135], v[220:223]
    s_waitcnt lgkmcnt(6)
    v_exp_f32 v58, v88
    v_exp_f32 v59, v89
    v_mfma_f32_16x16x32_bf16 v[216:219], v[108:111], v[128:131], v[216:219]
    ds_read_b128 v[108:111], v48 offset:44032
    v_cvt_pk_bf16_f32 v138, v58, v59
    v_mfma_f32_16x16x32_bf16 v[224:227], v[112:115], v[128:131], v[224:227]
    s_waitcnt lgkmcnt(6)
    v_exp_f32 v60, v90
    v_exp_f32 v61, v91
    v_mfma_f32_16x16x32_bf16 v[228:231], v[112:115], v[132:135], v[228:231]
    ds_read_b128 v[112:115], v48 offset:45056
    v_cvt_pk_bf16_f32 v139, v60, v61
    v_mfma_f32_16x16x32_bf16 v[236:239], v[116:119], v[132:135], v[236:239]
    s_waitcnt lgkmcnt(6)
    v_exp_f32 v58, v92
    v_exp_f32 v59, v93
    v_mfma_f32_16x16x32_bf16 v[232:235], v[116:119], v[128:131], v[232:235]
    ds_read_b128 v[116:119], v48 offset:46080
    v_cvt_pk_bf16_f32 v142, v58, v59
    v_mfma_f32_16x16x32_bf16 v[240:243], v[120:123], v[128:131], v[240:243]
    s_waitcnt lgkmcnt(6)
    v_exp_f32 v60, v94
    v_exp_f32 v61, v95
    v_mfma_f32_16x16x32_bf16 v[244:247], v[120:123], v[132:135], v[244:247]
    ds_read_b128 v[120:123], v48 offset:47104
    v_cvt_pk_bf16_f32 v143, v60, v61
    v_mfma_f32_16x16x32_bf16 v[252:255], v[124:127], v[132:135], v[252:255]
    s_waitcnt lgkmcnt(6)
    v_or3_b32 v62, v136, v137, v140
    v_or3_b32 v62, v62, v141, v138
    v_or3_b32 v62, v62, v139, v142
    v_bitop3_b32 v62, v62, v143, s72 bitop3:0xa8
    v_cmp_ne_u32 vcc, s65, v62
    v_mfma_f32_16x16x32_bf16 v[248:251], v[124:127], v[128:131], v[248:251]
    ds_read_b128 v[124:127], v48 offset:48128
    s_cbranch_vccnz L_back_15_h
L_back_15:
L_pv1:
    v_mfma_f32_16x16x32_bf16 v[192:195], v[96:99], v[136:139], v[192:195]
    s_waitcnt lgkmcnt(6)
    v_mfma_f32_16x16x32_bf16 v[196:199], v[96:99], v[140:143], v[196:199]
    v_mfma_f32_16x16x32_bf16 v[204:207], v[100:103], v[140:143], v[204:207]
    s_waitcnt lgkmcnt(5)
    v_mfma_f32_16x16x32_bf16 v[200:203], v[100:103], v[136:139], v[200:203]
    v_smfmac_f32_16x16x64_bf16 v[160:163], v[164:167], v[136:143], v168
    v_mfma_f32_16x16x32_bf16 v[208:211], v[104:107], v[136:139], v[208:211]
    s_waitcnt lgkmcnt(4)
    v_mfma_f32_16x16x32_bf16 v[212:215], v[104:107], v[140:143], v[212:215]
    v_mfma_f32_16x16x32_bf16 v[220:223], v[108:111], v[140:143], v[220:223]
    s_waitcnt lgkmcnt(3)
    v_mfma_f32_16x16x32_bf16 v[216:219], v[108:111], v[136:139], v[216:219]
    v_mfma_f32_16x16x32_bf16 v[224:227], v[112:115], v[136:139], v[224:227]
    s_waitcnt lgkmcnt(2)
    v_mfma_f32_16x16x32_bf16 v[228:231], v[112:115], v[140:143], v[228:231]
    v_mfma_f32_16x16x32_bf16 v[236:239], v[116:119], v[140:143], v[236:239]
    s_waitcnt lgkmcnt(1)
    v_mfma_f32_16x16x32_bf16 v[232:235], v[116:119], v[136:139], v[232:235]
    v_mfma_f32_16x16x32_bf16 v[240:243], v[120:123], v[136:139], v[240:243]
    s_waitcnt lgkmcnt(0)
    v_mfma_f32_16x16x32_bf16 v[244:247], v[120:123], v[140:143], v[244:247]
    v_mfma_f32_16x16x32_bf16 v[252:255], v[124:127], v[140:143], v[252:255]
    v_mfma_f32_16x16x32_bf16 v[248:251], v[124:127], v[136:139], v[248:251]
    s_branch L_fin
L_tail1:
    s_mov_b32 s65, 0
    v_mfma_f32_16x16x32_bf16 v[192:195], v[96:99], v[136:139], v[192:195]
    s_waitcnt lgkmcnt(6)
    v_exp_f32 v60, v66
    v_exp_f32 v61, v67
    v_mfma_f32_16x16x32_bf16 v[196:199], v[96:99], v[140:143], v[196:199]
    ds_read_b128 v[96:99], v48 offset:49152
    v_cvt_pk_bf16_f32 v128, v58, v59
    v_cvt_pk_bf16_f32 v129, v60, v61
    v_mfma_f32_16x16x32_bf16 v[204:207], v[100:103], v[140:143], v[204:207]
    s_waitcnt lgkmcnt(6)
    v_exp_f32 v58, v68
    v_exp_f32 v59, v69
    v_mfma_f32_16x16x32_bf16 v[200:203], v[100:103], v[136:139], v[200:203]
    ds_read_b128 v[100:103], v48 offset:50176
    v_cvt_pk_bf16_f32 v132, v58, v59
    v_smfmac_f32_16x16x64_bf16 v[160:163], v[164:167], v[136:143], v168
    v_mfma_f32_16x16x32_bf16 v[208:211], v[104:107], v[136:139], v[208:211]
    s_waitcnt lgkmcnt(6)
    v_exp_f32 v60, v70
    v_exp_f32 v61, v71
    v_mfma_f32_16x16x32_bf16 v[212:215], v[104:107], v[140:143], v[212:215]
    ds_read_b128 v[104:107], v48 offset:51200
    v_cvt_pk_bf16_f32 v133, v60, v61
    v_mfma_f32_16x16x32_bf16 v[220:223], v[108:111], v[140:143], v[220:223]
    s_waitcnt lgkmcnt(6)
    v_exp_f32 v58, v72
    v_exp_f32 v59, v73
    v_mfma_f32_16x16x32_bf16 v[216:219], v[108:111], v[136:139], v[216:219]
    ds_read_b128 v[108:111], v48 offset:52224
    v_cvt_pk_bf16_f32 v130, v58, v59
    v_mfma_f32_16x16x32_bf16 v[224:227], v[112:115], v[136:139], v[224:227]
    s_waitcnt lgkmcnt(6)
    v_exp_f32 v60, v74
    v_exp_f32 v61, v75
    v_mfma_f32_16x16x32_bf16 v[228:231], v[112:115], v[140:143], v[228:231]
    ds_read_b128 v[112:115], v48 offset:53248
    v_cvt_pk_bf16_f32 v131, v60, v61
    v_mfma_f32_16x16x32_bf16 v[236:239], v[116:119], v[140:143], v[236:239]
    s_waitcnt lgkmcnt(6)
    v_exp_f32 v58, v76
    v_exp_f32 v59, v77
    v_mfma_f32_16x16x32_bf16 v[232:235], v[116:119], v[136:139], v[232:235]
    ds_read_b128 v[116:119], v48 offset:54272
    v_cvt_pk_bf16_f32 v134, v58, v59
    v_mfma_f32_16x16x32_bf16 v[240:243], v[120:123], v[136:139], v[240:243]
    s_waitcnt lgkmcnt(6)
    v_exp_f32 v60, v78
    v_exp_f32 v61, v79
    v_mfma_f32_16x16x32_bf16 v[244:247], v[120:123], v[140:143], v[244:247]
    ds_read_b128 v[120:123], v48 offset:55296
    v_cvt_pk_bf16_f32 v135, v60, v61
    v_mfma_f32_16x16x32_bf16 v[252:255], v[124:127], v[140:143], v[252:255]
    s_waitcnt lgkmcnt(6)
    v_or3_b32 v62, v128, v129, v132
    v_or3_b32 v62, v62, v133, v130
    v_or3_b32 v62, v62, v131, v134
    v_bitop3_b32 v62, v62, v135, s72 bitop3:0xa8
    v_cmp_ne_u32 vcc, s65, v62
    v_mfma_f32_16x16x32_bf16 v[248:251], v[124:127], v[136:139], v[248:251]
    ds_read_b128 v[124:127], v48 offset:56320
    s_cbranch_vccnz L_back_16_h
L_back_16:
L_pv2:
    v_mfma_f32_16x16x32_bf16 v[192:195], v[96:99], v[128:131], v[192:195]
    s_waitcnt lgkmcnt(6)
    v_mfma_f32_16x16x32_bf16 v[196:199], v[96:99], v[132:135], v[196:199]
    v_mfma_f32_16x16x32_bf16 v[204:207], v[100:103], v[132:135], v[204:207]
    s_waitcnt lgkmcnt(5)
    v_mfma_f32_16x16x32_bf16 v[200:203], v[100:103], v[128:131], v[200:203]
    v_smfmac_f32_16x16x64_bf16 v[160:163], v[164:167], v[128:135], v168
    v_mfma_f32_16x16x32_bf16 v[208:211], v[104:107], v[128:131], v[208:211]
    s_waitcnt lgkmcnt(4)
    v_mfma_f32_16x16x32_bf16 v[212:215], v[104:107], v[132:135], v[212:215]
    v_mfma_f32_16x16x32_bf16 v[220:223], v[108:111], v[132:135], v[220:223]
    s_waitcnt lgkmcnt(3)
    v_mfma_f32_16x16x32_bf16 v[216:219], v[108:111], v[128:131], v[216:219]
    v_mfma_f32_16x16x32_bf16 v[224:227], v[112:115], v[128:131], v[224:227]
    s_waitcnt lgkmcnt(2)
    v_mfma_f32_16x16x32_bf16 v[228:231], v[112:115], v[132:135], v[228:231]
    v_mfma_f32_16x16x32_bf16 v[236:239], v[116:119], v[132:135], v[236:239]
    s_waitcnt lgkmcnt(1)
    v_mfma_f32_16x16x32_bf16 v[232:235], v[116:119], v[128:131], v[232:235]
    v_mfma_f32_16x16x32_bf16 v[240:243], v[120:123], v[128:131], v[240:243]
    s_waitcnt lgkmcnt(0)
    v_mfma_f32_16x16x32_bf16 v[244:247], v[120:123], v[132:135], v[244:247]
    v_mfma_f32_16x16x32_bf16 v[252:255], v[124:127], v[132:135], v[252:255]
    v_mfma_f32_16x16x32_bf16 v[248:251], v[124:127], v[128:131], v[248:251]
    s_cmp_eq_u32 s60, 0
    s_cbranch_scc1 L_fin
    s_waitcnt vmcnt(0) lgkmcnt(0)
    s_call_b64 s[82:83], L_pend
    s_barrier
    s_call_b64 s[82:83], L_load
    s_add_i32 s62, s62, 1
    s_branch L_fin
L_tail2:
    s_mov_b32 s65, 0
    v_mfma_f32_16x16x32_bf16 v[192:195], v[96:99], v[128:131], v[192:195]
    s_waitcnt lgkmcnt(6)
    v_exp_f32 v60, v82
    v_exp_f32 v61, v83
    v_mfma_f32_16x16x32_bf16 v[196:199], v[96:99], v[132:135], v[196:199]
    ds_read_b128 v[96:99], v48 offset:57344
    v_cvt_pk_bf16_f32 v136, v58, v59
    v_cvt_pk_bf16_f32 v137, v60, v61
    v_mfma_f32_16x16x32_bf16 v[204:207], v[100:103], v[132:135], v[204:207]
    s_waitcnt lgkmcnt(6)
    v_exp_f32 v58, v84
    v_exp_f32 v59, v85
    v_mfma_f32_16x16x32_bf16 v[200:203], v[100:103], v[128:131], v[200:203]
    ds_read_b128 v[100:103], v48 offset:58368
    v_cvt_pk_bf16_f32 v140, v58, v59
    v_smfmac_f32_16x16x64_bf16 v[160:163], v[164:167], v[128:135], v168
    v_mfma_f32_16x16x32_bf16 v[208:211], v[104:107], v[128:131], v[208:211]
    s_waitcnt lgkmcnt(6)
    v_exp_f32 v60, v86
    v_exp_f32 v61, v87
    v_mfma_f32_16x16x32_bf16 v[212:215], v[104:107], v[132:135], v[212:215]
    ds_read_b128 v[104:107], v48 offset:59392
    v_cvt_pk_bf16_f32 v141, v60, v61
    v_mfma_f32_16x16x32_bf16 v[220:223], v[108:111], v[132:135], v[220:223]
    s_waitcnt lgkmcnt(6)
    v_exp_f32 v58, v88
    v_exp_f32 v59, v89
    v_mfma_f32_16x16x32_bf16 v[216:219], v[108:111], v[128:131], v[216:219]
    ds_read_b128 v[108:111], v48 offset:60416
    v_cvt_pk_bf16_f32 v138, v58, v59
    v_mfma_f32_16x16x32_bf16 v[224:227], v[112:115], v[128:131], v[224:227]
    s_waitcnt lgkmcnt(6)
    v_exp_f32 v60, v90
    v_exp_f32 v61, v91
    v_mfma_f32_16x16x32_bf16 v[228:231], v[112:115], v[132:135], v[228:231]
    ds_read_b128 v[112:115], v48 offset:61440
    v_cvt_pk_bf16_f32 v139, v60, v61
    v_mfma_f32_16x16x32_bf16 v[236:239], v[116:119], v[132:135], v[236:239]
    s_waitcnt lgkmcnt(6)
    v_exp_f32 v58, v92
    v_exp_f32 v59, v93
    v_mfma_f32_16x16x32_bf16 v[232:235], v[116:119], v[128:131], v[232:235]
    ds_read_b128 v[116:119], v48 offset:62464
    v_cvt_pk_bf16_f32 v142, v58, v59
    v_mfma_f32_16x16x32_bf16 v[240:243], v[120:123], v[128:131], v[240:243]
    s_waitcnt lgkmcnt(6)
    v_exp_f32 v60, v94
    v_exp_f32 v61, v95
    v_mfma_f32_16x16x32_bf16 v[244:247], v[120:123], v[132:135], v[244:247]
    ds_read_b128 v[120:123], v48 offset:63488
    v_cvt_pk_bf16_f32 v143, v60, v61
    v_mfma_f32_16x16x32_bf16 v[252:255], v[124:127], v[132:135], v[252:255]
    s_waitcnt lgkmcnt(6)
    v_or3_b32 v62, v136, v137, v140
    v_or3_b32 v62, v62, v141, v138
    v_or3_b32 v62, v62, v139, v142
    v_bitop3_b32 v62, v62, v143, s72 bitop3:0xa8
    v_cmp_ne_u32 vcc, s65, v62
    v_mfma_f32_16x16x32_bf16 v[248:251], v[124:127], v[128:131], v[248:251]
    ds_read_b128 v[124:127], v48 offset:64512
    s_cbranch_vccnz L_back_18_h
L_back_18:
L_pv3:
    v_mfma_f32_16x16x32_bf16 v[192:195], v[96:99], v[136:139], v[192:195]
    s_waitcnt lgkmcnt(6)
    v_mfma_f32_16x16x32_bf16 v[196:199], v[96:99], v[140:143], v[196:199]
    v_xor_b32 v48, 0x10000, v48
    v_mfma_f32_16x16x32_bf16 v[204:207], v[100:103], v[140:143], v[204:207]
    s_waitcnt lgkmcnt(5)
    v_mfma_f32_16x16x32_bf16 v[200:203], v[100:103], v[136:139], v[200:203]
    v_smfmac_f32_16x16x64_bf16 v[160:163], v[164:167], v[136:143], v168
    s_waitcnt vmcnt(0) lgkmcnt(0)
    s_call_b64 s[82:83], L_pend
    s_barrier
    s_call_b64 s[82:83], L_load
    s_add_i32 s62, s62, 1
    v_mfma_f32_16x16x32_bf16 v[208:211], v[104:107], v[136:139], v[208:211]
    v_mfma_f32_16x16x32_bf16 v[212:215], v[104:107], v[140:143], v[212:215]
    v_mfma_f32_16x16x32_bf16 v[220:223], v[108:111], v[140:143], v[220:223]
    v_mfma_f32_16x16x32_bf16 v[216:219], v[108:111], v[136:139], v[216:219]
    v_mfma_f32_16x16x32_bf16 v[224:227], v[112:115], v[136:139], v[224:227]
    v_mfma_f32_16x16x32_bf16 v[228:231], v[112:115], v[140:143], v[228:231]
    v_mfma_f32_16x16x32_bf16 v[236:239], v[116:119], v[140:143], v[236:239]
    v_mfma_f32_16x16x32_bf16 v[232:235], v[116:119], v[136:139], v[232:235]
    v_mfma_f32_16x16x32_bf16 v[240:243], v[120:123], v[136:139], v[240:243]
    v_mfma_f32_16x16x32_bf16 v[244:247], v[120:123], v[140:143], v[244:247]
    v_mfma_f32_16x16x32_bf16 v[252:255], v[124:127], v[140:143], v[252:255]
    v_mfma_f32_16x16x32_bf16 v[248:251], v[124:127], v[136:139], v[248:251]
    s_branch L_fin
L_tail3:
    s_mov_b32 s65, 0
    v_mfma_f32_16x16x32_bf16 v[192:195], v[96:99], v[136:139], v[192:195]
    s_waitcnt lgkmcnt(6)
    v_exp_f32 v60, v66
    v_exp_f32 v61, v67
    v_mfma_f32_16x16x32_bf16 v[196:199], v[96:99], v[140:143], v[196:199]
    v_cvt_pk_bf16_f32 v128, v58, v59
    v_cvt_pk_bf16_f32 v129, v60, v61
    v_xor_b32 v48, 0x10000, v48
    v_mfma_f32_16x16x32_bf16 v[204:207], v[100:103], v[140:143], v[204:207]
    s_waitcnt lgkmcnt(5)
    v_exp_f32 v58, v68
    v_exp_f32 v59, v69
    v_mfma_f32_16x16x32_bf16 v[200:203], v[100:103], v[136:139], v[200:203]
    v_cvt_pk_bf16_f32 v132, v58, v59
    v_smfmac_f32_16x16x64_bf16 v[160:163], v[164:167], v[136:143], v168
    s_waitcnt vmcnt(0) lgkmcnt(0)
    s_call_b64 s[82:83], L_pend
    s_barrier
    s_call_b64 s[82:83], L_load
    s_add_i32 s62, s62, 1
    ds_read_b128 v[96:99], v48 offset:32768
    ds_read_b128 v[100:103], v48 offset:33792
    v_mfma_f32_16x16x32_bf16 v[208:211], v[104:107], v[136:139], v[208:211]
    v_exp_f32 v60, v70
    v_exp_f32 v61, v71
    v_mfma_f32_16x16x32_bf16 v[212:215], v[104:107], v[140:143], v[212:215]
    ds_read_b128 v[104:107], v48 offset:34816
    v_cvt_pk_bf16_f32 v133, v60, v61
    v_mfma_f32_16x16x32_bf16 v[220:223], v[108:111], v[140:143], v[220:223]
    v_exp_f32 v58, v72
    v_exp_f32 v59, v73
    v_mfma_f32_16x16x32_bf16 v[216:219], v[108:111], v[136:139], v[216:219]
    ds_read_b128 v[108:111], v48 offset:35840
    v_cvt_pk_bf16_f32 v130, v58, v59
    v_mfma_f32_16x16x32_bf16 v[224:227], v[112:115], v[136:139], v[224:227]
    v_exp_f32 v60, v74
    v_exp_f32 v61, v75
    v_mfma_f32_16x16x32_bf16 v[228:231], v[112:115], v[140:143], v[228:231]
    ds_read_b128 v[112:115], v48 offset:36864
    v_cvt_pk_bf16_f32 v131, v60, v61
    v_mfma_f32_16x16x32_bf16 v[236:239], v[116:119], v[140:143], v[236:239]
    v_exp_f32 v58, v76
    v_exp_f32 v59, v77
    v_mfma_f32_16x16x32_bf16 v[232:235], v[116:119], v[136:139], v[232:235]
    ds_read_b128 v[116:119], v48 offset:37888
    v_cvt_pk_bf16_f32 v134, v58, v59
    v_mfma_f32_16x16x32_bf16 v[240:243], v[120:123], v[136:139], v[240:243]
    v_exp_f32 v60, v78
    v_exp_f32 v61, v79
    v_mfma_f32_16x16x32_bf16 v[244:247], v[120:123], v[140:143], v[244:247]
    ds_read_b128 v[120:123], v48 offset:38912
    v_cvt_pk_bf16_f32 v135, v60, v61
    v_mfma_f32_16x16x32_bf16 v[252:255], v[124:127], v[140:143], v[252:255]
    s_waitcnt lgkmcnt(6)
    v_or3_b32 v62, v128, v129, v132
    v_or3_b32 v62, v62, v133, v130
    v_or3_b32 v62, v62, v131, v134
    v_bitop3_b32 v62, v62, v135, s72 bitop3:0xa8
    v_cmp_ne_u32 vcc, s65, v62
    v_mfma_f32_16x16x32_bf16 v[248:251], v[124:127], v[136:139], v[248:251]
    ds_read_b128 v[124:127], v48 offset:39936
    s_cbranch_vccnz L_back_21_h
L_back_21:
L_pv0:
    v_mfma_f32_16x16x32_bf16 v[192:195], v[96:99], v[128:131], v[192:195]
    s_waitcnt lgkmcnt(6)
    v_mfma_f32_16x16x32_bf16 v[196:199], v[96:99], v[132:135], v[196:199]
    v_mfma_f32_16x16x32_bf16 v[204:207], v[100:103], v[132:135], v[204:207]
    s_waitcnt lgkmcnt(5)
    v_mfma_f32_16x16x32_bf16 v[200:203], v[100:103], v[128:131], v[200:203]
    v_smfmac_f32_16x16x64_bf16 v[160:163], v[164:167], v[128:135], v168
    v_mfma_f32_16x16x32_bf16 v[208:211], v[104:107], v[128:131], v[208:211]
    s_waitcnt lgkmcnt(4)
    v_mfma_f32_16x16x32_bf16 v[212:215], v[104:107], v[132:135], v[212:215]
    v_mfma_f32_16x16x32_bf16 v[220:223], v[108:111], v[132:135], v[220:223]
    s_waitcnt lgkmcnt(3)
    v_mfma_f32_16x16x32_bf16 v[216:219], v[108:111], v[128:131], v[216:219]
    v_mfma_f32_16x16x32_bf16 v[224:227], v[112:115], v[128:131], v[224:227]
    s_waitcnt lgkmcnt(2)
    v_mfma_f32_16x16x32_bf16 v[228:231], v[112:115], v[132:135], v[228:231]
    v_mfma_f32_16x16x32_bf16 v[236:239], v[116:119], v[132:135], v[236:239]
    s_waitcnt lgkmcnt(1)
    v_mfma_f32_16x16x32_bf16 v[232:235], v[116:119], v[128:131], v[232:235]
    v_mfma_f32_16x16x32_bf16 v[240:243], v[120:123], v[128:131], v[240:243]
    s_waitcnt lgkmcnt(0)
    v_mfma_f32_16x16x32_bf16 v[244:247], v[120:123], v[132:135], v[244:247]
    v_mfma_f32_16x16x32_bf16 v[252:255], v[124:127], v[132:135], v[252:255]
    v_mfma_f32_16x16x32_bf16 v[248:251], v[124:127], v[128:131], v[248:251]
L_fin:
    v_and_b32 v3, 7, v1
    v_lshlrev_b32 v3, 2, v3
    s_mov_b32 s72, 0x3a0000
    buffer_load_dword v51, v3, s[8:11], s72 offen sc1
    v_add_f32 v56, v160, v161
    v_rcp_f32 v56, v56
    v_add_f32 v57, v162, v163
    v_rcp_f32 v57, v57
    s_lshl_b32 s6, s60, 18
    s_lshl_b32 s7, s4, 12
    s_add_u32 s6, s6, s7
    s_add_u32 s6, s6, 50331648
    s_nop 4
    v_mul_f32 v192, v56, v192
    v_mul_f32 v193, v56, v193
    v_mul_f32 v194, v56, v194
    v_mul_f32 v195, v56, v195
    v_cvt_pk_bf16_f32 v16, v192, v193
    v_cvt_pk_bf16_f32 v17, v194, v195
    v_mul_f32 v200, v56, v200
    v_mul_f32 v201, v56, v201
    v_mul_f32 v202, v56, v202
    v_mul_f32 v203, v56, v203
    v_cvt_pk_bf16_f32 v18, v200, v201
    v_cvt_pk_bf16_f32 v19, v202, v203
    buffer_store_dwordx4 v[16:19], v13, s[8:11], s6 offen offset:0 sc1
    v_mul_f32 v208, v56, v208
    v_mul_f32 v209, v56, v209
    v_mul_f32 v210, v56, v210
    v_mul_f32 v211, v56, v211
    v_cvt_pk_bf16_f32 v20, v208, v209
    v_cvt_pk_bf16_f32 v21, v210, v211
    v_mul_f32 v216, v56, v216
    v_mul_f32 v217, v56, v217
    v_mul_f32 v218, v56, v218
    v_mul_f32 v219, v56, v219
    v_cvt_pk_bf16_f32 v22, v216, v217
    v_cvt_pk_bf16_f32 v23, v218, v219
    buffer_store_dwordx4 v[20:23], v13, s[8:11], s6 offen offset:1024 sc1
    v_mul_f32 v224, v56, v224
    v_mul_f32 v225, v56, v225
    v_mul_f32 v226, v56, v226
    v_mul_f32 v227, v56, v227
    v_cvt_pk_bf16_f32 v24, v224, v225
    v_cvt_pk_bf16_f32 v25, v226, v227
    v_mul_f32 v232, v56, v232
    v_mul_f32 v233, v56, v233
    v_mul_f32 v234, v56, v234
    v_mul_f32 v235, v56, v235
    v_cvt_pk_bf16_f32 v26, v232, v233
    v_cvt_pk_bf16_f32 v27, v234, v235
    buffer_store_dwordx4 v[24:27], v13, s[8:11], s6 offen offset:2048 sc1
    v_mul_f32 v240, v56, v240
    v_mul_f32 v241, v56, v241
    v_mul_f32 v242, v56, v242
    v_mul_f32 v243, v56, v243
    v_cvt_pk_bf16_f32 v28, v240, v241
    v_cvt_pk_bf16_f32 v29, v242, v243
    v_mul_f32 v248, v56, v248
    v_mul_f32 v249, v56, v249
    v_mul_f32 v250, v56, v250
    v_mul_f32 v251, v56, v251
    v_cvt_pk_bf16_f32 v30, v248, v249
    v_cvt_pk_bf16_f32 v31, v250, v251
    buffer_store_dwordx4 v[28:31], v13, s[8:11], s6 offen offset:3072 sc1
    s_add_u32 s6, s6, 0x20000
    v_mul_f32 v196, v57, v196
    v_mul_f32 v197, v57, v197
    v_mul_f32 v198, v57, v198
    v_mul_f32 v199, v57, v199
    v_cvt_pk_bf16_f32 v32, v196, v197
    v_cvt_pk_bf16_f32 v33, v198, v199
    v_mul_f32 v204, v57, v204
    v_mul_f32 v205, v57, v205
    v_mul_f32 v206, v57, v206
    v_mul_f32 v207, v57, v207
    v_cvt_pk_bf16_f32 v34, v204, v205
    v_cvt_pk_bf16_f32 v35, v206, v207
    buffer_store_dwordx4 v[32:35], v13, s[8:11], s6 offen offset:0 sc1
    v_mul_f32 v212, v57, v212
    v_mul_f32 v213, v57, v213
    v_mul_f32 v214, v57, v214
    v_mul_f32 v215, v57, v215
    v_cvt_pk_bf16_f32 v36, v212, v213
    v_cvt_pk_bf16_f32 v37, v214, v215
    v_mul_f32 v220, v57, v220
    v_mul_f32 v221, v57, v221
    v_mul_f32 v222, v57, v222
    v_mul_f32 v223, v57, v223
    v_cvt_pk_bf16_f32 v38, v220, v221
    v_cvt_pk_bf16_f32 v39, v222, v223
    buffer_store_dwordx4 v[36:39], v13, s[8:11], s6 offen offset:1024 sc1
    v_mul_f32 v228, v57, v228
    v_mul_f32 v229, v57, v229
    v_mul_f32 v230, v57, v230
    v_mul_f32 v231, v57, v231
    v_cvt_pk_bf16_f32 v40, v228, v229
    v_cvt_pk_bf16_f32 v41, v230, v231
    v_mul_f32 v236, v57, v236
    v_mul_f32 v237, v57, v237
    v_mul_f32 v238, v57, v238
    v_mul_f32 v239, v57, v239
    v_cvt_pk_bf16_f32 v42, v236, v237
    v_cvt_pk_bf16_f32 v43, v238, v239
    buffer_store_dwordx4 v[40:43], v13, s[8:11], s6 offen offset:2048 sc1
    v_mul_f32 v244, v57, v244
    v_mul_f32 v245, v57, v245
    v_mul_f32 v246, v57, v246
    v_mul_f32 v247, v57, v247
    v_cvt_pk_bf16_f32 v44, v244, v245
    v_cvt_pk_bf16_f32 v45, v246, v247
    v_mul_f32 v252, v57, v252
    v_mul_f32 v253, v57, v253
    v_mul_f32 v254, v57, v254
    v_mul_f32 v255, v57, v255
    v_cvt_pk_bf16_f32 v46, v252, v253
    v_cvt_pk_bf16_f32 v47, v254, v255
    buffer_store_dwordx4 v[44:47], v13, s[8:11], s6 offen offset:3072 sc1
    s_cmp_gt_i32 s62, s63
    s_cbranch_scc1 L_pre
    s_waitcnt vmcnt(8)
    s_call_b64 s[82:83], L_pend
    s_barrier
    s_waitcnt vmcnt(0)
    s_lshl_b32 s6, s60, 5
    s_add_u32 s6, s6, s4
    s_lshl_b32 s6, s6, 7
    s_add_u32 s6, s6, 3932160
    v_mov_b32 v2, 1
    v_mov_b32 v3, 0x5000000
    v_writelane_b32 v3, s6, 0
    buffer_store_dword v2, v3, s[8:11], 0 offen sc1
    s_call_b64 s[82:83], L_load
    s_add_i32 s62, s62, 1
    s_lshl_b32 s6, s3, 8
    s_add_u32 s6, s6, s2
    s_cmp_eq_u32 s6, 31
    s_cbranch_scc1 L_top
L_idle:
    s_sub_i32 s6, s63, 5
    s_cmp_gt_i32 s62, s6
    s_cbranch_scc1 L_pre
    s_waitcnt vmcnt(0) lgkmcnt(0)
    s_call_b64 s[82:83], L_pend
    s_barrier
    s_call_b64 s[82:83], L_load
    s_add_i32 s62, s62, 1
    s_cmp_lt_u32 s61, 54
    s_cbranch_scc1 L_moe
    s_branch L_idle
L_pre:
    s_cmp_lt_u32 s3, 4
    s_cbranch_scc1 L_pre1
    s_barrier
    s_lshl_b32 s7, s76, 13
    s_add_u32 s7, s7, 0x10000
    v_add_u32 v3, s7, v13
    v_add_u32 v2, 0x10000, v3
    s_lshl_b32 s7, s76, 12
    s_add_u32 s7, s7, 0x10000
    v_add_u32 v12, s7, v13
    ds_read_b128 v[96:99], v2 offset:0
    ds_read_b128 v[100:103], v2 offset:1024
    ds_read_b128 v[104:107], v2 offset:2048
    ds_read_b128 v[108:111], v2 offset:3072
    ds_read_b128 v[112:115], v2 offset:4096
    ds_read_b128 v[116:119], v2 offset:5120
    ds_read_b128 v[120:123], v2 offset:6144
    ds_read_b128 v[124:127], v2 offset:7168
    ds_read_b128 v[128:131], v3 offset:0
    ds_read_b128 v[132:135], v3 offset:1024
    ds_read_b128 v[136:139], v3 offset:2048
    ds_read_b128 v[140:143], v3 offset:3072
    s_add_u32 s6, s76, 0
    s_and_b32 s6, s6, 3
    s_lshl_b32 s6, s6, 10
    v_add_u32 v44, s6, v13
    s_add_u32 s6, s76, 1
    s_and_b32 s6, s6, 3
    s_lshl_b32 s6, s6, 10
    v_add_u32 v45, s6, v13
    s_add_u32 s6, s76, 2
    s_and_b32 s6, s6, 3
    s_lshl_b32 s6, s6, 10
    v_add_u32 v46, s6, v13
    s_add_u32 s6, s76, 3
    s_and_b32 s6, s6, 3
    s_lshl_b32 s6, s6, 10
    v_add_u32 v47, s6, v13
    v_add_u32 v52, 4096, v13
    s_lshr_b32 s69, s4, 3
    s_lshl_b32 s69, s69, 2
    s_add_u32 s69, s69, s76
    s_mul_i32 s69, s69, 327680
    s_and_b32 s7, s4, 3
    s_mul_i32 s7, s7, 10240
    s_add_u32 s69, s69, s7
    s_add_u32 s69, s69, 4199424
    s_and_b32 s6, s4, 4
    s_lshr_b32 s7, s4, 3
    s_add_u32 s6, s6, s7
    s_lshl_b32 s7, s5, 3
    s_add_u32 s68, s6, s7
    s_sub_u32 s7, 120, s7
    s_add_u32 s61, s6, s7
    s_lshr_b32 s6, s4, 3
    s_lshl_b32 s6, s6, 15
    s_lshl_b32 s99, s3, 12
    s_add_u32 s66, s6, s99
    s_add_u32 s66, s66, 50331648
    s_lshl_b32 s6, s76, 13
    v_add_u32 v4, s6, v13
    v_add_u32 v7, 65536, v4
    ds_read_b128 v[144:147], v3 offset:4096
    ds_read_b128 v[148:151], v3 offset:5120
    ds_read_b128 v[152:155], v3 offset:6144
    ds_read_b128 v[156:159], v3 offset:7168
    ds_read_b128 v[160:163], v12 offset:49152
    ds_read_b128 v[164:167], v12 offset:50176
    ds_read_b128 v[168:171], v12 offset:51200
    ds_read_b128 v[172:175], v12 offset:52224
    s_add_u32 s75, s69, 163840
    buffer_load_dwordx4 v[176:179], v44, s[8:11], s75 offen sc1
    buffer_load_dwordx4 v[180:183], v45, s[8:11], s75 offen sc1
    buffer_load_dwordx4 v[184:187], v46, s[8:11], s75 offen sc1
    buffer_load_dwordx4 v[188:191], v47, s[8:11], s75 offen sc1
    buffer_load_dwordx4 v[192:195], v52, s[8:11], s75 offen sc1
    s_waitcnt vmcnt(5)
    s_lshl_b32 s6, s60, 5
    s_add_u32 s6, s6, s4
    s_lshl_b32 s6, s6, 7
    s_add_u32 s6, s6, 3932160
    v_mov_b32 v2, 1
    v_mov_b32 v3, 0x5000000
    v_writelane_b32 v3, s6, 0
    buffer_store_dword v2, v3, s[8:11], 0 offen sc1
    s_add_u32 s75, s69, 204800
    buffer_load_dwordx4 v[196:199], v44, s[8:11], s75 offen sc1
    buffer_load_dwordx4 v[200:203], v45, s[8:11], s75 offen sc1
    buffer_load_dwordx4 v[204:207], v46, s[8:11], s75 offen sc1
    buffer_load_dwordx4 v[208:211], v47, s[8:11], s75 offen sc1
    buffer_load_dwordx4 v[212:215], v52, s[8:11], s75 offen sc1
    s_add_u32 s75, s69, 245760
    buffer_load_dwordx4 v[216:219], v44, s[8:11], s75 offen sc1
    buffer_load_dwordx4 v[220:223], v45, s[8:11], s75 offen sc1
    buffer_load_dwordx4 v[224:227], v46, s[8:11], s75 offen sc1
    buffer_load_dwordx4 v[228:231], v47, s[8:11], s75 offen sc1
    buffer_load_dwordx4 v[232:235], v52, s[8:11], s75 offen sc1
    s_add_u32 s75, s69, 286720
    buffer_load_dwordx4 v[236:239], v44, s[8:11], s75 offen sc1
    buffer_load_dwordx4 v[240:243], v45, s[8:11], s75 offen sc1
    buffer_load_dwordx4 v[244:247], v46, s[8:11], s75 offen sc1
    buffer_load_dwordx4 v[248:251], v47, s[8:11], s75 offen sc1
    buffer_load_dwordx4 v[252:255], v52, s[8:11], s75 offen sc1
    s_waitcnt lgkmcnt(0)
    s_barrier
    s_branch L_adone
L_pre1:
    s_mov_b32 s28, s56
    s_mov_b32 s29, s57
    s_mov_b32 s30, 0x100
    s_mov_b32 s31, 0x20000
    v_and_b32 v3, 31, v1
    v_lshlrev_b32 v3, 2, v3
    s_mov_b32 s79, 262144
L_poll_24:
    buffer_load_dword v2, v3, s[28:31], 0 offen offset:128 sc1
    s_waitcnt vmcnt(0)
    v_cmp_gt_u32 vcc, 4, v2
    s_cbranch_vccz L_polldone_25
    s_sleep 8
    s_sub_u32 s79, s79, 1
    s_cmp_lg_u32 s79, 0
    s_cbranch_scc1 L_poll_24
L_polldone_25:
    s_mov_b32 s90, 1
    v_and_b32 v3, 7, v1
    v_lshlrev_b32 v3, 2, v3
    s_mov_b32 s72, 0x3a0000
    buffer_load_dword v51, v3, s[8:11], s72 offen sc1
    s_add_u32 s6, s76, 0
    s_and_b32 s6, s6, 3
    s_lshl_b32 s6, s6, 10
    v_add_u32 v44, s6, v13
    s_add_u32 s6, s76, 1
    s_and_b32 s6, s6, 3
    s_lshl_b32 s6, s6, 10
    v_add_u32 v45, s6, v13
    s_add_u32 s6, s76, 2
    s_and_b32 s6, s6, 3
    s_lshl_b32 s6, s6, 10
    v_add_u32 v46, s6, v13
    s_add_u32 s6, s76, 3
    s_and_b32 s6, s6, 3
    s_lshl_b32 s6, s6, 10
    v_add_u32 v47, s6, v13
    v_add_u32 v52, 4096, v13
    s_lshr_b32 s69, s4, 3
    s_lshl_b32 s69, s69, 2
    s_add_u32 s69, s69, s76
    s_mul_i32 s69, s69, 327680
    s_and_b32 s7, s4, 3
    s_mul_i32 s7, s7, 10240
    s_add_u32 s69, s69, s7
    s_add_u32 s69, s69, 4194304
    s_and_b32 s6, s4, 4
    s_lshr_b32 s7, s4, 3
    s_add_u32 s6, s6, s7
    s_lshl_b32 s7, s5, 3
    s_add_u32 s68, s6, s7
    s_sub_u32 s7, 120, s7
    s_add_u32 s61, s6, s7
    s_sub_i32 s6, s63, 4
    s_cmp_gt_i32 s62, s6
    s_cbranch_scc1 L_e2
    s_cmp_eq_i32 s62, s63
    s_cbranch_scc1 L_lw0
    s_waitcnt vmcnt(1)
L_lw0:
    s_waitcnt vmcnt(20)
    s_call_b64 s[82:83], L_pend
    s_barrier
    s_call_b64 s[82:83], L_load
    s_add_i32 s62, s62, 1
L_e2:
    s_add_u32 s75, s69, 0
    buffer_load_dwordx4 v[96:99], v44, s[8:11], s75 offen sc1
    buffer_load_dwordx4 v[100:103], v45, s[8:11], s75 offen sc1
    buffer_load_dwordx4 v[104:107], v46, s[8:11], s75 offen sc1
    buffer_load_dwordx4 v[108:111], v47, s[8:11], s75 offen sc1
    buffer_load_dwordx4 v[112:115], v52, s[8:11], s75 offen sc1
    s_add_u32 s75, s69, 40960
    buffer_load_dwordx4 v[116:119], v44, s[8:11], s75 offen sc1
    buffer_load_dwordx4 v[120:123], v45, s[8:11], s75 offen sc1
    buffer_load_dwordx4 v[124:127], v46, s[8:11], s75 offen sc1
    buffer_load_dwordx4 v[128:131], v47, s[8:11], s75 offen sc1
    buffer_load_dwordx4 v[132:135], v52, s[8:11], s75 offen sc1
    s_add_u32 s75, s69, 81920
    buffer_load_dwordx4 v[136:139], v44, s[8:11], s75 offen sc1
    buffer_load_dwordx4 v[140:143], v45, s[8:11], s75 offen sc1
    buffer_load_dwordx4 v[144:147], v46, s[8:11], s75 offen sc1
    buffer_load_dwordx4 v[148:151], v47, s[8:11], s75 offen sc1
    buffer_load_dwordx4 v[152:155], v52, s[8:11], s75 offen sc1
    s_cmp_gt_i32 s62, s63
    s_cbranch_scc1 L_e3
    s_cmp_eq_i32 s62, s63
    s_cbranch_scc1 L_lw1
    s_waitcnt vmcnt(15)
L_lw1:
    s_waitcnt vmcnt(20)
    s_call_b64 s[82:83], L_pend
    s_barrier
    s_call_b64 s[82:83], L_load
    s_add_i32 s62, s62, 1
L_e3:
    s_add_u32 s75, s69, 122880
    buffer_load_dwordx4 v[156:159], v44, s[8:11], s75 offen sc1
    buffer_load_dwordx4 v[160:163], v45, s[8:11], s75 offen sc1
    buffer_load_dwordx4 v[164:167], v46, s[8:11], s75 offen sc1
    buffer_load_dwordx4 v[168:171], v47, s[8:11], s75 offen sc1
    buffer_load_dwordx4 v[172:175], v52, s[8:11], s75 offen sc1
    s_add_u32 s75, s69, 163840
    buffer_load_dwordx4 v[176:179], v44, s[8:11], s75 offen sc1
    buffer_load_dwordx4 v[180:183], v45, s[8:11], s75 offen sc1
    buffer_load_dwordx4 v[184:187], v46, s[8:11], s75 offen sc1
    buffer_load_dwordx4 v[188:191], v47, s[8:11], s75 offen sc1
    buffer_load_dwordx4 v[192:195], v52, s[8:11], s75 offen sc1
    s_add_u32 s75, s69, 204800
    buffer_load_dwordx4 v[196:199], v44, s[8:11], s75 offen sc1
    buffer_load_dwordx4 v[200:203], v45, s[8:11], s75 offen sc1
    buffer_load_dwordx4 v[204:207], v46, s[8:11], s75 offen sc1
    buffer_load_dwordx4 v[208:211], v47, s[8:11], s75 offen sc1
    buffer_load_dwordx4 v[212:215], v52, s[8:11], s75 offen sc1
    s_cmp_gt_i32 s62, s63
    s_cbranch_scc1 L_e4
    s_cmp_eq_i32 s62, s63
    s_cbranch_scc1 L_lw2
    s_waitcnt vmcnt(15)
L_lw2:
    s_waitcnt vmcnt(20)
    s_call_b64 s[82:83], L_pend
    s_barrier
    s_call_b64 s[82:83], L_load
    s_add_i32 s62, s62, 1
L_e4:
    s_lshr_b32 s7, s3, 1
    s_lshl_b32 s7, s7, 4
    s_add_u32 s6, s5, s7
    s_cmp_lg_u32 s6, 3
    s_cbranch_scc1 L_yl0
    v_min_u32 v3, 53, v1
    v_lshlrev_b32 v3, 7, v3
    s_mov_b32 s72, 0xf20000
    buffer_load_dwordx4 v[16:19], v3, s[8:11], s72 offen sc1
L_yl0:
    s_add_u32 s75, s69, 245760
    buffer_load_dwordx4 v[216:219], v44, s[8:11], s75 offen sc1
    buffer_load_dwordx4 v[220:223], v45, s[8:11], s75 offen sc1
    buffer_load_dwordx4 v[224:227], v46, s[8:11], s75 offen sc1
    buffer_load_dwordx4 v[228:231], v47, s[8:11], s75 offen sc1
    buffer_load_dwordx4 v[232:235], v52, s[8:11], s75 offen sc1
    s_add_u32 s75, s69, 286720
    buffer_load_dwordx4 v[236:239], v44, s[8:11], s75 offen sc1
    buffer_load_dwordx4 v[240:243], v45, s[8:11], s75 offen sc1
    buffer_load_dwordx4 v[244:247], v46, s[8:11], s75 offen sc1
    buffer_load_dwordx4 v[248:251], v47, s[8:11], s75 offen sc1
    buffer_load_dwordx4 v[252:255], v52, s[8:11], s75 offen sc1
    s_cmp_gt_i32 s62, s63
    s_cbranch_scc1 L_e5
    s_cmp_eq_i32 s62, s63
    s_cbranch_scc1 L_lw3
    s_waitcnt vmcnt(10)
L_lw3:
    s_waitcnt vmcnt(20)
    s_call_b64 s[82:83], L_pend
    s_barrier
    s_call_b64 s[82:83], L_load
    s_add_i32 s62, s62, 1
L_e5:
    s_mov_b32 s101, 0
    s_lshr_b32 s7, s3, 1
    s_lshl_b32 s7, s7, 4
    s_add_u32 s6, s5, s7
    s_cmp_lg_u32 s6, 3
    s_cbranch_scc1 L_yl1
    v_and_b32 v16, v16, v17
    v_and_b32 v16, v16, v18
    v_and_b32 v16, v16, v19
    v_cmp_ne_u32 vcc, 1, v16
    s_cbranch_vccnz L_yl1
    s_call_b64 s[80:81], L_yld
L_yl1:
    v_and_b32 v3, 1, v1
    v_lshlrev_b32 v3, 12, v3
    v_and_b32 v2, 2, v1
    v_lshl_add_u32 v3, v2, 8, v3
    s_lshr_b32 s72, s68, 2
    s_lshl_b32 s72, s72, 6
    s_andn2_b32 s6, s4, 7
    s_add_u32 s72, s72, s6
    s_add_u32 s72, s72, s3
    s_lshl_b32 s72, s72, 7
    s_add_u32 s72, s72, 3932160
    buffer_load_dword v50, v3, s[8:11], s72 offen sc1
    s_cmp_gt_i32 s62, s63
    s_cbranch_scc1 L_e6
    s_waitcnt vmcnt(20)
    s_call_b64 s[82:83], L_pend
    s_barrier
    s_call_b64 s[82:83], L_load
    s_add_i32 s62, s62, 1
L_e6:
    s_lshr_b32 s7, s3, 1
    s_lshl_b32 s7, s7, 4
    s_add_u32 s6, s5, s7
    s_cmp_lg_u32 s6, 3
    s_cbranch_scc1 L_yd
    s_cmp_lg_u32 s101, 0
    s_cbranch_scc1 L_yf
    v_min_u32 v3, 53, v1
    v_lshlrev_b32 v3, 7, v3
    s_mov_b32 s72, 0xf20000
    s_mov_b32 s79, 262144
L_poll_31:
    buffer_load_dwordx4 v[16:19], v3, s[8:11], s72 offen sc1
    s_waitcnt vmcnt(0)
    v_and_b32 v16, v16, v17
    v_and_b32 v16, v16, v18
    v_and_b32 v16, v16, v19
    v_cmp_ne_u32 vcc, 1, v16
    s_cbranch_vccz L_polldone_32
    s_sleep 16
    s_sub_u32 s79, s79, 1
    s_cmp_lg_u32 s79, 0
    s_cbranch_scc1 L_poll_31
L_polldone_32:
    s_call_b64 s[80:81], L_yld
L_yf:
    s_bfe_u32 s6, s98, 0x10000b
    s_xor_b32 s7, s6, 0xffff
    s_bitcmp1_b32 s6, 15
    s_bitset0_b32 s6, 15
    s_cselect_b32 s6, s6, s7
    s_lshl_b32 s6, s6, 16
    v_mov_b32 v9, s6
    v_mul_f32 v9, 0xbfb8aa3b, v9
    v_exp_f32 v9, v9
    s_nop 0
    v_add_f32 v9, 1.0, v9
    v_rcp_f32 v9, v9
    s_nop 0
    v_cvt_pk_bf16_f32 v9, v9, v9
    v_lshlrev_b32 v9, 16, v9
    v_lshlrev_b32 v10, 2, v1
    v_mov_b32 v3, 0x5000000
    s_waitcnt vmcnt(0)
    v_pk_add_f32 v[16:17], v[16:17], v[20:21]
    v_pk_add_f32 v[18:19], v[18:19], v[22:23]
    v_pk_add_f32 v[16:17], v[16:17], v[24:25]
    v_pk_add_f32 v[18:19], v[18:19], v[26:27]
    v_pk_add_f32 v[16:17], v[16:17], v[28:29]
    v_pk_add_f32 v[18:19], v[18:19], v[30:31]
    v_pk_add_f32 v[16:17], v[16:17], v[32:33]
    v_pk_add_f32 v[18:19], v[18:19], v[34:35]
    v_pk_add_f32 v[16:17], v[16:17], v[36:37]
    v_pk_add_f32 v[18:19], v[18:19], v[38:39]
    v_pk_add_f32 v[16:17], v[16:17], v[40:41]
    v_pk_add_f32 v[18:19], v[18:19], v[42:43]
    v_pk_add_f32 v[16:17], v[16:17], v[56:57]
    v_pk_add_f32 v[18:19], v[18:19], v[58:59]
    v_pk_add_f32 v[16:17], v[16:17], v[60:61]
    v_pk_add_f32 v[18:19], v[18:19], v[62:63]
    v_pk_add_f32 v[16:17], v[16:17], v[64:65]
    v_pk_add_f32 v[18:19], v[18:19], v[66:67]
    v_pk_add_f32 v[16:17], v[16:17], v[68:69]
    v_pk_add_f32 v[18:19], v[18:19], v[70:71]
    v_pk_add_f32 v[16:17], v[16:17], v[72:73]
    v_pk_add_f32 v[18:19], v[18:19], v[74:75]
    v_pk_add_f32 v[16:17], v[16:17], v[76:77]
    v_pk_add_f32 v[18:19], v[18:19], v[78:79]
    v_pk_add_f32 v[16:17], v[16:17], v[80:81]
    v_pk_add_f32 v[18:19], v[18:19], v[82:83]
    v_pk_add_f32 v[16:17], v[16:17], v[84:85]
    v_pk_add_f32 v[18:19], v[18:19], v[86:87]
    v_pk_add_f32 v[16:17], v[16:17], v[88:89]
    v_pk_add_f32 v[18:19], v[18:19], v[90:91]
    v_pk_add_f32 v[16:17], v[16:17], v[92:93]
    v_pk_add_f32 v[18:19], v[18:19], v[94:95]
    v_pk_add_f32 v[16:17], v[16:17], v[4:5]
    v_pk_add_f32 v[18:19], v[18:19], v[6:7]
    ds_bpermute_b32 v20, v10, v16 offset:80
    ds_bpermute_b32 v21, v10, v17 offset:80
    ds_bpermute_b32 v22, v10, v18 offset:80
    ds_bpermute_b32 v23, v10, v19 offset:80
    ds_bpermute_b32 v24, v10, v16 offset:160
    ds_bpermute_b32 v25, v10, v17 offset:160
    ds_bpermute_b32 v26, v10, v18 offset:160
    ds_bpermute_b32 v27, v10, v19 offset:160
    s_waitcnt lgkmcnt(0)
    v_add_f32 v16, v16, v20
    v_add_f32 v16, v16, v24
    v_cvt_pk_bf16_f32 v16, v16, v16
    v_lshlrev_b32 v16, 16, v16
    v_mul_f32 v16, v16, v9
    v_cvt_pk_bf16_f32 v16, v16, v16
    v_lshlrev_b32 v16, 16, v16
    v_lshlrev_b32 v8, 16, v54
    v_add_f32 v16, v16, v8
    v_add_f32 v17, v17, v21
    v_add_f32 v17, v17, v25
    v_cvt_pk_bf16_f32 v17, v17, v17
    v_lshlrev_b32 v17, 16, v17
    v_mul_f32 v17, v17, v9
    v_cvt_pk_bf16_f32 v17, v17, v17
    v_lshlrev_b32 v17, 16, v17
    v_and_b32 v8, 0xffff0000, v54
    v_add_f32 v17, v17, v8
    v_add_f32 v18, v18, v22
    v_add_f32 v18, v18, v26
    v_cvt_pk_bf16_f32 v18, v18, v18
    v_lshlrev_b32 v18, 16, v18
    v_mul_f32 v18, v18, v9
    v_cvt_pk_bf16_f32 v18, v18, v18
    v_lshlrev_b32 v18, 16, v18
    v_lshlrev_b32 v8, 16, v55
    v_add_f32 v18, v18, v8
    v_add_f32 v19, v19, v23
    v_add_f32 v19, v19, v27
    v_cvt_pk_bf16_f32 v19, v19, v19
    v_lshlrev_b32 v19, 16, v19
    v_mul_f32 v19, v19, v9
    v_cvt_pk_bf16_f32 v19, v19, v19
    v_lshlrev_b32 v19, 16, v19
    v_and_b32 v8, 0xffff0000, v55
    v_add_f32 v19, v19, v8
    v_cvt_pk_bf16_f32 v20, v16, v17
    v_cvt_pk_bf16_f32 v21, v18, v19
    v_lshlrev_b32 v2, 3, v1
    v_cmp_lt_u32 vcc, 19, v1
    s_mul_i32 s6, s96, 1280
    s_mul_i32 s7, s97, 160
    v_cndmask_b32 v2, v2, v3, vcc
    s_add_u32 s6, s6, s7
    s_add_u32 s6, s6, 3837952
    buffer_store_dwordx2 v[20:21], v2, s[8:11], s6 offen sc1
L_yd:
    s_lshr_b32 s6, s4, 3
    s_lshl_b32 s6, s6, 15
    s_lshl_b32 s99, s3, 12
    s_add_u32 s66, s6, s99
    s_add_u32 s66, s66, 50331648
    s_lshl_b32 s6, s76, 13
    v_add_u32 v4, s6, v13
    v_add_u32 v7, 65536, v4
    s_waitcnt vmcnt(0)
    v_cmp_ne_u32 vcc, 1, v50
    s_cbranch_vccz L_ce
    v_and_b32 v3, 1, v1
    v_lshlrev_b32 v3, 12, v3
    v_and_b32 v2, 2, v1
    v_lshl_add_u32 v3, v2, 8, v3
    s_lshr_b32 s72, s68, 2
    s_lshl_b32 s72, s72, 6
    s_andn2_b32 s6, s4, 7
    s_add_u32 s72, s72, s6
    s_add_u32 s72, s72, s3
    s_lshl_b32 s72, s72, 7
    s_add_u32 s72, s72, 3932160
    s_mov_b32 s79, 262144
L_poll_33:
    buffer_load_dword v2, v3, s[8:11], s72 offen sc1
    s_waitcnt vmcnt(0)
    v_cmp_ne_u32 vcc, 1, v2
    s_cbranch_vccz L_polldone_34
    s_sleep 4
    s_sub_u32 s79, s79, 1
    s_cmp_lg_u32 s79, 0
    s_cbranch_scc1 L_poll_33
L_polldone_34:
L_ce:
    s_add_u32 s65, s68, 1
    s_and_b32 s65, s65, 3
    s_andn2_b32 s7, s68, 3
    s_add_u32 s65, s65, s7
    s_lshl_b32 s65, s65, 17
    s_add_u32 s65, s65, s66
    s_add_u32 m0, s99, 0
    s_add_u32 s65, s65, 0
    buffer_load_dwordx4 v13, s[8:11], s65 offen offset:0 sc1 lds
    buffer_load_dwordx4 v13, s[8:11], s65 offen offset:1024 sc1 lds
    buffer_load_dwordx4 v13, s[8:11], s65 offen offset:2048 sc1 lds
    buffer_load_dwordx4 v13, s[8:11], s65 offen offset:3072 sc1 lds
    s_add_u32 s65, s68, 1
    s_and_b32 s65, s65, 3
    s_andn2_b32 s7, s68, 3
    s_add_u32 s65, s65, s7
    s_lshl_b32 s65, s65, 17
    s_add_u32 s65, s65, s66
    s_add_u32 m0, s99, 16384
    s_add_u32 s65, s65, 16384
    buffer_load_dwordx4 v13, s[8:11], s65 offen offset:0 sc1 lds
    buffer_load_dwordx4 v13, s[8:11], s65 offen offset:1024 sc1 lds
    buffer_load_dwordx4 v13, s[8:11], s65 offen offset:2048 sc1 lds
    buffer_load_dwordx4 v13, s[8:11], s65 offen offset:3072 sc1 lds
    s_add_u32 s65, s68, 2
    s_and_b32 s65, s65, 3
    s_andn2_b32 s7, s68, 3
    s_add_u32 s65, s65, s7
    s_lshl_b32 s65, s65, 17
    s_add_u32 s65, s65, s66
    s_add_u32 m0, s99, 32768
    s_add_u32 s65, s65, 0
    buffer_load_dwordx4 v13, s[8:11], s65 offen offset:0 sc1 lds
    buffer_load_dwordx4 v13, s[8:11], s65 offen offset:1024 sc1 lds
    buffer_load_dwordx4 v13, s[8:11], s65 offen offset:2048 sc1 lds
    buffer_load_dwordx4 v13, s[8:11], s65 offen offset:3072 sc1 lds
    s_add_u32 s65, s68, 2
    s_and_b32 s65, s65, 3
    s_andn2_b32 s7, s68, 3
    s_add_u32 s65, s65, s7
    s_lshl_b32 s65, s65, 17
    s_add_u32 s65, s65, s66
    s_add_u32 m0, s99, 49152
    s_add_u32 s65, s65, 16384
    buffer_load_dwordx4 v13, s[8:11], s65 offen offset:0 sc1 lds
    buffer_load_dwordx4 v13, s[8:11], s65 offen offset:1024 sc1 lds
    buffer_load_dwordx4 v13, s[8:11], s65 offen offset:2048 sc1 lds
    buffer_load_dwordx4 v13, s[8:11], s65 offen offset:3072 sc1 lds
    s_lshr_b32 s7, s3, 1
    s_lshl_b32 s7, s7, 4
    s_add_u32 s6, s5, s7
    s_cmp_lg_u32 s6, 3
    s_cbranch_scc1 L_yg
    s_lshl_b32 s6, s5, 5
    s_add_u32 s6, s6, s4
    s_lshl_b32 s6, s6, 5
    s_add_u32 s6, s6, s3
    s_lshl_b32 s6, s6, 2
    s_add_u32 s6, s6, 3899392
    v_mov_b32 v2, 1
    v_mov_b32 v3, 0x5000000
    v_writelane_b32 v3, s6, 0
    buffer_store_dword v2, v3, s[8:11], 0 offen sc1
    s_waitcnt vmcnt(1)
    s_branch L_ye
L_yg:
    s_waitcnt vmcnt(0)
L_ye:
    s_setprio 0
    s_barrier
    s_branch L_adone
L_yld:
    v_cmp_le_i32 vcc, 0, v51
    s_cbranch_vccz L_idx_oka
    v_and_b32 v3, 7, v1
    v_lshlrev_b32 v3, 2, v3
    s_mov_b32 s72, 0x3a0000
    s_mov_b32 s79, 262144
L_poll_35:
    buffer_load_dword v51, v3, s[8:11], s72 offen sc1
    s_waitcnt vmcnt(0)
    v_cmp_le_i32 vcc, 0, v51
    s_cbranch_vccz L_polldone_36
    s_sleep 2
    s_sub_u32 s79, s79, 1
    s_cmp_lg_u32 s79, 0
    s_cbranch_scc1 L_poll_35
L_polldone_36:
L_idx_oka:
    s_lshr_b32 s96, s4, 2
    s_and_b32 s97, s4, 3
    s_lshl_b32 s97, s97, 1
    s_add_u32 s97, s97, s3
    s_mov_b32 m0, s96
    s_nop 3
    v_readlane_b32 s98, v51, m0
    s_nop 3
    s_and_b32 s100, s98, 0x7ff
    s_sub_u32 s100, 0x7ff, s100
    v_mul_u32_u24 v2, 13, v1
    v_lshrrev_b32 v2, 8, v2
    v_mul_u32_u24 v3, 20, v2
    v_sub_u32 v8, v1, v3
    s_mov_b32 s6, 368640
    v_mul_lo_u32 v2, v2, s6
    v_lshl_add_u32 v2, v8, 4, v2
    v_cmp_lt_u32 vcc, 59, v1
    v_mov_b32 v3, 0x5000000
    s_nop 0
    v_cndmask_b32 v2, v2, v3, vcc
    s_mul_i32 s6, s96, 2560
    s_mul_i32 s7, s97, 320
    s_add_u32 s6, s6, s7
    s_add_u32 s6, s6, 2686976
    buffer_load_dwordx4 v[16:19], v2, s[8:11], s6 offen sc1
    s_add_u32 s6, s6, 20480
    buffer_load_dwordx4 v[20:23], v2, s[8:11], s6 offen sc1
    s_add_u32 s6, s6, 20480
    buffer_load_dwordx4 v[24:27], v2, s[8:11], s6 offen sc1
    s_add_u32 s6, s6, 20480
    buffer_load_dwordx4 v[28:31], v2, s[8:11], s6 offen sc1
    s_add_u32 s6, s6, 20480
    buffer_load_dwordx4 v[32:35], v2, s[8:11], s6 offen sc1
    s_add_u32 s6, s6, 20480
    buffer_load_dwordx4 v[36:39], v2, s[8:11], s6 offen sc1
    s_add_u32 s6, s6, 20480
    buffer_load_dwordx4 v[40:43], v2, s[8:11], s6 offen sc1
    s_add_u32 s6, s6, 20480
    buffer_load_dwordx4 v[56:59], v2, s[8:11], s6 offen sc1
    s_add_u32 s6, s6, 20480
    buffer_load_dwordx4 v[60:63], v2, s[8:11], s6 offen sc1
    s_add_u32 s6, s6, 20480
    buffer_load_dwordx4 v[64:67], v2, s[8:11], s6 offen sc1
    s_add_u32 s6, s6, 20480
    buffer_load_dwordx4 v[68:71], v2, s[8:11], s6 offen sc1
    s_add_u32 s6, s6, 20480
    buffer_load_dwordx4 v[72:75], v2, s[8:11], s6 offen sc1
    s_add_u32 s6, s6, 20480
    buffer_load_dwordx4 v[76:79], v2, s[8:11], s6 offen sc1
    s_add_u32 s6, s6, 20480
    buffer_load_dwordx4 v[80:83], v2, s[8:11], s6 offen sc1
    s_add_u32 s6, s6, 20480
    buffer_load_dwordx4 v[84:87], v2, s[8:11], s6 offen sc1
    s_add_u32 s6, s6, 20480
    buffer_load_dwordx4 v[88:91], v2, s[8:11], s6 offen sc1
    s_add_u32 s6, s6, 20480
    buffer_load_dwordx4 v[92:95], v2, s[8:11], s6 offen sc1
    s_add_u32 s6, s6, 20480
    buffer_load_dwordx4 v[4:7], v2, s[8:11], s6 offen sc1
    s_add_u32 s6, s6, 20480
    s_lshr_b32 s6, s100, 4
    s_mul_i32 s6, s6, 20480
    s_and_b32 s7, s100, 15
    s_lshl_b32 s7, s7, 4
    s_add_u32 s6, s6, s7
    s_mul_i32 s7, s97, 2560
    s_add_u32 s6, s6, s7
    v_lshrrev_b32 v9, 1, v8
    v_lshlrev_b32 v9, 8, v9
    v_and_b32 v10, 1, v8
    v_lshl_add_u32 v9, v10, 3, v9
    buffer_load_dwordx2 v[54:55], v9, s[8:11], s6 offen sc1
    s_mov_b32 s101, 1
    s_setpc_b64 s[80:81]
L_moe:
    s_sub_u32 s6, s62, s5
    s_cmp_lg_u32 s6, 3
    s_cbranch_scc1 L_idle
    s_mov_b32 s12, s48
    s_mov_b32 s13, s49
    s_mov_b32 s14, 0x21c000
    s_mov_b32 s15, 0x20000
    s_cmp_ge_u32 s3, 2
    s_cselect_b32 s12, s50, s12
    s_cselect_b32 s13, s51, s13
    s_mov_b32 s16, s52
    s_mov_b32 s17, s53
    s_mov_b32 s18, 0x21c000
    s_mov_b32 s19, 0x20000
    v_lshrrev_b32 v3, 2, v1
    v_mul_u32_u24 v3, 3456, v3
    v_and_b32 v4, 3, v1
    v_lshl_add_u32 v16, v4, 4, v3
    v_lshrrev_b32 v3, 3, v1
    v_mul_u32_u24 v3, 1280, v3
    v_and_b32 v4, 7, v1
    v_lshl_add_u32 v18, v4, 4, v3
    s_and_b32 s7, s3, 1
    s_mul_i32 s84, s7, 1105920
    s_lshl_b32 s6, s61, 6
    s_add_u32 s84, s84, s6
    s_lshl_b32 s85, s3, 13
    s_add_u32 s85, s85, 131072
    s_mul_i32 s86, s61, 40960
    s_lshl_b32 s6, s3, 7
    s_add_u32 s86, s86, s6
    s_add_u32 m0, s85, 0
    s_nop 0
    buffer_load_dwordx4 v16, s[12:15], s84 offen lds
    s_add_u32 s84, s84, 55296
    s_add_u32 m0, s85, 1024
    s_nop 0
    buffer_load_dwordx4 v16, s[12:15], s84 offen lds
    s_add_u32 s84, s84, 55296
    s_add_u32 m0, s85, 2048
    s_nop 0
    buffer_load_dwordx4 v16, s[12:15], s84 offen lds
    s_add_u32 s84, s84, 55296
    s_add_u32 m0, s85, 3072
    s_nop 0
    buffer_load_dwordx4 v16, s[12:15], s84 offen lds
    s_add_u32 s84, s84, 55296
    s_add_u32 m0, s85, 4096
    s_nop 0
    buffer_load_dwordx4 v16, s[12:15], s84 offen lds
    s_add_u32 s84, s84, 55296
    s_add_u32 m0, s85, 5120
    s_nop 0
    buffer_load_dwordx4 v16, s[12:15], s84 offen lds
    s_add_u32 s84, s84, 55296
    s_add_u32 m0, s85, 6144
    s_nop 0
    buffer_load_dwordx4 v16, s[12:15], s84 offen lds
    s_add_u32 s84, s84, 55296
    s_add_u32 m0, s85, 7168
    s_nop 0
    buffer_load_dwordx4 v16, s[12:15], s84 offen lds
    s_add_u32 s84, s84, 55296
    v_lshrrev_b32 v7, 4, v1
    v_and_b32 v2, 15, v1
    v_lshrrev_b32 v3, 2, v2
    v_lshl_add_u32 v8, v7, 3, v3
    v_lshlrev_b32 v8, 6, v8
    v_and_b32 v4, 3, v2
    v_lshl_add_u32 v8, v4, 3, v8
    v_add_u32 v17, s85, v8
    v_lshl_add_u32 v8, v7, 2, v3
    v_lshlrev_b32 v8, 7, v8
    v_lshl_add_u32 v8, v4, 3, v8
    s_add_u32 s6, s85, 4096
    v_add_u32 v19, s6, v8
    v_mul_u32_u24 v3, 2560, v2
    v_lshl_add_u32 v3, v7, 4, v3
    v_mov_b32 v4, 0x5000000
    v_cmp_gt_u32 vcc, 8, v2
    s_mul_i32 s87, s61, 20480
    s_lshl_b32 s7, s3, 8
    s_add_u32 s87, s87, s7
    s_add_u32 s87, s87, 2686976
    v_cndmask_b32 v20, v4, v3, vcc
    s_and_b32 s7, s3, 1
    s_mul_i32 s88, s7, 10240
    s_add_u32 s88, s88, 12582912
    s_waitcnt vmcnt(0) lgkmcnt(0)
    s_call_b64 s[82:83], L_pend
    s_barrier
    ds_read_b64_tr_b16 v[104:105], v17 offset:0
    ds_read_b64_tr_b16 v[106:107], v17 offset:256
    ds_read_b64_tr_b16 v[108:109], v17 offset:32
    ds_read_b64_tr_b16 v[110:111], v17 offset:288
    ds_read_b64_tr_b16 v[112:113], v17 offset:2048
    ds_read_b64_tr_b16 v[114:115], v17 offset:2304
    ds_read_b64_tr_b16 v[116:117], v17 offset:2080
    ds_read_b64_tr_b16 v[118:119], v17 offset:2336
    s_waitcnt lgkmcnt(0)
    ds_read_b64_tr_b16 v[120:121], v17 offset:4096
    ds_read_b64_tr_b16 v[122:123], v17 offset:4352
    ds_read_b64_tr_b16 v[124:125], v17 offset:4128
    ds_read_b64_tr_b16 v[126:127], v17 offset:4384
    ds_read_b64_tr_b16 v[128:129], v17 offset:6144
    ds_read_b64_tr_b16 v[130:131], v17 offset:6400
    ds_read_b64_tr_b16 v[132:133], v17 offset:6176
    ds_read_b64_tr_b16 v[134:135], v17 offset:6432
    s_waitcnt lgkmcnt(0)
    s_add_u32 m0, s85, 0
    s_nop 0
    buffer_load_dwordx4 v16, s[12:15], s84 offen lds
    s_add_u32 s84, s84, 55296
    s_add_u32 m0, s85, 1024
    s_nop 0
    buffer_load_dwordx4 v16, s[12:15], s84 offen lds
    s_add_u32 s84, s84, 55296
    s_add_u32 m0, s85, 2048
    s_nop 0
    buffer_load_dwordx4 v16, s[12:15], s84 offen lds
    s_add_u32 s84, s84, 55296
    s_add_u32 m0, s85, 3072
    s_nop 0
    buffer_load_dwordx4 v16, s[12:15], s84 offen lds
    s_add_u32 s84, s84, 55296
    s_add_u32 m0, s85, 4096
    s_nop 0
    buffer_load_dwordx4 v16, s[12:15], s84 offen lds
    s_add_u32 s84, s84, 55296
    s_add_u32 m0, s85, 5120
    s_nop 0
    buffer_load_dwordx4 v16, s[12:15], s84 offen lds
    s_add_u32 s84, s84, 55296
    s_add_u32 m0, s85, 6144
    s_nop 0
    buffer_load_dwordx4 v16, s[12:15], s84 offen lds
    s_add_u32 s84, s84, 55296
    s_add_u32 m0, s85, 7168
    s_nop 0
    buffer_load_dwordx4 v16, s[12:15], s84 offen lds
    s_add_u32 s84, s84, 55296
    s_call_b64 s[82:83], L_load
    s_add_i32 s62, s62, 1
    v_and_b32 v3, 7, v1
    v_lshlrev_b32 v3, 2, v3
    s_mov_b32 s72, 0x3a0000
    buffer_load_dword v51, v3, s[8:11], s72 offen sc1
    s_waitcnt vmcnt(0) lgkmcnt(0)
    s_call_b64 s[82:83], L_pend
    s_barrier
    ds_read_b64_tr_b16 v[136:137], v17 offset:0
    ds_read_b64_tr_b16 v[138:139], v17 offset:256
    ds_read_b64_tr_b16 v[140:141], v17 offset:32
    ds_read_b64_tr_b16 v[142:143], v17 offset:288
    ds_read_b64_tr_b16 v[144:145], v17 offset:2048
    ds_read_b64_tr_b16 v[146:147], v17 offset:2304
    ds_read_b64_tr_b16 v[148:149], v17 offset:2080
    ds_read_b64_tr_b16 v[150:151], v17 offset:2336
    s_waitcnt lgkmcnt(0)
    ds_read_b64_tr_b16 v[152:153], v17 offset:4096
    ds_read_b64_tr_b16 v[154:155], v17 offset:4352
    ds_read_b64_tr_b16 v[156:157], v17 offset:4128
    ds_read_b64_tr_b16 v[158:159], v17 offset:4384
    ds_read_b64_tr_b16 v[160:161], v17 offset:6144
    ds_read_b64_tr_b16 v[162:163], v17 offset:6400
    ds_read_b64_tr_b16 v[164:165], v17 offset:6176
    ds_read_b64_tr_b16 v[166:167], v17 offset:6432
    s_waitcnt lgkmcnt(0)
    s_add_u32 m0, s85, 0
    s_nop 0
    buffer_load_dwordx4 v16, s[12:15], s84 offen lds
    s_add_u32 s84, s84, 55296
    s_add_u32 m0, s85, 1024
    s_nop 0
    buffer_load_dwordx4 v16, s[12:15], s84 offen lds
    s_add_u32 s84, s84, 55296
    s_add_u32 m0, s85, 2048
    s_nop 0
    buffer_load_dwordx4 v16, s[12:15], s84 offen lds
    s_add_u32 s84, s84, 55296
    s_add_u32 m0, s85, 3072
    s_nop 0
    buffer_load_dwordx4 v16, s[12:15], s84 offen lds
    s_add_u32 s84, s84, 55296
    s_add_u32 m0, s85, 4096
    s_add_u32 s6, s86, 0
    buffer_load_dwordx4 v18, s[16:19], s6 offen lds
    s_add_u32 m0, s85, 5120
    s_add_u32 s6, s86, 10240
    buffer_load_dwordx4 v18, s[16:19], s6 offen lds
    s_add_u32 m0, s85, 6144
    s_add_u32 s6, s86, 20480
    buffer_load_dwordx4 v18, s[16:19], s6 offen lds
    s_add_u32 m0, s85, 7168
    s_add_u32 s6, s86, 30720
    buffer_load_dwordx4 v18, s[16:19], s6 offen lds
    s_add_u32 s86, s86, 512
    s_call_b64 s[82:83], L_load
    s_add_i32 s62, s62, 1
    v_cmp_le_i32 vcc, 0, v51
    s_cbranch_vccz L_idx_okm
    v_and_b32 v3, 7, v1
    v_lshlrev_b32 v3, 2, v3
    s_mov_b32 s72, 0x3a0000
    s_mov_b32 s79, 262144
L_poll_39:
    buffer_load_dword v51, v3, s[8:11], s72 offen sc1
    s_waitcnt vmcnt(0)
    v_cmp_le_i32 vcc, 0, v51
    s_cbranch_vccz L_polldone_40
    s_sleep 2
    s_sub_u32 s79, s79, 1
    s_cmp_lg_u32 s79, 0
    s_cbranch_scc1 L_poll_39
L_polldone_40:
L_idx_okm:
    buffer_load_dwordx4 v[64:67], v13, s[8:11], s88 offen sc1
    s_add_u32 s88, s88, 1024
    buffer_load_dwordx4 v[68:71], v13, s[8:11], s88 offen sc1
    s_add_u32 s88, s88, 1024
    buffer_load_dwordx4 v[72:75], v13, s[8:11], s88 offen sc1
    s_add_u32 s88, s88, 1024
    buffer_load_dwordx4 v[76:79], v13, s[8:11], s88 offen sc1
    s_add_u32 s88, s88, 1024
    buffer_load_dwordx4 v[80:83], v13, s[8:11], s88 offen sc1
    s_add_u32 s88, s88, 1024
    buffer_load_dwordx4 v[84:87], v13, s[8:11], s88 offen sc1
    s_add_u32 s88, s88, 1024
    buffer_load_dwordx4 v[88:91], v13, s[8:11], s88 offen sc1
    s_add_u32 s88, s88, 1024
    buffer_load_dwordx4 v[92:95], v13, s[8:11], s88 offen sc1
    s_add_u32 s88, s88, 1024
    buffer_load_dwordx4 v[96:99], v13, s[8:11], s88 offen sc1
    s_add_u32 s88, s88, 1024
    buffer_load_dwordx4 v[100:103], v13, s[8:11], s88 offen sc1
    s_add_u32 s88, s88, 1024
    s_waitcnt vmcnt(10) lgkmcnt(0)
    s_call_b64 s[82:83], L_pend
    s_barrier
    ds_read_b64_tr_b16 v[168:169], v17 offset:0
    ds_read_b64_tr_b16 v[170:171], v17 offset:256
    ds_read_b64_tr_b16 v[172:173], v17 offset:32
    ds_read_b64_tr_b16 v[174:175], v17 offset:288
    ds_read_b64_tr_b16 v[176:177], v17 offset:2048
    ds_read_b64_tr_b16 v[178:179], v17 offset:2304
    ds_read_b64_tr_b16 v[180:181], v17 offset:2080
    ds_read_b64_tr_b16 v[182:183], v17 offset:2336
    s_waitcnt lgkmcnt(0)
    ds_read_b64_tr_b16 v[32:33], v19 offset:0
    ds_read_b64_tr_b16 v[34:35], v19 offset:2048
    ds_read_b64_tr_b16 v[36:37], v19 offset:32
    ds_read_b64_tr_b16 v[38:39], v19 offset:2080
    ds_read_b64_tr_b16 v[40:41], v19 offset:64
    ds_read_b64_tr_b16 v[42:43], v19 offset:2112
    ds_read_b64_tr_b16 v[44:45], v19 offset:96
    ds_read_b64_tr_b16 v[46:47], v19 offset:2144
    s_waitcnt lgkmcnt(0)
    s_add_u32 m0, s85, 4096
    s_add_u32 s6, s86, 0
    buffer_load_dwordx4 v18, s[16:19], s6 offen lds
    s_add_u32 m0, s85, 5120
    s_add_u32 s6, s86, 10240
    buffer_load_dwordx4 v18, s[16:19], s6 offen lds
    s_add_u32 m0, s85, 6144
    s_add_u32 s6, s86, 20480
    buffer_load_dwordx4 v18, s[16:19], s6 offen lds
    s_add_u32 m0, s85, 7168
    s_add_u32 s6, s86, 30720
    buffer_load_dwordx4 v18, s[16:19], s6 offen lds
    s_add_u32 s86, s86, 512
    s_call_b64 s[82:83], L_load
    s_add_i32 s62, s62, 1
    s_waitcnt vmcnt(20)
    v_mfma_f32_16x16x32_bf16 v[24:27], v[104:107], v[64:67], 0
    v_mfma_f32_16x16x32_bf16 v[28:31], v[108:111], v[64:67], 0
    v_mfma_f32_16x16x32_bf16 v[24:27], v[112:115], v[68:71], v[24:27]
    v_mfma_f32_16x16x32_bf16 v[28:31], v[116:119], v[68:71], v[28:31]
    v_mfma_f32_16x16x32_bf16 v[24:27], v[120:123], v[72:75], v[24:27]
    v_mfma_f32_16x16x32_bf16 v[28:31], v[124:127], v[72:75], v[28:31]
    v_mfma_f32_16x16x32_bf16 v[24:27], v[128:131], v[76:79], v[24:27]
    v_mfma_f32_16x16x32_bf16 v[28:31], v[132:135], v[76:79], v[28:31]
    v_mfma_f32_16x16x32_bf16 v[24:27], v[136:139], v[80:83], v[24:27]
    v_mfma_f32_16x16x32_bf16 v[28:31], v[140:143], v[80:83], v[28:31]
    v_mfma_f32_16x16x32_bf16 v[24:27], v[144:147], v[84:87], v[24:27]
    v_mfma_f32_16x16x32_bf16 v[28:31], v[148:151], v[84:87], v[28:31]
    v_mfma_f32_16x16x32_bf16 v[24:27], v[152:155], v[88:91], v[24:27]
    v_mfma_f32_16x16x32_bf16 v[28:31], v[156:159], v[88:91], v[28:31]
    v_mfma_f32_16x16x32_bf16 v[24:27], v[160:163], v[92:95], v[24:27]
    v_mfma_f32_16x16x32_bf16 v[28:31], v[164:167], v[92:95], v[28:31]
    v_mfma_f32_16x16x32_bf16 v[24:27], v[168:171], v[96:99], v[24:27]
    v_mfma_f32_16x16x32_bf16 v[28:31], v[172:175], v[96:99], v[28:31]
    v_mfma_f32_16x16x32_bf16 v[24:27], v[176:179], v[100:103], v[24:27]
    v_mfma_f32_16x16x32_bf16 v[28:31], v[180:183], v[100:103], v[28:31]
    v_add_u32 v10, s85, v13
    s_nop 7
    ds_write_b128 v10, v[24:27]
    ds_write_b128 v10, v[28:31] offset:1024
    s_waitcnt vmcnt(0) lgkmcnt(0)
    s_call_b64 s[82:83], L_pend
    s_barrier
    ds_read_b64_tr_b16 v[240:241], v19 offset:0
    ds_read_b64_tr_b16 v[242:243], v19 offset:2048
    ds_read_b64_tr_b16 v[244:245], v19 offset:32
    ds_read_b64_tr_b16 v[246:247], v19 offset:2080
    ds_read_b64_tr_b16 v[248:249], v19 offset:64
    ds_read_b64_tr_b16 v[250:251], v19 offset:2112
    ds_read_b64_tr_b16 v[252:253], v19 offset:96
    ds_read_b64_tr_b16 v[254:255], v19 offset:2144
    v_add_u32 v10, 131072, v13
    s_waitcnt lgkmcnt(0)
    ds_read_b128 v[184:187], v10 offset:0
    ds_read_b128 v[188:191], v10 offset:1024
    ds_read_b128 v[192:195], v10 offset:8192
    ds_read_b128 v[196:199], v10 offset:9216
    ds_read_b128 v[200:203], v10 offset:16384
    ds_read_b128 v[204:207], v10 offset:17408
    ds_read_b128 v[208:211], v10 offset:24576
    ds_read_b128 v[212:215], v10 offset:25600
    s_cmp_ge_u32 s3, 2
    s_cbranch_scc1 L_moe4b
    s_add_u32 m0, s85, 4096
    s_add_u32 s6, s86, 0
    buffer_load_dwordx4 v18, s[16:19], s6 offen lds
    s_add_u32 m0, s85, 5120
    s_add_u32 s6, s86, 10240
    buffer_load_dwordx4 v18, s[16:19], s6 offen lds
    s_add_u32 m0, s85, 6144
    s_add_u32 s6, s86, 20480
    buffer_load_dwordx4 v18, s[16:19], s6 offen lds
    s_add_u32 m0, s85, 7168
    s_add_u32 s6, s86, 30720
    buffer_load_dwordx4 v18, s[16:19], s6 offen lds
    s_add_u32 s86, s86, 512
L_moe4b:
    s_call_b64 s[82:83], L_load
    s_add_i32 s62, s62, 1
    s_waitcnt lgkmcnt(0)
    s_mov_b32 s6, 0xbfb8aa3b
    v_add_f32 v184, v184, v192
    v_add_f32 v200, v200, v208
    v_add_f32 v185, v185, v193
    v_add_f32 v201, v201, v209
    v_cvt_pk_bf16_f32 v185, v184, v185
    v_lshlrev_b32 v184, 16, v185
    v_and_b32 v185, 0xffff0000, v185
    v_cvt_pk_bf16_f32 v201, v200, v201
    v_lshlrev_b32 v200, 16, v201
    v_and_b32 v201, 0xffff0000, v201
    v_mul_f32 v2, s6, v184
    v_mul_f32 v3, s6, v185
    v_exp_f32 v2, v2
    v_exp_f32 v3, v3
    s_nop 0
    v_add_f32 v2, 1.0, v2
    v_add_f32 v3, 1.0, v3
    v_rcp_f32 v2, v2
    v_rcp_f32 v3, v3
    s_nop 0
    v_mul_f32 v184, v184, v2
    v_mul_f32 v185, v185, v3
    v_cvt_pk_bf16_f32 v185, v184, v185
    v_lshlrev_b32 v184, 16, v185
    v_and_b32 v185, 0xffff0000, v185
    v_mul_f32 v184, v184, v200
    v_mul_f32 v185, v185, v201
    v_cvt_pk_bf16_f32 v24, v184, v185
    v_add_f32 v186, v186, v194
    v_add_f32 v202, v202, v210
    v_add_f32 v187, v187, v195
    v_add_f32 v203, v203, v211
    v_cvt_pk_bf16_f32 v187, v186, v187
    v_lshlrev_b32 v186, 16, v187
    v_and_b32 v187, 0xffff0000, v187
    v_cvt_pk_bf16_f32 v203, v202, v203
    v_lshlrev_b32 v202, 16, v203
    v_and_b32 v203, 0xffff0000, v203
    v_mul_f32 v2, s6, v186
    v_mul_f32 v3, s6, v187
    v_exp_f32 v2, v2
    v_exp_f32 v3, v3
    s_nop 0
    v_add_f32 v2, 1.0, v2
    v_add_f32 v3, 1.0, v3
    v_rcp_f32 v2, v2
    v_rcp_f32 v3, v3
    s_nop 0
    v_mul_f32 v186, v186, v2
    v_mul_f32 v187, v187, v3
    v_cvt_pk_bf16_f32 v187, v186, v187
    v_lshlrev_b32 v186, 16, v187
    v_and_b32 v187, 0xffff0000, v187
    v_mul_f32 v186, v186, v202
    v_mul_f32 v187, v187, v203
    v_cvt_pk_bf16_f32 v25, v186, v187
    v_add_f32 v188, v188, v196
    v_add_f32 v204, v204, v212
    v_add_f32 v189, v189, v197
    v_add_f32 v205, v205, v213
    v_cvt_pk_bf16_f32 v189, v188, v189
    v_lshlrev_b32 v188, 16, v189
    v_and_b32 v189, 0xffff0000, v189
    v_cvt_pk_bf16_f32 v205, v204, v205
    v_lshlrev_b32 v204, 16, v205
    v_and_b32 v205, 0xffff0000, v205
    v_mul_f32 v2, s6, v188
    v_mul_f32 v3, s6, v189
    v_exp_f32 v2, v2
    v_exp_f32 v3, v3
    s_nop 0
    v_add_f32 v2, 1.0, v2
    v_add_f32 v3, 1.0, v3
    v_rcp_f32 v2, v2
    v_rcp_f32 v3, v3
    s_nop 0
    v_mul_f32 v188, v188, v2
    v_mul_f32 v189, v189, v3
    v_cvt_pk_bf16_f32 v189, v188, v189
    v_lshlrev_b32 v188, 16, v189
    v_and_b32 v189, 0xffff0000, v189
    v_mul_f32 v188, v188, v204
    v_mul_f32 v189, v189, v205
    v_cvt_pk_bf16_f32 v26, v188, v189
    v_add_f32 v190, v190, v198
    v_add_f32 v206, v206, v214
    v_add_f32 v191, v191, v199
    v_add_f32 v207, v207, v215
    v_cvt_pk_bf16_f32 v191, v190, v191
    v_lshlrev_b32 v190, 16, v191
    v_and_b32 v191, 0xffff0000, v191
    v_cvt_pk_bf16_f32 v207, v206, v207
    v_lshlrev_b32 v206, 16, v207
    v_and_b32 v207, 0xffff0000, v207
    v_mul_f32 v2, s6, v190
    v_mul_f32 v3, s6, v191
    v_exp_f32 v2, v2
    v_exp_f32 v3, v3
    s_nop 0
    v_add_f32 v2, 1.0, v2
    v_add_f32 v3, 1.0, v3
    v_rcp_f32 v2, v2
    v_rcp_f32 v3, v3
    s_nop 0
    v_mul_f32 v190, v190, v2
    v_mul_f32 v191, v191, v3
    v_cvt_pk_bf16_f32 v191, v190, v191
    v_lshlrev_b32 v190, 16, v191
    v_and_b32 v191, 0xffff0000, v191
    v_mul_f32 v190, v190, v206
    v_mul_f32 v191, v191, v207
    v_cvt_pk_bf16_f32 v27, v190, v191
    s_nop 1
    v_mfma_f32_16x16x32_bf16 v[216:219], v[32:35], v[24:27], 0
    v_mfma_f32_16x16x32_bf16 v[220:223], v[36:39], v[24:27], 0
    v_mfma_f32_16x16x32_bf16 v[224:227], v[40:43], v[24:27], 0
    v_mfma_f32_16x16x32_bf16 v[228:231], v[44:47], v[24:27], 0
    s_nop 7
    buffer_store_dwordx4 v[216:219], v20, s[8:11], s87 offen offset:0 sc1
    buffer_store_dwordx4 v[220:223], v20, s[8:11], s87 offen offset:64 sc1
    buffer_store_dwordx4 v[224:227], v20, s[8:11], s87 offen offset:128 sc1
    buffer_store_dwordx4 v[228:231], v20, s[8:11], s87 offen offset:192 sc1
    s_nop 1
    s_waitcnt vmcnt(4) lgkmcnt(0)
    s_call_b64 s[82:83], L_pend
    s_barrier
    s_call_b64 s[82:83], L_load
    s_add_i32 s62, s62, 1
    v_mfma_f32_16x16x32_bf16 v[216:219], v[240:243], v[24:27], 0
    v_mfma_f32_16x16x32_bf16 v[220:223], v[244:247], v[24:27], 0
    v_mfma_f32_16x16x32_bf16 v[224:227], v[248:251], v[24:27], 0
    v_mfma_f32_16x16x32_bf16 v[228:231], v[252:255], v[24:27], 0
    s_nop 7
    buffer_store_dwordx4 v[216:219], v20, s[8:11], s87 offen offset:1024 sc1
    buffer_store_dwordx4 v[220:223], v20, s[8:11], s87 offen offset:1088 sc1
    buffer_store_dwordx4 v[224:227], v20, s[8:11], s87 offen offset:1152 sc1
    buffer_store_dwordx4 v[228:231], v20, s[8:11], s87 offen offset:1216 sc1
    s_nop 1
    s_cmp_ge_u32 s3, 2
    s_cbranch_scc1 L_moe5b
    ds_read_b64_tr_b16 v[32:33], v19 offset:0
    ds_read_b64_tr_b16 v[34:35], v19 offset:2048
    ds_read_b64_tr_b16 v[36:37], v19 offset:32
    ds_read_b64_tr_b16 v[38:39], v19 offset:2080
    ds_read_b64_tr_b16 v[40:41], v19 offset:64
    ds_read_b64_tr_b16 v[42:43], v19 offset:2112
    ds_read_b64_tr_b16 v[44:45], v19 offset:96
    ds_read_b64_tr_b16 v[46:47], v19 offset:2144
    s_waitcnt lgkmcnt(0)
    v_mfma_f32_16x16x32_bf16 v[216:219], v[32:35], v[24:27], 0
    v_mfma_f32_16x16x32_bf16 v[220:223], v[36:39], v[24:27], 0
    v_mfma_f32_16x16x32_bf16 v[224:227], v[40:43], v[24:27], 0
    v_mfma_f32_16x16x32_bf16 v[228:231], v[44:47], v[24:27], 0
    s_nop 7
    buffer_store_dwordx4 v[216:219], v20, s[8:11], s87 offen offset:2048 sc1
    buffer_store_dwordx4 v[220:223], v20, s[8:11], s87 offen offset:2112 sc1
    buffer_store_dwordx4 v[224:227], v20, s[8:11], s87 offen offset:2176 sc1
    buffer_store_dwordx4 v[228:231], v20, s[8:11], s87 offen offset:2240 sc1
    s_nop 1
L_moe5b:
    s_waitcnt vmcnt(4) lgkmcnt(0)
    s_call_b64 s[82:83], L_pend
    s_barrier
    s_waitcnt vmcnt(0)
    s_lshl_b32 s6, s61, 5
    s_add_u32 s6, s6, s3
    s_lshl_b32 s6, s6, 2
    s_add_u32 s6, s6, 15859712
    v_mov_b32 v2, 1
    v_mov_b32 v3, 0x5000000
    v_writelane_b32 v3, s6, 0
    buffer_store_dword v2, v3, s[8:11], 0 offen sc1
    s_call_b64 s[82:83], L_load
    s_add_i32 s62, s62, 1
    s_branch L_idle
L_top:
    s_mov_b32 s6, 0x280000
    v_lshrrev_b32 v2, 1, v1
    v_and_b32 v3, 1, v1
    v_lshlrev_b32 v3, 4, v3
    v_lshl_add_u32 v2, v2, 7, v3
    buffer_load_dwordx4 v[64:67], v2, s[8:11], s6 offen sc1
    s_add_u32 s6, s6, 4096
    buffer_load_dwordx4 v[68:71], v2, s[8:11], s6 offen sc1
    s_add_u32 s6, s6, 4096
    buffer_load_dwordx4 v[72:75], v2, s[8:11], s6 offen sc1
    s_add_u32 s6, s6, 4096
    buffer_load_dwordx4 v[76:79], v2, s[8:11], s6 offen sc1
    s_add_u32 s6, s6, 4096
    buffer_load_dwordx4 v[80:83], v2, s[8:11], s6 offen sc1
    s_add_u32 s6, s6, 4096
    buffer_load_dwordx4 v[84:87], v2, s[8:11], s6 offen sc1
    s_add_u32 s6, s6, 4096
    buffer_load_dwordx4 v[88:91], v2, s[8:11], s6 offen sc1
    s_add_u32 s6, s6, 4096
    buffer_load_dwordx4 v[92:95], v2, s[8:11], s6 offen sc1
    s_add_u32 s6, s6, 4096
    s_waitcnt vmcnt(0)
    v_mov_b32 v24, 0
    s_mov_b32 s7, 0
    s_mov_b32 s84, 0
L_top_l:
    v_max3_u32 v4, v64, v65, v66
    v_max3_u32 v5, v67, v68, v69
    v_max3_u32 v4, v4, v70, v71
    v_max3_u32 v5, v5, v72, v73
    v_max3_u32 v4, v4, v74, v75
    v_max3_u32 v5, v5, v76, v77
    v_max3_u32 v4, v4, v78, v79
    v_max3_u32 v5, v5, v80, v81
    v_max3_u32 v4, v4, v82, v83
    v_max3_u32 v5, v5, v84, v85
    v_max3_u32 v4, v4, v86, v87
    v_max3_u32 v5, v5, v88, v89
    v_max3_u32 v4, v4, v90, v91
    v_max3_u32 v5, v5, v92, v93
    v_max3_u32 v4, v4, v94, v95
    v_max_u32 v4, v4, v5
    s_nop 1
    v_max_u32_dpp v4, v4, v4 quad_perm:[1,0,3,2] row_mask:0xf bank_mask:0xf
    s_nop 1
    v_max_u32_dpp v4, v4, v4 quad_perm:[2,3,0,1] row_mask:0xf bank_mask:0xf
    s_nop 1
    v_max_u32_dpp v4, v4, v4 row_half_mirror row_mask:0xf bank_mask:0xf
    s_nop 1
    v_max_u32_dpp v4, v4, v4 row_mirror row_mask:0xf bank_mask:0xf
    s_nop 1
    v_max_u32_dpp v4, v4, v4 row_bcast:15 row_mask:0xa bank_mask:0xf
    s_nop 1
    v_max_u32_dpp v4, v4, v4 row_bcast:31 row_mask:0xc bank_mask:0xf
    s_nop 1
    v_readlane_b32 s6, v4, 63
    s_mov_b32 m0, s7
    s_nop 3
    s_add_u32 s84, s84, s6
    v_writelane_b32 v24, s84, m0
    v_subrev_u32 v64, s6, v64
    v_subrev_u32 v65, s6, v65
    v_subrev_u32 v66, s6, v66
    v_subrev_u32 v67, s6, v67
    v_subrev_u32 v68, s6, v68
    v_subrev_u32 v69, s6, v69
    v_subrev_u32 v70, s6, v70
    v_subrev_u32 v71, s6, v71
    v_subrev_u32 v72, s6, v72
    v_subrev_u32 v73, s6, v73
    v_subrev_u32 v74, s6, v74
    v_subrev_u32 v75, s6, v75
    v_subrev_u32 v76, s6, v76
    v_subrev_u32 v77, s6, v77
    v_subrev_u32 v78, s6, v78
    v_subrev_u32 v79, s6, v79
    v_subrev_u32 v80, s6, v80
    v_subrev_u32 v81, s6, v81
    v_subrev_u32 v82, s6, v82
    v_subrev_u32 v83, s6, v83
    v_subrev_u32 v84, s6, v84
    v_subrev_u32 v85, s6, v85
    v_subrev_u32 v86, s6, v86
    v_subrev_u32 v87, s6, v87
    v_subrev_u32 v88, s6, v88
    v_subrev_u32 v89, s6, v89
    v_subrev_u32 v90, s6, v90
    v_subrev_u32 v91, s6, v91
    v_subrev_u32 v92, s6, v92
    v_subrev_u32 v93, s6, v93
    v_subrev_u32 v94, s6, v94
    v_subrev_u32 v95, s6, v95
    s_add_u32 s7, s7, 1
    s_cmp_lt_u32 s7, 8
    s_cbranch_scc1 L_top_l
    v_and_b32 v2, 7, v1
    v_lshlrev_b32 v2, 2, v2
    ds_bpermute_b32 v4, v2, v24
    s_waitcnt lgkmcnt(0)
    v_and_b32 v4, 0x7ff, v4
    v_sub_u32 v4, 0x7ff, v4
    v_lshrrev_b32 v5, 4, v4
    v_mul_u32_u24 v5, 20480, v5
    v_and_b32 v4, 15, v4
    v_lshl_add_u32 v5, v4, 4, v5
    v_lshrrev_b32 v7, 4, v1
    v_lshl_add_u32 v5, v7, 8, v5
    v_mov_b32 v6, 0x5000000
    v_and_b32 v2, 8, v1
    v_cmp_eq_u32 vcc, 0, v2
    s_mov_b32 s6, 0
    s_nop 0
    v_cndmask_b32 v5, v6, v5, vcc
    buffer_load_dwordx4 v[64:67], v5, s[8:11], s6 offen offset:0 sc1
    buffer_load_dwordx4 v[68:71], v5, s[8:11], s6 offen offset:1024 sc1
    buffer_load_dwordx4 v[72:75], v5, s[8:11], s6 offen offset:2048 sc1
    buffer_load_dwordx4 v[76:79], v5, s[8:11], s6 offen offset:3072 sc1
    s_add_u32 s6, s6, 4096
    buffer_load_dwordx4 v[80:83], v5, s[8:11], s6 offen offset:0 sc1
    buffer_load_dwordx4 v[84:87], v5, s[8:11], s6 offen offset:1024 sc1
    buffer_load_dwordx4 v[88:91], v5, s[8:11], s6 offen offset:2048 sc1
    buffer_load_dwordx4 v[92:95], v5, s[8:11], s6 offen offset:3072 sc1
    s_add_u32 s6, s6, 4096
    buffer_load_dwordx4 v[96:99], v5, s[8:11], s6 offen offset:0 sc1
    buffer_load_dwordx4 v[100:103], v5, s[8:11], s6 offen offset:1024 sc1
    buffer_load_dwordx4 v[104:107], v5, s[8:11], s6 offen offset:2048 sc1
    buffer_load_dwordx4 v[108:111], v5, s[8:11], s6 offen offset:3072 sc1
    s_add_u32 s6, s6, 4096
    buffer_load_dwordx4 v[112:115], v5, s[8:11], s6 offen offset:0 sc1
    buffer_load_dwordx4 v[116:119], v5, s[8:11], s6 offen offset:1024 sc1
    buffer_load_dwordx4 v[120:123], v5, s[8:11], s6 offen offset:2048 sc1
    buffer_load_dwordx4 v[124:127], v5, s[8:11], s6 offen offset:3072 sc1
    s_add_u32 s6, s6, 4096
    buffer_load_dwordx4 v[128:131], v5, s[8:11], s6 offen offset:0 sc1
    buffer_load_dwordx4 v[132:135], v5, s[8:11], s6 offen offset:1024 sc1
    buffer_load_dwordx4 v[136:139], v5, s[8:11], s6 offen offset:2048 sc1
    buffer_load_dwordx4 v[140:143], v5, s[8:11], s6 offen offset:3072 sc1
    s_waitcnt vmcnt(20)
    s_call_b64 s[82:83], L_pend
    s_barrier
    s_waitcnt vmcnt(0)
    s_mov_b32 s6, 0xc00000
    buffer_store_dwordx4 v[64:67], v13, s[8:11], s6 offen offset:0 sc1
    buffer_store_dwordx4 v[68:71], v13, s[8:11], s6 offen offset:1024 sc1
    buffer_store_dwordx4 v[72:75], v13, s[8:11], s6 offen offset:2048 sc1
    buffer_store_dwordx4 v[76:79], v13, s[8:11], s6 offen offset:3072 sc1
    s_add_u32 s6, s6, 4096
    buffer_store_dwordx4 v[80:83], v13, s[8:11], s6 offen offset:0 sc1
    buffer_store_dwordx4 v[84:87], v13, s[8:11], s6 offen offset:1024 sc1
    buffer_store_dwordx4 v[88:91], v13, s[8:11], s6 offen offset:2048 sc1
    buffer_store_dwordx4 v[92:95], v13, s[8:11], s6 offen offset:3072 sc1
    s_add_u32 s6, s6, 4096
    buffer_store_dwordx4 v[96:99], v13, s[8:11], s6 offen offset:0 sc1
    buffer_store_dwordx4 v[100:103], v13, s[8:11], s6 offen offset:1024 sc1
    buffer_store_dwordx4 v[104:107], v13, s[8:11], s6 offen offset:2048 sc1
    buffer_store_dwordx4 v[108:111], v13, s[8:11], s6 offen offset:3072 sc1
    s_add_u32 s6, s6, 4096
    buffer_store_dwordx4 v[112:115], v13, s[8:11], s6 offen offset:0 sc1
    buffer_store_dwordx4 v[116:119], v13, s[8:11], s6 offen offset:1024 sc1
    buffer_store_dwordx4 v[120:123], v13, s[8:11], s6 offen offset:2048 sc1
    buffer_store_dwordx4 v[124:127], v13, s[8:11], s6 offen offset:3072 sc1
    s_add_u32 s6, s6, 4096
    buffer_store_dwordx4 v[128:131], v13, s[8:11], s6 offen offset:0 sc1
    buffer_store_dwordx4 v[132:135], v13, s[8:11], s6 offen offset:1024 sc1
    buffer_store_dwordx4 v[136:139], v13, s[8:11], s6 offen offset:2048 sc1
    buffer_store_dwordx4 v[140:143], v13, s[8:11], s6 offen offset:3072 sc1
    s_call_b64 s[82:83], L_load
    s_add_i32 s62, s62, 1
    s_waitcnt vmcnt(16)
    v_or_b32 v24, 0x80000000, v24
    v_lshlrev_b32 v5, 2, v1
    v_mov_b32 v6, 0x5000000
    v_cmp_gt_u32 vcc, 8, v1
    s_mov_b32 s6, 0x3a0000
    s_nop 0
    v_cndmask_b32 v5, v6, v5, vcc
    buffer_store_dword v24, v5, s[8:11], s6 offen sc1
    s_branch L_idle
L_back_9_h:
    v_cmp_ne_u32 vcc, 0, v62
    s_cbranch_vccz L_back_9_n
    s_call_b64 s[80:81], L_rare0
L_back_9_n:
    s_branch L_back_9
L_back_10_h:
    v_cmp_ne_u32 vcc, 0, v62
    s_cbranch_vccz L_back_10_n
    s_call_b64 s[80:81], L_rare1
    v_exp_f32 v58, v64
    v_exp_f32 v59, v65
L_back_10_n:
    s_cmp_lt_i32 s64, 0
    s_cbranch_scc1 L_tail1
    s_cmp_gt_i32 s64, 0
    s_cbranch_scc1 L_back_10
    s_call_b64 s[82:83], L_mask
    s_branch L_back_10
L_back_11_h:
    v_cmp_ne_u32 vcc, 0, v62
    s_cbranch_vccz L_back_11_n
    s_call_b64 s[80:81], L_rare0
    v_exp_f32 v58, v80
    v_exp_f32 v59, v81
L_back_11_n:
    s_cmp_lt_i32 s64, 0
    s_cbranch_scc1 L_tail2
    s_cmp_gt_i32 s64, 0
    s_cbranch_scc1 L_back_11
    s_call_b64 s[82:83], L_mask
    s_branch L_back_11
L_back_12_h:
    v_cmp_ne_u32 vcc, 0, v62
    s_cbranch_vccz L_back_12_n
    s_call_b64 s[80:81], L_rare1
    v_exp_f32 v58, v64
    v_exp_f32 v59, v65
L_back_12_n:
    s_cmp_lt_i32 s64, 0
    s_cbranch_scc1 L_tail3
    s_cmp_gt_i32 s64, 0
    s_cbranch_scc1 L_back_12
    s_call_b64 s[82:83], L_mask
    s_branch L_back_12
L_ldback_13_c:
    s_waitcnt vmcnt(0) lgkmcnt(0)
    s_call_b64 s[82:83], L_pend
    s_barrier
    s_call_b64 s[82:83], L_load
    s_branch L_ldback_13
L_back_14_h:
    v_cmp_ne_u32 vcc, 0, v62
    s_cbranch_vccz L_back_14_n
    s_call_b64 s[80:81], L_rare0
    v_exp_f32 v58, v80
    v_exp_f32 v59, v81
L_back_14_n:
    s_cmp_lt_i32 s64, 0
    s_cbranch_scc1 L_tail0
    s_cmp_gt_i32 s64, 0
    s_cbranch_scc1 L_st0
    s_call_b64 s[82:83], L_mask
    s_branch L_st0
L_back_15_h:
    v_cmp_ne_u32 vcc, 0, v62
    s_cbranch_vccz L_back_15_n
    s_call_b64 s[80:81], L_rare1
L_back_15_n:
    s_branch L_back_15
L_back_16_h:
    v_cmp_ne_u32 vcc, 0, v62
    s_cbranch_vccz L_back_16_n
    s_call_b64 s[80:81], L_rare0
L_back_16_n:
    s_branch L_back_16
L_back_18_h:
    v_cmp_ne_u32 vcc, 0, v62
    s_cbranch_vccz L_back_18_n
    s_call_b64 s[80:81], L_rare1
L_back_18_n:
    s_branch L_back_18
L_back_21_h:
    v_cmp_ne_u32 vcc, 0, v62
    s_cbranch_vccz L_back_21_n
    s_call_b64 s[80:81], L_rare0
L_back_21_n:
    s_branch L_back_21
L_load:
    s_bitcmp1_b32 s89, 0
    s_cbranch_scc0 L_load_r
    s_add_u32 s77, s77, 32768
    s_xor_b32 s78, s78, 0x10000
    s_add_i32 s73, s62, 1
    s_cmp_gt_i32 s73, s63
    s_cbranch_scc1 L_load_r
    s_cmp_eq_i32 s73, s63
    s_cbranch_scc1 L_load_v
    s_cmp_lg_i32 s73, 3
    s_cbranch_scc1 L_load_k
    v_cmp_gt_u32 vcc, 2, v12
    s_cbranch_vccz L_load_k
    s_lshl_b32 s7, s4, 10
    s_add_u32 s7, s7, 3866624
    v_lshrrev_b32 v2, 3, v1
    v_and_b32 v3, 7, v1
    v_lshlrev_b32 v3, 2, v3
    v_lshl_add_u32 v3, v2, 7, v3
    s_mov_b32 s79, 262144
L_poll_46:
    buffer_load_dword v2, v3, s[8:11], s7 offen sc1
    s_waitcnt vmcnt(0)
    v_cmp_gt_u32 vcc, 2, v2
    s_cbranch_vccz L_polldone_47
    s_sleep 2
    s_sub_u32 s79, s79, 1
    s_cmp_lg_u32 s79, 0
    s_cbranch_scc1 L_poll_46
L_polldone_47:
L_load_k:
    s_lshl_b32 s6, s76, 13
    s_add_u32 s6, s6, s78
    s_add_u32 m0, s6, 0
    s_add_u32 s7, s77, 0
    buffer_load_dwordx4 v49, s[8:11], s7 offen offset:0 sc1 lds
    buffer_load_dwordx4 v49, s[8:11], s7 offen offset:1024 sc1 lds
    buffer_load_dwordx4 v49, s[8:11], s7 offen offset:2048 sc1 lds
    buffer_load_dwordx4 v49, s[8:11], s7 offen offset:3072 sc1 lds
    s_lshl_b32 s6, s76, 13
    s_add_u32 s6, s6, s78
    s_add_u32 m0, s6, 4096
    s_add_u32 s7, s77, 4096
    buffer_load_dwordx4 v49, s[8:11], s7 offen offset:0 sc1 lds
    buffer_load_dwordx4 v49, s[8:11], s7 offen offset:1024 sc1 lds
    buffer_load_dwordx4 v49, s[8:11], s7 offen offset:2048 sc1 lds
    buffer_load_dwordx4 v49, s[8:11], s7 offen offset:3072 sc1 lds
    s_lshl_b32 s6, s76, 12
    s_add_u32 s6, s6, s78
    s_add_u32 m0, s6, 49152
    s_add_u32 s7, s77, 524288
    buffer_load_dwordx4 v50, s[8:11], s7 offen offset:0 sc1 lds
    buffer_load_dwordx4 v50, s[8:11], s7 offen offset:1024 sc1 lds
    buffer_load_dwordx4 v50, s[8:11], s7 offen offset:2048 sc1 lds
    buffer_load_dwordx4 v50, s[8:11], s7 offen offset:3072 sc1 lds
L_load_v:
    s_lshl_b32 s6, s76, 12
    s_add_u32 s6, s6, s78
    s_add_u32 m0, s6, 32768
    s_add_u32 s7, s77, 507904
    buffer_load_dwordx4 v50, s[8:11], s7 offen offset:0 sc1 lds
    buffer_load_dwordx4 v50, s[8:11], s7 offen offset:1024 sc1 lds
    buffer_load_dwordx4 v50, s[8:11], s7 offen offset:2048 sc1 lds
    buffer_load_dwordx4 v50, s[8:11], s7 offen offset:3072 sc1 lds
    s_cmp_eq_i32 s73, s63
    s_cbranch_scc1 L_xa
    s_cmp_lg_i32 s73, 2
    s_cbranch_scc1 L_nolook
    s_lshl_b32 s7, s4, 10
    s_add_u32 s7, s7, 3866624
    v_lshrrev_b32 v2, 3, v1
    v_and_b32 v3, 7, v1
    v_lshlrev_b32 v3, 2, v3
    v_lshl_add_u32 v3, v2, 7, v3
    buffer_load_dword v12, v3, s[8:11], s7 offen sc1
L_nolook:
    s_bitcmp1_b32 240, s5
    s_cbranch_scc0 L_wb
    s_sub_i32 s6, s62, 0
    s_cmp_gt_u32 s6, 4
    s_cbranch_scc0 L_wsel
L_wb:
    s_cmp_lt_u32 s5, 4
    s_cbranch_scc1 L_load_r
    s_sub_i32 s79, s73, 1
    s_cmp_lt_u32 s79, 2
    s_cbranch_scc1 L_x3
L_load_r:
    s_setpc_b64 s[82:83]
L_pend:
    s_bitcmp1_b32 s89, 1
    s_cbranch_scc0 L_load_a
    s_cmp_lt_i32 s62, 0
    s_cbranch_scc1 L_load_a
    s_lshl_b32 s6, s4, 3
    s_add_u32 s6, s6, s5
    s_lshl_b32 s6, s6, 5
    s_add_u32 s6, s6, s3
    s_lshl_b32 s6, s6, 2
    s_add_u32 s6, s6, 3866624
    v_mov_b32 v2, 2
    v_mov_b32 v3, 0x5000000
    v_writelane_b32 v3, s6, 0
    buffer_store_dword v2, v3, s[8:11], 0 offen sc1
    s_and_b32 s89, s89, 1
L_load_a:
    s_setpc_b64 s[82:83]
L_wsel:
    s_bfm_b32 s7, s5, 0
    s_and_b32 s7, s7, 240
    s_bcnt1_i32_b32 s7, s7
    s_lshl_b32 s7, s7, 5
    s_and_b32 s91, s2, 31
    s_add_u32 s91, s91, s7
    s_lshl_b32 s91, s91, 1
    s_lshr_b32 s7, s6, 1
    s_add_u32 s91, s91, s7
    s_cmp_eq_u32 s6, 4
    s_cbranch_scc1 L_w2
    s_bitcmp1_b32 s6, 0
    s_cbranch_scc1 L_w1
L_w0:
    s_mov_b32 s28, s42
    s_mov_b32 s29, s43
    s_mov_b32 s30, 0x500000
    s_mov_b32 s31, 0x20000
    s_lshr_b32 s75, s91, 1
    s_mul_i32 s75, s75, 40960
    s_and_b32 s6, s91, 1
    s_mul_i32 s6, s6, 640
    s_add_u32 s75, s75, s6
    s_movk_i32 s7, 1639
    s_mul_i32 s74, s76, 5120
    s_add_u32 s74, s74, 141312
    s_mul_i32 s6, s76, 320
    v_add_u32 v9, s6, v1
    v_add_u32 v2, 0, v9
    v_mul_lo_u32 v3, v2, s7
    v_lshrrev_b32 v3, 16, v3
    v_mul_u32_u24 v4, 40, v3
    v_sub_u32 v4, v2, v4
    v_mul_u32_u24 v3, 1280, v3
    v_lshl_add_u32 v3, v4, 4, v3
    s_add_u32 m0, s74, 0
    s_nop 0
    buffer_load_dwordx4 v3, s[28:31], s75 offen nt lds
    v_add_u32 v2, 64, v9
    v_mul_lo_u32 v3, v2, s7
    v_lshrrev_b32 v3, 16, v3
    v_mul_u32_u24 v4, 40, v3
    v_sub_u32 v4, v2, v4
    v_mul_u32_u24 v3, 1280, v3
    v_lshl_add_u32 v3, v4, 4, v3
    s_add_u32 m0, s74, 1024
    s_nop 0
    buffer_load_dwordx4 v3, s[28:31], s75 offen nt lds
    v_add_u32 v2, 128, v9
    v_mul_lo_u32 v3, v2, s7
    v_lshrrev_b32 v3, 16, v3
    v_mul_u32_u24 v4, 40, v3
    v_sub_u32 v4, v2, v4
    v_mul_u32_u24 v3, 1280, v3
    v_lshl_add_u32 v3, v4, 4, v3
    s_add_u32 m0, s74, 2048
    s_nop 0
    buffer_load_dwordx4 v3, s[28:31], s75 offen nt lds
    v_add_u32 v2, 192, v9
    v_mul_lo_u32 v3, v2, s7
    v_lshrrev_b32 v3, 16, v3
    v_mul_u32_u24 v4, 40, v3
    v_sub_u32 v4, v2, v4
    v_mul_u32_u24 v3, 1280, v3
    v_lshl_add_u32 v3, v4, 4, v3
    s_add_u32 m0, s74, 3072
    s_nop 0
    buffer_load_dwordx4 v3, s[28:31], s75 offen nt lds
    v_add_u32 v2, 256, v9
    v_mul_lo_u32 v3, v2, s7
    v_lshrrev_b32 v3, 16, v3
    v_mul_u32_u24 v4, 40, v3
    v_sub_u32 v4, v2, v4
    v_mul_u32_u24 v3, 1280, v3
    v_lshl_add_u32 v3, v4, 4, v3
    s_add_u32 m0, s74, 4096
    s_nop 0
    buffer_load_dwordx4 v3, s[28:31], s75 offen nt lds
    s_branch L_wb
L_w1:
    v_and_b32 v2, 15, v1
    v_lshrrev_b32 v3, 4, v1
    v_lshrrev_b32 v4, 2, v2
    v_lshl_add_u32 v4, v3, 2, v4
    v_mul_u32_u24 v4, 640, v4
    v_and_b32 v2, 3, v2
    v_lshl_add_u32 v4, v2, 3, v4
    s_mul_i32 s6, s76, 160
    s_add_u32 s6, s6, 141312
    v_add_u32 v4, s6, v4
    s_mul_i32 s6, s91, 20480
    s_mul_i32 s7, s76, 5120
    s_add_u32 s6, s6, s7
    s_add_u32 s6, s6, 4194304
    s_add_u32 s7, s6, 4096
    ds_read_b64_tr_b16 v[172:173], v4 offset:0
    ds_read_b64_tr_b16 v[174:175], v4 offset:10240
    ds_read_b64_tr_b16 v[176:177], v4 offset:32
    ds_read_b64_tr_b16 v[178:179], v4 offset:10272
    ds_read_b64_tr_b16 v[180:181], v4 offset:64
    ds_read_b64_tr_b16 v[182:183], v4 offset:10304
    ds_read_b64_tr_b16 v[184:185], v4 offset:96
    ds_read_b64_tr_b16 v[186:187], v4 offset:10336
    ds_read_b64_tr_b16 v[188:189], v4 offset:128
    ds_read_b64_tr_b16 v[190:191], v4 offset:10368
    s_waitcnt lgkmcnt(0)
    buffer_store_dwordx4 v[172:175], v13, s[8:11], s6 offen offset:0 sc1
    buffer_store_dwordx4 v[176:179], v13, s[8:11], s6 offen offset:1024 sc1
    buffer_store_dwordx4 v[180:183], v13, s[8:11], s6 offen offset:2048 sc1
    buffer_store_dwordx4 v[184:187], v13, s[8:11], s6 offen offset:3072 sc1
    buffer_store_dwordx4 v[188:191], v13, s[8:11], s7 offen offset:0 sc1
    s_branch L_wb
L_w2:
    s_cmp_lg_u32 s3, 0
    s_cbranch_scc1 L_wb
    s_mov_b32 s28, s56
    s_mov_b32 s29, s57
    s_mov_b32 s30, 0x100
    s_mov_b32 s31, 0x20000
    v_mov_b32 v2, 1
    v_lshlrev_b32 v3, 8, v1
    s_and_b32 s6, s2, 31
    s_lshl_b32 s6, s6, 2
    buffer_atomic_add v2, v3, s[28:31], s6 offen offset:128 sc1
    s_branch L_wb
L_xa:
    s_cmp_lg_u32 s90, 0
    s_cbranch_scc1 L_xa1
    s_mov_b32 s28, s56
    s_mov_b32 s29, s57
    s_mov_b32 s30, 0x100
    s_mov_b32 s31, 0x20000
    v_and_b32 v3, 31, v1
    v_lshlrev_b32 v3, 2, v3
    s_mov_b32 s79, 262144
L_poll_48:
    buffer_load_dword v2, v3, s[28:31], 0 offen offset:128 sc1
    s_waitcnt vmcnt(0)
    v_cmp_gt_u32 vcc, 4, v2
    s_cbranch_vccz L_polldone_49
    s_sleep 8
    s_sub_u32 s79, s79, 1
    s_cmp_lg_u32 s79, 0
    s_cbranch_scc1 L_poll_48
L_polldone_49:
L_xa1:
    s_lshr_b32 s74, s4, 3
    s_lshl_b32 s74, s74, 2
    s_add_u32 s74, s74, s76
    s_mul_i32 s74, s74, 327680
    s_and_b32 s7, s4, 3
    s_mul_i32 s7, s7, 10240
    s_add_u32 s74, s74, s7
    s_add_u32 s74, s74, 4199424
    s_add_u32 s6, s76, 0
    s_and_b32 s6, s6, 3
    s_lshl_b32 s6, s6, 10
    s_add_u32 s84, s6, s74
    s_add_u32 s6, s76, 1
    s_and_b32 s6, s6, 3
    s_lshl_b32 s6, s6, 10
    s_add_u32 s85, s6, s74
    s_add_u32 s6, s76, 2
    s_and_b32 s6, s6, 3
    s_lshl_b32 s6, s6, 10
    s_add_u32 s86, s6, s74
    s_add_u32 s6, s76, 3
    s_and_b32 s6, s6, 3
    s_lshl_b32 s6, s6, 10
    s_add_u32 s87, s6, s74
    s_add_u32 s88, s74, 4096
    s_lshl_b32 s73, s3, 13
    s_add_u32 s75, s73, s78
    s_add_u32 m0, s73, 131072
    s_add_u32 s7, s84, 0
    buffer_load_dwordx4 v13, s[8:11], s7 offen sc1 lds
    s_add_u32 m0, s73, 132096
    s_add_u32 s7, s85, 0
    buffer_load_dwordx4 v13, s[8:11], s7 offen sc1 lds
    s_add_u32 m0, s73, 133120
    s_add_u32 s7, s86, 0
    buffer_load_dwordx4 v13, s[8:11], s7 offen sc1 lds
    s_add_u32 m0, s73, 134144
    s_add_u32 s7, s87, 0
    buffer_load_dwordx4 v13, s[8:11], s7 offen sc1 lds
    s_add_u32 m0, s73, 135168
    s_add_u32 s7, s88, 0
    buffer_load_dwordx4 v13, s[8:11], s7 offen sc1 lds
    s_add_u32 m0, s73, 136192
    s_add_u32 s7, s84, 40960
    buffer_load_dwordx4 v13, s[8:11], s7 offen sc1 lds
    s_add_u32 m0, s73, 137216
    s_add_u32 s7, s85, 40960
    buffer_load_dwordx4 v13, s[8:11], s7 offen sc1 lds
    s_add_u32 m0, s73, 138240
    s_add_u32 s7, s86, 40960
    buffer_load_dwordx4 v13, s[8:11], s7 offen sc1 lds
    s_add_u32 m0, s75, 0
    s_add_u32 s7, s87, 40960
    buffer_load_dwordx4 v13, s[8:11], s7 offen sc1 lds
    s_add_u32 m0, s75, 1024
    s_add_u32 s7, s88, 40960
    buffer_load_dwordx4 v13, s[8:11], s7 offen sc1 lds
    s_add_u32 m0, s75, 2048
    s_add_u32 s7, s84, 81920
    buffer_load_dwordx4 v13, s[8:11], s7 offen sc1 lds
    s_add_u32 m0, s75, 3072
    s_add_u32 s7, s85, 81920
    buffer_load_dwordx4 v13, s[8:11], s7 offen sc1 lds
    s_add_u32 m0, s75, 4096
    s_add_u32 s7, s86, 81920
    buffer_load_dwordx4 v13, s[8:11], s7 offen sc1 lds
    s_add_u32 m0, s75, 5120
    s_add_u32 s7, s87, 81920
    buffer_load_dwordx4 v13, s[8:11], s7 offen sc1 lds
    s_add_u32 m0, s75, 6144
    s_add_u32 s7, s88, 81920
    buffer_load_dwordx4 v13, s[8:11], s7 offen sc1 lds
    s_add_u32 m0, s75, 7168
    s_add_u32 s7, s84, 122880
    buffer_load_dwordx4 v13, s[8:11], s7 offen sc1 lds
    s_lshl_b32 s75, s3, 12
    s_add_u32 s75, s75, s78
    s_add_u32 m0, s75, 49152
    s_add_u32 s7, s85, 122880
    buffer_load_dwordx4 v13, s[8:11], s7 offen sc1 lds
    s_add_u32 m0, s75, 50176
    s_add_u32 s7, s86, 122880
    buffer_load_dwordx4 v13, s[8:11], s7 offen sc1 lds
    s_add_u32 m0, s75, 51200
    s_add_u32 s7, s87, 122880
    buffer_load_dwordx4 v13, s[8:11], s7 offen sc1 lds
    s_add_u32 m0, s75, 52224
    s_add_u32 s7, s88, 122880
    buffer_load_dwordx4 v13, s[8:11], s7 offen sc1 lds
    s_setpc_b64 s[82:83]
L_x3:
    s_mov_b32 s12, s48
    s_mov_b32 s13, s49
    s_mov_b32 s14, 0x21c000
    s_mov_b32 s15, 0x20000
    s_cmp_eq_u32 s3, 3
    s_cbranch_scc1 L_load_r
    s_cmp_eq_u32 s3, 1
    s_cselect_b32 s12, s50, s12
    s_cselect_b32 s13, s51, s13
    s_cmp_eq_u32 s3, 2
    s_cselect_b32 s12, s52, s12
    s_cselect_b32 s13, s53, s13
    s_mov_b32 s73, 3456
    s_cmov_b32 s73, 256
    s_mov_b32 s75, 256
    s_cmov_b32 s75, 163840
    s_lshr_b32 s6, s2, 3
    s_sub_u32 s6, s6, 16
    s_mul_i32 s6, s6, 40
    v_lshrrev_b32 v2, 2, v1
    v_add_u32 v2, s6, v2
    v_mul_lo_u32 v2, v2, s73
    v_and_b32 v3, 3, v1
    v_lshl_add_u32 v2, v3, 6, v2
    s_xor_b32 s79, s79, 1
    s_lshl_b32 s6, s79, 3
    s_lshr_b32 s7, s4, 2
    s_add_u32 s6, s6, s7
    s_mul_i32 s6, s6, s75
    v_mov_b32 v3, 0x5000000
    v_cmp_gt_u32 vcc, 32, v1
    s_lshl_b32 s73, s73, 4
    s_nop 0
    v_cndmask_b32 v3, v3, v2, vcc
    buffer_load_dword v11, v2, s[12:15], s6 offen
    s_add_u32 s7, s6, s73
    buffer_load_dword v11, v2, s[12:15], s7 offen
    s_add_u32 s7, s7, s73
    buffer_load_dword v11, v3, s[12:15], s7 offen
    s_setpc_b64 s[82:83]
L_mask:
    v_and_b32 v2, 15, v1
    v_lshrrev_b32 v3, 4, v1
    v_lshlrev_b32 v3, 2, v3
    v_sub_u32 v2, v2, v3
    v_mov_b32 v3, 0xff800000
    v_cmp_gt_i32 vcc, 0, v2
    v_mov_b32 v152, v3
    s_nop 0
    v_cndmask_b32 v144, v144, v3, vcc
    v_cndmask_b32 v156, v156, v3, vcc
    v_cmp_gt_i32 vcc, 1, v2
    v_mov_b32 v153, v3
    s_nop 0
    v_cndmask_b32 v145, v145, v3, vcc
    v_cndmask_b32 v157, v157, v3, vcc
    v_cmp_gt_i32 vcc, 2, v2
    v_mov_b32 v154, v3
    s_nop 0
    v_cndmask_b32 v146, v146, v3, vcc
    v_cndmask_b32 v158, v158, v3, vcc
    v_cmp_gt_i32 vcc, 3, v2
    v_mov_b32 v155, v3
    s_nop 0
    v_cndmask_b32 v147, v147, v3, vcc
    v_cndmask_b32 v159, v159, v3, vcc
    s_nop 1
    s_setpc_b64 s[82:83]
L_rare0:
    s_nop 15
    v_max_f32 v62, v64, v65
    v_max3_f32 v62, v62, v66, v67
    v_max3_f32 v62, v62, v72, v73
    v_max3_f32 v62, v62, v74, v75
    v_mov_b32 v58, v62
    s_nop 1
    v_permlane16_swap_b32 v62, v58
    s_nop 1
    v_max_f32 v62, v62, v58
    v_mov_b32 v58, v62
    s_nop 1
    v_permlane32_swap_b32 v62, v58
    s_nop 1
    v_max_f32 v62, v62, v58
    v_add_f32 v62, 0x41c00000, v62
    v_max_f32 v62, 0, v62
    v_exp_f32 v58, -v62
    v_sub_f32 v64, v64, v62
    v_sub_f32 v80, v80, v62
    v_sub_f32 v144, v144, v62
    v_sub_f32 v65, v65, v62
    v_sub_f32 v81, v81, v62
    v_sub_f32 v145, v145, v62
    v_sub_f32 v66, v66, v62
    v_sub_f32 v82, v82, v62
    v_sub_f32 v146, v146, v62
    v_sub_f32 v67, v67, v62
    v_sub_f32 v83, v83, v62
    v_sub_f32 v147, v147, v62
    v_sub_f32 v72, v72, v62
    v_sub_f32 v88, v88, v62
    v_sub_f32 v152, v152, v62
    v_sub_f32 v73, v73, v62
    v_sub_f32 v89, v89, v62
    v_sub_f32 v153, v153, v62
    v_sub_f32 v74, v74, v62
    v_sub_f32 v90, v90, v62
    v_sub_f32 v154, v154, v62
    v_sub_f32 v75, v75, v62
    v_sub_f32 v91, v91, v62
    v_sub_f32 v155, v155, v62
    v_mul_f32 v160, v58, v160
    v_mul_f32 v161, v58, v161
    v_mul_f32 v192, v58, v192
    v_mul_f32 v193, v58, v193
    v_mul_f32 v194, v58, v194
    v_mul_f32 v195, v58, v195
    v_mul_f32 v200, v58, v200
    v_mul_f32 v201, v58, v201
    v_mul_f32 v202, v58, v202
    v_mul_f32 v203, v58, v203
    v_mul_f32 v208, v58, v208
    v_mul_f32 v209, v58, v209
    v_mul_f32 v210, v58, v210
    v_mul_f32 v211, v58, v211
    v_mul_f32 v216, v58, v216
    v_mul_f32 v217, v58, v217
    v_mul_f32 v218, v58, v218
    v_mul_f32 v219, v58, v219
    v_mul_f32 v224, v58, v224
    v_mul_f32 v225, v58, v225
    v_mul_f32 v226, v58, v226
    v_mul_f32 v227, v58, v227
    v_mul_f32 v232, v58, v232
    v_mul_f32 v233, v58, v233
    v_mul_f32 v234, v58, v234
    v_mul_f32 v235, v58, v235
    v_mul_f32 v240, v58, v240
    v_mul_f32 v241, v58, v241
    v_mul_f32 v242, v58, v242
    v_mul_f32 v243, v58, v243
    v_mul_f32 v248, v58, v248
    v_mul_f32 v249, v58, v249
    v_mul_f32 v250, v58, v250
    v_mul_f32 v251, v58, v251
    v_max_f32 v62, v68, v69
    v_max3_f32 v62, v62, v70, v71
    v_max3_f32 v62, v62, v76, v77
    v_max3_f32 v62, v62, v78, v79
    v_mov_b32 v58, v62
    s_nop 1
    v_permlane16_swap_b32 v62, v58
    s_nop 1
    v_max_f32 v62, v62, v58
    v_mov_b32 v58, v62
    s_nop 1
    v_permlane32_swap_b32 v62, v58
    s_nop 1
    v_max_f32 v62, v62, v58
    v_add_f32 v62, 0x41c00000, v62
    v_max_f32 v62, 0, v62
    v_exp_f32 v58, -v62
    v_sub_f32 v68, v68, v62
    v_sub_f32 v84, v84, v62
    v_sub_f32 v148, v148, v62
    v_sub_f32 v69, v69, v62
    v_sub_f32 v85, v85, v62
    v_sub_f32 v149, v149, v62
    v_sub_f32 v70, v70, v62
    v_sub_f32 v86, v86, v62
    v_sub_f32 v150, v150, v62
    v_sub_f32 v71, v71, v62
    v_sub_f32 v87, v87, v62
    v_sub_f32 v151, v151, v62
    v_sub_f32 v76, v76, v62
    v_sub_f32 v92, v92, v62
    v_sub_f32 v156, v156, v62
    v_sub_f32 v77, v77, v62
    v_sub_f32 v93, v93, v62
    v_sub_f32 v157, v157, v62
    v_sub_f32 v78, v78, v62
    v_sub_f32 v94, v94, v62
    v_sub_f32 v158, v158, v62
    v_sub_f32 v79, v79, v62
    v_sub_f32 v95, v95, v62
    v_sub_f32 v159, v159, v62
    v_mul_f32 v162, v58, v162
    v_mul_f32 v163, v58, v163
    v_mul_f32 v196, v58, v196
    v_mul_f32 v197, v58, v197
    v_mul_f32 v198, v58, v198
    v_mul_f32 v199, v58, v199
    v_mul_f32 v204, v58, v204
    v_mul_f32 v205, v58, v205
    v_mul_f32 v206, v58, v206
    v_mul_f32 v207, v58, v207
    v_mul_f32 v212, v58, v212
    v_mul_f32 v213, v58, v213
    v_mul_f32 v214, v58, v214
    v_mul_f32 v215, v58, v215
    v_mul_f32 v220, v58, v220
    v_mul_f32 v221, v58, v221
    v_mul_f32 v222, v58, v222
    v_mul_f32 v223, v58, v223
    v_mul_f32 v228, v58, v228
    v_mul_f32 v229, v58, v229
    v_mul_f32 v230, v58, v230
    v_mul_f32 v231, v58, v231
    v_mul_f32 v236, v58, v236
    v_mul_f32 v237, v58, v237
    v_mul_f32 v238, v58, v238
    v_mul_f32 v239, v58, v239
    v_mul_f32 v244, v58, v244
    v_mul_f32 v245, v58, v245
    v_mul_f32 v246, v58, v246
    v_mul_f32 v247, v58, v247
    v_mul_f32 v252, v58, v252
    v_mul_f32 v253, v58, v253
    v_mul_f32 v254, v58, v254
    v_mul_f32 v255, v58, v255
    v_exp_f32 v58, v64
    s_nop 0
    v_exp_f32 v59, v65
    s_nop 0
    v_cvt_pk_bf16_f32 v128, v58, v59
    v_exp_f32 v60, v66
    s_nop 0
    v_exp_f32 v61, v67
    s_nop 0
    v_cvt_pk_bf16_f32 v129, v60, v61
    v_exp_f32 v58, v68
    s_nop 0
    v_exp_f32 v59, v69
    s_nop 0
    v_cvt_pk_bf16_f32 v132, v58, v59
    v_exp_f32 v60, v70
    s_nop 0
    v_exp_f32 v61, v71
    s_nop 0
    v_cvt_pk_bf16_f32 v133, v60, v61
    v_exp_f32 v58, v72
    s_nop 0
    v_exp_f32 v59, v73
    s_nop 0
    v_cvt_pk_bf16_f32 v130, v58, v59
    v_exp_f32 v60, v74
    s_nop 0
    v_exp_f32 v61, v75
    s_nop 0
    v_cvt_pk_bf16_f32 v131, v60, v61
    v_exp_f32 v58, v76
    s_nop 0
    v_exp_f32 v59, v77
    s_nop 0
    v_cvt_pk_bf16_f32 v134, v58, v59
    v_exp_f32 v60, v78
    s_nop 0
    v_exp_f32 v61, v79
    s_nop 0
    v_cvt_pk_bf16_f32 v135, v60, v61
    s_nop 1
    s_setpc_b64 s[80:81]
L_rare1:
    s_nop 15
    v_max_f32 v62, v80, v81
    v_max3_f32 v62, v62, v82, v83
    v_max3_f32 v62, v62, v88, v89
    v_max3_f32 v62, v62, v90, v91
    v_mov_b32 v58, v62
    s_nop 1
    v_permlane16_swap_b32 v62, v58
    s_nop 1
    v_max_f32 v62, v62, v58
    v_mov_b32 v58, v62
    s_nop 1
    v_permlane32_swap_b32 v62, v58
    s_nop 1
    v_max_f32 v62, v62, v58
    v_add_f32 v62, 0x41c00000, v62
    v_max_f32 v62, 0, v62
    v_exp_f32 v58, -v62
    v_sub_f32 v64, v64, v62
    v_sub_f32 v80, v80, v62
    v_sub_f32 v144, v144, v62
    v_sub_f32 v65, v65, v62
    v_sub_f32 v81, v81, v62
    v_sub_f32 v145, v145, v62
    v_sub_f32 v66, v66, v62
    v_sub_f32 v82, v82, v62
    v_sub_f32 v146, v146, v62
    v_sub_f32 v67, v67, v62
    v_sub_f32 v83, v83, v62
    v_sub_f32 v147, v147, v62
    v_sub_f32 v72, v72, v62
    v_sub_f32 v88, v88, v62
    v_sub_f32 v152, v152, v62
    v_sub_f32 v73, v73, v62
    v_sub_f32 v89, v89, v62
    v_sub_f32 v153, v153, v62
    v_sub_f32 v74, v74, v62
    v_sub_f32 v90, v90, v62
    v_sub_f32 v154, v154, v62
    v_sub_f32 v75, v75, v62
    v_sub_f32 v91, v91, v62
    v_sub_f32 v155, v155, v62
    v_mul_f32 v160, v58, v160
    v_mul_f32 v161, v58, v161
    v_mul_f32 v192, v58, v192
    v_mul_f32 v193, v58, v193
    v_mul_f32 v194, v58, v194
    v_mul_f32 v195, v58, v195
    v_mul_f32 v200, v58, v200
    v_mul_f32 v201, v58, v201
    v_mul_f32 v202, v58, v202
    v_mul_f32 v203, v58, v203
    v_mul_f32 v208, v58, v208
    v_mul_f32 v209, v58, v209
    v_mul_f32 v210, v58, v210
    v_mul_f32 v211, v58, v211
    v_mul_f32 v216, v58, v216
    v_mul_f32 v217, v58, v217
    v_mul_f32 v218, v58, v218
    v_mul_f32 v219, v58, v219
    v_mul_f32 v224, v58, v224
    v_mul_f32 v225, v58, v225
    v_mul_f32 v226, v58, v226
    v_mul_f32 v227, v58, v227
    v_mul_f32 v232, v58, v232
    v_mul_f32 v233, v58, v233
    v_mul_f32 v234, v58, v234
    v_mul_f32 v235, v58, v235
    v_mul_f32 v240, v58, v240
    v_mul_f32 v241, v58, v241
    v_mul_f32 v242, v58, v242
    v_mul_f32 v243, v58, v243
    v_mul_f32 v248, v58, v248
    v_mul_f32 v249, v58, v249
    v_mul_f32 v250, v58, v250
    v_mul_f32 v251, v58, v251
    v_max_f32 v62, v84, v85
    v_max3_f32 v62, v62, v86, v87
    v_max3_f32 v62, v62, v92, v93
    v_max3_f32 v62, v62, v94, v95
    v_mov_b32 v58, v62
    s_nop 1
    v_permlane16_swap_b32 v62, v58
    s_nop 1
    v_max_f32 v62, v62, v58
    v_mov_b32 v58, v62
    s_nop 1
    v_permlane32_swap_b32 v62, v58
    s_nop 1
    v_max_f32 v62, v62, v58
    v_add_f32 v62, 0x41c00000, v62
    v_max_f32 v62, 0, v62
    v_exp_f32 v58, -v62
    v_sub_f32 v68, v68, v62
    v_sub_f32 v84, v84, v62
    v_sub_f32 v148, v148, v62
    v_sub_f32 v69, v69, v62
    v_sub_f32 v85, v85, v62
    v_sub_f32 v149, v149, v62
    v_sub_f32 v70, v70, v62
    v_sub_f32 v86, v86, v62
    v_sub_f32 v150, v150, v62
    v_sub_f32 v71, v71, v62
    v_sub_f32 v87, v87, v62
    v_sub_f32 v151, v151, v62
    v_sub_f32 v76, v76, v62
    v_sub_f32 v92, v92, v62
    v_sub_f32 v156, v156, v62
    v_sub_f32 v77, v77, v62
    v_sub_f32 v93, v93, v62
    v_sub_f32 v157, v157, v62
    v_sub_f32 v78, v78, v62
    v_sub_f32 v94, v94, v62
    v_sub_f32 v158, v158, v62
    v_sub_f32 v79, v79, v62
    v_sub_f32 v95, v95, v62
    v_sub_f32 v159, v159, v62
    v_mul_f32 v162, v58, v162
    v_mul_f32 v163, v58, v163
    v_mul_f32 v196, v58, v196
    v_mul_f32 v197, v58, v197
    v_mul_f32 v198, v58, v198
    v_mul_f32 v199, v58, v199
    v_mul_f32 v204, v58, v204
    v_mul_f32 v205, v58, v205
    v_mul_f32 v206, v58, v206
    v_mul_f32 v207, v58, v207
    v_mul_f32 v212, v58, v212
    v_mul_f32 v213, v58, v213
    v_mul_f32 v214, v58, v214
    v_mul_f32 v215, v58, v215
    v_mul_f32 v220, v58, v220
    v_mul_f32 v221, v58, v221
    v_mul_f32 v222, v58, v222
    v_mul_f32 v223, v58, v223
    v_mul_f32 v228, v58, v228
    v_mul_f32 v229, v58, v229
    v_mul_f32 v230, v58, v230
    v_mul_f32 v231, v58, v231
    v_mul_f32 v236, v58, v236
    v_mul_f32 v237, v58, v237
    v_mul_f32 v238, v58, v238
    v_mul_f32 v239, v58, v239
    v_mul_f32 v244, v58, v244
    v_mul_f32 v245, v58, v245
    v_mul_f32 v246, v58, v246
    v_mul_f32 v247, v58, v247
    v_mul_f32 v252, v58, v252
    v_mul_f32 v253, v58, v253
    v_mul_f32 v254, v58, v254
    v_mul_f32 v255, v58, v255
    v_exp_f32 v58, v80
    s_nop 0
    v_exp_f32 v59, v81
    s_nop 0
    v_cvt_pk_bf16_f32 v136, v58, v59
    v_exp_f32 v60, v82
    s_nop 0
    v_exp_f32 v61, v83
    s_nop 0
    v_cvt_pk_bf16_f32 v137, v60, v61
    v_exp_f32 v58, v84
    s_nop 0
    v_exp_f32 v59, v85
    s_nop 0
    v_cvt_pk_bf16_f32 v140, v58, v59
    v_exp_f32 v60, v86
    s_nop 0
    v_exp_f32 v61, v87
    s_nop 0
    v_cvt_pk_bf16_f32 v141, v60, v61
    v_exp_f32 v58, v88
    s_nop 0
    v_exp_f32 v59, v89
    s_nop 0
    v_cvt_pk_bf16_f32 v138, v58, v59
    v_exp_f32 v60, v90
    s_nop 0
    v_exp_f32 v61, v91
    s_nop 0
    v_cvt_pk_bf16_f32 v139, v60, v61
    v_exp_f32 v58, v92
    s_nop 0
    v_exp_f32 v59, v93
    s_nop 0
    v_cvt_pk_bf16_f32 v142, v58, v59
    v_exp_f32 v60, v94
    s_nop 0
    v_exp_f32 v61, v95
    s_nop 0
    v_cvt_pk_bf16_f32 v143, v60, v61
    s_nop 1
    s_setpc_b64 s[80:81]
L_adone:
    ds_read_b128 v[16:19], v4 offset:0
    ds_read_b128 v[20:23], v4 offset:1024
    ds_read_b128 v[24:27], v4 offset:2048
    ds_read_b128 v[28:31], v4 offset:3072
    s_waitcnt lgkmcnt(3)
    v_mfma_f32_16x16x32_bf16 v[56:59], v[96:99], v[16:19], 0
    s_lshr_b32 s6, s3, 2
    s_mul_i32 s67, s6, 15360
    s_add_u32 s67, s67, 98304
    v_mfma_f32_16x16x32_bf16 v[60:63], v[100:103], v[16:19], 0
    v_add_u32 v6, s67, v44
    s_mul_i32 s73, s6, 5120
    s_add_u32 s73, s73, 67108864
    v_mfma_f32_16x16x32_bf16 v[64:67], v[104:107], v[16:19], 0
    s_lshl_b32 s6, s6, 1
    s_sub_u32 s71, s76, s6
    s_and_b32 s71, s71, 3
    v_mfma_f32_16x16x32_bf16 v[68:71], v[108:111], v[16:19], 0
    s_waitcnt lgkmcnt(2)
    v_mov_b32 v11, 0x5000000
    s_lshl_b32 s74, s3, 2
    s_add_u32 s74, s74, 15728640
    v_mfma_f32_16x16x32_bf16 v[72:75], v[112:115], v[16:19], 0
    ds_read_b128 v[16:19], v4 offset:4096
    s_and_b32 s72, s4, 7
    s_lshl_b32 s7, s5, 3
    s_add_u32 s72, s72, s7
    v_mfma_f32_16x16x32_bf16 v[56:59], v[116:119], v[20:23], v[56:59]
    s_mul_i32 s72, s72, 12
    s_lshr_b32 s75, s4, 3
    s_mul_i32 s7, s75, 3
    v_mfma_f32_16x16x32_bf16 v[60:63], v[120:123], v[20:23], v[60:63]
    s_add_u32 s7, s7, s72
    s_mul_i32 s62, s7, 20480
    s_add_u32 s62, s62, 67108864
    v_mfma_f32_16x16x32_bf16 v[64:67], v[124:127], v[20:23], v[64:67]
    s_lshl_b32 s7, s7, 7
    s_add_u32 s63, s7, 15728640
    s_add_u32 s6, s75, 1
    v_mfma_f32_16x16x32_bf16 v[68:71], v[128:131], v[20:23], v[68:71]
    s_waitcnt lgkmcnt(2)
    s_and_b32 s6, s6, 3
    s_mul_i32 s6, s6, 3
    s_add_u32 s6, s6, s72
    v_mfma_f32_16x16x32_bf16 v[72:75], v[132:135], v[20:23], v[72:75]
    ds_read_b128 v[20:23], v4 offset:5120
    s_add_u32 s6, s6, 0
    s_mul_i32 s7, s6, 20480
    s_add_u32 s96, s7, s73
    v_mfma_f32_16x16x32_bf16 v[72:75], v[152:155], v[24:27], v[72:75]
    s_lshl_b32 s6, s6, 7
    s_add_u32 s6, s6, s74
    v_writelane_b32 v11, s6, 0
    v_mfma_f32_16x16x32_bf16 v[68:71], v[148:151], v[24:27], v[68:71]
    s_add_u32 s6, s75, 2
    s_and_b32 s6, s6, 3
    s_mul_i32 s6, s6, 3
    v_mfma_f32_16x16x32_bf16 v[64:67], v[144:147], v[24:27], v[64:67]
    s_add_u32 s6, s6, s72
    s_add_u32 s6, s6, 1
    s_mul_i32 s7, s6, 20480
    v_mfma_f32_16x16x32_bf16 v[60:63], v[140:143], v[24:27], v[60:63]
    s_waitcnt lgkmcnt(2)
    s_add_u32 s97, s7, s73
    s_lshl_b32 s6, s6, 7
    s_add_u32 s6, s6, s74
    v_mfma_f32_16x16x32_bf16 v[56:59], v[136:139], v[24:27], v[56:59]
    ds_read_b128 v[24:27], v4 offset:6144
    v_writelane_b32 v11, s6, 1
    s_add_u32 s6, s75, 3
    s_and_b32 s6, s6, 3
    v_mfma_f32_16x16x32_bf16 v[56:59], v[156:159], v[28:31], v[56:59]
    s_mul_i32 s6, s6, 3
    s_add_u32 s6, s6, s72
    s_add_u32 s6, s6, 2
    v_mfma_f32_16x16x32_bf16 v[60:63], v[160:163], v[28:31], v[60:63]
    s_mul_i32 s7, s6, 20480
    s_add_u32 s98, s7, s73
    s_lshl_b32 s6, s6, 7
    v_mfma_f32_16x16x32_bf16 v[64:67], v[164:167], v[28:31], v[64:67]
    s_add_u32 s6, s6, s74
    v_writelane_b32 v11, s6, 2
    v_mfma_f32_16x16x32_bf16 v[68:71], v[168:171], v[28:31], v[68:71]
    s_waitcnt lgkmcnt(2)
    v_mfma_f32_16x16x32_bf16 v[72:75], v[172:175], v[28:31], v[72:75]
    ds_read_b128 v[28:31], v4 offset:7168
    s_waitcnt vmcnt(0)
    v_mfma_f32_16x16x32_bf16 v[72:75], v[192:195], v[16:19], v[72:75]
    v_mfma_f32_16x16x32_bf16 v[68:71], v[188:191], v[16:19], v[68:71]
    s_add_u32 s65, s68, 3
    s_and_b32 s65, s65, 3
    s_andn2_b32 s7, s68, 3
    v_mfma_f32_16x16x32_bf16 v[64:67], v[184:187], v[16:19], v[64:67]
    s_add_u32 s65, s65, s7
    s_lshl_b32 s65, s65, 17
    s_add_u32 s65, s65, s66
    v_mfma_f32_16x16x32_bf16 v[60:63], v[180:183], v[16:19], v[60:63]
    s_waitcnt lgkmcnt(2)
    s_add_u32 m0, s99, 65536
    v_mfma_f32_16x16x32_bf16 v[56:59], v[176:179], v[16:19], v[56:59]
    s_cmp_ge_u32 s3, 4
    s_cbranch_scc1 L_o0
    s_waitcnt vmcnt(0)
    s_barrier
L_o0:
    ds_read_b128 v[16:19], v4 offset:32768
    v_mfma_f32_16x16x32_bf16 v[56:59], v[196:199], v[20:23], v[56:59]
    buffer_load_dwordx4 v13, s[8:11], s65 offen offset:0 sc1 lds
    v_mfma_f32_16x16x32_bf16 v[60:63], v[200:203], v[20:23], v[60:63]
    buffer_load_dwordx4 v13, s[8:11], s65 offen offset:1024 sc1 lds
    v_mfma_f32_16x16x32_bf16 v[64:67], v[204:207], v[20:23], v[64:67]
    v_mfma_f32_16x16x32_bf16 v[68:71], v[208:211], v[20:23], v[68:71]
    buffer_load_dwordx4 v13, s[8:11], s65 offen offset:2048 sc1 lds
    s_waitcnt lgkmcnt(2)
    v_mfma_f32_16x16x32_bf16 v[72:75], v[212:215], v[20:23], v[72:75]
    ds_read_b128 v[20:23], v4 offset:33792
    v_mfma_f32_16x16x32_bf16 v[72:75], v[232:235], v[24:27], v[72:75]
    buffer_load_dwordx4 v13, s[8:11], s65 offen offset:3072 sc1 lds
    v_mfma_f32_16x16x32_bf16 v[68:71], v[228:231], v[24:27], v[68:71]
    v_mfma_f32_16x16x32_bf16 v[64:67], v[224:227], v[24:27], v[64:67]
    v_mfma_f32_16x16x32_bf16 v[60:63], v[220:223], v[24:27], v[60:63]
    s_waitcnt lgkmcnt(2)
    v_mfma_f32_16x16x32_bf16 v[56:59], v[216:219], v[24:27], v[56:59]
    ds_read_b128 v[24:27], v4 offset:34816
    v_mfma_f32_16x16x32_bf16 v[56:59], v[236:239], v[28:31], v[56:59]
    v_mfma_f32_16x16x32_bf16 v[60:63], v[240:243], v[28:31], v[60:63]
    v_mfma_f32_16x16x32_bf16 v[64:67], v[244:247], v[28:31], v[64:67]
    v_mfma_f32_16x16x32_bf16 v[68:71], v[248:251], v[28:31], v[68:71]
    s_waitcnt lgkmcnt(2)
    v_mfma_f32_16x16x32_bf16 v[72:75], v[252:255], v[28:31], v[72:75]
    ds_read_b128 v[28:31], v4 offset:35840
    v_mfma_f32_16x16x32_bf16 v[76:79], v[96:99], v[16:19], 0
    s_sub_u32 s6, s71, 1
    s_and_b32 s6, s6, 3
    s_mul_i32 s7, s6, 5120
    v_mfma_f32_16x16x32_bf16 v[80:83], v[100:103], v[16:19], 0
    s_add_u32 s7, s7, s67
    s_cmp_eq_u32 s6, 3
    s_cselect_b32 s7, 155648, s7
    v_mfma_f32_16x16x32_bf16 v[84:87], v[104:107], v[16:19], 0
    v_add_u32 v12, s7, v52
    v_add_u32 v5, s67, v45
    v_mfma_f32_16x16x32_bf16 v[88:91], v[108:111], v[16:19], 0
    s_waitcnt lgkmcnt(2)
    v_mfma_f32_16x16x32_bf16 v[92:95], v[112:115], v[16:19], 0
    ds_read_b128 v[16:19], v4 offset:36864
    v_mfma_f32_16x16x32_bf16 v[76:79], v[116:119], v[20:23], v[76:79]
    ds_write_b128 v5, v[60:63] offset:0
    v_add_u32 v5, s67, v46
    v_mfma_f32_16x16x32_bf16 v[80:83], v[120:123], v[20:23], v[80:83]
    v_and_b32 v3, 1, v1
    v_lshlrev_b32 v3, 12, v3
    s_lshr_b32 s72, s61, 2
    s_lshl_b32 s72, s72, 6
    s_andn2_b32 s6, s4, 7
    s_add_u32 s72, s72, s6
    s_add_u32 s72, s72, s3
    s_lshl_b32 s72, s72, 7
    s_add_u32 s72, s72, 3932160
    v_mfma_f32_16x16x32_bf16 v[84:87], v[124:127], v[20:23], v[84:87]
    v_mfma_f32_16x16x32_bf16 v[88:91], v[128:131], v[20:23], v[88:91]
    s_waitcnt lgkmcnt(3)
    v_mfma_f32_16x16x32_bf16 v[92:95], v[132:135], v[20:23], v[92:95]
    ds_read_b128 v[20:23], v4 offset:37888
    v_mfma_f32_16x16x32_bf16 v[92:95], v[152:155], v[24:27], v[92:95]
    ds_write_b128 v5, v[64:67] offset:5120
    v_add_u32 v5, s67, v47
    v_mfma_f32_16x16x32_bf16 v[88:91], v[148:151], v[24:27], v[88:91]
    v_mfma_f32_16x16x32_bf16 v[84:87], v[144:147], v[24:27], v[84:87]
    buffer_load_dword v50, v3, s[8:11], s72 offen sc1
    v_mfma_f32_16x16x32_bf16 v[80:83], v[140:143], v[24:27], v[80:83]
    s_waitcnt lgkmcnt(4)
    v_mfma_f32_16x16x32_bf16 v[76:79], v[136:139], v[24:27], v[76:79]
    ds_read_b128 v[24:27], v4 offset:38912
    v_mfma_f32_16x16x32_bf16 v[76:79], v[156:159], v[28:31], v[76:79]
    ds_write_b128 v5, v[68:71] offset:10240
    v_add_u32 v5, s67, v52
    v_mfma_f32_16x16x32_bf16 v[80:83], v[160:163], v[28:31], v[80:83]
    v_mfma_f32_16x16x32_bf16 v[84:87], v[164:167], v[28:31], v[84:87]
    v_mfma_f32_16x16x32_bf16 v[88:91], v[168:171], v[28:31], v[88:91]
    s_waitcnt lgkmcnt(5)
    v_mfma_f32_16x16x32_bf16 v[92:95], v[172:175], v[28:31], v[92:95]
    ds_read_b128 v[28:31], v4 offset:39936
    v_mfma_f32_16x16x32_bf16 v[92:95], v[192:195], v[16:19], v[92:95]
    ds_write_b128 v12, v[72:75] offset:0
    v_mfma_f32_16x16x32_bf16 v[88:91], v[188:191], v[16:19], v[88:91]
    v_mfma_f32_16x16x32_bf16 v[84:87], v[184:187], v[16:19], v[84:87]
    v_mfma_f32_16x16x32_bf16 v[80:83], v[180:183], v[16:19], v[80:83]
    s_waitcnt lgkmcnt(5)
    v_mfma_f32_16x16x32_bf16 v[76:79], v[176:179], v[16:19], v[76:79]
    s_waitcnt vmcnt(0)
    s_waitcnt lgkmcnt(0)
    s_barrier
    ds_read_b128 v[32:35], v6 offset:0
    ds_read_b128 v[36:39], v6 offset:5120
    ds_read_b128 v[40:43], v6 offset:10240
    ds_read_b128 v[16:19], v7 offset:0
    v_mfma_f32_16x16x32_bf16 v[76:79], v[196:199], v[20:23], v[76:79]
    v_cmp_ne_u32 vcc, 1, v50
    s_mov_b32 s91, 0
    s_cbranch_vccnz L_t3n
    s_add_u32 s65, s61, 1
    s_and_b32 s65, s65, 3
    s_andn2_b32 s7, s61, 3
    s_add_u32 s65, s65, s7
    s_lshl_b32 s65, s65, 17
    s_add_u32 s65, s65, s66
    s_add_u32 m0, s99, 0
    s_add_u32 s65, s65, 0
    buffer_load_dwordx4 v13, s[8:11], s65 offen offset:0 sc1 lds
    buffer_load_dwordx4 v13, s[8:11], s65 offen offset:1024 sc1 lds
    buffer_load_dwordx4 v13, s[8:11], s65 offen offset:2048 sc1 lds
    buffer_load_dwordx4 v13, s[8:11], s65 offen offset:3072 sc1 lds
    s_mov_b32 s91, 1
    s_branch L_t3j
L_t3n:
    buffer_load_dword v50, v3, s[8:11], s72 offen sc1
L_t3j:
    v_mfma_f32_16x16x32_bf16 v[80:83], v[200:203], v[20:23], v[80:83]
    v_mfma_f32_16x16x32_bf16 v[84:87], v[204:207], v[20:23], v[84:87]
    s_waitcnt lgkmcnt(3)
    v_add_f32 v56, v56, v32
    v_add_f32 v57, v57, v33
    v_mfma_f32_16x16x32_bf16 v[88:91], v[208:211], v[20:23], v[88:91]
    v_add_f32 v58, v58, v34
    v_add_f32 v59, v59, v35
    v_mfma_f32_16x16x32_bf16 v[92:95], v[212:215], v[20:23], v[92:95]
    s_waitcnt lgkmcnt(2)
    ds_read_b128 v[32:35], v5 offset:0
    ds_read_b128 v[20:23], v7 offset:1024
    v_add_f32 v56, v56, v36
    v_add_f32 v57, v57, v37
    v_mfma_f32_16x16x32_bf16 v[92:95], v[232:235], v[24:27], v[92:95]
    v_add_f32 v58, v58, v38
    v_add_f32 v59, v59, v39
    v_mfma_f32_16x16x32_bf16 v[88:91], v[228:231], v[24:27], v[88:91]
    s_waitcnt lgkmcnt(3)
    ds_read_b128 v[36:39], v5 offset:5120
    v_add_f32 v56, v56, v40
    v_add_f32 v57, v57, v41
    v_mfma_f32_16x16x32_bf16 v[84:87], v[224:227], v[24:27], v[84:87]
    v_add_f32 v58, v58, v42
    v_add_f32 v59, v59, v43
    v_mfma_f32_16x16x32_bf16 v[80:83], v[220:223], v[24:27], v[80:83]
    ds_read_b128 v[40:43], v5 offset:10240
    s_waitcnt lgkmcnt(3)
    v_add_f32 v72, v72, v32
    v_add_f32 v73, v73, v33
    s_add_u32 s6, s96, 0
    v_mfma_f32_16x16x32_bf16 v[76:79], v[216:219], v[24:27], v[76:79]
    ds_read_b128 v[24:27], v7 offset:2048
    v_add_f32 v74, v74, v34
    v_add_f32 v75, v75, v35
    v_mfma_f32_16x16x32_bf16 v[76:79], v[236:239], v[28:31], v[76:79]
    buffer_store_dwordx4 v[56:59], v44, s[8:11], s6 offen sc1
    s_waitcnt lgkmcnt(2)
    v_add_f32 v72, v72, v36
    v_add_f32 v73, v73, v37
    v_mfma_f32_16x16x32_bf16 v[80:83], v[240:243], v[28:31], v[80:83]
    v_add_f32 v74, v74, v38
    v_add_f32 v75, v75, v39
    v_mfma_f32_16x16x32_bf16 v[84:87], v[244:247], v[28:31], v[84:87]
    s_waitcnt lgkmcnt(1)
    v_add_f32 v72, v72, v40
    v_add_f32 v73, v73, v41
    v_mfma_f32_16x16x32_bf16 v[88:91], v[248:251], v[28:31], v[88:91]
    v_add_f32 v74, v74, v42
    v_add_f32 v75, v75, v43
    s_cmp_lg_u32 s71, 0
    v_mfma_f32_16x16x32_bf16 v[92:95], v[252:255], v[28:31], v[92:95]
    s_cbranch_scc1 L_nost_50
    buffer_store_dwordx4 v[72:75], v52, s[8:11], s6 offen sc1
L_nost_50:
    ds_read_b128 v[28:31], v7 offset:3072
    v_mfma_f32_16x16x32_bf16 v[56:59], v[96:99], v[16:19], 0
    s_sub_u32 s6, s71, 2
    s_and_b32 s6, s6, 3
    s_mul_i32 s7, s6, 5120
    v_mfma_f32_16x16x32_bf16 v[60:63], v[100:103], v[16:19], 0
    s_add_u32 s7, s7, s67
    s_cmp_eq_u32 s6, 3
    s_cselect_b32 s7, 124928, s7
    v_mfma_f32_16x16x32_bf16 v[64:67], v[104:107], v[16:19], 0
    v_add_u32 v12, s7, v52
    v_add_u32 v5, s67, v45
    s_cmp_lg_u32 s91, 0
    s_cbranch_scc1 L_o2
    s_waitcnt vmcnt(1)
    v_cmp_ne_u32 vcc, 1, v50
    s_cbranch_vccz L_o1
    s_mov_b32 s79, 262144
L_poll_52:
    buffer_load_dword v2, v3, s[8:11], s72 offen sc1
    s_waitcnt vmcnt(0)
    v_cmp_ne_u32 vcc, 1, v2
    s_cbranch_vccz L_polldone_53
    s_sleep 1
    s_sub_u32 s79, s79, 1
    s_cmp_lg_u32 s79, 0
    s_cbranch_scc1 L_poll_52
L_polldone_53:
L_o1:
    s_add_u32 s65, s61, 1
    s_and_b32 s65, s65, 3
    s_andn2_b32 s7, s61, 3
    s_add_u32 s65, s65, s7
    s_lshl_b32 s65, s65, 17
    s_add_u32 s65, s65, s66
    s_add_u32 m0, s99, 0
    s_add_u32 s65, s65, 0
    buffer_load_dwordx4 v13, s[8:11], s65 offen offset:0 sc1 lds
    buffer_load_dwordx4 v13, s[8:11], s65 offen offset:1024 sc1 lds
    buffer_load_dwordx4 v13, s[8:11], s65 offen offset:2048 sc1 lds
    buffer_load_dwordx4 v13, s[8:11], s65 offen offset:3072 sc1 lds
L_o2:
    v_mfma_f32_16x16x32_bf16 v[68:71], v[108:111], v[16:19], 0
    v_mfma_f32_16x16x32_bf16 v[72:75], v[112:115], v[16:19], 0
    ds_read_b128 v[16:19], v7 offset:4096
    v_mfma_f32_16x16x32_bf16 v[56:59], v[116:119], v[20:23], v[56:59]
    ds_write_b128 v5, v[80:83] offset:30720
    v_add_u32 v5, s67, v46
    v_mfma_f32_16x16x32_bf16 v[60:63], v[120:123], v[20:23], v[60:63]
    s_add_u32 s65, s61, 2
    s_and_b32 s65, s65, 3
    s_andn2_b32 s7, s61, 3
    v_mfma_f32_16x16x32_bf16 v[64:67], v[124:127], v[20:23], v[64:67]
    s_add_u32 s65, s65, s7
    s_lshl_b32 s65, s65, 17
    s_add_u32 s65, s65, s66
    v_mfma_f32_16x16x32_bf16 v[68:71], v[128:131], v[20:23], v[68:71]
    s_waitcnt lgkmcnt(3)
    s_add_u32 m0, s99, 32768
    v_mfma_f32_16x16x32_bf16 v[72:75], v[132:135], v[20:23], v[72:75]
    buffer_load_dwordx4 v13, s[8:11], s65 offen offset:0 sc1 lds
    ds_read_b128 v[20:23], v7 offset:5120
    v_mfma_f32_16x16x32_bf16 v[72:75], v[152:155], v[24:27], v[72:75]
    ds_write_b128 v5, v[84:87] offset:35840
    v_add_u32 v5, s67, v47
    v_mfma_f32_16x16x32_bf16 v[68:71], v[148:151], v[24:27], v[68:71]
    buffer_load_dwordx4 v13, s[8:11], s65 offen offset:1024 sc1 lds
    v_mfma_f32_16x16x32_bf16 v[64:67], v[144:147], v[24:27], v[64:67]
    buffer_load_dwordx4 v13, s[8:11], s65 offen offset:2048 sc1 lds
    v_mfma_f32_16x16x32_bf16 v[60:63], v[140:143], v[24:27], v[60:63]
    buffer_load_dwordx4 v13, s[8:11], s65 offen offset:3072 sc1 lds
    s_waitcnt lgkmcnt(4)
    v_mfma_f32_16x16x32_bf16 v[56:59], v[136:139], v[24:27], v[56:59]
    ds_read_b128 v[24:27], v7 offset:6144
    v_mfma_f32_16x16x32_bf16 v[56:59], v[156:159], v[28:31], v[56:59]
    ds_write_b128 v5, v[88:91] offset:40960
    v_add_u32 v5, s67, v52
    v_mfma_f32_16x16x32_bf16 v[60:63], v[160:163], v[28:31], v[60:63]
    v_mfma_f32_16x16x32_bf16 v[64:67], v[164:167], v[28:31], v[64:67]
    v_mfma_f32_16x16x32_bf16 v[68:71], v[168:171], v[28:31], v[68:71]
    s_waitcnt lgkmcnt(5)
    v_mfma_f32_16x16x32_bf16 v[72:75], v[172:175], v[28:31], v[72:75]
    ds_read_b128 v[28:31], v7 offset:7168
    v_mfma_f32_16x16x32_bf16 v[72:75], v[192:195], v[16:19], v[72:75]
    ds_write_b128 v12, v[92:95] offset:30720
    v_mfma_f32_16x16x32_bf16 v[68:71], v[188:191], v[16:19], v[68:71]
    s_add_u32 s65, s61, 3
    s_and_b32 s65, s65, 3
    s_andn2_b32 s7, s61, 3
    v_mfma_f32_16x16x32_bf16 v[64:67], v[184:187], v[16:19], v[64:67]
    s_add_u32 s65, s65, s7
    s_lshl_b32 s65, s65, 17
    s_add_u32 s65, s65, s66
    v_mfma_f32_16x16x32_bf16 v[60:63], v[180:183], v[16:19], v[60:63]
    s_waitcnt lgkmcnt(5)
    s_add_u32 m0, s99, 65536
    v_mfma_f32_16x16x32_bf16 v[56:59], v[176:179], v[16:19], v[56:59]
    s_waitcnt vmcnt(4)
    s_waitcnt lgkmcnt(0)
    s_barrier
    ds_read_b128 v[32:35], v6 offset:30720
    ds_read_b128 v[36:39], v6 offset:35840
    ds_read_b128 v[40:43], v6 offset:40960
    ds_read_b128 v[16:19], v4 offset:0
    v_mfma_f32_16x16x32_bf16 v[56:59], v[196:199], v[20:23], v[56:59]
    buffer_load_dwordx4 v13, s[8:11], s65 offen offset:0 sc1 lds
    v_mfma_f32_16x16x32_bf16 v[60:63], v[200:203], v[20:23], v[60:63]
    buffer_load_dwordx4 v13, s[8:11], s65 offen offset:1024 sc1 lds
    v_mfma_f32_16x16x32_bf16 v[64:67], v[204:207], v[20:23], v[64:67]
    s_waitcnt lgkmcnt(3)
    v_add_f32 v76, v76, v32
    v_add_f32 v77, v77, v33
    v_mfma_f32_16x16x32_bf16 v[68:71], v[208:211], v[20:23], v[68:71]
    buffer_load_dwordx4 v13, s[8:11], s65 offen offset:2048 sc1 lds
    v_add_f32 v78, v78, v34
    v_add_f32 v79, v79, v35
    v_mfma_f32_16x16x32_bf16 v[72:75], v[212:215], v[20:23], v[72:75]
    s_waitcnt lgkmcnt(2)
    ds_read_b128 v[32:35], v5 offset:30720
    ds_read_b128 v[20:23], v4 offset:1024
    v_add_f32 v76, v76, v36
    v_add_f32 v77, v77, v37
    v_mfma_f32_16x16x32_bf16 v[72:75], v[232:235], v[24:27], v[72:75]
    buffer_load_dwordx4 v13, s[8:11], s65 offen offset:3072 sc1 lds
    v_add_f32 v78, v78, v38
    v_add_f32 v79, v79, v39
    v_mfma_f32_16x16x32_bf16 v[68:71], v[228:231], v[24:27], v[68:71]
    s_waitcnt lgkmcnt(3)
    ds_read_b128 v[36:39], v5 offset:35840
    v_add_f32 v76, v76, v40
    v_add_f32 v77, v77, v41
    v_mfma_f32_16x16x32_bf16 v[64:67], v[224:227], v[24:27], v[64:67]
    v_add_f32 v78, v78, v42
    v_add_f32 v79, v79, v43
    v_mfma_f32_16x16x32_bf16 v[60:63], v[220:223], v[24:27], v[60:63]
    ds_read_b128 v[40:43], v5 offset:40960
    s_waitcnt lgkmcnt(3)
    v_add_f32 v92, v92, v32
    v_add_f32 v93, v93, v33
    s_add_u32 s6, s97, 0
    v_mfma_f32_16x16x32_bf16 v[56:59], v[216:219], v[24:27], v[56:59]
    ds_read_b128 v[24:27], v4 offset:2048
    v_add_f32 v94, v94, v34
    v_add_f32 v95, v95, v35
    v_mfma_f32_16x16x32_bf16 v[56:59], v[236:239], v[28:31], v[56:59]
    buffer_store_dwordx4 v[76:79], v44, s[8:11], s6 offen sc1
    s_waitcnt lgkmcnt(2)
    v_add_f32 v92, v92, v36
    v_add_f32 v93, v93, v37
    v_mfma_f32_16x16x32_bf16 v[60:63], v[240:243], v[28:31], v[60:63]
    v_add_f32 v94, v94, v38
    v_add_f32 v95, v95, v39
    v_mfma_f32_16x16x32_bf16 v[64:67], v[244:247], v[28:31], v[64:67]
    s_waitcnt lgkmcnt(1)
    v_add_f32 v92, v92, v40
    v_add_f32 v93, v93, v41
    v_mfma_f32_16x16x32_bf16 v[68:71], v[248:251], v[28:31], v[68:71]
    v_add_f32 v94, v94, v42
    v_add_f32 v95, v95, v43
    s_cmp_lg_u32 s71, 1
    v_mfma_f32_16x16x32_bf16 v[72:75], v[252:255], v[28:31], v[72:75]
    s_cbranch_scc1 L_nost_51
    buffer_store_dwordx4 v[92:95], v52, s[8:11], s6 offen sc1
L_nost_51:
    ds_read_b128 v[28:31], v4 offset:3072
    v_mfma_f32_16x16x32_bf16 v[76:79], v[96:99], v[16:19], 0
    s_sub_u32 s6, s71, 3
    s_and_b32 s6, s6, 3
    s_mul_i32 s7, s6, 5120
    v_mfma_f32_16x16x32_bf16 v[80:83], v[100:103], v[16:19], 0
    s_add_u32 s7, s7, s67
    s_cmp_eq_u32 s6, 3
    s_cselect_b32 s7, 155648, s7
    v_mfma_f32_16x16x32_bf16 v[84:87], v[104:107], v[16:19], 0
    v_add_u32 v12, s7, v52
    v_add_u32 v5, s67, v45
    v_mfma_f32_16x16x32_bf16 v[88:91], v[108:111], v[16:19], 0
    s_mov_b32 s12, s32
    s_mov_b32 s13, s33
    s_mov_b32 s14, 0x280000
    s_mov_b32 s15, 0x20000
    v_mfma_f32_16x16x32_bf16 v[92:95], v[112:115], v[16:19], 0
    ds_read_b128 v[16:19], v4 offset:4096
    s_and_b32 s75, s4, 3
    s_mul_i32 s70, s75, 320
    s_add_u32 s73, s70, 3837952
    s_mul_i32 s72, s75, 5120
    v_mfma_f32_16x16x32_bf16 v[76:79], v[116:119], v[20:23], v[76:79]
    ds_write_b128 v5, v[60:63] offset:0
    v_add_u32 v5, s67, v46
    v_mfma_f32_16x16x32_bf16 v[80:83], v[120:123], v[20:23], v[80:83]
    v_lshrrev_b32 v2, 4, v1
    v_and_b32 v3, 15, v1
    v_mul_u32_u24 v54, 1280, v3
    v_lshl_add_u32 v54, v2, 4, v54
    v_mfma_f32_16x16x32_bf16 v[84:87], v[124:127], v[20:23], v[84:87]
    v_lshlrev_b32 v3, 4, v3
    v_lshl_add_u32 v9, v2, 9, v3
    s_lshr_b32 s100, s3, 2
    s_cselect_b32 s6, s61, s68
    v_mfma_f32_16x16x32_bf16 v[88:91], v[128:131], v[20:23], v[88:91]
    s_waitcnt lgkmcnt(3)
    s_mul_i32 s6, s6, 20480
    s_lshl_b32 s7, s76, 6
    s_add_u32 s7, s7, s6
    v_add_u32 v53, s7, v54
    v_mfma_f32_16x16x32_bf16 v[92:95], v[132:135], v[20:23], v[92:95]
    ds_read_b128 v[20:23], v4 offset:5120
    s_lshl_b32 s7, s76, 10
    s_add_u32 s7, s7, s6
    s_add_u32 s7, s7, s72
    v_add_u32 v48, s7, v13
    v_mfma_f32_16x16x32_bf16 v[92:95], v[152:155], v[24:27], v[92:95]
    ds_write_b128 v5, v[64:67] offset:5120
    v_add_u32 v5, s67, v47
    v_mfma_f32_16x16x32_bf16 v[88:91], v[148:151], v[24:27], v[88:91]
    s_mul_i32 s6, s100, 10240
    s_lshl_b32 s7, s76, 11
    s_add_u32 s6, s6, s7
    v_add_u32 v8, s6, v9
    v_mfma_f32_16x16x32_bf16 v[84:87], v[144:147], v[24:27], v[84:87]
    s_mul_i32 s6, s100, 75776
    s_sub_u32 s6, 65536, s6
    v_add_u32 v10, s6, v8
    s_lshl_b32 s7, s76, 2
    v_mfma_f32_16x16x32_bf16 v[80:83], v[140:143], v[24:27], v[80:83]
    s_waitcnt lgkmcnt(4)
    v_add_u32 v2, s7, v2
    v_cmp_lt_u32 vcc, 9, v2
    s_mul_i32 s6, s100, 86016
    s_add_u32 s6, s6, 15360
    v_mfma_f32_16x16x32_bf16 v[76:79], v[136:139], v[24:27], v[76:79]
    ds_read_b128 v[24:27], v4 offset:6144
    v_add_u32 v3, s6, v10
    v_cndmask_b32 v10, v10, v3, vcc
    s_and_b32 s100, s3, 1
    s_cselect_b32 s6, s61, s68
    v_mfma_f32_16x16x32_bf16 v[76:79], v[156:159], v[28:31], v[76:79]
    ds_write_b128 v5, v[68:71] offset:10240
    v_add_u32 v5, s67, v52
    v_mfma_f32_16x16x32_bf16 v[80:83], v[160:163], v[28:31], v[80:83]
    s_mul_i32 s6, s6, 20480
    s_add_u32 s7, s6, 256
    v_add_u32 v54, s7, v54
    s_add_u32 s7, s6, s72
    v_mfma_f32_16x16x32_bf16 v[84:87], v[164:167], v[28:31], v[84:87]
    s_add_u32 s7, s7, 4096
    v_add_u32 v49, s7, v13
    s_mul_i32 s6, s100, 10240
    s_add_u32 s6, s6, 8192
    v_mfma_f32_16x16x32_bf16 v[88:91], v[168:171], v[28:31], v[88:91]
    s_waitcnt lgkmcnt(5)
    v_add_u32 v9, s6, v9
    s_mul_i32 s6, s100, 10240
    s_add_u32 s6, s6, 80896
    v_add_u32 v55, s6, v9
    v_mfma_f32_16x16x32_bf16 v[92:95], v[172:175], v[28:31], v[92:95]
    ds_read_b128 v[28:31], v4 offset:7168
    v_mfma_f32_16x16x32_bf16 v[92:95], v[192:195], v[16:19], v[92:95]
    ds_write_b128 v12, v[72:75] offset:0
    v_mfma_f32_16x16x32_bf16 v[88:91], v[188:191], v[16:19], v[88:91]
    s_add_u32 s65, s68, 0
    s_and_b32 s65, s65, 3
    s_andn2_b32 s7, s68, 3
    v_mfma_f32_16x16x32_bf16 v[84:87], v[184:187], v[16:19], v[84:87]
    s_add_u32 s65, s65, s7
    s_lshl_b32 s65, s65, 17
    s_add_u32 s65, s65, s66
    v_mfma_f32_16x16x32_bf16 v[80:83], v[180:183], v[16:19], v[80:83]
    s_waitcnt lgkmcnt(5)
    s_add_u32 m0, s99, 0
    v_mfma_f32_16x16x32_bf16 v[76:79], v[176:179], v[16:19], v[76:79]
    s_waitcnt vmcnt(5)
    s_waitcnt lgkmcnt(0)
    s_barrier
    ds_read_b128 v[32:35], v6 offset:0
    ds_read_b128 v[36:39], v6 offset:5120
    ds_read_b128 v[40:43], v6 offset:10240
    ds_read_b128 v[16:19], v4 offset:32768
    v_mfma_f32_16x16x32_bf16 v[76:79], v[196:199], v[20:23], v[76:79]
    buffer_load_dwordx4 v13, s[8:11], s65 offen offset:0 sc1 lds
    v_mfma_f32_16x16x32_bf16 v[80:83], v[200:203], v[20:23], v[80:83]
    buffer_load_dwordx4 v13, s[8:11], s65 offen offset:1024 sc1 lds
    v_mfma_f32_16x16x32_bf16 v[84:87], v[204:207], v[20:23], v[84:87]
    s_waitcnt lgkmcnt(3)
    v_add_f32 v56, v56, v32
    v_add_f32 v57, v57, v33
    v_mfma_f32_16x16x32_bf16 v[88:91], v[208:211], v[20:23], v[88:91]
    buffer_load_dwordx4 v13, s[8:11], s65 offen offset:2048 sc1 lds
    v_add_f32 v58, v58, v34
    v_add_f32 v59, v59, v35
    v_mfma_f32_16x16x32_bf16 v[92:95], v[212:215], v[20:23], v[92:95]
    s_waitcnt lgkmcnt(2)
    ds_read_b128 v[32:35], v5 offset:0
    ds_read_b128 v[20:23], v4 offset:33792
    v_add_f32 v56, v56, v36
    v_add_f32 v57, v57, v37
    v_mfma_f32_16x16x32_bf16 v[92:95], v[232:235], v[24:27], v[92:95]
    buffer_load_dwordx4 v13, s[8:11], s65 offen offset:3072 sc1 lds
    v_add_f32 v58, v58, v38
    v_add_f32 v59, v59, v39
    v_mfma_f32_16x16x32_bf16 v[88:91], v[228:231], v[24:27], v[88:91]
    s_waitcnt lgkmcnt(3)
    ds_read_b128 v[36:39], v5 offset:5120
    v_add_f32 v56, v56, v40
    v_add_f32 v57, v57, v41
    v_mfma_f32_16x16x32_bf16 v[84:87], v[224:227], v[24:27], v[84:87]
    v_add_f32 v58, v58, v42
    v_add_f32 v59, v59, v43
    v_mfma_f32_16x16x32_bf16 v[80:83], v[220:223], v[24:27], v[80:83]
    ds_read_b128 v[40:43], v5 offset:10240
    s_waitcnt lgkmcnt(3)
    v_add_f32 v72, v72, v32
    v_add_f32 v73, v73, v33
    s_add_u32 s6, s98, 0
    v_mfma_f32_16x16x32_bf16 v[76:79], v[216:219], v[24:27], v[76:79]
    ds_read_b128 v[24:27], v4 offset:34816
    v_add_f32 v74, v74, v34
    v_add_f32 v75, v75, v35
    v_mfma_f32_16x16x32_bf16 v[76:79], v[236:239], v[28:31], v[76:79]
    buffer_store_dwordx4 v[56:59], v44, s[8:11], s6 offen sc1
    s_waitcnt lgkmcnt(2)
    v_add_f32 v72, v72, v36
    v_add_f32 v73, v73, v37
    v_mfma_f32_16x16x32_bf16 v[80:83], v[240:243], v[28:31], v[80:83]
    v_add_f32 v74, v74, v38
    v_add_f32 v75, v75, v39
    v_mfma_f32_16x16x32_bf16 v[84:87], v[244:247], v[28:31], v[84:87]
    s_waitcnt lgkmcnt(1)
    v_add_f32 v72, v72, v40
    v_add_f32 v73, v73, v41
    v_mfma_f32_16x16x32_bf16 v[88:91], v[248:251], v[28:31], v[88:91]
    v_add_f32 v74, v74, v42
    v_add_f32 v75, v75, v43
    s_cmp_lg_u32 s71, 2
    v_mfma_f32_16x16x32_bf16 v[92:95], v[252:255], v[28:31], v[92:95]
    s_cbranch_scc1 L_nost_54
    buffer_store_dwordx4 v[72:75], v52, s[8:11], s6 offen sc1
L_nost_54:
    ds_read_b128 v[28:31], v4 offset:35840
    v_mfma_f32_16x16x32_bf16 v[56:59], v[96:99], v[16:19], 0
    s_sub_u32 s6, s71, 4
    s_and_b32 s6, s6, 3
    s_mul_i32 s7, s6, 5120
    v_mfma_f32_16x16x32_bf16 v[60:63], v[100:103], v[16:19], 0
    s_add_u32 s7, s7, s67
    s_cmp_eq_u32 s6, 3
    s_cselect_b32 s7, 124928, s7
    v_mfma_f32_16x16x32_bf16 v[64:67], v[104:107], v[16:19], 0
    v_add_u32 v12, s7, v52
    v_add_u32 v5, s67, v45
    v_mfma_f32_16x16x32_bf16 v[68:71], v[108:111], v[16:19], 0
    v_mfma_f32_16x16x32_bf16 v[72:75], v[112:115], v[16:19], 0
    ds_read_b128 v[16:19], v4 offset:36864
    v_mfma_f32_16x16x32_bf16 v[56:59], v[116:119], v[20:23], v[56:59]
    ds_write_b128 v5, v[80:83] offset:30720
    v_add_u32 v5, s67, v46
    v_mfma_f32_16x16x32_bf16 v[60:63], v[120:123], v[20:23], v[60:63]
    v_mfma_f32_16x16x32_bf16 v[64:67], v[124:127], v[20:23], v[64:67]
    v_cmp_le_i32 vcc, 0, v51
    s_cbranch_vccz L_idx_okb
    v_and_b32 v3, 7, v1
    v_lshlrev_b32 v3, 2, v3
    s_mov_b32 s72, 0x3a0000
    s_mov_b32 s79, 262144
L_poll_56:
    buffer_load_dword v51, v3, s[8:11], s72 offen sc1
    s_waitcnt vmcnt(0)
    v_cmp_le_i32 vcc, 0, v51
    s_cbranch_vccz L_polldone_57
    s_sleep 2
    s_sub_u32 s79, s79, 1
    s_cmp_lg_u32 s79, 0
    s_cbranch_scc1 L_poll_56
L_polldone_57:
L_idx_okb:
    s_mov_b32 s64, 0
    v_and_b32 v2, 0x7ff, v51
    v_sub_u32 v2, 0x7ff, v2
    v_lshrrev_b32 v3, 4, v2
    v_cmp_eq_u32 vcc, s68, v3
    v_cmp_eq_u32 s[74:75], s61, v3
    s_nop 3
    s_or_b64 vcc, vcc, s[74:75]
    s_cbranch_scc0 L_notok_58
    v_readlane_b32 s84, v2, 0
    v_readlane_b32 s85, v2, 1
    v_readlane_b32 s86, v2, 2
    v_readlane_b32 s87, v2, 3
    v_readlane_b32 s88, v2, 4
    v_readlane_b32 s65, v2, 5
    v_readlane_b32 s91, v2, 6
    v_readlane_b32 s101, v2, 7
    s_lshl_b32 s7, s76, 6
    s_lshr_b32 s100, s3, 2
    s_cselect_b32 s6, s61, s68
    s_lshl_b32 s6, s6, 4
    v_and_b32 v2, 15, v1
    v_add_u32 v2, s6, v2
    s_add_u32 s7, s7, s73
    v_and_b32 v3, 48, v1
    v_add_u32 v3, s7, v3
    v_cmp_eq_u32 vcc, s84, v2
    s_nop 1
    v_cndmask_b32 v48, v48, v3, vcc
    v_add_u32 v3, 1280, v3
    v_cmp_eq_u32 vcc, s85, v2
    s_nop 1
    v_cndmask_b32 v48, v48, v3, vcc
    v_add_u32 v3, 1280, v3
    v_cmp_eq_u32 vcc, s86, v2
    s_nop 1
    v_cndmask_b32 v48, v48, v3, vcc
    v_add_u32 v3, 1280, v3
    v_cmp_eq_u32 vcc, s87, v2
    s_nop 1
    v_cndmask_b32 v48, v48, v3, vcc
    v_add_u32 v3, 1280, v3
    v_cmp_eq_u32 vcc, s88, v2
    s_nop 1
    v_cndmask_b32 v48, v48, v3, vcc
    v_add_u32 v3, 1280, v3
    v_cmp_eq_u32 vcc, s65, v2
    s_nop 1
    v_cndmask_b32 v48, v48, v3, vcc
    v_add_u32 v3, 1280, v3
    v_cmp_eq_u32 vcc, s91, v2
    s_nop 1
    v_cndmask_b32 v48, v48, v3, vcc
    v_add_u32 v3, 1280, v3
    v_cmp_eq_u32 vcc, s101, v2
    s_nop 1
    v_cndmask_b32 v48, v48, v3, vcc
    s_movk_i32 s7, 256
    s_and_b32 s100, s3, 1
    s_cselect_b32 s6, s61, s68
    s_lshl_b32 s6, s6, 4
    v_and_b32 v2, 15, v1
    v_add_u32 v2, s6, v2
    s_add_u32 s7, s7, s73
    v_and_b32 v3, 48, v1
    v_add_u32 v3, s7, v3
    v_cmp_eq_u32 vcc, s84, v2
    s_nop 1
    v_cndmask_b32 v49, v49, v3, vcc
    v_add_u32 v3, 1280, v3
    v_cmp_eq_u32 vcc, s85, v2
    s_nop 1
    v_cndmask_b32 v49, v49, v3, vcc
    v_add_u32 v3, 1280, v3
    v_cmp_eq_u32 vcc, s86, v2
    s_nop 1
    v_cndmask_b32 v49, v49, v3, vcc
    v_add_u32 v3, 1280, v3
    v_cmp_eq_u32 vcc, s87, v2
    s_nop 1
    v_cndmask_b32 v49, v49, v3, vcc
    v_add_u32 v3, 1280, v3
    v_cmp_eq_u32 vcc, s88, v2
    s_nop 1
    v_cndmask_b32 v49, v49, v3, vcc
    v_add_u32 v3, 1280, v3
    v_cmp_eq_u32 vcc, s65, v2
    s_nop 1
    v_cndmask_b32 v49, v49, v3, vcc
    v_add_u32 v3, 1280, v3
    v_cmp_eq_u32 vcc, s91, v2
    s_nop 1
    v_cndmask_b32 v49, v49, v3, vcc
    v_add_u32 v3, 1280, v3
    v_cmp_eq_u32 vcc, s101, v2
    s_nop 1
    v_cndmask_b32 v49, v49, v3, vcc
    s_mov_b32 s64, 1
L_notok_58:
    v_mfma_f32_16x16x32_bf16 v[68:71], v[128:131], v[20:23], v[68:71]
    s_waitcnt lgkmcnt(3)
    v_mfma_f32_16x16x32_bf16 v[72:75], v[132:135], v[20:23], v[72:75]
    ds_read_b128 v[20:23], v4 offset:37888
    v_mfma_f32_16x16x32_bf16 v[72:75], v[152:155], v[24:27], v[72:75]
    ds_write_b128 v5, v[84:87] offset:35840
    v_add_u32 v5, s67, v47
    v_mfma_f32_16x16x32_bf16 v[68:71], v[148:151], v[24:27], v[68:71]
    v_mfma_f32_16x16x32_bf16 v[64:67], v[144:147], v[24:27], v[64:67]
    v_mfma_f32_16x16x32_bf16 v[60:63], v[140:143], v[24:27], v[60:63]
    s_waitcnt lgkmcnt(4)
    v_mfma_f32_16x16x32_bf16 v[56:59], v[136:139], v[24:27], v[56:59]
    ds_read_b128 v[24:27], v4 offset:38912
    v_mfma_f32_16x16x32_bf16 v[56:59], v[156:159], v[28:31], v[56:59]
    ds_write_b128 v5, v[88:91] offset:40960
    v_add_u32 v5, s67, v52
    v_mfma_f32_16x16x32_bf16 v[60:63], v[160:163], v[28:31], v[60:63]
    v_mfma_f32_16x16x32_bf16 v[64:67], v[164:167], v[28:31], v[64:67]
    v_mfma_f32_16x16x32_bf16 v[68:71], v[168:171], v[28:31], v[68:71]
    s_waitcnt lgkmcnt(5)
    v_mfma_f32_16x16x32_bf16 v[72:75], v[172:175], v[28:31], v[72:75]
    ds_read_b128 v[28:31], v4 offset:39936
    v_mfma_f32_16x16x32_bf16 v[72:75], v[192:195], v[16:19], v[72:75]
    ds_write_b128 v12, v[92:95] offset:30720
    v_mfma_f32_16x16x32_bf16 v[68:71], v[188:191], v[16:19], v[68:71]
    s_add_u32 s65, s61, 0
    s_and_b32 s65, s65, 3
    s_andn2_b32 s7, s61, 3
    v_mfma_f32_16x16x32_bf16 v[64:67], v[184:187], v[16:19], v[64:67]
    s_add_u32 s65, s65, s7
    s_lshl_b32 s65, s65, 17
    s_add_u32 s65, s65, s66
    v_mfma_f32_16x16x32_bf16 v[60:63], v[180:183], v[16:19], v[60:63]
    s_waitcnt lgkmcnt(5)
    s_add_u32 m0, s99, 32768
    v_mfma_f32_16x16x32_bf16 v[56:59], v[176:179], v[16:19], v[56:59]
    s_waitcnt vmcnt(5)
    s_waitcnt lgkmcnt(0)
    s_barrier
    ds_read_b128 v[32:35], v6 offset:30720
    ds_read_b128 v[36:39], v6 offset:35840
    ds_read_b128 v[40:43], v6 offset:40960
    ds_read_b128 v[16:19], v7 offset:0
    v_mfma_f32_16x16x32_bf16 v[56:59], v[196:199], v[20:23], v[56:59]
    buffer_load_dwordx4 v13, s[8:11], s65 offen offset:0 sc1 lds
    v_mfma_f32_16x16x32_bf16 v[60:63], v[200:203], v[20:23], v[60:63]
    buffer_load_dwordx4 v13, s[8:11], s65 offen offset:1024 sc1 lds
    v_mfma_f32_16x16x32_bf16 v[64:67], v[204:207], v[20:23], v[64:67]
    s_waitcnt lgkmcnt(3)
    v_add_f32 v76, v76, v32
    v_add_f32 v77, v77, v33
    v_mfma_f32_16x16x32_bf16 v[68:71], v[208:211], v[20:23], v[68:71]
    buffer_load_dwordx4 v13, s[8:11], s65 offen offset:2048 sc1 lds
    v_add_f32 v78, v78, v34
    v_add_f32 v79, v79, v35
    v_mfma_f32_16x16x32_bf16 v[72:75], v[212:215], v[20:23], v[72:75]
    s_waitcnt lgkmcnt(2)
    ds_read_b128 v[32:35], v5 offset:30720
    ds_read_b128 v[20:23], v7 offset:1024
    v_add_f32 v76, v76, v36
    v_add_f32 v77, v77, v37
    v_mfma_f32_16x16x32_bf16 v[72:75], v[232:235], v[24:27], v[72:75]
    buffer_load_dwordx4 v13, s[8:11], s65 offen offset:3072 sc1 lds
    v_add_f32 v78, v78, v38
    v_add_f32 v79, v79, v39
    v_mfma_f32_16x16x32_bf16 v[68:71], v[228:231], v[24:27], v[68:71]
    s_waitcnt lgkmcnt(3)
    ds_read_b128 v[36:39], v5 offset:35840
    v_add_f32 v76, v76, v40
    v_add_f32 v77, v77, v41
    v_mfma_f32_16x16x32_bf16 v[64:67], v[224:227], v[24:27], v[64:67]
    v_add_f32 v78, v78, v42
    v_add_f32 v79, v79, v43
    v_mfma_f32_16x16x32_bf16 v[60:63], v[220:223], v[24:27], v[60:63]
    ds_read_b128 v[40:43], v5 offset:40960
    s_waitcnt lgkmcnt(3)
    v_add_f32 v92, v92, v32
    v_add_f32 v93, v93, v33
    s_add_u32 s6, s96, 10240
    v_mfma_f32_16x16x32_bf16 v[56:59], v[216:219], v[24:27], v[56:59]
    ds_read_b128 v[24:27], v7 offset:2048
    v_add_f32 v94, v94, v34
    v_add_f32 v95, v95, v35
    v_mfma_f32_16x16x32_bf16 v[56:59], v[236:239], v[28:31], v[56:59]
    buffer_store_dwordx4 v[76:79], v44, s[8:11], s6 offen sc1
    s_waitcnt lgkmcnt(2)
    v_add_f32 v92, v92, v36
    v_add_f32 v93, v93, v37
    v_mfma_f32_16x16x32_bf16 v[60:63], v[240:243], v[28:31], v[60:63]
    v_add_f32 v94, v94, v38
    v_add_f32 v95, v95, v39
    v_mfma_f32_16x16x32_bf16 v[64:67], v[244:247], v[28:31], v[64:67]
    s_waitcnt lgkmcnt(1)
    v_add_f32 v92, v92, v40
    v_add_f32 v93, v93, v41
    v_mfma_f32_16x16x32_bf16 v[68:71], v[248:251], v[28:31], v[68:71]
    v_add_f32 v94, v94, v42
    v_add_f32 v95, v95, v43
    s_cmp_lg_u32 s71, 3
    v_mfma_f32_16x16x32_bf16 v[72:75], v[252:255], v[28:31], v[72:75]
    s_cbranch_scc1 L_nost_55
    buffer_store_dwordx4 v[92:95], v52, s[8:11], s6 offen sc1
L_nost_55:
    ds_read_b128 v[28:31], v7 offset:3072
    v_mfma_f32_16x16x32_bf16 v[76:79], v[96:99], v[16:19], 0
    s_sub_u32 s6, s71, 5
    s_and_b32 s6, s6, 3
    s_mul_i32 s7, s6, 5120
    v_mfma_f32_16x16x32_bf16 v[80:83], v[100:103], v[16:19], 0
    s_add_u32 s7, s7, s67
    s_cmp_eq_u32 s6, 3
    s_cselect_b32 s7, 155648, s7
    v_mfma_f32_16x16x32_bf16 v[84:87], v[104:107], v[16:19], 0
    v_add_u32 v12, s7, v52
    v_add_u32 v5, s67, v45
    v_mfma_f32_16x16x32_bf16 v[88:91], v[108:111], v[16:19], 0
    v_mfma_f32_16x16x32_bf16 v[92:95], v[112:115], v[16:19], 0
    ds_read_b128 v[16:19], v7 offset:4096
    v_mfma_f32_16x16x32_bf16 v[76:79], v[116:119], v[20:23], v[76:79]
    ds_write_b128 v5, v[60:63] offset:0
    v_add_u32 v5, s67, v46
    v_mfma_f32_16x16x32_bf16 v[80:83], v[120:123], v[20:23], v[80:83]
    v_mfma_f32_16x16x32_bf16 v[84:87], v[124:127], v[20:23], v[84:87]
    v_mfma_f32_16x16x32_bf16 v[88:91], v[128:131], v[20:23], v[88:91]
    s_waitcnt lgkmcnt(3)
    v_mfma_f32_16x16x32_bf16 v[92:95], v[132:135], v[20:23], v[92:95]
    ds_read_b128 v[20:23], v7 offset:5120
    v_mfma_f32_16x16x32_bf16 v[92:95], v[152:155], v[24:27], v[92:95]
    ds_write_b128 v5, v[64:67] offset:5120
    v_add_u32 v5, s67, v47
    v_mfma_f32_16x16x32_bf16 v[88:91], v[148:151], v[24:27], v[88:91]
    v_mfma_f32_16x16x32_bf16 v[84:87], v[144:147], v[24:27], v[84:87]
    v_mfma_f32_16x16x32_bf16 v[80:83], v[140:143], v[24:27], v[80:83]
    s_waitcnt lgkmcnt(4)
    v_mfma_f32_16x16x32_bf16 v[76:79], v[136:139], v[24:27], v[76:79]
    ds_read_b128 v[24:27], v7 offset:6144
    v_mfma_f32_16x16x32_bf16 v[76:79], v[156:159], v[28:31], v[76:79]
    ds_write_b128 v5, v[68:71] offset:10240
    v_add_u32 v5, s67, v52
    v_mfma_f32_16x16x32_bf16 v[80:83], v[160:163], v[28:31], v[80:83]
    v_mfma_f32_16x16x32_bf16 v[84:87], v[164:167], v[28:31], v[84:87]
    v_mfma_f32_16x16x32_bf16 v[88:91], v[168:171], v[28:31], v[88:91]
    s_waitcnt lgkmcnt(5)
    v_mfma_f32_16x16x32_bf16 v[92:95], v[172:175], v[28:31], v[92:95]
    ds_read_b128 v[28:31], v7 offset:7168
    v_mfma_f32_16x16x32_bf16 v[92:95], v[192:195], v[16:19], v[92:95]
    ds_write_b128 v12, v[72:75] offset:0
    v_mfma_f32_16x16x32_bf16 v[88:91], v[188:191], v[16:19], v[88:91]
    v_mfma_f32_16x16x32_bf16 v[84:87], v[184:187], v[16:19], v[84:87]
    v_mfma_f32_16x16x32_bf16 v[80:83], v[180:183], v[16:19], v[80:83]
    s_waitcnt lgkmcnt(5)
    v_mfma_f32_16x16x32_bf16 v[76:79], v[176:179], v[16:19], v[76:79]
    s_waitcnt vmcnt(5)
    s_waitcnt lgkmcnt(0)
    s_barrier
    ds_read_b128 v[32:35], v6 offset:0
    ds_read_b128 v[36:39], v6 offset:5120
    ds_read_b128 v[40:43], v6 offset:10240
    ds_read_b128 v[16:19], v4 offset:0
    v_mfma_f32_16x16x32_bf16 v[76:79], v[196:199], v[20:23], v[76:79]
    v_mfma_f32_16x16x32_bf16 v[80:83], v[200:203], v[20:23], v[80:83]
    v_mfma_f32_16x16x32_bf16 v[84:87], v[204:207], v[20:23], v[84:87]
    s_waitcnt lgkmcnt(3)
    v_add_f32 v56, v56, v32
    v_add_f32 v57, v57, v33
    v_mfma_f32_16x16x32_bf16 v[88:91], v[208:211], v[20:23], v[88:91]
    v_add_f32 v58, v58, v34
    v_add_f32 v59, v59, v35
    v_mfma_f32_16x16x32_bf16 v[92:95], v[212:215], v[20:23], v[92:95]
    s_waitcnt lgkmcnt(2)
    ds_read_b128 v[32:35], v5 offset:0
    ds_read_b128 v[20:23], v4 offset:1024
    v_add_f32 v56, v56, v36
    v_add_f32 v57, v57, v37
    v_mfma_f32_16x16x32_bf16 v[92:95], v[232:235], v[24:27], v[92:95]
    v_add_f32 v58, v58, v38
    v_add_f32 v59, v59, v39
    v_mfma_f32_16x16x32_bf16 v[88:91], v[228:231], v[24:27], v[88:91]
    s_waitcnt lgkmcnt(3)
    ds_read_b128 v[36:39], v5 offset:5120
    v_add_f32 v56, v56, v40
    v_add_f32 v57, v57, v41
    v_mfma_f32_16x16x32_bf16 v[84:87], v[224:227], v[24:27], v[84:87]
    v_add_f32 v58, v58, v42
    v_add_f32 v59, v59, v43
    v_mfma_f32_16x16x32_bf16 v[80:83], v[220:223], v[24:27], v[80:83]
    ds_read_b128 v[40:43], v5 offset:10240
    s_waitcnt lgkmcnt(3)
    v_add_f32 v72, v72, v32
    v_add_f32 v73, v73, v33
    s_add_u32 s6, s97, 10240
    v_mfma_f32_16x16x32_bf16 v[76:79], v[216:219], v[24:27], v[76:79]
    ds_read_b128 v[24:27], v4 offset:2048
    v_add_f32 v74, v74, v34
    v_add_f32 v75, v75, v35
    v_mfma_f32_16x16x32_bf16 v[76:79], v[236:239], v[28:31], v[76:79]
    buffer_store_dwordx4 v[56:59], v44, s[8:11], s6 offen sc1
    s_waitcnt lgkmcnt(2)
    v_add_f32 v72, v72, v36
    v_add_f32 v73, v73, v37
    v_mfma_f32_16x16x32_bf16 v[80:83], v[240:243], v[28:31], v[80:83]
    v_add_f32 v74, v74, v38
    v_add_f32 v75, v75, v39
    v_mfma_f32_16x16x32_bf16 v[84:87], v[244:247], v[28:31], v[84:87]
    s_waitcnt lgkmcnt(1)
    v_add_f32 v72, v72, v40
    v_add_f32 v73, v73, v41
    v_mfma_f32_16x16x32_bf16 v[88:91], v[248:251], v[28:31], v[88:91]
    v_add_f32 v74, v74, v42
    v_add_f32 v75, v75, v43
    s_cmp_lg_u32 s71, 0
    v_mfma_f32_16x16x32_bf16 v[92:95], v[252:255], v[28:31], v[92:95]
    s_cbranch_scc1 L_nost_59
    buffer_store_dwordx4 v[72:75], v52, s[8:11], s6 offen sc1
L_nost_59:
    ds_read_b128 v[28:31], v4 offset:3072
    v_mfma_f32_16x16x32_bf16 v[56:59], v[96:99], v[16:19], 0
    s_sub_u32 s6, s71, 6
    s_and_b32 s6, s6, 3
    s_mul_i32 s7, s6, 5120
    v_mfma_f32_16x16x32_bf16 v[60:63], v[100:103], v[16:19], 0
    s_add_u32 s7, s7, s67
    s_cmp_eq_u32 s6, 3
    s_cselect_b32 s7, 124928, s7
    v_mfma_f32_16x16x32_bf16 v[64:67], v[104:107], v[16:19], 0
    v_add_u32 v12, s7, v52
    v_add_u32 v5, s67, v45
    v_mfma_f32_16x16x32_bf16 v[68:71], v[108:111], v[16:19], 0
    v_mfma_f32_16x16x32_bf16 v[72:75], v[112:115], v[16:19], 0
    ds_read_b128 v[16:19], v4 offset:4096
    v_mfma_f32_16x16x32_bf16 v[56:59], v[116:119], v[20:23], v[56:59]
    ds_write_b128 v5, v[80:83] offset:30720
    v_add_u32 v5, s67, v46
    v_mfma_f32_16x16x32_bf16 v[60:63], v[120:123], v[20:23], v[60:63]
    v_mfma_f32_16x16x32_bf16 v[64:67], v[124:127], v[20:23], v[64:67]
    v_mfma_f32_16x16x32_bf16 v[68:71], v[128:131], v[20:23], v[68:71]
    s_waitcnt lgkmcnt(3)
    v_mfma_f32_16x16x32_bf16 v[72:75], v[132:135], v[20:23], v[72:75]
    ds_read_b128 v[20:23], v4 offset:5120
    v_mfma_f32_16x16x32_bf16 v[72:75], v[152:155], v[24:27], v[72:75]
    ds_write_b128 v5, v[84:87] offset:35840
    v_add_u32 v5, s67, v47
    v_mfma_f32_16x16x32_bf16 v[68:71], v[148:151], v[24:27], v[68:71]
    v_mfma_f32_16x16x32_bf16 v[64:67], v[144:147], v[24:27], v[64:67]
    v_mfma_f32_16x16x32_bf16 v[60:63], v[140:143], v[24:27], v[60:63]
    s_waitcnt lgkmcnt(4)
    v_mfma_f32_16x16x32_bf16 v[56:59], v[136:139], v[24:27], v[56:59]
    ds_read_b128 v[24:27], v4 offset:6144
    v_mfma_f32_16x16x32_bf16 v[56:59], v[156:159], v[28:31], v[56:59]
    ds_write_b128 v5, v[88:91] offset:40960
    v_add_u32 v5, s67, v52
    v_mfma_f32_16x16x32_bf16 v[60:63], v[160:163], v[28:31], v[60:63]
    v_mfma_f32_16x16x32_bf16 v[64:67], v[164:167], v[28:31], v[64:67]
    v_mfma_f32_16x16x32_bf16 v[68:71], v[168:171], v[28:31], v[68:71]
    s_waitcnt lgkmcnt(5)
    v_mfma_f32_16x16x32_bf16 v[72:75], v[172:175], v[28:31], v[72:75]
    ds_read_b128 v[28:31], v4 offset:7168
    v_mfma_f32_16x16x32_bf16 v[72:75], v[192:195], v[16:19], v[72:75]
    ds_write_b128 v12, v[92:95] offset:30720
    v_mfma_f32_16x16x32_bf16 v[68:71], v[188:191], v[16:19], v[68:71]
    v_mfma_f32_16x16x32_bf16 v[64:67], v[184:187], v[16:19], v[64:67]
    v_mov_b32 v2, 1
    v_writelane_b32 v2, 2, 0
    v_mfma_f32_16x16x32_bf16 v[60:63], v[180:183], v[16:19], v[60:63]
    s_waitcnt lgkmcnt(5)
    v_mfma_f32_16x16x32_bf16 v[56:59], v[176:179], v[16:19], v[56:59]
    s_waitcnt vmcnt(1)
    buffer_store_dword v2, v11, s[8:11], 0 offen sc1
    s_waitcnt lgkmcnt(0)
    s_barrier
    ds_read_b128 v[32:35], v6 offset:30720
    ds_read_b128 v[36:39], v6 offset:35840
    ds_read_b128 v[40:43], v6 offset:40960
    ds_read_b128 v[16:19], v4 offset:32768
    v_mfma_f32_16x16x32_bf16 v[56:59], v[196:199], v[20:23], v[56:59]
    v_mfma_f32_16x16x32_bf16 v[60:63], v[200:203], v[20:23], v[60:63]
    v_mfma_f32_16x16x32_bf16 v[64:67], v[204:207], v[20:23], v[64:67]
    s_waitcnt lgkmcnt(3)
    v_add_f32 v76, v76, v32
    v_add_f32 v77, v77, v33
    v_mfma_f32_16x16x32_bf16 v[68:71], v[208:211], v[20:23], v[68:71]
    v_add_f32 v78, v78, v34
    v_add_f32 v79, v79, v35
    v_mfma_f32_16x16x32_bf16 v[72:75], v[212:215], v[20:23], v[72:75]
    s_waitcnt lgkmcnt(2)
    ds_read_b128 v[32:35], v5 offset:30720
    ds_read_b128 v[20:23], v4 offset:33792
    v_add_f32 v76, v76, v36
    v_add_f32 v77, v77, v37
    v_mfma_f32_16x16x32_bf16 v[72:75], v[232:235], v[24:27], v[72:75]
    v_add_f32 v78, v78, v38
    v_add_f32 v79, v79, v39
    v_mfma_f32_16x16x32_bf16 v[68:71], v[228:231], v[24:27], v[68:71]
    s_waitcnt lgkmcnt(3)
    ds_read_b128 v[36:39], v5 offset:35840
    v_add_f32 v76, v76, v40
    v_add_f32 v77, v77, v41
    v_mfma_f32_16x16x32_bf16 v[64:67], v[224:227], v[24:27], v[64:67]
    v_add_f32 v78, v78, v42
    v_add_f32 v79, v79, v43
    v_mfma_f32_16x16x32_bf16 v[60:63], v[220:223], v[24:27], v[60:63]
    ds_read_b128 v[40:43], v5 offset:40960
    s_waitcnt lgkmcnt(3)
    v_add_f32 v92, v92, v32
    v_add_f32 v93, v93, v33
    s_add_u32 s6, s98, 10240
    v_mfma_f32_16x16x32_bf16 v[56:59], v[216:219], v[24:27], v[56:59]
    ds_read_b128 v[24:27], v4 offset:34816
    v_add_f32 v94, v94, v34
    v_add_f32 v95, v95, v35
    v_mfma_f32_16x16x32_bf16 v[56:59], v[236:239], v[28:31], v[56:59]
    buffer_store_dwordx4 v[76:79], v44, s[8:11], s6 offen sc1
    s_waitcnt lgkmcnt(2)
    v_add_f32 v92, v92, v36
    v_add_f32 v93, v93, v37
    v_mfma_f32_16x16x32_bf16 v[60:63], v[240:243], v[28:31], v[60:63]
    v_add_f32 v94, v94, v38
    v_add_f32 v95, v95, v39
    v_mfma_f32_16x16x32_bf16 v[64:67], v[244:247], v[28:31], v[64:67]
    s_waitcnt lgkmcnt(1)
    v_add_f32 v92, v92, v40
    v_add_f32 v93, v93, v41
    v_mfma_f32_16x16x32_bf16 v[68:71], v[248:251], v[28:31], v[68:71]
    v_add_f32 v94, v94, v42
    v_add_f32 v95, v95, v43
    s_cmp_lg_u32 s71, 1
    v_mfma_f32_16x16x32_bf16 v[72:75], v[252:255], v[28:31], v[72:75]
    s_cbranch_scc1 L_nost_60
    buffer_store_dwordx4 v[92:95], v52, s[8:11], s6 offen sc1
L_nost_60:
    ds_read_b128 v[28:31], v4 offset:35840
    v_mfma_f32_16x16x32_bf16 v[76:79], v[96:99], v[16:19], 0
    v_mfma_f32_16x16x32_bf16 v[80:83], v[100:103], v[16:19], 0
    v_mfma_f32_16x16x32_bf16 v[84:87], v[104:107], v[16:19], 0
    s_mul_i32 s73, s3, 5120
    s_add_u32 s6, s73, 65536
    v_mfma_f32_16x16x32_bf16 v[88:91], v[108:111], v[16:19], 0
    v_add_u32 v5, s6, v44
    v_mfma_f32_16x16x32_bf16 v[92:95], v[112:115], v[16:19], 0
    ds_read_b128 v[16:19], v4 offset:36864
    v_mfma_f32_16x16x32_bf16 v[76:79], v[116:119], v[20:23], v[76:79]
    ds_write_b128 v5, v[56:59]
    s_add_u32 s6, s73, 65536
    v_add_u32 v5, s6, v45
    v_mfma_f32_16x16x32_bf16 v[80:83], v[120:123], v[20:23], v[80:83]
    v_mfma_f32_16x16x32_bf16 v[84:87], v[124:127], v[20:23], v[84:87]
    v_mfma_f32_16x16x32_bf16 v[88:91], v[128:131], v[20:23], v[88:91]
    s_waitcnt lgkmcnt(3)
    v_mfma_f32_16x16x32_bf16 v[92:95], v[132:135], v[20:23], v[92:95]
    ds_read_b128 v[20:23], v4 offset:37888
    v_mfma_f32_16x16x32_bf16 v[92:95], v[152:155], v[24:27], v[92:95]
    ds_write_b128 v5, v[60:63]
    s_add_u32 s6, s73, 65536
    v_add_u32 v5, s6, v46
    v_mfma_f32_16x16x32_bf16 v[88:91], v[148:151], v[24:27], v[88:91]
    v_mfma_f32_16x16x32_bf16 v[84:87], v[144:147], v[24:27], v[84:87]
    v_mov_b32 v2, 2
    s_waitcnt vmcnt(0)
    buffer_store_dword v2, v11, s[8:11], 0 offen sc1
    v_mfma_f32_16x16x32_bf16 v[80:83], v[140:143], v[24:27], v[80:83]
    s_waitcnt lgkmcnt(4)
    v_mfma_f32_16x16x32_bf16 v[76:79], v[136:139], v[24:27], v[76:79]
    ds_read_b128 v[24:27], v4 offset:38912
    s_cmp_eq_u32 s64, 0
    s_cbranch_scc1 L_nb
    v_bfe_u32 v2, v1, 1, 3
    v_and_b32 v3, 1, v1
    v_lshl_add_u32 v3, v2, 7, v3
    v_lshlrev_b32 v3, 2, v3
    s_and_b32 s6, s4, 3
    s_lshl_b32 s6, s6, 7
    s_add_u32 s6, s6, 3911680
    s_mov_b32 s79, 262144
L_poll_61:
    buffer_load_dword v2, v3, s[8:11], s6 offen sc1
    s_waitcnt vmcnt(0)
    v_cmp_ne_u32 vcc, 1, v2
    s_cbranch_vccz L_polldone_62
    s_sleep 2
    s_sub_u32 s79, s79, 1
    s_cmp_lg_u32 s79, 0
    s_cbranch_scc1 L_poll_61
L_polldone_62:
L_nb:
    buffer_load_dwordx4 v[96:99], v53, s[12:15], s70 offen
    buffer_load_dwordx4 v[100:103], v48, s[8:11], 0 offen sc1
    s_cmp_ge_u32 s3, 2
    s_cbranch_scc1 L_itskip_63
    buffer_load_dwordx4 v[104:107], v54, s[12:15], s70 offen
    buffer_load_dwordx4 v[108:111], v49, s[8:11], 0 offen sc1
L_itskip_63:
    v_mfma_f32_16x16x32_bf16 v[76:79], v[156:159], v[28:31], v[76:79]
    ds_write_b128 v5, v[64:67]
    s_add_u32 s6, s73, 65536
    v_add_u32 v5, s6, v47
    v_mfma_f32_16x16x32_bf16 v[80:83], v[160:163], v[28:31], v[80:83]
    v_mfma_f32_16x16x32_bf16 v[84:87], v[164:167], v[28:31], v[84:87]
    v_mfma_f32_16x16x32_bf16 v[88:91], v[168:171], v[28:31], v[88:91]
    s_waitcnt lgkmcnt(5)
    v_mfma_f32_16x16x32_bf16 v[92:95], v[172:175], v[28:31], v[92:95]
    ds_read_b128 v[28:31], v4 offset:39936
    v_mfma_f32_16x16x32_bf16 v[92:95], v[192:195], v[16:19], v[92:95]
    ds_write_b128 v5, v[68:71]
    s_add_u32 s6, s73, 65536
    v_add_u32 v5, s6, v52
    v_mfma_f32_16x16x32_bf16 v[88:91], v[188:191], v[16:19], v[88:91]
    v_bfe_u32 v2, v1, 3, 2
    v_min_u32 v2, 2, v2
    v_and_b32 v3, 7, v1
    v_lshlrev_b32 v3, 2, v3
    v_lshl_add_u32 v3, v2, 7, v3
    v_mfma_f32_16x16x32_bf16 v[84:87], v[184:187], v[16:19], v[84:87]
    s_bitcmp1_b32 13, s3
    s_cselect_b32 s77, 1, 2
    buffer_load_dword v50, v3, s[8:11], s63 offen sc1
    v_mfma_f32_16x16x32_bf16 v[80:83], v[180:183], v[16:19], v[80:83]
    s_waitcnt lgkmcnt(5)
    v_mfma_f32_16x16x32_bf16 v[76:79], v[176:179], v[16:19], v[76:79]
    v_mfma_f32_16x16x32_bf16 v[76:79], v[196:199], v[20:23], v[76:79]
    ds_write_b128 v5, v[72:75]
    v_mfma_f32_16x16x32_bf16 v[80:83], v[200:203], v[20:23], v[80:83]
    v_mfma_f32_16x16x32_bf16 v[84:87], v[204:207], v[20:23], v[84:87]
    v_mfma_f32_16x16x32_bf16 v[88:91], v[208:211], v[20:23], v[88:91]
    s_waitcnt lgkmcnt(4)
    v_mfma_f32_16x16x32_bf16 v[92:95], v[212:215], v[20:23], v[92:95]
    v_mfma_f32_16x16x32_bf16 v[92:95], v[232:235], v[24:27], v[92:95]
    v_mfma_f32_16x16x32_bf16 v[88:91], v[228:231], v[24:27], v[88:91]
    v_mfma_f32_16x16x32_bf16 v[84:87], v[224:227], v[24:27], v[84:87]
    v_mfma_f32_16x16x32_bf16 v[80:83], v[220:223], v[24:27], v[80:83]
    s_waitcnt lgkmcnt(2)
    s_add_u32 s6, s73, 86016
    s_cmp_lt_u32 s3, 4
    s_cselect_b32 s73, s73, s6
    v_mfma_f32_16x16x32_bf16 v[76:79], v[216:219], v[24:27], v[76:79]
    s_waitcnt vmcnt(0)
    v_cmp_gt_u32 vcc, s77, v50
    s_mov_b32 s91, 0
    s_cbranch_vccnz L_x1n
    s_add_u32 s6, s62, 0
    buffer_load_dwordx4 v[112:115], v8, s[8:11], s6 offen offset:0 sc1
    buffer_load_dwordx4 v[116:119], v8, s[8:11], s6 offen offset:256 sc1
    s_add_u32 s6, s62, 20480
    buffer_load_dwordx4 v[120:123], v8, s[8:11], s6 offen offset:0 sc1
    buffer_load_dwordx4 v[124:127], v8, s[8:11], s6 offen offset:256 sc1
    s_add_u32 s6, s62, 40960
    buffer_load_dwordx4 v[128:131], v8, s[8:11], s6 offen offset:0 sc1
    buffer_load_dwordx4 v[132:135], v8, s[8:11], s6 offen offset:256 sc1
    s_cmp_ge_u32 s3, 2
    s_cbranch_scc1 L_xi_64
    s_add_u32 s6, s62, 0
    buffer_load_dwordx4 v[136:139], v9, s[8:11], s6 offen offset:0 sc1
    buffer_load_dwordx4 v[140:143], v9, s[8:11], s6 offen offset:256 sc1
    s_add_u32 s6, s62, 20480
    buffer_load_dwordx4 v[144:147], v9, s[8:11], s6 offen offset:0 sc1
    buffer_load_dwordx4 v[148:151], v9, s[8:11], s6 offen offset:256 sc1
    s_add_u32 s6, s62, 40960
    buffer_load_dwordx4 v[152:155], v9, s[8:11], s6 offen offset:0 sc1
    buffer_load_dwordx4 v[156:159], v9, s[8:11], s6 offen offset:256 sc1
L_xi_64:
    s_mov_b32 s91, 1
    s_branch L_x1j
L_x1n:
    buffer_load_dword v50, v3, s[8:11], s63 offen sc1
L_x1j:
    v_mfma_f32_16x16x32_bf16 v[76:79], v[236:239], v[28:31], v[76:79]
    v_mfma_f32_16x16x32_bf16 v[80:83], v[240:243], v[28:31], v[80:83]
    v_mfma_f32_16x16x32_bf16 v[84:87], v[244:247], v[28:31], v[84:87]
    v_mfma_f32_16x16x32_bf16 v[88:91], v[248:251], v[28:31], v[88:91]
    v_mfma_f32_16x16x32_bf16 v[92:95], v[252:255], v[28:31], v[92:95]
    s_nop 4
    v_add_u32 v5, s73, v44
    ds_write_b128 v5, v[76:79]
    v_add_u32 v5, s73, v45
    ds_write_b128 v5, v[80:83]
    v_add_u32 v5, s73, v46
    ds_write_b128 v5, v[84:87]
    v_add_u32 v5, s73, v47
    ds_write_b128 v5, v[88:91]
    v_add_u32 v5, s73, v52
    ds_write_b128 v5, v[92:95]
    s_mov_b64 s[78:79], 0
    s_cmp_lg_u32 s91, 0
    s_cbranch_scc1 L_x2a
    s_waitcnt vmcnt(0)
    v_cmp_gt_u32 s[78:79], s77, v50
    s_nop 3
    s_cmp_lg_u64 s[78:79], 0
    s_cbranch_scc1 L_x2a
    s_add_u32 s6, s62, 0
    buffer_load_dwordx4 v[112:115], v8, s[8:11], s6 offen offset:0 sc1
    buffer_load_dwordx4 v[116:119], v8, s[8:11], s6 offen offset:256 sc1
    s_add_u32 s6, s62, 20480
    buffer_load_dwordx4 v[120:123], v8, s[8:11], s6 offen offset:0 sc1
    buffer_load_dwordx4 v[124:127], v8, s[8:11], s6 offen offset:256 sc1
    s_add_u32 s6, s62, 40960
    buffer_load_dwordx4 v[128:131], v8, s[8:11], s6 offen offset:0 sc1
    buffer_load_dwordx4 v[132:135], v8, s[8:11], s6 offen offset:256 sc1
    s_cmp_ge_u32 s3, 2
    s_cbranch_scc1 L_xi_65
    s_add_u32 s6, s62, 0
    buffer_load_dwordx4 v[136:139], v9, s[8:11], s6 offen offset:0 sc1
    buffer_load_dwordx4 v[140:143], v9, s[8:11], s6 offen offset:256 sc1
    s_add_u32 s6, s62, 20480
    buffer_load_dwordx4 v[144:147], v9, s[8:11], s6 offen offset:0 sc1
    buffer_load_dwordx4 v[148:151], v9, s[8:11], s6 offen offset:256 sc1
    s_add_u32 s6, s62, 40960
    buffer_load_dwordx4 v[152:155], v9, s[8:11], s6 offen offset:0 sc1
    buffer_load_dwordx4 v[156:159], v9, s[8:11], s6 offen offset:256 sc1
L_xi_65:
L_x2a:
    s_waitcnt lgkmcnt(0)
    s_barrier
    ds_read_b128 v[160:163], v10 offset:0
    ds_read_b128 v[164:167], v10 offset:256
    ds_read_b128 v[168:171], v10 offset:5120
    ds_read_b128 v[172:175], v10 offset:5376
    ds_read_b128 v[176:179], v10 offset:10240
    ds_read_b128 v[180:183], v10 offset:10496
    ds_read_b128 v[184:187], v10 offset:15360
    ds_read_b128 v[188:191], v10 offset:15616
    ds_read_b128 v[192:195], v55 offset:0
    ds_read_b128 v[196:199], v55 offset:256
    ds_read_b128 v[200:203], v55 offset:5120
    ds_read_b128 v[204:207], v55 offset:5376
    ds_read_b128 v[208:211], v55 offset:10240
    ds_read_b128 v[212:215], v55 offset:10496
    ds_read_b128 v[216:219], v55 offset:15360
    ds_read_b128 v[220:223], v55 offset:15616
    s_cmp_eq_u64 s[78:79], 0
    s_cbranch_scc1 L_x2b
    s_mov_b32 s79, 262144
L_poll_66:
    buffer_load_dword v2, v3, s[8:11], s63 offen sc1
    s_waitcnt vmcnt(0)
    v_cmp_gt_u32 vcc, s77, v2
    s_cbranch_vccz L_polldone_67
    s_sleep 1
    s_sub_u32 s79, s79, 1
    s_cmp_lg_u32 s79, 0
    s_cbranch_scc1 L_poll_66
L_polldone_67:
    s_add_u32 s6, s62, 0
    buffer_load_dwordx4 v[112:115], v8, s[8:11], s6 offen offset:0 sc1
    buffer_load_dwordx4 v[116:119], v8, s[8:11], s6 offen offset:256 sc1
    s_add_u32 s6, s62, 20480
    buffer_load_dwordx4 v[120:123], v8, s[8:11], s6 offen offset:0 sc1
    buffer_load_dwordx4 v[124:127], v8, s[8:11], s6 offen offset:256 sc1
    s_add_u32 s6, s62, 40960
    buffer_load_dwordx4 v[128:131], v8, s[8:11], s6 offen offset:0 sc1
    buffer_load_dwordx4 v[132:135], v8, s[8:11], s6 offen offset:256 sc1
    s_cmp_ge_u32 s3, 2
    s_cbranch_scc1 L_xi_68
    s_add_u32 s6, s62, 0
    buffer_load_dwordx4 v[136:139], v9, s[8:11], s6 offen offset:0 sc1
    buffer_load_dwordx4 v[140:143], v9, s[8:11], s6 offen offset:256 sc1
    s_add_u32 s6, s62, 20480
    buffer_load_dwordx4 v[144:147], v9, s[8:11], s6 offen offset:0 sc1
    buffer_load_dwordx4 v[148:151], v9, s[8:11], s6 offen offset:256 sc1
    s_add_u32 s6, s62, 40960
    buffer_load_dwordx4 v[152:155], v9, s[8:11], s6 offen offset:0 sc1
    buffer_load_dwordx4 v[156:159], v9, s[8:11], s6 offen offset:256 sc1
L_xi_68:
L_x2b:
    s_mov_b32 s16, s54
    s_mov_b32 s17, s55
    s_mov_b32 s18, 0x280000
    s_mov_b32 s19, 0x20000
    s_waitcnt lgkmcnt(8)
    v_pk_add_f32 v[160:161], v[160:161], v[168:169]
    v_pk_add_f32 v[162:163], v[162:163], v[170:171]
    v_pk_add_f32 v[164:165], v[164:165], v[172:173]
    v_pk_add_f32 v[166:167], v[166:167], v[174:175]
    v_pk_add_f32 v[160:161], v[160:161], v[176:177]
    v_pk_add_f32 v[162:163], v[162:163], v[178:179]
    v_pk_add_f32 v[164:165], v[164:165], v[180:181]
    v_pk_add_f32 v[166:167], v[166:167], v[182:183]
    v_pk_add_f32 v[160:161], v[160:161], v[184:185]
    v_pk_add_f32 v[162:163], v[162:163], v[186:187]
    v_pk_add_f32 v[164:165], v[164:165], v[188:189]
    v_pk_add_f32 v[166:167], v[166:167], v[190:191]
    s_waitcnt vmcnt(0)
    v_pk_add_f32 v[160:161], v[160:161], v[112:113]
    v_pk_add_f32 v[162:163], v[162:163], v[114:115]
    v_pk_add_f32 v[164:165], v[164:165], v[116:117]
    v_pk_add_f32 v[166:167], v[166:167], v[118:119]
    v_pk_add_f32 v[160:161], v[160:161], v[120:121]
    v_pk_add_f32 v[162:163], v[162:163], v[122:123]
    v_pk_add_f32 v[164:165], v[164:165], v[124:125]
    v_pk_add_f32 v[166:167], v[166:167], v[126:127]
    v_pk_add_f32 v[160:161], v[160:161], v[128:129]
    v_pk_add_f32 v[162:163], v[162:163], v[130:131]
    v_pk_add_f32 v[164:165], v[164:165], v[132:133]
    v_pk_add_f32 v[166:167], v[166:167], v[134:135]
    v_cvt_pk_bf16_f32 v2, v160, v161
    v_lshlrev_b32 v160, 16, v2
    v_and_b32 v161, 0xffff0000, v2
    v_lshlrev_b32 v2, 16, v96
    v_and_b32 v3, 0xffff0000, v96
    v_pk_add_f32 v[160:161], v[160:161], v[2:3]
    v_cvt_pk_bf16_f32 v2, v160, v161
    v_lshlrev_b32 v160, 16, v2
    v_and_b32 v161, 0xffff0000, v2
    v_lshlrev_b32 v2, 16, v100
    v_and_b32 v3, 0xffff0000, v100
    v_pk_add_f32 v[160:161], v[160:161], v[2:3]
    v_cvt_pk_bf16_f32 v224, v160, v161
    v_cvt_pk_bf16_f32 v2, v162, v163
    v_lshlrev_b32 v162, 16, v2
    v_and_b32 v163, 0xffff0000, v2
    v_lshlrev_b32 v2, 16, v97
    v_and_b32 v3, 0xffff0000, v97
    v_pk_add_f32 v[162:163], v[162:163], v[2:3]
    v_cvt_pk_bf16_f32 v2, v162, v163
    v_lshlrev_b32 v162, 16, v2
    v_and_b32 v163, 0xffff0000, v2
    v_lshlrev_b32 v2, 16, v101
    v_and_b32 v3, 0xffff0000, v101
    v_pk_add_f32 v[162:163], v[162:163], v[2:3]
    v_cvt_pk_bf16_f32 v225, v162, v163
    v_cvt_pk_bf16_f32 v2, v164, v165
    v_lshlrev_b32 v164, 16, v2
    v_and_b32 v165, 0xffff0000, v2
    v_lshlrev_b32 v2, 16, v98
    v_and_b32 v3, 0xffff0000, v98
    v_pk_add_f32 v[164:165], v[164:165], v[2:3]
    v_cvt_pk_bf16_f32 v2, v164, v165
    v_lshlrev_b32 v164, 16, v2
    v_and_b32 v165, 0xffff0000, v2
    v_lshlrev_b32 v2, 16, v102
    v_and_b32 v3, 0xffff0000, v102
    v_pk_add_f32 v[164:165], v[164:165], v[2:3]
    v_cvt_pk_bf16_f32 v226, v164, v165
    v_cvt_pk_bf16_f32 v2, v166, v167
    v_lshlrev_b32 v166, 16, v2
    v_and_b32 v167, 0xffff0000, v2
    v_lshlrev_b32 v2, 16, v99
    v_and_b32 v3, 0xffff0000, v99
    v_pk_add_f32 v[166:167], v[166:167], v[2:3]
    v_cvt_pk_bf16_f32 v2, v166, v167
    v_lshlrev_b32 v166, 16, v2
    v_and_b32 v167, 0xffff0000, v2
    v_lshlrev_b32 v2, 16, v103
    v_and_b32 v3, 0xffff0000, v103
    v_pk_add_f32 v[166:167], v[166:167], v[2:3]
    v_cvt_pk_bf16_f32 v227, v166, v167
    buffer_store_dwordx4 v[224:227], v53, s[16:19], s70 offen
    s_cmp_ge_u32 s3, 2
    s_cbranch_scc1 L_end
    s_waitcnt lgkmcnt(0)
    v_pk_add_f32 v[192:193], v[192:193], v[200:201]
    v_pk_add_f32 v[194:195], v[194:195], v[202:203]
    v_pk_add_f32 v[196:197], v[196:197], v[204:205]
    v_pk_add_f32 v[198:199], v[198:199], v[206:207]
    v_pk_add_f32 v[192:193], v[192:193], v[208:209]
    v_pk_add_f32 v[194:195], v[194:195], v[210:211]
    v_pk_add_f32 v[196:197], v[196:197], v[212:213]
    v_pk_add_f32 v[198:199], v[198:199], v[214:215]
    v_pk_add_f32 v[192:193], v[192:193], v[216:217]
    v_pk_add_f32 v[194:195], v[194:195], v[218:219]
    v_pk_add_f32 v[196:197], v[196:197], v[220:221]
    v_pk_add_f32 v[198:199], v[198:199], v[222:223]
    s_nop 0
    v_pk_add_f32 v[192:193], v[192:193], v[136:137]
    v_pk_add_f32 v[194:195], v[194:195], v[138:139]
    v_pk_add_f32 v[196:197], v[196:197], v[140:141]
    v_pk_add_f32 v[198:199], v[198:199], v[142:143]
    v_pk_add_f32 v[192:193], v[192:193], v[144:145]
    v_pk_add_f32 v[194:195], v[194:195], v[146:147]
    v_pk_add_f32 v[196:197], v[196:197], v[148:149]
    v_pk_add_f32 v[198:199], v[198:199], v[150:151]
    v_pk_add_f32 v[192:193], v[192:193], v[152:153]
    v_pk_add_f32 v[194:195], v[194:195], v[154:155]
    v_pk_add_f32 v[196:197], v[196:197], v[156:157]
    v_pk_add_f32 v[198:199], v[198:199], v[158:159]
    v_cvt_pk_bf16_f32 v2, v192, v193
    v_lshlrev_b32 v192, 16, v2
    v_and_b32 v193, 0xffff0000, v2
    v_lshlrev_b32 v2, 16, v104
    v_and_b32 v3, 0xffff0000, v104
    v_pk_add_f32 v[192:193], v[192:193], v[2:3]
    v_cvt_pk_bf16_f32 v2, v192, v193
    v_lshlrev_b32 v192, 16, v2
    v_and_b32 v193, 0xffff0000, v2
    v_lshlrev_b32 v2, 16, v108
    v_and_b32 v3, 0xffff0000, v108
    v_pk_add_f32 v[192:193], v[192:193], v[2:3]
    v_cvt_pk_bf16_f32 v228, v192, v193
    v_cvt_pk_bf16_f32 v2, v194, v195
    v_lshlrev_b32 v194, 16, v2
    v_and_b32 v195, 0xffff0000, v2
    v_lshlrev_b32 v2, 16, v105
    v_and_b32 v3, 0xffff0000, v105
    v_pk_add_f32 v[194:195], v[194:195], v[2:3]
    v_cvt_pk_bf16_f32 v2, v194, v195
    v_lshlrev_b32 v194, 16, v2
    v_and_b32 v195, 0xffff0000, v2
    v_lshlrev_b32 v2, 16, v109
    v_and_b32 v3, 0xffff0000, v109
    v_pk_add_f32 v[194:195], v[194:195], v[2:3]
    v_cvt_pk_bf16_f32 v229, v194, v195
    v_cvt_pk_bf16_f32 v2, v196, v197
    v_lshlrev_b32 v196, 16, v2
    v_and_b32 v197, 0xffff0000, v2
    v_lshlrev_b32 v2, 16, v106
    v_and_b32 v3, 0xffff0000, v106
    v_pk_add_f32 v[196:197], v[196:197], v[2:3]
    v_cvt_pk_bf16_f32 v2, v196, v197
    v_lshlrev_b32 v196, 16, v2
    v_and_b32 v197, 0xffff0000, v2
    v_lshlrev_b32 v2, 16, v110
    v_and_b32 v3, 0xffff0000, v110
    v_pk_add_f32 v[196:197], v[196:197], v[2:3]
    v_cvt_pk_bf16_f32 v230, v196, v197
    v_cvt_pk_bf16_f32 v2, v198, v199
    v_lshlrev_b32 v198, 16, v2
    v_and_b32 v199, 0xffff0000, v2
    v_lshlrev_b32 v2, 16, v107
    v_and_b32 v3, 0xffff0000, v107
    v_pk_add_f32 v[198:199], v[198:199], v[2:3]
    v_cvt_pk_bf16_f32 v2, v198, v199
    v_lshlrev_b32 v198, 16, v2
    v_and_b32 v199, 0xffff0000, v2
    v_lshlrev_b32 v2, 16, v111
    v_and_b32 v3, 0xffff0000, v111
    v_pk_add_f32 v[198:199], v[198:199], v[2:3]
    v_cvt_pk_bf16_f32 v231, v198, v199
    buffer_store_dwordx4 v[228:231], v54, s[16:19], s70 offen
L_end:
L_exit:
    s_endpgm
.section .rodata,"a"
.p2align 6
.amdhsa_kernel parallel_sum__compressed_kv_cla__moe_arch_mod__prompt_kernel
  .amdhsa_next_free_vgpr 256
  .amdhsa_next_free_sgpr 102
  .amdhsa_accum_offset 256
  .amdhsa_group_segment_fixed_size 0
  .amdhsa_kernarg_size 112
  .amdhsa_user_sgpr_count 2
  .amdhsa_user_sgpr_kernarg_segment_ptr 1
  .amdhsa_system_sgpr_workgroup_id_x 1
  .amdhsa_float_denorm_mode_32 3
.end_amdhsa_kernel
```

```asm
; @launch grid=(256,1,1) block=(512,1,1) lds=163840
.amdgcn_target "amdgcn-amd-amdhsa--gfx950"
.text
.globl parallel_sum__compressed_kv_cla__moe_arch_mod__prompt_kernel
.p2align 8
.type parallel_sum__compressed_kv_cla__moe_arch_mod__prompt_kernel,@function
parallel_sum__compressed_kv_cla__moe_arch_mod__prompt_kernel:
    s_cmp_ge_u32 s2, 256
    s_cbranch_scc1 L_exit
    s_load_dwordx16 s[32:47], s[0:1], 0
    s_load_dwordx8 s[48:55], s[0:1], 64
    s_load_dwordx4 s[56:59], s[0:1], 96
    v_lshrrev_b32 v2, 6, v0
    v_and_b32 v1, 63, v0
    v_readfirstlane_b32 s3, v2
    s_getpc_b64 s[80:81]
L_pc:
    s_lshr_b32 s6, s2, 3
    s_and_b32 s6, s6, 15
    s_lshl_b32 s6, s6, 12
    s_cmp_lt_u32 s3, 2
    s_cselect_b32 s6, 0, s6
    v_lshl_add_u32 v3, v0, 6, s6
    v_min_u32 v3, L_exit-L_pc, v3
    s_cmp_ge_u32 s3, 3
    s_cbranch_scc1 L_noct
    global_load_dword v11, v3, s[80:81]
L_noct:
    v_lshrrev_b32 v62, 5, v0
    v_and_b32 v62, 7, v62
    v_and_b32 v2, 31, v0
    v_lshlrev_b32 v2, 3, v2
    v_mul_u32_u24 v63, 1280, v62
    v_add_u32 v63, v63, v2
    s_mul_i32 s6, s2, 10240
    v_add_u32 v10, s6, v63
    s_cmp_lt_u32 s3, 4
    s_cbranch_scc1 L_st_k0
    s_waitcnt lgkmcnt(0)
    global_load_dwordx2 v[16:17], v10, s[32:33] offset:0
    global_load_dwordx2 v[18:19], v10, s[32:33] offset:256
    global_load_dwordx2 v[20:21], v10, s[32:33] offset:512
    global_load_dwordx2 v[22:23], v10, s[32:33] offset:768
    global_load_dwordx2 v[24:25], v10, s[32:33] offset:1024
    global_load_dwordx2 v[26:27], v2, s[46:47] offset:0
    global_load_dwordx2 v[28:29], v2, s[46:47] offset:256
    global_load_dwordx2 v[30:31], v2, s[46:47] offset:512
    global_load_dwordx2 v[32:33], v2, s[46:47] offset:768
    global_load_dwordx2 v[34:35], v2, s[46:47] offset:1024
    s_bfe_u32 s6, s2, 0x20003
    s_lshl_b32 s6, s6, 9
    s_bfe_u32 s7, s3, 0x10001
    s_lshl_b32 s7, s7, 8
    s_add_u32 s6, s6, s7
    s_andn2_b32 s7, s2, 31
    s_add_u32 s6, s6, s7
    s_and_b32 s72, s3, 1
    s_lshl_b32 s7, s72, 4
    s_add_u32 s6, s6, s7
    v_lshrrev_b32 v4, 3, v1
    v_add_u32 v4, s6, v4
    v_and_b32 v5, 7, v1
    v_lshlrev_b32 v5, 4, v5
    v_lshl_add_u32 v4, v4, 10, v5
    v_add_u32 v5, 8192, v4
    s_lshr_b32 s6, s2, 5
    s_lshl_b32 s6, s6, 1
    s_add_u32 s6, s6, s72
    s_lshl_b32 s6, s6, 15
    s_and_b32 s7, s2, 7
    s_lshl_b32 s7, s7, 10
    s_add_u32 s6, s6, s7
    s_bfe_u32 s7, s2, 0x20003
    s_lshl_b32 s7, s7, 8
    s_add_u32 s6, s6, s7
    v_lshrrev_b32 v6, 4, v1
    v_and_b32 v7, 15, v1
    v_lshlrev_b32 v7, 4, v7
    v_lshl_add_u32 v6, v6, 13, v7
    v_add_u32 v6, s6, v6
    s_cmp_ge_u32 s3, 6
    s_cselect_b32 s74, s40, s38
    s_cselect_b32 s75, s41, s39
    global_load_dwordx4 v[36:39], v4, s[34:35] offset:0
    global_load_dwordx4 v[36:39], v5, s[34:35] offset:0
    global_load_dwordx4 v[36:39], v6, s[74:75] nt
    v_add_u32 v6, 524288, v6
    global_load_dwordx4 v[36:39], v4, s[34:35] offset:128
    global_load_dwordx4 v[36:39], v5, s[34:35] offset:128
    global_load_dwordx4 v[36:39], v6, s[74:75] nt
    v_add_u32 v6, 524288, v6
    s_barrier
L_st_k0:
    s_and_b32 s6, s2, 7
    s_lshl_b32 s6, s6, 2
    s_lshr_b32 s7, s2, 3
    s_and_b32 s7, s7, 3
    s_add_u32 s4, s6, s7
    s_lshr_b32 s5, s2, 5
    s_and_b32 s76, s3, 3
    v_lshrrev_b32 v2, 3, v1
    v_and_b32 v3, 7, v1
    v_lshrrev_b32 v4, 4, v1
    v_xor_b32 v5, v3, v4
    v_lshlrev_b32 v5, 4, v5
    v_lshl_add_u32 v40, v2, 10, v5
    v_xor_b32 v5, 64, v40
    v_add_u32 v41, 7168, v5
    v_add_u32 v42, 14336, v40
    v_add_u32 v43, 14336, v41
    v_and_b32 v6, 15, v1
    s_lshl_b32 s6, s76, 4
    v_add_u32 v7, s6, v4
    v_lshlrev_b32 v5, 1, v4
    v_xor_b32 v5, v6, v5
    v_lshlrev_b32 v5, 4, v5
    v_lshl_add_u32 v44, v7, 13, v5
    v_add_u32 v45, 31744, v44
    v_xor_b32 v5, 0x80, v44
    v_add_u32 v46, 63488, v5
    v_add_u32 v47, 31744, v46
    s_and_b32 s6, s76, 1
    s_lshl_b32 s6, s6, 20
    s_lshr_b32 s7, s76, 1
    s_lshl_b32 s7, s7, 18
    s_add_u32 s6, s6, s7
    s_lshl_b32 s62, s5, 15
    s_add_u32 s62, s62, s6
    s_lshl_b32 s63, s4, 8
    s_lshl_b32 s64, s76, 13
    s_lshl_b32 s73, s76, 12
    s_add_u32 s73, s73, 32768
    s_andn2_b32 s100, 1, s5
    s_lshl_b32 s100, s100, 16
    s_add_u32 s64, s64, s100
    s_add_u32 s73, s73, s100
    s_waitcnt lgkmcnt(0)
    s_mov_b32 s12, s34
    s_mov_b32 s13, s35
    s_mov_b32 s14, 0x200000
    s_mov_b32 s15, 0x20000
    s_mov_b32 s16, s38
    s_mov_b32 s17, s39
    s_mov_b32 s18, 0x400000
    s_mov_b32 s19, 0x20000
    s_mov_b32 s20, s40
    s_mov_b32 s21, s41
    s_mov_b32 s22, 0x400000
    s_mov_b32 s23, 0x20000
    s_cmp_ge_u32 s3, 4
    s_cbranch_scc1 L_st_v0
    s_barrier
    s_mov_b32 m0, s64
    s_add_u32 s72, s62, 524288
    buffer_load_dwordx4 v40, s[12:15], s62 offen offset:0 lds
    buffer_load_dwordx4 v41, s[12:15], s62 offen offset:1024 lds
    buffer_load_dwordx4 v42, s[12:15], s62 offen offset:2048 lds
    buffer_load_dwordx4 v43, s[12:15], s62 offen offset:3072 lds
    s_add_u32 m0, s64, 4096
    s_add_u32 s62, s62, 128
    s_bitset0_b32 s62, 10
    buffer_load_dwordx4 v40, s[12:15], s72 offen offset:0 lds
    buffer_load_dwordx4 v41, s[12:15], s72 offen offset:1024 lds
    buffer_load_dwordx4 v42, s[12:15], s72 offen offset:2048 lds
    buffer_load_dwordx4 v43, s[12:15], s72 offen offset:3072 lds
    s_mov_b32 m0, s73
    s_xor_b32 s64, s64, 0x10000
    buffer_load_dwordx4 v44, s[16:19], s63 offen offset:0 nt lds
    buffer_load_dwordx4 v45, s[16:19], s63 offen offset:1024 nt lds
    buffer_load_dwordx4 v46, s[16:19], s63 offen offset:2048 nt lds
    buffer_load_dwordx4 v47, s[16:19], s63 offen offset:3072 nt lds
    s_add_u32 m0, s73, 16384
    s_xor_b32 s73, s73, 0x10000
    buffer_load_dwordx4 v44, s[20:23], s63 offen offset:0 nt lds
    buffer_load_dwordx4 v45, s[20:23], s63 offen offset:1024 nt lds
    buffer_load_dwordx4 v46, s[20:23], s63 offen offset:2048 nt lds
    buffer_load_dwordx4 v47, s[20:23], s63 offen offset:3072 nt lds
    s_add_u32 s63, s63, 524288
    s_bitset0_b32 s63, 22
    s_setprio 1
L_st_v0:
    s_mov_b32 s8, s58
    s_mov_b32 s9, s59
    s_mov_b32 s10, 0x5000000
    s_mov_b32 s11, 0x20000
    s_mov_b32 s24, s36
    s_mov_b32 s25, s37
    s_mov_b32 s26, 0x500000
    s_mov_b32 s27, 0x20000
    v_lshlrev_b32 v13, 4, v1
    s_lshl_b32 s6, s5, 2
    s_add_u32 s7, s6, s3
    s_sub_u32 s6, 56, s6
    s_add_u32 s6, s6, s3
    s_cmp_lt_u32 s3, 4
    s_cselect_b32 s60, s7, s6
    s_sub_u32 s6, 2, s5
    s_and_b32 s6, s6, 7
    s_lshl_b32 s6, s6, 5
    s_add_u32 s61, s6, s4
    v_and_b32 v2, 15, v1
    v_lshrrev_b32 v3, 4, v1
    s_and_b32 s6, s3, 1
    s_lshl_b32 s6, s6, 7
    v_add_u32 v4, s6, v2
    v_lshlrev_b32 v4, 7, v4
    v_add_u32 v4, s100, v4
    v_lshrrev_b32 v5, 1, v2
    v_add_u32 v6, 0, v3
    v_xor_b32 v6, v6, v5
    v_lshl_add_u32 v48, v6, 4, v4
    v_add_u32 v6, 4, v3
    v_xor_b32 v6, v6, v5
    v_lshl_add_u32 v49, v6, 4, v4
    v_lshrrev_b32 v4, 2, v2
    v_lshl_add_u32 v5, v3, 3, v4
    v_lshlrev_b32 v5, 8, v5
    v_and_b32 v6, 1, v2
    v_lshl_add_u32 v5, v6, 3, v5
    v_and_b32 v6, 1, v3
    v_lshl_or_b32 v4, v6, 2, v4
    v_lshlrev_b32 v4, 1, v4
    v_bfe_u32 v6, v2, 1, 1
    v_add_u32 v8, 131072, v5
    v_add_u32 v7, 0, v6
    v_xor_b32 v7, v7, v4
    v_lshl_add_u32 v54, v7, 4, v8
    v_add_u32 v7, 2, v6
    v_xor_b32 v7, v7, v4
    v_lshl_add_u32 v55, v7, 4, v8
    v_add_u32 v7, 4, v6
    v_xor_b32 v7, v7, v4
    v_lshl_add_u32 v56, v7, 4, v8
    v_add_u32 v7, 6, v6
    v_xor_b32 v7, v7, v4
    v_lshl_add_u32 v57, v7, 4, v8
    v_add_u32 v7, 8, v6
    v_xor_b32 v7, v7, v4
    v_lshl_add_u32 v58, v7, 4, v8
    v_add_u32 v7, 10, v6
    v_xor_b32 v7, v7, v4
    v_lshl_add_u32 v59, v7, 4, v8
    v_add_u32 v7, 12, v6
    v_xor_b32 v7, v7, v4
    v_lshl_add_u32 v60, v7, 4, v8
    v_add_u32 v7, 14, v6
    v_xor_b32 v7, v7, v4
    v_lshl_add_u32 v61, v7, 4, v8
    s_lshr_b32 s6, s3, 2
    s_lshl_b32 s6, s6, 14
    s_add_u32 s6, s6, 32768
    s_add_u32 s6, s6, s100
    v_add_u32 v5, s6, v5
    s_lshr_b32 s7, s3, 1
    s_and_b32 s7, s7, 1
    s_lshl_b32 s7, s7, 3
    s_add_u32 s6, s7, 0
    v_add_u32 v7, s6, v6
    v_xor_b32 v7, v7, v4
    v_lshl_add_u32 v50, v7, 4, v5
    s_add_u32 s6, s7, 2
    v_add_u32 v7, s6, v6
    v_xor_b32 v7, v7, v4
    v_lshl_add_u32 v51, v7, 4, v5
    s_add_u32 s6, s7, 4
    v_add_u32 v7, s6, v6
    v_xor_b32 v7, v7, v4
    v_lshl_add_u32 v52, v7, 4, v5
    s_add_u32 s6, s7, 6
    v_add_u32 v7, s6, v6
    v_xor_b32 v7, v7, v4
    v_lshl_add_u32 v53, v7, 4, v5
    v_mov_b64 v[128:129], 0
    v_mov_b64 v[130:131], 0
    v_mov_b64 v[132:133], 0
    v_mov_b64 v[134:135], 0
    v_mov_b64 v[136:137], 0
    v_mov_b64 v[138:139], 0
    v_mov_b64 v[140:141], 0
    v_mov_b64 v[142:143], 0
    v_mov_b64 v[144:145], 0
    v_mov_b64 v[146:147], 0
    v_mov_b64 v[148:149], 0
    v_mov_b64 v[150:151], 0
    v_mov_b64 v[152:153], 0
    v_mov_b64 v[154:155], 0
    v_mov_b64 v[156:157], 0
    v_mov_b64 v[158:159], 0
    v_mov_b64 v[160:161], 0
    v_mov_b64 v[162:163], 0
    v_mov_b64 v[164:165], 0
    v_mov_b64 v[166:167], 0
    v_mov_b64 v[168:169], 0
    v_mov_b64 v[170:171], 0
    v_mov_b64 v[172:173], 0
    v_mov_b64 v[174:175], 0
    v_mov_b64 v[176:177], 0
    v_mov_b64 v[178:179], 0
    v_mov_b64 v[180:181], 0
    v_mov_b64 v[182:183], 0
    v_mov_b64 v[184:185], 0
    v_mov_b64 v[186:187], 0
    v_mov_b64 v[188:189], 0
    v_mov_b64 v[190:191], 0
    v_mov_b64 v[192:193], 0
    v_mov_b64 v[194:195], 0
    v_mov_b64 v[196:197], 0
    v_mov_b64 v[198:199], 0
    v_mov_b64 v[200:201], 0
    v_mov_b64 v[202:203], 0
    v_mov_b64 v[204:205], 0
    v_mov_b64 v[206:207], 0
    v_mov_b64 v[208:209], 0
    v_mov_b64 v[210:211], 0
    v_mov_b64 v[212:213], 0
    v_mov_b64 v[214:215], 0
    v_mov_b64 v[216:217], 0
    v_mov_b64 v[218:219], 0
    v_mov_b64 v[220:221], 0
    v_mov_b64 v[222:223], 0
    v_mov_b64 v[224:225], 0
    v_mov_b64 v[226:227], 0
    v_mov_b64 v[228:229], 0
    v_mov_b64 v[230:231], 0
    v_mov_b64 v[232:233], 0
    v_mov_b64 v[234:235], 0
    v_mov_b64 v[236:237], 0
    v_mov_b64 v[238:239], 0
    v_mov_b64 v[240:241], 0
    v_mov_b64 v[242:243], 0
    v_mov_b64 v[244:245], 0
    v_mov_b64 v[246:247], 0
    v_mov_b64 v[248:249], 0
    v_mov_b64 v[250:251], 0
    v_mov_b64 v[252:253], 0
    v_mov_b64 v[254:255], 0
    v_add_u32 v12, 20480, v13
    s_mul_i32 s70, s60, 40960
    s_mov_b32 s65, 0
    s_lshl_b32 s6, s4, 20
    s_lshl_b32 s7, s5, 13
    s_add_u32 s6, s6, s7
    s_and_b32 s7, s3, 1
    s_lshl_b32 s7, s7, 16
    s_add_u32 s6, s6, s7
    s_add_u32 s67, s6, 16777216
    s_and_b32 s6, s4, 3
    s_add_u32 s6, s6, s5
    s_sub_u32 s7, s6, 5
    s_cselect_b32 s6, s6, s7
    s_sub_u32 s7, s6, 5
    s_cselect_b32 s6, s6, s7
    s_lshl_b32 s71, s6, 20
    s_lshl_b32 s7, s4, 8
    s_add_u32 s71, s71, s7
    s_lshl_b32 s7, s6, 12
    s_add_u32 s84, s70, s7
    s_add_u32 s6, s6, 1
    s_cmp_eq_u32 s6, 5
    s_cselect_b32 s6, 0, s6
    s_lshl_b32 s7, s6, 12
    s_add_u32 s85, s70, s7
    s_add_u32 s6, s6, 1
    s_cmp_eq_u32 s6, 5
    s_cselect_b32 s6, 0, s6
    s_lshl_b32 s7, s6, 12
    s_add_u32 s86, s70, s7
    s_add_u32 s6, s6, 1
    s_cmp_eq_u32 s6, 5
    s_cselect_b32 s6, 0, s6
    s_lshl_b32 s7, s6, 12
    s_add_u32 s87, s70, s7
    s_add_u32 s6, s6, 1
    s_cmp_eq_u32 s6, 5
    s_cselect_b32 s6, 0, s6
    s_lshl_b32 s7, s6, 12
    s_add_u32 s88, s70, s7
    s_lshr_b32 s7, s3, 1
    s_and_b32 s7, s7, 1
    s_cmp_ge_u32 s3, 4
    s_cbranch_scc1 L_c_v
    s_lshl_b32 s7, s7, 11
    s_add_u32 s67, s67, s7
    s_movk_i32 s68, 3072
    s_mov_b32 s69, 125952
    s_add_u32 s71, s71, 1048576
    s_sub_u32 s75, s71, 5242880
    s_cselect_b32 s71, s71, s75
    s_lshl_b32 s74, s76, 12
    s_add_u32 s74, s74, s100
    s_branch L_c_j
L_c_v:
    s_lshl_b32 s7, s7, 12
    s_add_u32 s67, s67, s7
    s_add_u32 s67, s67, 0x80000
    s_movk_i32 s68, 1024
    s_mov_b32 s69, 128000
L_c_j:
    s_cmp_ge_u32 s3, 4
    s_cbranch_scc1 L_st_v1
    s_mov_b32 m0, s64
    s_add_u32 s72, s62, 524288
    buffer_load_dwordx4 v40, s[12:15], s62 offen offset:0 lds
    buffer_load_dwordx4 v41, s[12:15], s62 offen offset:1024 lds
    buffer_load_dwordx4 v42, s[12:15], s62 offen offset:2048 lds
    buffer_load_dwordx4 v43, s[12:15], s62 offen offset:3072 lds
    s_add_u32 m0, s64, 4096
    s_add_u32 s62, s62, 128
    s_bitset0_b32 s62, 10
    buffer_load_dwordx4 v40, s[12:15], s72 offen offset:0 lds
    buffer_load_dwordx4 v41, s[12:15], s72 offen offset:1024 lds
    buffer_load_dwordx4 v42, s[12:15], s72 offen offset:2048 lds
    buffer_load_dwordx4 v43, s[12:15], s72 offen offset:3072 lds
    s_waitcnt vmcnt(8)
    s_branch L_st_j1
L_st_v1:
    s_waitcnt vmcnt(6)
    v_lshlrev_b32 v64, 16, v16
    v_and_b32 v65, 0xffff0000, v16
    v_lshlrev_b32 v66, 16, v17
    v_and_b32 v67, 0xffff0000, v17
    v_lshlrev_b32 v68, 16, v18
    v_and_b32 v69, 0xffff0000, v18
    v_lshlrev_b32 v70, 16, v19
    v_and_b32 v71, 0xffff0000, v19
    v_lshlrev_b32 v72, 16, v20
    v_and_b32 v73, 0xffff0000, v20
    v_lshlrev_b32 v74, 16, v21
    v_and_b32 v75, 0xffff0000, v21
    v_lshlrev_b32 v76, 16, v22
    v_and_b32 v77, 0xffff0000, v22
    v_lshlrev_b32 v78, 16, v23
    v_and_b32 v79, 0xffff0000, v23
    v_lshlrev_b32 v80, 16, v24
    v_and_b32 v81, 0xffff0000, v24
    v_lshlrev_b32 v82, 16, v25
    v_and_b32 v83, 0xffff0000, v25
    v_pk_add_f32 v[2:3], v[64:65], v[66:67]
    v_pk_add_f32 v[2:3], v[2:3], v[68:69]
    v_pk_add_f32 v[2:3], v[2:3], v[70:71]
    v_pk_add_f32 v[2:3], v[2:3], v[72:73]
    v_pk_add_f32 v[2:3], v[2:3], v[74:75]
    v_pk_add_f32 v[2:3], v[2:3], v[76:77]
    v_pk_add_f32 v[2:3], v[2:3], v[78:79]
    v_pk_add_f32 v[2:3], v[2:3], v[80:81]
    v_pk_add_f32 v[2:3], v[2:3], v[82:83]
    v_add_f32 v2, v2, v3
    s_nop 1
    v_add_f32_dpp v2, v2, v2 quad_perm:[1,0,3,2] row_mask:0xf bank_mask:0xf
    s_nop 1
    v_add_f32_dpp v2, v2, v2 quad_perm:[2,3,0,1] row_mask:0xf bank_mask:0xf
    s_nop 1
    v_add_f32_dpp v2, v2, v2 row_half_mirror row_mask:0xf bank_mask:0xf
    s_nop 1
    v_add_f32_dpp v2, v2, v2 row_mirror row_mask:0xf bank_mask:0xf
    v_mov_b32 v8, v2
    s_nop 1
    v_permlane16_swap_b32 v2, v8
    s_nop 1
    v_add_f32 v2, v2, v8
    s_mov_b32 s7, 0x3acccccd
    v_mul_f32 v2, s7, v2
    v_mov_b64 v[4:5], 0
    v_pk_add_f32 v[6:7], v[64:65], v[2:3] op_sel_hi:[1,0] neg_lo:[0,1] neg_hi:[0,1]
    v_pk_fma_f32 v[4:5], v[6:7], v[6:7], v[4:5]
    v_pk_add_f32 v[6:7], v[66:67], v[2:3] op_sel_hi:[1,0] neg_lo:[0,1] neg_hi:[0,1]
    v_pk_fma_f32 v[4:5], v[6:7], v[6:7], v[4:5]
    v_pk_add_f32 v[6:7], v[68:69], v[2:3] op_sel_hi:[1,0] neg_lo:[0,1] neg_hi:[0,1]
    v_pk_fma_f32 v[4:5], v[6:7], v[6:7], v[4:5]
    v_pk_add_f32 v[6:7], v[70:71], v[2:3] op_sel_hi:[1,0] neg_lo:[0,1] neg_hi:[0,1]
    v_pk_fma_f32 v[4:5], v[6:7], v[6:7], v[4:5]
    v_pk_add_f32 v[6:7], v[72:73], v[2:3] op_sel_hi:[1,0] neg_lo:[0,1] neg_hi:[0,1]
    v_pk_fma_f32 v[4:5], v[6:7], v[6:7], v[4:5]
    v_pk_add_f32 v[6:7], v[74:75], v[2:3] op_sel_hi:[1,0] neg_lo:[0,1] neg_hi:[0,1]
    v_pk_fma_f32 v[4:5], v[6:7], v[6:7], v[4:5]
    v_pk_add_f32 v[6:7], v[76:77], v[2:3] op_sel_hi:[1,0] neg_lo:[0,1] neg_hi:[0,1]
    v_pk_fma_f32 v[4:5], v[6:7], v[6:7], v[4:5]
    v_pk_add_f32 v[6:7], v[78:79], v[2:3] op_sel_hi:[1,0] neg_lo:[0,1] neg_hi:[0,1]
    v_pk_fma_f32 v[4:5], v[6:7], v[6:7], v[4:5]
    v_pk_add_f32 v[6:7], v[80:81], v[2:3] op_sel_hi:[1,0] neg_lo:[0,1] neg_hi:[0,1]
    v_pk_fma_f32 v[4:5], v[6:7], v[6:7], v[4:5]
    v_pk_add_f32 v[6:7], v[82:83], v[2:3] op_sel_hi:[1,0] neg_lo:[0,1] neg_hi:[0,1]
    v_pk_fma_f32 v[4:5], v[6:7], v[6:7], v[4:5]
    v_add_f32 v4, v4, v5
    s_nop 1
    v_add_f32_dpp v4, v4, v4 quad_perm:[1,0,3,2] row_mask:0xf bank_mask:0xf
    s_nop 1
    v_add_f32_dpp v4, v4, v4 quad_perm:[2,3,0,1] row_mask:0xf bank_mask:0xf
    s_nop 1
    v_add_f32_dpp v4, v4, v4 row_half_mirror row_mask:0xf bank_mask:0xf
    s_nop 1
    v_add_f32_dpp v4, v4, v4 row_mirror row_mask:0xf bank_mask:0xf
    v_mov_b32 v8, v4
    s_nop 1
    v_permlane16_swap_b32 v4, v8
    s_nop 1
    v_add_f32 v4, v4, v8
    v_mul_f32 v4, s7, v4
    v_cvt_pk_bf16_f32 v2, v2, v2
    v_lshlrev_b32 v2, 16, v2
    v_cvt_pk_bf16_f32 v4, v4, v4
    v_lshlrev_b32 v4, 16, v4
    v_add_f32 v4, 0x3727c5ac, v4
    v_cvt_pk_bf16_f32 v4, v4, v4
    v_lshlrev_b32 v4, 16, v4
    v_sqrt_f32 v4, v4
    s_nop 0
    v_cvt_pk_bf16_f32 v4, v4, v4
    v_lshlrev_b32 v4, 16, v4
    v_rcp_f32 v6, v4
    s_nop 0
    v_fma_f32 v5, -v4, v6, 1.0
    v_fmac_f32 v6, v5, v6
    v_mov_b32 v9, 0
    v_pk_add_f32 v[64:65], v[64:65], v[2:3] op_sel_hi:[1,0] neg_lo:[0,1] neg_hi:[0,1]
    v_cvt_pk_bf16_f32 v5, v64, v65
    v_lshlrev_b32 v64, 16, v5
    v_and_b32 v65, 0xffff0000, v5
    v_pk_mul_f32 v[64:65], v[64:65], v[6:7] op_sel_hi:[1,0]
    v_cvt_pk_bf16_f32 v16, v64, v65
    v_pk_add_f32 v[66:67], v[66:67], v[2:3] op_sel_hi:[1,0] neg_lo:[0,1] neg_hi:[0,1]
    v_cvt_pk_bf16_f32 v5, v66, v67
    v_lshlrev_b32 v66, 16, v5
    v_and_b32 v67, 0xffff0000, v5
    v_pk_mul_f32 v[66:67], v[66:67], v[6:7] op_sel_hi:[1,0]
    v_cvt_pk_bf16_f32 v17, v66, v67
    v_pk_add_f32 v[68:69], v[68:69], v[2:3] op_sel_hi:[1,0] neg_lo:[0,1] neg_hi:[0,1]
    v_cvt_pk_bf16_f32 v5, v68, v69
    v_lshlrev_b32 v68, 16, v5
    v_and_b32 v69, 0xffff0000, v5
    v_pk_mul_f32 v[68:69], v[68:69], v[6:7] op_sel_hi:[1,0]
    v_cvt_pk_bf16_f32 v18, v68, v69
    v_pk_add_f32 v[70:71], v[70:71], v[2:3] op_sel_hi:[1,0] neg_lo:[0,1] neg_hi:[0,1]
    v_cvt_pk_bf16_f32 v5, v70, v71
    v_lshlrev_b32 v70, 16, v5
    v_and_b32 v71, 0xffff0000, v5
    v_pk_mul_f32 v[70:71], v[70:71], v[6:7] op_sel_hi:[1,0]
    v_cvt_pk_bf16_f32 v19, v70, v71
    v_pk_add_f32 v[72:73], v[72:73], v[2:3] op_sel_hi:[1,0] neg_lo:[0,1] neg_hi:[0,1]
    v_cvt_pk_bf16_f32 v5, v72, v73
    v_lshlrev_b32 v72, 16, v5
    v_and_b32 v73, 0xffff0000, v5
    v_pk_mul_f32 v[72:73], v[72:73], v[6:7] op_sel_hi:[1,0]
    v_cvt_pk_bf16_f32 v20, v72, v73
    v_pk_add_f32 v[74:75], v[74:75], v[2:3] op_sel_hi:[1,0] neg_lo:[0,1] neg_hi:[0,1]
    v_cvt_pk_bf16_f32 v5, v74, v75
    v_lshlrev_b32 v74, 16, v5
    v_and_b32 v75, 0xffff0000, v5
    v_pk_mul_f32 v[74:75], v[74:75], v[6:7] op_sel_hi:[1,0]
    v_cvt_pk_bf16_f32 v21, v74, v75
    v_pk_add_f32 v[76:77], v[76:77], v[2:3] op_sel_hi:[1,0] neg_lo:[0,1] neg_hi:[0,1]
    v_cvt_pk_bf16_f32 v5, v76, v77
    v_lshlrev_b32 v76, 16, v5
    v_and_b32 v77, 0xffff0000, v5
    v_pk_mul_f32 v[76:77], v[76:77], v[6:7] op_sel_hi:[1,0]
    v_cvt_pk_bf16_f32 v22, v76, v77
    v_pk_add_f32 v[78:79], v[78:79], v[2:3] op_sel_hi:[1,0] neg_lo:[0,1] neg_hi:[0,1]
    v_cvt_pk_bf16_f32 v5, v78, v79
    v_lshlrev_b32 v78, 16, v5
    v_and_b32 v79, 0xffff0000, v5
    v_pk_mul_f32 v[78:79], v[78:79], v[6:7] op_sel_hi:[1,0]
    v_cvt_pk_bf16_f32 v23, v78, v79
    v_pk_add_f32 v[80:81], v[80:81], v[2:3] op_sel_hi:[1,0] neg_lo:[0,1] neg_hi:[0,1]
    v_cvt_pk_bf16_f32 v5, v80, v81
    v_lshlrev_b32 v80, 16, v5
    v_and_b32 v81, 0xffff0000, v5
    v_pk_mul_f32 v[80:81], v[80:81], v[6:7] op_sel_hi:[1,0]
    v_cvt_pk_bf16_f32 v24, v80, v81
    v_pk_add_f32 v[82:83], v[82:83], v[2:3] op_sel_hi:[1,0] neg_lo:[0,1] neg_hi:[0,1]
    v_cvt_pk_bf16_f32 v5, v82, v83
    v_lshlrev_b32 v82, 16, v5
    v_and_b32 v83, 0xffff0000, v5
    v_pk_mul_f32 v[82:83], v[82:83], v[6:7] op_sel_hi:[1,0]
    v_cvt_pk_bf16_f32 v25, v82, v83
    v_add_u32 v10, 131072, v63
    ds_write_b64 v10, v[16:17] offset:0
    ds_write_b64 v10, v[18:19] offset:256
    ds_write_b64 v10, v[20:21] offset:512
    ds_write_b64 v10, v[22:23] offset:768
    ds_write_b64 v10, v[24:25] offset:1024
    s_waitcnt lgkmcnt(0)
    v_mov_b32 v2, 0
    v_lshlrev_b32 v4, 16, v16
    v_lshlrev_b32 v5, 16, v26
    v_fmac_f32 v2, v4, v5
    v_and_b32 v4, 0xffff0000, v16
    v_and_b32 v5, 0xffff0000, v26
    v_fmac_f32 v2, v4, v5
    v_lshlrev_b32 v4, 16, v17
    v_lshlrev_b32 v5, 16, v27
    v_fmac_f32 v2, v4, v5
    v_and_b32 v4, 0xffff0000, v17
    v_and_b32 v5, 0xffff0000, v27
    v_fmac_f32 v2, v4, v5
    v_lshlrev_b32 v4, 16, v18
    v_lshlrev_b32 v5, 16, v28
    v_fmac_f32 v2, v4, v5
    v_and_b32 v4, 0xffff0000, v18
    v_and_b32 v5, 0xffff0000, v28
    v_fmac_f32 v2, v4, v5
    v_lshlrev_b32 v4, 16, v19
    v_lshlrev_b32 v5, 16, v29
    v_fmac_f32 v2, v4, v5
    v_and_b32 v4, 0xffff0000, v19
    v_and_b32 v5, 0xffff0000, v29
    v_fmac_f32 v2, v4, v5
    v_lshlrev_b32 v4, 16, v20
    v_lshlrev_b32 v5, 16, v30
    v_fmac_f32 v2, v4, v5
    v_and_b32 v4, 0xffff0000, v20
    v_and_b32 v5, 0xffff0000, v30
    v_fmac_f32 v2, v4, v5
    v_lshlrev_b32 v4, 16, v21
    v_lshlrev_b32 v5, 16, v31
    v_fmac_f32 v2, v4, v5
    v_and_b32 v4, 0xffff0000, v21
    v_and_b32 v5, 0xffff0000, v31
    v_fmac_f32 v2, v4, v5
    v_lshlrev_b32 v4, 16, v22
    v_lshlrev_b32 v5, 16, v32
    v_fmac_f32 v2, v4, v5
    v_and_b32 v4, 0xffff0000, v22
    v_and_b32 v5, 0xffff0000, v32
    v_fmac_f32 v2, v4, v5
    v_lshlrev_b32 v4, 16, v23
    v_lshlrev_b32 v5, 16, v33
    v_fmac_f32 v2, v4, v5
    v_and_b32 v4, 0xffff0000, v23
    v_and_b32 v5, 0xffff0000, v33
    v_fmac_f32 v2, v4, v5
    v_lshlrev_b32 v4, 16, v24
    v_lshlrev_b32 v5, 16, v34
    v_fmac_f32 v2, v4, v5
    v_and_b32 v4, 0xffff0000, v24
    v_and_b32 v5, 0xffff0000, v34
    v_fmac_f32 v2, v4, v5
    v_lshlrev_b32 v4, 16, v25
    v_lshlrev_b32 v5, 16, v35
    v_fmac_f32 v2, v4, v5
    v_and_b32 v4, 0xffff0000, v25
    v_and_b32 v5, 0xffff0000, v35
    v_fmac_f32 v2, v4, v5
    s_nop 1
    v_add_f32_dpp v2, v2, v2 quad_perm:[1,0,3,2] row_mask:0xf bank_mask:0xf
    s_nop 1
    v_add_f32_dpp v2, v2, v2 quad_perm:[2,3,0,1] row_mask:0xf bank_mask:0xf
    s_nop 1
    v_add_f32_dpp v2, v2, v2 row_half_mirror row_mask:0xf bank_mask:0xf
    s_nop 1
    v_add_f32_dpp v2, v2, v2 row_mirror row_mask:0xf bank_mask:0xf
    v_mov_b32 v8, v2
    s_nop 1
    v_permlane16_swap_b32 v2, v8
    s_nop 1
    v_add_f32 v2, v2, v8
    v_cvt_pk_bf16_f32 v2, v2, v2
    v_and_b32 v2, 0xffff, v2
    v_bfe_i32 v3, v2, 15, 1
    v_and_b32 v3, 0x7fff, v3
    v_or_b32 v3, 0x8000, v3
    v_xor_b32 v2, v2, v3
    s_lshl_b32 s7, s2, 3
    s_sub_u32 s6, 2047, s7
    v_sub_u32 v3, s6, v62
    v_lshl_or_b32 v2, v2, 11, v3
    v_lshlrev_b32 v3, 2, v62
    v_add_u32 v3, 161792, v3
    ds_write_b32 v3, v2
    s_waitcnt lgkmcnt(0)
L_st_j1:
    s_barrier
    s_cmp_ge_u32 s3, 4
    s_cbranch_scc1 L_kv_v
    ds_read_b128 v[64:67], v48 offset:0
    ds_read_b128 v[68:71], v48 offset:2048
    ds_read_b64_tr_b16 v[96:97], v50 offset:0
    ds_read_b64_tr_b16 v[98:99], v50 offset:1024
    ds_read_b64_tr_b16 v[100:101], v51 offset:0
    ds_read_b64_tr_b16 v[102:103], v51 offset:1024
    ds_read_b128 v[72:75], v48 offset:4096
    ds_read_b64_tr_b16 v[104:105], v52 offset:0
    ds_read_b64_tr_b16 v[106:107], v52 offset:1024
    ds_read_b64_tr_b16 v[108:109], v53 offset:0
    ds_read_b64_tr_b16 v[110:111], v53 offset:1024
    ds_read_b128 v[76:79], v48 offset:6144
    ds_read_b128 v[80:83], v48 offset:8192
    ds_read_b128 v[84:87], v48 offset:10240
    ds_read_b128 v[88:91], v48 offset:12288
    ds_read_b128 v[92:95], v48 offset:14336
    s_mov_b32 m0, s73
    s_xor_b32 s64, s64, 0x10000
    buffer_load_dwordx4 v44, s[16:19], s63 offen offset:0 nt lds
    buffer_load_dwordx4 v45, s[16:19], s63 offen offset:1024 nt lds
    buffer_load_dwordx4 v46, s[16:19], s63 offen offset:2048 nt lds
    buffer_load_dwordx4 v47, s[16:19], s63 offen offset:3072 nt lds
    s_add_u32 m0, s73, 16384
    s_xor_b32 s73, s73, 0x10000
    buffer_load_dwordx4 v44, s[20:23], s63 offen offset:0 nt lds
    buffer_load_dwordx4 v45, s[20:23], s63 offen offset:1024 nt lds
    buffer_load_dwordx4 v46, s[20:23], s63 offen offset:2048 nt lds
    buffer_load_dwordx4 v47, s[20:23], s63 offen offset:3072 nt lds
    s_add_u32 s63, s63, 524288
    s_bitset0_b32 s63, 22
.p2align 4
L_kloopA:
    s_waitcnt lgkmcnt(12)
    v_mfma_f32_16x16x32_bf16 v[128:131], v[96:99], v[64:67], v[128:131]
    ds_read_b64_tr_b16 v[112:113], v50 offset:8192
    s_waitcnt lgkmcnt(11)
    v_mfma_f32_16x16x32_bf16 v[132:135], v[100:103], v[64:67], v[132:135]
    ds_read_b64_tr_b16 v[114:115], v50 offset:9216
    s_waitcnt lgkmcnt(9)
    v_mfma_f32_16x16x32_bf16 v[136:139], v[104:107], v[64:67], v[136:139]
    ds_read_b64_tr_b16 v[116:117], v51 offset:8192
    s_waitcnt lgkmcnt(8)
    v_mfma_f32_16x16x32_bf16 v[140:143], v[108:111], v[64:67], v[140:143]
    ds_read_b64_tr_b16 v[118:119], v51 offset:9216
    ds_read_b128 v[64:67], v49 offset:0
    v_mfma_f32_16x16x32_bf16 v[156:159], v[108:111], v[68:71], v[156:159]
    ds_read_b64_tr_b16 v[120:121], v52 offset:8192
    v_mfma_f32_16x16x32_bf16 v[152:155], v[104:107], v[68:71], v[152:155]
    ds_read_b64_tr_b16 v[122:123], v52 offset:9216
    v_mfma_f32_16x16x32_bf16 v[148:151], v[100:103], v[68:71], v[148:151]
    ds_read_b64_tr_b16 v[124:125], v53 offset:8192
    v_mfma_f32_16x16x32_bf16 v[144:147], v[96:99], v[68:71], v[144:147]
    ds_read_b64_tr_b16 v[126:127], v53 offset:9216
    ds_read_b128 v[68:71], v49 offset:2048
    v_mfma_f32_16x16x32_bf16 v[160:163], v[96:99], v[72:75], v[160:163]
    v_mfma_f32_16x16x32_bf16 v[164:167], v[100:103], v[72:75], v[164:167]
    v_mfma_f32_16x16x32_bf16 v[168:171], v[104:107], v[72:75], v[168:171]
    v_mfma_f32_16x16x32_bf16 v[172:175], v[108:111], v[72:75], v[172:175]
    ds_read_b128 v[72:75], v49 offset:4096
    s_waitcnt lgkmcnt(15)
    v_mfma_f32_16x16x32_bf16 v[188:191], v[108:111], v[76:79], v[188:191]
    v_mfma_f32_16x16x32_bf16 v[184:187], v[104:107], v[76:79], v[184:187]
    v_mfma_f32_16x16x32_bf16 v[180:183], v[100:103], v[76:79], v[180:183]
    v_mfma_f32_16x16x32_bf16 v[176:179], v[96:99], v[76:79], v[176:179]
    ds_read_b128 v[76:79], v49 offset:6144
    s_waitcnt lgkmcnt(15)
    v_mfma_f32_16x16x32_bf16 v[192:195], v[96:99], v[80:83], v[192:195]
    v_mfma_f32_16x16x32_bf16 v[196:199], v[100:103], v[80:83], v[196:199]
    v_mfma_f32_16x16x32_bf16 v[200:203], v[104:107], v[80:83], v[200:203]
    v_mfma_f32_16x16x32_bf16 v[204:207], v[108:111], v[80:83], v[204:207]
    ds_read_b128 v[80:83], v49 offset:8192
    s_waitcnt lgkmcnt(15)
    v_mfma_f32_16x16x32_bf16 v[220:223], v[108:111], v[84:87], v[220:223]
    v_mfma_f32_16x16x32_bf16 v[216:219], v[104:107], v[84:87], v[216:219]
    v_mfma_f32_16x16x32_bf16 v[212:215], v[100:103], v[84:87], v[212:215]
    v_mfma_f32_16x16x32_bf16 v[208:211], v[96:99], v[84:87], v[208:211]
    ds_read_b128 v[84:87], v49 offset:10240
    s_waitcnt lgkmcnt(15)
    v_mfma_f32_16x16x32_bf16 v[224:227], v[96:99], v[88:91], v[224:227]
    v_mfma_f32_16x16x32_bf16 v[228:231], v[100:103], v[88:91], v[228:231]
    v_mfma_f32_16x16x32_bf16 v[232:235], v[104:107], v[88:91], v[232:235]
    v_mfma_f32_16x16x32_bf16 v[236:239], v[108:111], v[88:91], v[236:239]
    ds_read_b128 v[88:91], v49 offset:12288
    s_waitcnt lgkmcnt(15)
    v_mfma_f32_16x16x32_bf16 v[252:255], v[108:111], v[92:95], v[252:255]
    v_mfma_f32_16x16x32_bf16 v[248:251], v[104:107], v[92:95], v[248:251]
    v_mfma_f32_16x16x32_bf16 v[244:247], v[100:103], v[92:95], v[244:247]
    v_mfma_f32_16x16x32_bf16 v[240:243], v[96:99], v[92:95], v[240:243]
    ds_read_b128 v[92:95], v49 offset:14336
    s_waitcnt lgkmcnt(11)
    v_mfma_f32_16x16x32_bf16 v[128:131], v[112:115], v[64:67], v[128:131]
    v_mfma_f32_16x16x32_bf16 v[132:135], v[116:119], v[64:67], v[132:135]
    s_waitcnt lgkmcnt(9)
    v_mfma_f32_16x16x32_bf16 v[136:139], v[120:123], v[64:67], v[136:139]
    s_waitcnt lgkmcnt(7)
    v_mfma_f32_16x16x32_bf16 v[140:143], v[124:127], v[64:67], v[140:143]
    s_waitcnt lgkmcnt(6)
    v_mfma_f32_16x16x32_bf16 v[156:159], v[124:127], v[68:71], v[156:159]
    v_mfma_f32_16x16x32_bf16 v[152:155], v[120:123], v[68:71], v[152:155]
    v_mfma_f32_16x16x32_bf16 v[148:151], v[116:119], v[68:71], v[148:151]
    v_mfma_f32_16x16x32_bf16 v[144:147], v[112:115], v[68:71], v[144:147]
    v_xor_b32 v48, 0x10000, v48
    v_xor_b32 v49, 0x10000, v49
    v_xor_b32 v50, 0x10000, v50
    v_xor_b32 v51, 0x10000, v51
    v_xor_b32 v52, 0x10000, v52
    v_xor_b32 v53, 0x10000, v53
    s_waitcnt vmcnt(0) lgkmcnt(0)
    s_barrier
    ds_read_b128 v[64:67], v48 offset:0
    ds_read_b128 v[68:71], v48 offset:2048
    v_mfma_f32_16x16x32_bf16 v[160:163], v[112:115], v[72:75], v[160:163]
    ds_read_b64_tr_b16 v[96:97], v50 offset:0
    s_mov_b32 m0, s64
    s_add_u32 s72, s62, 524288
    v_mfma_f32_16x16x32_bf16 v[164:167], v[116:119], v[72:75], v[164:167]
    ds_read_b64_tr_b16 v[98:99], v50 offset:1024
    buffer_load_dwordx4 v40, s[12:15], s62 offen offset:0 lds
    v_mfma_f32_16x16x32_bf16 v[168:171], v[120:123], v[72:75], v[168:171]
    ds_read_b64_tr_b16 v[100:101], v51 offset:0
    buffer_load_dwordx4 v41, s[12:15], s62 offen offset:1024 lds
    v_mfma_f32_16x16x32_bf16 v[172:175], v[124:127], v[72:75], v[172:175]
    ds_read_b64_tr_b16 v[102:103], v51 offset:1024
    buffer_load_dwordx4 v42, s[12:15], s62 offen offset:2048 lds
    ds_read_b128 v[72:75], v48 offset:4096
    v_mfma_f32_16x16x32_bf16 v[188:191], v[124:127], v[76:79], v[188:191]
    ds_read_b64_tr_b16 v[104:105], v52 offset:0
    buffer_load_dwordx4 v43, s[12:15], s62 offen offset:3072 lds
    v_mfma_f32_16x16x32_bf16 v[184:187], v[120:123], v[76:79], v[184:187]
    ds_read_b64_tr_b16 v[106:107], v52 offset:1024
    s_add_u32 m0, s64, 4096
    s_add_u32 s62, s62, 128
    s_bitset0_b32 s62, 10
    v_mfma_f32_16x16x32_bf16 v[180:183], v[116:119], v[76:79], v[180:183]
    ds_read_b64_tr_b16 v[108:109], v53 offset:0
    buffer_load_dwordx4 v40, s[12:15], s72 offen offset:0 lds
    v_mfma_f32_16x16x32_bf16 v[176:179], v[112:115], v[76:79], v[176:179]
    ds_read_b64_tr_b16 v[110:111], v53 offset:1024
    buffer_load_dwordx4 v41, s[12:15], s72 offen offset:1024 lds
    ds_read_b128 v[76:79], v48 offset:6144
    v_mfma_f32_16x16x32_bf16 v[192:195], v[112:115], v[80:83], v[192:195]
    buffer_load_dwordx4 v42, s[12:15], s72 offen offset:2048 lds
    v_mfma_f32_16x16x32_bf16 v[196:199], v[116:119], v[80:83], v[196:199]
    buffer_load_dwordx4 v43, s[12:15], s72 offen offset:3072 lds
    v_mfma_f32_16x16x32_bf16 v[200:203], v[120:123], v[80:83], v[200:203]
    s_mov_b32 m0, s73
    s_xor_b32 s64, s64, 0x10000
    v_mfma_f32_16x16x32_bf16 v[204:207], v[124:127], v[80:83], v[204:207]
    buffer_load_dwordx4 v44, s[16:19], s63 offen offset:0 nt lds
    ds_read_b128 v[80:83], v48 offset:8192
    v_mfma_f32_16x16x32_bf16 v[220:223], v[124:127], v[84:87], v[220:223]
    buffer_load_dwordx4 v45, s[16:19], s63 offen offset:1024 nt lds
    v_mfma_f32_16x16x32_bf16 v[216:219], v[120:123], v[84:87], v[216:219]
    buffer_load_dwordx4 v46, s[16:19], s63 offen offset:2048 nt lds
    v_mfma_f32_16x16x32_bf16 v[212:215], v[116:119], v[84:87], v[212:215]
    buffer_load_dwordx4 v47, s[16:19], s63 offen offset:3072 nt lds
    v_mfma_f32_16x16x32_bf16 v[208:211], v[112:115], v[84:87], v[208:211]
    s_add_u32 m0, s73, 16384
    s_xor_b32 s73, s73, 0x10000
    ds_read_b128 v[84:87], v48 offset:10240
    v_mfma_f32_16x16x32_bf16 v[224:227], v[112:115], v[88:91], v[224:227]
    buffer_load_dwordx4 v44, s[20:23], s63 offen offset:0 nt lds
    v_mfma_f32_16x16x32_bf16 v[228:231], v[116:119], v[88:91], v[228:231]
    buffer_load_dwordx4 v45, s[20:23], s63 offen offset:1024 nt lds
    v_mfma_f32_16x16x32_bf16 v[232:235], v[120:123], v[88:91], v[232:235]
    buffer_load_dwordx4 v46, s[20:23], s63 offen offset:2048 nt lds
    v_mfma_f32_16x16x32_bf16 v[236:239], v[124:127], v[88:91], v[236:239]
    buffer_load_dwordx4 v47, s[20:23], s63 offen offset:3072 nt lds
    ds_read_b128 v[88:91], v48 offset:12288
    v_mfma_f32_16x16x32_bf16 v[252:255], v[124:127], v[92:95], v[252:255]
    s_add_u32 s63, s63, 524288
    s_bitset0_b32 s63, 22
    v_mfma_f32_16x16x32_bf16 v[248:251], v[120:123], v[92:95], v[248:251]
    v_mfma_f32_16x16x32_bf16 v[244:247], v[116:119], v[92:95], v[244:247]
    v_mfma_f32_16x16x32_bf16 v[240:243], v[112:115], v[92:95], v[240:243]
    ds_read_b128 v[92:95], v48 offset:14336
    s_add_u32 s65, s65, 1
    s_cmp_lt_u32 s65, 6
    s_cbranch_scc1 L_kloopA
.p2align 4
L_kloopB:
    s_bitcmp1_b32 128, s65
    s_cbranch_scc1 L_khook
L_khook_back:
    s_waitcnt lgkmcnt(12)
    v_mfma_f32_16x16x32_bf16 v[128:131], v[96:99], v[64:67], v[128:131]
    ds_read_b64_tr_b16 v[112:113], v50 offset:8192
    s_waitcnt lgkmcnt(11)
    v_mfma_f32_16x16x32_bf16 v[132:135], v[100:103], v[64:67], v[132:135]
    ds_read_b64_tr_b16 v[114:115], v50 offset:9216
    s_waitcnt lgkmcnt(9)
    v_mfma_f32_16x16x32_bf16 v[136:139], v[104:107], v[64:67], v[136:139]
    ds_read_b64_tr_b16 v[116:117], v51 offset:8192
    s_waitcnt lgkmcnt(8)
    v_mfma_f32_16x16x32_bf16 v[140:143], v[108:111], v[64:67], v[140:143]
    ds_read_b64_tr_b16 v[118:119], v51 offset:9216
    ds_read_b128 v[64:67], v49 offset:0
    v_mfma_f32_16x16x32_bf16 v[156:159], v[108:111], v[68:71], v[156:159]
    ds_read_b64_tr_b16 v[120:121], v52 offset:8192
    v_mfma_f32_16x16x32_bf16 v[152:155], v[104:107], v[68:71], v[152:155]
    ds_read_b64_tr_b16 v[122:123], v52 offset:9216
    v_mfma_f32_16x16x32_bf16 v[148:151], v[100:103], v[68:71], v[148:151]
    ds_read_b64_tr_b16 v[124:125], v53 offset:8192
    v_mfma_f32_16x16x32_bf16 v[144:147], v[96:99], v[68:71], v[144:147]
    ds_read_b64_tr_b16 v[126:127], v53 offset:9216
    ds_read_b128 v[68:71], v49 offset:2048
    v_mfma_f32_16x16x32_bf16 v[160:163], v[96:99], v[72:75], v[160:163]
    v_mfma_f32_16x16x32_bf16 v[164:167], v[100:103], v[72:75], v[164:167]
    v_mfma_f32_16x16x32_bf16 v[168:171], v[104:107], v[72:75], v[168:171]
    v_mfma_f32_16x16x32_bf16 v[172:175], v[108:111], v[72:75], v[172:175]
    ds_read_b128 v[72:75], v49 offset:4096
    s_waitcnt lgkmcnt(15)
    v_mfma_f32_16x16x32_bf16 v[188:191], v[108:111], v[76:79], v[188:191]
    v_mfma_f32_16x16x32_bf16 v[184:187], v[104:107], v[76:79], v[184:187]
    v_mfma_f32_16x16x32_bf16 v[180:183], v[100:103], v[76:79], v[180:183]
    v_mfma_f32_16x16x32_bf16 v[176:179], v[96:99], v[76:79], v[176:179]
    ds_read_b128 v[76:79], v49 offset:6144
    s_waitcnt lgkmcnt(15)
    v_mfma_f32_16x16x32_bf16 v[192:195], v[96:99], v[80:83], v[192:195]
    v_mfma_f32_16x16x32_bf16 v[196:199], v[100:103], v[80:83], v[196:199]
    v_mfma_f32_16x16x32_bf16 v[200:203], v[104:107], v[80:83], v[200:203]
    v_mfma_f32_16x16x32_bf16 v[204:207], v[108:111], v[80:83], v[204:207]
    ds_read_b128 v[80:83], v49 offset:8192
    s_waitcnt lgkmcnt(15)
    v_mfma_f32_16x16x32_bf16 v[220:223], v[108:111], v[84:87], v[220:223]
    v_mfma_f32_16x16x32_bf16 v[216:219], v[104:107], v[84:87], v[216:219]
    v_mfma_f32_16x16x32_bf16 v[212:215], v[100:103], v[84:87], v[212:215]
    v_mfma_f32_16x16x32_bf16 v[208:211], v[96:99], v[84:87], v[208:211]
    ds_read_b128 v[84:87], v49 offset:10240
    s_waitcnt lgkmcnt(15)
    v_mfma_f32_16x16x32_bf16 v[224:227], v[96:99], v[88:91], v[224:227]
    v_mfma_f32_16x16x32_bf16 v[228:231], v[100:103], v[88:91], v[228:231]
    v_mfma_f32_16x16x32_bf16 v[232:235], v[104:107], v[88:91], v[232:235]
    v_mfma_f32_16x16x32_bf16 v[236:239], v[108:111], v[88:91], v[236:239]
    ds_read_b128 v[88:91], v49 offset:12288
    s_waitcnt lgkmcnt(15)
    v_mfma_f32_16x16x32_bf16 v[252:255], v[108:111], v[92:95], v[252:255]
    v_mfma_f32_16x16x32_bf16 v[248:251], v[104:107], v[92:95], v[248:251]
    v_mfma_f32_16x16x32_bf16 v[244:247], v[100:103], v[92:95], v[244:247]
    v_mfma_f32_16x16x32_bf16 v[240:243], v[96:99], v[92:95], v[240:243]
    ds_read_b128 v[92:95], v49 offset:14336
    s_waitcnt lgkmcnt(11)
    v_mfma_f32_16x16x32_bf16 v[128:131], v[112:115], v[64:67], v[128:131]
    v_mfma_f32_16x16x32_bf16 v[132:135], v[116:119], v[64:67], v[132:135]
    s_waitcnt lgkmcnt(9)
    v_mfma_f32_16x16x32_bf16 v[136:139], v[120:123], v[64:67], v[136:139]
    s_waitcnt lgkmcnt(7)
    v_mfma_f32_16x16x32_bf16 v[140:143], v[124:127], v[64:67], v[140:143]
    s_waitcnt lgkmcnt(6)
    v_mfma_f32_16x16x32_bf16 v[156:159], v[124:127], v[68:71], v[156:159]
    v_mfma_f32_16x16x32_bf16 v[152:155], v[120:123], v[68:71], v[152:155]
    v_mfma_f32_16x16x32_bf16 v[148:151], v[116:119], v[68:71], v[148:151]
    v_mfma_f32_16x16x32_bf16 v[144:147], v[112:115], v[68:71], v[144:147]
    v_xor_b32 v48, 0x10000, v48
    v_xor_b32 v49, 0x10000, v49
    v_xor_b32 v50, 0x10000, v50
    v_xor_b32 v51, 0x10000, v51
    v_xor_b32 v52, 0x10000, v52
    v_xor_b32 v53, 0x10000, v53
    s_waitcnt vmcnt(0) lgkmcnt(0)
    s_barrier
    ds_read_b128 v[64:67], v48 offset:0
    ds_read_b128 v[68:71], v48 offset:2048
    v_mfma_f32_16x16x32_bf16 v[160:163], v[112:115], v[72:75], v[160:163]
    ds_read_b64_tr_b16 v[96:97], v50 offset:0
    s_mov_b32 m0, s74
    s_add_u32 s74, s74, 16384
    s_bitset0_b32 s74, 17
    v_mfma_f32_16x16x32_bf16 v[164:167], v[116:119], v[72:75], v[164:167]
    ds_read_b64_tr_b16 v[98:99], v50 offset:1024
    buffer_load_dwordx4 v44, s[24:27], s71 offen offset:0 lds
    v_mfma_f32_16x16x32_bf16 v[168:171], v[120:123], v[72:75], v[168:171]
    ds_read_b64_tr_b16 v[100:101], v51 offset:0
    buffer_load_dwordx4 v45, s[24:27], s71 offen offset:1024 lds
    v_mfma_f32_16x16x32_bf16 v[172:175], v[124:127], v[72:75], v[172:175]
    ds_read_b64_tr_b16 v[102:103], v51 offset:1024
    buffer_load_dwordx4 v46, s[24:27], s71 offen offset:2048 lds
    ds_read_b128 v[72:75], v48 offset:4096
    v_mfma_f32_16x16x32_bf16 v[188:191], v[124:127], v[76:79], v[188:191]
    ds_read_b64_tr_b16 v[104:105], v52 offset:0
    buffer_load_dwordx4 v47, s[24:27], s71 offen offset:3072 lds
    v_mfma_f32_16x16x32_bf16 v[184:187], v[120:123], v[76:79], v[184:187]
    ds_read_b64_tr_b16 v[106:107], v52 offset:1024
    s_add_u32 s71, s71, 524288
    s_sub_u32 s75, s71, 5242880
    s_cselect_b32 s71, s71, s75
    v_mfma_f32_16x16x32_bf16 v[180:183], v[116:119], v[76:79], v[180:183]
    ds_read_b64_tr_b16 v[108:109], v53 offset:0
    s_mov_b32 m0, s74
    s_add_u32 s74, s74, 16384
    s_bitset0_b32 s74, 17
    v_mfma_f32_16x16x32_bf16 v[176:179], v[112:115], v[76:79], v[176:179]
    ds_read_b64_tr_b16 v[110:111], v53 offset:1024
    buffer_load_dwordx4 v44, s[24:27], s71 offen offset:0 lds
    ds_read_b128 v[76:79], v48 offset:6144
    v_mfma_f32_16x16x32_bf16 v[192:195], v[112:115], v[80:83], v[192:195]
    buffer_load_dwordx4 v45, s[24:27], s71 offen offset:1024 lds
    v_mfma_f32_16x16x32_bf16 v[196:199], v[116:119], v[80:83], v[196:199]
    buffer_load_dwordx4 v46, s[24:27], s71 offen offset:2048 lds
    v_mfma_f32_16x16x32_bf16 v[200:203], v[120:123], v[80:83], v[200:203]
    buffer_load_dwordx4 v47, s[24:27], s71 offen offset:3072 lds
    v_mfma_f32_16x16x32_bf16 v[204:207], v[124:127], v[80:83], v[204:207]
    s_add_u32 s71, s71, 524288
    s_sub_u32 s75, s71, 5242880
    s_cselect_b32 s71, s71, s75
    ds_read_b128 v[80:83], v48 offset:8192
    v_mfma_f32_16x16x32_bf16 v[220:223], v[124:127], v[84:87], v[220:223]
    s_mov_b32 m0, s74
    s_add_u32 s74, s74, 16384
    s_bitset0_b32 s74, 17
    v_mfma_f32_16x16x32_bf16 v[216:219], v[120:123], v[84:87], v[216:219]
    buffer_load_dwordx4 v44, s[24:27], s71 offen offset:0 lds
    v_mfma_f32_16x16x32_bf16 v[212:215], v[116:119], v[84:87], v[212:215]
    buffer_load_dwordx4 v45, s[24:27], s71 offen offset:1024 lds
    v_mfma_f32_16x16x32_bf16 v[208:211], v[112:115], v[84:87], v[208:211]
    buffer_load_dwordx4 v46, s[24:27], s71 offen offset:2048 lds
    ds_read_b128 v[84:87], v48 offset:10240
    v_mfma_f32_16x16x32_bf16 v[224:227], v[112:115], v[88:91], v[224:227]
    buffer_load_dwordx4 v47, s[24:27], s71 offen offset:3072 lds
    v_mfma_f32_16x16x32_bf16 v[228:231], v[116:119], v[88:91], v[228:231]
    s_add_u32 s71, s71, 524288
    s_sub_u32 s75, s71, 5242880
    s_cselect_b32 s71, s71, s75
    v_mfma_f32_16x16x32_bf16 v[232:235], v[120:123], v[88:91], v[232:235]
    s_mov_b32 m0, s74
    s_add_u32 s74, s74, 16384
    s_bitset0_b32 s74, 17
    v_mfma_f32_16x16x32_bf16 v[236:239], v[124:127], v[88:91], v[236:239]
    buffer_load_dwordx4 v44, s[24:27], s71 offen offset:0 lds
    ds_read_b128 v[88:91], v48 offset:12288
    v_mfma_f32_16x16x32_bf16 v[252:255], v[124:127], v[92:95], v[252:255]
    buffer_load_dwordx4 v45, s[24:27], s71 offen offset:1024 lds
    v_mfma_f32_16x16x32_bf16 v[248:251], v[120:123], v[92:95], v[248:251]
    buffer_load_dwordx4 v46, s[24:27], s71 offen offset:2048 lds
    v_mfma_f32_16x16x32_bf16 v[244:247], v[116:119], v[92:95], v[244:247]
    buffer_load_dwordx4 v47, s[24:27], s71 offen offset:3072 lds
    v_mfma_f32_16x16x32_bf16 v[240:243], v[112:115], v[92:95], v[240:243]
    s_add_u32 s71, s71, 524288
    s_sub_u32 s75, s71, 5242880
    s_cselect_b32 s71, s71, s75
    ds_read_b128 v[92:95], v48 offset:14336
    s_add_u32 s65, s65, 1
    s_cmp_lt_u32 s65, 8
    s_cbranch_scc1 L_kloopB
    s_waitcnt lgkmcnt(0)
    s_nop 7
    v_cvt_pk_bf16_f32 v128, v128, v129
    v_cvt_pk_bf16_f32 v129, v130, v131
    v_cvt_pk_bf16_f32 v130, v132, v133
    v_cvt_pk_bf16_f32 v131, v134, v135
    v_cvt_pk_bf16_f32 v132, v136, v137
    v_cvt_pk_bf16_f32 v133, v138, v139
    v_cvt_pk_bf16_f32 v134, v140, v141
    v_cvt_pk_bf16_f32 v135, v142, v143
    v_cvt_pk_bf16_f32 v136, v144, v145
    v_cvt_pk_bf16_f32 v137, v146, v147
    v_cvt_pk_bf16_f32 v138, v148, v149
    v_cvt_pk_bf16_f32 v139, v150, v151
    v_cvt_pk_bf16_f32 v140, v152, v153
    v_cvt_pk_bf16_f32 v141, v154, v155
    v_cvt_pk_bf16_f32 v142, v156, v157
    v_cvt_pk_bf16_f32 v143, v158, v159
    v_cvt_pk_bf16_f32 v144, v160, v161
    v_cvt_pk_bf16_f32 v145, v162, v163
    v_cvt_pk_bf16_f32 v146, v164, v165
    v_cvt_pk_bf16_f32 v147, v166, v167
    v_cvt_pk_bf16_f32 v148, v168, v169
    v_cvt_pk_bf16_f32 v149, v170, v171
    v_cvt_pk_bf16_f32 v150, v172, v173
    v_cvt_pk_bf16_f32 v151, v174, v175
    v_cvt_pk_bf16_f32 v152, v176, v177
    v_cvt_pk_bf16_f32 v153, v178, v179
    v_cvt_pk_bf16_f32 v154, v180, v181
    v_cvt_pk_bf16_f32 v155, v182, v183
    v_cvt_pk_bf16_f32 v156, v184, v185
    v_cvt_pk_bf16_f32 v157, v186, v187
    v_cvt_pk_bf16_f32 v158, v188, v189
    v_cvt_pk_bf16_f32 v159, v190, v191
    v_cvt_pk_bf16_f32 v160, v192, v193
    v_cvt_pk_bf16_f32 v161, v194, v195
    v_cvt_pk_bf16_f32 v162, v196, v197
    v_cvt_pk_bf16_f32 v163, v198, v199
    v_cvt_pk_bf16_f32 v164, v200, v201
    v_cvt_pk_bf16_f32 v165, v202, v203
    v_cvt_pk_bf16_f32 v166, v204, v205
    v_cvt_pk_bf16_f32 v167, v206, v207
    v_cvt_pk_bf16_f32 v168, v208, v209
    v_cvt_pk_bf16_f32 v169, v210, v211
    v_cvt_pk_bf16_f32 v170, v212, v213
    v_cvt_pk_bf16_f32 v171, v214, v215
    v_cvt_pk_bf16_f32 v172, v216, v217
    v_cvt_pk_bf16_f32 v173, v218, v219
    v_cvt_pk_bf16_f32 v174, v220, v221
    v_cvt_pk_bf16_f32 v175, v222, v223
    v_cvt_pk_bf16_f32 v176, v224, v225
    v_cvt_pk_bf16_f32 v177, v226, v227
    v_cvt_pk_bf16_f32 v178, v228, v229
    v_cvt_pk_bf16_f32 v179, v230, v231
    v_cvt_pk_bf16_f32 v180, v232, v233
    v_cvt_pk_bf16_f32 v181, v234, v235
    v_cvt_pk_bf16_f32 v182, v236, v237
    v_cvt_pk_bf16_f32 v183, v238, v239
    v_cvt_pk_bf16_f32 v184, v240, v241
    v_cvt_pk_bf16_f32 v185, v242, v243
    v_cvt_pk_bf16_f32 v186, v244, v245
    v_cvt_pk_bf16_f32 v187, v246, v247
    v_cvt_pk_bf16_f32 v188, v248, v249
    v_cvt_pk_bf16_f32 v189, v250, v251
    v_cvt_pk_bf16_f32 v190, v252, v253
    v_cvt_pk_bf16_f32 v191, v254, v255
    s_waitcnt vmcnt(16)
    s_branch L_q
L_hook:
    s_cmp_eq_u32 s65, 1
    s_cbranch_scc1 L_hook1
    s_cmp_eq_u32 s65, 2
    s_cbranch_scc1 L_hook2
    s_cmp_eq_u32 s65, 4
    s_cbranch_scc1 L_hook4
    s_cmp_eq_u32 s65, 6
    s_cbranch_scc1 L_hook6
    s_cmp_lg_u32 s65, 7
    s_cbranch_scc1 L_hook_back
    buffer_load_dwordx4 v[16:19], v13, s[8:11], s84 offen offset:0 sc1
    buffer_load_dwordx4 v[20:23], v12, s[8:11], s84 offen offset:0 sc1
    buffer_load_dwordx4 v[24:27], v13, s[8:11], s84 offen offset:1024 sc1
    buffer_load_dwordx4 v[28:31], v12, s[8:11], s84 offen offset:1024 sc1
    buffer_load_dwordx4 v[32:35], v13, s[8:11], s84 offen offset:2048 sc1
    buffer_load_dwordx4 v[36:39], v12, s[8:11], s84 offen offset:2048 sc1
    s_branch L_hook_back
L_hook1:
    s_cmp_ge_u32 s76, 2
    s_cbranch_scc1 L_tch_1a
    s_and_b32 s6, s4, 3
    s_lshl_b32 s6, s6, 19
    s_lshl_b32 s7, s5, 15
    s_add_u32 s6, s6, s7
    s_lshl_b32 s7, s76, 7
    s_add_u32 s6, s6, s7
    s_add_u32 s6, s6, 512
    v_lshrrev_b32 v6, 1, v1
    v_lshlrev_b32 v6, 10, v6
    v_and_b32 v7, 1, v1
    v_lshl_add_u32 v6, v7, 6, v6
    buffer_load_dword v11, v6, s[12:15], s6 offen
    s_add_u32 s6, s6, 262144
    buffer_load_dword v11, v6, s[12:15], s6 offen
    s_branch L_tch_1c
L_tch_1a:
    v_lshrrev_b32 v6, 5, v1
    v_lshlrev_b32 v6, 6, v6
    v_bfe_u32 v7, v1, 2, 3
    v_add_u32 v6, v6, v7
    v_lshlrev_b32 v6, 13, v6
    v_and_b32 v7, 3, v1
    v_lshl_add_u32 v6, v7, 6, v6
    s_lshl_b32 s6, s4, 8
    s_lshl_b32 s7, s5, 16
    s_add_u32 s6, s6, s7
    s_add_u32 s6, s6, 2097152
    s_cmp_lg_u32 s76, 2
    s_cbranch_scc1 L_tch_1b
    buffer_load_dword v11, v6, s[16:19], s6 offen nt
    s_branch L_tch_1c
L_tch_1b:
    buffer_load_dword v11, v6, s[20:23], s6 offen nt
L_tch_1c:
    s_branch L_hook_back
L_hook2:
    s_lshr_b32 s72, s2, 1
    s_mul_i32 s72, s72, 20480
    s_and_b32 s7, s2, 1
    s_lshl_b32 s7, s7, 7
    s_add_u32 s72, s72, s7
    v_add_u32 v2, -256, v0
    v_lshrrev_b32 v3, 3, v2
    v_and_b32 v4, 7, v2
    v_mul_u32_u24 v5, 1280, v4
    v_lshl_add_u32 v5, v3, 4, v5
    v_add_u32 v5, 131072, v5
    ds_read_b128 v[16:19], v5
    v_lshlrev_b32 v5, 8, v3
    v_lshl_add_u32 v6, v4, 4, v5
    v_add_u32 v2, 0, v0
    v_lshrrev_b32 v3, 3, v2
    v_and_b32 v4, 7, v2
    v_mul_u32_u24 v5, 1280, v4
    v_lshl_add_u32 v5, v3, 4, v5
    v_add_u32 v5, 131072, v5
    ds_read_b128 v[24:27], v5
    v_lshlrev_b32 v5, 8, v3
    v_lshl_add_u32 v7, v4, 4, v5
    v_add_u32 v2, 256, v0
    v_lshrrev_b32 v3, 3, v2
    v_and_b32 v4, 7, v2
    v_mul_u32_u24 v5, 1280, v4
    v_lshl_add_u32 v5, v3, 4, v5
    v_add_u32 v5, 131072, v5
    ds_read_b128 v[32:35], v5
    v_lshlrev_b32 v5, 8, v3
    v_lshl_add_u32 v8, v4, 4, v5
    s_waitcnt lgkmcnt(0)
    buffer_store_dwordx4 v[16:19], v6, s[8:11], s72 offen sc1
    buffer_store_dwordx4 v[24:27], v7, s[8:11], s72 offen sc1
    s_cmp_ge_u32 s3, 6
    s_cbranch_scc1 L_lns
    buffer_store_dwordx4 v[32:35], v8, s[8:11], s72 offen sc1
L_lns:
    s_cmp_lt_u32 s3, 6
    s_cbranch_scc1 L_zd
    v_mov_b64 v[36:37], 0
    v_mov_b64 v[38:39], 0
    v_lshrrev_b32 v2, 3, v1
    s_cmp_eq_u32 s3, 6
    s_cbranch_scc1 L_z6
    s_lshl_b32 s6, s5, 2
    s_sub_u32 s7, 56, s6
    v_mov_b32 v3, s6
    v_mov_b32 v4, s7
    v_cmp_gt_u32 vcc, 4, v2
    s_lshl_b32 s6, s4, 7
    s_add_u32 s6, s6, 3932160
    v_cndmask_b32 v3, v4, v3, vcc
    v_add_u32 v3, v3, v2
    v_lshl_add_u32 v3, v3, 12, s6
    s_branch L_z7
L_z6:
    v_mov_b32 v3, 0x5000000
    s_lshl_b32 s6, s4, 3
    s_add_u32 s6, s6, s5
    s_lshl_b32 s6, s6, 5
    s_add_u32 s6, s6, s3
    s_lshl_b32 s6, s6, 2
    s_add_u32 s6, s6, 3866624
    s_andn2_b32 s6, s6, 127
    v_cmp_eq_u32 vcc, 0, v2
    v_mov_b32 v4, s6
    s_nop 0
    v_cndmask_b32 v3, v3, v4, vcc
    s_lshl_b32 s6, s61, 5
    s_add_u32 s6, s6, s3
    s_lshl_b32 s6, s6, 2
    s_add_u32 s6, s6, 15859712
    s_andn2_b32 s6, s6, 127
    v_cmp_eq_u32 vcc, 1, v2
    v_mov_b32 v4, s6
    s_nop 0
    v_cndmask_b32 v3, v3, v4, vcc
    s_lshl_b32 s6, s5, 5
    s_add_u32 s6, s6, s4
    s_lshl_b32 s6, s6, 5
    s_add_u32 s6, s6, s3
    s_lshl_b32 s6, s6, 2
    s_add_u32 s6, s6, 3899392
    s_andn2_b32 s6, s6, 127
    v_cmp_eq_u32 vcc, 2, v2
    v_mov_b32 v4, s6
    s_nop 0
    v_cndmask_b32 v3, v3, v4, vcc
    s_and_b32 s6, s4, 7
    s_lshl_b32 s7, s5, 3
    s_add_u32 s6, s6, s7
    s_lshr_b32 s7, s4, 3
    s_add_u32 s7, s7, 0
    s_add_u32 s7, s7, 1
    s_and_b32 s7, s7, 3
    s_lshl_b32 s6, s6, 2
    s_add_u32 s6, s6, s7
    s_mul_i32 s6, s6, 3
    s_add_u32 s6, s6, 0
    s_lshl_b32 s6, s6, 5
    s_add_u32 s6, s6, s3
    s_lshl_b32 s6, s6, 2
    s_add_u32 s6, s6, 15728640
    s_andn2_b32 s6, s6, 127
    v_cmp_eq_u32 vcc, 3, v2
    v_mov_b32 v4, s6
    s_nop 0
    v_cndmask_b32 v3, v3, v4, vcc
    s_and_b32 s6, s4, 7
    s_lshl_b32 s7, s5, 3
    s_add_u32 s6, s6, s7
    s_lshr_b32 s7, s4, 3
    s_add_u32 s7, s7, 1
    s_add_u32 s7, s7, 1
    s_and_b32 s7, s7, 3
    s_lshl_b32 s6, s6, 2
    s_add_u32 s6, s6, s7
    s_mul_i32 s6, s6, 3
    s_add_u32 s6, s6, 1
    s_lshl_b32 s6, s6, 5
    s_add_u32 s6, s6, s3
    s_lshl_b32 s6, s6, 2
    s_add_u32 s6, s6, 15728640
    s_andn2_b32 s6, s6, 127
    v_cmp_eq_u32 vcc, 4, v2
    v_mov_b32 v4, s6
    s_nop 0
    v_cndmask_b32 v3, v3, v4, vcc
    s_and_b32 s6, s4, 7
    s_lshl_b32 s7, s5, 3
    s_add_u32 s6, s6, s7
    s_lshr_b32 s7, s4, 3
    s_add_u32 s7, s7, 2
    s_add_u32 s7, s7, 1
    s_and_b32 s7, s7, 3
    s_lshl_b32 s6, s6, 2
    s_add_u32 s6, s6, s7
    s_mul_i32 s6, s6, 3
    s_add_u32 s6, s6, 2
    s_lshl_b32 s6, s6, 5
    s_add_u32 s6, s6, s3
    s_lshl_b32 s6, s6, 2
    s_add_u32 s6, s6, 15728640
    s_andn2_b32 s6, s6, 127
    v_cmp_eq_u32 vcc, 5, v2
    v_mov_b32 v4, s6
    s_nop 0
    v_cndmask_b32 v3, v3, v4, vcc
    s_mov_b32 s6, 0x5000000
    s_cmp_eq_u32 s2, 31
    s_cmov_b32 s6, 3801088
    s_andn2_b32 s6, s6, 127
    v_cmp_eq_u32 vcc, 6, v2
    v_mov_b32 v4, s6
    s_nop 0
    v_cndmask_b32 v3, v3, v4, vcc
    s_lshl_b32 s6, s2, 7
    s_add_u32 s6, s6, 2621440
    s_andn2_b32 s6, s6, 127
    v_cmp_eq_u32 vcc, 7, v2
    v_mov_b32 v4, s6
    s_nop 0
    v_cndmask_b32 v3, v3, v4, vcc
    v_add_u32 v4, 160896, v13
    s_mov_b32 exec_lo, 0
    s_mov_b32 exec_hi, 0x03000000
    ds_read_b128 v[36:39], v4
    s_mov_b64 exec, -1
    s_waitcnt lgkmcnt(0)
L_z7:
    v_and_b32 v2, 7, v1
    v_lshl_add_u32 v3, v2, 4, v3
    buffer_store_dwordx4 v[36:39], v3, s[8:11], 0 offen sc1
L_zd:
    s_cmp_ge_u32 s76, 2
    s_cbranch_scc1 L_tch_2a
    s_and_b32 s6, s4, 3
    s_lshl_b32 s6, s6, 19
    s_lshl_b32 s7, s5, 15
    s_add_u32 s6, s6, s7
    s_lshl_b32 s7, s76, 7
    s_add_u32 s6, s6, s7
    s_add_u32 s6, s6, 768
    v_lshrrev_b32 v6, 1, v1
    v_lshlrev_b32 v6, 10, v6
    v_and_b32 v7, 1, v1
    v_lshl_add_u32 v6, v7, 6, v6
    buffer_load_dword v11, v6, s[12:15], s6 offen
    s_add_u32 s6, s6, 262144
    buffer_load_dword v11, v6, s[12:15], s6 offen
    s_branch L_tch_2c
L_tch_2a:
    v_lshrrev_b32 v6, 5, v1
    v_lshlrev_b32 v6, 6, v6
    v_bfe_u32 v7, v1, 2, 3
    v_add_u32 v6, v6, v7
    v_lshlrev_b32 v6, 13, v6
    v_and_b32 v7, 3, v1
    v_lshl_add_u32 v6, v7, 6, v6
    s_lshl_b32 s6, s4, 8
    s_lshl_b32 s7, s5, 16
    s_add_u32 s6, s6, s7
    s_add_u32 s6, s6, 3145728
    s_cmp_lg_u32 s76, 2
    s_cbranch_scc1 L_tch_2b
    buffer_load_dword v11, v6, s[16:19], s6 offen nt
    s_branch L_tch_2c
L_tch_2b:
    buffer_load_dword v11, v6, s[20:23], s6 offen nt
L_tch_2c:
    s_branch L_hook_back
L_hook4:
    s_cmp_lg_u32 s3, 4
    s_cbranch_scc1 L_hook4b
    s_mov_b32 s28, s56
    s_mov_b32 s29, s57
    s_mov_b32 s30, 0x100
    s_mov_b32 s31, 0x20000
    v_mov_b32 v2, 1
    v_lshlrev_b32 v3, 8, v1
    s_and_b32 s6, s2, 31
    s_lshl_b32 s6, s6, 2
    buffer_atomic_add v2, v3, s[28:31], s6 offen offset:0 sc1
L_hook4b:
    s_lshl_b32 s74, s76, 12
    s_add_u32 s74, s74, 131072
    s_mov_b32 m0, s74
    s_add_u32 s74, s74, 16384
    buffer_load_dwordx4 v44, s[24:27], s71 offen offset:0 lds
    buffer_load_dwordx4 v45, s[24:27], s71 offen offset:1024 lds
    buffer_load_dwordx4 v46, s[24:27], s71 offen offset:2048 lds
    buffer_load_dwordx4 v47, s[24:27], s71 offen offset:3072 lds
    s_add_u32 s71, s71, 524288
    s_sub_u32 s75, s71, 5242880
    s_cselect_b32 s71, s71, s75
    s_mov_b32 m0, s74
    s_add_u32 s74, s74, 16384
    buffer_load_dwordx4 v44, s[24:27], s71 offen offset:0 lds
    buffer_load_dwordx4 v45, s[24:27], s71 offen offset:1024 lds
    buffer_load_dwordx4 v46, s[24:27], s71 offen offset:2048 lds
    buffer_load_dwordx4 v47, s[24:27], s71 offen offset:3072 lds
    s_add_u32 s71, s71, 524288
    s_sub_u32 s75, s71, 5242880
    s_cselect_b32 s71, s71, s75
    s_branch L_hook_back
L_hook6:
    s_cmp_lg_u32 s3, 5
    s_cbranch_scc1 L_hook_back
    s_mov_b32 s28, s56
    s_mov_b32 s29, s57
    s_mov_b32 s30, 0x100
    s_mov_b32 s31, 0x20000
    v_and_b32 v3, 31, v1
    v_lshlrev_b32 v3, 2, v3
    buffer_load_dword v62, v3, s[28:31], 0 offen offset:0 sc1
    s_branch L_hook_back
L_vpre:
    s_waitcnt vmcnt(0)
    s_lshl_b32 s6, s65, 4
    s_add_u32 s6, s6, s3
    s_cmp_lg_u32 s6, 0x65
    s_cbranch_scc1 L_vnow
    v_cmp_gt_u32 vcc, 8, v62
    s_cbranch_vccz L_cntok_3
    s_mov_b32 s28, s56
    s_mov_b32 s29, s57
    s_mov_b32 s30, 0x100
    s_mov_b32 s31, 0x20000
    v_and_b32 v3, 31, v1
    v_lshlrev_b32 v3, 2, v3
    s_mov_b32 s79, 262144
L_poll_4:
    buffer_load_dword v2, v3, s[28:31], 0 offen offset:0 sc1
    s_waitcnt vmcnt(0)
    v_cmp_gt_u32 vcc, 8, v2
    s_cbranch_vccz L_polldone_5
    s_sleep 8
    s_sub_u32 s79, s79, 1
    s_cmp_lg_u32 s79, 0
    s_cbranch_scc1 L_poll_4
L_polldone_5:
L_cntok_3:
    s_branch L_vnow
L_khook:
    s_cmp_lg_u32 s65, 7
    s_cbranch_scc1 L_khook_back
    buffer_load_dwordx4 v[16:19], v13, s[8:11], s84 offen offset:0 sc1
    buffer_load_dwordx4 v[20:23], v12, s[8:11], s84 offen offset:0 sc1
    buffer_load_dwordx4 v[24:27], v13, s[8:11], s84 offen offset:1024 sc1
    buffer_load_dwordx4 v[28:31], v12, s[8:11], s84 offen offset:1024 sc1
    buffer_load_dwordx4 v[32:35], v13, s[8:11], s84 offen offset:2048 sc1
    buffer_load_dwordx4 v[36:39], v12, s[8:11], s84 offen offset:2048 sc1
    s_branch L_khook_back
L_kv_v:
    ds_read_b128 v[64:67], v48 offset:0
    ds_read_b128 v[68:71], v48 offset:2048
    ds_read_b64_tr_b16 v[96:97], v50 offset:0
    ds_read_b64_tr_b16 v[98:99], v50 offset:1024
    ds_read_b64_tr_b16 v[100:101], v51 offset:0
    ds_read_b64_tr_b16 v[102:103], v51 offset:1024
    ds_read_b128 v[72:75], v48 offset:4096
    ds_read_b64_tr_b16 v[104:105], v52 offset:0
    ds_read_b64_tr_b16 v[106:107], v52 offset:1024
    ds_read_b64_tr_b16 v[108:109], v53 offset:0
    ds_read_b64_tr_b16 v[110:111], v53 offset:1024
    ds_read_b128 v[76:79], v48 offset:6144
    ds_read_b128 v[80:83], v48 offset:8192
    ds_read_b128 v[84:87], v48 offset:10240
    ds_read_b128 v[88:91], v48 offset:12288
    ds_read_b128 v[92:95], v48 offset:14336
    s_cmp_ge_u32 s76, 2
    s_cbranch_scc1 L_tch_6a
    s_and_b32 s6, s4, 3
    s_lshl_b32 s6, s6, 19
    s_lshl_b32 s7, s5, 15
    s_add_u32 s6, s6, s7
    s_lshl_b32 s7, s76, 7
    s_add_u32 s6, s6, s7
    s_add_u32 s6, s6, 256
    v_lshrrev_b32 v6, 1, v1
    v_lshlrev_b32 v6, 10, v6
    v_and_b32 v7, 1, v1
    v_lshl_add_u32 v6, v7, 6, v6
    buffer_load_dword v11, v6, s[12:15], s6 offen
    s_add_u32 s6, s6, 262144
    buffer_load_dword v11, v6, s[12:15], s6 offen
    s_branch L_tch_6c
L_tch_6a:
    v_lshrrev_b32 v6, 5, v1
    v_lshlrev_b32 v6, 6, v6
    v_bfe_u32 v7, v1, 2, 3
    v_add_u32 v6, v6, v7
    v_lshlrev_b32 v6, 13, v6
    v_and_b32 v7, 3, v1
    v_lshl_add_u32 v6, v7, 6, v6
    s_lshl_b32 s6, s4, 8
    s_lshl_b32 s7, s5, 16
    s_add_u32 s6, s6, s7
    s_add_u32 s6, s6, 1048576
    s_cmp_lg_u32 s76, 2
    s_cbranch_scc1 L_tch_6b
    buffer_load_dword v11, v6, s[16:19], s6 offen nt
    s_branch L_tch_6c
L_tch_6b:
    buffer_load_dword v11, v6, s[20:23], s6 offen nt
L_tch_6c:
.p2align 4
L_vloop:
    s_bitcmp1_b32 214, s65
    s_cbranch_scc1 L_hook
L_hook_back:
    s_waitcnt lgkmcnt(12)
    v_mfma_f32_16x16x32_bf16 v[128:131], v[64:67], v[96:99], v[128:131]
    ds_read_b64_tr_b16 v[112:113], v50 offset:8192
    s_waitcnt lgkmcnt(11)
    v_mfma_f32_16x16x32_bf16 v[132:135], v[64:67], v[100:103], v[132:135]
    ds_read_b64_tr_b16 v[114:115], v50 offset:9216
    s_waitcnt lgkmcnt(9)
    v_mfma_f32_16x16x32_bf16 v[136:139], v[64:67], v[104:107], v[136:139]
    ds_read_b64_tr_b16 v[116:117], v51 offset:8192
    s_waitcnt lgkmcnt(8)
    v_mfma_f32_16x16x32_bf16 v[140:143], v[64:67], v[108:111], v[140:143]
    ds_read_b64_tr_b16 v[118:119], v51 offset:9216
    ds_read_b128 v[64:67], v49 offset:0
    v_mfma_f32_16x16x32_bf16 v[156:159], v[68:71], v[108:111], v[156:159]
    ds_read_b64_tr_b16 v[120:121], v52 offset:8192
    v_mfma_f32_16x16x32_bf16 v[152:155], v[68:71], v[104:107], v[152:155]
    ds_read_b64_tr_b16 v[122:123], v52 offset:9216
    v_mfma_f32_16x16x32_bf16 v[148:151], v[68:71], v[100:103], v[148:151]
    ds_read_b64_tr_b16 v[124:125], v53 offset:8192
    v_mfma_f32_16x16x32_bf16 v[144:147], v[68:71], v[96:99], v[144:147]
    ds_read_b64_tr_b16 v[126:127], v53 offset:9216
    ds_read_b128 v[68:71], v49 offset:2048
    v_mfma_f32_16x16x32_bf16 v[160:163], v[72:75], v[96:99], v[160:163]
    v_mfma_f32_16x16x32_bf16 v[164:167], v[72:75], v[100:103], v[164:167]
    v_mfma_f32_16x16x32_bf16 v[168:171], v[72:75], v[104:107], v[168:171]
    v_mfma_f32_16x16x32_bf16 v[172:175], v[72:75], v[108:111], v[172:175]
    ds_read_b128 v[72:75], v49 offset:4096
    s_waitcnt lgkmcnt(15)
    v_mfma_f32_16x16x32_bf16 v[188:191], v[76:79], v[108:111], v[188:191]
    v_mfma_f32_16x16x32_bf16 v[184:187], v[76:79], v[104:107], v[184:187]
    v_mfma_f32_16x16x32_bf16 v[180:183], v[76:79], v[100:103], v[180:183]
    v_mfma_f32_16x16x32_bf16 v[176:179], v[76:79], v[96:99], v[176:179]
    ds_read_b128 v[76:79], v49 offset:6144
    s_waitcnt lgkmcnt(15)
    v_mfma_f32_16x16x32_bf16 v[192:195], v[80:83], v[96:99], v[192:195]
    v_mfma_f32_16x16x32_bf16 v[196:199], v[80:83], v[100:103], v[196:199]
    v_mfma_f32_16x16x32_bf16 v[200:203], v[80:83], v[104:107], v[200:203]
    v_mfma_f32_16x16x32_bf16 v[204:207], v[80:83], v[108:111], v[204:207]
    ds_read_b128 v[80:83], v49 offset:8192
    s_waitcnt lgkmcnt(15)
    v_mfma_f32_16x16x32_bf16 v[220:223], v[84:87], v[108:111], v[220:223]
    v_mfma_f32_16x16x32_bf16 v[216:219], v[84:87], v[104:107], v[216:219]
    v_mfma_f32_16x16x32_bf16 v[212:215], v[84:87], v[100:103], v[212:215]
    v_mfma_f32_16x16x32_bf16 v[208:211], v[84:87], v[96:99], v[208:211]
    ds_read_b128 v[84:87], v49 offset:10240
    s_waitcnt lgkmcnt(15)
    v_mfma_f32_16x16x32_bf16 v[224:227], v[88:91], v[96:99], v[224:227]
    v_mfma_f32_16x16x32_bf16 v[228:231], v[88:91], v[100:103], v[228:231]
    v_mfma_f32_16x16x32_bf16 v[232:235], v[88:91], v[104:107], v[232:235]
    v_mfma_f32_16x16x32_bf16 v[236:239], v[88:91], v[108:111], v[236:239]
    ds_read_b128 v[88:91], v49 offset:12288
    s_waitcnt lgkmcnt(15)
    v_mfma_f32_16x16x32_bf16 v[252:255], v[92:95], v[108:111], v[252:255]
    v_mfma_f32_16x16x32_bf16 v[248:251], v[92:95], v[104:107], v[248:251]
    v_mfma_f32_16x16x32_bf16 v[244:247], v[92:95], v[100:103], v[244:247]
    v_mfma_f32_16x16x32_bf16 v[240:243], v[92:95], v[96:99], v[240:243]
    ds_read_b128 v[92:95], v49 offset:14336
    s_waitcnt lgkmcnt(11)
    v_mfma_f32_16x16x32_bf16 v[128:131], v[64:67], v[112:115], v[128:131]
    v_mfma_f32_16x16x32_bf16 v[132:135], v[64:67], v[116:119], v[132:135]
    s_waitcnt lgkmcnt(9)
    v_mfma_f32_16x16x32_bf16 v[136:139], v[64:67], v[120:123], v[136:139]
    s_waitcnt lgkmcnt(7)
    v_mfma_f32_16x16x32_bf16 v[140:143], v[64:67], v[124:127], v[140:143]
    s_waitcnt lgkmcnt(6)
    v_mfma_f32_16x16x32_bf16 v[156:159], v[68:71], v[124:127], v[156:159]
    v_mfma_f32_16x16x32_bf16 v[152:155], v[68:71], v[120:123], v[152:155]
    v_mfma_f32_16x16x32_bf16 v[148:151], v[68:71], v[116:119], v[148:151]
    v_mfma_f32_16x16x32_bf16 v[144:147], v[68:71], v[112:115], v[144:147]
    v_xor_b32 v48, 0x10000, v48
    v_xor_b32 v49, 0x10000, v49
    v_xor_b32 v50, 0x10000, v50
    v_xor_b32 v51, 0x10000, v51
    v_xor_b32 v52, 0x10000, v52
    v_xor_b32 v53, 0x10000, v53
    s_bitcmp1_b32 0x48, s65
    s_cbranch_scc1 L_vpre
L_vnow:
    s_waitcnt lgkmcnt(0)
    s_barrier
    ds_read_b128 v[64:67], v48 offset:0
    ds_read_b128 v[68:71], v48 offset:2048
    v_mfma_f32_16x16x32_bf16 v[160:163], v[72:75], v[112:115], v[160:163]
    ds_read_b64_tr_b16 v[96:97], v50 offset:0
    v_mfma_f32_16x16x32_bf16 v[164:167], v[72:75], v[116:119], v[164:167]
    ds_read_b64_tr_b16 v[98:99], v50 offset:1024
    v_mfma_f32_16x16x32_bf16 v[168:171], v[72:75], v[120:123], v[168:171]
    ds_read_b64_tr_b16 v[100:101], v51 offset:0
    v_mfma_f32_16x16x32_bf16 v[172:175], v[72:75], v[124:127], v[172:175]
    ds_read_b64_tr_b16 v[102:103], v51 offset:1024
    ds_read_b128 v[72:75], v48 offset:4096
    v_mfma_f32_16x16x32_bf16 v[188:191], v[76:79], v[124:127], v[188:191]
    ds_read_b64_tr_b16 v[104:105], v52 offset:0
    v_mfma_f32_16x16x32_bf16 v[184:187], v[76:79], v[120:123], v[184:187]
    ds_read_b64_tr_b16 v[106:107], v52 offset:1024
    v_mfma_f32_16x16x32_bf16 v[180:183], v[76:79], v[116:119], v[180:183]
    ds_read_b64_tr_b16 v[108:109], v53 offset:0
    v_mfma_f32_16x16x32_bf16 v[176:179], v[76:79], v[112:115], v[176:179]
    ds_read_b64_tr_b16 v[110:111], v53 offset:1024
    ds_read_b128 v[76:79], v48 offset:6144
    v_mfma_f32_16x16x32_bf16 v[192:195], v[80:83], v[112:115], v[192:195]
    v_mfma_f32_16x16x32_bf16 v[196:199], v[80:83], v[116:119], v[196:199]
    v_mfma_f32_16x16x32_bf16 v[200:203], v[80:83], v[120:123], v[200:203]
    v_mfma_f32_16x16x32_bf16 v[204:207], v[80:83], v[124:127], v[204:207]
    ds_read_b128 v[80:83], v48 offset:8192
    v_mfma_f32_16x16x32_bf16 v[220:223], v[84:87], v[124:127], v[220:223]
    v_mfma_f32_16x16x32_bf16 v[216:219], v[84:87], v[120:123], v[216:219]
    v_mfma_f32_16x16x32_bf16 v[212:215], v[84:87], v[116:119], v[212:215]
    v_mfma_f32_16x16x32_bf16 v[208:211], v[84:87], v[112:115], v[208:211]
    ds_read_b128 v[84:87], v48 offset:10240
    v_mfma_f32_16x16x32_bf16 v[224:227], v[88:91], v[112:115], v[224:227]
    v_mfma_f32_16x16x32_bf16 v[228:231], v[88:91], v[116:119], v[228:231]
    v_mfma_f32_16x16x32_bf16 v[232:235], v[88:91], v[120:123], v[232:235]
    v_mfma_f32_16x16x32_bf16 v[236:239], v[88:91], v[124:127], v[236:239]
    ds_read_b128 v[88:91], v48 offset:12288
    v_mfma_f32_16x16x32_bf16 v[252:255], v[92:95], v[124:127], v[252:255]
    v_mfma_f32_16x16x32_bf16 v[248:251], v[92:95], v[120:123], v[248:251]
    v_mfma_f32_16x16x32_bf16 v[244:247], v[92:95], v[116:119], v[244:247]
    v_mfma_f32_16x16x32_bf16 v[240:243], v[92:95], v[112:115], v[240:243]
    ds_read_b128 v[92:95], v48 offset:14336
    s_add_u32 s65, s65, 1
    s_cmp_lt_u32 s65, 8
    s_cbranch_scc1 L_vloop
    s_waitcnt lgkmcnt(0)
    s_nop 7
    v_cvt_pk_bf16_f32 v128, v128, v129
    v_cvt_pk_bf16_f32 v129, v130, v131
    v_cvt_pk_bf16_f32 v130, v144, v145
    v_cvt_pk_bf16_f32 v131, v146, v147
    v_cvt_pk_bf16_f32 v132, v132, v133
    v_cvt_pk_bf16_f32 v133, v134, v135
    v_cvt_pk_bf16_f32 v134, v148, v149
    v_cvt_pk_bf16_f32 v135, v150, v151
    v_cvt_pk_bf16_f32 v136, v136, v137
    v_cvt_pk_bf16_f32 v137, v138, v139
    v_cvt_pk_bf16_f32 v138, v152, v153
    v_cvt_pk_bf16_f32 v139, v154, v155
    v_cvt_pk_bf16_f32 v140, v140, v141
    v_cvt_pk_bf16_f32 v141, v142, v143
    v_cvt_pk_bf16_f32 v142, v156, v157
    v_cvt_pk_bf16_f32 v143, v158, v159
    v_cvt_pk_bf16_f32 v144, v160, v161
    v_cvt_pk_bf16_f32 v145, v162, v163
    v_cvt_pk_bf16_f32 v146, v176, v177
    v_cvt_pk_bf16_f32 v147, v178, v179
    v_cvt_pk_bf16_f32 v148, v164, v165
    v_cvt_pk_bf16_f32 v149, v166, v167
    v_cvt_pk_bf16_f32 v150, v180, v181
    v_cvt_pk_bf16_f32 v151, v182, v183
    v_cvt_pk_bf16_f32 v152, v168, v169
    v_cvt_pk_bf16_f32 v153, v170, v171
    v_cvt_pk_bf16_f32 v154, v184, v185
    v_cvt_pk_bf16_f32 v155, v186, v187
    v_cvt_pk_bf16_f32 v156, v172, v173
    v_cvt_pk_bf16_f32 v157, v174, v175
    v_cvt_pk_bf16_f32 v158, v188, v189
    v_cvt_pk_bf16_f32 v159, v190, v191
    v_cvt_pk_bf16_f32 v160, v192, v193
    v_cvt_pk_bf16_f32 v161, v194, v195
    v_cvt_pk_bf16_f32 v162, v208, v209
    v_cvt_pk_bf16_f32 v163, v210, v211
    v_cvt_pk_bf16_f32 v164, v196, v197
    v_cvt_pk_bf16_f32 v165, v198, v199
    v_cvt_pk_bf16_f32 v166, v212, v213
    v_cvt_pk_bf16_f32 v167, v214, v215
    v_cvt_pk_bf16_f32 v168, v200, v201
    v_cvt_pk_bf16_f32 v169, v202, v203
    v_cvt_pk_bf16_f32 v170, v216, v217
    v_cvt_pk_bf16_f32 v171, v218, v219
    v_cvt_pk_bf16_f32 v172, v204, v205
    v_cvt_pk_bf16_f32 v173, v206, v207
    v_cvt_pk_bf16_f32 v174, v220, v221
    v_cvt_pk_bf16_f32 v175, v222, v223
    v_cvt_pk_bf16_f32 v176, v224, v225
    v_cvt_pk_bf16_f32 v177, v226, v227
    v_cvt_pk_bf16_f32 v178, v240, v241
    v_cvt_pk_bf16_f32 v179, v242, v243
    v_cvt_pk_bf16_f32 v180, v228, v229
    v_cvt_pk_bf16_f32 v181, v230, v231
    v_cvt_pk_bf16_f32 v182, v244, v245
    v_cvt_pk_bf16_f32 v183, v246, v247
    v_cvt_pk_bf16_f32 v184, v232, v233
    v_cvt_pk_bf16_f32 v185, v234, v235
    v_cvt_pk_bf16_f32 v186, v248, v249
    v_cvt_pk_bf16_f32 v187, v250, v251
    v_cvt_pk_bf16_f32 v188, v236, v237
    v_cvt_pk_bf16_f32 v189, v238, v239
    v_cvt_pk_bf16_f32 v190, v252, v253
    v_cvt_pk_bf16_f32 v191, v254, v255
    s_waitcnt vmcnt(0)
L_q:
    s_mov_b32 s28, s56
    s_mov_b32 s29, s57
    s_mov_b32 s30, 0x100
    s_mov_b32 s31, 0x20000
    s_lshl_b32 s6, s76, 13
    v_add_u32 v49, s6, v13
    s_lshl_b32 s6, s76, 12
    v_add_u32 v50, s6, v13
    s_lshl_b32 s77, s4, 20
    s_add_u32 s77, s77, 16777216
    s_mov_b32 s78, s100
    s_sub_u32 s101, s100, 131072
    s_mov_b32 s90, 0
    s_cmp_lt_u32 s3, 4
    s_cselect_b32 s89, 3, 2
    ds_read_b64_tr_b16 v[96:97], v54 offset:0
    ds_read_b64_tr_b16 v[98:99], v54 offset:1024
    ds_read_b64_tr_b16 v[100:101], v55 offset:0
    ds_read_b64_tr_b16 v[102:103], v55 offset:1024
    ds_read_b64_tr_b16 v[104:105], v56 offset:0
    ds_read_b64_tr_b16 v[106:107], v56 offset:1024
    ds_read_b64_tr_b16 v[108:109], v57 offset:0
    ds_read_b64_tr_b16 v[110:111], v57 offset:1024
    ds_read_b64_tr_b16 v[112:113], v58 offset:0
    ds_read_b64_tr_b16 v[114:115], v58 offset:1024
    ds_read_b64_tr_b16 v[116:117], v59 offset:0
    ds_read_b64_tr_b16 v[118:119], v59 offset:1024
    ds_read_b64_tr_b16 v[120:121], v60 offset:0
    ds_read_b64_tr_b16 v[122:123], v60 offset:1024
    ds_read_b64_tr_b16 v[124:125], v61 offset:0
    ds_read_b64_tr_b16 v[126:127], v61 offset:1024
    buffer_load_dwordx4 v[64:67], v13, s[8:11], s84 offen offset:3072 sc1
    buffer_load_dwordx4 v[68:71], v12, s[8:11], s84 offen offset:3072 sc1
    buffer_load_dwordx4 v[72:75], v13, s[8:11], s85 offen offset:0 sc1
    buffer_load_dwordx4 v[76:79], v12, s[8:11], s85 offen offset:0 sc1
    buffer_load_dwordx4 v[80:83], v13, s[8:11], s85 offen offset:1024 sc1
    buffer_load_dwordx4 v[84:87], v12, s[8:11], s85 offen offset:1024 sc1
    buffer_load_dwordx4 v[88:91], v13, s[8:11], s85 offen offset:2048 sc1
    buffer_load_dwordx4 v[92:95], v12, s[8:11], s85 offen offset:2048 sc1
    s_waitcnt lgkmcnt(14)
    v_mfma_f32_16x16x32_bf16 v[192:195], v[96:99], v[16:19], 0
    v_mfma_f32_16x16x32_bf16 v[196:199], v[96:99], v[20:23], 0
    ds_read_b64_tr_b16 v[96:97], v54 offset:8192
    s_waitcnt lgkmcnt(13)
    v_mfma_f32_16x16x32_bf16 v[204:207], v[100:103], v[20:23], 0
    ds_read_b64_tr_b16 v[98:99], v54 offset:9216
    v_mfma_f32_16x16x32_bf16 v[200:203], v[100:103], v[16:19], 0
    ds_read_b64_tr_b16 v[100:101], v55 offset:8192
    s_waitcnt lgkmcnt(13)
    v_mfma_f32_16x16x32_bf16 v[208:211], v[104:107], v[16:19], 0
    ds_read_b64_tr_b16 v[102:103], v55 offset:9216
    v_mfma_f32_16x16x32_bf16 v[212:215], v[104:107], v[20:23], 0
    ds_read_b64_tr_b16 v[104:105], v56 offset:8192
    s_waitcnt lgkmcnt(13)
    v_mfma_f32_16x16x32_bf16 v[220:223], v[108:111], v[20:23], 0
    ds_read_b64_tr_b16 v[106:107], v56 offset:9216
    buffer_store_dwordx4 v[128:131], v13, s[8:11], s67 offen sc1
    s_add_u32 s67, s67, 1024
    v_mfma_f32_16x16x32_bf16 v[216:219], v[108:111], v[16:19], 0
    ds_read_b64_tr_b16 v[108:109], v57 offset:8192
    s_waitcnt lgkmcnt(13)
    v_mfma_f32_16x16x32_bf16 v[224:227], v[112:115], v[16:19], 0
    ds_read_b64_tr_b16 v[110:111], v57 offset:9216
    v_mfma_f32_16x16x32_bf16 v[228:231], v[112:115], v[20:23], 0
    ds_read_b64_tr_b16 v[112:113], v58 offset:8192
    s_waitcnt lgkmcnt(13)
    v_mfma_f32_16x16x32_bf16 v[236:239], v[116:119], v[20:23], 0
    ds_read_b64_tr_b16 v[114:115], v58 offset:9216
    v_mfma_f32_16x16x32_bf16 v[232:235], v[116:119], v[16:19], 0
    ds_read_b64_tr_b16 v[116:117], v59 offset:8192
    s_waitcnt lgkmcnt(13)
    v_mfma_f32_16x16x32_bf16 v[240:243], v[120:123], v[16:19], 0
    ds_read_b64_tr_b16 v[118:119], v59 offset:9216
    v_mfma_f32_16x16x32_bf16 v[244:247], v[120:123], v[20:23], 0
    ds_read_b64_tr_b16 v[120:121], v60 offset:8192
    s_waitcnt lgkmcnt(13)
    v_mfma_f32_16x16x32_bf16 v[252:255], v[124:127], v[20:23], 0
    ds_read_b64_tr_b16 v[122:123], v60 offset:9216
    v_mfma_f32_16x16x32_bf16 v[248:251], v[124:127], v[16:19], 0
    ds_read_b64_tr_b16 v[124:125], v61 offset:8192
    ds_read_b64_tr_b16 v[126:127], v61 offset:9216
    buffer_load_dwordx4 v[16:19], v13, s[8:11], s85 offen offset:3072 sc1
    buffer_load_dwordx4 v[20:23], v12, s[8:11], s85 offen offset:3072 sc1
    s_waitcnt lgkmcnt(14)
    v_mfma_f32_16x16x32_bf16 v[192:195], v[96:99], v[24:27], v[192:195]
    v_mfma_f32_16x16x32_bf16 v[196:199], v[96:99], v[28:31], v[196:199]
    ds_read_b64_tr_b16 v[96:97], v54 offset:16384
    s_waitcnt lgkmcnt(13)
    v_mfma_f32_16x16x32_bf16 v[204:207], v[100:103], v[28:31], v[204:207]
    ds_read_b64_tr_b16 v[98:99], v54 offset:17408
    v_mfma_f32_16x16x32_bf16 v[200:203], v[100:103], v[24:27], v[200:203]
    ds_read_b64_tr_b16 v[100:101], v55 offset:16384
    s_waitcnt lgkmcnt(13)
    v_mfma_f32_16x16x32_bf16 v[208:211], v[104:107], v[24:27], v[208:211]
    ds_read_b64_tr_b16 v[102:103], v55 offset:17408
    v_mfma_f32_16x16x32_bf16 v[212:215], v[104:107], v[28:31], v[212:215]
    ds_read_b64_tr_b16 v[104:105], v56 offset:16384
    s_waitcnt lgkmcnt(13)
    v_mfma_f32_16x16x32_bf16 v[220:223], v[108:111], v[28:31], v[220:223]
    ds_read_b64_tr_b16 v[106:107], v56 offset:17408
    buffer_store_dwordx4 v[132:135], v13, s[8:11], s67 offen sc1
    s_add_u32 s67, s67, s68
    v_mfma_f32_16x16x32_bf16 v[216:219], v[108:111], v[24:27], v[216:219]
    ds_read_b64_tr_b16 v[108:109], v57 offset:16384
    s_waitcnt lgkmcnt(13)
    v_mfma_f32_16x16x32_bf16 v[224:227], v[112:115], v[24:27], v[224:227]
    ds_read_b64_tr_b16 v[110:111], v57 offset:17408
    v_mfma_f32_16x16x32_bf16 v[228:231], v[112:115], v[28:31], v[228:231]
    ds_read_b64_tr_b16 v[112:113], v58 offset:16384
    s_waitcnt lgkmcnt(13)
    v_mfma_f32_16x16x32_bf16 v[236:239], v[116:119], v[28:31], v[236:239]
    ds_read_b64_tr_b16 v[114:115], v58 offset:17408
    v_mfma_f32_16x16x32_bf16 v[232:235], v[116:119], v[24:27], v[232:235]
    ds_read_b64_tr_b16 v[116:117], v59 offset:16384
    s_waitcnt lgkmcnt(13)
    v_mfma_f32_16x16x32_bf16 v[240:243], v[120:123], v[24:27], v[240:243]
    ds_read_b64_tr_b16 v[118:119], v59 offset:17408
    v_mfma_f32_16x16x32_bf16 v[244:247], v[120:123], v[28:31], v[244:247]
    ds_read_b64_tr_b16 v[120:121], v60 offset:16384
    s_waitcnt lgkmcnt(13)
    v_mfma_f32_16x16x32_bf16 v[252:255], v[124:127], v[28:31], v[252:255]
    ds_read_b64_tr_b16 v[122:123], v60 offset:17408
    v_mfma_f32_16x16x32_bf16 v[248:251], v[124:127], v[24:27], v[248:251]
    ds_read_b64_tr_b16 v[124:125], v61 offset:16384
    ds_read_b64_tr_b16 v[126:127], v61 offset:17408
    buffer_load_dwordx4 v[24:27], v13, s[8:11], s86 offen offset:0 sc1
    buffer_load_dwordx4 v[28:31], v12, s[8:11], s86 offen offset:0 sc1
    s_waitcnt lgkmcnt(14)
    v_mfma_f32_16x16x32_bf16 v[192:195], v[96:99], v[32:35], v[192:195]
    v_mfma_f32_16x16x32_bf16 v[196:199], v[96:99], v[36:39], v[196:199]
    ds_read_b64_tr_b16 v[96:97], v54 offset:24576
    s_waitcnt lgkmcnt(13)
    v_mfma_f32_16x16x32_bf16 v[204:207], v[100:103], v[36:39], v[204:207]
    ds_read_b64_tr_b16 v[98:99], v54 offset:25600
    v_mfma_f32_16x16x32_bf16 v[200:203], v[100:103], v[32:35], v[200:203]
    ds_read_b64_tr_b16 v[100:101], v55 offset:24576
    s_waitcnt lgkmcnt(13)
    v_mfma_f32_16x16x32_bf16 v[208:211], v[104:107], v[32:35], v[208:211]
    ds_read_b64_tr_b16 v[102:103], v55 offset:25600
    v_mfma_f32_16x16x32_bf16 v[212:215], v[104:107], v[36:39], v[212:215]
    ds_read_b64_tr_b16 v[104:105], v56 offset:24576
    s_waitcnt lgkmcnt(13)
    v_mfma_f32_16x16x32_bf16 v[220:223], v[108:111], v[36:39], v[220:223]
    ds_read_b64_tr_b16 v[106:107], v56 offset:25600
    buffer_store_dwordx4 v[136:139], v13, s[8:11], s67 offen sc1
    s_add_u32 s67, s67, 1024
    v_mfma_f32_16x16x32_bf16 v[216:219], v[108:111], v[32:35], v[216:219]
    ds_read_b64_tr_b16 v[108:109], v57 offset:24576
    s_waitcnt lgkmcnt(13)
    v_mfma_f32_16x16x32_bf16 v[224:227], v[112:115], v[32:35], v[224:227]
    ds_read_b64_tr_b16 v[110:111], v57 offset:25600
    v_mfma_f32_16x16x32_bf16 v[228:231], v[112:115], v[36:39], v[228:231]
    ds_read_b64_tr_b16 v[112:113], v58 offset:24576
    s_waitcnt lgkmcnt(13)
    v_mfma_f32_16x16x32_bf16 v[236:239], v[116:119], v[36:39], v[236:239]
    ds_read_b64_tr_b16 v[114:115], v58 offset:25600
    v_mfma_f32_16x16x32_bf16 v[232:235], v[116:119], v[32:35], v[232:235]
    ds_read_b64_tr_b16 v[116:117], v59 offset:24576
    s_waitcnt lgkmcnt(13)
    v_mfma_f32_16x16x32_bf16 v[240:243], v[120:123], v[32:35], v[240:243]
    ds_read_b64_tr_b16 v[118:119], v59 offset:25600
    v_mfma_f32_16x16x32_bf16 v[244:247], v[120:123], v[36:39], v[244:247]
    ds_read_b64_tr_b16 v[120:121], v60 offset:24576
    s_waitcnt lgkmcnt(13)
    v_mfma_f32_16x16x32_bf16 v[252:255], v[124:127], v[36:39], v[252:255]
    ds_read_b64_tr_b16 v[122:123], v60 offset:25600
    v_mfma_f32_16x16x32_bf16 v[248:251], v[124:127], v[32:35], v[248:251]
    ds_read_b64_tr_b16 v[124:125], v61 offset:24576
    ds_read_b64_tr_b16 v[126:127], v61 offset:25600
    buffer_load_dwordx4 v[32:35], v13, s[8:11], s86 offen offset:1024 sc1
    buffer_load_dwordx4 v[36:39], v12, s[8:11], s86 offen offset:1024 sc1
    s_waitcnt vmcnt(15)
    s_waitcnt lgkmcnt(14)
    v_mfma_f32_16x16x32_bf16 v[192:195], v[96:99], v[64:67], v[192:195]
    v_add_u32 v54, s101, v54
    v_mfma_f32_16x16x32_bf16 v[196:199], v[96:99], v[68:71], v[196:199]
    ds_read_b64_tr_b16 v[96:97], v54 offset:0
    s_waitcnt lgkmcnt(13)
    v_mfma_f32_16x16x32_bf16 v[204:207], v[100:103], v[68:71], v[204:207]
    ds_read_b64_tr_b16 v[98:99], v54 offset:1024
    v_add_u32 v55, s101, v55
    v_mfma_f32_16x16x32_bf16 v[200:203], v[100:103], v[64:67], v[200:203]
    ds_read_b64_tr_b16 v[100:101], v55 offset:0
    s_waitcnt lgkmcnt(13)
    v_mfma_f32_16x16x32_bf16 v[208:211], v[104:107], v[64:67], v[208:211]
    ds_read_b64_tr_b16 v[102:103], v55 offset:1024
    v_add_u32 v56, s101, v56
    v_mfma_f32_16x16x32_bf16 v[212:215], v[104:107], v[68:71], v[212:215]
    ds_read_b64_tr_b16 v[104:105], v56 offset:0
    s_waitcnt lgkmcnt(13)
    v_mfma_f32_16x16x32_bf16 v[220:223], v[108:111], v[68:71], v[220:223]
    ds_read_b64_tr_b16 v[106:107], v56 offset:1024
    v_add_u32 v57, s101, v57
    buffer_store_dwordx4 v[140:143], v13, s[8:11], s67 offen sc1
    s_add_u32 s67, s67, s69
    v_mfma_f32_16x16x32_bf16 v[216:219], v[108:111], v[64:67], v[216:219]
    ds_read_b64_tr_b16 v[108:109], v57 offset:0
    s_waitcnt lgkmcnt(13)
    v_mfma_f32_16x16x32_bf16 v[224:227], v[112:115], v[64:67], v[224:227]
    ds_read_b64_tr_b16 v[110:111], v57 offset:1024
    v_add_u32 v58, s101, v58
    v_mfma_f32_16x16x32_bf16 v[228:231], v[112:115], v[68:71], v[228:231]
    ds_read_b64_tr_b16 v[112:113], v58 offset:0
    s_waitcnt lgkmcnt(13)
    v_mfma_f32_16x16x32_bf16 v[236:239], v[116:119], v[68:71], v[236:239]
    ds_read_b64_tr_b16 v[114:115], v58 offset:1024
    v_add_u32 v59, s101, v59
    v_mfma_f32_16x16x32_bf16 v[232:235], v[116:119], v[64:67], v[232:235]
    ds_read_b64_tr_b16 v[116:117], v59 offset:0
    s_waitcnt lgkmcnt(13)
    v_mfma_f32_16x16x32_bf16 v[240:243], v[120:123], v[64:67], v[240:243]
    ds_read_b64_tr_b16 v[118:119], v59 offset:1024
    v_add_u32 v60, s101, v60
    v_mfma_f32_16x16x32_bf16 v[244:247], v[120:123], v[68:71], v[244:247]
    ds_read_b64_tr_b16 v[120:121], v60 offset:0
    s_waitcnt lgkmcnt(13)
    v_mfma_f32_16x16x32_bf16 v[252:255], v[124:127], v[68:71], v[252:255]
    ds_read_b64_tr_b16 v[122:123], v60 offset:1024
    v_add_u32 v61, s101, v61
    v_mfma_f32_16x16x32_bf16 v[248:251], v[124:127], v[64:67], v[248:251]
    ds_read_b64_tr_b16 v[124:125], v61 offset:0
    ds_read_b64_tr_b16 v[126:127], v61 offset:1024
    buffer_load_dwordx4 v[64:67], v13, s[8:11], s86 offen offset:2048 sc1
    buffer_load_dwordx4 v[68:71], v12, s[8:11], s86 offen offset:2048 sc1
    s_waitcnt vmcnt(16)
    s_waitcnt lgkmcnt(14)
    v_mfma_f32_16x16x32_bf16 v[192:195], v[96:99], v[72:75], v[192:195]
    v_mfma_f32_16x16x32_bf16 v[196:199], v[96:99], v[76:79], v[196:199]
    ds_read_b64_tr_b16 v[96:97], v54 offset:8192
    s_waitcnt lgkmcnt(13)
    v_mfma_f32_16x16x32_bf16 v[204:207], v[100:103], v[76:79], v[204:207]
    ds_read_b64_tr_b16 v[98:99], v54 offset:9216
    v_mfma_f32_16x16x32_bf16 v[200:203], v[100:103], v[72:75], v[200:203]
    ds_read_b64_tr_b16 v[100:101], v55 offset:8192
    s_waitcnt lgkmcnt(13)
    v_mfma_f32_16x16x32_bf16 v[208:211], v[104:107], v[72:75], v[208:211]
    ds_read_b64_tr_b16 v[102:103], v55 offset:9216
    v_mfma_f32_16x16x32_bf16 v[212:215], v[104:107], v[76:79], v[212:215]
    ds_read_b64_tr_b16 v[104:105], v56 offset:8192
    s_waitcnt lgkmcnt(13)
    v_mfma_f32_16x16x32_bf16 v[220:223], v[108:111], v[76:79], v[220:223]
    ds_read_b64_tr_b16 v[106:107], v56 offset:9216
    v_mfma_f32_16x16x32_bf16 v[216:219], v[108:111], v[72:75], v[216:219]
    ds_read_b64_tr_b16 v[108:109], v57 offset:8192
    s_waitcnt lgkmcnt(13)
    v_mfma_f32_16x16x32_bf16 v[224:227], v[112:115], v[72:75], v[224:227]
    ds_read_b64_tr_b16 v[110:111], v57 offset:9216
    v_mfma_f32_16x16x32_bf16 v[228:231], v[112:115], v[76:79], v[228:231]
    ds_read_b64_tr_b16 v[112:113], v58 offset:8192
    s_waitcnt lgkmcnt(13)
    v_mfma_f32_16x16x32_bf16 v[236:239], v[116:119], v[76:79], v[236:239]
    ds_read_b64_tr_b16 v[114:115], v58 offset:9216
    v_mfma_f32_16x16x32_bf16 v[232:235], v[116:119], v[72:75], v[232:235]
    ds_read_b64_tr_b16 v[116:117], v59 offset:8192
    s_waitcnt lgkmcnt(13)
    v_mfma_f32_16x16x32_bf16 v[240:243], v[120:123], v[72:75], v[240:243]
    ds_read_b64_tr_b16 v[118:119], v59 offset:9216
    v_mfma_f32_16x16x32_bf16 v[244:247], v[120:123], v[76:79], v[244:247]
    ds_read_b64_tr_b16 v[120:121], v60 offset:8192
    s_waitcnt lgkmcnt(13)
    v_mfma_f32_16x16x32_bf16 v[252:255], v[124:127], v[76:79], v[252:255]
    ds_read_b64_tr_b16 v[122:123], v60 offset:9216
    v_mfma_f32_16x16x32_bf16 v[248:251], v[124:127], v[72:75], v[248:251]
    ds_read_b64_tr_b16 v[124:125], v61 offset:8192
    ds_read_b64_tr_b16 v[126:127], v61 offset:9216
    buffer_load_dwordx4 v[72:75], v13, s[8:11], s86 offen offset:3072 sc1
    buffer_load_dwordx4 v[76:79], v12, s[8:11], s86 offen offset:3072 sc1
    s_waitcnt vmcnt(16)
    s_waitcnt lgkmcnt(14)
    v_mfma_f32_16x16x32_bf16 v[192:195], v[96:99], v[80:83], v[192:195]
    v_mfma_f32_16x16x32_bf16 v[196:199], v[96:99], v[84:87], v[196:199]
    ds_read_b64_tr_b16 v[96:97], v54 offset:16384
    s_waitcnt lgkmcnt(13)
    v_mfma_f32_16x16x32_bf16 v[204:207], v[100:103], v[84:87], v[204:207]
    ds_read_b64_tr_b16 v[98:99], v54 offset:17408
    v_mfma_f32_16x16x32_bf16 v[200:203], v[100:103], v[80:83], v[200:203]
    ds_read_b64_tr_b16 v[100:101], v55 offset:16384
    s_waitcnt lgkmcnt(13)
    v_mfma_f32_16x16x32_bf16 v[208:211], v[104:107], v[80:83], v[208:211]
    ds_read_b64_tr_b16 v[102:103], v55 offset:17408
    v_mfma_f32_16x16x32_bf16 v[212:215], v[104:107], v[84:87], v[212:215]
    ds_read_b64_tr_b16 v[104:105], v56 offset:16384
    s_waitcnt lgkmcnt(13)
    v_mfma_f32_16x16x32_bf16 v[220:223], v[108:111], v[84:87], v[220:223]
    ds_read_b64_tr_b16 v[106:107], v56 offset:17408
    v_mfma_f32_16x16x32_bf16 v[216:219], v[108:111], v[80:83], v[216:219]
    ds_read_b64_tr_b16 v[108:109], v57 offset:16384
    s_waitcnt lgkmcnt(13)
    v_mfma_f32_16x16x32_bf16 v[224:227], v[112:115], v[80:83], v[224:227]
    ds_read_b64_tr_b16 v[110:111], v57 offset:17408
    v_mfma_f32_16x16x32_bf16 v[228:231], v[112:115], v[84:87], v[228:231]
    ds_read_b64_tr_b16 v[112:113], v58 offset:16384
    s_waitcnt lgkmcnt(13)
    v_mfma_f32_16x16x32_bf16 v[236:239], v[116:119], v[84:87], v[236:239]
    ds_read_b64_tr_b16 v[114:115], v58 offset:17408
    v_mfma_f32_16x16x32_bf16 v[232:235], v[116:119], v[80:83], v[232:235]
    ds_read_b64_tr_b16 v[116:117], v59 offset:16384
    s_waitcnt lgkmcnt(13)
    v_mfma_f32_16x16x32_bf16 v[240:243], v[120:123], v[80:83], v[240:243]
    ds_read_b64_tr_b16 v[118:119], v59 offset:17408
    v_mfma_f32_16x16x32_bf16 v[244:247], v[120:123], v[84:87], v[244:247]
    ds_read_b64_tr_b16 v[120:121], v60 offset:16384
    s_waitcnt lgkmcnt(13)
    v_mfma_f32_16x16x32_bf16 v[252:255], v[124:127], v[84:87], v[252:255]
    ds_read_b64_tr_b16 v[122:123], v60 offset:17408
    v_mfma_f32_16x16x32_bf16 v[248:251], v[124:127], v[80:83], v[248:251]
    ds_read_b64_tr_b16 v[124:125], v61 offset:16384
    ds_read_b64_tr_b16 v[126:127], v61 offset:17408
    buffer_load_dwordx4 v[80:83], v13, s[8:11], s87 offen offset:0 sc1
    buffer_load_dwordx4 v[84:87], v12, s[8:11], s87 offen offset:0 sc1
    s_waitcnt vmcnt(16)
    s_waitcnt lgkmcnt(14)
    v_mfma_f32_16x16x32_bf16 v[192:195], v[96:99], v[88:91], v[192:195]
    v_mfma_f32_16x16x32_bf16 v[196:199], v[96:99], v[92:95], v[196:199]
    ds_read_b64_tr_b16 v[96:97], v54 offset:24576
    s_waitcnt lgkmcnt(13)
    v_mfma_f32_16x16x32_bf16 v[204:207], v[100:103], v[92:95], v[204:207]
    ds_read_b64_tr_b16 v[98:99], v54 offset:25600
    v_mfma_f32_16x16x32_bf16 v[200:203], v[100:103], v[88:91], v[200:203]
    ds_read_b64_tr_b16 v[100:101], v55 offset:24576
    s_waitcnt lgkmcnt(13)
    v_mfma_f32_16x16x32_bf16 v[208:211], v[104:107], v[88:91], v[208:211]
    ds_read_b64_tr_b16 v[102:103], v55 offset:25600
    v_mfma_f32_16x16x32_bf16 v[212:215], v[104:107], v[92:95], v[212:215]
    ds_read_b64_tr_b16 v[104:105], v56 offset:24576
    s_waitcnt lgkmcnt(13)
    v_mfma_f32_16x16x32_bf16 v[220:223], v[108:111], v[92:95], v[220:223]
    ds_read_b64_tr_b16 v[106:107], v56 offset:25600
    v_mfma_f32_16x16x32_bf16 v[216:219], v[108:111], v[88:91], v[216:219]
    ds_read_b64_tr_b16 v[108:109], v57 offset:24576
    s_waitcnt lgkmcnt(13)
    v_mfma_f32_16x16x32_bf16 v[224:227], v[112:115], v[88:91], v[224:227]
    ds_read_b64_tr_b16 v[110:111], v57 offset:25600
    v_mfma_f32_16x16x32_bf16 v[228:231], v[112:115], v[92:95], v[228:231]
    ds_read_b64_tr_b16 v[112:113], v58 offset:24576
    s_waitcnt lgkmcnt(13)
    v_mfma_f32_16x16x32_bf16 v[236:239], v[116:119], v[92:95], v[236:239]
    ds_read_b64_tr_b16 v[114:115], v58 offset:25600
    v_mfma_f32_16x16x32_bf16 v[232:235], v[116:119], v[88:91], v[232:235]
    ds_read_b64_tr_b16 v[116:117], v59 offset:24576
    s_waitcnt lgkmcnt(13)
    v_mfma_f32_16x16x32_bf16 v[240:243], v[120:123], v[88:91], v[240:243]
    ds_read_b64_tr_b16 v[118:119], v59 offset:25600
    v_mfma_f32_16x16x32_bf16 v[244:247], v[120:123], v[92:95], v[244:247]
    ds_read_b64_tr_b16 v[120:121], v60 offset:24576
    s_waitcnt lgkmcnt(13)
    v_mfma_f32_16x16x32_bf16 v[252:255], v[124:127], v[92:95], v[252:255]
    ds_read_b64_tr_b16 v[122:123], v60 offset:25600
    v_mfma_f32_16x16x32_bf16 v[248:251], v[124:127], v[88:91], v[248:251]
    ds_read_b64_tr_b16 v[124:125], v61 offset:24576
    ds_read_b64_tr_b16 v[126:127], v61 offset:25600
    buffer_load_dwordx4 v[88:91], v13, s[8:11], s87 offen offset:1024 sc1
    buffer_load_dwordx4 v[92:95], v12, s[8:11], s87 offen offset:1024 sc1
    s_waitcnt vmcnt(8)
    s_lshl_b32 s6, s4, 3
    s_add_u32 s6, s6, s5
    s_lshl_b32 s6, s6, 5
    s_add_u32 s6, s6, s3
    s_lshl_b32 s6, s6, 2
    s_add_u32 s6, s6, 3866624
    v_mov_b32 v2, 1
    v_mov_b32 v3, 0x5000000
    v_writelane_b32 v3, s6, 0
    buffer_store_dword v2, v3, s[8:11], 0 offen sc1
    s_waitcnt lgkmcnt(14)
    v_mfma_f32_16x16x32_bf16 v[192:195], v[96:99], v[16:19], v[192:195]
    v_mfma_f32_16x16x32_bf16 v[196:199], v[96:99], v[20:23], v[196:199]
    ds_read_b64_tr_b16 v[96:97], v54 offset:32768
    s_waitcnt lgkmcnt(13)
    v_mfma_f32_16x16x32_bf16 v[204:207], v[100:103], v[20:23], v[204:207]
    ds_read_b64_tr_b16 v[98:99], v54 offset:33792
    v_mfma_f32_16x16x32_bf16 v[200:203], v[100:103], v[16:19], v[200:203]
    ds_read_b64_tr_b16 v[100:101], v55 offset:32768
    s_waitcnt lgkmcnt(13)
    v_mfma_f32_16x16x32_bf16 v[208:211], v[104:107], v[16:19], v[208:211]
    ds_read_b64_tr_b16 v[102:103], v55 offset:33792
    v_mfma_f32_16x16x32_bf16 v[212:215], v[104:107], v[20:23], v[212:215]
    ds_read_b64_tr_b16 v[104:105], v56 offset:32768
    s_waitcnt lgkmcnt(13)
    v_mfma_f32_16x16x32_bf16 v[220:223], v[108:111], v[20:23], v[220:223]
    ds_read_b64_tr_b16 v[106:107], v56 offset:33792
    v_mfma_f32_16x16x32_bf16 v[216:219], v[108:111], v[16:19], v[216:219]
    ds_read_b64_tr_b16 v[108:109], v57 offset:32768
    s_waitcnt lgkmcnt(13)
    v_mfma_f32_16x16x32_bf16 v[224:227], v[112:115], v[16:19], v[224:227]
    ds_read_b64_tr_b16 v[110:111], v57 offset:33792
    v_mfma_f32_16x16x32_bf16 v[228:231], v[112:115], v[20:23], v[228:231]
    ds_read_b64_tr_b16 v[112:113], v58 offset:32768
    s_waitcnt lgkmcnt(13)
    v_mfma_f32_16x16x32_bf16 v[236:239], v[116:119], v[20:23], v[236:239]
    ds_read_b64_tr_b16 v[114:115], v58 offset:33792
    v_mfma_f32_16x16x32_bf16 v[232:235], v[116:119], v[16:19], v[232:235]
    ds_read_b64_tr_b16 v[116:117], v59 offset:32768
    s_waitcnt lgkmcnt(13)
    v_mfma_f32_16x16x32_bf16 v[240:243], v[120:123], v[16:19], v[240:243]
    ds_read_b64_tr_b16 v[118:119], v59 offset:33792
    v_mfma_f32_16x16x32_bf16 v[244:247], v[120:123], v[20:23], v[244:247]
    ds_read_b64_tr_b16 v[120:121], v60 offset:32768
    s_waitcnt lgkmcnt(13)
    v_mfma_f32_16x16x32_bf16 v[252:255], v[124:127], v[20:23], v[252:255]
    ds_read_b64_tr_b16 v[122:123], v60 offset:33792
    v_mfma_f32_16x16x32_bf16 v[248:251], v[124:127], v[16:19], v[248:251]
    ds_read_b64_tr_b16 v[124:125], v61 offset:32768
    ds_read_b64_tr_b16 v[126:127], v61 offset:33792
    buffer_load_dwordx4 v[16:19], v13, s[8:11], s87 offen offset:2048 sc1
    buffer_load_dwordx4 v[20:23], v12, s[8:11], s87 offen offset:2048 sc1
    s_waitcnt lgkmcnt(14)
    v_mfma_f32_16x16x32_bf16 v[192:195], v[96:99], v[24:27], v[192:195]
    v_mfma_f32_16x16x32_bf16 v[196:199], v[96:99], v[28:31], v[196:199]
    ds_read_b64_tr_b16 v[96:97], v54 offset:40960
    s_waitcnt lgkmcnt(13)
    v_mfma_f32_16x16x32_bf16 v[204:207], v[100:103], v[28:31], v[204:207]
    ds_read_b64_tr_b16 v[98:99], v54 offset:41984
    v_mfma_f32_16x16x32_bf16 v[200:203], v[100:103], v[24:27], v[200:203]
    ds_read_b64_tr_b16 v[100:101], v55 offset:40960
    s_waitcnt lgkmcnt(13)
    v_mfma_f32_16x16x32_bf16 v[208:211], v[104:107], v[24:27], v[208:211]
    ds_read_b64_tr_b16 v[102:103], v55 offset:41984
    v_mfma_f32_16x16x32_bf16 v[212:215], v[104:107], v[28:31], v[212:215]
    ds_read_b64_tr_b16 v[104:105], v56 offset:40960
    s_waitcnt lgkmcnt(13)
    v_mfma_f32_16x16x32_bf16 v[220:223], v[108:111], v[28:31], v[220:223]
    ds_read_b64_tr_b16 v[106:107], v56 offset:41984
    v_mfma_f32_16x16x32_bf16 v[216:219], v[108:111], v[24:27], v[216:219]
    ds_read_b64_tr_b16 v[108:109], v57 offset:40960
    s_waitcnt lgkmcnt(13)
    v_mfma_f32_16x16x32_bf16 v[224:227], v[112:115], v[24:27], v[224:227]
    ds_read_b64_tr_b16 v[110:111], v57 offset:41984
    v_mfma_f32_16x16x32_bf16 v[228:231], v[112:115], v[28:31], v[228:231]
    ds_read_b64_tr_b16 v[112:113], v58 offset:40960
    s_waitcnt lgkmcnt(13)
    v_mfma_f32_16x16x32_bf16 v[236:239], v[116:119], v[28:31], v[236:239]
    ds_read_b64_tr_b16 v[114:115], v58 offset:41984
    v_mfma_f32_16x16x32_bf16 v[232:235], v[116:119], v[24:27], v[232:235]
    ds_read_b64_tr_b16 v[116:117], v59 offset:40960
    s_waitcnt lgkmcnt(13)
    v_mfma_f32_16x16x32_bf16 v[240:243], v[120:123], v[24:27], v[240:243]
    ds_read_b64_tr_b16 v[118:119], v59 offset:41984
    v_mfma_f32_16x16x32_bf16 v[244:247], v[120:123], v[28:31], v[244:247]
    ds_read_b64_tr_b16 v[120:121], v60 offset:40960
    s_waitcnt lgkmcnt(13)
    v_mfma_f32_16x16x32_bf16 v[252:255], v[124:127], v[28:31], v[252:255]
    ds_read_b64_tr_b16 v[122:123], v60 offset:41984
    v_mfma_f32_16x16x32_bf16 v[248:251], v[124:127], v[24:27], v[248:251]
    ds_read_b64_tr_b16 v[124:125], v61 offset:40960
    ds_read_b64_tr_b16 v[126:127], v61 offset:41984
    buffer_load_dwordx4 v[24:27], v13, s[8:11], s87 offen offset:3072 sc1
    buffer_load_dwordx4 v[28:31], v12, s[8:11], s87 offen offset:3072 sc1
    s_waitcnt lgkmcnt(14)
    v_mfma_f32_16x16x32_bf16 v[192:195], v[96:99], v[32:35], v[192:195]
    v_mfma_f32_16x16x32_bf16 v[196:199], v[96:99], v[36:39], v[196:199]
    ds_read_b64_tr_b16 v[96:97], v54 offset:49152
    s_waitcnt lgkmcnt(13)
    v_mfma_f32_16x16x32_bf16 v[204:207], v[100:103], v[36:39], v[204:207]
    ds_read_b64_tr_b16 v[98:99], v54 offset:50176
    v_mfma_f32_16x16x32_bf16 v[200:203], v[100:103], v[32:35], v[200:203]
    ds_read_b64_tr_b16 v[100:101], v55 offset:49152
    s_waitcnt lgkmcnt(13)
    v_mfma_f32_16x16x32_bf16 v[208:211], v[104:107], v[32:35], v[208:211]
    ds_read_b64_tr_b16 v[102:103], v55 offset:50176
    v_mfma_f32_16x16x32_bf16 v[212:215], v[104:107], v[36:39], v[212:215]
    ds_read_b64_tr_b16 v[104:105], v56 offset:49152
    s_waitcnt lgkmcnt(13)
    v_mfma_f32_16x16x32_bf16 v[220:223], v[108:111], v[36:39], v[220:223]
    ds_read_b64_tr_b16 v[106:107], v56 offset:50176
    v_mfma_f32_16x16x32_bf16 v[216:219], v[108:111], v[32:35], v[216:219]
    ds_read_b64_tr_b16 v[108:109], v57 offset:49152
    s_waitcnt lgkmcnt(13)
    v_mfma_f32_16x16x32_bf16 v[224:227], v[112:115], v[32:35], v[224:227]
    ds_read_b64_tr_b16 v[110:111], v57 offset:50176
    v_mfma_f32_16x16x32_bf16 v[228:231], v[112:115], v[36:39], v[228:231]
    ds_read_b64_tr_b16 v[112:113], v58 offset:49152
    s_waitcnt lgkmcnt(13)
    v_mfma_f32_16x16x32_bf16 v[236:239], v[116:119], v[36:39], v[236:239]
    ds_read_b64_tr_b16 v[114:115], v58 offset:50176
    v_mfma_f32_16x16x32_bf16 v[232:235], v[116:119], v[32:35], v[232:235]
    ds_read_b64_tr_b16 v[116:117], v59 offset:49152
    s_waitcnt lgkmcnt(13)
    v_mfma_f32_16x16x32_bf16 v[240:243], v[120:123], v[32:35], v[240:243]
    ds_read_b64_tr_b16 v[118:119], v59 offset:50176
    v_mfma_f32_16x16x32_bf16 v[244:247], v[120:123], v[36:39], v[244:247]
    ds_read_b64_tr_b16 v[120:121], v60 offset:49152
    s_waitcnt lgkmcnt(13)
    v_mfma_f32_16x16x32_bf16 v[252:255], v[124:127], v[36:39], v[252:255]
    ds_read_b64_tr_b16 v[122:123], v60 offset:50176
    v_mfma_f32_16x16x32_bf16 v[248:251], v[124:127], v[32:35], v[248:251]
    ds_read_b64_tr_b16 v[124:125], v61 offset:49152
    ds_read_b64_tr_b16 v[126:127], v61 offset:50176
    buffer_load_dwordx4 v[32:35], v13, s[8:11], s88 offen offset:0 sc1
    buffer_load_dwordx4 v[36:39], v12, s[8:11], s88 offen offset:0 sc1
    s_waitcnt vmcnt(13)
    s_waitcnt lgkmcnt(14)
    v_mfma_f32_16x16x32_bf16 v[192:195], v[96:99], v[64:67], v[192:195]
    v_mfma_f32_16x16x32_bf16 v[196:199], v[96:99], v[68:71], v[196:199]
    ds_read_b64_tr_b16 v[96:97], v54 offset:57344
    s_waitcnt lgkmcnt(13)
    v_mfma_f32_16x16x32_bf16 v[204:207], v[100:103], v[68:71], v[204:207]
    ds_read_b64_tr_b16 v[98:99], v54 offset:58368
    v_mfma_f32_16x16x32_bf16 v[200:203], v[100:103], v[64:67], v[200:203]
    ds_read_b64_tr_b16 v[100:101], v55 offset:57344
    s_waitcnt lgkmcnt(13)
    v_mfma_f32_16x16x32_bf16 v[208:211], v[104:107], v[64:67], v[208:211]
    ds_read_b64_tr_b16 v[102:103], v55 offset:58368
    v_mfma_f32_16x16x32_bf16 v[212:215], v[104:107], v[68:71], v[212:215]
    ds_read_b64_tr_b16 v[104:105], v56 offset:57344
    s_waitcnt lgkmcnt(13)
    v_mfma_f32_16x16x32_bf16 v[220:223], v[108:111], v[68:71], v[220:223]
    ds_read_b64_tr_b16 v[106:107], v56 offset:58368
    v_mfma_f32_16x16x32_bf16 v[216:219], v[108:111], v[64:67], v[216:219]
    ds_read_b64_tr_b16 v[108:109], v57 offset:57344
    s_waitcnt lgkmcnt(13)
    v_mfma_f32_16x16x32_bf16 v[224:227], v[112:115], v[64:67], v[224:227]
    ds_read_b64_tr_b16 v[110:111], v57 offset:58368
    v_mfma_f32_16x16x32_bf16 v[228:231], v[112:115], v[68:71], v[228:231]
    ds_read_b64_tr_b16 v[112:113], v58 offset:57344
    s_waitcnt lgkmcnt(13)
    v_mfma_f32_16x16x32_bf16 v[236:239], v[116:119], v[68:71], v[236:239]
    ds_read_b64_tr_b16 v[114:115], v58 offset:58368
    v_mfma_f32_16x16x32_bf16 v[232:235], v[116:119], v[64:67], v[232:235]
    ds_read_b64_tr_b16 v[116:117], v59 offset:57344
    s_waitcnt lgkmcnt(13)
    v_mfma_f32_16x16x32_bf16 v[240:243], v[120:123], v[64:67], v[240:243]
    ds_read_b64_tr_b16 v[118:119], v59 offset:58368
    v_mfma_f32_16x16x32_bf16 v[244:247], v[120:123], v[68:71], v[244:247]
    ds_read_b64_tr_b16 v[120:121], v60 offset:57344
    s_waitcnt lgkmcnt(13)
    v_mfma_f32_16x16x32_bf16 v[252:255], v[124:127], v[68:71], v[252:255]
    ds_read_b64_tr_b16 v[122:123], v60 offset:58368
    v_mfma_f32_16x16x32_bf16 v[248:251], v[124:127], v[64:67], v[248:251]
    ds_read_b64_tr_b16 v[124:125], v61 offset:57344
    ds_read_b64_tr_b16 v[126:127], v61 offset:58368
    buffer_load_dwordx4 v[64:67], v13, s[8:11], s88 offen offset:1024 sc1
    buffer_load_dwordx4 v[68:71], v12, s[8:11], s88 offen offset:1024 sc1
    s_waitcnt vmcnt(13)
    s_waitcnt lgkmcnt(14)
    v_mfma_f32_16x16x32_bf16 v[192:195], v[96:99], v[72:75], v[192:195]
    v_xor_b32 v54, 0x10000, v54
    v_mfma_f32_16x16x32_bf16 v[196:199], v[96:99], v[76:79], v[196:199]
    s_waitcnt lgkmcnt(12)
    v_mfma_f32_16x16x32_bf16 v[204:207], v[100:103], v[76:79], v[204:207]
    v_xor_b32 v55, 0x10000, v55
    v_mfma_f32_16x16x32_bf16 v[200:203], v[100:103], v[72:75], v[200:203]
    s_waitcnt lgkmcnt(0)
    s_barrier
    ds_read_b64_tr_b16 v[96:97], v54 offset:0
    ds_read_b64_tr_b16 v[98:99], v54 offset:1024
    ds_read_b64_tr_b16 v[100:101], v55 offset:0
    v_mfma_f32_16x16x32_bf16 v[208:211], v[104:107], v[72:75], v[208:211]
    ds_read_b64_tr_b16 v[102:103], v55 offset:1024
    v_xor_b32 v56, 0x10000, v56
    v_mfma_f32_16x16x32_bf16 v[212:215], v[104:107], v[76:79], v[212:215]
    ds_read_b64_tr_b16 v[104:105], v56 offset:0
    v_mfma_f32_16x16x32_bf16 v[220:223], v[108:111], v[76:79], v[220:223]
    ds_read_b64_tr_b16 v[106:107], v56 offset:1024
    v_xor_b32 v57, 0x10000, v57
    v_mfma_f32_16x16x32_bf16 v[216:219], v[108:111], v[72:75], v[216:219]
    ds_read_b64_tr_b16 v[108:109], v57 offset:0
    v_mfma_f32_16x16x32_bf16 v[224:227], v[112:115], v[72:75], v[224:227]
    ds_read_b64_tr_b16 v[110:111], v57 offset:1024
    v_xor_b32 v58, 0x10000, v58
    v_mfma_f32_16x16x32_bf16 v[228:231], v[112:115], v[76:79], v[228:231]
    ds_read_b64_tr_b16 v[112:113], v58 offset:0
    v_mfma_f32_16x16x32_bf16 v[236:239], v[116:119], v[76:79], v[236:239]
    ds_read_b64_tr_b16 v[114:115], v58 offset:1024
    v_xor_b32 v59, 0x10000, v59
    v_mfma_f32_16x16x32_bf16 v[232:235], v[116:119], v[72:75], v[232:235]
    ds_read_b64_tr_b16 v[116:117], v59 offset:0
    v_mfma_f32_16x16x32_bf16 v[240:243], v[120:123], v[72:75], v[240:243]
    ds_read_b64_tr_b16 v[118:119], v59 offset:1024
    v_xor_b32 v60, 0x10000, v60
    v_mfma_f32_16x16x32_bf16 v[244:247], v[120:123], v[76:79], v[244:247]
    ds_read_b64_tr_b16 v[120:121], v60 offset:0
    v_mfma_f32_16x16x32_bf16 v[252:255], v[124:127], v[76:79], v[252:255]
    ds_read_b64_tr_b16 v[122:123], v60 offset:1024
    v_xor_b32 v61, 0x10000, v61
    v_mfma_f32_16x16x32_bf16 v[248:251], v[124:127], v[72:75], v[248:251]
    ds_read_b64_tr_b16 v[124:125], v61 offset:0
    ds_read_b64_tr_b16 v[126:127], v61 offset:1024
    buffer_load_dwordx4 v[72:75], v13, s[8:11], s88 offen offset:2048 sc1
    buffer_load_dwordx4 v[76:79], v12, s[8:11], s88 offen offset:2048 sc1
    s_waitcnt vmcnt(13)
    s_waitcnt lgkmcnt(14)
    v_mfma_f32_16x16x32_bf16 v[192:195], v[96:99], v[80:83], v[192:195]
    v_mfma_f32_16x16x32_bf16 v[196:199], v[96:99], v[84:87], v[196:199]
    ds_read_b64_tr_b16 v[96:97], v54 offset:8192
    s_waitcnt lgkmcnt(13)
    v_mfma_f32_16x16x32_bf16 v[204:207], v[100:103], v[84:87], v[204:207]
    ds_read_b64_tr_b16 v[98:99], v54 offset:9216
    v_mfma_f32_16x16x32_bf16 v[200:203], v[100:103], v[80:83], v[200:203]
    ds_read_b64_tr_b16 v[100:101], v55 offset:8192
    s_waitcnt lgkmcnt(13)
    v_mfma_f32_16x16x32_bf16 v[208:211], v[104:107], v[80:83], v[208:211]
    ds_read_b64_tr_b16 v[102:103], v55 offset:9216
    v_mfma_f32_16x16x32_bf16 v[212:215], v[104:107], v[84:87], v[212:215]
    ds_read_b64_tr_b16 v[104:105], v56 offset:8192
    s_waitcnt lgkmcnt(13)
    v_mfma_f32_16x16x32_bf16 v[220:223], v[108:111], v[84:87], v[220:223]
    ds_read_b64_tr_b16 v[106:107], v56 offset:9216
    v_mfma_f32_16x16x32_bf16 v[216:219], v[108:111], v[80:83], v[216:219]
    ds_read_b64_tr_b16 v[108:109], v57 offset:8192
    s_waitcnt lgkmcnt(13)
    v_mfma_f32_16x16x32_bf16 v[224:227], v[112:115], v[80:83], v[224:227]
    ds_read_b64_tr_b16 v[110:111], v57 offset:9216
    v_mfma_f32_16x16x32_bf16 v[228:231], v[112:115], v[84:87], v[228:231]
    ds_read_b64_tr_b16 v[112:113], v58 offset:8192
    s_waitcnt lgkmcnt(13)
    v_mfma_f32_16x16x32_bf16 v[236:239], v[116:119], v[84:87], v[236:239]
    ds_read_b64_tr_b16 v[114:115], v58 offset:9216
    v_mfma_f32_16x16x32_bf16 v[232:235], v[116:119], v[80:83], v[232:235]
    ds_read_b64_tr_b16 v[116:117], v59 offset:8192
    s_waitcnt lgkmcnt(13)
    v_mfma_f32_16x16x32_bf16 v[240:243], v[120:123], v[80:83], v[240:243]
    ds_read_b64_tr_b16 v[118:119], v59 offset:9216
    v_mfma_f32_16x16x32_bf16 v[244:247], v[120:123], v[84:87], v[244:247]
    ds_read_b64_tr_b16 v[120:121], v60 offset:8192
    s_waitcnt lgkmcnt(13)
    v_mfma_f32_16x16x32_bf16 v[252:255], v[124:127], v[84:87], v[252:255]
    ds_read_b64_tr_b16 v[122:123], v60 offset:9216
    v_mfma_f32_16x16x32_bf16 v[248:251], v[124:127], v[80:83], v[248:251]
    ds_read_b64_tr_b16 v[124:125], v61 offset:8192
    ds_read_b64_tr_b16 v[126:127], v61 offset:9216
    buffer_load_dwordx4 v[80:83], v13, s[8:11], s88 offen offset:3072 sc1
    buffer_load_dwordx4 v[84:87], v12, s[8:11], s88 offen offset:3072 sc1
    s_waitcnt vmcnt(13)
    s_waitcnt lgkmcnt(14)
    v_mfma_f32_16x16x32_bf16 v[192:195], v[96:99], v[88:91], v[192:195]
    v_mfma_f32_16x16x32_bf16 v[196:199], v[96:99], v[92:95], v[196:199]
    ds_read_b64_tr_b16 v[96:97], v54 offset:16384
    s_waitcnt lgkmcnt(13)
    v_mfma_f32_16x16x32_bf16 v[204:207], v[100:103], v[92:95], v[204:207]
    ds_read_b64_tr_b16 v[98:99], v54 offset:17408
    v_mfma_f32_16x16x32_bf16 v[200:203], v[100:103], v[88:91], v[200:203]
    ds_read_b64_tr_b16 v[100:101], v55 offset:16384
    s_waitcnt lgkmcnt(13)
    v_mfma_f32_16x16x32_bf16 v[208:211], v[104:107], v[88:91], v[208:211]
    ds_read_b64_tr_b16 v[102:103], v55 offset:17408
    v_mfma_f32_16x16x32_bf16 v[212:215], v[104:107], v[92:95], v[212:215]
    ds_read_b64_tr_b16 v[104:105], v56 offset:16384
    s_waitcnt lgkmcnt(13)
    v_mfma_f32_16x16x32_bf16 v[220:223], v[108:111], v[92:95], v[220:223]
    ds_read_b64_tr_b16 v[106:107], v56 offset:17408
    v_mfma_f32_16x16x32_bf16 v[216:219], v[108:111], v[88:91], v[216:219]
    ds_read_b64_tr_b16 v[108:109], v57 offset:16384
    s_waitcnt lgkmcnt(13)
    v_mfma_f32_16x16x32_bf16 v[224:227], v[112:115], v[88:91], v[224:227]
    ds_read_b64_tr_b16 v[110:111], v57 offset:17408
    v_mfma_f32_16x16x32_bf16 v[228:231], v[112:115], v[92:95], v[228:231]
    ds_read_b64_tr_b16 v[112:113], v58 offset:16384
    s_waitcnt lgkmcnt(13)
    v_mfma_f32_16x16x32_bf16 v[236:239], v[116:119], v[92:95], v[236:239]
    ds_read_b64_tr_b16 v[114:115], v58 offset:17408
    v_mfma_f32_16x16x32_bf16 v[232:235], v[116:119], v[88:91], v[232:235]
    ds_read_b64_tr_b16 v[116:117], v59 offset:16384
    s_waitcnt lgkmcnt(13)
    v_mfma_f32_16x16x32_bf16 v[240:243], v[120:123], v[88:91], v[240:243]
    ds_read_b64_tr_b16 v[118:119], v59 offset:17408
    v_mfma_f32_16x16x32_bf16 v[244:247], v[120:123], v[92:95], v[244:247]
    ds_read_b64_tr_b16 v[120:121], v60 offset:16384
    s_waitcnt lgkmcnt(13)
    v_mfma_f32_16x16x32_bf16 v[252:255], v[124:127], v[92:95], v[252:255]
    ds_read_b64_tr_b16 v[122:123], v60 offset:17408
    v_mfma_f32_16x16x32_bf16 v[248:251], v[124:127], v[88:91], v[248:251]
    ds_read_b64_tr_b16 v[124:125], v61 offset:16384
    ds_read_b64_tr_b16 v[126:127], v61 offset:17408
    s_waitcnt vmcnt(10)
    s_waitcnt lgkmcnt(14)
    v_mfma_f32_16x16x32_bf16 v[192:195], v[96:99], v[16:19], v[192:195]
    v_mfma_f32_16x16x32_bf16 v[196:199], v[96:99], v[20:23], v[196:199]
    ds_read_b64_tr_b16 v[96:97], v54 offset:24576
    s_waitcnt lgkmcnt(13)
    v_mfma_f32_16x16x32_bf16 v[204:207], v[100:103], v[20:23], v[204:207]
    ds_read_b64_tr_b16 v[98:99], v54 offset:25600
    v_mfma_f32_16x16x32_bf16 v[200:203], v[100:103], v[16:19], v[200:203]
    ds_read_b64_tr_b16 v[100:101], v55 offset:24576
    s_waitcnt lgkmcnt(13)
    v_mfma_f32_16x16x32_bf16 v[208:211], v[104:107], v[16:19], v[208:211]
    ds_read_b64_tr_b16 v[102:103], v55 offset:25600
    v_mfma_f32_16x16x32_bf16 v[212:215], v[104:107], v[20:23], v[212:215]
    ds_read_b64_tr_b16 v[104:105], v56 offset:24576
    s_waitcnt lgkmcnt(13)
    v_mfma_f32_16x16x32_bf16 v[220:223], v[108:111], v[20:23], v[220:223]
    ds_read_b64_tr_b16 v[106:107], v56 offset:25600
    v_mfma_f32_16x16x32_bf16 v[216:219], v[108:111], v[16:19], v[216:219]
    ds_read_b64_tr_b16 v[108:109], v57 offset:24576
    s_waitcnt lgkmcnt(13)
    v_mfma_f32_16x16x32_bf16 v[224:227], v[112:115], v[16:19], v[224:227]
    ds_read_b64_tr_b16 v[110:111], v57 offset:25600
    v_mfma_f32_16x16x32_bf16 v[228:231], v[112:115], v[20:23], v[228:231]
    ds_read_b64_tr_b16 v[112:113], v58 offset:24576
    s_waitcnt lgkmcnt(13)
    v_mfma_f32_16x16x32_bf16 v[236:239], v[116:119], v[20:23], v[236:239]
    ds_read_b64_tr_b16 v[114:115], v58 offset:25600
    v_mfma_f32_16x16x32_bf16 v[232:235], v[116:119], v[16:19], v[232:235]
    ds_read_b64_tr_b16 v[116:117], v59 offset:24576
    s_waitcnt lgkmcnt(13)
    v_mfma_f32_16x16x32_bf16 v[240:243], v[120:123], v[16:19], v[240:243]
    ds_read_b64_tr_b16 v[118:119], v59 offset:25600
    v_mfma_f32_16x16x32_bf16 v[244:247], v[120:123], v[20:23], v[244:247]
    ds_read_b64_tr_b16 v[120:121], v60 offset:24576
    s_waitcnt lgkmcnt(13)
    v_mfma_f32_16x16x32_bf16 v[252:255], v[124:127], v[20:23], v[252:255]
    ds_read_b64_tr_b16 v[122:123], v60 offset:25600
    v_mfma_f32_16x16x32_bf16 v[248:251], v[124:127], v[16:19], v[248:251]
    ds_read_b64_tr_b16 v[124:125], v61 offset:24576
    ds_read_b64_tr_b16 v[126:127], v61 offset:25600
    s_waitcnt vmcnt(8)
    s_waitcnt lgkmcnt(14)
    v_mfma_f32_16x16x32_bf16 v[192:195], v[96:99], v[24:27], v[192:195]
    v_mfma_f32_16x16x32_bf16 v[196:199], v[96:99], v[28:31], v[196:199]
    ds_read_b64_tr_b16 v[96:97], v54 offset:32768
    s_waitcnt lgkmcnt(13)
    v_mfma_f32_16x16x32_bf16 v[204:207], v[100:103], v[28:31], v[204:207]
    ds_read_b64_tr_b16 v[98:99], v54 offset:33792
    v_mfma_f32_16x16x32_bf16 v[200:203], v[100:103], v[24:27], v[200:203]
    ds_read_b64_tr_b16 v[100:101], v55 offset:32768
    s_waitcnt lgkmcnt(13)
    v_mfma_f32_16x16x32_bf16 v[208:211], v[104:107], v[24:27], v[208:211]
    ds_read_b64_tr_b16 v[102:103], v55 offset:33792
    v_mfma_f32_16x16x32_bf16 v[212:215], v[104:107], v[28:31], v[212:215]
    ds_read_b64_tr_b16 v[104:105], v56 offset:32768
    s_waitcnt lgkmcnt(13)
    v_mfma_f32_16x16x32_bf16 v[220:223], v[108:111], v[28:31], v[220:223]
    ds_read_b64_tr_b16 v[106:107], v56 offset:33792
    v_mfma_f32_16x16x32_bf16 v[216:219], v[108:111], v[24:27], v[216:219]
    ds_read_b64_tr_b16 v[108:109], v57 offset:32768
    s_waitcnt lgkmcnt(13)
    v_mfma_f32_16x16x32_bf16 v[224:227], v[112:115], v[24:27], v[224:227]
    ds_read_b64_tr_b16 v[110:111], v57 offset:33792
    v_mfma_f32_16x16x32_bf16 v[228:231], v[112:115], v[28:31], v[228:231]
    ds_read_b64_tr_b16 v[112:113], v58 offset:32768
    s_waitcnt lgkmcnt(13)
    v_mfma_f32_16x16x32_bf16 v[236:239], v[116:119], v[28:31], v[236:239]
    ds_read_b64_tr_b16 v[114:115], v58 offset:33792
    v_mfma_f32_16x16x32_bf16 v[232:235], v[116:119], v[24:27], v[232:235]
    ds_read_b64_tr_b16 v[116:117], v59 offset:32768
    s_waitcnt lgkmcnt(13)
    v_mfma_f32_16x16x32_bf16 v[240:243], v[120:123], v[24:27], v[240:243]
    ds_read_b64_tr_b16 v[118:119], v59 offset:33792
    v_mfma_f32_16x16x32_bf16 v[244:247], v[120:123], v[28:31], v[244:247]
    ds_read_b64_tr_b16 v[120:121], v60 offset:32768
    s_waitcnt lgkmcnt(13)
    v_mfma_f32_16x16x32_bf16 v[252:255], v[124:127], v[28:31], v[252:255]
    ds_read_b64_tr_b16 v[122:123], v60 offset:33792
    v_mfma_f32_16x16x32_bf16 v[248:251], v[124:127], v[24:27], v[248:251]
    ds_read_b64_tr_b16 v[124:125], v61 offset:32768
    ds_read_b64_tr_b16 v[126:127], v61 offset:33792
    s_waitcnt vmcnt(0)
    s_cmp_ge_u32 s3, 4
    s_cbranch_scc1 L_q_nold
    s_lshl_b32 s7, s4, 10
    s_add_u32 s7, s7, 3866624
    v_lshrrev_b32 v2, 3, v1
    v_and_b32 v3, 7, v1
    v_lshlrev_b32 v3, 2, v3
    v_lshl_add_u32 v3, v2, 7, v3
    s_mov_b32 s79, 262144
L_poll_7:
    buffer_load_dword v2, v3, s[8:11], s7 offen sc1
    s_waitcnt vmcnt(0)
    v_cmp_gt_u32 vcc, 1, v2
    s_cbranch_vccz L_polldone_8
    s_sleep 2
    s_sub_u32 s79, s79, 1
    s_cmp_lg_u32 s79, 0
    s_cbranch_scc1 L_poll_7
L_polldone_8:
    s_lshl_b32 s6, s76, 13
    s_add_u32 s6, s6, s78
    s_add_u32 m0, s6, 0
    s_add_u32 s7, s77, 0
    buffer_load_dwordx4 v49, s[8:11], s7 offen offset:0 sc1 lds
    buffer_load_dwordx4 v49, s[8:11], s7 offen offset:1024 sc1 lds
    buffer_load_dwordx4 v49, s[8:11], s7 offen offset:2048 sc1 lds
    buffer_load_dwordx4 v49, s[8:11], s7 offen offset:3072 sc1 lds
    s_lshl_b32 s6, s76, 13
    s_add_u32 s6, s6, s78
    s_add_u32 m0, s6, 4096
    s_add_u32 s7, s77, 4096
    buffer_load_dwordx4 v49, s[8:11], s7 offen offset:0 sc1 lds
    buffer_load_dwordx4 v49, s[8:11], s7 offen offset:1024 sc1 lds
    buffer_load_dwordx4 v49, s[8:11], s7 offen offset:2048 sc1 lds
    buffer_load_dwordx4 v49, s[8:11], s7 offen offset:3072 sc1 lds
    s_lshl_b32 s6, s76, 12
    s_add_u32 s6, s6, s78
    s_add_u32 m0, s6, 49152
    s_add_u32 s7, s77, 524288
    buffer_load_dwordx4 v50, s[8:11], s7 offen offset:0 sc1 lds
    buffer_load_dwordx4 v50, s[8:11], s7 offen offset:1024 sc1 lds
    buffer_load_dwordx4 v50, s[8:11], s7 offen offset:2048 sc1 lds
    buffer_load_dwordx4 v50, s[8:11], s7 offen offset:3072 sc1 lds
L_q_nold:
    s_waitcnt lgkmcnt(14)
    v_mfma_f32_16x16x32_bf16 v[192:195], v[96:99], v[32:35], v[192:195]
    v_mfma_f32_16x16x32_bf16 v[196:199], v[96:99], v[36:39], v[196:199]
    ds_read_b64_tr_b16 v[96:97], v54 offset:40960
    s_waitcnt lgkmcnt(13)
    v_mfma_f32_16x16x32_bf16 v[204:207], v[100:103], v[36:39], v[204:207]
    ds_read_b64_tr_b16 v[98:99], v54 offset:41984
    v_mfma_f32_16x16x32_bf16 v[200:203], v[100:103], v[32:35], v[200:203]
    ds_read_b64_tr_b16 v[100:101], v55 offset:40960
    s_waitcnt lgkmcnt(13)
    v_mfma_f32_16x16x32_bf16 v[208:211], v[104:107], v[32:35], v[208:211]
    ds_read_b64_tr_b16 v[102:103], v55 offset:41984
    v_mfma_f32_16x16x32_bf16 v[212:215], v[104:107], v[36:39], v[212:215]
    ds_read_b64_tr_b16 v[104:105], v56 offset:40960
    s_waitcnt lgkmcnt(13)
    v_mfma_f32_16x16x32_bf16 v[220:223], v[108:111], v[36:39], v[220:223]
    ds_read_b64_tr_b16 v[106:107], v56 offset:41984
    buffer_store_dwordx4 v[144:147], v13, s[8:11], s67 offen sc1
    s_add_u32 s67, s67, 1024
    v_mfma_f32_16x16x32_bf16 v[216:219], v[108:111], v[32:35], v[216:219]
    ds_read_b64_tr_b16 v[108:109], v57 offset:40960
    s_waitcnt lgkmcnt(13)
    v_mfma_f32_16x16x32_bf16 v[224:227], v[112:115], v[32:35], v[224:227]
    ds_read_b64_tr_b16 v[110:111], v57 offset:41984
    v_mfma_f32_16x16x32_bf16 v[228:231], v[112:115], v[36:39], v[228:231]
    ds_read_b64_tr_b16 v[112:113], v58 offset:40960
    s_waitcnt lgkmcnt(13)
    v_mfma_f32_16x16x32_bf16 v[236:239], v[116:119], v[36:39], v[236:239]
    ds_read_b64_tr_b16 v[114:115], v58 offset:41984
    v_mfma_f32_16x16x32_bf16 v[232:235], v[116:119], v[32:35], v[232:235]
    ds_read_b64_tr_b16 v[116:117], v59 offset:40960
    s_waitcnt lgkmcnt(13)
    v_mfma_f32_16x16x32_bf16 v[240:243], v[120:123], v[32:35], v[240:243]
    ds_read_b64_tr_b16 v[118:119], v59 offset:41984
    v_mfma_f32_16x16x32_bf16 v[244:247], v[120:123], v[36:39], v[244:247]
    ds_read_b64_tr_b16 v[120:121], v60 offset:40960
    s_waitcnt lgkmcnt(13)
    v_mfma_f32_16x16x32_bf16 v[252:255], v[124:127], v[36:39], v[252:255]
    ds_read_b64_tr_b16 v[122:123], v60 offset:41984
    v_mfma_f32_16x16x32_bf16 v[248:251], v[124:127], v[32:35], v[248:251]
    ds_read_b64_tr_b16 v[124:125], v61 offset:40960
    ds_read_b64_tr_b16 v[126:127], v61 offset:41984
    s_waitcnt lgkmcnt(14)
    v_mfma_f32_16x16x32_bf16 v[192:195], v[96:99], v[64:67], v[192:195]
    v_mfma_f32_16x16x32_bf16 v[196:199], v[96:99], v[68:71], v[196:199]
    ds_read_b64_tr_b16 v[96:97], v54 offset:49152
    s_waitcnt lgkmcnt(13)
    v_mfma_f32_16x16x32_bf16 v[204:207], v[100:103], v[68:71], v[204:207]
    ds_read_b64_tr_b16 v[98:99], v54 offset:50176
    v_mfma_f32_16x16x32_bf16 v[200:203], v[100:103], v[64:67], v[200:203]
    ds_read_b64_tr_b16 v[100:101], v55 offset:49152
    s_waitcnt lgkmcnt(13)
    v_mfma_f32_16x16x32_bf16 v[208:211], v[104:107], v[64:67], v[208:211]
    ds_read_b64_tr_b16 v[102:103], v55 offset:50176
    v_mfma_f32_16x16x32_bf16 v[212:215], v[104:107], v[68:71], v[212:215]
    ds_read_b64_tr_b16 v[104:105], v56 offset:49152
    s_waitcnt lgkmcnt(13)
    v_mfma_f32_16x16x32_bf16 v[220:223], v[108:111], v[68:71], v[220:223]
    ds_read_b64_tr_b16 v[106:107], v56 offset:50176
    buffer_store_dwordx4 v[148:151], v13, s[8:11], s67 offen sc1
    s_add_u32 s67, s67, s68
    v_mfma_f32_16x16x32_bf16 v[216:219], v[108:111], v[64:67], v[216:219]
    ds_read_b64_tr_b16 v[108:109], v57 offset:49152
    s_waitcnt lgkmcnt(13)
    v_mfma_f32_16x16x32_bf16 v[224:227], v[112:115], v[64:67], v[224:227]
    ds_read_b64_tr_b16 v[110:111], v57 offset:50176
    v_mfma_f32_16x16x32_bf16 v[228:231], v[112:115], v[68:71], v[228:231]
    ds_read_b64_tr_b16 v[112:113], v58 offset:49152
    s_waitcnt lgkmcnt(13)
    v_mfma_f32_16x16x32_bf16 v[236:239], v[116:119], v[68:71], v[236:239]
    ds_read_b64_tr_b16 v[114:115], v58 offset:50176
    v_mfma_f32_16x16x32_bf16 v[232:235], v[116:119], v[64:67], v[232:235]
    ds_read_b64_tr_b16 v[116:117], v59 offset:49152
    s_waitcnt lgkmcnt(13)
    v_mfma_f32_16x16x32_bf16 v[240:243], v[120:123], v[64:67], v[240:243]
    ds_read_b64_tr_b16 v[118:119], v59 offset:50176
    v_mfma_f32_16x16x32_bf16 v[244:247], v[120:123], v[68:71], v[244:247]
    ds_read_b64_tr_b16 v[120:121], v60 offset:49152
    s_waitcnt lgkmcnt(13)
    v_mfma_f32_16x16x32_bf16 v[252:255], v[124:127], v[68:71], v[252:255]
    ds_read_b64_tr_b16 v[122:123], v60 offset:50176
    v_mfma_f32_16x16x32_bf16 v[248:251], v[124:127], v[64:67], v[248:251]
    ds_read_b64_tr_b16 v[124:125], v61 offset:49152
    ds_read_b64_tr_b16 v[126:127], v61 offset:50176
    s_waitcnt lgkmcnt(14)
    v_mfma_f32_16x16x32_bf16 v[192:195], v[96:99], v[72:75], v[192:195]
    v_mfma_f32_16x16x32_bf16 v[196:199], v[96:99], v[76:79], v[196:199]
    ds_read_b64_tr_b16 v[96:97], v54 offset:57344
    s_waitcnt lgkmcnt(13)
    v_mfma_f32_16x16x32_bf16 v[204:207], v[100:103], v[76:79], v[204:207]
    ds_read_b64_tr_b16 v[98:99], v54 offset:58368
    v_mfma_f32_16x16x32_bf16 v[200:203], v[100:103], v[72:75], v[200:203]
    ds_read_b64_tr_b16 v[100:101], v55 offset:57344
    s_waitcnt lgkmcnt(13)
    v_mfma_f32_16x16x32_bf16 v[208:211], v[104:107], v[72:75], v[208:211]
    ds_read_b64_tr_b16 v[102:103], v55 offset:58368
    v_mfma_f32_16x16x32_bf16 v[212:215], v[104:107], v[76:79], v[212:215]
    ds_read_b64_tr_b16 v[104:105], v56 offset:57344
    s_waitcnt lgkmcnt(13)
    v_mfma_f32_16x16x32_bf16 v[220:223], v[108:111], v[76:79], v[220:223]
    ds_read_b64_tr_b16 v[106:107], v56 offset:58368
    buffer_store_dwordx4 v[152:155], v13, s[8:11], s67 offen sc1
    s_add_u32 s67, s67, 1024
    v_mfma_f32_16x16x32_bf16 v[216:219], v[108:111], v[72:75], v[216:219]
    ds_read_b64_tr_b16 v[108:109], v57 offset:57344
    s_waitcnt lgkmcnt(13)
    v_mfma_f32_16x16x32_bf16 v[224:227], v[112:115], v[72:75], v[224:227]
    ds_read_b64_tr_b16 v[110:111], v57 offset:58368
    v_mfma_f32_16x16x32_bf16 v[228:231], v[112:115], v[76:79], v[228:231]
    ds_read_b64_tr_b16 v[112:113], v58 offset:57344
    s_waitcnt lgkmcnt(13)
    v_mfma_f32_16x16x32_bf16 v[236:239], v[116:119], v[76:79], v[236:239]
    ds_read_b64_tr_b16 v[114:115], v58 offset:58368
    v_mfma_f32_16x16x32_bf16 v[232:235], v[116:119], v[72:75], v[232:235]
    ds_read_b64_tr_b16 v[116:117], v59 offset:57344
    s_waitcnt lgkmcnt(13)
    v_mfma_f32_16x16x32_bf16 v[240:243], v[120:123], v[72:75], v[240:243]
    ds_read_b64_tr_b16 v[118:119], v59 offset:58368
    v_mfma_f32_16x16x32_bf16 v[244:247], v[120:123], v[76:79], v[244:247]
    ds_read_b64_tr_b16 v[120:121], v60 offset:57344
    s_waitcnt lgkmcnt(13)
    v_mfma_f32_16x16x32_bf16 v[252:255], v[124:127], v[76:79], v[252:255]
    ds_read_b64_tr_b16 v[122:123], v60 offset:58368
    v_mfma_f32_16x16x32_bf16 v[248:251], v[124:127], v[72:75], v[248:251]
    ds_read_b64_tr_b16 v[124:125], v61 offset:57344
    ds_read_b64_tr_b16 v[126:127], v61 offset:58368
    s_waitcnt lgkmcnt(14)
    v_mfma_f32_16x16x32_bf16 v[192:195], v[96:99], v[80:83], v[192:195]
    v_mfma_f32_16x16x32_bf16 v[196:199], v[96:99], v[84:87], v[196:199]
    s_waitcnt lgkmcnt(12)
    v_mfma_f32_16x16x32_bf16 v[204:207], v[100:103], v[84:87], v[204:207]
    v_mfma_f32_16x16x32_bf16 v[200:203], v[100:103], v[80:83], v[200:203]
    s_waitcnt lgkmcnt(10)
    v_mfma_f32_16x16x32_bf16 v[208:211], v[104:107], v[80:83], v[208:211]
    v_mfma_f32_16x16x32_bf16 v[212:215], v[104:107], v[84:87], v[212:215]
    s_waitcnt lgkmcnt(8)
    v_mfma_f32_16x16x32_bf16 v[220:223], v[108:111], v[84:87], v[220:223]
    buffer_store_dwordx4 v[156:159], v13, s[8:11], s67 offen sc1
    s_add_u32 s67, s67, s69
    v_mfma_f32_16x16x32_bf16 v[216:219], v[108:111], v[80:83], v[216:219]
    s_waitcnt lgkmcnt(6)
    v_mfma_f32_16x16x32_bf16 v[224:227], v[112:115], v[80:83], v[224:227]
    v_mfma_f32_16x16x32_bf16 v[228:231], v[112:115], v[84:87], v[228:231]
    s_waitcnt lgkmcnt(4)
    v_mfma_f32_16x16x32_bf16 v[236:239], v[116:119], v[84:87], v[236:239]
    v_mfma_f32_16x16x32_bf16 v[232:235], v[116:119], v[80:83], v[232:235]
    s_waitcnt lgkmcnt(2)
    v_mfma_f32_16x16x32_bf16 v[240:243], v[120:123], v[80:83], v[240:243]
    v_mfma_f32_16x16x32_bf16 v[244:247], v[120:123], v[84:87], v[244:247]
    s_waitcnt lgkmcnt(0)
    v_mfma_f32_16x16x32_bf16 v[252:255], v[124:127], v[84:87], v[252:255]
    v_mfma_f32_16x16x32_bf16 v[248:251], v[124:127], v[80:83], v[248:251]
    s_cmp_lt_u32 s3, 4
    s_cbranch_scc1 L_qb
    s_barrier
L_qb:
    s_mov_b32 s6, 0x3e0293ee
    s_nop 7
    buffer_store_dwordx4 v[160:163], v13, s[8:11], s67 offen sc1
    s_add_u32 s67, s67, 1024
    buffer_store_dwordx4 v[164:167], v13, s[8:11], s67 offen sc1
    s_add_u32 s67, s67, s68
    buffer_store_dwordx4 v[168:171], v13, s[8:11], s67 offen sc1
    s_add_u32 s67, s67, 1024
    buffer_store_dwordx4 v[172:175], v13, s[8:11], s67 offen sc1
    s_add_u32 s67, s67, s69
    v_mul_f32 v192, s6, v192
    v_mul_f32 v193, s6, v193
    v_mul_f32 v194, s6, v194
    v_mul_f32 v195, s6, v195
    v_cvt_pk_bf16_f32 v16, v192, v193
    v_cvt_pk_bf16_f32 v17, v194, v195
    v_mul_f32 v200, s6, v200
    v_mul_f32 v201, s6, v201
    v_mul_f32 v202, s6, v202
    v_mul_f32 v203, s6, v203
    v_cvt_pk_bf16_f32 v18, v200, v201
    v_cvt_pk_bf16_f32 v19, v202, v203
    v_mul_f32 v208, s6, v208
    v_mul_f32 v209, s6, v209
    v_mul_f32 v210, s6, v210
    v_mul_f32 v211, s6, v211
    v_cvt_pk_bf16_f32 v20, v208, v209
    v_cvt_pk_bf16_f32 v21, v210, v211
    v_mul_f32 v216, s6, v216
    v_mul_f32 v217, s6, v217
    v_mul_f32 v218, s6, v218
    v_mul_f32 v219, s6, v219
    v_cvt_pk_bf16_f32 v22, v216, v217
    v_cvt_pk_bf16_f32 v23, v218, v219
    v_mul_f32 v224, s6, v224
    v_mul_f32 v225, s6, v225
    v_mul_f32 v226, s6, v226
    v_mul_f32 v227, s6, v227
    v_cvt_pk_bf16_f32 v24, v224, v225
    v_cvt_pk_bf16_f32 v25, v226, v227
    v_mul_f32 v232, s6, v232
    v_mul_f32 v233, s6, v233
    v_mul_f32 v234, s6, v234
    v_mul_f32 v235, s6, v235
    v_cvt_pk_bf16_f32 v26, v232, v233
    v_cvt_pk_bf16_f32 v27, v234, v235
    v_mul_f32 v240, s6, v240
    v_mul_f32 v241, s6, v241
    v_mul_f32 v242, s6, v242
    v_mul_f32 v243, s6, v243
    v_cvt_pk_bf16_f32 v28, v240, v241
    v_cvt_pk_bf16_f32 v29, v242, v243
    v_mul_f32 v248, s6, v248
    v_mul_f32 v249, s6, v249
    v_mul_f32 v250, s6, v250
    v_mul_f32 v251, s6, v251
    v_cvt_pk_bf16_f32 v30, v248, v249
    v_cvt_pk_bf16_f32 v31, v250, v251
    v_mul_f32 v196, s6, v196
    v_mul_f32 v197, s6, v197
    v_mul_f32 v198, s6, v198
    v_mul_f32 v199, s6, v199
    v_cvt_pk_bf16_f32 v32, v196, v197
    v_cvt_pk_bf16_f32 v33, v198, v199
    v_mul_f32 v204, s6, v204
    v_mul_f32 v205, s6, v205
    v_mul_f32 v206, s6, v206
    v_mul_f32 v207, s6, v207
    v_cvt_pk_bf16_f32 v34, v204, v205
    v_cvt_pk_bf16_f32 v35, v206, v207
    v_mul_f32 v212, s6, v212
    v_mul_f32 v213, s6, v213
    v_mul_f32 v214, s6, v214
    v_mul_f32 v215, s6, v215
    v_cvt_pk_bf16_f32 v36, v212, v213
    v_cvt_pk_bf16_f32 v37, v214, v215
    v_mul_f32 v220, s6, v220
    v_mul_f32 v221, s6, v221
    v_mul_f32 v222, s6, v222
    v_mul_f32 v223, s6, v223
    v_cvt_pk_bf16_f32 v38, v220, v221
    v_cvt_pk_bf16_f32 v39, v222, v223
    v_mul_f32 v228, s6, v228
    v_mul_f32 v229, s6, v229
    v_mul_f32 v230, s6, v230
    v_mul_f32 v231, s6, v231
    v_cvt_pk_bf16_f32 v40, v228, v229
    v_cvt_pk_bf16_f32 v41, v230, v231
    v_mul_f32 v236, s6, v236
    v_mul_f32 v237, s6, v237
    v_mul_f32 v238, s6, v238
    v_mul_f32 v239, s6, v239
    v_cvt_pk_bf16_f32 v42, v236, v237
    v_cvt_pk_bf16_f32 v43, v238, v239
    v_mul_f32 v244, s6, v244
    v_mul_f32 v245, s6, v245
    v_mul_f32 v246, s6, v246
    v_mul_f32 v247, s6, v247
    v_cvt_pk_bf16_f32 v44, v244, v245
    v_cvt_pk_bf16_f32 v45, v246, v247
    v_mul_f32 v252, s6, v252
    v_mul_f32 v253, s6, v253
    v_mul_f32 v254, s6, v254
    v_mul_f32 v255, s6, v255
    v_cvt_pk_bf16_f32 v46, v252, v253
    v_cvt_pk_bf16_f32 v47, v254, v255
    v_mov_b64 v[192:193], 0
    v_mov_b64 v[194:195], 0
    v_mov_b64 v[196:197], 0
    v_mov_b64 v[198:199], 0
    v_mov_b64 v[200:201], 0
    v_mov_b64 v[202:203], 0
    v_mov_b64 v[204:205], 0
    v_mov_b64 v[206:207], 0
    v_mov_b64 v[208:209], 0
    v_mov_b64 v[210:211], 0
    v_mov_b64 v[212:213], 0
    v_mov_b64 v[214:215], 0
    v_mov_b64 v[216:217], 0
    v_mov_b64 v[218:219], 0
    v_mov_b64 v[220:221], 0
    v_mov_b64 v[222:223], 0
    v_mov_b64 v[224:225], 0
    v_mov_b64 v[226:227], 0
    v_mov_b64 v[228:229], 0
    v_mov_b64 v[230:231], 0
    v_mov_b64 v[232:233], 0
    v_mov_b64 v[234:235], 0
    v_mov_b64 v[236:237], 0
    v_mov_b64 v[238:239], 0
    v_mov_b64 v[240:241], 0
    v_mov_b64 v[242:243], 0
    v_mov_b64 v[244:245], 0
    v_mov_b64 v[246:247], 0
    v_mov_b64 v[248:249], 0
    v_mov_b64 v[250:251], 0
    v_mov_b64 v[252:253], 0
    v_mov_b64 v[254:255], 0
    v_mov_b64 v[144:145], 0
    v_mov_b64 v[146:147], 0
    v_mov_b64 v[148:149], 0
    v_mov_b64 v[150:151], 0
    v_mov_b64 v[152:153], 0
    v_mov_b64 v[154:155], 0
    v_mov_b64 v[156:157], 0
    v_mov_b64 v[158:159], 0
    v_mov_b64 v[160:161], 0
    v_mov_b64 v[162:163], 0
    v_bfe_u32 v2, v1, 1, 1
    v_lshrrev_b32 v3, 5, v1
    v_cmp_eq_u32 vcc, v2, v3
    v_mov_b32 v2, 0x3f803f80
    v_and_b32 v3, 1, v1
    v_mul_u32_u24 v3, 0xaaaa, v3
    v_add_u32 v168, 0x4444, v3
    v_cndmask_b32 v164, 0, v2, vcc
    v_cndmask_b32 v165, 0, v2, vcc
    v_cndmask_b32 v166, 0, v2, vcc
    v_cndmask_b32 v167, 0, v2, vcc
    v_add_u32 v48, s100, v13
    s_waitcnt vmcnt(8)
    s_mov_b32 s72, 0x40004000
    s_mov_b32 s65, 0
    s_sub_u32 s63, 15, s5
    s_mov_b32 s62, -1
    s_cmp_ge_u32 s3, 4
    s_cbranch_scc1 L_qb2
    s_barrier
L_qb2:
    ds_read_b128 v[96:99], v48 offset:0
    ds_read_b128 v[100:103], v48 offset:1024
    ds_read_b128 v[104:107], v48 offset:2048
    ds_read_b128 v[108:111], v48 offset:3072
    ds_read_b128 v[112:115], v48 offset:4096
    ds_read_b128 v[116:119], v48 offset:5120
    ds_read_b128 v[120:123], v48 offset:6144
    ds_read_b128 v[124:127], v48 offset:7168
    s_cmp_lg_u32 s60, 0
    s_cbranch_scc1 L_nm0
    s_call_b64 s[82:83], L_mask
L_nm0:
    s_waitcnt lgkmcnt(7)
    v_mfma_f32_16x16x32_bf16 v[64:67], v[96:99], v[16:19], v[144:147]
    v_mfma_f32_16x16x32_bf16 v[68:71], v[96:99], v[32:35], v[148:151]
    ds_read_b128 v[96:99], v48 offset:8192
    s_waitcnt lgkmcnt(7)
    v_mfma_f32_16x16x32_bf16 v[64:67], v[100:103], v[20:23], v[64:67]
    v_mfma_f32_16x16x32_bf16 v[68:71], v[100:103], v[36:39], v[68:71]
    ds_read_b128 v[100:103], v48 offset:9216
    s_waitcnt lgkmcnt(7)
    v_mfma_f32_16x16x32_bf16 v[64:67], v[104:107], v[24:27], v[64:67]
    v_mfma_f32_16x16x32_bf16 v[68:71], v[104:107], v[40:43], v[68:71]
    ds_read_b128 v[104:107], v48 offset:10240
    s_waitcnt lgkmcnt(7)
    v_mfma_f32_16x16x32_bf16 v[64:67], v[108:111], v[28:31], v[64:67]
    v_mfma_f32_16x16x32_bf16 v[68:71], v[108:111], v[44:47], v[68:71]
    ds_read_b128 v[108:111], v48 offset:11264
    s_waitcnt lgkmcnt(7)
    v_mfma_f32_16x16x32_bf16 v[72:75], v[112:115], v[16:19], v[152:155]
    v_mfma_f32_16x16x32_bf16 v[76:79], v[112:115], v[32:35], v[156:159]
    ds_read_b128 v[112:115], v48 offset:12288
    s_waitcnt lgkmcnt(7)
    v_mfma_f32_16x16x32_bf16 v[72:75], v[116:119], v[20:23], v[72:75]
    v_mfma_f32_16x16x32_bf16 v[76:79], v[116:119], v[36:39], v[76:79]
    ds_read_b128 v[116:119], v48 offset:13312
    s_waitcnt lgkmcnt(7)
    v_mfma_f32_16x16x32_bf16 v[72:75], v[120:123], v[24:27], v[72:75]
    v_mfma_f32_16x16x32_bf16 v[76:79], v[120:123], v[40:43], v[76:79]
    ds_read_b128 v[120:123], v48 offset:14336
    s_waitcnt lgkmcnt(7)
    v_mfma_f32_16x16x32_bf16 v[72:75], v[124:127], v[28:31], v[72:75]
    v_mfma_f32_16x16x32_bf16 v[76:79], v[124:127], v[44:47], v[76:79]
    ds_read_b128 v[124:127], v48 offset:15360
    s_nop 7
    v_max3_f32 v58, v64, v65, v66
    v_max3_f32 v58, v58, v67, v72
    v_max3_f32 v58, v58, v73, v74
    v_max_f32 v58, v58, v75
    v_mov_b32 v60, v58
    s_nop 1
    v_permlane16_swap_b32 v58, v60
    s_nop 1
    v_max_f32 v58, v58, v60
    v_mov_b32 v60, v58
    s_nop 1
    v_permlane32_swap_b32 v58, v60
    s_nop 1
    v_max_f32 v58, v58, v60
    v_add_f32 v58, 0x41c00000, v58
    v_sub_f32 v64, v64, v58
    v_sub_f32 v144, 0, v58
    v_sub_f32 v65, v65, v58
    v_sub_f32 v145, 0, v58
    v_sub_f32 v66, v66, v58
    v_sub_f32 v146, 0, v58
    v_sub_f32 v67, v67, v58
    v_sub_f32 v147, 0, v58
    v_sub_f32 v72, v72, v58
    v_sub_f32 v152, 0, v58
    v_sub_f32 v73, v73, v58
    v_sub_f32 v153, 0, v58
    v_sub_f32 v74, v74, v58
    v_sub_f32 v154, 0, v58
    v_sub_f32 v75, v75, v58
    v_sub_f32 v155, 0, v58
    v_max3_f32 v59, v68, v69, v70
    v_max3_f32 v59, v59, v71, v76
    v_max3_f32 v59, v59, v77, v78
    v_max_f32 v59, v59, v79
    v_mov_b32 v60, v59
    s_nop 1
    v_permlane16_swap_b32 v59, v60
    s_nop 1
    v_max_f32 v59, v59, v60
    v_mov_b32 v60, v59
    s_nop 1
    v_permlane32_swap_b32 v59, v60
    s_nop 1
    v_max_f32 v59, v59, v60
    v_add_f32 v59, 0x41c00000, v59
    v_sub_f32 v68, v68, v59
    v_sub_f32 v148, 0, v59
    v_sub_f32 v69, v69, v59
    v_sub_f32 v149, 0, v59
    v_sub_f32 v70, v70, v59
    v_sub_f32 v150, 0, v59
    v_sub_f32 v71, v71, v59
    v_sub_f32 v151, 0, v59
    v_sub_f32 v76, v76, v59
    v_sub_f32 v156, 0, v59
    v_sub_f32 v77, v77, v59
    v_sub_f32 v157, 0, v59
    v_sub_f32 v78, v78, v59
    v_sub_f32 v158, 0, v59
    v_sub_f32 v79, v79, v59
    v_sub_f32 v159, 0, v59
    s_cmp_lg_u32 s60, 1
    s_cbranch_scc1 L_nm1
    s_call_b64 s[82:83], L_mask
L_nm1:
    v_exp_f32 v58, v64
    v_exp_f32 v59, v65
    s_waitcnt lgkmcnt(7)
    v_mfma_f32_16x16x32_bf16 v[80:83], v[96:99], v[16:19], v[144:147]
    s_waitcnt lgkmcnt(6)
    v_exp_f32 v60, v66
    v_exp_f32 v61, v67
    v_mfma_f32_16x16x32_bf16 v[84:87], v[96:99], v[32:35], v[148:151]
    ds_read_b128 v[96:99], v48 offset:49152
    v_cvt_pk_bf16_f32 v128, v58, v59
    v_cvt_pk_bf16_f32 v129, v60, v61
    v_mfma_f32_16x16x32_bf16 v[84:87], v[100:103], v[36:39], v[84:87]
    s_waitcnt lgkmcnt(6)
    v_exp_f32 v58, v68
    v_exp_f32 v59, v69
    v_mfma_f32_16x16x32_bf16 v[80:83], v[100:103], v[20:23], v[80:83]
    ds_read_b128 v[100:103], v48 offset:50176
    v_cvt_pk_bf16_f32 v132, v58, v59
    v_mfma_f32_16x16x32_bf16 v[80:83], v[104:107], v[24:27], v[80:83]
    s_waitcnt lgkmcnt(6)
    v_exp_f32 v60, v70
    v_exp_f32 v61, v71
    v_mfma_f32_16x16x32_bf16 v[84:87], v[104:107], v[40:43], v[84:87]
    ds_read_b128 v[104:107], v48 offset:51200
    v_cvt_pk_bf16_f32 v133, v60, v61
    v_mfma_f32_16x16x32_bf16 v[84:87], v[108:111], v[44:47], v[84:87]
    s_waitcnt lgkmcnt(6)
    v_exp_f32 v58, v72
    v_exp_f32 v59, v73
    v_mfma_f32_16x16x32_bf16 v[80:83], v[108:111], v[28:31], v[80:83]
    ds_read_b128 v[108:111], v48 offset:52224
    v_cvt_pk_bf16_f32 v130, v58, v59
    v_mfma_f32_16x16x32_bf16 v[88:91], v[112:115], v[16:19], v[152:155]
    s_waitcnt lgkmcnt(6)
    v_exp_f32 v60, v74
    v_exp_f32 v61, v75
    v_mfma_f32_16x16x32_bf16 v[92:95], v[112:115], v[32:35], v[156:159]
    ds_read_b128 v[112:115], v48 offset:53248
    v_cvt_pk_bf16_f32 v131, v60, v61
    v_mfma_f32_16x16x32_bf16 v[92:95], v[116:119], v[36:39], v[92:95]
    s_waitcnt lgkmcnt(6)
    v_exp_f32 v58, v76
    v_exp_f32 v59, v77
    v_mfma_f32_16x16x32_bf16 v[88:91], v[116:119], v[20:23], v[88:91]
    ds_read_b128 v[116:119], v48 offset:54272
    v_cvt_pk_bf16_f32 v134, v58, v59
    v_mfma_f32_16x16x32_bf16 v[88:91], v[120:123], v[24:27], v[88:91]
    s_waitcnt lgkmcnt(6)
    v_exp_f32 v60, v78
    v_exp_f32 v61, v79
    v_mfma_f32_16x16x32_bf16 v[92:95], v[120:123], v[40:43], v[92:95]
    ds_read_b128 v[120:123], v48 offset:55296
    v_cvt_pk_bf16_f32 v135, v60, v61
    v_mfma_f32_16x16x32_bf16 v[92:95], v[124:127], v[44:47], v[92:95]
    s_waitcnt lgkmcnt(6)
    v_or3_b32 v62, v128, v129, v132
    v_or3_b32 v62, v62, v133, v130
    v_or3_b32 v62, v62, v131, v134
    v_bitop3_b32 v62, v62, v135, s72 bitop3:0xa8
    v_cmp_ne_u32 vcc, s65, v62
    v_mfma_f32_16x16x32_bf16 v[88:91], v[124:127], v[28:31], v[88:91]
    ds_read_b128 v[124:127], v48 offset:56320
    s_cbranch_vccnz L_back_9_h
L_back_9:
    s_nop 7
    v_exp_f32 v58, v80
    v_exp_f32 v59, v81
    s_call_b64 s[82:83], L_load
    s_mov_b32 s62, 0
    buffer_store_dwordx4 v[176:179], v13, s[8:11], s67 offen sc1
    s_add_u32 s67, s67, 1024
    buffer_store_dwordx4 v[180:183], v13, s[8:11], s67 offen sc1
    s_add_u32 s67, s67, s68
    buffer_store_dwordx4 v[184:187], v13, s[8:11], s67 offen sc1
    s_add_u32 s67, s67, 1024
    buffer_store_dwordx4 v[188:191], v13, s[8:11], s67 offen sc1
    s_add_u32 s67, s67, s69
    s_sub_i32 s64, s60, 2
    s_cmp_eq_u32 s60, 0
    s_cbranch_scc1 L_pv2
    s_cmp_eq_u32 s60, 1
    s_cbranch_scc1 L_tail2
    s_cmp_lg_u32 s60, 2
    s_cbranch_scc1 L_st2
    s_call_b64 s[82:83], L_mask
    s_branch L_st2
.p2align 6
L_st0:
    v_mfma_f32_16x16x32_bf16 v[192:195], v[96:99], v[128:131], v[192:195]
    s_waitcnt lgkmcnt(6)
    v_exp_f32 v60, v82
    v_mfma_f32_16x16x32_bf16 v[196:199], v[96:99], v[132:135], v[196:199]
    ds_read_b128 v[96:99], v48 offset:0
    v_cvt_pk_bf16_f32 v136, v58, v59
    v_mfma_f32_16x16x32_bf16 v[204:207], v[100:103], v[132:135], v[204:207]
    s_waitcnt lgkmcnt(6)
    v_exp_f32 v61, v83
    v_mfma_f32_16x16x32_bf16 v[200:203], v[100:103], v[128:131], v[200:203]
    s_sub_i32 s64, s64, 1
    ds_read_b128 v[100:103], v48 offset:1024
    v_cvt_pk_bf16_f32 v137, v60, v61
    v_mfma_f32_16x16x32_bf16 v[208:211], v[104:107], v[128:131], v[208:211]
    s_waitcnt lgkmcnt(6)
    v_exp_f32 v58, v84
    v_mfma_f32_16x16x32_bf16 v[212:215], v[104:107], v[132:135], v[212:215]
    ds_read_b128 v[104:107], v48 offset:2048
    v_mfma_f32_16x16x32_bf16 v[220:223], v[108:111], v[132:135], v[220:223]
    s_waitcnt lgkmcnt(6)
    v_exp_f32 v59, v85
    v_mfma_f32_16x16x32_bf16 v[216:219], v[108:111], v[128:131], v[216:219]
    s_cmp_gt_i32 s64, 0
    ds_read_b128 v[108:111], v48 offset:3072
    v_cvt_pk_bf16_f32 v140, v58, v59
    v_mfma_f32_16x16x32_bf16 v[224:227], v[112:115], v[128:131], v[224:227]
    s_waitcnt lgkmcnt(6)
    v_exp_f32 v60, v86
    v_mfma_f32_16x16x32_bf16 v[228:231], v[112:115], v[132:135], v[228:231]
    ds_read_b128 v[112:115], v48 offset:4096
    v_or3_b32 v62, v136, v137, v140
    v_mfma_f32_16x16x32_bf16 v[236:239], v[116:119], v[132:135], v[236:239]
    s_waitcnt lgkmcnt(6)
    v_exp_f32 v61, v87
    v_mfma_f32_16x16x32_bf16 v[232:235], v[116:119], v[128:131], v[232:235]
    s_cselect_b32 s65, 0, 1
    ds_read_b128 v[116:119], v48 offset:5120
    v_cvt_pk_bf16_f32 v141, v60, v61
    v_mfma_f32_16x16x32_bf16 v[240:243], v[120:123], v[128:131], v[240:243]
    s_waitcnt lgkmcnt(6)
    v_exp_f32 v58, v88
    v_mfma_f32_16x16x32_bf16 v[244:247], v[120:123], v[132:135], v[244:247]
    ds_read_b128 v[120:123], v48 offset:6144
    v_mfma_f32_16x16x32_bf16 v[252:255], v[124:127], v[132:135], v[252:255]
    s_waitcnt lgkmcnt(6)
    v_exp_f32 v59, v89
    v_mfma_f32_16x16x32_bf16 v[248:251], v[124:127], v[128:131], v[248:251]
    ds_read_b128 v[124:127], v48 offset:7168
    v_cvt_pk_bf16_f32 v138, v58, v59
    v_mfma_f32_16x16x32_bf16 v[64:67], v[96:99], v[16:19], v[144:147]
    s_waitcnt lgkmcnt(6)
    v_exp_f32 v60, v90
    v_mfma_f32_16x16x32_bf16 v[68:71], v[96:99], v[32:35], v[148:151]
    ds_read_b128 v[96:99], v48 offset:40960
    v_or3_b32 v62, v62, v141, v138
    v_mfma_f32_16x16x32_bf16 v[68:71], v[100:103], v[36:39], v[68:71]
    s_waitcnt lgkmcnt(6)
    v_exp_f32 v61, v91
    v_mfma_f32_16x16x32_bf16 v[64:67], v[100:103], v[20:23], v[64:67]
    ds_read_b128 v[100:103], v48 offset:41984
    v_cvt_pk_bf16_f32 v139, v60, v61
    v_mfma_f32_16x16x32_bf16 v[64:67], v[104:107], v[24:27], v[64:67]
    s_waitcnt lgkmcnt(6)
    v_exp_f32 v58, v92
    v_mfma_f32_16x16x32_bf16 v[68:71], v[104:107], v[40:43], v[68:71]
    ds_read_b128 v[104:107], v48 offset:43008
    v_mfma_f32_16x16x32_bf16 v[68:71], v[108:111], v[44:47], v[68:71]
    s_waitcnt lgkmcnt(6)
    v_exp_f32 v59, v93
    v_mfma_f32_16x16x32_bf16 v[64:67], v[108:111], v[28:31], v[64:67]
    ds_read_b128 v[108:111], v48 offset:44032
    v_cvt_pk_bf16_f32 v142, v58, v59
    v_mfma_f32_16x16x32_bf16 v[72:75], v[112:115], v[16:19], v[152:155]
    s_waitcnt lgkmcnt(6)
    v_exp_f32 v60, v94
    v_mfma_f32_16x16x32_bf16 v[76:79], v[112:115], v[32:35], v[156:159]
    ds_read_b128 v[112:115], v48 offset:45056
    v_or3_b32 v62, v62, v139, v142
    v_mfma_f32_16x16x32_bf16 v[76:79], v[116:119], v[36:39], v[76:79]
    s_waitcnt lgkmcnt(6)
    v_exp_f32 v61, v95
    v_mfma_f32_16x16x32_bf16 v[72:75], v[116:119], v[20:23], v[72:75]
    ds_read_b128 v[116:119], v48 offset:46080
    v_cvt_pk_bf16_f32 v143, v60, v61
    v_smfmac_f32_16x16x64_bf16 v[160:163], v[164:167], v[128:135], v168
    v_bitop3_b32 v62, v62, v143, s72 bitop3:0xa8
    v_mfma_f32_16x16x32_bf16 v[72:75], v[120:123], v[24:27], v[72:75]
    s_waitcnt lgkmcnt(6)
    v_exp_f32 v58, v64
    v_mfma_f32_16x16x32_bf16 v[76:79], v[120:123], v[40:43], v[76:79]
    ds_read_b128 v[120:123], v48 offset:47104
    v_cmp_ne_u32 vcc, s65, v62
    v_mfma_f32_16x16x32_bf16 v[76:79], v[124:127], v[44:47], v[76:79]
    s_waitcnt lgkmcnt(6)
    v_exp_f32 v59, v65
    v_mfma_f32_16x16x32_bf16 v[72:75], v[124:127], v[28:31], v[72:75]
    ds_read_b128 v[124:127], v48 offset:48128
    s_cbranch_vccnz L_back_10_h
L_back_10:
    v_mfma_f32_16x16x32_bf16 v[192:195], v[96:99], v[136:139], v[192:195]
    s_waitcnt lgkmcnt(6)
    v_exp_f32 v60, v66
    v_mfma_f32_16x16x32_bf16 v[196:199], v[96:99], v[140:143], v[196:199]
    ds_read_b128 v[96:99], v48 offset:8192
    v_cvt_pk_bf16_f32 v128, v58, v59
    v_mfma_f32_16x16x32_bf16 v[204:207], v[100:103], v[140:143], v[204:207]
    s_waitcnt lgkmcnt(6)
    v_exp_f32 v61, v67
    v_mfma_f32_16x16x32_bf16 v[200:203], v[100:103], v[136:139], v[200:203]
    s_sub_i32 s64, s64, 1
    ds_read_b128 v[100:103], v48 offset:9216
    v_cvt_pk_bf16_f32 v129, v60, v61
    v_mfma_f32_16x16x32_bf16 v[208:211], v[104:107], v[136:139], v[208:211]
    s_waitcnt lgkmcnt(6)
    v_exp_f32 v58, v68
    v_mfma_f32_16x16x32_bf16 v[212:215], v[104:107], v[140:143], v[212:215]
    ds_read_b128 v[104:107], v48 offset:10240
    v_mfma_f32_16x16x32_bf16 v[220:223], v[108:111], v[140:143], v[220:223]
    s_waitcnt lgkmcnt(6)
    v_exp_f32 v59, v69
    v_mfma_f32_16x16x32_bf16 v[216:219], v[108:111], v[136:139], v[216:219]
    s_cmp_gt_i32 s64, 0
    ds_read_b128 v[108:111], v48 offset:11264
    v_cvt_pk_bf16_f32 v132, v58, v59
    v_mfma_f32_16x16x32_bf16 v[224:227], v[112:115], v[136:139], v[224:227]
    s_waitcnt lgkmcnt(6)
    v_exp_f32 v60, v70
    v_mfma_f32_16x16x32_bf16 v[228:231], v[112:115], v[140:143], v[228:231]
    ds_read_b128 v[112:115], v48 offset:12288
    v_or3_b32 v62, v128, v129, v132
    v_mfma_f32_16x16x32_bf16 v[236:239], v[116:119], v[140:143], v[236:239]
    s_waitcnt lgkmcnt(6)
    v_exp_f32 v61, v71
    v_mfma_f32_16x16x32_bf16 v[232:235], v[116:119], v[136:139], v[232:235]
    s_cselect_b32 s65, 0, 1
    ds_read_b128 v[116:119], v48 offset:13312
    v_cvt_pk_bf16_f32 v133, v60, v61
    v_mfma_f32_16x16x32_bf16 v[240:243], v[120:123], v[136:139], v[240:243]
    s_waitcnt lgkmcnt(6)
    v_exp_f32 v58, v72
    v_mfma_f32_16x16x32_bf16 v[244:247], v[120:123], v[140:143], v[244:247]
    ds_read_b128 v[120:123], v48 offset:14336
    v_mfma_f32_16x16x32_bf16 v[252:255], v[124:127], v[140:143], v[252:255]
    s_waitcnt lgkmcnt(6)
    v_exp_f32 v59, v73
    v_mfma_f32_16x16x32_bf16 v[248:251], v[124:127], v[136:139], v[248:251]
    ds_read_b128 v[124:127], v48 offset:15360
    v_cvt_pk_bf16_f32 v130, v58, v59
    v_mfma_f32_16x16x32_bf16 v[80:83], v[96:99], v[16:19], v[144:147]
    s_waitcnt lgkmcnt(6)
    v_exp_f32 v60, v74
    v_mfma_f32_16x16x32_bf16 v[84:87], v[96:99], v[32:35], v[148:151]
    ds_read_b128 v[96:99], v48 offset:49152
    v_or3_b32 v62, v62, v133, v130
    v_mfma_f32_16x16x32_bf16 v[84:87], v[100:103], v[36:39], v[84:87]
    s_waitcnt lgkmcnt(6)
    v_exp_f32 v61, v75
    v_mfma_f32_16x16x32_bf16 v[80:83], v[100:103], v[20:23], v[80:83]
    ds_read_b128 v[100:103], v48 offset:50176
    v_cvt_pk_bf16_f32 v131, v60, v61
    v_mfma_f32_16x16x32_bf16 v[80:83], v[104:107], v[24:27], v[80:83]
    s_waitcnt lgkmcnt(6)
    v_exp_f32 v58, v76
    v_mfma_f32_16x16x32_bf16 v[84:87], v[104:107], v[40:43], v[84:87]
    ds_read_b128 v[104:107], v48 offset:51200
    v_mfma_f32_16x16x32_bf16 v[84:87], v[108:111], v[44:47], v[84:87]
    s_waitcnt lgkmcnt(6)
    v_exp_f32 v59, v77
    v_mfma_f32_16x16x32_bf16 v[80:83], v[108:111], v[28:31], v[80:83]
    ds_read_b128 v[108:111], v48 offset:52224
    v_cvt_pk_bf16_f32 v134, v58, v59
    v_mfma_f32_16x16x32_bf16 v[88:91], v[112:115], v[16:19], v[152:155]
    s_waitcnt lgkmcnt(6)
    v_exp_f32 v60, v78
    v_mfma_f32_16x16x32_bf16 v[92:95], v[112:115], v[32:35], v[156:159]
    ds_read_b128 v[112:115], v48 offset:53248
    v_or3_b32 v62, v62, v131, v134
    v_mfma_f32_16x16x32_bf16 v[92:95], v[116:119], v[36:39], v[92:95]
    s_waitcnt lgkmcnt(6)
    v_exp_f32 v61, v79
    v_mfma_f32_16x16x32_bf16 v[88:91], v[116:119], v[20:23], v[88:91]
    ds_read_b128 v[116:119], v48 offset:54272
    v_cvt_pk_bf16_f32 v135, v60, v61
    v_smfmac_f32_16x16x64_bf16 v[160:163], v[164:167], v[136:143], v168
    v_bitop3_b32 v62, v62, v135, s72 bitop3:0xa8
    v_mfma_f32_16x16x32_bf16 v[88:91], v[120:123], v[24:27], v[88:91]
    s_waitcnt lgkmcnt(6)
    v_exp_f32 v58, v80
    v_mfma_f32_16x16x32_bf16 v[92:95], v[120:123], v[40:43], v[92:95]
    ds_read_b128 v[120:123], v48 offset:55296
    v_cmp_ne_u32 vcc, s65, v62
    v_mfma_f32_16x16x32_bf16 v[92:95], v[124:127], v[44:47], v[92:95]
    s_waitcnt lgkmcnt(6)
    v_exp_f32 v59, v81
    v_mfma_f32_16x16x32_bf16 v[88:91], v[124:127], v[28:31], v[88:91]
    ds_read_b128 v[124:127], v48 offset:56320
    s_cbranch_vccnz L_back_11_h
L_back_11:
L_st2:
    v_mfma_f32_16x16x32_bf16 v[192:195], v[96:99], v[128:131], v[192:195]
    s_waitcnt lgkmcnt(6)
    v_exp_f32 v60, v82
    v_mfma_f32_16x16x32_bf16 v[196:199], v[96:99], v[132:135], v[196:199]
    ds_read_b128 v[96:99], v48 offset:16384
    v_cvt_pk_bf16_f32 v136, v58, v59
    v_mfma_f32_16x16x32_bf16 v[204:207], v[100:103], v[132:135], v[204:207]
    s_waitcnt lgkmcnt(6)
    v_exp_f32 v61, v83
    v_mfma_f32_16x16x32_bf16 v[200:203], v[100:103], v[128:131], v[200:203]
    s_sub_i32 s64, s64, 1
    ds_read_b128 v[100:103], v48 offset:17408
    v_cvt_pk_bf16_f32 v137, v60, v61
    v_mfma_f32_16x16x32_bf16 v[208:211], v[104:107], v[128:131], v[208:211]
    s_waitcnt lgkmcnt(6)
    v_exp_f32 v58, v84
    v_mfma_f32_16x16x32_bf16 v[212:215], v[104:107], v[132:135], v[212:215]
    ds_read_b128 v[104:107], v48 offset:18432
    v_mfma_f32_16x16x32_bf16 v[220:223], v[108:111], v[132:135], v[220:223]
    s_waitcnt lgkmcnt(6)
    v_exp_f32 v59, v85
    v_mfma_f32_16x16x32_bf16 v[216:219], v[108:111], v[128:131], v[216:219]
    s_cmp_gt_i32 s64, 0
    ds_read_b128 v[108:111], v48 offset:19456
    v_cvt_pk_bf16_f32 v140, v58, v59
    v_mfma_f32_16x16x32_bf16 v[224:227], v[112:115], v[128:131], v[224:227]
    s_waitcnt lgkmcnt(6)
    v_exp_f32 v60, v86
    v_mfma_f32_16x16x32_bf16 v[228:231], v[112:115], v[132:135], v[228:231]
    ds_read_b128 v[112:115], v48 offset:20480
    v_or3_b32 v62, v136, v137, v140
    v_mfma_f32_16x16x32_bf16 v[236:239], v[116:119], v[132:135], v[236:239]
    s_waitcnt lgkmcnt(6)
    v_exp_f32 v61, v87
    v_mfma_f32_16x16x32_bf16 v[232:235], v[116:119], v[128:131], v[232:235]
    s_cselect_b32 s65, 0, 1
    ds_read_b128 v[116:119], v48 offset:21504
    v_cvt_pk_bf16_f32 v141, v60, v61
    v_mfma_f32_16x16x32_bf16 v[240:243], v[120:123], v[128:131], v[240:243]
    s_waitcnt lgkmcnt(6)
    v_exp_f32 v58, v88
    v_mfma_f32_16x16x32_bf16 v[244:247], v[120:123], v[132:135], v[244:247]
    ds_read_b128 v[120:123], v48 offset:22528
    v_mfma_f32_16x16x32_bf16 v[252:255], v[124:127], v[132:135], v[252:255]
    s_waitcnt lgkmcnt(6)
    v_exp_f32 v59, v89
    v_mfma_f32_16x16x32_bf16 v[248:251], v[124:127], v[128:131], v[248:251]
    ds_read_b128 v[124:127], v48 offset:23552
    v_cvt_pk_bf16_f32 v138, v58, v59
    v_mfma_f32_16x16x32_bf16 v[64:67], v[96:99], v[16:19], v[144:147]
    s_waitcnt lgkmcnt(6)
    v_exp_f32 v60, v90
    v_mfma_f32_16x16x32_bf16 v[68:71], v[96:99], v[32:35], v[148:151]
    ds_read_b128 v[96:99], v48 offset:57344
    v_or3_b32 v62, v62, v141, v138
    v_mfma_f32_16x16x32_bf16 v[68:71], v[100:103], v[36:39], v[68:71]
    s_waitcnt lgkmcnt(6)
    v_exp_f32 v61, v91
    v_mfma_f32_16x16x32_bf16 v[64:67], v[100:103], v[20:23], v[64:67]
    ds_read_b128 v[100:103], v48 offset:58368
    v_cvt_pk_bf16_f32 v139, v60, v61
    v_mfma_f32_16x16x32_bf16 v[64:67], v[104:107], v[24:27], v[64:67]
    s_waitcnt lgkmcnt(6)
    v_exp_f32 v58, v92
    v_mfma_f32_16x16x32_bf16 v[68:71], v[104:107], v[40:43], v[68:71]
    ds_read_b128 v[104:107], v48 offset:59392
    v_mfma_f32_16x16x32_bf16 v[68:71], v[108:111], v[44:47], v[68:71]
    s_waitcnt lgkmcnt(6)
    v_exp_f32 v59, v93
    v_mfma_f32_16x16x32_bf16 v[64:67], v[108:111], v[28:31], v[64:67]
    ds_read_b128 v[108:111], v48 offset:60416
    v_cvt_pk_bf16_f32 v142, v58, v59
    v_mfma_f32_16x16x32_bf16 v[72:75], v[112:115], v[16:19], v[152:155]
    s_waitcnt lgkmcnt(6)
    v_exp_f32 v60, v94
    v_mfma_f32_16x16x32_bf16 v[76:79], v[112:115], v[32:35], v[156:159]
    ds_read_b128 v[112:115], v48 offset:61440
    v_or3_b32 v62, v62, v139, v142
    v_mfma_f32_16x16x32_bf16 v[76:79], v[116:119], v[36:39], v[76:79]
    s_waitcnt lgkmcnt(6)
    v_exp_f32 v61, v95
    v_mfma_f32_16x16x32_bf16 v[72:75], v[116:119], v[20:23], v[72:75]
    ds_read_b128 v[116:119], v48 offset:62464
    v_cvt_pk_bf16_f32 v143, v60, v61
    v_smfmac_f32_16x16x64_bf16 v[160:163], v[164:167], v[128:135], v168
    v_bitop3_b32 v62, v62, v143, s72 bitop3:0xa8
    v_mfma_f32_16x16x32_bf16 v[72:75], v[120:123], v[24:27], v[72:75]
    s_waitcnt lgkmcnt(6)
    v_exp_f32 v58, v64
    v_mfma_f32_16x16x32_bf16 v[76:79], v[120:123], v[40:43], v[76:79]
    ds_read_b128 v[120:123], v48 offset:63488
    v_cmp_ne_u32 vcc, s65, v62
    v_mfma_f32_16x16x32_bf16 v[76:79], v[124:127], v[44:47], v[76:79]
    s_waitcnt lgkmcnt(6)
    v_exp_f32 v59, v65
    v_mfma_f32_16x16x32_bf16 v[72:75], v[124:127], v[28:31], v[72:75]
    ds_read_b128 v[124:127], v48 offset:64512
    s_cbranch_vccnz L_back_12_h
L_back_12:
    v_mfma_f32_16x16x32_bf16 v[192:195], v[96:99], v[136:139], v[192:195]
    s_waitcnt lgkmcnt(6)
    v_exp_f32 v60, v66
    v_mfma_f32_16x16x32_bf16 v[196:199], v[96:99], v[140:143], v[196:199]
    ds_read_b128 v[96:99], v48 offset:24576
    v_cvt_pk_bf16_f32 v128, v58, v59
    v_mfma_f32_16x16x32_bf16 v[204:207], v[100:103], v[140:143], v[204:207]
    s_waitcnt lgkmcnt(6)
    v_exp_f32 v61, v67
    v_mfma_f32_16x16x32_bf16 v[200:203], v[100:103], v[136:139], v[200:203]
    s_sub_i32 s64, s64, 1
    ds_read_b128 v[100:103], v48 offset:25600
    v_cvt_pk_bf16_f32 v129, v60, v61
    v_mfma_f32_16x16x32_bf16 v[208:211], v[104:107], v[136:139], v[208:211]
    s_waitcnt lgkmcnt(6)
    v_exp_f32 v58, v68
    v_mfma_f32_16x16x32_bf16 v[212:215], v[104:107], v[140:143], v[212:215]
    ds_read_b128 v[104:107], v48 offset:26624
    v_mfma_f32_16x16x32_bf16 v[220:223], v[108:111], v[140:143], v[220:223]
    s_waitcnt lgkmcnt(6)
    v_exp_f32 v59, v69
    v_mfma_f32_16x16x32_bf16 v[216:219], v[108:111], v[136:139], v[216:219]
    s_cmp_gt_i32 s64, 0
    ds_read_b128 v[108:111], v48 offset:27648
    v_cvt_pk_bf16_f32 v132, v58, v59
    v_mfma_f32_16x16x32_bf16 v[224:227], v[112:115], v[136:139], v[224:227]
    s_waitcnt lgkmcnt(6)
    v_exp_f32 v60, v70
    v_mfma_f32_16x16x32_bf16 v[228:231], v[112:115], v[140:143], v[228:231]
    ds_read_b128 v[112:115], v48 offset:28672
    v_or3_b32 v62, v128, v129, v132
    v_mfma_f32_16x16x32_bf16 v[236:239], v[116:119], v[140:143], v[236:239]
    s_waitcnt lgkmcnt(6)
    v_exp_f32 v61, v71
    v_mfma_f32_16x16x32_bf16 v[232:235], v[116:119], v[136:139], v[232:235]
    s_cselect_b32 s65, 0, 1
    ds_read_b128 v[116:119], v48 offset:29696
    v_cvt_pk_bf16_f32 v133, v60, v61
    v_mfma_f32_16x16x32_bf16 v[240:243], v[120:123], v[136:139], v[240:243]
    s_waitcnt lgkmcnt(6)
    v_exp_f32 v58, v72
    v_mfma_f32_16x16x32_bf16 v[244:247], v[120:123], v[140:143], v[244:247]
    ds_read_b128 v[120:123], v48 offset:30720
    v_mfma_f32_16x16x32_bf16 v[252:255], v[124:127], v[140:143], v[252:255]
    s_waitcnt lgkmcnt(6)
    v_exp_f32 v59, v73
    v_mfma_f32_16x16x32_bf16 v[248:251], v[124:127], v[136:139], v[248:251]
    ds_read_b128 v[124:127], v48 offset:31744
    v_cvt_pk_bf16_f32 v130, v58, v59
    v_mfma_f32_16x16x32_bf16 v[80:83], v[96:99], v[16:19], v[144:147]
    s_waitcnt lgkmcnt(6)
    v_exp_f32 v60, v74
    v_mfma_f32_16x16x32_bf16 v[84:87], v[96:99], v[32:35], v[148:151]
    s_cmp_lg_u32 s89, 0
    v_or3_b32 v62, v62, v133, v130
    v_xor_b32 v48, 0x10000, v48
    v_mfma_f32_16x16x32_bf16 v[84:87], v[100:103], v[36:39], v[84:87]
    s_waitcnt lgkmcnt(5)
    v_exp_f32 v61, v75
    v_mfma_f32_16x16x32_bf16 v[80:83], v[100:103], v[20:23], v[80:83]
    s_waitcnt lgkmcnt(0)
    v_cvt_pk_bf16_f32 v131, v60, v61
    v_smfmac_f32_16x16x64_bf16 v[160:163], v[164:167], v[136:143], v168
    s_cbranch_scc1 L_ldback_13_c
    s_barrier
L_ldback_13:
    s_add_i32 s62, s62, 1
    ds_read_b128 v[96:99], v48 offset:32768
    ds_read_b128 v[100:103], v48 offset:33792
    v_mfma_f32_16x16x32_bf16 v[80:83], v[104:107], v[24:27], v[80:83]
    v_exp_f32 v58, v76
    v_mfma_f32_16x16x32_bf16 v[84:87], v[104:107], v[40:43], v[84:87]
    ds_read_b128 v[104:107], v48 offset:34816
    v_mfma_f32_16x16x32_bf16 v[84:87], v[108:111], v[44:47], v[84:87]
    v_exp_f32 v59, v77
    v_mfma_f32_16x16x32_bf16 v[80:83], v[108:111], v[28:31], v[80:83]
    ds_read_b128 v[108:111], v48 offset:35840
    v_cvt_pk_bf16_f32 v134, v58, v59
    v_mfma_f32_16x16x32_bf16 v[88:91], v[112:115], v[16:19], v[152:155]
    v_exp_f32 v60, v78
    v_mfma_f32_16x16x32_bf16 v[92:95], v[112:115], v[32:35], v[156:159]
    ds_read_b128 v[112:115], v48 offset:36864
    v_or3_b32 v62, v62, v131, v134
    v_mfma_f32_16x16x32_bf16 v[92:95], v[116:119], v[36:39], v[92:95]
    v_exp_f32 v61, v79
    v_mfma_f32_16x16x32_bf16 v[88:91], v[116:119], v[20:23], v[88:91]
    ds_read_b128 v[116:119], v48 offset:37888
    v_cvt_pk_bf16_f32 v135, v60, v61
    v_mfma_f32_16x16x32_bf16 v[88:91], v[120:123], v[24:27], v[88:91]
    v_exp_f32 v58, v80
    v_mfma_f32_16x16x32_bf16 v[92:95], v[120:123], v[40:43], v[92:95]
    ds_read_b128 v[120:123], v48 offset:38912
    v_bitop3_b32 v62, v62, v135, s72 bitop3:0xa8
    v_cmp_ne_u32 vcc, s65, v62
    v_mfma_f32_16x16x32_bf16 v[92:95], v[124:127], v[44:47], v[92:95]
    s_waitcnt lgkmcnt(6)
    v_exp_f32 v59, v81
    v_mfma_f32_16x16x32_bf16 v[88:91], v[124:127], v[28:31], v[88:91]
    ds_read_b128 v[124:127], v48 offset:39936
    s_cbranch_vccz L_st0
    s_branch L_back_14_h
L_tail0:
    s_mov_b32 s65, 0
    v_mfma_f32_16x16x32_bf16 v[192:195], v[96:99], v[128:131], v[192:195]
    s_waitcnt lgkmcnt(6)
    v_exp_f32 v60, v82
    v_exp_f32 v61, v83
    v_mfma_f32_16x16x32_bf16 v[196:199], v[96:99], v[132:135], v[196:199]
    ds_read_b128 v[96:99], v48 offset:40960
    v_cvt_pk_bf16_f32 v136, v58, v59
    v_cvt_pk_bf16_f32 v137, v60, v61
    v_mfma_f32_16x16x32_bf16 v[204:207], v[100:103], v[132:135], v[204:207]
    s_waitcnt lgkmcnt(6)
    v_exp_f32 v58, v84
    v_exp_f32 v59, v85
    v_mfma_f32_16x16x32_bf16 v[200:203], v[100:103], v[128:131], v[200:203]
    ds_read_b128 v[100:103], v48 offset:41984
    v_cvt_pk_bf16_f32 v140, v58, v59
    v_smfmac_f32_16x16x64_bf16 v[160:163], v[164:167], v[128:135], v168
    v_mfma_f32_16x16x32_bf16 v[208:211], v[104:107], v[128:131], v[208:211]
    s_waitcnt lgkmcnt(6)
    v_exp_f32 v60, v86
    v_exp_f32 v61, v87
    v_mfma_f32_16x16x32_bf16 v[212:215], v[104:107], v[132:135], v[212:215]
    ds_read_b128 v[104:107], v48 offset:43008
    v_cvt_pk_bf16_f32 v141, v60, v61
    v_mfma_f32_16x16x32_bf16 v[220:223], v[108:111], v[132:135], v[220:223]
    s_waitcnt lgkmcnt(6)
    v_exp_f32 v58, v88
    v_exp_f32 v59, v89
    v_mfma_f32_16x16x32_bf16 v[216:219], v[108:111], v[128:131], v[216:219]
    ds_read_b128 v[108:111], v48 offset:44032
    v_cvt_pk_bf16_f32 v138, v58, v59
    v_mfma_f32_16x16x32_bf16 v[224:227], v[112:115], v[128:131], v[224:227]
    s_waitcnt lgkmcnt(6)
    v_exp_f32 v60, v90
    v_exp_f32 v61, v91
    v_mfma_f32_16x16x32_bf16 v[228:231], v[112:115], v[132:135], v[228:231]
    ds_read_b128 v[112:115], v48 offset:45056
    v_cvt_pk_bf16_f32 v139, v60, v61
    v_mfma_f32_16x16x32_bf16 v[236:239], v[116:119], v[132:135], v[236:239]
    s_waitcnt lgkmcnt(6)
    v_exp_f32 v58, v92
    v_exp_f32 v59, v93
    v_mfma_f32_16x16x32_bf16 v[232:235], v[116:119], v[128:131], v[232:235]
    ds_read_b128 v[116:119], v48 offset:46080
    v_cvt_pk_bf16_f32 v142, v58, v59
    v_mfma_f32_16x16x32_bf16 v[240:243], v[120:123], v[128:131], v[240:243]
    s_waitcnt lgkmcnt(6)
    v_exp_f32 v60, v94
    v_exp_f32 v61, v95
    v_mfma_f32_16x16x32_bf16 v[244:247], v[120:123], v[132:135], v[244:247]
    ds_read_b128 v[120:123], v48 offset:47104
    v_cvt_pk_bf16_f32 v143, v60, v61
    v_mfma_f32_16x16x32_bf16 v[252:255], v[124:127], v[132:135], v[252:255]
    s_waitcnt lgkmcnt(6)
    v_or3_b32 v62, v136, v137, v140
    v_or3_b32 v62, v62, v141, v138
    v_or3_b32 v62, v62, v139, v142
    v_bitop3_b32 v62, v62, v143, s72 bitop3:0xa8
    v_cmp_ne_u32 vcc, s65, v62
    v_mfma_f32_16x16x32_bf16 v[248:251], v[124:127], v[128:131], v[248:251]
    ds_read_b128 v[124:127], v48 offset:48128
    s_cbranch_vccnz L_back_15_h
L_back_15:
L_pv1:
    v_mfma_f32_16x16x32_bf16 v[192:195], v[96:99], v[136:139], v[192:195]
    s_waitcnt lgkmcnt(6)
    v_mfma_f32_16x16x32_bf16 v[196:199], v[96:99], v[140:143], v[196:199]
    v_mfma_f32_16x16x32_bf16 v[204:207], v[100:103], v[140:143], v[204:207]
    s_waitcnt lgkmcnt(5)
    v_mfma_f32_16x16x32_bf16 v[200:203], v[100:103], v[136:139], v[200:203]
    v_smfmac_f32_16x16x64_bf16 v[160:163], v[164:167], v[136:143], v168
    v_mfma_f32_16x16x32_bf16 v[208:211], v[104:107], v[136:139], v[208:211]
    s_waitcnt lgkmcnt(4)
    v_mfma_f32_16x16x32_bf16 v[212:215], v[104:107], v[140:143], v[212:215]
    v_mfma_f32_16x16x32_bf16 v[220:223], v[108:111], v[140:143], v[220:223]
    s_waitcnt lgkmcnt(3)
    v_mfma_f32_16x16x32_bf16 v[216:219], v[108:111], v[136:139], v[216:219]
    v_mfma_f32_16x16x32_bf16 v[224:227], v[112:115], v[136:139], v[224:227]
    s_waitcnt lgkmcnt(2)
    v_mfma_f32_16x16x32_bf16 v[228:231], v[112:115], v[140:143], v[228:231]
    v_mfma_f32_16x16x32_bf16 v[236:239], v[116:119], v[140:143], v[236:239]
    s_waitcnt lgkmcnt(1)
    v_mfma_f32_16x16x32_bf16 v[232:235], v[116:119], v[136:139], v[232:235]
    v_mfma_f32_16x16x32_bf16 v[240:243], v[120:123], v[136:139], v[240:243]
    s_waitcnt lgkmcnt(0)
    v_mfma_f32_16x16x32_bf16 v[244:247], v[120:123], v[140:143], v[244:247]
    v_mfma_f32_16x16x32_bf16 v[252:255], v[124:127], v[140:143], v[252:255]
    v_mfma_f32_16x16x32_bf16 v[248:251], v[124:127], v[136:139], v[248:251]
    s_branch L_fin
L_tail1:
    s_mov_b32 s65, 0
    v_mfma_f32_16x16x32_bf16 v[192:195], v[96:99], v[136:139], v[192:195]
    s_waitcnt lgkmcnt(6)
    v_exp_f32 v60, v66
    v_exp_f32 v61, v67
    v_mfma_f32_16x16x32_bf16 v[196:199], v[96:99], v[140:143], v[196:199]
    ds_read_b128 v[96:99], v48 offset:49152
    v_cvt_pk_bf16_f32 v128, v58, v59
    v_cvt_pk_bf16_f32 v129, v60, v61
    v_mfma_f32_16x16x32_bf16 v[204:207], v[100:103], v[140:143], v[204:207]
    s_waitcnt lgkmcnt(6)
    v_exp_f32 v58, v68
    v_exp_f32 v59, v69
    v_mfma_f32_16x16x32_bf16 v[200:203], v[100:103], v[136:139], v[200:203]
    ds_read_b128 v[100:103], v48 offset:50176
    v_cvt_pk_bf16_f32 v132, v58, v59
    v_smfmac_f32_16x16x64_bf16 v[160:163], v[164:167], v[136:143], v168
    v_mfma_f32_16x16x32_bf16 v[208:211], v[104:107], v[136:139], v[208:211]
    s_waitcnt lgkmcnt(6)
    v_exp_f32 v60, v70
    v_exp_f32 v61, v71
    v_mfma_f32_16x16x32_bf16 v[212:215], v[104:107], v[140:143], v[212:215]
    ds_read_b128 v[104:107], v48 offset:51200
    v_cvt_pk_bf16_f32 v133, v60, v61
    v_mfma_f32_16x16x32_bf16 v[220:223], v[108:111], v[140:143], v[220:223]
    s_waitcnt lgkmcnt(6)
    v_exp_f32 v58, v72
    v_exp_f32 v59, v73
    v_mfma_f32_16x16x32_bf16 v[216:219], v[108:111], v[136:139], v[216:219]
    ds_read_b128 v[108:111], v48 offset:52224
    v_cvt_pk_bf16_f32 v130, v58, v59
    v_mfma_f32_16x16x32_bf16 v[224:227], v[112:115], v[136:139], v[224:227]
    s_waitcnt lgkmcnt(6)
    v_exp_f32 v60, v74
    v_exp_f32 v61, v75
    v_mfma_f32_16x16x32_bf16 v[228:231], v[112:115], v[140:143], v[228:231]
    ds_read_b128 v[112:115], v48 offset:53248
    v_cvt_pk_bf16_f32 v131, v60, v61
    v_mfma_f32_16x16x32_bf16 v[236:239], v[116:119], v[140:143], v[236:239]
    s_waitcnt lgkmcnt(6)
    v_exp_f32 v58, v76
    v_exp_f32 v59, v77
    v_mfma_f32_16x16x32_bf16 v[232:235], v[116:119], v[136:139], v[232:235]
    ds_read_b128 v[116:119], v48 offset:54272
    v_cvt_pk_bf16_f32 v134, v58, v59
    v_mfma_f32_16x16x32_bf16 v[240:243], v[120:123], v[136:139], v[240:243]
    s_waitcnt lgkmcnt(6)
    v_exp_f32 v60, v78
    v_exp_f32 v61, v79
    v_mfma_f32_16x16x32_bf16 v[244:247], v[120:123], v[140:143], v[244:247]
    ds_read_b128 v[120:123], v48 offset:55296
    v_cvt_pk_bf16_f32 v135, v60, v61
    v_mfma_f32_16x16x32_bf16 v[252:255], v[124:127], v[140:143], v[252:255]
    s_waitcnt lgkmcnt(6)
    v_or3_b32 v62, v128, v129, v132
    v_or3_b32 v62, v62, v133, v130
    v_or3_b32 v62, v62, v131, v134
    v_bitop3_b32 v62, v62, v135, s72 bitop3:0xa8
    v_cmp_ne_u32 vcc, s65, v62
    v_mfma_f32_16x16x32_bf16 v[248:251], v[124:127], v[136:139], v[248:251]
    ds_read_b128 v[124:127], v48 offset:56320
    s_cbranch_vccnz L_back_16_h
L_back_16:
L_pv2:
    v_mfma_f32_16x16x32_bf16 v[192:195], v[96:99], v[128:131], v[192:195]
    s_waitcnt lgkmcnt(6)
    v_mfma_f32_16x16x32_bf16 v[196:199], v[96:99], v[132:135], v[196:199]
    v_mfma_f32_16x16x32_bf16 v[204:207], v[100:103], v[132:135], v[204:207]
    s_waitcnt lgkmcnt(5)
    v_mfma_f32_16x16x32_bf16 v[200:203], v[100:103], v[128:131], v[200:203]
    v_smfmac_f32_16x16x64_bf16 v[160:163], v[164:167], v[128:135], v168
    v_mfma_f32_16x16x32_bf16 v[208:211], v[104:107], v[128:131], v[208:211]
    s_waitcnt lgkmcnt(4)
    v_mfma_f32_16x16x32_bf16 v[212:215], v[104:107], v[132:135], v[212:215]
    v_mfma_f32_16x16x32_bf16 v[220:223], v[108:111], v[132:135], v[220:223]
    s_waitcnt lgkmcnt(3)
    v_mfma_f32_16x16x32_bf16 v[216:219], v[108:111], v[128:131], v[216:219]
    v_mfma_f32_16x16x32_bf16 v[224:227], v[112:115], v[128:131], v[224:227]
    s_waitcnt lgkmcnt(2)
    v_mfma_f32_16x16x32_bf16 v[228:231], v[112:115], v[132:135], v[228:231]
    v_mfma_f32_16x16x32_bf16 v[236:239], v[116:119], v[132:135], v[236:239]
    s_waitcnt lgkmcnt(1)
    v_mfma_f32_16x16x32_bf16 v[232:235], v[116:119], v[128:131], v[232:235]
    v_mfma_f32_16x16x32_bf16 v[240:243], v[120:123], v[128:131], v[240:243]
    s_waitcnt lgkmcnt(0)
    v_mfma_f32_16x16x32_bf16 v[244:247], v[120:123], v[132:135], v[244:247]
    v_mfma_f32_16x16x32_bf16 v[252:255], v[124:127], v[132:135], v[252:255]
    v_mfma_f32_16x16x32_bf16 v[248:251], v[124:127], v[128:131], v[248:251]
    s_cmp_eq_u32 s60, 0
    s_cbranch_scc1 L_fin
    s_waitcnt vmcnt(0) lgkmcnt(0)
    s_call_b64 s[82:83], L_pend
    s_barrier
    s_call_b64 s[82:83], L_load
    s_add_i32 s62, s62, 1
    s_branch L_fin
L_tail2:
    s_mov_b32 s65, 0
    v_mfma_f32_16x16x32_bf16 v[192:195], v[96:99], v[128:131], v[192:195]
    s_waitcnt lgkmcnt(6)
    v_exp_f32 v60, v82
    v_exp_f32 v61, v83
    v_mfma_f32_16x16x32_bf16 v[196:199], v[96:99], v[132:135], v[196:199]
    ds_read_b128 v[96:99], v48 offset:57344
    v_cvt_pk_bf16_f32 v136, v58, v59
    v_cvt_pk_bf16_f32 v137, v60, v61
    v_mfma_f32_16x16x32_bf16 v[204:207], v[100:103], v[132:135], v[204:207]
    s_waitcnt lgkmcnt(6)
    v_exp_f32 v58, v84
    v_exp_f32 v59, v85
    v_mfma_f32_16x16x32_bf16 v[200:203], v[100:103], v[128:131], v[200:203]
    ds_read_b128 v[100:103], v48 offset:58368
    v_cvt_pk_bf16_f32 v140, v58, v59
    v_smfmac_f32_16x16x64_bf16 v[160:163], v[164:167], v[128:135], v168
    v_mfma_f32_16x16x32_bf16 v[208:211], v[104:107], v[128:131], v[208:211]
    s_waitcnt lgkmcnt(6)
    v_exp_f32 v60, v86
    v_exp_f32 v61, v87
    v_mfma_f32_16x16x32_bf16 v[212:215], v[104:107], v[132:135], v[212:215]
    ds_read_b128 v[104:107], v48 offset:59392
    v_cvt_pk_bf16_f32 v141, v60, v61
    v_mfma_f32_16x16x32_bf16 v[220:223], v[108:111], v[132:135], v[220:223]
    s_waitcnt lgkmcnt(6)
    v_exp_f32 v58, v88
    v_exp_f32 v59, v89
    v_mfma_f32_16x16x32_bf16 v[216:219], v[108:111], v[128:131], v[216:219]
    ds_read_b128 v[108:111], v48 offset:60416
    v_cvt_pk_bf16_f32 v138, v58, v59
    v_mfma_f32_16x16x32_bf16 v[224:227], v[112:115], v[128:131], v[224:227]
    s_waitcnt lgkmcnt(6)
    v_exp_f32 v60, v90
    v_exp_f32 v61, v91
    v_mfma_f32_16x16x32_bf16 v[228:231], v[112:115], v[132:135], v[228:231]
    ds_read_b128 v[112:115], v48 offset:61440
    v_cvt_pk_bf16_f32 v139, v60, v61
    v_mfma_f32_16x16x32_bf16 v[236:239], v[116:119], v[132:135], v[236:239]
    s_waitcnt lgkmcnt(6)
    v_exp_f32 v58, v92
    v_exp_f32 v59, v93
    v_mfma_f32_16x16x32_bf16 v[232:235], v[116:119], v[128:131], v[232:235]
    ds_read_b128 v[116:119], v48 offset:62464
    v_cvt_pk_bf16_f32 v142, v58, v59
    v_mfma_f32_16x16x32_bf16 v[240:243], v[120:123], v[128:131], v[240:243]
    s_waitcnt lgkmcnt(6)
    v_exp_f32 v60, v94
    v_exp_f32 v61, v95
    v_mfma_f32_16x16x32_bf16 v[244:247], v[120:123], v[132:135], v[244:247]
    ds_read_b128 v[120:123], v48 offset:63488
    v_cvt_pk_bf16_f32 v143, v60, v61
    v_mfma_f32_16x16x32_bf16 v[252:255], v[124:127], v[132:135], v[252:255]
    s_waitcnt lgkmcnt(6)
    v_or3_b32 v62, v136, v137, v140
    v_or3_b32 v62, v62, v141, v138
    v_or3_b32 v62, v62, v139, v142
    v_bitop3_b32 v62, v62, v143, s72 bitop3:0xa8
    v_cmp_ne_u32 vcc, s65, v62
    v_mfma_f32_16x16x32_bf16 v[248:251], v[124:127], v[128:131], v[248:251]
    ds_read_b128 v[124:127], v48 offset:64512
    s_cbranch_vccnz L_back_18_h
L_back_18:
L_pv3:
    v_mfma_f32_16x16x32_bf16 v[192:195], v[96:99], v[136:139], v[192:195]
    s_waitcnt lgkmcnt(6)
    v_mfma_f32_16x16x32_bf16 v[196:199], v[96:99], v[140:143], v[196:199]
    v_xor_b32 v48, 0x10000, v48
    v_mfma_f32_16x16x32_bf16 v[204:207], v[100:103], v[140:143], v[204:207]
    s_waitcnt lgkmcnt(5)
    v_mfma_f32_16x16x32_bf16 v[200:203], v[100:103], v[136:139], v[200:203]
    v_smfmac_f32_16x16x64_bf16 v[160:163], v[164:167], v[136:143], v168
    s_waitcnt vmcnt(0) lgkmcnt(0)
    s_call_b64 s[82:83], L_pend
    s_barrier
    s_call_b64 s[82:83], L_load
    s_add_i32 s62, s62, 1
    v_mfma_f32_16x16x32_bf16 v[208:211], v[104:107], v[136:139], v[208:211]
    v_mfma_f32_16x16x32_bf16 v[212:215], v[104:107], v[140:143], v[212:215]
    v_mfma_f32_16x16x32_bf16 v[220:223], v[108:111], v[140:143], v[220:223]
    v_mfma_f32_16x16x32_bf16 v[216:219], v[108:111], v[136:139], v[216:219]
    v_mfma_f32_16x16x32_bf16 v[224:227], v[112:115], v[136:139], v[224:227]
    v_mfma_f32_16x16x32_bf16 v[228:231], v[112:115], v[140:143], v[228:231]
    v_mfma_f32_16x16x32_bf16 v[236:239], v[116:119], v[140:143], v[236:239]
    v_mfma_f32_16x16x32_bf16 v[232:235], v[116:119], v[136:139], v[232:235]
    v_mfma_f32_16x16x32_bf16 v[240:243], v[120:123], v[136:139], v[240:243]
    v_mfma_f32_16x16x32_bf16 v[244:247], v[120:123], v[140:143], v[244:247]
    v_mfma_f32_16x16x32_bf16 v[252:255], v[124:127], v[140:143], v[252:255]
    v_mfma_f32_16x16x32_bf16 v[248:251], v[124:127], v[136:139], v[248:251]
    s_branch L_fin
L_tail3:
    s_mov_b32 s65, 0
    v_mfma_f32_16x16x32_bf16 v[192:195], v[96:99], v[136:139], v[192:195]
    s_waitcnt lgkmcnt(6)
    v_exp_f32 v60, v66
    v_exp_f32 v61, v67
    v_mfma_f32_16x16x32_bf16 v[196:199], v[96:99], v[140:143], v[196:199]
    v_cvt_pk_bf16_f32 v128, v58, v59
    v_cvt_pk_bf16_f32 v129, v60, v61
    v_xor_b32 v48, 0x10000, v48
    v_mfma_f32_16x16x32_bf16 v[204:207], v[100:103], v[140:143], v[204:207]
    s_waitcnt lgkmcnt(5)
    v_exp_f32 v58, v68
    v_exp_f32 v59, v69
    v_mfma_f32_16x16x32_bf16 v[200:203], v[100:103], v[136:139], v[200:203]
    v_cvt_pk_bf16_f32 v132, v58, v59
    v_smfmac_f32_16x16x64_bf16 v[160:163], v[164:167], v[136:143], v168
    s_waitcnt vmcnt(0) lgkmcnt(0)
    s_call_b64 s[82:83], L_pend
    s_barrier
    s_call_b64 s[82:83], L_load
    s_add_i32 s62, s62, 1
    ds_read_b128 v[96:99], v48 offset:32768
    ds_read_b128 v[100:103], v48 offset:33792
    v_mfma_f32_16x16x32_bf16 v[208:211], v[104:107], v[136:139], v[208:211]
    v_exp_f32 v60, v70
    v_exp_f32 v61, v71
    v_mfma_f32_16x16x32_bf16 v[212:215], v[104:107], v[140:143], v[212:215]
    ds_read_b128 v[104:107], v48 offset:34816
    v_cvt_pk_bf16_f32 v133, v60, v61
    v_mfma_f32_16x16x32_bf16 v[220:223], v[108:111], v[140:143], v[220:223]
    v_exp_f32 v58, v72
    v_exp_f32 v59, v73
    v_mfma_f32_16x16x32_bf16 v[216:219], v[108:111], v[136:139], v[216:219]
    ds_read_b128 v[108:111], v48 offset:35840
    v_cvt_pk_bf16_f32 v130, v58, v59
    v_mfma_f32_16x16x32_bf16 v[224:227], v[112:115], v[136:139], v[224:227]
    v_exp_f32 v60, v74
    v_exp_f32 v61, v75
    v_mfma_f32_16x16x32_bf16 v[228:231], v[112:115], v[140:143], v[228:231]
    ds_read_b128 v[112:115], v48 offset:36864
    v_cvt_pk_bf16_f32 v131, v60, v61
    v_mfma_f32_16x16x32_bf16 v[236:239], v[116:119], v[140:143], v[236:239]
    v_exp_f32 v58, v76
    v_exp_f32 v59, v77
    v_mfma_f32_16x16x32_bf16 v[232:235], v[116:119], v[136:139], v[232:235]
    ds_read_b128 v[116:119], v48 offset:37888
    v_cvt_pk_bf16_f32 v134, v58, v59
    v_mfma_f32_16x16x32_bf16 v[240:243], v[120:123], v[136:139], v[240:243]
    v_exp_f32 v60, v78
    v_exp_f32 v61, v79
    v_mfma_f32_16x16x32_bf16 v[244:247], v[120:123], v[140:143], v[244:247]
    ds_read_b128 v[120:123], v48 offset:38912
    v_cvt_pk_bf16_f32 v135, v60, v61
    v_mfma_f32_16x16x32_bf16 v[252:255], v[124:127], v[140:143], v[252:255]
    s_waitcnt lgkmcnt(6)
    v_or3_b32 v62, v128, v129, v132
    v_or3_b32 v62, v62, v133, v130
    v_or3_b32 v62, v62, v131, v134
    v_bitop3_b32 v62, v62, v135, s72 bitop3:0xa8
    v_cmp_ne_u32 vcc, s65, v62
    v_mfma_f32_16x16x32_bf16 v[248:251], v[124:127], v[136:139], v[248:251]
    ds_read_b128 v[124:127], v48 offset:39936
    s_cbranch_vccnz L_back_21_h
L_back_21:
L_pv0:
    v_mfma_f32_16x16x32_bf16 v[192:195], v[96:99], v[128:131], v[192:195]
    s_waitcnt lgkmcnt(6)
    v_mfma_f32_16x16x32_bf16 v[196:199], v[96:99], v[132:135], v[196:199]
    v_mfma_f32_16x16x32_bf16 v[204:207], v[100:103], v[132:135], v[204:207]
    s_waitcnt lgkmcnt(5)
    v_mfma_f32_16x16x32_bf16 v[200:203], v[100:103], v[128:131], v[200:203]
    v_smfmac_f32_16x16x64_bf16 v[160:163], v[164:167], v[128:135], v168
    v_mfma_f32_16x16x32_bf16 v[208:211], v[104:107], v[128:131], v[208:211]
    s_waitcnt lgkmcnt(4)
    v_mfma_f32_16x16x32_bf16 v[212:215], v[104:107], v[132:135], v[212:215]
    v_mfma_f32_16x16x32_bf16 v[220:223], v[108:111], v[132:135], v[220:223]
    s_waitcnt lgkmcnt(3)
    v_mfma_f32_16x16x32_bf16 v[216:219], v[108:111], v[128:131], v[216:219]
    v_mfma_f32_16x16x32_bf16 v[224:227], v[112:115], v[128:131], v[224:227]
    s_waitcnt lgkmcnt(2)
    v_mfma_f32_16x16x32_bf16 v[228:231], v[112:115], v[132:135], v[228:231]
    v_mfma_f32_16x16x32_bf16 v[236:239], v[116:119], v[132:135], v[236:239]
    s_waitcnt lgkmcnt(1)
    v_mfma_f32_16x16x32_bf16 v[232:235], v[116:119], v[128:131], v[232:235]
    v_mfma_f32_16x16x32_bf16 v[240:243], v[120:123], v[128:131], v[240:243]
    s_waitcnt lgkmcnt(0)
    v_mfma_f32_16x16x32_bf16 v[244:247], v[120:123], v[132:135], v[244:247]
    v_mfma_f32_16x16x32_bf16 v[252:255], v[124:127], v[132:135], v[252:255]
    v_mfma_f32_16x16x32_bf16 v[248:251], v[124:127], v[128:131], v[248:251]
L_fin:
    v_and_b32 v3, 7, v1
    v_lshlrev_b32 v3, 2, v3
    s_mov_b32 s72, 0x3a0000
    buffer_load_dword v51, v3, s[8:11], s72 offen sc1
    v_add_f32 v56, v160, v161
    v_rcp_f32 v56, v56
    v_add_f32 v57, v162, v163
    v_rcp_f32 v57, v57
    s_lshl_b32 s6, s60, 18
    s_lshl_b32 s7, s4, 12
    s_add_u32 s6, s6, s7
    s_add_u32 s6, s6, 50331648
    s_nop 4
    v_mul_f32 v192, v56, v192
    v_mul_f32 v193, v56, v193
    v_mul_f32 v194, v56, v194
    v_mul_f32 v195, v56, v195
    v_cvt_pk_bf16_f32 v16, v192, v193
    v_cvt_pk_bf16_f32 v17, v194, v195
    v_mul_f32 v200, v56, v200
    v_mul_f32 v201, v56, v201
    v_mul_f32 v202, v56, v202
    v_mul_f32 v203, v56, v203
    v_cvt_pk_bf16_f32 v18, v200, v201
    v_cvt_pk_bf16_f32 v19, v202, v203
    buffer_store_dwordx4 v[16:19], v13, s[8:11], s6 offen offset:0 sc1
    v_mul_f32 v208, v56, v208
    v_mul_f32 v209, v56, v209
    v_mul_f32 v210, v56, v210
    v_mul_f32 v211, v56, v211
    v_cvt_pk_bf16_f32 v20, v208, v209
    v_cvt_pk_bf16_f32 v21, v210, v211
    v_mul_f32 v216, v56, v216
    v_mul_f32 v217, v56, v217
    v_mul_f32 v218, v56, v218
    v_mul_f32 v219, v56, v219
    v_cvt_pk_bf16_f32 v22, v216, v217
    v_cvt_pk_bf16_f32 v23, v218, v219
    buffer_store_dwordx4 v[20:23], v13, s[8:11], s6 offen offset:1024 sc1
    v_mul_f32 v224, v56, v224
    v_mul_f32 v225, v56, v225
    v_mul_f32 v226, v56, v226
    v_mul_f32 v227, v56, v227
    v_cvt_pk_bf16_f32 v24, v224, v225
    v_cvt_pk_bf16_f32 v25, v226, v227
    v_mul_f32 v232, v56, v232
    v_mul_f32 v233, v56, v233
    v_mul_f32 v234, v56, v234
    v_mul_f32 v235, v56, v235
    v_cvt_pk_bf16_f32 v26, v232, v233
    v_cvt_pk_bf16_f32 v27, v234, v235
    buffer_store_dwordx4 v[24:27], v13, s[8:11], s6 offen offset:2048 sc1
    v_mul_f32 v240, v56, v240
    v_mul_f32 v241, v56, v241
    v_mul_f32 v242, v56, v242
    v_mul_f32 v243, v56, v243
    v_cvt_pk_bf16_f32 v28, v240, v241
    v_cvt_pk_bf16_f32 v29, v242, v243
    v_mul_f32 v248, v56, v248
    v_mul_f32 v249, v56, v249
    v_mul_f32 v250, v56, v250
    v_mul_f32 v251, v56, v251
    v_cvt_pk_bf16_f32 v30, v248, v249
    v_cvt_pk_bf16_f32 v31, v250, v251
    buffer_store_dwordx4 v[28:31], v13, s[8:11], s6 offen offset:3072 sc1
    s_add_u32 s6, s6, 0x20000
    v_mul_f32 v196, v57, v196
    v_mul_f32 v197, v57, v197
    v_mul_f32 v198, v57, v198
    v_mul_f32 v199, v57, v199
    v_cvt_pk_bf16_f32 v32, v196, v197
    v_cvt_pk_bf16_f32 v33, v198, v199
    v_mul_f32 v204, v57, v204
    v_mul_f32 v205, v57, v205
    v_mul_f32 v206, v57, v206
    v_mul_f32 v207, v57, v207
    v_cvt_pk_bf16_f32 v34, v204, v205
    v_cvt_pk_bf16_f32 v35, v206, v207
    buffer_store_dwordx4 v[32:35], v13, s[8:11], s6 offen offset:0 sc1
    v_mul_f32 v212, v57, v212
    v_mul_f32 v213, v57, v213
    v_mul_f32 v214, v57, v214
    v_mul_f32 v215, v57, v215
    v_cvt_pk_bf16_f32 v36, v212, v213
    v_cvt_pk_bf16_f32 v37, v214, v215
    v_mul_f32 v220, v57, v220
    v_mul_f32 v221, v57, v221
    v_mul_f32 v222, v57, v222
    v_mul_f32 v223, v57, v223
    v_cvt_pk_bf16_f32 v38, v220, v221
    v_cvt_pk_bf16_f32 v39, v222, v223
    buffer_store_dwordx4 v[36:39], v13, s[8:11], s6 offen offset:1024 sc1
    v_mul_f32 v228, v57, v228
    v_mul_f32 v229, v57, v229
    v_mul_f32 v230, v57, v230
    v_mul_f32 v231, v57, v231
    v_cvt_pk_bf16_f32 v40, v228, v229
    v_cvt_pk_bf16_f32 v41, v230, v231
    v_mul_f32 v236, v57, v236
    v_mul_f32 v237, v57, v237
    v_mul_f32 v238, v57, v238
    v_mul_f32 v239, v57, v239
    v_cvt_pk_bf16_f32 v42, v236, v237
    v_cvt_pk_bf16_f32 v43, v238, v239
    buffer_store_dwordx4 v[40:43], v13, s[8:11], s6 offen offset:2048 sc1
    v_mul_f32 v244, v57, v244
    v_mul_f32 v245, v57, v245
    v_mul_f32 v246, v57, v246
    v_mul_f32 v247, v57, v247
    v_cvt_pk_bf16_f32 v44, v244, v245
    v_cvt_pk_bf16_f32 v45, v246, v247
    v_mul_f32 v252, v57, v252
    v_mul_f32 v253, v57, v253
    v_mul_f32 v254, v57, v254
    v_mul_f32 v255, v57, v255
    v_cvt_pk_bf16_f32 v46, v252, v253
    v_cvt_pk_bf16_f32 v47, v254, v255
    buffer_store_dwordx4 v[44:47], v13, s[8:11], s6 offen offset:3072 sc1
    s_cmp_gt_i32 s62, s63
    s_cbranch_scc1 L_pre
    s_waitcnt vmcnt(8)
    s_call_b64 s[82:83], L_pend
    s_barrier
    s_waitcnt vmcnt(0)
    s_lshl_b32 s6, s60, 5
    s_add_u32 s6, s6, s4
    s_lshl_b32 s6, s6, 7
    s_add_u32 s6, s6, 3932160
    v_mov_b32 v2, 1
    v_mov_b32 v3, 0x5000000
    v_writelane_b32 v3, s6, 0
    buffer_store_dword v2, v3, s[8:11], 0 offen sc1
    s_call_b64 s[82:83], L_load
    s_add_i32 s62, s62, 1
    s_lshl_b32 s6, s3, 8
    s_add_u32 s6, s6, s2
    s_cmp_eq_u32 s6, 31
    s_cbranch_scc1 L_top
L_idle:
    s_sub_i32 s6, s63, 5
    s_cmp_gt_i32 s62, s6
    s_cbranch_scc1 L_pre
    s_waitcnt vmcnt(0) lgkmcnt(0)
    s_call_b64 s[82:83], L_pend
    s_barrier
    s_call_b64 s[82:83], L_load
    s_add_i32 s62, s62, 1
    s_cmp_lt_u32 s61, 54
    s_cbranch_scc1 L_moe
    s_branch L_idle
L_pre:
    s_cmp_lt_u32 s3, 4
    s_cbranch_scc1 L_pre1
    s_barrier
    s_lshl_b32 s7, s76, 13
    s_add_u32 s7, s7, 0x10000
    v_add_u32 v3, s7, v13
    v_add_u32 v2, 0x10000, v3
    s_lshl_b32 s7, s76, 12
    s_add_u32 s7, s7, 0x10000
    v_add_u32 v12, s7, v13
    ds_read_b128 v[96:99], v2 offset:0
    ds_read_b128 v[100:103], v2 offset:1024
    ds_read_b128 v[104:107], v2 offset:2048
    ds_read_b128 v[108:111], v2 offset:3072
    ds_read_b128 v[112:115], v2 offset:4096
    ds_read_b128 v[116:119], v2 offset:5120
    ds_read_b128 v[120:123], v2 offset:6144
    ds_read_b128 v[124:127], v2 offset:7168
    ds_read_b128 v[128:131], v3 offset:0
    ds_read_b128 v[132:135], v3 offset:1024
    ds_read_b128 v[136:139], v3 offset:2048
    ds_read_b128 v[140:143], v3 offset:3072
    s_add_u32 s6, s76, 0
    s_and_b32 s6, s6, 3
    s_lshl_b32 s6, s6, 10
    v_add_u32 v44, s6, v13
    s_add_u32 s6, s76, 1
    s_and_b32 s6, s6, 3
    s_lshl_b32 s6, s6, 10
    v_add_u32 v45, s6, v13
    s_add_u32 s6, s76, 2
    s_and_b32 s6, s6, 3
    s_lshl_b32 s6, s6, 10
    v_add_u32 v46, s6, v13
    s_add_u32 s6, s76, 3
    s_and_b32 s6, s6, 3
    s_lshl_b32 s6, s6, 10
    v_add_u32 v47, s6, v13
    v_add_u32 v52, 4096, v13
    s_lshr_b32 s69, s4, 3
    s_lshl_b32 s69, s69, 2
    s_add_u32 s69, s69, s76
    s_mul_i32 s69, s69, 327680
    s_and_b32 s7, s4, 3
    s_mul_i32 s7, s7, 10240
    s_add_u32 s69, s69, s7
    s_add_u32 s69, s69, 4199424
    s_and_b32 s6, s4, 4
    s_lshr_b32 s7, s4, 3
    s_add_u32 s6, s6, s7
    s_lshl_b32 s7, s5, 3
    s_add_u32 s68, s6, s7
    s_sub_u32 s7, 120, s7
    s_add_u32 s61, s6, s7
    s_lshr_b32 s6, s4, 3
    s_lshl_b32 s6, s6, 15
    s_lshl_b32 s99, s3, 12
    s_add_u32 s66, s6, s99
    s_add_u32 s66, s66, 50331648
    s_lshl_b32 s6, s76, 13
    v_add_u32 v4, s6, v13
    v_add_u32 v7, 65536, v4
    ds_read_b128 v[144:147], v3 offset:4096
    ds_read_b128 v[148:151], v3 offset:5120
    ds_read_b128 v[152:155], v3 offset:6144
    ds_read_b128 v[156:159], v3 offset:7168
    ds_read_b128 v[160:163], v12 offset:49152
    ds_read_b128 v[164:167], v12 offset:50176
    ds_read_b128 v[168:171], v12 offset:51200
    ds_read_b128 v[172:175], v12 offset:52224
    s_add_u32 s75, s69, 163840
    buffer_load_dwordx4 v[176:179], v44, s[8:11], s75 offen sc1
    buffer_load_dwordx4 v[180:183], v45, s[8:11], s75 offen sc1
    buffer_load_dwordx4 v[184:187], v46, s[8:11], s75 offen sc1
    buffer_load_dwordx4 v[188:191], v47, s[8:11], s75 offen sc1
    buffer_load_dwordx4 v[192:195], v52, s[8:11], s75 offen sc1
    s_waitcnt vmcnt(5)
    s_lshl_b32 s6, s60, 5
    s_add_u32 s6, s6, s4
    s_lshl_b32 s6, s6, 7
    s_add_u32 s6, s6, 3932160
    v_mov_b32 v2, 1
    v_mov_b32 v3, 0x5000000
    v_writelane_b32 v3, s6, 0
    buffer_store_dword v2, v3, s[8:11], 0 offen sc1
    s_add_u32 s75, s69, 204800
    buffer_load_dwordx4 v[196:199], v44, s[8:11], s75 offen sc1
    buffer_load_dwordx4 v[200:203], v45, s[8:11], s75 offen sc1
    buffer_load_dwordx4 v[204:207], v46, s[8:11], s75 offen sc1
    buffer_load_dwordx4 v[208:211], v47, s[8:11], s75 offen sc1
    buffer_load_dwordx4 v[212:215], v52, s[8:11], s75 offen sc1
    s_add_u32 s75, s69, 245760
    buffer_load_dwordx4 v[216:219], v44, s[8:11], s75 offen sc1
    buffer_load_dwordx4 v[220:223], v45, s[8:11], s75 offen sc1
    buffer_load_dwordx4 v[224:227], v46, s[8:11], s75 offen sc1
    buffer_load_dwordx4 v[228:231], v47, s[8:11], s75 offen sc1
    buffer_load_dwordx4 v[232:235], v52, s[8:11], s75 offen sc1
    s_add_u32 s75, s69, 286720
    buffer_load_dwordx4 v[236:239], v44, s[8:11], s75 offen sc1
    buffer_load_dwordx4 v[240:243], v45, s[8:11], s75 offen sc1
    buffer_load_dwordx4 v[244:247], v46, s[8:11], s75 offen sc1
    buffer_load_dwordx4 v[248:251], v47, s[8:11], s75 offen sc1
    buffer_load_dwordx4 v[252:255], v52, s[8:11], s75 offen sc1
    s_waitcnt lgkmcnt(0)
    s_barrier
    s_branch L_adone
L_pre1:
    s_mov_b32 s28, s56
    s_mov_b32 s29, s57
    s_mov_b32 s30, 0x100
    s_mov_b32 s31, 0x20000
    v_and_b32 v3, 31, v1
    v_lshlrev_b32 v3, 2, v3
    buffer_load_dword v12, v3, s[28:31], 0 offen offset:128 sc1
    v_and_b32 v3, 7, v1
    v_lshlrev_b32 v3, 2, v3
    s_mov_b32 s72, 0x3a0000
    buffer_load_dword v51, v3, s[8:11], s72 offen sc1
    s_add_u32 s6, s76, 0
    s_and_b32 s6, s6, 3
    s_lshl_b32 s6, s6, 10
    v_add_u32 v44, s6, v13
    s_add_u32 s6, s76, 1
    s_and_b32 s6, s6, 3
    s_lshl_b32 s6, s6, 10
    v_add_u32 v45, s6, v13
    s_add_u32 s6, s76, 2
    s_and_b32 s6, s6, 3
    s_lshl_b32 s6, s6, 10
    v_add_u32 v46, s6, v13
    s_add_u32 s6, s76, 3
    s_and_b32 s6, s6, 3
    s_lshl_b32 s6, s6, 10
    v_add_u32 v47, s6, v13
    v_add_u32 v52, 4096, v13
    s_lshr_b32 s69, s4, 3
    s_lshl_b32 s69, s69, 2
    s_add_u32 s69, s69, s76
    s_mul_i32 s69, s69, 327680
    s_and_b32 s7, s4, 3
    s_mul_i32 s7, s7, 10240
    s_add_u32 s69, s69, s7
    s_add_u32 s69, s69, 4194304
    s_and_b32 s6, s4, 4
    s_lshr_b32 s7, s4, 3
    s_add_u32 s6, s6, s7
    s_lshl_b32 s7, s5, 3
    s_add_u32 s68, s6, s7
    s_sub_u32 s7, 120, s7
    s_add_u32 s61, s6, s7
    s_sub_i32 s6, s63, 4
    s_cmp_gt_i32 s62, s6
    s_cbranch_scc1 L_wpoll
    s_cmp_eq_i32 s62, s63
    s_cbranch_scc1 L_lw0
    s_waitcnt vmcnt(0)
L_lw0:
    s_waitcnt vmcnt(20)
    s_call_b64 s[82:83], L_pend
    s_barrier
    s_call_b64 s[82:83], L_load
    s_add_i32 s62, s62, 1
L_e2:
    v_cmp_gt_u32 vcc, 4, v12
    s_cbranch_vccz L_wok
L_wpoll:
    s_mov_b32 s28, s56
    s_mov_b32 s29, s57
    s_mov_b32 s30, 0x100
    s_mov_b32 s31, 0x20000
    v_and_b32 v3, 31, v1
    v_lshlrev_b32 v3, 2, v3
    s_mov_b32 s79, 262144
L_poll_25:
    buffer_load_dword v2, v3, s[28:31], 0 offen offset:128 sc1
    s_waitcnt vmcnt(0)
    v_cmp_gt_u32 vcc, 4, v2
    s_cbranch_vccz L_polldone_26
    s_sleep 8
    s_sub_u32 s79, s79, 1
    s_cmp_lg_u32 s79, 0
    s_cbranch_scc1 L_poll_25
L_polldone_26:
L_wok:
    s_mov_b32 s90, 1
    s_add_u32 s75, s69, 0
    buffer_load_dwordx4 v[96:99], v44, s[8:11], s75 offen sc1
    buffer_load_dwordx4 v[100:103], v45, s[8:11], s75 offen sc1
    buffer_load_dwordx4 v[104:107], v46, s[8:11], s75 offen sc1
    buffer_load_dwordx4 v[108:111], v47, s[8:11], s75 offen sc1
    buffer_load_dwordx4 v[112:115], v52, s[8:11], s75 offen sc1
    s_add_u32 s75, s69, 40960
    buffer_load_dwordx4 v[116:119], v44, s[8:11], s75 offen sc1
    buffer_load_dwordx4 v[120:123], v45, s[8:11], s75 offen sc1
    buffer_load_dwordx4 v[124:127], v46, s[8:11], s75 offen sc1
    buffer_load_dwordx4 v[128:131], v47, s[8:11], s75 offen sc1
    buffer_load_dwordx4 v[132:135], v52, s[8:11], s75 offen sc1
    s_add_u32 s75, s69, 81920
    buffer_load_dwordx4 v[136:139], v44, s[8:11], s75 offen sc1
    buffer_load_dwordx4 v[140:143], v45, s[8:11], s75 offen sc1
    buffer_load_dwordx4 v[144:147], v46, s[8:11], s75 offen sc1
    buffer_load_dwordx4 v[148:151], v47, s[8:11], s75 offen sc1
    buffer_load_dwordx4 v[152:155], v52, s[8:11], s75 offen sc1
    s_cmp_gt_i32 s62, s63
    s_cbranch_scc1 L_e3
    s_cmp_eq_i32 s62, s63
    s_cbranch_scc1 L_lw1
    s_waitcnt vmcnt(15)
L_lw1:
    s_waitcnt vmcnt(20)
    s_call_b64 s[82:83], L_pend
    s_barrier
    s_call_b64 s[82:83], L_load
    s_add_i32 s62, s62, 1
L_e3:
    s_add_u32 s75, s69, 122880
    buffer_load_dwordx4 v[156:159], v44, s[8:11], s75 offen sc1
    buffer_load_dwordx4 v[160:163], v45, s[8:11], s75 offen sc1
    buffer_load_dwordx4 v[164:167], v46, s[8:11], s75 offen sc1
    buffer_load_dwordx4 v[168:171], v47, s[8:11], s75 offen sc1
    buffer_load_dwordx4 v[172:175], v52, s[8:11], s75 offen sc1
    s_add_u32 s75, s69, 163840
    buffer_load_dwordx4 v[176:179], v44, s[8:11], s75 offen sc1
    buffer_load_dwordx4 v[180:183], v45, s[8:11], s75 offen sc1
    buffer_load_dwordx4 v[184:187], v46, s[8:11], s75 offen sc1
    buffer_load_dwordx4 v[188:191], v47, s[8:11], s75 offen sc1
    buffer_load_dwordx4 v[192:195], v52, s[8:11], s75 offen sc1
    s_add_u32 s75, s69, 204800
    buffer_load_dwordx4 v[196:199], v44, s[8:11], s75 offen sc1
    buffer_load_dwordx4 v[200:203], v45, s[8:11], s75 offen sc1
    buffer_load_dwordx4 v[204:207], v46, s[8:11], s75 offen sc1
    buffer_load_dwordx4 v[208:211], v47, s[8:11], s75 offen sc1
    buffer_load_dwordx4 v[212:215], v52, s[8:11], s75 offen sc1
    s_cmp_gt_i32 s62, s63
    s_cbranch_scc1 L_e4
    s_cmp_eq_i32 s62, s63
    s_cbranch_scc1 L_lw2
    s_waitcnt vmcnt(15)
L_lw2:
    s_waitcnt vmcnt(20)
    s_call_b64 s[82:83], L_pend
    s_barrier
    s_call_b64 s[82:83], L_load
    s_add_i32 s62, s62, 1
L_e4:
    s_lshr_b32 s7, s3, 1
    s_lshl_b32 s7, s7, 4
    s_add_u32 s6, s5, s7
    s_cmp_lg_u32 s6, 3
    s_cbranch_scc1 L_yl0
    v_min_u32 v3, 53, v1
    v_lshlrev_b32 v3, 7, v3
    s_mov_b32 s72, 0xf20000
    buffer_load_dwordx4 v[16:19], v3, s[8:11], s72 offen sc1
L_yl0:
    s_add_u32 s75, s69, 245760
    buffer_load_dwordx4 v[216:219], v44, s[8:11], s75 offen sc1
    buffer_load_dwordx4 v[220:223], v45, s[8:11], s75 offen sc1
    buffer_load_dwordx4 v[224:227], v46, s[8:11], s75 offen sc1
    buffer_load_dwordx4 v[228:231], v47, s[8:11], s75 offen sc1
    buffer_load_dwordx4 v[232:235], v52, s[8:11], s75 offen sc1
    s_add_u32 s75, s69, 286720
    buffer_load_dwordx4 v[236:239], v44, s[8:11], s75 offen sc1
    buffer_load_dwordx4 v[240:243], v45, s[8:11], s75 offen sc1
    buffer_load_dwordx4 v[244:247], v46, s[8:11], s75 offen sc1
    buffer_load_dwordx4 v[248:251], v47, s[8:11], s75 offen sc1
    buffer_load_dwordx4 v[252:255], v52, s[8:11], s75 offen sc1
    s_cmp_gt_i32 s62, s63
    s_cbranch_scc1 L_e5
    s_cmp_eq_i32 s62, s63
    s_cbranch_scc1 L_lw3
    s_waitcnt vmcnt(10)
L_lw3:
    s_waitcnt vmcnt(20)
    s_call_b64 s[82:83], L_pend
    s_barrier
    s_call_b64 s[82:83], L_load
    s_add_i32 s62, s62, 1
L_e5:
    s_mov_b32 s101, 0
    s_lshr_b32 s7, s3, 1
    s_lshl_b32 s7, s7, 4
    s_add_u32 s6, s5, s7
    s_cmp_lg_u32 s6, 3
    s_cbranch_scc1 L_yl1
    v_and_b32 v16, v16, v17
    v_and_b32 v16, v16, v18
    v_and_b32 v16, v16, v19
    v_cmp_ne_u32 vcc, 1, v16
    s_cbranch_vccnz L_yl1
    s_call_b64 s[80:81], L_yld
L_yl1:
    v_and_b32 v3, 1, v1
    v_lshlrev_b32 v3, 12, v3
    v_and_b32 v2, 2, v1
    v_lshl_add_u32 v3, v2, 8, v3
    s_lshr_b32 s72, s68, 2
    s_lshl_b32 s72, s72, 6
    s_andn2_b32 s6, s4, 7
    s_add_u32 s72, s72, s6
    s_add_u32 s72, s72, s3
    s_lshl_b32 s72, s72, 7
    s_add_u32 s72, s72, 3932160
    buffer_load_dword v50, v3, s[8:11], s72 offen sc1
    s_cmp_gt_i32 s62, s63
    s_cbranch_scc1 L_e6
    s_waitcnt vmcnt(20)
    s_call_b64 s[82:83], L_pend
    s_barrier
    s_call_b64 s[82:83], L_load
    s_add_i32 s62, s62, 1
L_e6:
    s_lshr_b32 s7, s3, 1
    s_lshl_b32 s7, s7, 4
    s_add_u32 s6, s5, s7
    s_cmp_lg_u32 s6, 3
    s_cbranch_scc1 L_yd
    s_cmp_lg_u32 s101, 0
    s_cbranch_scc1 L_yf
    v_min_u32 v3, 53, v1
    v_lshlrev_b32 v3, 7, v3
    s_mov_b32 s72, 0xf20000
    s_mov_b32 s79, 262144
L_poll_31:
    buffer_load_dwordx4 v[16:19], v3, s[8:11], s72 offen sc1
    s_waitcnt vmcnt(0)
    v_and_b32 v16, v16, v17
    v_and_b32 v16, v16, v18
    v_and_b32 v16, v16, v19
    v_cmp_ne_u32 vcc, 1, v16
    s_cbranch_vccz L_polldone_32
    s_sleep 16
    s_sub_u32 s79, s79, 1
    s_cmp_lg_u32 s79, 0
    s_cbranch_scc1 L_poll_31
L_polldone_32:
    s_call_b64 s[80:81], L_yld
L_yf:
    s_bfe_u32 s6, s98, 0x10000b
    s_xor_b32 s7, s6, 0xffff
    s_bitcmp1_b32 s6, 15
    s_bitset0_b32 s6, 15
    s_cselect_b32 s6, s6, s7
    s_lshl_b32 s6, s6, 16
    v_mov_b32 v9, s6
    v_mul_f32 v9, 0xbfb8aa3b, v9
    v_exp_f32 v9, v9
    s_nop 0
    v_add_f32 v9, 1.0, v9
    v_rcp_f32 v9, v9
    s_nop 0
    v_cvt_pk_bf16_f32 v9, v9, v9
    v_lshlrev_b32 v9, 16, v9
    v_lshlrev_b32 v10, 2, v1
    v_mov_b32 v3, 0x5000000
    s_waitcnt vmcnt(0)
    v_pk_add_f32 v[16:17], v[16:17], v[20:21]
    v_pk_add_f32 v[18:19], v[18:19], v[22:23]
    v_pk_add_f32 v[16:17], v[16:17], v[24:25]
    v_pk_add_f32 v[18:19], v[18:19], v[26:27]
    v_pk_add_f32 v[16:17], v[16:17], v[28:29]
    v_pk_add_f32 v[18:19], v[18:19], v[30:31]
    v_pk_add_f32 v[16:17], v[16:17], v[32:33]
    v_pk_add_f32 v[18:19], v[18:19], v[34:35]
    v_pk_add_f32 v[16:17], v[16:17], v[36:37]
    v_pk_add_f32 v[18:19], v[18:19], v[38:39]
    v_pk_add_f32 v[16:17], v[16:17], v[40:41]
    v_pk_add_f32 v[18:19], v[18:19], v[42:43]
    v_pk_add_f32 v[16:17], v[16:17], v[56:57]
    v_pk_add_f32 v[18:19], v[18:19], v[58:59]
    v_pk_add_f32 v[16:17], v[16:17], v[60:61]
    v_pk_add_f32 v[18:19], v[18:19], v[62:63]
    v_pk_add_f32 v[16:17], v[16:17], v[64:65]
    v_pk_add_f32 v[18:19], v[18:19], v[66:67]
    v_pk_add_f32 v[16:17], v[16:17], v[68:69]
    v_pk_add_f32 v[18:19], v[18:19], v[70:71]
    v_pk_add_f32 v[16:17], v[16:17], v[72:73]
    v_pk_add_f32 v[18:19], v[18:19], v[74:75]
    v_pk_add_f32 v[16:17], v[16:17], v[76:77]
    v_pk_add_f32 v[18:19], v[18:19], v[78:79]
    v_pk_add_f32 v[16:17], v[16:17], v[80:81]
    v_pk_add_f32 v[18:19], v[18:19], v[82:83]
    v_pk_add_f32 v[16:17], v[16:17], v[84:85]
    v_pk_add_f32 v[18:19], v[18:19], v[86:87]
    v_pk_add_f32 v[16:17], v[16:17], v[88:89]
    v_pk_add_f32 v[18:19], v[18:19], v[90:91]
    v_pk_add_f32 v[16:17], v[16:17], v[92:93]
    v_pk_add_f32 v[18:19], v[18:19], v[94:95]
    v_pk_add_f32 v[16:17], v[16:17], v[4:5]
    v_pk_add_f32 v[18:19], v[18:19], v[6:7]
    ds_bpermute_b32 v20, v10, v16 offset:80
    ds_bpermute_b32 v21, v10, v17 offset:80
    ds_bpermute_b32 v22, v10, v18 offset:80
    ds_bpermute_b32 v23, v10, v19 offset:80
    ds_bpermute_b32 v24, v10, v16 offset:160
    ds_bpermute_b32 v25, v10, v17 offset:160
    ds_bpermute_b32 v26, v10, v18 offset:160
    ds_bpermute_b32 v27, v10, v19 offset:160
    s_waitcnt lgkmcnt(0)
    v_add_f32 v16, v16, v20
    v_add_f32 v16, v16, v24
    v_cvt_pk_bf16_f32 v16, v16, v16
    v_lshlrev_b32 v16, 16, v16
    v_mul_f32 v16, v16, v9
    v_cvt_pk_bf16_f32 v16, v16, v16
    v_lshlrev_b32 v16, 16, v16
    v_lshlrev_b32 v8, 16, v54
    v_add_f32 v16, v16, v8
    v_add_f32 v17, v17, v21
    v_add_f32 v17, v17, v25
    v_cvt_pk_bf16_f32 v17, v17, v17
    v_lshlrev_b32 v17, 16, v17
    v_mul_f32 v17, v17, v9
    v_cvt_pk_bf16_f32 v17, v17, v17
    v_lshlrev_b32 v17, 16, v17
    v_and_b32 v8, 0xffff0000, v54
    v_add_f32 v17, v17, v8
    v_add_f32 v18, v18, v22
    v_add_f32 v18, v18, v26
    v_cvt_pk_bf16_f32 v18, v18, v18
    v_lshlrev_b32 v18, 16, v18
    v_mul_f32 v18, v18, v9
    v_cvt_pk_bf16_f32 v18, v18, v18
    v_lshlrev_b32 v18, 16, v18
    v_lshlrev_b32 v8, 16, v55
    v_add_f32 v18, v18, v8
    v_add_f32 v19, v19, v23
    v_add_f32 v19, v19, v27
    v_cvt_pk_bf16_f32 v19, v19, v19
    v_lshlrev_b32 v19, 16, v19
    v_mul_f32 v19, v19, v9
    v_cvt_pk_bf16_f32 v19, v19, v19
    v_lshlrev_b32 v19, 16, v19
    v_and_b32 v8, 0xffff0000, v55
    v_add_f32 v19, v19, v8
    v_cvt_pk_bf16_f32 v20, v16, v17
    v_cvt_pk_bf16_f32 v21, v18, v19
    v_lshlrev_b32 v2, 3, v1
    v_cmp_lt_u32 vcc, 19, v1
    s_mul_i32 s6, s96, 1280
    s_mul_i32 s7, s97, 160
    v_cndmask_b32 v2, v2, v3, vcc
    s_add_u32 s6, s6, s7
    s_add_u32 s6, s6, 3837952
    buffer_store_dwordx2 v[20:21], v2, s[8:11], s6 offen sc1
L_yd:
    s_lshr_b32 s6, s4, 3
    s_lshl_b32 s6, s6, 15
    s_lshl_b32 s99, s3, 12
    s_add_u32 s66, s6, s99
    s_add_u32 s66, s66, 50331648
    s_lshl_b32 s6, s76, 13
    v_add_u32 v4, s6, v13
    v_add_u32 v7, 65536, v4
    s_waitcnt vmcnt(0)
    v_cmp_ne_u32 vcc, 1, v50
    s_cbranch_vccz L_ce
    v_and_b32 v3, 1, v1
    v_lshlrev_b32 v3, 12, v3
    v_and_b32 v2, 2, v1
    v_lshl_add_u32 v3, v2, 8, v3
    s_lshr_b32 s72, s68, 2
    s_lshl_b32 s72, s72, 6
    s_andn2_b32 s6, s4, 7
    s_add_u32 s72, s72, s6
    s_add_u32 s72, s72, s3
    s_lshl_b32 s72, s72, 7
    s_add_u32 s72, s72, 3932160
    s_mov_b32 s79, 262144
L_poll_33:
    buffer_load_dword v2, v3, s[8:11], s72 offen sc1
    s_waitcnt vmcnt(0)
    v_cmp_ne_u32 vcc, 1, v2
    s_cbranch_vccz L_polldone_34
    s_sleep 4
    s_sub_u32 s79, s79, 1
    s_cmp_lg_u32 s79, 0
    s_cbranch_scc1 L_poll_33
L_polldone_34:
L_ce:
    s_add_u32 s65, s68, 1
    s_and_b32 s65, s65, 3
    s_andn2_b32 s7, s68, 3
    s_add_u32 s65, s65, s7
    s_lshl_b32 s65, s65, 17
    s_add_u32 s65, s65, s66
    s_add_u32 m0, s99, 0
    s_add_u32 s65, s65, 0
    buffer_load_dwordx4 v13, s[8:11], s65 offen offset:0 sc1 lds
    buffer_load_dwordx4 v13, s[8:11], s65 offen offset:1024 sc1 lds
    buffer_load_dwordx4 v13, s[8:11], s65 offen offset:2048 sc1 lds
    buffer_load_dwordx4 v13, s[8:11], s65 offen offset:3072 sc1 lds
    s_add_u32 s65, s68, 1
    s_and_b32 s65, s65, 3
    s_andn2_b32 s7, s68, 3
    s_add_u32 s65, s65, s7
    s_lshl_b32 s65, s65, 17
    s_add_u32 s65, s65, s66
    s_add_u32 m0, s99, 16384
    s_add_u32 s65, s65, 16384
    buffer_load_dwordx4 v13, s[8:11], s65 offen offset:0 sc1 lds
    buffer_load_dwordx4 v13, s[8:11], s65 offen offset:1024 sc1 lds
    buffer_load_dwordx4 v13, s[8:11], s65 offen offset:2048 sc1 lds
    buffer_load_dwordx4 v13, s[8:11], s65 offen offset:3072 sc1 lds
    s_add_u32 s65, s68, 2
    s_and_b32 s65, s65, 3
    s_andn2_b32 s7, s68, 3
    s_add_u32 s65, s65, s7
    s_lshl_b32 s65, s65, 17
    s_add_u32 s65, s65, s66
    s_add_u32 m0, s99, 32768
    s_add_u32 s65, s65, 0
    buffer_load_dwordx4 v13, s[8:11], s65 offen offset:0 sc1 lds
    buffer_load_dwordx4 v13, s[8:11], s65 offen offset:1024 sc1 lds
    buffer_load_dwordx4 v13, s[8:11], s65 offen offset:2048 sc1 lds
    buffer_load_dwordx4 v13, s[8:11], s65 offen offset:3072 sc1 lds
    s_add_u32 s65, s68, 2
    s_and_b32 s65, s65, 3
    s_andn2_b32 s7, s68, 3
    s_add_u32 s65, s65, s7
    s_lshl_b32 s65, s65, 17
    s_add_u32 s65, s65, s66
    s_add_u32 m0, s99, 49152
    s_add_u32 s65, s65, 16384
    buffer_load_dwordx4 v13, s[8:11], s65 offen offset:0 sc1 lds
    buffer_load_dwordx4 v13, s[8:11], s65 offen offset:1024 sc1 lds
    buffer_load_dwordx4 v13, s[8:11], s65 offen offset:2048 sc1 lds
    buffer_load_dwordx4 v13, s[8:11], s65 offen offset:3072 sc1 lds
    s_lshr_b32 s7, s3, 1
    s_lshl_b32 s7, s7, 4
    s_add_u32 s6, s5, s7
    s_cmp_lg_u32 s6, 3
    s_cbranch_scc1 L_yg
    s_lshl_b32 s6, s5, 5
    s_add_u32 s6, s6, s4
    s_lshl_b32 s6, s6, 5
    s_add_u32 s6, s6, s3
    s_lshl_b32 s6, s6, 2
    s_add_u32 s6, s6, 3899392
    v_mov_b32 v2, 1
    v_mov_b32 v3, 0x5000000
    v_writelane_b32 v3, s6, 0
    buffer_store_dword v2, v3, s[8:11], 0 offen sc1
    s_waitcnt vmcnt(1)
    s_branch L_ye
L_yg:
    s_waitcnt vmcnt(0)
L_ye:
    s_setprio 0
    s_barrier
    s_branch L_adone
L_yld:
    v_cmp_le_i32 vcc, 0, v51
    s_cbranch_vccz L_idx_oka
    v_and_b32 v3, 7, v1
    v_lshlrev_b32 v3, 2, v3
    s_mov_b32 s72, 0x3a0000
    s_mov_b32 s79, 262144
L_poll_35:
    buffer_load_dword v51, v3, s[8:11], s72 offen sc1
    s_waitcnt vmcnt(0)
    v_cmp_le_i32 vcc, 0, v51
    s_cbranch_vccz L_polldone_36
    s_sleep 2
    s_sub_u32 s79, s79, 1
    s_cmp_lg_u32 s79, 0
    s_cbranch_scc1 L_poll_35
L_polldone_36:
L_idx_oka:
    s_lshr_b32 s96, s4, 2
    s_and_b32 s97, s4, 3
    s_lshl_b32 s97, s97, 1
    s_add_u32 s97, s97, s3
    s_mov_b32 m0, s96
    s_nop 3
    v_readlane_b32 s98, v51, m0
    s_nop 3
    s_and_b32 s100, s98, 0x7ff
    s_sub_u32 s100, 0x7ff, s100
    v_mul_u32_u24 v2, 13, v1
    v_lshrrev_b32 v2, 8, v2
    v_mul_u32_u24 v3, 20, v2
    v_sub_u32 v8, v1, v3
    s_mov_b32 s6, 368640
    v_mul_lo_u32 v2, v2, s6
    v_lshl_add_u32 v2, v8, 4, v2
    v_cmp_lt_u32 vcc, 59, v1
    v_mov_b32 v3, 0x5000000
    s_nop 0
    v_cndmask_b32 v2, v2, v3, vcc
    s_mul_i32 s6, s96, 2560
    s_mul_i32 s7, s97, 320
    s_add_u32 s6, s6, s7
    s_add_u32 s6, s6, 2686976
    buffer_load_dwordx4 v[16:19], v2, s[8:11], s6 offen sc1
    s_add_u32 s6, s6, 20480
    buffer_load_dwordx4 v[20:23], v2, s[8:11], s6 offen sc1
    s_add_u32 s6, s6, 20480
    buffer_load_dwordx4 v[24:27], v2, s[8:11], s6 offen sc1
    s_add_u32 s6, s6, 20480
    buffer_load_dwordx4 v[28:31], v2, s[8:11], s6 offen sc1
    s_add_u32 s6, s6, 20480
    buffer_load_dwordx4 v[32:35], v2, s[8:11], s6 offen sc1
    s_add_u32 s6, s6, 20480
    buffer_load_dwordx4 v[36:39], v2, s[8:11], s6 offen sc1
    s_add_u32 s6, s6, 20480
    buffer_load_dwordx4 v[40:43], v2, s[8:11], s6 offen sc1
    s_add_u32 s6, s6, 20480
    buffer_load_dwordx4 v[56:59], v2, s[8:11], s6 offen sc1
    s_add_u32 s6, s6, 20480
    buffer_load_dwordx4 v[60:63], v2, s[8:11], s6 offen sc1
    s_add_u32 s6, s6, 20480
    buffer_load_dwordx4 v[64:67], v2, s[8:11], s6 offen sc1
    s_add_u32 s6, s6, 20480
    buffer_load_dwordx4 v[68:71], v2, s[8:11], s6 offen sc1
    s_add_u32 s6, s6, 20480
    buffer_load_dwordx4 v[72:75], v2, s[8:11], s6 offen sc1
    s_add_u32 s6, s6, 20480
    buffer_load_dwordx4 v[76:79], v2, s[8:11], s6 offen sc1
    s_add_u32 s6, s6, 20480
    buffer_load_dwordx4 v[80:83], v2, s[8:11], s6 offen sc1
    s_add_u32 s6, s6, 20480
    buffer_load_dwordx4 v[84:87], v2, s[8:11], s6 offen sc1
    s_add_u32 s6, s6, 20480
    buffer_load_dwordx4 v[88:91], v2, s[8:11], s6 offen sc1
    s_add_u32 s6, s6, 20480
    buffer_load_dwordx4 v[92:95], v2, s[8:11], s6 offen sc1
    s_add_u32 s6, s6, 20480
    buffer_load_dwordx4 v[4:7], v2, s[8:11], s6 offen sc1
    s_add_u32 s6, s6, 20480
    s_lshr_b32 s6, s100, 4
    s_mul_i32 s6, s6, 20480
    s_and_b32 s7, s100, 15
    s_lshl_b32 s7, s7, 4
    s_add_u32 s6, s6, s7
    s_mul_i32 s7, s97, 2560
    s_add_u32 s6, s6, s7
    v_lshrrev_b32 v9, 1, v8
    v_lshlrev_b32 v9, 8, v9
    v_and_b32 v10, 1, v8
    v_lshl_add_u32 v9, v10, 3, v9
    buffer_load_dwordx2 v[54:55], v9, s[8:11], s6 offen sc1
    s_mov_b32 s101, 1
    s_setpc_b64 s[80:81]
L_moe:
    s_sub_u32 s6, s62, s5
    s_cmp_lg_u32 s6, 3
    s_cbranch_scc1 L_idle
    s_mov_b32 s12, s48
    s_mov_b32 s13, s49
    s_mov_b32 s14, 0x21c000
    s_mov_b32 s15, 0x20000
    s_cmp_ge_u32 s3, 2
    s_cselect_b32 s12, s50, s12
    s_cselect_b32 s13, s51, s13
    s_mov_b32 s16, s52
    s_mov_b32 s17, s53
    s_mov_b32 s18, 0x21c000
    s_mov_b32 s19, 0x20000
    v_lshrrev_b32 v3, 2, v1
    v_mul_u32_u24 v3, 3456, v3
    v_and_b32 v4, 3, v1
    v_lshl_add_u32 v16, v4, 4, v3
    v_lshrrev_b32 v3, 3, v1
    v_mul_u32_u24 v3, 1280, v3
    v_and_b32 v4, 7, v1
    v_lshl_add_u32 v18, v4, 4, v3
    s_and_b32 s7, s3, 1
    s_mul_i32 s84, s7, 1105920
    s_lshl_b32 s6, s61, 6
    s_add_u32 s84, s84, s6
    s_lshl_b32 s85, s3, 13
    s_add_u32 s85, s85, 131072
    s_mul_i32 s86, s61, 40960
    s_lshl_b32 s6, s3, 7
    s_add_u32 s86, s86, s6
    s_add_u32 m0, s85, 0
    s_nop 0
    buffer_load_dwordx4 v16, s[12:15], s84 offen lds
    s_add_u32 s84, s84, 55296
    s_add_u32 m0, s85, 1024
    s_nop 0
    buffer_load_dwordx4 v16, s[12:15], s84 offen lds
    s_add_u32 s84, s84, 55296
    s_add_u32 m0, s85, 2048
    s_nop 0
    buffer_load_dwordx4 v16, s[12:15], s84 offen lds
    s_add_u32 s84, s84, 55296
    s_add_u32 m0, s85, 3072
    s_nop 0
    buffer_load_dwordx4 v16, s[12:15], s84 offen lds
    s_add_u32 s84, s84, 55296
    s_add_u32 m0, s85, 4096
    s_nop 0
    buffer_load_dwordx4 v16, s[12:15], s84 offen lds
    s_add_u32 s84, s84, 55296
    s_add_u32 m0, s85, 5120
    s_nop 0
    buffer_load_dwordx4 v16, s[12:15], s84 offen lds
    s_add_u32 s84, s84, 55296
    s_add_u32 m0, s85, 6144
    s_nop 0
    buffer_load_dwordx4 v16, s[12:15], s84 offen lds
    s_add_u32 s84, s84, 55296
    s_add_u32 m0, s85, 7168
    s_nop 0
    buffer_load_dwordx4 v16, s[12:15], s84 offen lds
    s_add_u32 s84, s84, 55296
    v_lshrrev_b32 v7, 4, v1
    v_and_b32 v2, 15, v1
    v_lshrrev_b32 v3, 2, v2
    v_lshl_add_u32 v8, v7, 3, v3
    v_lshlrev_b32 v8, 6, v8
    v_and_b32 v4, 3, v2
    v_lshl_add_u32 v8, v4, 3, v8
    v_add_u32 v17, s85, v8
    v_lshl_add_u32 v8, v7, 2, v3
    v_lshlrev_b32 v8, 7, v8
    v_lshl_add_u32 v8, v4, 3, v8
    s_add_u32 s6, s85, 4096
    v_add_u32 v19, s6, v8
    v_mul_u32_u24 v3, 2560, v2
    v_lshl_add_u32 v3, v7, 4, v3
    v_mov_b32 v4, 0x5000000
    v_cmp_gt_u32 vcc, 8, v2
    s_mul_i32 s87, s61, 20480
    s_lshl_b32 s7, s3, 8
    s_add_u32 s87, s87, s7
    s_add_u32 s87, s87, 2686976
    v_cndmask_b32 v20, v4, v3, vcc
    s_and_b32 s7, s3, 1
    s_mul_i32 s88, s7, 10240
    s_add_u32 s88, s88, 12582912
    s_waitcnt vmcnt(0) lgkmcnt(0)
    s_call_b64 s[82:83], L_pend
    s_barrier
    ds_read_b64_tr_b16 v[104:105], v17 offset:0
    ds_read_b64_tr_b16 v[106:107], v17 offset:256
    ds_read_b64_tr_b16 v[108:109], v17 offset:32
    ds_read_b64_tr_b16 v[110:111], v17 offset:288
    ds_read_b64_tr_b16 v[112:113], v17 offset:2048
    ds_read_b64_tr_b16 v[114:115], v17 offset:2304
    ds_read_b64_tr_b16 v[116:117], v17 offset:2080
    ds_read_b64_tr_b16 v[118:119], v17 offset:2336
    s_waitcnt lgkmcnt(0)
    ds_read_b64_tr_b16 v[120:121], v17 offset:4096
    ds_read_b64_tr_b16 v[122:123], v17 offset:4352
    ds_read_b64_tr_b16 v[124:125], v17 offset:4128
    ds_read_b64_tr_b16 v[126:127], v17 offset:4384
    ds_read_b64_tr_b16 v[128:129], v17 offset:6144
    ds_read_b64_tr_b16 v[130:131], v17 offset:6400
    ds_read_b64_tr_b16 v[132:133], v17 offset:6176
    ds_read_b64_tr_b16 v[134:135], v17 offset:6432
    s_waitcnt lgkmcnt(0)
    s_add_u32 m0, s85, 0
    s_nop 0
    buffer_load_dwordx4 v16, s[12:15], s84 offen lds
    s_add_u32 s84, s84, 55296
    s_add_u32 m0, s85, 1024
    s_nop 0
    buffer_load_dwordx4 v16, s[12:15], s84 offen lds
    s_add_u32 s84, s84, 55296
    s_add_u32 m0, s85, 2048
    s_nop 0
    buffer_load_dwordx4 v16, s[12:15], s84 offen lds
    s_add_u32 s84, s84, 55296
    s_add_u32 m0, s85, 3072
    s_nop 0
    buffer_load_dwordx4 v16, s[12:15], s84 offen lds
    s_add_u32 s84, s84, 55296
    s_add_u32 m0, s85, 4096
    s_nop 0
    buffer_load_dwordx4 v16, s[12:15], s84 offen lds
    s_add_u32 s84, s84, 55296
    s_add_u32 m0, s85, 5120
    s_nop 0
    buffer_load_dwordx4 v16, s[12:15], s84 offen lds
    s_add_u32 s84, s84, 55296
    s_add_u32 m0, s85, 6144
    s_nop 0
    buffer_load_dwordx4 v16, s[12:15], s84 offen lds
    s_add_u32 s84, s84, 55296
    s_add_u32 m0, s85, 7168
    s_nop 0
    buffer_load_dwordx4 v16, s[12:15], s84 offen lds
    s_add_u32 s84, s84, 55296
    s_call_b64 s[82:83], L_load
    s_add_i32 s62, s62, 1
    v_and_b32 v3, 7, v1
    v_lshlrev_b32 v3, 2, v3
    s_mov_b32 s72, 0x3a0000
    buffer_load_dword v51, v3, s[8:11], s72 offen sc1
    s_waitcnt vmcnt(0) lgkmcnt(0)
    s_call_b64 s[82:83], L_pend
    s_barrier
    ds_read_b64_tr_b16 v[136:137], v17 offset:0
    ds_read_b64_tr_b16 v[138:139], v17 offset:256
    ds_read_b64_tr_b16 v[140:141], v17 offset:32
    ds_read_b64_tr_b16 v[142:143], v17 offset:288
    ds_read_b64_tr_b16 v[144:145], v17 offset:2048
    ds_read_b64_tr_b16 v[146:147], v17 offset:2304
    ds_read_b64_tr_b16 v[148:149], v17 offset:2080
    ds_read_b64_tr_b16 v[150:151], v17 offset:2336
    s_waitcnt lgkmcnt(0)
    ds_read_b64_tr_b16 v[152:153], v17 offset:4096
    ds_read_b64_tr_b16 v[154:155], v17 offset:4352
    ds_read_b64_tr_b16 v[156:157], v17 offset:4128
    ds_read_b64_tr_b16 v[158:159], v17 offset:4384
    ds_read_b64_tr_b16 v[160:161], v17 offset:6144
    ds_read_b64_tr_b16 v[162:163], v17 offset:6400
    ds_read_b64_tr_b16 v[164:165], v17 offset:6176
    ds_read_b64_tr_b16 v[166:167], v17 offset:6432
    s_waitcnt lgkmcnt(0)
    s_add_u32 m0, s85, 0
    s_nop 0
    buffer_load_dwordx4 v16, s[12:15], s84 offen lds
    s_add_u32 s84, s84, 55296
    s_add_u32 m0, s85, 1024
    s_nop 0
    buffer_load_dwordx4 v16, s[12:15], s84 offen lds
    s_add_u32 s84, s84, 55296
    s_add_u32 m0, s85, 2048
    s_nop 0
    buffer_load_dwordx4 v16, s[12:15], s84 offen lds
    s_add_u32 s84, s84, 55296
    s_add_u32 m0, s85, 3072
    s_nop 0
    buffer_load_dwordx4 v16, s[12:15], s84 offen lds
    s_add_u32 s84, s84, 55296
    s_add_u32 m0, s85, 4096
    s_add_u32 s6, s86, 0
    buffer_load_dwordx4 v18, s[16:19], s6 offen lds
    s_add_u32 m0, s85, 5120
    s_add_u32 s6, s86, 10240
    buffer_load_dwordx4 v18, s[16:19], s6 offen lds
    s_add_u32 m0, s85, 6144
    s_add_u32 s6, s86, 20480
    buffer_load_dwordx4 v18, s[16:19], s6 offen lds
    s_add_u32 m0, s85, 7168
    s_add_u32 s6, s86, 30720
    buffer_load_dwordx4 v18, s[16:19], s6 offen lds
    s_add_u32 s86, s86, 512
    s_call_b64 s[82:83], L_load
    s_add_i32 s62, s62, 1
    v_cmp_le_i32 vcc, 0, v51
    s_cbranch_vccz L_idx_okm
    v_and_b32 v3, 7, v1
    v_lshlrev_b32 v3, 2, v3
    s_mov_b32 s72, 0x3a0000
    s_mov_b32 s79, 262144
L_poll_39:
    buffer_load_dword v51, v3, s[8:11], s72 offen sc1
    s_waitcnt vmcnt(0)
    v_cmp_le_i32 vcc, 0, v51
    s_cbranch_vccz L_polldone_40
    s_sleep 2
    s_sub_u32 s79, s79, 1
    s_cmp_lg_u32 s79, 0
    s_cbranch_scc1 L_poll_39
L_polldone_40:
L_idx_okm:
    buffer_load_dwordx4 v[64:67], v13, s[8:11], s88 offen sc1
    s_add_u32 s88, s88, 1024
    buffer_load_dwordx4 v[68:71], v13, s[8:11], s88 offen sc1
    s_add_u32 s88, s88, 1024
    buffer_load_dwordx4 v[72:75], v13, s[8:11], s88 offen sc1
    s_add_u32 s88, s88, 1024
    buffer_load_dwordx4 v[76:79], v13, s[8:11], s88 offen sc1
    s_add_u32 s88, s88, 1024
    buffer_load_dwordx4 v[80:83], v13, s[8:11], s88 offen sc1
    s_add_u32 s88, s88, 1024
    buffer_load_dwordx4 v[84:87], v13, s[8:11], s88 offen sc1
    s_add_u32 s88, s88, 1024
    buffer_load_dwordx4 v[88:91], v13, s[8:11], s88 offen sc1
    s_add_u32 s88, s88, 1024
    buffer_load_dwordx4 v[92:95], v13, s[8:11], s88 offen sc1
    s_add_u32 s88, s88, 1024
    buffer_load_dwordx4 v[96:99], v13, s[8:11], s88 offen sc1
    s_add_u32 s88, s88, 1024
    buffer_load_dwordx4 v[100:103], v13, s[8:11], s88 offen sc1
    s_add_u32 s88, s88, 1024
    s_waitcnt vmcnt(10) lgkmcnt(0)
    s_call_b64 s[82:83], L_pend
    s_barrier
    ds_read_b64_tr_b16 v[168:169], v17 offset:0
    ds_read_b64_tr_b16 v[170:171], v17 offset:256
    ds_read_b64_tr_b16 v[172:173], v17 offset:32
    ds_read_b64_tr_b16 v[174:175], v17 offset:288
    ds_read_b64_tr_b16 v[176:177], v17 offset:2048
    ds_read_b64_tr_b16 v[178:179], v17 offset:2304
    ds_read_b64_tr_b16 v[180:181], v17 offset:2080
    ds_read_b64_tr_b16 v[182:183], v17 offset:2336
    s_waitcnt lgkmcnt(0)
    ds_read_b64_tr_b16 v[32:33], v19 offset:0
    ds_read_b64_tr_b16 v[34:35], v19 offset:2048
    ds_read_b64_tr_b16 v[36:37], v19 offset:32
    ds_read_b64_tr_b16 v[38:39], v19 offset:2080
    ds_read_b64_tr_b16 v[40:41], v19 offset:64
    ds_read_b64_tr_b16 v[42:43], v19 offset:2112
    ds_read_b64_tr_b16 v[44:45], v19 offset:96
    ds_read_b64_tr_b16 v[46:47], v19 offset:2144
    s_waitcnt lgkmcnt(0)
    s_add_u32 m0, s85, 4096
    s_add_u32 s6, s86, 0
    buffer_load_dwordx4 v18, s[16:19], s6 offen lds
    s_add_u32 m0, s85, 5120
    s_add_u32 s6, s86, 10240
    buffer_load_dwordx4 v18, s[16:19], s6 offen lds
    s_add_u32 m0, s85, 6144
    s_add_u32 s6, s86, 20480
    buffer_load_dwordx4 v18, s[16:19], s6 offen lds
    s_add_u32 m0, s85, 7168
    s_add_u32 s6, s86, 30720
    buffer_load_dwordx4 v18, s[16:19], s6 offen lds
    s_add_u32 s86, s86, 512
    s_call_b64 s[82:83], L_load
    s_add_i32 s62, s62, 1
    s_waitcnt vmcnt(20)
    v_mfma_f32_16x16x32_bf16 v[24:27], v[104:107], v[64:67], 0
    v_mfma_f32_16x16x32_bf16 v[28:31], v[108:111], v[64:67], 0
    v_mfma_f32_16x16x32_bf16 v[24:27], v[112:115], v[68:71], v[24:27]
    v_mfma_f32_16x16x32_bf16 v[28:31], v[116:119], v[68:71], v[28:31]
    v_mfma_f32_16x16x32_bf16 v[24:27], v[120:123], v[72:75], v[24:27]
    v_mfma_f32_16x16x32_bf16 v[28:31], v[124:127], v[72:75], v[28:31]
    v_mfma_f32_16x16x32_bf16 v[24:27], v[128:131], v[76:79], v[24:27]
    v_mfma_f32_16x16x32_bf16 v[28:31], v[132:135], v[76:79], v[28:31]
    v_mfma_f32_16x16x32_bf16 v[24:27], v[136:139], v[80:83], v[24:27]
    v_mfma_f32_16x16x32_bf16 v[28:31], v[140:143], v[80:83], v[28:31]
    v_mfma_f32_16x16x32_bf16 v[24:27], v[144:147], v[84:87], v[24:27]
    v_mfma_f32_16x16x32_bf16 v[28:31], v[148:151], v[84:87], v[28:31]
    v_mfma_f32_16x16x32_bf16 v[24:27], v[152:155], v[88:91], v[24:27]
    v_mfma_f32_16x16x32_bf16 v[28:31], v[156:159], v[88:91], v[28:31]
    v_mfma_f32_16x16x32_bf16 v[24:27], v[160:163], v[92:95], v[24:27]
    v_mfma_f32_16x16x32_bf16 v[28:31], v[164:167], v[92:95], v[28:31]
    v_mfma_f32_16x16x32_bf16 v[24:27], v[168:171], v[96:99], v[24:27]
    v_mfma_f32_16x16x32_bf16 v[28:31], v[172:175], v[96:99], v[28:31]
    v_mfma_f32_16x16x32_bf16 v[24:27], v[176:179], v[100:103], v[24:27]
    v_mfma_f32_16x16x32_bf16 v[28:31], v[180:183], v[100:103], v[28:31]
    v_add_u32 v10, s85, v13
    s_nop 7
    ds_write_b128 v10, v[24:27]
    ds_write_b128 v10, v[28:31] offset:1024
    s_waitcnt vmcnt(0) lgkmcnt(0)
    s_call_b64 s[82:83], L_pend
    s_barrier
    ds_read_b64_tr_b16 v[240:241], v19 offset:0
    ds_read_b64_tr_b16 v[242:243], v19 offset:2048
    ds_read_b64_tr_b16 v[244:245], v19 offset:32
    ds_read_b64_tr_b16 v[246:247], v19 offset:2080
    ds_read_b64_tr_b16 v[248:249], v19 offset:64
    ds_read_b64_tr_b16 v[250:251], v19 offset:2112
    ds_read_b64_tr_b16 v[252:253], v19 offset:96
    ds_read_b64_tr_b16 v[254:255], v19 offset:2144
    v_add_u32 v10, 131072, v13
    s_waitcnt lgkmcnt(0)
    ds_read_b128 v[184:187], v10 offset:0
    ds_read_b128 v[188:191], v10 offset:1024
    ds_read_b128 v[192:195], v10 offset:8192
    ds_read_b128 v[196:199], v10 offset:9216
    ds_read_b128 v[200:203], v10 offset:16384
    ds_read_b128 v[204:207], v10 offset:17408
    ds_read_b128 v[208:211], v10 offset:24576
    ds_read_b128 v[212:215], v10 offset:25600
    s_cmp_ge_u32 s3, 2
    s_cbranch_scc1 L_moe4b
    s_add_u32 m0, s85, 4096
    s_add_u32 s6, s86, 0
    buffer_load_dwordx4 v18, s[16:19], s6 offen lds
    s_add_u32 m0, s85, 5120
    s_add_u32 s6, s86, 10240
    buffer_load_dwordx4 v18, s[16:19], s6 offen lds
    s_add_u32 m0, s85, 6144
    s_add_u32 s6, s86, 20480
    buffer_load_dwordx4 v18, s[16:19], s6 offen lds
    s_add_u32 m0, s85, 7168
    s_add_u32 s6, s86, 30720
    buffer_load_dwordx4 v18, s[16:19], s6 offen lds
    s_add_u32 s86, s86, 512
L_moe4b:
    s_call_b64 s[82:83], L_load
    s_add_i32 s62, s62, 1
    s_waitcnt lgkmcnt(0)
    s_mov_b32 s6, 0xbfb8aa3b
    v_add_f32 v184, v184, v192
    v_add_f32 v200, v200, v208
    v_add_f32 v185, v185, v193
    v_add_f32 v201, v201, v209
    v_cvt_pk_bf16_f32 v185, v184, v185
    v_lshlrev_b32 v184, 16, v185
    v_and_b32 v185, 0xffff0000, v185
    v_cvt_pk_bf16_f32 v201, v200, v201
    v_lshlrev_b32 v200, 16, v201
    v_and_b32 v201, 0xffff0000, v201
    v_mul_f32 v2, s6, v184
    v_mul_f32 v3, s6, v185
    v_exp_f32 v2, v2
    v_exp_f32 v3, v3
    s_nop 0
    v_add_f32 v2, 1.0, v2
    v_add_f32 v3, 1.0, v3
    v_rcp_f32 v2, v2
    v_rcp_f32 v3, v3
    s_nop 0
    v_mul_f32 v184, v184, v2
    v_mul_f32 v185, v185, v3
    v_cvt_pk_bf16_f32 v185, v184, v185
    v_lshlrev_b32 v184, 16, v185
    v_and_b32 v185, 0xffff0000, v185
    v_mul_f32 v184, v184, v200
    v_mul_f32 v185, v185, v201
    v_cvt_pk_bf16_f32 v24, v184, v185
    v_add_f32 v186, v186, v194
    v_add_f32 v202, v202, v210
    v_add_f32 v187, v187, v195
    v_add_f32 v203, v203, v211
    v_cvt_pk_bf16_f32 v187, v186, v187
    v_lshlrev_b32 v186, 16, v187
    v_and_b32 v187, 0xffff0000, v187
    v_cvt_pk_bf16_f32 v203, v202, v203
    v_lshlrev_b32 v202, 16, v203
    v_and_b32 v203, 0xffff0000, v203
    v_mul_f32 v2, s6, v186
    v_mul_f32 v3, s6, v187
    v_exp_f32 v2, v2
    v_exp_f32 v3, v3
    s_nop 0
    v_add_f32 v2, 1.0, v2
    v_add_f32 v3, 1.0, v3
    v_rcp_f32 v2, v2
    v_rcp_f32 v3, v3
    s_nop 0
    v_mul_f32 v186, v186, v2
    v_mul_f32 v187, v187, v3
    v_cvt_pk_bf16_f32 v187, v186, v187
    v_lshlrev_b32 v186, 16, v187
    v_and_b32 v187, 0xffff0000, v187
    v_mul_f32 v186, v186, v202
    v_mul_f32 v187, v187, v203
    v_cvt_pk_bf16_f32 v25, v186, v187
    v_add_f32 v188, v188, v196
    v_add_f32 v204, v204, v212
    v_add_f32 v189, v189, v197
    v_add_f32 v205, v205, v213
    v_cvt_pk_bf16_f32 v189, v188, v189
    v_lshlrev_b32 v188, 16, v189
    v_and_b32 v189, 0xffff0000, v189
    v_cvt_pk_bf16_f32 v205, v204, v205
    v_lshlrev_b32 v204, 16, v205
    v_and_b32 v205, 0xffff0000, v205
    v_mul_f32 v2, s6, v188
    v_mul_f32 v3, s6, v189
    v_exp_f32 v2, v2
    v_exp_f32 v3, v3
    s_nop 0
    v_add_f32 v2, 1.0, v2
    v_add_f32 v3, 1.0, v3
    v_rcp_f32 v2, v2
    v_rcp_f32 v3, v3
    s_nop 0
    v_mul_f32 v188, v188, v2
    v_mul_f32 v189, v189, v3
    v_cvt_pk_bf16_f32 v189, v188, v189
    v_lshlrev_b32 v188, 16, v189
    v_and_b32 v189, 0xffff0000, v189
    v_mul_f32 v188, v188, v204
    v_mul_f32 v189, v189, v205
    v_cvt_pk_bf16_f32 v26, v188, v189
    v_add_f32 v190, v190, v198
    v_add_f32 v206, v206, v214
    v_add_f32 v191, v191, v199
    v_add_f32 v207, v207, v215
    v_cvt_pk_bf16_f32 v191, v190, v191
    v_lshlrev_b32 v190, 16, v191
    v_and_b32 v191, 0xffff0000, v191
    v_cvt_pk_bf16_f32 v207, v206, v207
    v_lshlrev_b32 v206, 16, v207
    v_and_b32 v207, 0xffff0000, v207
    v_mul_f32 v2, s6, v190
    v_mul_f32 v3, s6, v191
    v_exp_f32 v2, v2
    v_exp_f32 v3, v3
    s_nop 0
    v_add_f32 v2, 1.0, v2
    v_add_f32 v3, 1.0, v3
    v_rcp_f32 v2, v2
    v_rcp_f32 v3, v3
    s_nop 0
    v_mul_f32 v190, v190, v2
    v_mul_f32 v191, v191, v3
    v_cvt_pk_bf16_f32 v191, v190, v191
    v_lshlrev_b32 v190, 16, v191
    v_and_b32 v191, 0xffff0000, v191
    v_mul_f32 v190, v190, v206
    v_mul_f32 v191, v191, v207
    v_cvt_pk_bf16_f32 v27, v190, v191
    s_nop 1
    v_mfma_f32_16x16x32_bf16 v[216:219], v[32:35], v[24:27], 0
    v_mfma_f32_16x16x32_bf16 v[220:223], v[36:39], v[24:27], 0
    v_mfma_f32_16x16x32_bf16 v[224:227], v[40:43], v[24:27], 0
    v_mfma_f32_16x16x32_bf16 v[228:231], v[44:47], v[24:27], 0
    s_nop 7
    buffer_store_dwordx4 v[216:219], v20, s[8:11], s87 offen offset:0 sc1
    buffer_store_dwordx4 v[220:223], v20, s[8:11], s87 offen offset:64 sc1
    buffer_store_dwordx4 v[224:227], v20, s[8:11], s87 offen offset:128 sc1
    buffer_store_dwordx4 v[228:231], v20, s[8:11], s87 offen offset:192 sc1
    s_nop 1
    s_waitcnt vmcnt(4) lgkmcnt(0)
    s_call_b64 s[82:83], L_pend
    s_barrier
    s_call_b64 s[82:83], L_load
    s_add_i32 s62, s62, 1
    v_mfma_f32_16x16x32_bf16 v[216:219], v[240:243], v[24:27], 0
    v_mfma_f32_16x16x32_bf16 v[220:223], v[244:247], v[24:27], 0
    v_mfma_f32_16x16x32_bf16 v[224:227], v[248:251], v[24:27], 0
    v_mfma_f32_16x16x32_bf16 v[228:231], v[252:255], v[24:27], 0
    s_nop 7
    buffer_store_dwordx4 v[216:219], v20, s[8:11], s87 offen offset:1024 sc1
    buffer_store_dwordx4 v[220:223], v20, s[8:11], s87 offen offset:1088 sc1
    buffer_store_dwordx4 v[224:227], v20, s[8:11], s87 offen offset:1152 sc1
    buffer_store_dwordx4 v[228:231], v20, s[8:11], s87 offen offset:1216 sc1
    s_nop 1
    s_cmp_ge_u32 s3, 2
    s_cbranch_scc1 L_moe5b
    ds_read_b64_tr_b16 v[32:33], v19 offset:0
    ds_read_b64_tr_b16 v[34:35], v19 offset:2048
    ds_read_b64_tr_b16 v[36:37], v19 offset:32
    ds_read_b64_tr_b16 v[38:39], v19 offset:2080
    ds_read_b64_tr_b16 v[40:41], v19 offset:64
    ds_read_b64_tr_b16 v[42:43], v19 offset:2112
    ds_read_b64_tr_b16 v[44:45], v19 offset:96
    ds_read_b64_tr_b16 v[46:47], v19 offset:2144
    s_waitcnt lgkmcnt(0)
    v_mfma_f32_16x16x32_bf16 v[216:219], v[32:35], v[24:27], 0
    v_mfma_f32_16x16x32_bf16 v[220:223], v[36:39], v[24:27], 0
    v_mfma_f32_16x16x32_bf16 v[224:227], v[40:43], v[24:27], 0
    v_mfma_f32_16x16x32_bf16 v[228:231], v[44:47], v[24:27], 0
    s_nop 7
    buffer_store_dwordx4 v[216:219], v20, s[8:11], s87 offen offset:2048 sc1
    buffer_store_dwordx4 v[220:223], v20, s[8:11], s87 offen offset:2112 sc1
    buffer_store_dwordx4 v[224:227], v20, s[8:11], s87 offen offset:2176 sc1
    buffer_store_dwordx4 v[228:231], v20, s[8:11], s87 offen offset:2240 sc1
    s_nop 1
L_moe5b:
    s_waitcnt vmcnt(4) lgkmcnt(0)
    s_call_b64 s[82:83], L_pend
    s_barrier
    s_waitcnt vmcnt(0)
    s_lshl_b32 s6, s61, 5
    s_add_u32 s6, s6, s3
    s_lshl_b32 s6, s6, 2
    s_add_u32 s6, s6, 15859712
    v_mov_b32 v2, 1
    v_mov_b32 v3, 0x5000000
    v_writelane_b32 v3, s6, 0
    buffer_store_dword v2, v3, s[8:11], 0 offen sc1
    s_call_b64 s[82:83], L_load
    s_add_i32 s62, s62, 1
    s_branch L_idle
L_top:
    s_mov_b32 s6, 0x280000
    v_lshrrev_b32 v2, 1, v1
    v_and_b32 v3, 1, v1
    v_lshlrev_b32 v3, 4, v3
    v_lshl_add_u32 v2, v2, 7, v3
    buffer_load_dwordx4 v[64:67], v2, s[8:11], s6 offen sc1
    s_add_u32 s6, s6, 4096
    buffer_load_dwordx4 v[68:71], v2, s[8:11], s6 offen sc1
    s_add_u32 s6, s6, 4096
    buffer_load_dwordx4 v[72:75], v2, s[8:11], s6 offen sc1
    s_add_u32 s6, s6, 4096
    buffer_load_dwordx4 v[76:79], v2, s[8:11], s6 offen sc1
    s_add_u32 s6, s6, 4096
    buffer_load_dwordx4 v[80:83], v2, s[8:11], s6 offen sc1
    s_add_u32 s6, s6, 4096
    buffer_load_dwordx4 v[84:87], v2, s[8:11], s6 offen sc1
    s_add_u32 s6, s6, 4096
    buffer_load_dwordx4 v[88:91], v2, s[8:11], s6 offen sc1
    s_add_u32 s6, s6, 4096
    buffer_load_dwordx4 v[92:95], v2, s[8:11], s6 offen sc1
    s_add_u32 s6, s6, 4096
    s_waitcnt vmcnt(0)
    v_mov_b32 v24, 0
    s_mov_b32 s7, 0
    s_mov_b32 s84, 0
L_top_l:
    v_max3_u32 v4, v64, v65, v66
    v_max3_u32 v5, v67, v68, v69
    v_max3_u32 v4, v4, v70, v71
    v_max3_u32 v5, v5, v72, v73
    v_max3_u32 v4, v4, v74, v75
    v_max3_u32 v5, v5, v76, v77
    v_max3_u32 v4, v4, v78, v79
    v_max3_u32 v5, v5, v80, v81
    v_max3_u32 v4, v4, v82, v83
    v_max3_u32 v5, v5, v84, v85
    v_max3_u32 v4, v4, v86, v87
    v_max3_u32 v5, v5, v88, v89
    v_max3_u32 v4, v4, v90, v91
    v_max3_u32 v5, v5, v92, v93
    v_max3_u32 v4, v4, v94, v95
    v_max_u32 v4, v4, v5
    s_nop 1
    v_max_u32_dpp v4, v4, v4 quad_perm:[1,0,3,2] row_mask:0xf bank_mask:0xf
    s_nop 1
    v_max_u32_dpp v4, v4, v4 quad_perm:[2,3,0,1] row_mask:0xf bank_mask:0xf
    s_nop 1
    v_max_u32_dpp v4, v4, v4 row_half_mirror row_mask:0xf bank_mask:0xf
    s_nop 1
    v_max_u32_dpp v4, v4, v4 row_mirror row_mask:0xf bank_mask:0xf
    s_nop 1
    v_max_u32_dpp v4, v4, v4 row_bcast:15 row_mask:0xa bank_mask:0xf
    s_nop 1
    v_max_u32_dpp v4, v4, v4 row_bcast:31 row_mask:0xc bank_mask:0xf
    s_nop 1
    v_readlane_b32 s6, v4, 63
    s_mov_b32 m0, s7
    s_nop 3
    s_add_u32 s84, s84, s6
    v_writelane_b32 v24, s84, m0
    v_subrev_u32 v64, s6, v64
    v_subrev_u32 v65, s6, v65
    v_subrev_u32 v66, s6, v66
    v_subrev_u32 v67, s6, v67
    v_subrev_u32 v68, s6, v68
    v_subrev_u32 v69, s6, v69
    v_subrev_u32 v70, s6, v70
    v_subrev_u32 v71, s6, v71
    v_subrev_u32 v72, s6, v72
    v_subrev_u32 v73, s6, v73
    v_subrev_u32 v74, s6, v74
    v_subrev_u32 v75, s6, v75
    v_subrev_u32 v76, s6, v76
    v_subrev_u32 v77, s6, v77
    v_subrev_u32 v78, s6, v78
    v_subrev_u32 v79, s6, v79
    v_subrev_u32 v80, s6, v80
    v_subrev_u32 v81, s6, v81
    v_subrev_u32 v82, s6, v82
    v_subrev_u32 v83, s6, v83
    v_subrev_u32 v84, s6, v84
    v_subrev_u32 v85, s6, v85
    v_subrev_u32 v86, s6, v86
    v_subrev_u32 v87, s6, v87
    v_subrev_u32 v88, s6, v88
    v_subrev_u32 v89, s6, v89
    v_subrev_u32 v90, s6, v90
    v_subrev_u32 v91, s6, v91
    v_subrev_u32 v92, s6, v92
    v_subrev_u32 v93, s6, v93
    v_subrev_u32 v94, s6, v94
    v_subrev_u32 v95, s6, v95
    s_add_u32 s7, s7, 1
    s_cmp_lt_u32 s7, 8
    s_cbranch_scc1 L_top_l
    v_and_b32 v2, 7, v1
    v_lshlrev_b32 v2, 2, v2
    ds_bpermute_b32 v4, v2, v24
    s_waitcnt lgkmcnt(0)
    v_and_b32 v4, 0x7ff, v4
    v_sub_u32 v4, 0x7ff, v4
    v_lshrrev_b32 v5, 4, v4
    v_mul_u32_u24 v5, 20480, v5
    v_and_b32 v4, 15, v4
    v_lshl_add_u32 v5, v4, 4, v5
    v_lshrrev_b32 v7, 4, v1
    v_lshl_add_u32 v5, v7, 8, v5
    v_mov_b32 v6, 0x5000000
    v_and_b32 v2, 8, v1
    v_cmp_eq_u32 vcc, 0, v2
    s_mov_b32 s6, 0
    s_nop 0
    v_cndmask_b32 v5, v6, v5, vcc
    buffer_load_dwordx4 v[64:67], v5, s[8:11], s6 offen offset:0 sc1
    buffer_load_dwordx4 v[68:71], v5, s[8:11], s6 offen offset:1024 sc1
    buffer_load_dwordx4 v[72:75], v5, s[8:11], s6 offen offset:2048 sc1
    buffer_load_dwordx4 v[76:79], v5, s[8:11], s6 offen offset:3072 sc1
    s_add_u32 s6, s6, 4096
    buffer_load_dwordx4 v[80:83], v5, s[8:11], s6 offen offset:0 sc1
    buffer_load_dwordx4 v[84:87], v5, s[8:11], s6 offen offset:1024 sc1
    buffer_load_dwordx4 v[88:91], v5, s[8:11], s6 offen offset:2048 sc1
    buffer_load_dwordx4 v[92:95], v5, s[8:11], s6 offen offset:3072 sc1
    s_add_u32 s6, s6, 4096
    buffer_load_dwordx4 v[96:99], v5, s[8:11], s6 offen offset:0 sc1
    buffer_load_dwordx4 v[100:103], v5, s[8:11], s6 offen offset:1024 sc1
    buffer_load_dwordx4 v[104:107], v5, s[8:11], s6 offen offset:2048 sc1
    buffer_load_dwordx4 v[108:111], v5, s[8:11], s6 offen offset:3072 sc1
    s_add_u32 s6, s6, 4096
    buffer_load_dwordx4 v[112:115], v5, s[8:11], s6 offen offset:0 sc1
    buffer_load_dwordx4 v[116:119], v5, s[8:11], s6 offen offset:1024 sc1
    buffer_load_dwordx4 v[120:123], v5, s[8:11], s6 offen offset:2048 sc1
    buffer_load_dwordx4 v[124:127], v5, s[8:11], s6 offen offset:3072 sc1
    s_add_u32 s6, s6, 4096
    buffer_load_dwordx4 v[128:131], v5, s[8:11], s6 offen offset:0 sc1
    buffer_load_dwordx4 v[132:135], v5, s[8:11], s6 offen offset:1024 sc1
    buffer_load_dwordx4 v[136:139], v5, s[8:11], s6 offen offset:2048 sc1
    buffer_load_dwordx4 v[140:143], v5, s[8:11], s6 offen offset:3072 sc1
    s_waitcnt vmcnt(20)
    s_call_b64 s[82:83], L_pend
    s_barrier
    s_waitcnt vmcnt(0)
    s_mov_b32 s6, 0xc00000
    buffer_store_dwordx4 v[64:67], v13, s[8:11], s6 offen offset:0 sc1
    buffer_store_dwordx4 v[68:71], v13, s[8:11], s6 offen offset:1024 sc1
    buffer_store_dwordx4 v[72:75], v13, s[8:11], s6 offen offset:2048 sc1
    buffer_store_dwordx4 v[76:79], v13, s[8:11], s6 offen offset:3072 sc1
    s_add_u32 s6, s6, 4096
    buffer_store_dwordx4 v[80:83], v13, s[8:11], s6 offen offset:0 sc1
    buffer_store_dwordx4 v[84:87], v13, s[8:11], s6 offen offset:1024 sc1
    buffer_store_dwordx4 v[88:91], v13, s[8:11], s6 offen offset:2048 sc1
    buffer_store_dwordx4 v[92:95], v13, s[8:11], s6 offen offset:3072 sc1
    s_add_u32 s6, s6, 4096
    buffer_store_dwordx4 v[96:99], v13, s[8:11], s6 offen offset:0 sc1
    buffer_store_dwordx4 v[100:103], v13, s[8:11], s6 offen offset:1024 sc1
    buffer_store_dwordx4 v[104:107], v13, s[8:11], s6 offen offset:2048 sc1
    buffer_store_dwordx4 v[108:111], v13, s[8:11], s6 offen offset:3072 sc1
    s_add_u32 s6, s6, 4096
    buffer_store_dwordx4 v[112:115], v13, s[8:11], s6 offen offset:0 sc1
    buffer_store_dwordx4 v[116:119], v13, s[8:11], s6 offen offset:1024 sc1
    buffer_store_dwordx4 v[120:123], v13, s[8:11], s6 offen offset:2048 sc1
    buffer_store_dwordx4 v[124:127], v13, s[8:11], s6 offen offset:3072 sc1
    s_add_u32 s6, s6, 4096
    buffer_store_dwordx4 v[128:131], v13, s[8:11], s6 offen offset:0 sc1
    buffer_store_dwordx4 v[132:135], v13, s[8:11], s6 offen offset:1024 sc1
    buffer_store_dwordx4 v[136:139], v13, s[8:11], s6 offen offset:2048 sc1
    buffer_store_dwordx4 v[140:143], v13, s[8:11], s6 offen offset:3072 sc1
    s_call_b64 s[82:83], L_load
    s_add_i32 s62, s62, 1
    s_waitcnt vmcnt(16)
    v_or_b32 v24, 0x80000000, v24
    v_lshlrev_b32 v5, 2, v1
    v_mov_b32 v6, 0x5000000
    v_cmp_gt_u32 vcc, 8, v1
    s_mov_b32 s6, 0x3a0000
    s_nop 0
    v_cndmask_b32 v5, v6, v5, vcc
    buffer_store_dword v24, v5, s[8:11], s6 offen sc1
    s_branch L_idle
L_back_9_h:
    v_cmp_ne_u32 vcc, 0, v62
    s_cbranch_vccz L_back_9_n
    s_call_b64 s[80:81], L_rare0
L_back_9_n:
    s_branch L_back_9
L_back_10_h:
    v_cmp_ne_u32 vcc, 0, v62
    s_cbranch_vccz L_back_10_n
    s_call_b64 s[80:81], L_rare1
    v_exp_f32 v58, v64
    v_exp_f32 v59, v65
L_back_10_n:
    s_cmp_lt_i32 s64, 0
    s_cbranch_scc1 L_tail1
    s_cmp_gt_i32 s64, 0
    s_cbranch_scc1 L_back_10
    s_call_b64 s[82:83], L_mask
    s_branch L_back_10
L_back_11_h:
    v_cmp_ne_u32 vcc, 0, v62
    s_cbranch_vccz L_back_11_n
    s_call_b64 s[80:81], L_rare0
    v_exp_f32 v58, v80
    v_exp_f32 v59, v81
L_back_11_n:
    s_cmp_lt_i32 s64, 0
    s_cbranch_scc1 L_tail2
    s_cmp_gt_i32 s64, 0
    s_cbranch_scc1 L_back_11
    s_call_b64 s[82:83], L_mask
    s_branch L_back_11
L_back_12_h:
    v_cmp_ne_u32 vcc, 0, v62
    s_cbranch_vccz L_back_12_n
    s_call_b64 s[80:81], L_rare1
    v_exp_f32 v58, v64
    v_exp_f32 v59, v65
L_back_12_n:
    s_cmp_lt_i32 s64, 0
    s_cbranch_scc1 L_tail3
    s_cmp_gt_i32 s64, 0
    s_cbranch_scc1 L_back_12
    s_call_b64 s[82:83], L_mask
    s_branch L_back_12
L_ldback_13_c:
    s_waitcnt vmcnt(0) lgkmcnt(0)
    s_call_b64 s[82:83], L_pend
    s_barrier
    s_call_b64 s[82:83], L_load
    s_branch L_ldback_13
L_back_14_h:
    v_cmp_ne_u32 vcc, 0, v62
    s_cbranch_vccz L_back_14_n
    s_call_b64 s[80:81], L_rare0
    v_exp_f32 v58, v80
    v_exp_f32 v59, v81
L_back_14_n:
    s_cmp_lt_i32 s64, 0
    s_cbranch_scc1 L_tail0
    s_cmp_gt_i32 s64, 0
    s_cbranch_scc1 L_st0
    s_call_b64 s[82:83], L_mask
    s_branch L_st0
L_back_15_h:
    v_cmp_ne_u32 vcc, 0, v62
    s_cbranch_vccz L_back_15_n
    s_call_b64 s[80:81], L_rare1
L_back_15_n:
    s_branch L_back_15
L_back_16_h:
    v_cmp_ne_u32 vcc, 0, v62
    s_cbranch_vccz L_back_16_n
    s_call_b64 s[80:81], L_rare0
L_back_16_n:
    s_branch L_back_16
L_back_18_h:
    v_cmp_ne_u32 vcc, 0, v62
    s_cbranch_vccz L_back_18_n
    s_call_b64 s[80:81], L_rare1
L_back_18_n:
    s_branch L_back_18
L_back_21_h:
    v_cmp_ne_u32 vcc, 0, v62
    s_cbranch_vccz L_back_21_n
    s_call_b64 s[80:81], L_rare0
L_back_21_n:
    s_branch L_back_21
L_load:
    s_bitcmp1_b32 s89, 0
    s_cbranch_scc0 L_load_r
    s_add_u32 s77, s77, 32768
    s_xor_b32 s78, s78, 0x10000
    s_add_i32 s73, s62, 1
    s_cmp_gt_i32 s73, s63
    s_cbranch_scc1 L_load_r
    s_cmp_eq_i32 s73, s63
    s_cbranch_scc1 L_load_v
    s_cmp_lg_i32 s73, 3
    s_cbranch_scc1 L_load_k
    v_cmp_gt_u32 vcc, 2, v12
    s_cbranch_vccz L_load_k
    s_lshl_b32 s7, s4, 10
    s_add_u32 s7, s7, 3866624
    v_lshrrev_b32 v2, 3, v1
    v_and_b32 v3, 7, v1
    v_lshlrev_b32 v3, 2, v3
    v_lshl_add_u32 v3, v2, 7, v3
    s_mov_b32 s79, 262144
L_poll_46:
    buffer_load_dword v2, v3, s[8:11], s7 offen sc1
    s_waitcnt vmcnt(0)
    v_cmp_gt_u32 vcc, 2, v2
    s_cbranch_vccz L_polldone_47
    s_sleep 2
    s_sub_u32 s79, s79, 1
    s_cmp_lg_u32 s79, 0
    s_cbranch_scc1 L_poll_46
L_polldone_47:
L_load_k:
    s_lshl_b32 s6, s76, 13
    s_add_u32 s6, s6, s78
    s_add_u32 m0, s6, 0
    s_add_u32 s7, s77, 0
    buffer_load_dwordx4 v49, s[8:11], s7 offen offset:0 sc1 lds
    buffer_load_dwordx4 v49, s[8:11], s7 offen offset:1024 sc1 lds
    buffer_load_dwordx4 v49, s[8:11], s7 offen offset:2048 sc1 lds
    buffer_load_dwordx4 v49, s[8:11], s7 offen offset:3072 sc1 lds
    s_lshl_b32 s6, s76, 13
    s_add_u32 s6, s6, s78
    s_add_u32 m0, s6, 4096
    s_add_u32 s7, s77, 4096
    buffer_load_dwordx4 v49, s[8:11], s7 offen offset:0 sc1 lds
    buffer_load_dwordx4 v49, s[8:11], s7 offen offset:1024 sc1 lds
    buffer_load_dwordx4 v49, s[8:11], s7 offen offset:2048 sc1 lds
    buffer_load_dwordx4 v49, s[8:11], s7 offen offset:3072 sc1 lds
    s_lshl_b32 s6, s76, 12
    s_add_u32 s6, s6, s78
    s_add_u32 m0, s6, 49152
    s_add_u32 s7, s77, 524288
    buffer_load_dwordx4 v50, s[8:11], s7 offen offset:0 sc1 lds
    buffer_load_dwordx4 v50, s[8:11], s7 offen offset:1024 sc1 lds
    buffer_load_dwordx4 v50, s[8:11], s7 offen offset:2048 sc1 lds
    buffer_load_dwordx4 v50, s[8:11], s7 offen offset:3072 sc1 lds
L_load_v:
    s_lshl_b32 s6, s76, 12
    s_add_u32 s6, s6, s78
    s_add_u32 m0, s6, 32768
    s_add_u32 s7, s77, 507904
    buffer_load_dwordx4 v50, s[8:11], s7 offen offset:0 sc1 lds
    buffer_load_dwordx4 v50, s[8:11], s7 offen offset:1024 sc1 lds
    buffer_load_dwordx4 v50, s[8:11], s7 offen offset:2048 sc1 lds
    buffer_load_dwordx4 v50, s[8:11], s7 offen offset:3072 sc1 lds
    s_cmp_eq_i32 s73, s63
    s_cbranch_scc1 L_xa
    s_cmp_lg_i32 s73, 2
    s_cbranch_scc1 L_nolook
    s_lshl_b32 s7, s4, 10
    s_add_u32 s7, s7, 3866624
    v_lshrrev_b32 v2, 3, v1
    v_and_b32 v3, 7, v1
    v_lshlrev_b32 v3, 2, v3
    v_lshl_add_u32 v3, v2, 7, v3
    buffer_load_dword v12, v3, s[8:11], s7 offen sc1
L_nolook:
    s_bitcmp1_b32 240, s5
    s_cbranch_scc0 L_wb
    s_sub_i32 s6, s62, 0
    s_cmp_gt_u32 s6, 4
    s_cbranch_scc0 L_wsel
L_wb:
    s_cmp_lt_u32 s5, 4
    s_cbranch_scc1 L_load_r
    s_sub_i32 s79, s73, 1
    s_cmp_lt_u32 s79, 2
    s_cbranch_scc1 L_x3
L_load_r:
    s_setpc_b64 s[82:83]
L_pend:
    s_bitcmp1_b32 s89, 1
    s_cbranch_scc0 L_load_a
    s_cmp_lt_i32 s62, 0
    s_cbranch_scc1 L_load_a
    s_lshl_b32 s6, s4, 3
    s_add_u32 s6, s6, s5
    s_lshl_b32 s6, s6, 5
    s_add_u32 s6, s6, s3
    s_lshl_b32 s6, s6, 2
    s_add_u32 s6, s6, 3866624
    v_mov_b32 v2, 2
    v_mov_b32 v3, 0x5000000
    v_writelane_b32 v3, s6, 0
    buffer_store_dword v2, v3, s[8:11], 0 offen sc1
    s_and_b32 s89, s89, 1
L_load_a:
    s_setpc_b64 s[82:83]
L_wsel:
    s_bfm_b32 s7, s5, 0
    s_and_b32 s7, s7, 240
    s_bcnt1_i32_b32 s7, s7
    s_lshl_b32 s7, s7, 5
    s_and_b32 s91, s2, 31
    s_add_u32 s91, s91, s7
    s_lshl_b32 s91, s91, 1
    s_lshr_b32 s7, s6, 1
    s_add_u32 s91, s91, s7
    s_cmp_eq_u32 s6, 4
    s_cbranch_scc1 L_w2
    s_bitcmp1_b32 s6, 0
    s_cbranch_scc1 L_w1
L_w0:
    s_mov_b32 s28, s42
    s_mov_b32 s29, s43
    s_mov_b32 s30, 0x500000
    s_mov_b32 s31, 0x20000
    s_lshr_b32 s75, s91, 1
    s_mul_i32 s75, s75, 40960
    s_and_b32 s6, s91, 1
    s_mul_i32 s6, s6, 640
    s_add_u32 s75, s75, s6
    s_movk_i32 s7, 1639
    s_mul_i32 s74, s76, 5120
    s_add_u32 s74, s74, 141312
    s_mul_i32 s6, s76, 320
    v_add_u32 v9, s6, v1
    v_add_u32 v2, 0, v9
    v_mul_lo_u32 v3, v2, s7
    v_lshrrev_b32 v3, 16, v3
    v_mul_u32_u24 v4, 40, v3
    v_sub_u32 v4, v2, v4
    v_mul_u32_u24 v3, 1280, v3
    v_lshl_add_u32 v3, v4, 4, v3
    s_add_u32 m0, s74, 0
    s_nop 0
    buffer_load_dwordx4 v3, s[28:31], s75 offen nt lds
    v_add_u32 v2, 64, v9
    v_mul_lo_u32 v3, v2, s7
    v_lshrrev_b32 v3, 16, v3
    v_mul_u32_u24 v4, 40, v3
    v_sub_u32 v4, v2, v4
    v_mul_u32_u24 v3, 1280, v3
    v_lshl_add_u32 v3, v4, 4, v3
    s_add_u32 m0, s74, 1024
    s_nop 0
    buffer_load_dwordx4 v3, s[28:31], s75 offen nt lds
    v_add_u32 v2, 128, v9
    v_mul_lo_u32 v3, v2, s7
    v_lshrrev_b32 v3, 16, v3
    v_mul_u32_u24 v4, 40, v3
    v_sub_u32 v4, v2, v4
    v_mul_u32_u24 v3, 1280, v3
    v_lshl_add_u32 v3, v4, 4, v3
    s_add_u32 m0, s74, 2048
    s_nop 0
    buffer_load_dwordx4 v3, s[28:31], s75 offen nt lds
    v_add_u32 v2, 192, v9
    v_mul_lo_u32 v3, v2, s7
    v_lshrrev_b32 v3, 16, v3
    v_mul_u32_u24 v4, 40, v3
    v_sub_u32 v4, v2, v4
    v_mul_u32_u24 v3, 1280, v3
    v_lshl_add_u32 v3, v4, 4, v3
    s_add_u32 m0, s74, 3072
    s_nop 0
    buffer_load_dwordx4 v3, s[28:31], s75 offen nt lds
    v_add_u32 v2, 256, v9
    v_mul_lo_u32 v3, v2, s7
    v_lshrrev_b32 v3, 16, v3
    v_mul_u32_u24 v4, 40, v3
    v_sub_u32 v4, v2, v4
    v_mul_u32_u24 v3, 1280, v3
    v_lshl_add_u32 v3, v4, 4, v3
    s_add_u32 m0, s74, 4096
    s_nop 0
    buffer_load_dwordx4 v3, s[28:31], s75 offen nt lds
    s_branch L_wb
L_w1:
    v_and_b32 v2, 15, v1
    v_lshrrev_b32 v3, 4, v1
    v_lshrrev_b32 v4, 2, v2
    v_lshl_add_u32 v4, v3, 2, v4
    v_mul_u32_u24 v4, 640, v4
    v_and_b32 v2, 3, v2
    v_lshl_add_u32 v4, v2, 3, v4
    s_mul_i32 s6, s76, 160
    s_add_u32 s6, s6, 141312
    v_add_u32 v4, s6, v4
    s_mul_i32 s6, s91, 20480
    s_mul_i32 s7, s76, 5120
    s_add_u32 s6, s6, s7
    s_add_u32 s6, s6, 4194304
    s_add_u32 s7, s6, 4096
    ds_read_b64_tr_b16 v[172:173], v4 offset:0
    ds_read_b64_tr_b16 v[174:175], v4 offset:10240
    ds_read_b64_tr_b16 v[176:177], v4 offset:32
    ds_read_b64_tr_b16 v[178:179], v4 offset:10272
    ds_read_b64_tr_b16 v[180:181], v4 offset:64
    ds_read_b64_tr_b16 v[182:183], v4 offset:10304
    ds_read_b64_tr_b16 v[184:185], v4 offset:96
    ds_read_b64_tr_b16 v[186:187], v4 offset:10336
    ds_read_b64_tr_b16 v[188:189], v4 offset:128
    ds_read_b64_tr_b16 v[190:191], v4 offset:10368
    s_waitcnt lgkmcnt(0)
    buffer_store_dwordx4 v[172:175], v13, s[8:11], s6 offen offset:0 sc1
    buffer_store_dwordx4 v[176:179], v13, s[8:11], s6 offen offset:1024 sc1
    buffer_store_dwordx4 v[180:183], v13, s[8:11], s6 offen offset:2048 sc1
    buffer_store_dwordx4 v[184:187], v13, s[8:11], s6 offen offset:3072 sc1
    buffer_store_dwordx4 v[188:191], v13, s[8:11], s7 offen offset:0 sc1
    s_branch L_wb
L_w2:
    s_cmp_lg_u32 s3, 0
    s_cbranch_scc1 L_wb
    s_mov_b32 s28, s56
    s_mov_b32 s29, s57
    s_mov_b32 s30, 0x100
    s_mov_b32 s31, 0x20000
    v_mov_b32 v2, 1
    v_lshlrev_b32 v3, 8, v1
    s_and_b32 s6, s2, 31
    s_lshl_b32 s6, s6, 2
    buffer_atomic_add v2, v3, s[28:31], s6 offen offset:128 sc1
    s_branch L_wb
L_xa:
    s_cmp_lg_u32 s90, 0
    s_cbranch_scc1 L_xa1
    s_mov_b32 s28, s56
    s_mov_b32 s29, s57
    s_mov_b32 s30, 0x100
    s_mov_b32 s31, 0x20000
    v_and_b32 v3, 31, v1
    v_lshlrev_b32 v3, 2, v3
    s_mov_b32 s79, 262144
L_poll_48:
    buffer_load_dword v2, v3, s[28:31], 0 offen offset:128 sc1
    s_waitcnt vmcnt(0)
    v_cmp_gt_u32 vcc, 4, v2
    s_cbranch_vccz L_polldone_49
    s_sleep 8
    s_sub_u32 s79, s79, 1
    s_cmp_lg_u32 s79, 0
    s_cbranch_scc1 L_poll_48
L_polldone_49:
L_xa1:
    s_lshr_b32 s74, s4, 3
    s_lshl_b32 s74, s74, 2
    s_add_u32 s74, s74, s76
    s_mul_i32 s74, s74, 327680
    s_and_b32 s7, s4, 3
    s_mul_i32 s7, s7, 10240
    s_add_u32 s74, s74, s7
    s_add_u32 s74, s74, 4199424
    s_add_u32 s6, s76, 0
    s_and_b32 s6, s6, 3
    s_lshl_b32 s6, s6, 10
    s_add_u32 s84, s6, s74
    s_add_u32 s6, s76, 1
    s_and_b32 s6, s6, 3
    s_lshl_b32 s6, s6, 10
    s_add_u32 s85, s6, s74
    s_add_u32 s6, s76, 2
    s_and_b32 s6, s6, 3
    s_lshl_b32 s6, s6, 10
    s_add_u32 s86, s6, s74
    s_add_u32 s6, s76, 3
    s_and_b32 s6, s6, 3
    s_lshl_b32 s6, s6, 10
    s_add_u32 s87, s6, s74
    s_add_u32 s88, s74, 4096
    s_lshl_b32 s73, s3, 13
    s_add_u32 s75, s73, s78
    s_add_u32 m0, s73, 131072
    s_add_u32 s7, s84, 0
    buffer_load_dwordx4 v13, s[8:11], s7 offen sc1 lds
    s_add_u32 m0, s73, 132096
    s_add_u32 s7, s85, 0
    buffer_load_dwordx4 v13, s[8:11], s7 offen sc1 lds
    s_add_u32 m0, s73, 133120
    s_add_u32 s7, s86, 0
    buffer_load_dwordx4 v13, s[8:11], s7 offen sc1 lds
    s_add_u32 m0, s73, 134144
    s_add_u32 s7, s87, 0
    buffer_load_dwordx4 v13, s[8:11], s7 offen sc1 lds
    s_add_u32 m0, s73, 135168
    s_add_u32 s7, s88, 0
    buffer_load_dwordx4 v13, s[8:11], s7 offen sc1 lds
    s_add_u32 m0, s73, 136192
    s_add_u32 s7, s84, 40960
    buffer_load_dwordx4 v13, s[8:11], s7 offen sc1 lds
    s_add_u32 m0, s73, 137216
    s_add_u32 s7, s85, 40960
    buffer_load_dwordx4 v13, s[8:11], s7 offen sc1 lds
    s_add_u32 m0, s73, 138240
    s_add_u32 s7, s86, 40960
    buffer_load_dwordx4 v13, s[8:11], s7 offen sc1 lds
    s_add_u32 m0, s75, 0
    s_add_u32 s7, s87, 40960
    buffer_load_dwordx4 v13, s[8:11], s7 offen sc1 lds
    s_add_u32 m0, s75, 1024
    s_add_u32 s7, s88, 40960
    buffer_load_dwordx4 v13, s[8:11], s7 offen sc1 lds
    s_add_u32 m0, s75, 2048
    s_add_u32 s7, s84, 81920
    buffer_load_dwordx4 v13, s[8:11], s7 offen sc1 lds
    s_add_u32 m0, s75, 3072
    s_add_u32 s7, s85, 81920
    buffer_load_dwordx4 v13, s[8:11], s7 offen sc1 lds
    s_add_u32 m0, s75, 4096
    s_add_u32 s7, s86, 81920
    buffer_load_dwordx4 v13, s[8:11], s7 offen sc1 lds
    s_add_u32 m0, s75, 5120
    s_add_u32 s7, s87, 81920
    buffer_load_dwordx4 v13, s[8:11], s7 offen sc1 lds
    s_add_u32 m0, s75, 6144
    s_add_u32 s7, s88, 81920
    buffer_load_dwordx4 v13, s[8:11], s7 offen sc1 lds
    s_add_u32 m0, s75, 7168
    s_add_u32 s7, s84, 122880
    buffer_load_dwordx4 v13, s[8:11], s7 offen sc1 lds
    s_lshl_b32 s75, s3, 12
    s_add_u32 s75, s75, s78
    s_add_u32 m0, s75, 49152
    s_add_u32 s7, s85, 122880
    buffer_load_dwordx4 v13, s[8:11], s7 offen sc1 lds
    s_add_u32 m0, s75, 50176
    s_add_u32 s7, s86, 122880
    buffer_load_dwordx4 v13, s[8:11], s7 offen sc1 lds
    s_add_u32 m0, s75, 51200
    s_add_u32 s7, s87, 122880
    buffer_load_dwordx4 v13, s[8:11], s7 offen sc1 lds
    s_add_u32 m0, s75, 52224
    s_add_u32 s7, s88, 122880
    buffer_load_dwordx4 v13, s[8:11], s7 offen sc1 lds
    s_setpc_b64 s[82:83]
L_x3:
    s_mov_b32 s12, s48
    s_mov_b32 s13, s49
    s_mov_b32 s14, 0x21c000
    s_mov_b32 s15, 0x20000
    s_cmp_eq_u32 s3, 3
    s_cbranch_scc1 L_load_r
    s_cmp_eq_u32 s3, 1
    s_cselect_b32 s12, s50, s12
    s_cselect_b32 s13, s51, s13
    s_cmp_eq_u32 s3, 2
    s_cselect_b32 s12, s52, s12
    s_cselect_b32 s13, s53, s13
    s_mov_b32 s73, 3456
    s_cmov_b32 s73, 256
    s_mov_b32 s75, 256
    s_cmov_b32 s75, 163840
    s_lshr_b32 s6, s2, 3
    s_sub_u32 s6, s6, 16
    s_mul_i32 s6, s6, 40
    v_lshrrev_b32 v2, 2, v1
    v_add_u32 v2, s6, v2
    v_mul_lo_u32 v2, v2, s73
    v_and_b32 v3, 3, v1
    v_lshl_add_u32 v2, v3, 6, v2
    s_xor_b32 s79, s79, 1
    s_lshl_b32 s6, s79, 3
    s_lshr_b32 s7, s4, 2
    s_add_u32 s6, s6, s7
    s_mul_i32 s6, s6, s75
    v_mov_b32 v3, 0x5000000
    v_cmp_gt_u32 vcc, 32, v1
    s_lshl_b32 s73, s73, 4
    s_nop 0
    v_cndmask_b32 v3, v3, v2, vcc
    buffer_load_dword v11, v2, s[12:15], s6 offen
    s_add_u32 s7, s6, s73
    buffer_load_dword v11, v2, s[12:15], s7 offen
    s_add_u32 s7, s7, s73
    buffer_load_dword v11, v3, s[12:15], s7 offen
    s_setpc_b64 s[82:83]
L_mask:
    v_and_b32 v2, 15, v1
    v_lshrrev_b32 v3, 4, v1
    v_lshlrev_b32 v3, 2, v3
    v_sub_u32 v2, v2, v3
    v_mov_b32 v3, 0xff800000
    v_cmp_gt_i32 vcc, 0, v2
    v_mov_b32 v152, v3
    s_nop 0
    v_cndmask_b32 v144, v144, v3, vcc
    v_cndmask_b32 v156, v156, v3, vcc
    v_cmp_gt_i32 vcc, 1, v2
    v_mov_b32 v153, v3
    s_nop 0
    v_cndmask_b32 v145, v145, v3, vcc
    v_cndmask_b32 v157, v157, v3, vcc
    v_cmp_gt_i32 vcc, 2, v2
    v_mov_b32 v154, v3
    s_nop 0
    v_cndmask_b32 v146, v146, v3, vcc
    v_cndmask_b32 v158, v158, v3, vcc
    v_cmp_gt_i32 vcc, 3, v2
    v_mov_b32 v155, v3
    s_nop 0
    v_cndmask_b32 v147, v147, v3, vcc
    v_cndmask_b32 v159, v159, v3, vcc
    s_nop 1
    s_setpc_b64 s[82:83]
L_rare0:
    s_nop 15
    v_max_f32 v62, v64, v65
    v_max3_f32 v62, v62, v66, v67
    v_max3_f32 v62, v62, v72, v73
    v_max3_f32 v62, v62, v74, v75
    v_mov_b32 v58, v62
    s_nop 1
    v_permlane16_swap_b32 v62, v58
    s_nop 1
    v_max_f32 v62, v62, v58
    v_mov_b32 v58, v62
    s_nop 1
    v_permlane32_swap_b32 v62, v58
    s_nop 1
    v_max_f32 v62, v62, v58
    v_add_f32 v62, 0x41c00000, v62
    v_max_f32 v62, 0, v62
    v_exp_f32 v58, -v62
    v_sub_f32 v64, v64, v62
    v_sub_f32 v80, v80, v62
    v_sub_f32 v144, v144, v62
    v_sub_f32 v65, v65, v62
    v_sub_f32 v81, v81, v62
    v_sub_f32 v145, v145, v62
    v_sub_f32 v66, v66, v62
    v_sub_f32 v82, v82, v62
    v_sub_f32 v146, v146, v62
    v_sub_f32 v67, v67, v62
    v_sub_f32 v83, v83, v62
    v_sub_f32 v147, v147, v62
    v_sub_f32 v72, v72, v62
    v_sub_f32 v88, v88, v62
    v_sub_f32 v152, v152, v62
    v_sub_f32 v73, v73, v62
    v_sub_f32 v89, v89, v62
    v_sub_f32 v153, v153, v62
    v_sub_f32 v74, v74, v62
    v_sub_f32 v90, v90, v62
    v_sub_f32 v154, v154, v62
    v_sub_f32 v75, v75, v62
    v_sub_f32 v91, v91, v62
    v_sub_f32 v155, v155, v62
    v_mul_f32 v160, v58, v160
    v_mul_f32 v161, v58, v161
    v_mul_f32 v192, v58, v192
    v_mul_f32 v193, v58, v193
    v_mul_f32 v194, v58, v194
    v_mul_f32 v195, v58, v195
    v_mul_f32 v200, v58, v200
    v_mul_f32 v201, v58, v201
    v_mul_f32 v202, v58, v202
    v_mul_f32 v203, v58, v203
    v_mul_f32 v208, v58, v208
    v_mul_f32 v209, v58, v209
    v_mul_f32 v210, v58, v210
    v_mul_f32 v211, v58, v211
    v_mul_f32 v216, v58, v216
    v_mul_f32 v217, v58, v217
    v_mul_f32 v218, v58, v218
    v_mul_f32 v219, v58, v219
    v_mul_f32 v224, v58, v224
    v_mul_f32 v225, v58, v225
    v_mul_f32 v226, v58, v226
    v_mul_f32 v227, v58, v227
    v_mul_f32 v232, v58, v232
    v_mul_f32 v233, v58, v233
    v_mul_f32 v234, v58, v234
    v_mul_f32 v235, v58, v235
    v_mul_f32 v240, v58, v240
    v_mul_f32 v241, v58, v241
    v_mul_f32 v242, v58, v242
    v_mul_f32 v243, v58, v243
    v_mul_f32 v248, v58, v248
    v_mul_f32 v249, v58, v249
    v_mul_f32 v250, v58, v250
    v_mul_f32 v251, v58, v251
    v_max_f32 v62, v68, v69
    v_max3_f32 v62, v62, v70, v71
    v_max3_f32 v62, v62, v76, v77
    v_max3_f32 v62, v62, v78, v79
    v_mov_b32 v58, v62
    s_nop 1
    v_permlane16_swap_b32 v62, v58
    s_nop 1
    v_max_f32 v62, v62, v58
    v_mov_b32 v58, v62
    s_nop 1
    v_permlane32_swap_b32 v62, v58
    s_nop 1
    v_max_f32 v62, v62, v58
    v_add_f32 v62, 0x41c00000, v62
    v_max_f32 v62, 0, v62
    v_exp_f32 v58, -v62
    v_sub_f32 v68, v68, v62
    v_sub_f32 v84, v84, v62
    v_sub_f32 v148, v148, v62
    v_sub_f32 v69, v69, v62
    v_sub_f32 v85, v85, v62
    v_sub_f32 v149, v149, v62
    v_sub_f32 v70, v70, v62
    v_sub_f32 v86, v86, v62
    v_sub_f32 v150, v150, v62
    v_sub_f32 v71, v71, v62
    v_sub_f32 v87, v87, v62
    v_sub_f32 v151, v151, v62
    v_sub_f32 v76, v76, v62
    v_sub_f32 v92, v92, v62
    v_sub_f32 v156, v156, v62
    v_sub_f32 v77, v77, v62
    v_sub_f32 v93, v93, v62
    v_sub_f32 v157, v157, v62
    v_sub_f32 v78, v78, v62
    v_sub_f32 v94, v94, v62
    v_sub_f32 v158, v158, v62
    v_sub_f32 v79, v79, v62
    v_sub_f32 v95, v95, v62
    v_sub_f32 v159, v159, v62
    v_mul_f32 v162, v58, v162
    v_mul_f32 v163, v58, v163
    v_mul_f32 v196, v58, v196
    v_mul_f32 v197, v58, v197
    v_mul_f32 v198, v58, v198
    v_mul_f32 v199, v58, v199
    v_mul_f32 v204, v58, v204
    v_mul_f32 v205, v58, v205
    v_mul_f32 v206, v58, v206
    v_mul_f32 v207, v58, v207
    v_mul_f32 v212, v58, v212
    v_mul_f32 v213, v58, v213
    v_mul_f32 v214, v58, v214
    v_mul_f32 v215, v58, v215
    v_mul_f32 v220, v58, v220
    v_mul_f32 v221, v58, v221
    v_mul_f32 v222, v58, v222
    v_mul_f32 v223, v58, v223
    v_mul_f32 v228, v58, v228
    v_mul_f32 v229, v58, v229
    v_mul_f32 v230, v58, v230
    v_mul_f32 v231, v58, v231
    v_mul_f32 v236, v58, v236
    v_mul_f32 v237, v58, v237
    v_mul_f32 v238, v58, v238
    v_mul_f32 v239, v58, v239
    v_mul_f32 v244, v58, v244
    v_mul_f32 v245, v58, v245
    v_mul_f32 v246, v58, v246
    v_mul_f32 v247, v58, v247
    v_mul_f32 v252, v58, v252
    v_mul_f32 v253, v58, v253
    v_mul_f32 v254, v58, v254
    v_mul_f32 v255, v58, v255
    v_exp_f32 v58, v64
    s_nop 0
    v_exp_f32 v59, v65
    s_nop 0
    v_cvt_pk_bf16_f32 v128, v58, v59
    v_exp_f32 v60, v66
    s_nop 0
    v_exp_f32 v61, v67
    s_nop 0
    v_cvt_pk_bf16_f32 v129, v60, v61
    v_exp_f32 v58, v68
    s_nop 0
    v_exp_f32 v59, v69
    s_nop 0
    v_cvt_pk_bf16_f32 v132, v58, v59
    v_exp_f32 v60, v70
    s_nop 0
    v_exp_f32 v61, v71
    s_nop 0
    v_cvt_pk_bf16_f32 v133, v60, v61
    v_exp_f32 v58, v72
    s_nop 0
    v_exp_f32 v59, v73
    s_nop 0
    v_cvt_pk_bf16_f32 v130, v58, v59
    v_exp_f32 v60, v74
    s_nop 0
    v_exp_f32 v61, v75
    s_nop 0
    v_cvt_pk_bf16_f32 v131, v60, v61
    v_exp_f32 v58, v76
    s_nop 0
    v_exp_f32 v59, v77
    s_nop 0
    v_cvt_pk_bf16_f32 v134, v58, v59
    v_exp_f32 v60, v78
    s_nop 0
    v_exp_f32 v61, v79
    s_nop 0
    v_cvt_pk_bf16_f32 v135, v60, v61
    s_nop 1
    s_setpc_b64 s[80:81]
L_rare1:
    s_nop 15
    v_max_f32 v62, v80, v81
    v_max3_f32 v62, v62, v82, v83
    v_max3_f32 v62, v62, v88, v89
    v_max3_f32 v62, v62, v90, v91
    v_mov_b32 v58, v62
    s_nop 1
    v_permlane16_swap_b32 v62, v58
    s_nop 1
    v_max_f32 v62, v62, v58
    v_mov_b32 v58, v62
    s_nop 1
    v_permlane32_swap_b32 v62, v58
    s_nop 1
    v_max_f32 v62, v62, v58
    v_add_f32 v62, 0x41c00000, v62
    v_max_f32 v62, 0, v62
    v_exp_f32 v58, -v62
    v_sub_f32 v64, v64, v62
    v_sub_f32 v80, v80, v62
    v_sub_f32 v144, v144, v62
    v_sub_f32 v65, v65, v62
    v_sub_f32 v81, v81, v62
    v_sub_f32 v145, v145, v62
    v_sub_f32 v66, v66, v62
    v_sub_f32 v82, v82, v62
    v_sub_f32 v146, v146, v62
    v_sub_f32 v67, v67, v62
    v_sub_f32 v83, v83, v62
    v_sub_f32 v147, v147, v62
    v_sub_f32 v72, v72, v62
    v_sub_f32 v88, v88, v62
    v_sub_f32 v152, v152, v62
    v_sub_f32 v73, v73, v62
    v_sub_f32 v89, v89, v62
    v_sub_f32 v153, v153, v62
    v_sub_f32 v74, v74, v62
    v_sub_f32 v90, v90, v62
    v_sub_f32 v154, v154, v62
    v_sub_f32 v75, v75, v62
    v_sub_f32 v91, v91, v62
    v_sub_f32 v155, v155, v62
    v_mul_f32 v160, v58, v160
    v_mul_f32 v161, v58, v161
    v_mul_f32 v192, v58, v192
    v_mul_f32 v193, v58, v193
    v_mul_f32 v194, v58, v194
    v_mul_f32 v195, v58, v195
    v_mul_f32 v200, v58, v200
    v_mul_f32 v201, v58, v201
    v_mul_f32 v202, v58, v202
    v_mul_f32 v203, v58, v203
    v_mul_f32 v208, v58, v208
    v_mul_f32 v209, v58, v209
    v_mul_f32 v210, v58, v210
    v_mul_f32 v211, v58, v211
    v_mul_f32 v216, v58, v216
    v_mul_f32 v217, v58, v217
    v_mul_f32 v218, v58, v218
    v_mul_f32 v219, v58, v219
    v_mul_f32 v224, v58, v224
    v_mul_f32 v225, v58, v225
    v_mul_f32 v226, v58, v226
    v_mul_f32 v227, v58, v227
    v_mul_f32 v232, v58, v232
    v_mul_f32 v233, v58, v233
    v_mul_f32 v234, v58, v234
    v_mul_f32 v235, v58, v235
    v_mul_f32 v240, v58, v240
    v_mul_f32 v241, v58, v241
    v_mul_f32 v242, v58, v242
    v_mul_f32 v243, v58, v243
    v_mul_f32 v248, v58, v248
    v_mul_f32 v249, v58, v249
    v_mul_f32 v250, v58, v250
    v_mul_f32 v251, v58, v251
    v_max_f32 v62, v84, v85
    v_max3_f32 v62, v62, v86, v87
    v_max3_f32 v62, v62, v92, v93
    v_max3_f32 v62, v62, v94, v95
    v_mov_b32 v58, v62
    s_nop 1
    v_permlane16_swap_b32 v62, v58
    s_nop 1
    v_max_f32 v62, v62, v58
    v_mov_b32 v58, v62
    s_nop 1
    v_permlane32_swap_b32 v62, v58
    s_nop 1
    v_max_f32 v62, v62, v58
    v_add_f32 v62, 0x41c00000, v62
    v_max_f32 v62, 0, v62
    v_exp_f32 v58, -v62
    v_sub_f32 v68, v68, v62
    v_sub_f32 v84, v84, v62
    v_sub_f32 v148, v148, v62
    v_sub_f32 v69, v69, v62
    v_sub_f32 v85, v85, v62
    v_sub_f32 v149, v149, v62
    v_sub_f32 v70, v70, v62
    v_sub_f32 v86, v86, v62
    v_sub_f32 v150, v150, v62
    v_sub_f32 v71, v71, v62
    v_sub_f32 v87, v87, v62
    v_sub_f32 v151, v151, v62
    v_sub_f32 v76, v76, v62
    v_sub_f32 v92, v92, v62
    v_sub_f32 v156, v156, v62
    v_sub_f32 v77, v77, v62
    v_sub_f32 v93, v93, v62
    v_sub_f32 v157, v157, v62
    v_sub_f32 v78, v78, v62
    v_sub_f32 v94, v94, v62
    v_sub_f32 v158, v158, v62
    v_sub_f32 v79, v79, v62
    v_sub_f32 v95, v95, v62
    v_sub_f32 v159, v159, v62
    v_mul_f32 v162, v58, v162
    v_mul_f32 v163, v58, v163
    v_mul_f32 v196, v58, v196
    v_mul_f32 v197, v58, v197
    v_mul_f32 v198, v58, v198
    v_mul_f32 v199, v58, v199
    v_mul_f32 v204, v58, v204
    v_mul_f32 v205, v58, v205
    v_mul_f32 v206, v58, v206
    v_mul_f32 v207, v58, v207
    v_mul_f32 v212, v58, v212
    v_mul_f32 v213, v58, v213
    v_mul_f32 v214, v58, v214
    v_mul_f32 v215, v58, v215
    v_mul_f32 v220, v58, v220
    v_mul_f32 v221, v58, v221
    v_mul_f32 v222, v58, v222
    v_mul_f32 v223, v58, v223
    v_mul_f32 v228, v58, v228
    v_mul_f32 v229, v58, v229
    v_mul_f32 v230, v58, v230
    v_mul_f32 v231, v58, v231
    v_mul_f32 v236, v58, v236
    v_mul_f32 v237, v58, v237
    v_mul_f32 v238, v58, v238
    v_mul_f32 v239, v58, v239
    v_mul_f32 v244, v58, v244
    v_mul_f32 v245, v58, v245
    v_mul_f32 v246, v58, v246
    v_mul_f32 v247, v58, v247
    v_mul_f32 v252, v58, v252
    v_mul_f32 v253, v58, v253
    v_mul_f32 v254, v58, v254
    v_mul_f32 v255, v58, v255
    v_exp_f32 v58, v80
    s_nop 0
    v_exp_f32 v59, v81
    s_nop 0
    v_cvt_pk_bf16_f32 v136, v58, v59
    v_exp_f32 v60, v82
    s_nop 0
    v_exp_f32 v61, v83
    s_nop 0
    v_cvt_pk_bf16_f32 v137, v60, v61
    v_exp_f32 v58, v84
    s_nop 0
    v_exp_f32 v59, v85
    s_nop 0
    v_cvt_pk_bf16_f32 v140, v58, v59
    v_exp_f32 v60, v86
    s_nop 0
    v_exp_f32 v61, v87
    s_nop 0
    v_cvt_pk_bf16_f32 v141, v60, v61
    v_exp_f32 v58, v88
    s_nop 0
    v_exp_f32 v59, v89
    s_nop 0
    v_cvt_pk_bf16_f32 v138, v58, v59
    v_exp_f32 v60, v90
    s_nop 0
    v_exp_f32 v61, v91
    s_nop 0
    v_cvt_pk_bf16_f32 v139, v60, v61
    v_exp_f32 v58, v92
    s_nop 0
    v_exp_f32 v59, v93
    s_nop 0
    v_cvt_pk_bf16_f32 v142, v58, v59
    v_exp_f32 v60, v94
    s_nop 0
    v_exp_f32 v61, v95
    s_nop 0
    v_cvt_pk_bf16_f32 v143, v60, v61
    s_nop 1
    s_setpc_b64 s[80:81]
L_adone:
    ds_read_b128 v[16:19], v4 offset:0
    ds_read_b128 v[20:23], v4 offset:1024
    ds_read_b128 v[24:27], v4 offset:2048
    ds_read_b128 v[28:31], v4 offset:3072
    s_waitcnt lgkmcnt(3)
    v_mfma_f32_16x16x32_bf16 v[56:59], v[96:99], v[16:19], 0
    s_lshr_b32 s6, s3, 2
    s_mul_i32 s67, s6, 15360
    s_add_u32 s67, s67, 98304
    v_mfma_f32_16x16x32_bf16 v[60:63], v[100:103], v[16:19], 0
    v_add_u32 v6, s67, v44
    s_mul_i32 s73, s6, 5120
    s_add_u32 s73, s73, 67108864
    v_mfma_f32_16x16x32_bf16 v[64:67], v[104:107], v[16:19], 0
    s_lshl_b32 s6, s6, 1
    s_sub_u32 s71, s76, s6
    s_and_b32 s71, s71, 3
    v_mfma_f32_16x16x32_bf16 v[68:71], v[108:111], v[16:19], 0
    s_waitcnt lgkmcnt(2)
    v_mov_b32 v11, 0x5000000
    s_lshl_b32 s74, s3, 2
    s_add_u32 s74, s74, 15728640
    v_mfma_f32_16x16x32_bf16 v[72:75], v[112:115], v[16:19], 0
    ds_read_b128 v[16:19], v4 offset:4096
    s_and_b32 s72, s4, 7
    s_lshl_b32 s7, s5, 3
    s_add_u32 s72, s72, s7
    v_mfma_f32_16x16x32_bf16 v[56:59], v[116:119], v[20:23], v[56:59]
    s_mul_i32 s72, s72, 12
    s_lshr_b32 s75, s4, 3
    s_mul_i32 s7, s75, 3
    v_mfma_f32_16x16x32_bf16 v[60:63], v[120:123], v[20:23], v[60:63]
    s_add_u32 s7, s7, s72
    s_mul_i32 s62, s7, 20480
    s_add_u32 s62, s62, 67108864
    v_mfma_f32_16x16x32_bf16 v[64:67], v[124:127], v[20:23], v[64:67]
    s_lshl_b32 s7, s7, 7
    s_add_u32 s63, s7, 15728640
    s_add_u32 s6, s75, 1
    v_mfma_f32_16x16x32_bf16 v[68:71], v[128:131], v[20:23], v[68:71]
    s_waitcnt lgkmcnt(2)
    s_and_b32 s6, s6, 3
    s_mul_i32 s6, s6, 3
    s_add_u32 s6, s6, s72
    v_mfma_f32_16x16x32_bf16 v[72:75], v[132:135], v[20:23], v[72:75]
    ds_read_b128 v[20:23], v4 offset:5120
    s_add_u32 s6, s6, 0
    s_mul_i32 s7, s6, 20480
    s_add_u32 s96, s7, s73
    v_mfma_f32_16x16x32_bf16 v[72:75], v[152:155], v[24:27], v[72:75]
    s_lshl_b32 s6, s6, 7
    s_add_u32 s6, s6, s74
    v_writelane_b32 v11, s6, 0
    v_mfma_f32_16x16x32_bf16 v[68:71], v[148:151], v[24:27], v[68:71]
    s_add_u32 s6, s75, 2
    s_and_b32 s6, s6, 3
    s_mul_i32 s6, s6, 3
    v_mfma_f32_16x16x32_bf16 v[64:67], v[144:147], v[24:27], v[64:67]
    s_add_u32 s6, s6, s72
    s_add_u32 s6, s6, 1
    s_mul_i32 s7, s6, 20480
    v_mfma_f32_16x16x32_bf16 v[60:63], v[140:143], v[24:27], v[60:63]
    s_waitcnt lgkmcnt(2)
    s_add_u32 s97, s7, s73
    s_lshl_b32 s6, s6, 7
    s_add_u32 s6, s6, s74
    v_mfma_f32_16x16x32_bf16 v[56:59], v[136:139], v[24:27], v[56:59]
    ds_read_b128 v[24:27], v4 offset:6144
    v_writelane_b32 v11, s6, 1
    s_add_u32 s6, s75, 3
    s_and_b32 s6, s6, 3
    v_mfma_f32_16x16x32_bf16 v[56:59], v[156:159], v[28:31], v[56:59]
    s_mul_i32 s6, s6, 3
    s_add_u32 s6, s6, s72
    s_add_u32 s6, s6, 2
    v_mfma_f32_16x16x32_bf16 v[60:63], v[160:163], v[28:31], v[60:63]
    s_mul_i32 s7, s6, 20480
    s_add_u32 s98, s7, s73
    s_lshl_b32 s6, s6, 7
    v_mfma_f32_16x16x32_bf16 v[64:67], v[164:167], v[28:31], v[64:67]
    s_add_u32 s6, s6, s74
    v_writelane_b32 v11, s6, 2
    v_mfma_f32_16x16x32_bf16 v[68:71], v[168:171], v[28:31], v[68:71]
    s_waitcnt lgkmcnt(2)
    v_mfma_f32_16x16x32_bf16 v[72:75], v[172:175], v[28:31], v[72:75]
    ds_read_b128 v[28:31], v4 offset:7168
    s_waitcnt vmcnt(0)
    v_mfma_f32_16x16x32_bf16 v[72:75], v[192:195], v[16:19], v[72:75]
    v_mfma_f32_16x16x32_bf16 v[68:71], v[188:191], v[16:19], v[68:71]
    s_add_u32 s65, s68, 3
    s_and_b32 s65, s65, 3
    s_andn2_b32 s7, s68, 3
    v_mfma_f32_16x16x32_bf16 v[64:67], v[184:187], v[16:19], v[64:67]
    s_add_u32 s65, s65, s7
    s_lshl_b32 s65, s65, 17
    s_add_u32 s65, s65, s66
    v_mfma_f32_16x16x32_bf16 v[60:63], v[180:183], v[16:19], v[60:63]
    s_waitcnt lgkmcnt(2)
    s_add_u32 m0, s99, 65536
    v_mfma_f32_16x16x32_bf16 v[56:59], v[176:179], v[16:19], v[56:59]
    s_cmp_ge_u32 s3, 4
    s_cbranch_scc1 L_o0
    s_waitcnt vmcnt(0)
    s_barrier
L_o0:
    ds_read_b128 v[16:19], v4 offset:32768
    v_mfma_f32_16x16x32_bf16 v[56:59], v[196:199], v[20:23], v[56:59]
    buffer_load_dwordx4 v13, s[8:11], s65 offen offset:0 sc1 lds
    v_mfma_f32_16x16x32_bf16 v[60:63], v[200:203], v[20:23], v[60:63]
    buffer_load_dwordx4 v13, s[8:11], s65 offen offset:1024 sc1 lds
    v_mfma_f32_16x16x32_bf16 v[64:67], v[204:207], v[20:23], v[64:67]
    v_mfma_f32_16x16x32_bf16 v[68:71], v[208:211], v[20:23], v[68:71]
    buffer_load_dwordx4 v13, s[8:11], s65 offen offset:2048 sc1 lds
    s_waitcnt lgkmcnt(2)
    v_mfma_f32_16x16x32_bf16 v[72:75], v[212:215], v[20:23], v[72:75]
    ds_read_b128 v[20:23], v4 offset:33792
    v_mfma_f32_16x16x32_bf16 v[72:75], v[232:235], v[24:27], v[72:75]
    buffer_load_dwordx4 v13, s[8:11], s65 offen offset:3072 sc1 lds
    v_mfma_f32_16x16x32_bf16 v[68:71], v[228:231], v[24:27], v[68:71]
    v_mfma_f32_16x16x32_bf16 v[64:67], v[224:227], v[24:27], v[64:67]
    v_mfma_f32_16x16x32_bf16 v[60:63], v[220:223], v[24:27], v[60:63]
    s_waitcnt lgkmcnt(2)
    v_mfma_f32_16x16x32_bf16 v[56:59], v[216:219], v[24:27], v[56:59]
    ds_read_b128 v[24:27], v4 offset:34816
    v_mfma_f32_16x16x32_bf16 v[56:59], v[236:239], v[28:31], v[56:59]
    v_mfma_f32_16x16x32_bf16 v[60:63], v[240:243], v[28:31], v[60:63]
    v_mfma_f32_16x16x32_bf16 v[64:67], v[244:247], v[28:31], v[64:67]
    v_mfma_f32_16x16x32_bf16 v[68:71], v[248:251], v[28:31], v[68:71]
    s_waitcnt lgkmcnt(2)
    v_mfma_f32_16x16x32_bf16 v[72:75], v[252:255], v[28:31], v[72:75]
    ds_read_b128 v[28:31], v4 offset:35840
    v_mfma_f32_16x16x32_bf16 v[76:79], v[96:99], v[16:19], 0
    s_sub_u32 s6, s71, 1
    s_and_b32 s6, s6, 3
    s_mul_i32 s7, s6, 5120
    v_mfma_f32_16x16x32_bf16 v[80:83], v[100:103], v[16:19], 0
    s_add_u32 s7, s7, s67
    s_cmp_eq_u32 s6, 3
    s_cselect_b32 s7, 155648, s7
    v_mfma_f32_16x16x32_bf16 v[84:87], v[104:107], v[16:19], 0
    v_add_u32 v12, s7, v52
    v_add_u32 v5, s67, v45
    v_mfma_f32_16x16x32_bf16 v[88:91], v[108:111], v[16:19], 0
    s_waitcnt lgkmcnt(2)
    v_mfma_f32_16x16x32_bf16 v[92:95], v[112:115], v[16:19], 0
    ds_read_b128 v[16:19], v4 offset:36864
    v_mfma_f32_16x16x32_bf16 v[76:79], v[116:119], v[20:23], v[76:79]
    ds_write_b128 v5, v[60:63] offset:0
    v_add_u32 v5, s67, v46
    v_mfma_f32_16x16x32_bf16 v[80:83], v[120:123], v[20:23], v[80:83]
    v_and_b32 v3, 1, v1
    v_lshlrev_b32 v3, 12, v3
    s_lshr_b32 s72, s61, 2
    s_lshl_b32 s72, s72, 6
    s_andn2_b32 s6, s4, 7
    s_add_u32 s72, s72, s6
    s_add_u32 s72, s72, s3
    s_lshl_b32 s72, s72, 7
    s_add_u32 s72, s72, 3932160
    v_mfma_f32_16x16x32_bf16 v[84:87], v[124:127], v[20:23], v[84:87]
    v_mfma_f32_16x16x32_bf16 v[88:91], v[128:131], v[20:23], v[88:91]
    s_waitcnt lgkmcnt(3)
    v_mfma_f32_16x16x32_bf16 v[92:95], v[132:135], v[20:23], v[92:95]
    ds_read_b128 v[20:23], v4 offset:37888
    v_mfma_f32_16x16x32_bf16 v[92:95], v[152:155], v[24:27], v[92:95]
    ds_write_b128 v5, v[64:67] offset:5120
    v_add_u32 v5, s67, v47
    v_mfma_f32_16x16x32_bf16 v[88:91], v[148:151], v[24:27], v[88:91]
    v_mfma_f32_16x16x32_bf16 v[84:87], v[144:147], v[24:27], v[84:87]
    buffer_load_dword v50, v3, s[8:11], s72 offen sc1
    v_mfma_f32_16x16x32_bf16 v[80:83], v[140:143], v[24:27], v[80:83]
    s_waitcnt lgkmcnt(4)
    v_mfma_f32_16x16x32_bf16 v[76:79], v[136:139], v[24:27], v[76:79]
    ds_read_b128 v[24:27], v4 offset:38912
    v_mfma_f32_16x16x32_bf16 v[76:79], v[156:159], v[28:31], v[76:79]
    ds_write_b128 v5, v[68:71] offset:10240
    v_add_u32 v5, s67, v52
    v_mfma_f32_16x16x32_bf16 v[80:83], v[160:163], v[28:31], v[80:83]
    v_mfma_f32_16x16x32_bf16 v[84:87], v[164:167], v[28:31], v[84:87]
    v_mfma_f32_16x16x32_bf16 v[88:91], v[168:171], v[28:31], v[88:91]
    s_waitcnt lgkmcnt(5)
    v_mfma_f32_16x16x32_bf16 v[92:95], v[172:175], v[28:31], v[92:95]
    ds_read_b128 v[28:31], v4 offset:39936
    v_mfma_f32_16x16x32_bf16 v[92:95], v[192:195], v[16:19], v[92:95]
    ds_write_b128 v12, v[72:75] offset:0
    v_mfma_f32_16x16x32_bf16 v[88:91], v[188:191], v[16:19], v[88:91]
    v_mfma_f32_16x16x32_bf16 v[84:87], v[184:187], v[16:19], v[84:87]
    v_mfma_f32_16x16x32_bf16 v[80:83], v[180:183], v[16:19], v[80:83]
    s_waitcnt lgkmcnt(5)
    v_mfma_f32_16x16x32_bf16 v[76:79], v[176:179], v[16:19], v[76:79]
    s_waitcnt vmcnt(0)
    s_waitcnt lgkmcnt(0)
    s_barrier
    ds_read_b128 v[32:35], v6 offset:0
    ds_read_b128 v[36:39], v6 offset:5120
    ds_read_b128 v[40:43], v6 offset:10240
    ds_read_b128 v[16:19], v7 offset:0
    v_mfma_f32_16x16x32_bf16 v[76:79], v[196:199], v[20:23], v[76:79]
    v_cmp_ne_u32 vcc, 1, v50
    s_mov_b32 s91, 0
    s_cbranch_vccnz L_t3n
    s_add_u32 s65, s61, 1
    s_and_b32 s65, s65, 3
    s_andn2_b32 s7, s61, 3
    s_add_u32 s65, s65, s7
    s_lshl_b32 s65, s65, 17
    s_add_u32 s65, s65, s66
    s_add_u32 m0, s99, 0
    s_add_u32 s65, s65, 0
    buffer_load_dwordx4 v13, s[8:11], s65 offen offset:0 sc1 lds
    buffer_load_dwordx4 v13, s[8:11], s65 offen offset:1024 sc1 lds
    buffer_load_dwordx4 v13, s[8:11], s65 offen offset:2048 sc1 lds
    buffer_load_dwordx4 v13, s[8:11], s65 offen offset:3072 sc1 lds
    s_mov_b32 s91, 1
    s_branch L_t3j
L_t3n:
    buffer_load_dword v50, v3, s[8:11], s72 offen sc1
L_t3j:
    v_mfma_f32_16x16x32_bf16 v[80:83], v[200:203], v[20:23], v[80:83]
    v_mfma_f32_16x16x32_bf16 v[84:87], v[204:207], v[20:23], v[84:87]
    s_waitcnt lgkmcnt(3)
    v_add_f32 v56, v56, v32
    v_add_f32 v57, v57, v33
    v_mfma_f32_16x16x32_bf16 v[88:91], v[208:211], v[20:23], v[88:91]
    v_add_f32 v58, v58, v34
    v_add_f32 v59, v59, v35
    v_mfma_f32_16x16x32_bf16 v[92:95], v[212:215], v[20:23], v[92:95]
    s_waitcnt lgkmcnt(2)
    ds_read_b128 v[32:35], v5 offset:0
    ds_read_b128 v[20:23], v7 offset:1024
    v_add_f32 v56, v56, v36
    v_add_f32 v57, v57, v37
    v_mfma_f32_16x16x32_bf16 v[92:95], v[232:235], v[24:27], v[92:95]
    v_add_f32 v58, v58, v38
    v_add_f32 v59, v59, v39
    v_mfma_f32_16x16x32_bf16 v[88:91], v[228:231], v[24:27], v[88:91]
    s_waitcnt lgkmcnt(3)
    ds_read_b128 v[36:39], v5 offset:5120
    v_add_f32 v56, v56, v40
    v_add_f32 v57, v57, v41
    v_mfma_f32_16x16x32_bf16 v[84:87], v[224:227], v[24:27], v[84:87]
    v_add_f32 v58, v58, v42
    v_add_f32 v59, v59, v43
    v_mfma_f32_16x16x32_bf16 v[80:83], v[220:223], v[24:27], v[80:83]
    ds_read_b128 v[40:43], v5 offset:10240
    s_waitcnt lgkmcnt(3)
    v_add_f32 v72, v72, v32
    v_add_f32 v73, v73, v33
    s_add_u32 s6, s96, 0
    v_mfma_f32_16x16x32_bf16 v[76:79], v[216:219], v[24:27], v[76:79]
    ds_read_b128 v[24:27], v7 offset:2048
    v_add_f32 v74, v74, v34
    v_add_f32 v75, v75, v35
    v_mfma_f32_16x16x32_bf16 v[76:79], v[236:239], v[28:31], v[76:79]
    buffer_store_dwordx4 v[56:59], v44, s[8:11], s6 offen sc1
    s_waitcnt lgkmcnt(2)
    v_add_f32 v72, v72, v36
    v_add_f32 v73, v73, v37
    v_mfma_f32_16x16x32_bf16 v[80:83], v[240:243], v[28:31], v[80:83]
    v_add_f32 v74, v74, v38
    v_add_f32 v75, v75, v39
    v_mfma_f32_16x16x32_bf16 v[84:87], v[244:247], v[28:31], v[84:87]
    s_waitcnt lgkmcnt(1)
    v_add_f32 v72, v72, v40
    v_add_f32 v73, v73, v41
    v_mfma_f32_16x16x32_bf16 v[88:91], v[248:251], v[28:31], v[88:91]
    v_add_f32 v74, v74, v42
    v_add_f32 v75, v75, v43
    s_cmp_lg_u32 s71, 0
    v_mfma_f32_16x16x32_bf16 v[92:95], v[252:255], v[28:31], v[92:95]
    s_cbranch_scc1 L_nost_50
    buffer_store_dwordx4 v[72:75], v52, s[8:11], s6 offen sc1
L_nost_50:
    ds_read_b128 v[28:31], v7 offset:3072
    v_mfma_f32_16x16x32_bf16 v[56:59], v[96:99], v[16:19], 0
    s_sub_u32 s6, s71, 2
    s_and_b32 s6, s6, 3
    s_mul_i32 s7, s6, 5120
    v_mfma_f32_16x16x32_bf16 v[60:63], v[100:103], v[16:19], 0
    s_add_u32 s7, s7, s67
    s_cmp_eq_u32 s6, 3
    s_cselect_b32 s7, 124928, s7
    v_mfma_f32_16x16x32_bf16 v[64:67], v[104:107], v[16:19], 0
    v_add_u32 v12, s7, v52
    v_add_u32 v5, s67, v45
    s_cmp_lg_u32 s91, 0
    s_cbranch_scc1 L_o2
    s_waitcnt vmcnt(1)
    v_cmp_ne_u32 vcc, 1, v50
    s_cbranch_vccz L_o1
    s_mov_b32 s79, 262144
L_poll_52:
    buffer_load_dword v2, v3, s[8:11], s72 offen sc1
    s_waitcnt vmcnt(0)
    v_cmp_ne_u32 vcc, 1, v2
    s_cbranch_vccz L_polldone_53
    s_sleep 1
    s_sub_u32 s79, s79, 1
    s_cmp_lg_u32 s79, 0
    s_cbranch_scc1 L_poll_52
L_polldone_53:
L_o1:
    s_add_u32 s65, s61, 1
    s_and_b32 s65, s65, 3
    s_andn2_b32 s7, s61, 3
    s_add_u32 s65, s65, s7
    s_lshl_b32 s65, s65, 17
    s_add_u32 s65, s65, s66
    s_add_u32 m0, s99, 0
    s_add_u32 s65, s65, 0
    buffer_load_dwordx4 v13, s[8:11], s65 offen offset:0 sc1 lds
    buffer_load_dwordx4 v13, s[8:11], s65 offen offset:1024 sc1 lds
    buffer_load_dwordx4 v13, s[8:11], s65 offen offset:2048 sc1 lds
    buffer_load_dwordx4 v13, s[8:11], s65 offen offset:3072 sc1 lds
L_o2:
    v_mfma_f32_16x16x32_bf16 v[68:71], v[108:111], v[16:19], 0
    v_mfma_f32_16x16x32_bf16 v[72:75], v[112:115], v[16:19], 0
    ds_read_b128 v[16:19], v7 offset:4096
    v_mfma_f32_16x16x32_bf16 v[56:59], v[116:119], v[20:23], v[56:59]
    ds_write_b128 v5, v[80:83] offset:30720
    v_add_u32 v5, s67, v46
    v_mfma_f32_16x16x32_bf16 v[60:63], v[120:123], v[20:23], v[60:63]
    s_add_u32 s65, s61, 2
    s_and_b32 s65, s65, 3
    s_andn2_b32 s7, s61, 3
    v_mfma_f32_16x16x32_bf16 v[64:67], v[124:127], v[20:23], v[64:67]
    s_add_u32 s65, s65, s7
    s_lshl_b32 s65, s65, 17
    s_add_u32 s65, s65, s66
    v_mfma_f32_16x16x32_bf16 v[68:71], v[128:131], v[20:23], v[68:71]
    s_waitcnt lgkmcnt(3)
    s_add_u32 m0, s99, 32768
    v_mfma_f32_16x16x32_bf16 v[72:75], v[132:135], v[20:23], v[72:75]
    buffer_load_dwordx4 v13, s[8:11], s65 offen offset:0 sc1 lds
    ds_read_b128 v[20:23], v7 offset:5120
    v_mfma_f32_16x16x32_bf16 v[72:75], v[152:155], v[24:27], v[72:75]
    ds_write_b128 v5, v[84:87] offset:35840
    v_add_u32 v5, s67, v47
    v_mfma_f32_16x16x32_bf16 v[68:71], v[148:151], v[24:27], v[68:71]
    buffer_load_dwordx4 v13, s[8:11], s65 offen offset:1024 sc1 lds
    v_mfma_f32_16x16x32_bf16 v[64:67], v[144:147], v[24:27], v[64:67]
    buffer_load_dwordx4 v13, s[8:11], s65 offen offset:2048 sc1 lds
    v_mfma_f32_16x16x32_bf16 v[60:63], v[140:143], v[24:27], v[60:63]
    buffer_load_dwordx4 v13, s[8:11], s65 offen offset:3072 sc1 lds
    s_waitcnt lgkmcnt(4)
    v_mfma_f32_16x16x32_bf16 v[56:59], v[136:139], v[24:27], v[56:59]
    ds_read_b128 v[24:27], v7 offset:6144
    v_mfma_f32_16x16x32_bf16 v[56:59], v[156:159], v[28:31], v[56:59]
    ds_write_b128 v5, v[88:91] offset:40960
    v_add_u32 v5, s67, v52
    v_mfma_f32_16x16x32_bf16 v[60:63], v[160:163], v[28:31], v[60:63]
    v_mfma_f32_16x16x32_bf16 v[64:67], v[164:167], v[28:31], v[64:67]
    v_mfma_f32_16x16x32_bf16 v[68:71], v[168:171], v[28:31], v[68:71]
    s_waitcnt lgkmcnt(5)
    v_mfma_f32_16x16x32_bf16 v[72:75], v[172:175], v[28:31], v[72:75]
    ds_read_b128 v[28:31], v7 offset:7168
    v_mfma_f32_16x16x32_bf16 v[72:75], v[192:195], v[16:19], v[72:75]
    ds_write_b128 v12, v[92:95] offset:30720
    v_mfma_f32_16x16x32_bf16 v[68:71], v[188:191], v[16:19], v[68:71]
    s_add_u32 s65, s61, 3
    s_and_b32 s65, s65, 3
    s_andn2_b32 s7, s61, 3
    v_mfma_f32_16x16x32_bf16 v[64:67], v[184:187], v[16:19], v[64:67]
    s_add_u32 s65, s65, s7
    s_lshl_b32 s65, s65, 17
    s_add_u32 s65, s65, s66
    v_mfma_f32_16x16x32_bf16 v[60:63], v[180:183], v[16:19], v[60:63]
    s_waitcnt lgkmcnt(5)
    s_add_u32 m0, s99, 65536
    v_mfma_f32_16x16x32_bf16 v[56:59], v[176:179], v[16:19], v[56:59]
    s_waitcnt vmcnt(4)
    s_waitcnt lgkmcnt(0)
    s_barrier
    ds_read_b128 v[32:35], v6 offset:30720
    ds_read_b128 v[36:39], v6 offset:35840
    ds_read_b128 v[40:43], v6 offset:40960
    ds_read_b128 v[16:19], v4 offset:0
    v_mfma_f32_16x16x32_bf16 v[56:59], v[196:199], v[20:23], v[56:59]
    buffer_load_dwordx4 v13, s[8:11], s65 offen offset:0 sc1 lds
    v_mfma_f32_16x16x32_bf16 v[60:63], v[200:203], v[20:23], v[60:63]
    buffer_load_dwordx4 v13, s[8:11], s65 offen offset:1024 sc1 lds
    v_mfma_f32_16x16x32_bf16 v[64:67], v[204:207], v[20:23], v[64:67]
    s_waitcnt lgkmcnt(3)
    v_add_f32 v76, v76, v32
    v_add_f32 v77, v77, v33
    v_mfma_f32_16x16x32_bf16 v[68:71], v[208:211], v[20:23], v[68:71]
    buffer_load_dwordx4 v13, s[8:11], s65 offen offset:2048 sc1 lds
    v_add_f32 v78, v78, v34
    v_add_f32 v79, v79, v35
    v_mfma_f32_16x16x32_bf16 v[72:75], v[212:215], v[20:23], v[72:75]
    s_waitcnt lgkmcnt(2)
    ds_read_b128 v[32:35], v5 offset:30720
    ds_read_b128 v[20:23], v4 offset:1024
    v_add_f32 v76, v76, v36
    v_add_f32 v77, v77, v37
    v_mfma_f32_16x16x32_bf16 v[72:75], v[232:235], v[24:27], v[72:75]
    buffer_load_dwordx4 v13, s[8:11], s65 offen offset:3072 sc1 lds
    v_add_f32 v78, v78, v38
    v_add_f32 v79, v79, v39
    v_mfma_f32_16x16x32_bf16 v[68:71], v[228:231], v[24:27], v[68:71]
    s_waitcnt lgkmcnt(3)
    ds_read_b128 v[36:39], v5 offset:35840
    v_add_f32 v76, v76, v40
    v_add_f32 v77, v77, v41
    v_mfma_f32_16x16x32_bf16 v[64:67], v[224:227], v[24:27], v[64:67]
    v_add_f32 v78, v78, v42
    v_add_f32 v79, v79, v43
    v_mfma_f32_16x16x32_bf16 v[60:63], v[220:223], v[24:27], v[60:63]
    ds_read_b128 v[40:43], v5 offset:40960
    s_waitcnt lgkmcnt(3)
    v_add_f32 v92, v92, v32
    v_add_f32 v93, v93, v33
    s_add_u32 s6, s97, 0
    v_mfma_f32_16x16x32_bf16 v[56:59], v[216:219], v[24:27], v[56:59]
    ds_read_b128 v[24:27], v4 offset:2048
    v_add_f32 v94, v94, v34
    v_add_f32 v95, v95, v35
    v_mfma_f32_16x16x32_bf16 v[56:59], v[236:239], v[28:31], v[56:59]
    buffer_store_dwordx4 v[76:79], v44, s[8:11], s6 offen sc1
    s_waitcnt lgkmcnt(2)
    v_add_f32 v92, v92, v36
    v_add_f32 v93, v93, v37
    v_mfma_f32_16x16x32_bf16 v[60:63], v[240:243], v[28:31], v[60:63]
    v_add_f32 v94, v94, v38
    v_add_f32 v95, v95, v39
    v_mfma_f32_16x16x32_bf16 v[64:67], v[244:247], v[28:31], v[64:67]
    s_waitcnt lgkmcnt(1)
    v_add_f32 v92, v92, v40
    v_add_f32 v93, v93, v41
    v_mfma_f32_16x16x32_bf16 v[68:71], v[248:251], v[28:31], v[68:71]
    v_add_f32 v94, v94, v42
    v_add_f32 v95, v95, v43
    s_cmp_lg_u32 s71, 1
    v_mfma_f32_16x16x32_bf16 v[72:75], v[252:255], v[28:31], v[72:75]
    s_cbranch_scc1 L_nost_51
    buffer_store_dwordx4 v[92:95], v52, s[8:11], s6 offen sc1
L_nost_51:
    ds_read_b128 v[28:31], v4 offset:3072
    v_mfma_f32_16x16x32_bf16 v[76:79], v[96:99], v[16:19], 0
    s_sub_u32 s6, s71, 3
    s_and_b32 s6, s6, 3
    s_mul_i32 s7, s6, 5120
    v_mfma_f32_16x16x32_bf16 v[80:83], v[100:103], v[16:19], 0
    s_add_u32 s7, s7, s67
    s_cmp_eq_u32 s6, 3
    s_cselect_b32 s7, 155648, s7
    v_mfma_f32_16x16x32_bf16 v[84:87], v[104:107], v[16:19], 0
    v_add_u32 v12, s7, v52
    v_add_u32 v5, s67, v45
    v_mfma_f32_16x16x32_bf16 v[88:91], v[108:111], v[16:19], 0
    s_mov_b32 s12, s32
    s_mov_b32 s13, s33
    s_mov_b32 s14, 0x280000
    s_mov_b32 s15, 0x20000
    v_mfma_f32_16x16x32_bf16 v[92:95], v[112:115], v[16:19], 0
    ds_read_b128 v[16:19], v4 offset:4096
    s_and_b32 s75, s4, 3
    s_mul_i32 s70, s75, 320
    s_add_u32 s73, s70, 3837952
    s_mul_i32 s72, s75, 5120
    v_mfma_f32_16x16x32_bf16 v[76:79], v[116:119], v[20:23], v[76:79]
    ds_write_b128 v5, v[60:63] offset:0
    v_add_u32 v5, s67, v46
    v_mfma_f32_16x16x32_bf16 v[80:83], v[120:123], v[20:23], v[80:83]
    v_lshrrev_b32 v2, 4, v1
    v_and_b32 v3, 15, v1
    v_mul_u32_u24 v54, 1280, v3
    v_lshl_add_u32 v54, v2, 4, v54
    v_mfma_f32_16x16x32_bf16 v[84:87], v[124:127], v[20:23], v[84:87]
    v_lshlrev_b32 v3, 4, v3
    v_lshl_add_u32 v9, v2, 9, v3
    s_lshr_b32 s100, s3, 2
    s_cselect_b32 s6, s61, s68
    v_mfma_f32_16x16x32_bf16 v[88:91], v[128:131], v[20:23], v[88:91]
    s_waitcnt lgkmcnt(3)
    s_mul_i32 s6, s6, 20480
    s_lshl_b32 s7, s76, 6
    s_add_u32 s7, s7, s6
    v_add_u32 v53, s7, v54
    v_mfma_f32_16x16x32_bf16 v[92:95], v[132:135], v[20:23], v[92:95]
    ds_read_b128 v[20:23], v4 offset:5120
    s_lshl_b32 s7, s76, 10
    s_add_u32 s7, s7, s6
    s_add_u32 s7, s7, s72
    v_add_u32 v48, s7, v13
    v_mfma_f32_16x16x32_bf16 v[92:95], v[152:155], v[24:27], v[92:95]
    ds_write_b128 v5, v[64:67] offset:5120
    v_add_u32 v5, s67, v47
    v_mfma_f32_16x16x32_bf16 v[88:91], v[148:151], v[24:27], v[88:91]
    s_mul_i32 s6, s100, 10240
    s_lshl_b32 s7, s76, 11
    s_add_u32 s6, s6, s7
    v_add_u32 v8, s6, v9
    v_mfma_f32_16x16x32_bf16 v[84:87], v[144:147], v[24:27], v[84:87]
    s_mul_i32 s6, s100, 75776
    s_sub_u32 s6, 65536, s6
    v_add_u32 v10, s6, v8
    s_lshl_b32 s7, s76, 2
    v_mfma_f32_16x16x32_bf16 v[80:83], v[140:143], v[24:27], v[80:83]
    s_waitcnt lgkmcnt(4)
    v_add_u32 v2, s7, v2
    v_cmp_lt_u32 vcc, 9, v2
    s_mul_i32 s6, s100, 86016
    s_add_u32 s6, s6, 15360
    v_mfma_f32_16x16x32_bf16 v[76:79], v[136:139], v[24:27], v[76:79]
    ds_read_b128 v[24:27], v4 offset:6144
    v_add_u32 v3, s6, v10
    v_cndmask_b32 v10, v10, v3, vcc
    s_and_b32 s100, s3, 1
    s_cselect_b32 s6, s61, s68
    v_mfma_f32_16x16x32_bf16 v[76:79], v[156:159], v[28:31], v[76:79]
    ds_write_b128 v5, v[68:71] offset:10240
    v_add_u32 v5, s67, v52
    v_mfma_f32_16x16x32_bf16 v[80:83], v[160:163], v[28:31], v[80:83]
    s_mul_i32 s6, s6, 20480
    s_add_u32 s7, s6, 256
    v_add_u32 v54, s7, v54
    s_add_u32 s7, s6, s72
    v_mfma_f32_16x16x32_bf16 v[84:87], v[164:167], v[28:31], v[84:87]
    s_add_u32 s7, s7, 4096
    v_add_u32 v49, s7, v13
    s_mul_i32 s6, s100, 10240
    s_add_u32 s6, s6, 8192
    v_mfma_f32_16x16x32_bf16 v[88:91], v[168:171], v[28:31], v[88:91]
    s_waitcnt lgkmcnt(5)
    v_add_u32 v9, s6, v9
    s_mul_i32 s6, s100, 10240
    s_add_u32 s6, s6, 80896
    v_add_u32 v55, s6, v9
    v_mfma_f32_16x16x32_bf16 v[92:95], v[172:175], v[28:31], v[92:95]
    ds_read_b128 v[28:31], v4 offset:7168
    v_mfma_f32_16x16x32_bf16 v[92:95], v[192:195], v[16:19], v[92:95]
    ds_write_b128 v12, v[72:75] offset:0
    v_mfma_f32_16x16x32_bf16 v[88:91], v[188:191], v[16:19], v[88:91]
    s_add_u32 s65, s68, 0
    s_and_b32 s65, s65, 3
    s_andn2_b32 s7, s68, 3
    v_mfma_f32_16x16x32_bf16 v[84:87], v[184:187], v[16:19], v[84:87]
    s_add_u32 s65, s65, s7
    s_lshl_b32 s65, s65, 17
    s_add_u32 s65, s65, s66
    v_mfma_f32_16x16x32_bf16 v[80:83], v[180:183], v[16:19], v[80:83]
    s_waitcnt lgkmcnt(5)
    s_add_u32 m0, s99, 0
    v_mfma_f32_16x16x32_bf16 v[76:79], v[176:179], v[16:19], v[76:79]
    s_waitcnt vmcnt(5)
    s_waitcnt lgkmcnt(0)
    s_barrier
    ds_read_b128 v[32:35], v6 offset:0
    ds_read_b128 v[36:39], v6 offset:5120
    ds_read_b128 v[40:43], v6 offset:10240
    ds_read_b128 v[16:19], v4 offset:32768
    v_mfma_f32_16x16x32_bf16 v[76:79], v[196:199], v[20:23], v[76:79]
    buffer_load_dwordx4 v13, s[8:11], s65 offen offset:0 sc1 lds
    v_mfma_f32_16x16x32_bf16 v[80:83], v[200:203], v[20:23], v[80:83]
    buffer_load_dwordx4 v13, s[8:11], s65 offen offset:1024 sc1 lds
    v_mfma_f32_16x16x32_bf16 v[84:87], v[204:207], v[20:23], v[84:87]
    s_waitcnt lgkmcnt(3)
    v_add_f32 v56, v56, v32
    v_add_f32 v57, v57, v33
    v_mfma_f32_16x16x32_bf16 v[88:91], v[208:211], v[20:23], v[88:91]
    buffer_load_dwordx4 v13, s[8:11], s65 offen offset:2048 sc1 lds
    v_add_f32 v58, v58, v34
    v_add_f32 v59, v59, v35
    v_mfma_f32_16x16x32_bf16 v[92:95], v[212:215], v[20:23], v[92:95]
    s_waitcnt lgkmcnt(2)
    ds_read_b128 v[32:35], v5 offset:0
    ds_read_b128 v[20:23], v4 offset:33792
    v_add_f32 v56, v56, v36
    v_add_f32 v57, v57, v37
    v_mfma_f32_16x16x32_bf16 v[92:95], v[232:235], v[24:27], v[92:95]
    buffer_load_dwordx4 v13, s[8:11], s65 offen offset:3072 sc1 lds
    v_add_f32 v58, v58, v38
    v_add_f32 v59, v59, v39
    v_mfma_f32_16x16x32_bf16 v[88:91], v[228:231], v[24:27], v[88:91]
    s_waitcnt lgkmcnt(3)
    ds_read_b128 v[36:39], v5 offset:5120
    v_add_f32 v56, v56, v40
    v_add_f32 v57, v57, v41
    v_mfma_f32_16x16x32_bf16 v[84:87], v[224:227], v[24:27], v[84:87]
    v_add_f32 v58, v58, v42
    v_add_f32 v59, v59, v43
    v_mfma_f32_16x16x32_bf16 v[80:83], v[220:223], v[24:27], v[80:83]
    ds_read_b128 v[40:43], v5 offset:10240
    s_waitcnt lgkmcnt(3)
    v_add_f32 v72, v72, v32
    v_add_f32 v73, v73, v33
    s_add_u32 s6, s98, 0
    v_mfma_f32_16x16x32_bf16 v[76:79], v[216:219], v[24:27], v[76:79]
    ds_read_b128 v[24:27], v4 offset:34816
    v_add_f32 v74, v74, v34
    v_add_f32 v75, v75, v35
    v_mfma_f32_16x16x32_bf16 v[76:79], v[236:239], v[28:31], v[76:79]
    buffer_store_dwordx4 v[56:59], v44, s[8:11], s6 offen sc1
    s_waitcnt lgkmcnt(2)
    v_add_f32 v72, v72, v36
    v_add_f32 v73, v73, v37
    v_mfma_f32_16x16x32_bf16 v[80:83], v[240:243], v[28:31], v[80:83]
    v_add_f32 v74, v74, v38
    v_add_f32 v75, v75, v39
    v_mfma_f32_16x16x32_bf16 v[84:87], v[244:247], v[28:31], v[84:87]
    s_waitcnt lgkmcnt(1)
    v_add_f32 v72, v72, v40
    v_add_f32 v73, v73, v41
    v_mfma_f32_16x16x32_bf16 v[88:91], v[248:251], v[28:31], v[88:91]
    v_add_f32 v74, v74, v42
    v_add_f32 v75, v75, v43
    s_cmp_lg_u32 s71, 2
    v_mfma_f32_16x16x32_bf16 v[92:95], v[252:255], v[28:31], v[92:95]
    s_cbranch_scc1 L_nost_54
    buffer_store_dwordx4 v[72:75], v52, s[8:11], s6 offen sc1
L_nost_54:
    ds_read_b128 v[28:31], v4 offset:35840
    v_mfma_f32_16x16x32_bf16 v[56:59], v[96:99], v[16:19], 0
    s_sub_u32 s6, s71, 4
    s_and_b32 s6, s6, 3
    s_mul_i32 s7, s6, 5120
    v_mfma_f32_16x16x32_bf16 v[60:63], v[100:103], v[16:19], 0
    s_add_u32 s7, s7, s67
    s_cmp_eq_u32 s6, 3
    s_cselect_b32 s7, 124928, s7
    v_mfma_f32_16x16x32_bf16 v[64:67], v[104:107], v[16:19], 0
    v_add_u32 v12, s7, v52
    v_add_u32 v5, s67, v45
    v_mfma_f32_16x16x32_bf16 v[68:71], v[108:111], v[16:19], 0
    v_mfma_f32_16x16x32_bf16 v[72:75], v[112:115], v[16:19], 0
    ds_read_b128 v[16:19], v4 offset:36864
    v_mfma_f32_16x16x32_bf16 v[56:59], v[116:119], v[20:23], v[56:59]
    ds_write_b128 v5, v[80:83] offset:30720
    v_add_u32 v5, s67, v46
    v_mfma_f32_16x16x32_bf16 v[60:63], v[120:123], v[20:23], v[60:63]
    v_mfma_f32_16x16x32_bf16 v[64:67], v[124:127], v[20:23], v[64:67]
    v_cmp_le_i32 vcc, 0, v51
    s_cbranch_vccz L_idx_okb
    v_and_b32 v3, 7, v1
    v_lshlrev_b32 v3, 2, v3
    s_mov_b32 s72, 0x3a0000
    s_mov_b32 s79, 262144
L_poll_56:
    buffer_load_dword v51, v3, s[8:11], s72 offen sc1
    s_waitcnt vmcnt(0)
    v_cmp_le_i32 vcc, 0, v51
    s_cbranch_vccz L_polldone_57
    s_sleep 2
    s_sub_u32 s79, s79, 1
    s_cmp_lg_u32 s79, 0
    s_cbranch_scc1 L_poll_56
L_polldone_57:
L_idx_okb:
    s_mov_b32 s64, 0
    v_and_b32 v2, 0x7ff, v51
    v_sub_u32 v2, 0x7ff, v2
    v_lshrrev_b32 v3, 4, v2
    v_cmp_eq_u32 vcc, s68, v3
    v_cmp_eq_u32 s[74:75], s61, v3
    s_nop 3
    s_or_b64 vcc, vcc, s[74:75]
    s_cbranch_scc0 L_notok_58
    v_readlane_b32 s84, v2, 0
    v_readlane_b32 s85, v2, 1
    v_readlane_b32 s86, v2, 2
    v_readlane_b32 s87, v2, 3
    v_readlane_b32 s88, v2, 4
    v_readlane_b32 s65, v2, 5
    v_readlane_b32 s91, v2, 6
    v_readlane_b32 s101, v2, 7
    s_lshl_b32 s7, s76, 6
    s_lshr_b32 s100, s3, 2
    s_cselect_b32 s6, s61, s68
    s_lshl_b32 s6, s6, 4
    v_and_b32 v2, 15, v1
    v_add_u32 v2, s6, v2
    s_add_u32 s7, s7, s73
    v_and_b32 v3, 48, v1
    v_add_u32 v3, s7, v3
    v_cmp_eq_u32 vcc, s84, v2
    s_nop 1
    v_cndmask_b32 v48, v48, v3, vcc
    v_add_u32 v3, 1280, v3
    v_cmp_eq_u32 vcc, s85, v2
    s_nop 1
    v_cndmask_b32 v48, v48, v3, vcc
    v_add_u32 v3, 1280, v3
    v_cmp_eq_u32 vcc, s86, v2
    s_nop 1
    v_cndmask_b32 v48, v48, v3, vcc
    v_add_u32 v3, 1280, v3
    v_cmp_eq_u32 vcc, s87, v2
    s_nop 1
    v_cndmask_b32 v48, v48, v3, vcc
    v_add_u32 v3, 1280, v3
    v_cmp_eq_u32 vcc, s88, v2
    s_nop 1
    v_cndmask_b32 v48, v48, v3, vcc
    v_add_u32 v3, 1280, v3
    v_cmp_eq_u32 vcc, s65, v2
    s_nop 1
    v_cndmask_b32 v48, v48, v3, vcc
    v_add_u32 v3, 1280, v3
    v_cmp_eq_u32 vcc, s91, v2
    s_nop 1
    v_cndmask_b32 v48, v48, v3, vcc
    v_add_u32 v3, 1280, v3
    v_cmp_eq_u32 vcc, s101, v2
    s_nop 1
    v_cndmask_b32 v48, v48, v3, vcc
    s_movk_i32 s7, 256
    s_and_b32 s100, s3, 1
    s_cselect_b32 s6, s61, s68
    s_lshl_b32 s6, s6, 4
    v_and_b32 v2, 15, v1
    v_add_u32 v2, s6, v2
    s_add_u32 s7, s7, s73
    v_and_b32 v3, 48, v1
    v_add_u32 v3, s7, v3
    v_cmp_eq_u32 vcc, s84, v2
    s_nop 1
    v_cndmask_b32 v49, v49, v3, vcc
    v_add_u32 v3, 1280, v3
    v_cmp_eq_u32 vcc, s85, v2
    s_nop 1
    v_cndmask_b32 v49, v49, v3, vcc
    v_add_u32 v3, 1280, v3
    v_cmp_eq_u32 vcc, s86, v2
    s_nop 1
    v_cndmask_b32 v49, v49, v3, vcc
    v_add_u32 v3, 1280, v3
    v_cmp_eq_u32 vcc, s87, v2
    s_nop 1
    v_cndmask_b32 v49, v49, v3, vcc
    v_add_u32 v3, 1280, v3
    v_cmp_eq_u32 vcc, s88, v2
    s_nop 1
    v_cndmask_b32 v49, v49, v3, vcc
    v_add_u32 v3, 1280, v3
    v_cmp_eq_u32 vcc, s65, v2
    s_nop 1
    v_cndmask_b32 v49, v49, v3, vcc
    v_add_u32 v3, 1280, v3
    v_cmp_eq_u32 vcc, s91, v2
    s_nop 1
    v_cndmask_b32 v49, v49, v3, vcc
    v_add_u32 v3, 1280, v3
    v_cmp_eq_u32 vcc, s101, v2
    s_nop 1
    v_cndmask_b32 v49, v49, v3, vcc
    s_mov_b32 s64, 1
L_notok_58:
    v_mfma_f32_16x16x32_bf16 v[68:71], v[128:131], v[20:23], v[68:71]
    s_waitcnt lgkmcnt(3)
    v_mfma_f32_16x16x32_bf16 v[72:75], v[132:135], v[20:23], v[72:75]
    ds_read_b128 v[20:23], v4 offset:37888
    v_mfma_f32_16x16x32_bf16 v[72:75], v[152:155], v[24:27], v[72:75]
    ds_write_b128 v5, v[84:87] offset:35840
    v_add_u32 v5, s67, v47
    v_mfma_f32_16x16x32_bf16 v[68:71], v[148:151], v[24:27], v[68:71]
    v_mfma_f32_16x16x32_bf16 v[64:67], v[144:147], v[24:27], v[64:67]
    v_mfma_f32_16x16x32_bf16 v[60:63], v[140:143], v[24:27], v[60:63]
    s_waitcnt lgkmcnt(4)
    v_mfma_f32_16x16x32_bf16 v[56:59], v[136:139], v[24:27], v[56:59]
    ds_read_b128 v[24:27], v4 offset:38912
    v_mfma_f32_16x16x32_bf16 v[56:59], v[156:159], v[28:31], v[56:59]
    ds_write_b128 v5, v[88:91] offset:40960
    v_add_u32 v5, s67, v52
    v_mfma_f32_16x16x32_bf16 v[60:63], v[160:163], v[28:31], v[60:63]
    v_mfma_f32_16x16x32_bf16 v[64:67], v[164:167], v[28:31], v[64:67]
    v_mfma_f32_16x16x32_bf16 v[68:71], v[168:171], v[28:31], v[68:71]
    s_waitcnt lgkmcnt(5)
    v_mfma_f32_16x16x32_bf16 v[72:75], v[172:175], v[28:31], v[72:75]
    ds_read_b128 v[28:31], v4 offset:39936
    v_mfma_f32_16x16x32_bf16 v[72:75], v[192:195], v[16:19], v[72:75]
    ds_write_b128 v12, v[92:95] offset:30720
    v_mfma_f32_16x16x32_bf16 v[68:71], v[188:191], v[16:19], v[68:71]
    s_add_u32 s65, s61, 0
    s_and_b32 s65, s65, 3
    s_andn2_b32 s7, s61, 3
    v_mfma_f32_16x16x32_bf16 v[64:67], v[184:187], v[16:19], v[64:67]
    s_add_u32 s65, s65, s7
    s_lshl_b32 s65, s65, 17
    s_add_u32 s65, s65, s66
    v_mfma_f32_16x16x32_bf16 v[60:63], v[180:183], v[16:19], v[60:63]
    s_waitcnt lgkmcnt(5)
    s_add_u32 m0, s99, 32768
    v_mfma_f32_16x16x32_bf16 v[56:59], v[176:179], v[16:19], v[56:59]
    s_waitcnt vmcnt(5)
    s_waitcnt lgkmcnt(0)
    s_barrier
    ds_read_b128 v[32:35], v6 offset:30720
    ds_read_b128 v[36:39], v6 offset:35840
    ds_read_b128 v[40:43], v6 offset:40960
    ds_read_b128 v[16:19], v7 offset:0
    v_mfma_f32_16x16x32_bf16 v[56:59], v[196:199], v[20:23], v[56:59]
    buffer_load_dwordx4 v13, s[8:11], s65 offen offset:0 sc1 lds
    v_mfma_f32_16x16x32_bf16 v[60:63], v[200:203], v[20:23], v[60:63]
    buffer_load_dwordx4 v13, s[8:11], s65 offen offset:1024 sc1 lds
    v_mfma_f32_16x16x32_bf16 v[64:67], v[204:207], v[20:23], v[64:67]
    s_waitcnt lgkmcnt(3)
    v_add_f32 v76, v76, v32
    v_add_f32 v77, v77, v33
    v_mfma_f32_16x16x32_bf16 v[68:71], v[208:211], v[20:23], v[68:71]
    buffer_load_dwordx4 v13, s[8:11], s65 offen offset:2048 sc1 lds
    v_add_f32 v78, v78, v34
    v_add_f32 v79, v79, v35
    v_mfma_f32_16x16x32_bf16 v[72:75], v[212:215], v[20:23], v[72:75]
    s_waitcnt lgkmcnt(2)
    ds_read_b128 v[32:35], v5 offset:30720
    ds_read_b128 v[20:23], v7 offset:1024
    v_add_f32 v76, v76, v36
    v_add_f32 v77, v77, v37
    v_mfma_f32_16x16x32_bf16 v[72:75], v[232:235], v[24:27], v[72:75]
    buffer_load_dwordx4 v13, s[8:11], s65 offen offset:3072 sc1 lds
    v_add_f32 v78, v78, v38
    v_add_f32 v79, v79, v39
    v_mfma_f32_16x16x32_bf16 v[68:71], v[228:231], v[24:27], v[68:71]
    s_waitcnt lgkmcnt(3)
    ds_read_b128 v[36:39], v5 offset:35840
    v_add_f32 v76, v76, v40
    v_add_f32 v77, v77, v41
    v_mfma_f32_16x16x32_bf16 v[64:67], v[224:227], v[24:27], v[64:67]
    v_add_f32 v78, v78, v42
    v_add_f32 v79, v79, v43
    v_mfma_f32_16x16x32_bf16 v[60:63], v[220:223], v[24:27], v[60:63]
    ds_read_b128 v[40:43], v5 offset:40960
    s_waitcnt lgkmcnt(3)
    v_add_f32 v92, v92, v32
    v_add_f32 v93, v93, v33
    s_add_u32 s6, s96, 10240
    v_mfma_f32_16x16x32_bf16 v[56:59], v[216:219], v[24:27], v[56:59]
    ds_read_b128 v[24:27], v7 offset:2048
    v_add_f32 v94, v94, v34
    v_add_f32 v95, v95, v35
    v_mfma_f32_16x16x32_bf16 v[56:59], v[236:239], v[28:31], v[56:59]
    buffer_store_dwordx4 v[76:79], v44, s[8:11], s6 offen sc1
    s_waitcnt lgkmcnt(2)
    v_add_f32 v92, v92, v36
    v_add_f32 v93, v93, v37
    v_mfma_f32_16x16x32_bf16 v[60:63], v[240:243], v[28:31], v[60:63]
    v_add_f32 v94, v94, v38
    v_add_f32 v95, v95, v39
    v_mfma_f32_16x16x32_bf16 v[64:67], v[244:247], v[28:31], v[64:67]
    s_waitcnt lgkmcnt(1)
    v_add_f32 v92, v92, v40
    v_add_f32 v93, v93, v41
    v_mfma_f32_16x16x32_bf16 v[68:71], v[248:251], v[28:31], v[68:71]
    v_add_f32 v94, v94, v42
    v_add_f32 v95, v95, v43
    s_cmp_lg_u32 s71, 3
    v_mfma_f32_16x16x32_bf16 v[72:75], v[252:255], v[28:31], v[72:75]
    s_cbranch_scc1 L_nost_55
    buffer_store_dwordx4 v[92:95], v52, s[8:11], s6 offen sc1
L_nost_55:
    ds_read_b128 v[28:31], v7 offset:3072
    v_mfma_f32_16x16x32_bf16 v[76:79], v[96:99], v[16:19], 0
    s_sub_u32 s6, s71, 5
    s_and_b32 s6, s6, 3
    s_mul_i32 s7, s6, 5120
    v_mfma_f32_16x16x32_bf16 v[80:83], v[100:103], v[16:19], 0
    s_add_u32 s7, s7, s67
    s_cmp_eq_u32 s6, 3
    s_cselect_b32 s7, 155648, s7
    v_mfma_f32_16x16x32_bf16 v[84:87], v[104:107], v[16:19], 0
    v_add_u32 v12, s7, v52
    v_add_u32 v5, s67, v45
    v_mfma_f32_16x16x32_bf16 v[88:91], v[108:111], v[16:19], 0
    v_mfma_f32_16x16x32_bf16 v[92:95], v[112:115], v[16:19], 0
    ds_read_b128 v[16:19], v7 offset:4096
    v_mfma_f32_16x16x32_bf16 v[76:79], v[116:119], v[20:23], v[76:79]
    ds_write_b128 v5, v[60:63] offset:0
    v_add_u32 v5, s67, v46
    v_mfma_f32_16x16x32_bf16 v[80:83], v[120:123], v[20:23], v[80:83]
    v_mfma_f32_16x16x32_bf16 v[84:87], v[124:127], v[20:23], v[84:87]
    v_mfma_f32_16x16x32_bf16 v[88:91], v[128:131], v[20:23], v[88:91]
    s_waitcnt lgkmcnt(3)
    v_mfma_f32_16x16x32_bf16 v[92:95], v[132:135], v[20:23], v[92:95]
    ds_read_b128 v[20:23], v7 offset:5120
    v_mfma_f32_16x16x32_bf16 v[92:95], v[152:155], v[24:27], v[92:95]
    ds_write_b128 v5, v[64:67] offset:5120
    v_add_u32 v5, s67, v47
    v_mfma_f32_16x16x32_bf16 v[88:91], v[148:151], v[24:27], v[88:91]
    v_mfma_f32_16x16x32_bf16 v[84:87], v[144:147], v[24:27], v[84:87]
    v_mfma_f32_16x16x32_bf16 v[80:83], v[140:143], v[24:27], v[80:83]
    s_waitcnt lgkmcnt(4)
    v_mfma_f32_16x16x32_bf16 v[76:79], v[136:139], v[24:27], v[76:79]
    ds_read_b128 v[24:27], v7 offset:6144
    v_mfma_f32_16x16x32_bf16 v[76:79], v[156:159], v[28:31], v[76:79]
    ds_write_b128 v5, v[68:71] offset:10240
    v_add_u32 v5, s67, v52
    v_mfma_f32_16x16x32_bf16 v[80:83], v[160:163], v[28:31], v[80:83]
    v_mfma_f32_16x16x32_bf16 v[84:87], v[164:167], v[28:31], v[84:87]
    v_mfma_f32_16x16x32_bf16 v[88:91], v[168:171], v[28:31], v[88:91]
    s_waitcnt lgkmcnt(5)
    v_mfma_f32_16x16x32_bf16 v[92:95], v[172:175], v[28:31], v[92:95]
    ds_read_b128 v[28:31], v7 offset:7168
    v_mfma_f32_16x16x32_bf16 v[92:95], v[192:195], v[16:19], v[92:95]
    ds_write_b128 v12, v[72:75] offset:0
    v_mfma_f32_16x16x32_bf16 v[88:91], v[188:191], v[16:19], v[88:91]
    v_mfma_f32_16x16x32_bf16 v[84:87], v[184:187], v[16:19], v[84:87]
    v_mfma_f32_16x16x32_bf16 v[80:83], v[180:183], v[16:19], v[80:83]
    s_waitcnt lgkmcnt(5)
    v_mfma_f32_16x16x32_bf16 v[76:79], v[176:179], v[16:19], v[76:79]
    s_waitcnt vmcnt(5)
    s_waitcnt lgkmcnt(0)
    s_barrier
    ds_read_b128 v[32:35], v6 offset:0
    ds_read_b128 v[36:39], v6 offset:5120
    ds_read_b128 v[40:43], v6 offset:10240
    ds_read_b128 v[16:19], v4 offset:0
    v_mfma_f32_16x16x32_bf16 v[76:79], v[196:199], v[20:23], v[76:79]
    v_mfma_f32_16x16x32_bf16 v[80:83], v[200:203], v[20:23], v[80:83]
    v_mfma_f32_16x16x32_bf16 v[84:87], v[204:207], v[20:23], v[84:87]
    s_waitcnt lgkmcnt(3)
    v_add_f32 v56, v56, v32
    v_add_f32 v57, v57, v33
    v_mfma_f32_16x16x32_bf16 v[88:91], v[208:211], v[20:23], v[88:91]
    v_add_f32 v58, v58, v34
    v_add_f32 v59, v59, v35
    v_mfma_f32_16x16x32_bf16 v[92:95], v[212:215], v[20:23], v[92:95]
    s_waitcnt lgkmcnt(2)
    ds_read_b128 v[32:35], v5 offset:0
    ds_read_b128 v[20:23], v4 offset:1024
    v_add_f32 v56, v56, v36
    v_add_f32 v57, v57, v37
    v_mfma_f32_16x16x32_bf16 v[92:95], v[232:235], v[24:27], v[92:95]
    v_add_f32 v58, v58, v38
    v_add_f32 v59, v59, v39
    v_mfma_f32_16x16x32_bf16 v[88:91], v[228:231], v[24:27], v[88:91]
    s_waitcnt lgkmcnt(3)
    ds_read_b128 v[36:39], v5 offset:5120
    v_add_f32 v56, v56, v40
    v_add_f32 v57, v57, v41
    v_mfma_f32_16x16x32_bf16 v[84:87], v[224:227], v[24:27], v[84:87]
    v_add_f32 v58, v58, v42
    v_add_f32 v59, v59, v43
    v_mfma_f32_16x16x32_bf16 v[80:83], v[220:223], v[24:27], v[80:83]
    ds_read_b128 v[40:43], v5 offset:10240
    s_waitcnt lgkmcnt(3)
    v_add_f32 v72, v72, v32
    v_add_f32 v73, v73, v33
    s_add_u32 s6, s97, 10240
    v_mfma_f32_16x16x32_bf16 v[76:79], v[216:219], v[24:27], v[76:79]
    ds_read_b128 v[24:27], v4 offset:2048
    v_add_f32 v74, v74, v34
    v_add_f32 v75, v75, v35
    v_mfma_f32_16x16x32_bf16 v[76:79], v[236:239], v[28:31], v[76:79]
    buffer_store_dwordx4 v[56:59], v44, s[8:11], s6 offen sc1
    s_waitcnt lgkmcnt(2)
    v_add_f32 v72, v72, v36
    v_add_f32 v73, v73, v37
    v_mfma_f32_16x16x32_bf16 v[80:83], v[240:243], v[28:31], v[80:83]
    v_add_f32 v74, v74, v38
    v_add_f32 v75, v75, v39
    v_mfma_f32_16x16x32_bf16 v[84:87], v[244:247], v[28:31], v[84:87]
    s_waitcnt lgkmcnt(1)
    v_add_f32 v72, v72, v40
    v_add_f32 v73, v73, v41
    v_mfma_f32_16x16x32_bf16 v[88:91], v[248:251], v[28:31], v[88:91]
    v_add_f32 v74, v74, v42
    v_add_f32 v75, v75, v43
    s_cmp_lg_u32 s71, 0
    v_mfma_f32_16x16x32_bf16 v[92:95], v[252:255], v[28:31], v[92:95]
    s_cbranch_scc1 L_nost_59
    buffer_store_dwordx4 v[72:75], v52, s[8:11], s6 offen sc1
L_nost_59:
    ds_read_b128 v[28:31], v4 offset:3072
    v_mfma_f32_16x16x32_bf16 v[56:59], v[96:99], v[16:19], 0
    s_sub_u32 s6, s71, 6
    s_and_b32 s6, s6, 3
    s_mul_i32 s7, s6, 5120
    v_mfma_f32_16x16x32_bf16 v[60:63], v[100:103], v[16:19], 0
    s_add_u32 s7, s7, s67
    s_cmp_eq_u32 s6, 3
    s_cselect_b32 s7, 124928, s7
    v_mfma_f32_16x16x32_bf16 v[64:67], v[104:107], v[16:19], 0
    v_add_u32 v12, s7, v52
    v_add_u32 v5, s67, v45
    v_mfma_f32_16x16x32_bf16 v[68:71], v[108:111], v[16:19], 0
    v_mfma_f32_16x16x32_bf16 v[72:75], v[112:115], v[16:19], 0
    ds_read_b128 v[16:19], v4 offset:4096
    v_mfma_f32_16x16x32_bf16 v[56:59], v[116:119], v[20:23], v[56:59]
    ds_write_b128 v5, v[80:83] offset:30720
    v_add_u32 v5, s67, v46
    v_mfma_f32_16x16x32_bf16 v[60:63], v[120:123], v[20:23], v[60:63]
    v_mfma_f32_16x16x32_bf16 v[64:67], v[124:127], v[20:23], v[64:67]
    v_mfma_f32_16x16x32_bf16 v[68:71], v[128:131], v[20:23], v[68:71]
    s_waitcnt lgkmcnt(3)
    v_mfma_f32_16x16x32_bf16 v[72:75], v[132:135], v[20:23], v[72:75]
    ds_read_b128 v[20:23], v4 offset:5120
    v_mfma_f32_16x16x32_bf16 v[72:75], v[152:155], v[24:27], v[72:75]
    ds_write_b128 v5, v[84:87] offset:35840
    v_add_u32 v5, s67, v47
    v_mfma_f32_16x16x32_bf16 v[68:71], v[148:151], v[24:27], v[68:71]
    v_mfma_f32_16x16x32_bf16 v[64:67], v[144:147], v[24:27], v[64:67]
    v_mfma_f32_16x16x32_bf16 v[60:63], v[140:143], v[24:27], v[60:63]
    s_waitcnt lgkmcnt(4)
    v_mfma_f32_16x16x32_bf16 v[56:59], v[136:139], v[24:27], v[56:59]
    ds_read_b128 v[24:27], v4 offset:6144
    v_mfma_f32_16x16x32_bf16 v[56:59], v[156:159], v[28:31], v[56:59]
    ds_write_b128 v5, v[88:91] offset:40960
    v_add_u32 v5, s67, v52
    v_mfma_f32_16x16x32_bf16 v[60:63], v[160:163], v[28:31], v[60:63]
    v_mfma_f32_16x16x32_bf16 v[64:67], v[164:167], v[28:31], v[64:67]
    v_mfma_f32_16x16x32_bf16 v[68:71], v[168:171], v[28:31], v[68:71]
    s_waitcnt lgkmcnt(5)
    v_mfma_f32_16x16x32_bf16 v[72:75], v[172:175], v[28:31], v[72:75]
    ds_read_b128 v[28:31], v4 offset:7168
    v_mfma_f32_16x16x32_bf16 v[72:75], v[192:195], v[16:19], v[72:75]
    ds_write_b128 v12, v[92:95] offset:30720
    v_mfma_f32_16x16x32_bf16 v[68:71], v[188:191], v[16:19], v[68:71]
    v_mfma_f32_16x16x32_bf16 v[64:67], v[184:187], v[16:19], v[64:67]
    v_mov_b32 v2, 1
    v_writelane_b32 v2, 2, 0
    v_mfma_f32_16x16x32_bf16 v[60:63], v[180:183], v[16:19], v[60:63]
    s_waitcnt lgkmcnt(5)
    v_mfma_f32_16x16x32_bf16 v[56:59], v[176:179], v[16:19], v[56:59]
    s_waitcnt vmcnt(1)
    buffer_store_dword v2, v11, s[8:11], 0 offen sc1
    s_waitcnt lgkmcnt(0)
    s_barrier
    ds_read_b128 v[32:35], v6 offset:30720
    ds_read_b128 v[36:39], v6 offset:35840
    ds_read_b128 v[40:43], v6 offset:40960
    ds_read_b128 v[16:19], v4 offset:32768
    v_mfma_f32_16x16x32_bf16 v[56:59], v[196:199], v[20:23], v[56:59]
    v_mfma_f32_16x16x32_bf16 v[60:63], v[200:203], v[20:23], v[60:63]
    v_mfma_f32_16x16x32_bf16 v[64:67], v[204:207], v[20:23], v[64:67]
    s_waitcnt lgkmcnt(3)
    v_add_f32 v76, v76, v32
    v_add_f32 v77, v77, v33
    v_mfma_f32_16x16x32_bf16 v[68:71], v[208:211], v[20:23], v[68:71]
    v_add_f32 v78, v78, v34
    v_add_f32 v79, v79, v35
    v_mfma_f32_16x16x32_bf16 v[72:75], v[212:215], v[20:23], v[72:75]
    s_waitcnt lgkmcnt(2)
    ds_read_b128 v[32:35], v5 offset:30720
    ds_read_b128 v[20:23], v4 offset:33792
    v_add_f32 v76, v76, v36
    v_add_f32 v77, v77, v37
    v_mfma_f32_16x16x32_bf16 v[72:75], v[232:235], v[24:27], v[72:75]
    v_add_f32 v78, v78, v38
    v_add_f32 v79, v79, v39
    v_mfma_f32_16x16x32_bf16 v[68:71], v[228:231], v[24:27], v[68:71]
    s_waitcnt lgkmcnt(3)
    ds_read_b128 v[36:39], v5 offset:35840
    v_add_f32 v76, v76, v40
    v_add_f32 v77, v77, v41
    v_mfma_f32_16x16x32_bf16 v[64:67], v[224:227], v[24:27], v[64:67]
    v_add_f32 v78, v78, v42
    v_add_f32 v79, v79, v43
    v_mfma_f32_16x16x32_bf16 v[60:63], v[220:223], v[24:27], v[60:63]
    ds_read_b128 v[40:43], v5 offset:40960
    s_waitcnt lgkmcnt(3)
    v_add_f32 v92, v92, v32
    v_add_f32 v93, v93, v33
    s_add_u32 s6, s98, 10240
    v_mfma_f32_16x16x32_bf16 v[56:59], v[216:219], v[24:27], v[56:59]
    ds_read_b128 v[24:27], v4 offset:34816
    v_add_f32 v94, v94, v34
    v_add_f32 v95, v95, v35
    v_mfma_f32_16x16x32_bf16 v[56:59], v[236:239], v[28:31], v[56:59]
    buffer_store_dwordx4 v[76:79], v44, s[8:11], s6 offen sc1
    s_waitcnt lgkmcnt(2)
    v_add_f32 v92, v92, v36
    v_add_f32 v93, v93, v37
    v_mfma_f32_16x16x32_bf16 v[60:63], v[240:243], v[28:31], v[60:63]
    v_add_f32 v94, v94, v38
    v_add_f32 v95, v95, v39
    v_mfma_f32_16x16x32_bf16 v[64:67], v[244:247], v[28:31], v[64:67]
    s_waitcnt lgkmcnt(1)
    v_add_f32 v92, v92, v40
    v_add_f32 v93, v93, v41
    v_mfma_f32_16x16x32_bf16 v[68:71], v[248:251], v[28:31], v[68:71]
    v_add_f32 v94, v94, v42
    v_add_f32 v95, v95, v43
    s_cmp_lg_u32 s71, 1
    v_mfma_f32_16x16x32_bf16 v[72:75], v[252:255], v[28:31], v[72:75]
    s_cbranch_scc1 L_nost_60
    buffer_store_dwordx4 v[92:95], v52, s[8:11], s6 offen sc1
L_nost_60:
    ds_read_b128 v[28:31], v4 offset:35840
    v_mfma_f32_16x16x32_bf16 v[76:79], v[96:99], v[16:19], 0
    v_mfma_f32_16x16x32_bf16 v[80:83], v[100:103], v[16:19], 0
    v_mfma_f32_16x16x32_bf16 v[84:87], v[104:107], v[16:19], 0
    s_mul_i32 s73, s3, 5120
    s_add_u32 s6, s73, 65536
    v_mfma_f32_16x16x32_bf16 v[88:91], v[108:111], v[16:19], 0
    v_add_u32 v5, s6, v44
    v_mfma_f32_16x16x32_bf16 v[92:95], v[112:115], v[16:19], 0
    ds_read_b128 v[16:19], v4 offset:36864
    v_mfma_f32_16x16x32_bf16 v[76:79], v[116:119], v[20:23], v[76:79]
    ds_write_b128 v5, v[56:59]
    s_add_u32 s6, s73, 65536
    v_add_u32 v5, s6, v45
    v_mfma_f32_16x16x32_bf16 v[80:83], v[120:123], v[20:23], v[80:83]
    v_mfma_f32_16x16x32_bf16 v[84:87], v[124:127], v[20:23], v[84:87]
    v_mfma_f32_16x16x32_bf16 v[88:91], v[128:131], v[20:23], v[88:91]
    s_waitcnt lgkmcnt(3)
    v_mfma_f32_16x16x32_bf16 v[92:95], v[132:135], v[20:23], v[92:95]
    ds_read_b128 v[20:23], v4 offset:37888
    v_mfma_f32_16x16x32_bf16 v[92:95], v[152:155], v[24:27], v[92:95]
    ds_write_b128 v5, v[60:63]
    s_add_u32 s6, s73, 65536
    v_add_u32 v5, s6, v46
    v_mfma_f32_16x16x32_bf16 v[88:91], v[148:151], v[24:27], v[88:91]
    v_mfma_f32_16x16x32_bf16 v[84:87], v[144:147], v[24:27], v[84:87]
    v_mov_b32 v2, 2
    s_waitcnt vmcnt(0)
    buffer_store_dword v2, v11, s[8:11], 0 offen sc1
    v_mfma_f32_16x16x32_bf16 v[80:83], v[140:143], v[24:27], v[80:83]
    s_waitcnt lgkmcnt(4)
    v_mfma_f32_16x16x32_bf16 v[76:79], v[136:139], v[24:27], v[76:79]
    ds_read_b128 v[24:27], v4 offset:38912
    s_cmp_eq_u32 s64, 0
    s_cbranch_scc1 L_nb
    v_bfe_u32 v2, v1, 1, 3
    v_and_b32 v3, 1, v1
    v_lshl_add_u32 v3, v2, 7, v3
    v_lshlrev_b32 v3, 2, v3
    s_and_b32 s6, s4, 3
    s_lshl_b32 s6, s6, 7
    s_add_u32 s6, s6, 3911680
    s_mov_b32 s79, 262144
L_poll_61:
    buffer_load_dword v2, v3, s[8:11], s6 offen sc1
    s_waitcnt vmcnt(0)
    v_cmp_ne_u32 vcc, 1, v2
    s_cbranch_vccz L_polldone_62
    s_sleep 2
    s_sub_u32 s79, s79, 1
    s_cmp_lg_u32 s79, 0
    s_cbranch_scc1 L_poll_61
L_polldone_62:
L_nb:
    buffer_load_dwordx4 v[96:99], v53, s[12:15], s70 offen
    buffer_load_dwordx4 v[100:103], v48, s[8:11], 0 offen sc1
    s_cmp_ge_u32 s3, 2
    s_cbranch_scc1 L_itskip_63
    buffer_load_dwordx4 v[104:107], v54, s[12:15], s70 offen
    buffer_load_dwordx4 v[108:111], v49, s[8:11], 0 offen sc1
L_itskip_63:
    v_mfma_f32_16x16x32_bf16 v[76:79], v[156:159], v[28:31], v[76:79]
    ds_write_b128 v5, v[64:67]
    s_add_u32 s6, s73, 65536
    v_add_u32 v5, s6, v47
    v_mfma_f32_16x16x32_bf16 v[80:83], v[160:163], v[28:31], v[80:83]
    v_mfma_f32_16x16x32_bf16 v[84:87], v[164:167], v[28:31], v[84:87]
    v_mfma_f32_16x16x32_bf16 v[88:91], v[168:171], v[28:31], v[88:91]
    s_waitcnt lgkmcnt(5)
    v_mfma_f32_16x16x32_bf16 v[92:95], v[172:175], v[28:31], v[92:95]
    ds_read_b128 v[28:31], v4 offset:39936
    v_mfma_f32_16x16x32_bf16 v[92:95], v[192:195], v[16:19], v[92:95]
    ds_write_b128 v5, v[68:71]
    s_add_u32 s6, s73, 65536
    v_add_u32 v5, s6, v52
    v_mfma_f32_16x16x32_bf16 v[88:91], v[188:191], v[16:19], v[88:91]
    v_bfe_u32 v2, v1, 3, 2
    v_min_u32 v2, 2, v2
    v_and_b32 v3, 7, v1
    v_lshlrev_b32 v3, 2, v3
    v_lshl_add_u32 v3, v2, 7, v3
    v_mfma_f32_16x16x32_bf16 v[84:87], v[184:187], v[16:19], v[84:87]
    s_bitcmp1_b32 13, s3
    s_cselect_b32 s77, 1, 2
    buffer_load_dword v50, v3, s[8:11], s63 offen sc1
    v_mfma_f32_16x16x32_bf16 v[80:83], v[180:183], v[16:19], v[80:83]
    s_waitcnt lgkmcnt(5)
    v_mfma_f32_16x16x32_bf16 v[76:79], v[176:179], v[16:19], v[76:79]
    v_mfma_f32_16x16x32_bf16 v[76:79], v[196:199], v[20:23], v[76:79]
    ds_write_b128 v5, v[72:75]
    v_mfma_f32_16x16x32_bf16 v[80:83], v[200:203], v[20:23], v[80:83]
    v_mfma_f32_16x16x32_bf16 v[84:87], v[204:207], v[20:23], v[84:87]
    v_mfma_f32_16x16x32_bf16 v[88:91], v[208:211], v[20:23], v[88:91]
    s_waitcnt lgkmcnt(4)
    v_mfma_f32_16x16x32_bf16 v[92:95], v[212:215], v[20:23], v[92:95]
    v_mfma_f32_16x16x32_bf16 v[92:95], v[232:235], v[24:27], v[92:95]
    v_mfma_f32_16x16x32_bf16 v[88:91], v[228:231], v[24:27], v[88:91]
    v_mfma_f32_16x16x32_bf16 v[84:87], v[224:227], v[24:27], v[84:87]
    v_mfma_f32_16x16x32_bf16 v[80:83], v[220:223], v[24:27], v[80:83]
    s_waitcnt lgkmcnt(2)
    s_add_u32 s6, s73, 86016
    s_cmp_lt_u32 s3, 4
    s_cselect_b32 s73, s73, s6
    v_mfma_f32_16x16x32_bf16 v[76:79], v[216:219], v[24:27], v[76:79]
    s_waitcnt vmcnt(0)
    v_cmp_gt_u32 vcc, s77, v50
    s_mov_b32 s91, 0
    s_cbranch_vccnz L_x1n
    s_add_u32 s6, s62, 0
    buffer_load_dwordx4 v[112:115], v8, s[8:11], s6 offen offset:0 sc1
    buffer_load_dwordx4 v[116:119], v8, s[8:11], s6 offen offset:256 sc1
    s_add_u32 s6, s62, 20480
    buffer_load_dwordx4 v[120:123], v8, s[8:11], s6 offen offset:0 sc1
    buffer_load_dwordx4 v[124:127], v8, s[8:11], s6 offen offset:256 sc1
    s_add_u32 s6, s62, 40960
    buffer_load_dwordx4 v[128:131], v8, s[8:11], s6 offen offset:0 sc1
    buffer_load_dwordx4 v[132:135], v8, s[8:11], s6 offen offset:256 sc1
    s_cmp_ge_u32 s3, 2
    s_cbranch_scc1 L_xi_64
    s_add_u32 s6, s62, 0
    buffer_load_dwordx4 v[136:139], v9, s[8:11], s6 offen offset:0 sc1
    buffer_load_dwordx4 v[140:143], v9, s[8:11], s6 offen offset:256 sc1
    s_add_u32 s6, s62, 20480
    buffer_load_dwordx4 v[144:147], v9, s[8:11], s6 offen offset:0 sc1
    buffer_load_dwordx4 v[148:151], v9, s[8:11], s6 offen offset:256 sc1
    s_add_u32 s6, s62, 40960
    buffer_load_dwordx4 v[152:155], v9, s[8:11], s6 offen offset:0 sc1
    buffer_load_dwordx4 v[156:159], v9, s[8:11], s6 offen offset:256 sc1
L_xi_64:
    s_mov_b32 s91, 1
    s_branch L_x1j
L_x1n:
    buffer_load_dword v50, v3, s[8:11], s63 offen sc1
L_x1j:
    v_mfma_f32_16x16x32_bf16 v[76:79], v[236:239], v[28:31], v[76:79]
    v_mfma_f32_16x16x32_bf16 v[80:83], v[240:243], v[28:31], v[80:83]
    v_mfma_f32_16x16x32_bf16 v[84:87], v[244:247], v[28:31], v[84:87]
    v_mfma_f32_16x16x32_bf16 v[88:91], v[248:251], v[28:31], v[88:91]
    v_mfma_f32_16x16x32_bf16 v[92:95], v[252:255], v[28:31], v[92:95]
    s_nop 4
    v_add_u32 v5, s73, v44
    ds_write_b128 v5, v[76:79]
    v_add_u32 v5, s73, v45
    ds_write_b128 v5, v[80:83]
    v_add_u32 v5, s73, v46
    ds_write_b128 v5, v[84:87]
    v_add_u32 v5, s73, v47
    ds_write_b128 v5, v[88:91]
    v_add_u32 v5, s73, v52
    ds_write_b128 v5, v[92:95]
    s_mov_b64 s[78:79], 0
    s_cmp_lg_u32 s91, 0
    s_cbranch_scc1 L_x2a
    s_waitcnt vmcnt(0)
    v_cmp_gt_u32 s[78:79], s77, v50
    s_nop 3
    s_cmp_lg_u64 s[78:79], 0
    s_cbranch_scc1 L_x2a
    s_add_u32 s6, s62, 0
    buffer_load_dwordx4 v[112:115], v8, s[8:11], s6 offen offset:0 sc1
    buffer_load_dwordx4 v[116:119], v8, s[8:11], s6 offen offset:256 sc1
    s_add_u32 s6, s62, 20480
    buffer_load_dwordx4 v[120:123], v8, s[8:11], s6 offen offset:0 sc1
    buffer_load_dwordx4 v[124:127], v8, s[8:11], s6 offen offset:256 sc1
    s_add_u32 s6, s62, 40960
    buffer_load_dwordx4 v[128:131], v8, s[8:11], s6 offen offset:0 sc1
    buffer_load_dwordx4 v[132:135], v8, s[8:11], s6 offen offset:256 sc1
    s_cmp_ge_u32 s3, 2
    s_cbranch_scc1 L_xi_65
    s_add_u32 s6, s62, 0
    buffer_load_dwordx4 v[136:139], v9, s[8:11], s6 offen offset:0 sc1
    buffer_load_dwordx4 v[140:143], v9, s[8:11], s6 offen offset:256 sc1
    s_add_u32 s6, s62, 20480
    buffer_load_dwordx4 v[144:147], v9, s[8:11], s6 offen offset:0 sc1
    buffer_load_dwordx4 v[148:151], v9, s[8:11], s6 offen offset:256 sc1
    s_add_u32 s6, s62, 40960
    buffer_load_dwordx4 v[152:155], v9, s[8:11], s6 offen offset:0 sc1
    buffer_load_dwordx4 v[156:159], v9, s[8:11], s6 offen offset:256 sc1
L_xi_65:
L_x2a:
    s_waitcnt lgkmcnt(0)
    s_barrier
    ds_read_b128 v[160:163], v10 offset:0
    ds_read_b128 v[164:167], v10 offset:256
    ds_read_b128 v[168:171], v10 offset:5120
    ds_read_b128 v[172:175], v10 offset:5376
    ds_read_b128 v[176:179], v10 offset:10240
    ds_read_b128 v[180:183], v10 offset:10496
    ds_read_b128 v[184:187], v10 offset:15360
    ds_read_b128 v[188:191], v10 offset:15616
    ds_read_b128 v[192:195], v55 offset:0
    ds_read_b128 v[196:199], v55 offset:256
    ds_read_b128 v[200:203], v55 offset:5120
    ds_read_b128 v[204:207], v55 offset:5376
    ds_read_b128 v[208:211], v55 offset:10240
    ds_read_b128 v[212:215], v55 offset:10496
    ds_read_b128 v[216:219], v55 offset:15360
    ds_read_b128 v[220:223], v55 offset:15616
    s_cmp_eq_u64 s[78:79], 0
    s_cbranch_scc1 L_x2b
    s_mov_b32 s79, 262144
L_poll_66:
    buffer_load_dword v2, v3, s[8:11], s63 offen sc1
    s_waitcnt vmcnt(0)
    v_cmp_gt_u32 vcc, s77, v2
    s_cbranch_vccz L_polldone_67
    s_sleep 1
    s_sub_u32 s79, s79, 1
    s_cmp_lg_u32 s79, 0
    s_cbranch_scc1 L_poll_66
L_polldone_67:
    s_add_u32 s6, s62, 0
    buffer_load_dwordx4 v[112:115], v8, s[8:11], s6 offen offset:0 sc1
    buffer_load_dwordx4 v[116:119], v8, s[8:11], s6 offen offset:256 sc1
    s_add_u32 s6, s62, 20480
    buffer_load_dwordx4 v[120:123], v8, s[8:11], s6 offen offset:0 sc1
    buffer_load_dwordx4 v[124:127], v8, s[8:11], s6 offen offset:256 sc1
    s_add_u32 s6, s62, 40960
    buffer_load_dwordx4 v[128:131], v8, s[8:11], s6 offen offset:0 sc1
    buffer_load_dwordx4 v[132:135], v8, s[8:11], s6 offen offset:256 sc1
    s_cmp_ge_u32 s3, 2
    s_cbranch_scc1 L_xi_68
    s_add_u32 s6, s62, 0
    buffer_load_dwordx4 v[136:139], v9, s[8:11], s6 offen offset:0 sc1
    buffer_load_dwordx4 v[140:143], v9, s[8:11], s6 offen offset:256 sc1
    s_add_u32 s6, s62, 20480
    buffer_load_dwordx4 v[144:147], v9, s[8:11], s6 offen offset:0 sc1
    buffer_load_dwordx4 v[148:151], v9, s[8:11], s6 offen offset:256 sc1
    s_add_u32 s6, s62, 40960
    buffer_load_dwordx4 v[152:155], v9, s[8:11], s6 offen offset:0 sc1
    buffer_load_dwordx4 v[156:159], v9, s[8:11], s6 offen offset:256 sc1
L_xi_68:
L_x2b:
    s_mov_b32 s16, s54
    s_mov_b32 s17, s55
    s_mov_b32 s18, 0x280000
    s_mov_b32 s19, 0x20000
    s_waitcnt lgkmcnt(8)
    v_pk_add_f32 v[160:161], v[160:161], v[168:169]
    v_pk_add_f32 v[162:163], v[162:163], v[170:171]
    v_pk_add_f32 v[164:165], v[164:165], v[172:173]
    v_pk_add_f32 v[166:167], v[166:167], v[174:175]
    v_pk_add_f32 v[160:161], v[160:161], v[176:177]
    v_pk_add_f32 v[162:163], v[162:163], v[178:179]
    v_pk_add_f32 v[164:165], v[164:165], v[180:181]
    v_pk_add_f32 v[166:167], v[166:167], v[182:183]
    v_pk_add_f32 v[160:161], v[160:161], v[184:185]
    v_pk_add_f32 v[162:163], v[162:163], v[186:187]
    v_pk_add_f32 v[164:165], v[164:165], v[188:189]
    v_pk_add_f32 v[166:167], v[166:167], v[190:191]
    s_waitcnt vmcnt(0)
    v_pk_add_f32 v[160:161], v[160:161], v[112:113]
    v_pk_add_f32 v[162:163], v[162:163], v[114:115]
    v_pk_add_f32 v[164:165], v[164:165], v[116:117]
    v_pk_add_f32 v[166:167], v[166:167], v[118:119]
    v_pk_add_f32 v[160:161], v[160:161], v[120:121]
    v_pk_add_f32 v[162:163], v[162:163], v[122:123]
    v_pk_add_f32 v[164:165], v[164:165], v[124:125]
    v_pk_add_f32 v[166:167], v[166:167], v[126:127]
    v_pk_add_f32 v[160:161], v[160:161], v[128:129]
    v_pk_add_f32 v[162:163], v[162:163], v[130:131]
    v_pk_add_f32 v[164:165], v[164:165], v[132:133]
    v_pk_add_f32 v[166:167], v[166:167], v[134:135]
    v_cvt_pk_bf16_f32 v2, v160, v161
    v_lshlrev_b32 v160, 16, v2
    v_and_b32 v161, 0xffff0000, v2
    v_lshlrev_b32 v2, 16, v96
    v_and_b32 v3, 0xffff0000, v96
    v_pk_add_f32 v[160:161], v[160:161], v[2:3]
    v_cvt_pk_bf16_f32 v2, v160, v161
    v_lshlrev_b32 v160, 16, v2
    v_and_b32 v161, 0xffff0000, v2
    v_lshlrev_b32 v2, 16, v100
    v_and_b32 v3, 0xffff0000, v100
    v_pk_add_f32 v[160:161], v[160:161], v[2:3]
    v_cvt_pk_bf16_f32 v224, v160, v161
    v_cvt_pk_bf16_f32 v2, v162, v163
    v_lshlrev_b32 v162, 16, v2
    v_and_b32 v163, 0xffff0000, v2
    v_lshlrev_b32 v2, 16, v97
    v_and_b32 v3, 0xffff0000, v97
    v_pk_add_f32 v[162:163], v[162:163], v[2:3]
    v_cvt_pk_bf16_f32 v2, v162, v163
    v_lshlrev_b32 v162, 16, v2
    v_and_b32 v163, 0xffff0000, v2
    v_lshlrev_b32 v2, 16, v101
    v_and_b32 v3, 0xffff0000, v101
    v_pk_add_f32 v[162:163], v[162:163], v[2:3]
    v_cvt_pk_bf16_f32 v225, v162, v163
    v_cvt_pk_bf16_f32 v2, v164, v165
    v_lshlrev_b32 v164, 16, v2
    v_and_b32 v165, 0xffff0000, v2
    v_lshlrev_b32 v2, 16, v98
    v_and_b32 v3, 0xffff0000, v98
    v_pk_add_f32 v[164:165], v[164:165], v[2:3]
    v_cvt_pk_bf16_f32 v2, v164, v165
    v_lshlrev_b32 v164, 16, v2
    v_and_b32 v165, 0xffff0000, v2
    v_lshlrev_b32 v2, 16, v102
    v_and_b32 v3, 0xffff0000, v102
    v_pk_add_f32 v[164:165], v[164:165], v[2:3]
    v_cvt_pk_bf16_f32 v226, v164, v165
    v_cvt_pk_bf16_f32 v2, v166, v167
    v_lshlrev_b32 v166, 16, v2
    v_and_b32 v167, 0xffff0000, v2
    v_lshlrev_b32 v2, 16, v99
    v_and_b32 v3, 0xffff0000, v99
    v_pk_add_f32 v[166:167], v[166:167], v[2:3]
    v_cvt_pk_bf16_f32 v2, v166, v167
    v_lshlrev_b32 v166, 16, v2
    v_and_b32 v167, 0xffff0000, v2
    v_lshlrev_b32 v2, 16, v103
    v_and_b32 v3, 0xffff0000, v103
    v_pk_add_f32 v[166:167], v[166:167], v[2:3]
    v_cvt_pk_bf16_f32 v227, v166, v167
    buffer_store_dwordx4 v[224:227], v53, s[16:19], s70 offen
    s_cmp_ge_u32 s3, 2
    s_cbranch_scc1 L_end
    s_waitcnt lgkmcnt(0)
    v_pk_add_f32 v[192:193], v[192:193], v[200:201]
    v_pk_add_f32 v[194:195], v[194:195], v[202:203]
    v_pk_add_f32 v[196:197], v[196:197], v[204:205]
    v_pk_add_f32 v[198:199], v[198:199], v[206:207]
    v_pk_add_f32 v[192:193], v[192:193], v[208:209]
    v_pk_add_f32 v[194:195], v[194:195], v[210:211]
    v_pk_add_f32 v[196:197], v[196:197], v[212:213]
    v_pk_add_f32 v[198:199], v[198:199], v[214:215]
    v_pk_add_f32 v[192:193], v[192:193], v[216:217]
    v_pk_add_f32 v[194:195], v[194:195], v[218:219]
    v_pk_add_f32 v[196:197], v[196:197], v[220:221]
    v_pk_add_f32 v[198:199], v[198:199], v[222:223]
    s_nop 0
    v_pk_add_f32 v[192:193], v[192:193], v[136:137]
    v_pk_add_f32 v[194:195], v[194:195], v[138:139]
    v_pk_add_f32 v[196:197], v[196:197], v[140:141]
    v_pk_add_f32 v[198:199], v[198:199], v[142:143]
    v_pk_add_f32 v[192:193], v[192:193], v[144:145]
    v_pk_add_f32 v[194:195], v[194:195], v[146:147]
    v_pk_add_f32 v[196:197], v[196:197], v[148:149]
    v_pk_add_f32 v[198:199], v[198:199], v[150:151]
    v_pk_add_f32 v[192:193], v[192:193], v[152:153]
    v_pk_add_f32 v[194:195], v[194:195], v[154:155]
    v_pk_add_f32 v[196:197], v[196:197], v[156:157]
    v_pk_add_f32 v[198:199], v[198:199], v[158:159]
    v_cvt_pk_bf16_f32 v2, v192, v193
    v_lshlrev_b32 v192, 16, v2
    v_and_b32 v193, 0xffff0000, v2
    v_lshlrev_b32 v2, 16, v104
    v_and_b32 v3, 0xffff0000, v104
    v_pk_add_f32 v[192:193], v[192:193], v[2:3]
    v_cvt_pk_bf16_f32 v2, v192, v193
    v_lshlrev_b32 v192, 16, v2
    v_and_b32 v193, 0xffff0000, v2
    v_lshlrev_b32 v2, 16, v108
    v_and_b32 v3, 0xffff0000, v108
    v_pk_add_f32 v[192:193], v[192:193], v[2:3]
    v_cvt_pk_bf16_f32 v228, v192, v193
    v_cvt_pk_bf16_f32 v2, v194, v195
    v_lshlrev_b32 v194, 16, v2
    v_and_b32 v195, 0xffff0000, v2
    v_lshlrev_b32 v2, 16, v105
    v_and_b32 v3, 0xffff0000, v105
    v_pk_add_f32 v[194:195], v[194:195], v[2:3]
    v_cvt_pk_bf16_f32 v2, v194, v195
    v_lshlrev_b32 v194, 16, v2
    v_and_b32 v195, 0xffff0000, v2
    v_lshlrev_b32 v2, 16, v109
    v_and_b32 v3, 0xffff0000, v109
    v_pk_add_f32 v[194:195], v[194:195], v[2:3]
    v_cvt_pk_bf16_f32 v229, v194, v195
    v_cvt_pk_bf16_f32 v2, v196, v197
    v_lshlrev_b32 v196, 16, v2
    v_and_b32 v197, 0xffff0000, v2
    v_lshlrev_b32 v2, 16, v106
    v_and_b32 v3, 0xffff0000, v106
    v_pk_add_f32 v[196:197], v[196:197], v[2:3]
    v_cvt_pk_bf16_f32 v2, v196, v197
    v_lshlrev_b32 v196, 16, v2
    v_and_b32 v197, 0xffff0000, v2
    v_lshlrev_b32 v2, 16, v110
    v_and_b32 v3, 0xffff0000, v110
    v_pk_add_f32 v[196:197], v[196:197], v[2:3]
    v_cvt_pk_bf16_f32 v230, v196, v197
    v_cvt_pk_bf16_f32 v2, v198, v199
    v_lshlrev_b32 v198, 16, v2
    v_and_b32 v199, 0xffff0000, v2
    v_lshlrev_b32 v2, 16, v107
    v_and_b32 v3, 0xffff0000, v107
    v_pk_add_f32 v[198:199], v[198:199], v[2:3]
    v_cvt_pk_bf16_f32 v2, v198, v199
    v_lshlrev_b32 v198, 16, v2
    v_and_b32 v199, 0xffff0000, v2
    v_lshlrev_b32 v2, 16, v111
    v_and_b32 v3, 0xffff0000, v111
    v_pk_add_f32 v[198:199], v[198:199], v[2:3]
    v_cvt_pk_bf16_f32 v231, v198, v199
    buffer_store_dwordx4 v[228:231], v54, s[16:19], s70 offen
L_end:
L_exit:
    s_endpgm
.section .rodata,"a"
.p2align 6
.amdhsa_kernel parallel_sum__compressed_kv_cla__moe_arch_mod__prompt_kernel
  .amdhsa_next_free_vgpr 256
  .amdhsa_next_free_sgpr 102
  .amdhsa_accum_offset 256
  .amdhsa_group_segment_fixed_size 0
  .amdhsa_kernarg_size 112
  .amdhsa_user_sgpr_count 2
  .amdhsa_user_sgpr_kernarg_segment_ptr 1
  .amdhsa_system_sgpr_workgroup_id_x 1
  .amdhsa_float_denorm_mode_32 3
.end_amdhsa_kernel
```

```asm
; @launch grid=(256,1,1) block=(512,1,1) lds=163840
.amdgcn_target "amdgcn-amd-amdhsa--gfx950"
.text
.globl parallel_sum__compressed_kv_cla__moe_arch_mod__prompt_kernel
.p2align 8
.type parallel_sum__compressed_kv_cla__moe_arch_mod__prompt_kernel,@function
parallel_sum__compressed_kv_cla__moe_arch_mod__prompt_kernel:
    s_cmp_ge_u32 s2, 256
    s_cbranch_scc1 L_exit
    s_load_dwordx16 s[32:47], s[0:1], 0
    s_load_dwordx8 s[48:55], s[0:1], 64
    s_load_dwordx4 s[56:59], s[0:1], 96
    v_lshrrev_b32 v2, 6, v0
    v_and_b32 v1, 63, v0
    v_readfirstlane_b32 s3, v2
    s_getpc_b64 s[80:81]
L_pc:
    s_lshr_b32 s6, s2, 3
    s_and_b32 s6, s6, 15
    s_lshl_b32 s6, s6, 12
    s_cmp_lt_u32 s3, 2
    s_cselect_b32 s6, 0, s6
    v_lshl_add_u32 v3, v0, 6, s6
    v_min_u32 v3, L_exit-L_pc, v3
    s_cmp_ge_u32 s3, 3
    s_cbranch_scc1 L_noct
    global_load_dword v11, v3, s[80:81]
L_noct:
    v_lshrrev_b32 v62, 5, v0
    v_and_b32 v62, 7, v62
    v_and_b32 v2, 31, v0
    v_lshlrev_b32 v2, 3, v2
    v_mul_u32_u24 v63, 1280, v62
    v_add_u32 v63, v63, v2
    s_mul_i32 s6, s2, 10240
    v_add_u32 v10, s6, v63
    s_cmp_lt_u32 s3, 4
    s_cbranch_scc1 L_st_k0
    s_waitcnt lgkmcnt(0)
    global_load_dwordx2 v[16:17], v10, s[32:33] offset:0
    global_load_dwordx2 v[18:19], v10, s[32:33] offset:256
    global_load_dwordx2 v[20:21], v10, s[32:33] offset:512
    global_load_dwordx2 v[22:23], v10, s[32:33] offset:768
    global_load_dwordx2 v[24:25], v10, s[32:33] offset:1024
    global_load_dwordx2 v[26:27], v2, s[46:47] offset:0
    global_load_dwordx2 v[28:29], v2, s[46:47] offset:256
    global_load_dwordx2 v[30:31], v2, s[46:47] offset:512
    global_load_dwordx2 v[32:33], v2, s[46:47] offset:768
    global_load_dwordx2 v[34:35], v2, s[46:47] offset:1024
    s_bfe_u32 s6, s2, 0x20003
    s_lshl_b32 s6, s6, 9
    s_bfe_u32 s7, s3, 0x10001
    s_lshl_b32 s7, s7, 8
    s_add_u32 s6, s6, s7
    s_andn2_b32 s7, s2, 31
    s_add_u32 s6, s6, s7
    s_and_b32 s72, s3, 1
    s_lshl_b32 s7, s72, 4
    s_add_u32 s6, s6, s7
    v_lshrrev_b32 v4, 3, v1
    v_add_u32 v4, s6, v4
    v_and_b32 v5, 7, v1
    v_lshlrev_b32 v5, 4, v5
    v_lshl_add_u32 v4, v4, 10, v5
    v_add_u32 v5, 8192, v4
    s_lshr_b32 s6, s2, 5
    s_lshl_b32 s6, s6, 1
    s_add_u32 s6, s6, s72
    s_lshl_b32 s6, s6, 15
    s_and_b32 s7, s2, 7
    s_lshl_b32 s7, s7, 10
    s_add_u32 s6, s6, s7
    s_bfe_u32 s7, s2, 0x20003
    s_lshl_b32 s7, s7, 8
    s_add_u32 s6, s6, s7
    v_lshrrev_b32 v6, 4, v1
    v_and_b32 v7, 15, v1
    v_lshlrev_b32 v7, 4, v7
    v_lshl_add_u32 v6, v6, 13, v7
    v_add_u32 v6, s6, v6
    s_cmp_ge_u32 s3, 6
    s_cselect_b32 s74, s40, s38
    s_cselect_b32 s75, s41, s39
    global_load_dwordx4 v[36:39], v4, s[34:35] offset:0
    global_load_dwordx4 v[36:39], v5, s[34:35] offset:0
    global_load_dwordx4 v[36:39], v6, s[74:75] nt
    v_add_u32 v6, 524288, v6
    global_load_dwordx4 v[36:39], v4, s[34:35] offset:128
    global_load_dwordx4 v[36:39], v5, s[34:35] offset:128
    global_load_dwordx4 v[36:39], v6, s[74:75] nt
    v_add_u32 v6, 524288, v6
    s_barrier
L_st_k0:
    s_and_b32 s6, s2, 7
    s_lshl_b32 s6, s6, 2
    s_lshr_b32 s7, s2, 3
    s_and_b32 s7, s7, 3
    s_add_u32 s4, s6, s7
    s_lshr_b32 s5, s2, 5
    s_and_b32 s76, s3, 3
    v_lshrrev_b32 v2, 3, v1
    v_and_b32 v3, 7, v1
    v_lshrrev_b32 v4, 4, v1
    v_xor_b32 v5, v3, v4
    v_lshlrev_b32 v5, 4, v5
    v_lshl_add_u32 v40, v2, 10, v5
    v_xor_b32 v5, 64, v40
    v_add_u32 v41, 7168, v5
    v_add_u32 v42, 14336, v40
    v_add_u32 v43, 14336, v41
    v_and_b32 v6, 15, v1
    s_lshl_b32 s6, s76, 4
    v_add_u32 v7, s6, v4
    v_lshlrev_b32 v5, 1, v4
    v_xor_b32 v5, v6, v5
    v_lshlrev_b32 v5, 4, v5
    v_lshl_add_u32 v44, v7, 13, v5
    v_add_u32 v45, 31744, v44
    v_xor_b32 v5, 0x80, v44
    v_add_u32 v46, 63488, v5
    v_add_u32 v47, 31744, v46
    s_and_b32 s6, s76, 1
    s_lshl_b32 s6, s6, 20
    s_lshr_b32 s7, s76, 1
    s_lshl_b32 s7, s7, 18
    s_add_u32 s6, s6, s7
    s_lshl_b32 s62, s5, 15
    s_add_u32 s62, s62, s6
    s_lshl_b32 s63, s4, 8
    s_lshl_b32 s64, s76, 13
    s_lshl_b32 s73, s76, 12
    s_add_u32 s73, s73, 32768
    s_andn2_b32 s100, 1, s5
    s_lshl_b32 s100, s100, 16
    s_add_u32 s64, s64, s100
    s_add_u32 s73, s73, s100
    s_waitcnt lgkmcnt(0)
    s_mov_b32 s12, s34
    s_mov_b32 s13, s35
    s_mov_b32 s14, 0x200000
    s_mov_b32 s15, 0x20000
    s_mov_b32 s16, s38
    s_mov_b32 s17, s39
    s_mov_b32 s18, 0x400000
    s_mov_b32 s19, 0x20000
    s_mov_b32 s20, s40
    s_mov_b32 s21, s41
    s_mov_b32 s22, 0x400000
    s_mov_b32 s23, 0x20000
    s_cmp_ge_u32 s3, 4
    s_cbranch_scc1 L_st_v0
    s_barrier
    s_mov_b32 m0, s64
    s_add_u32 s72, s62, 524288
    buffer_load_dwordx4 v40, s[12:15], s62 offen offset:0 lds
    buffer_load_dwordx4 v41, s[12:15], s62 offen offset:1024 lds
    buffer_load_dwordx4 v42, s[12:15], s62 offen offset:2048 lds
    buffer_load_dwordx4 v43, s[12:15], s62 offen offset:3072 lds
    s_add_u32 m0, s64, 4096
    s_add_u32 s62, s62, 128
    s_bitset0_b32 s62, 10
    buffer_load_dwordx4 v40, s[12:15], s72 offen offset:0 lds
    buffer_load_dwordx4 v41, s[12:15], s72 offen offset:1024 lds
    buffer_load_dwordx4 v42, s[12:15], s72 offen offset:2048 lds
    buffer_load_dwordx4 v43, s[12:15], s72 offen offset:3072 lds
    s_mov_b32 m0, s73
    s_xor_b32 s64, s64, 0x10000
    buffer_load_dwordx4 v44, s[16:19], s63 offen offset:0 nt lds
    buffer_load_dwordx4 v45, s[16:19], s63 offen offset:1024 nt lds
    buffer_load_dwordx4 v46, s[16:19], s63 offen offset:2048 nt lds
    buffer_load_dwordx4 v47, s[16:19], s63 offen offset:3072 nt lds
    s_add_u32 m0, s73, 16384
    s_xor_b32 s73, s73, 0x10000
    buffer_load_dwordx4 v44, s[20:23], s63 offen offset:0 nt lds
    buffer_load_dwordx4 v45, s[20:23], s63 offen offset:1024 nt lds
    buffer_load_dwordx4 v46, s[20:23], s63 offen offset:2048 nt lds
    buffer_load_dwordx4 v47, s[20:23], s63 offen offset:3072 nt lds
    s_add_u32 s63, s63, 524288
    s_bitset0_b32 s63, 22
    s_setprio 1
L_st_v0:
    s_mov_b32 s8, s58
    s_mov_b32 s9, s59
    s_mov_b32 s10, 0x5000000
    s_mov_b32 s11, 0x20000
    s_mov_b32 s24, s36
    s_mov_b32 s25, s37
    s_mov_b32 s26, 0x500000
    s_mov_b32 s27, 0x20000
    v_lshlrev_b32 v13, 4, v1
    s_lshl_b32 s6, s5, 2
    s_add_u32 s7, s6, s3
    s_sub_u32 s6, 56, s6
    s_add_u32 s6, s6, s3
    s_cmp_lt_u32 s3, 4
    s_cselect_b32 s60, s7, s6
    s_sub_u32 s6, 1, s5
    s_and_b32 s6, s6, 7
    s_lshl_b32 s6, s6, 5
    s_add_u32 s61, s6, s4
    v_and_b32 v2, 15, v1
    v_lshrrev_b32 v3, 4, v1
    s_and_b32 s6, s3, 1
    s_lshl_b32 s6, s6, 7
    v_add_u32 v4, s6, v2
    v_lshlrev_b32 v4, 7, v4
    v_add_u32 v4, s100, v4
    v_lshrrev_b32 v5, 1, v2
    v_add_u32 v6, 0, v3
    v_xor_b32 v6, v6, v5
    v_lshl_add_u32 v48, v6, 4, v4
    v_add_u32 v6, 4, v3
    v_xor_b32 v6, v6, v5
    v_lshl_add_u32 v49, v6, 4, v4
    v_lshrrev_b32 v4, 2, v2
    v_lshl_add_u32 v5, v3, 3, v4
    v_lshlrev_b32 v5, 8, v5
    v_and_b32 v6, 1, v2
    v_lshl_add_u32 v5, v6, 3, v5
    v_and_b32 v6, 1, v3
    v_lshl_or_b32 v4, v6, 2, v4
    v_lshlrev_b32 v4, 1, v4
    v_bfe_u32 v6, v2, 1, 1
    v_add_u32 v8, 131072, v5
    v_add_u32 v7, 0, v6
    v_xor_b32 v7, v7, v4
    v_lshl_add_u32 v54, v7, 4, v8
    v_add_u32 v7, 2, v6
    v_xor_b32 v7, v7, v4
    v_lshl_add_u32 v55, v7, 4, v8
    v_add_u32 v7, 4, v6
    v_xor_b32 v7, v7, v4
    v_lshl_add_u32 v56, v7, 4, v8
    v_add_u32 v7, 6, v6
    v_xor_b32 v7, v7, v4
    v_lshl_add_u32 v57, v7, 4, v8
    v_add_u32 v7, 8, v6
    v_xor_b32 v7, v7, v4
    v_lshl_add_u32 v58, v7, 4, v8
    v_add_u32 v7, 10, v6
    v_xor_b32 v7, v7, v4
    v_lshl_add_u32 v59, v7, 4, v8
    v_add_u32 v7, 12, v6
    v_xor_b32 v7, v7, v4
    v_lshl_add_u32 v60, v7, 4, v8
    v_add_u32 v7, 14, v6
    v_xor_b32 v7, v7, v4
    v_lshl_add_u32 v61, v7, 4, v8
    s_lshr_b32 s6, s3, 2
    s_lshl_b32 s6, s6, 14
    s_add_u32 s6, s6, 32768
    s_add_u32 s6, s6, s100
    v_add_u32 v5, s6, v5
    s_lshr_b32 s7, s3, 1
    s_and_b32 s7, s7, 1
    s_lshl_b32 s7, s7, 3
    s_add_u32 s6, s7, 0
    v_add_u32 v7, s6, v6
    v_xor_b32 v7, v7, v4
    v_lshl_add_u32 v50, v7, 4, v5
    s_add_u32 s6, s7, 2
    v_add_u32 v7, s6, v6
    v_xor_b32 v7, v7, v4
    v_lshl_add_u32 v51, v7, 4, v5
    s_add_u32 s6, s7, 4
    v_add_u32 v7, s6, v6
    v_xor_b32 v7, v7, v4
    v_lshl_add_u32 v52, v7, 4, v5
    s_add_u32 s6, s7, 6
    v_add_u32 v7, s6, v6
    v_xor_b32 v7, v7, v4
    v_lshl_add_u32 v53, v7, 4, v5
    v_mov_b64 v[128:129], 0
    v_mov_b64 v[130:131], 0
    v_mov_b64 v[132:133], 0
    v_mov_b64 v[134:135], 0
    v_mov_b64 v[136:137], 0
    v_mov_b64 v[138:139], 0
    v_mov_b64 v[140:141], 0
    v_mov_b64 v[142:143], 0
    v_mov_b64 v[144:145], 0
    v_mov_b64 v[146:147], 0
    v_mov_b64 v[148:149], 0
    v_mov_b64 v[150:151], 0
    v_mov_b64 v[152:153], 0
    v_mov_b64 v[154:155], 0
    v_mov_b64 v[156:157], 0
    v_mov_b64 v[158:159], 0
    v_mov_b64 v[160:161], 0
    v_mov_b64 v[162:163], 0
    v_mov_b64 v[164:165], 0
    v_mov_b64 v[166:167], 0
    v_mov_b64 v[168:169], 0
    v_mov_b64 v[170:171], 0
    v_mov_b64 v[172:173], 0
    v_mov_b64 v[174:175], 0
    v_mov_b64 v[176:177], 0
    v_mov_b64 v[178:179], 0
    v_mov_b64 v[180:181], 0
    v_mov_b64 v[182:183], 0
    v_mov_b64 v[184:185], 0
    v_mov_b64 v[186:187], 0
    v_mov_b64 v[188:189], 0
    v_mov_b64 v[190:191], 0
    v_mov_b64 v[192:193], 0
    v_mov_b64 v[194:195], 0
    v_mov_b64 v[196:197], 0
    v_mov_b64 v[198:199], 0
    v_mov_b64 v[200:201], 0
    v_mov_b64 v[202:203], 0
    v_mov_b64 v[204:205], 0
    v_mov_b64 v[206:207], 0
    v_mov_b64 v[208:209], 0
    v_mov_b64 v[210:211], 0
    v_mov_b64 v[212:213], 0
    v_mov_b64 v[214:215], 0
    v_mov_b64 v[216:217], 0
    v_mov_b64 v[218:219], 0
    v_mov_b64 v[220:221], 0
    v_mov_b64 v[222:223], 0
    v_mov_b64 v[224:225], 0
    v_mov_b64 v[226:227], 0
    v_mov_b64 v[228:229], 0
    v_mov_b64 v[230:231], 0
    v_mov_b64 v[232:233], 0
    v_mov_b64 v[234:235], 0
    v_mov_b64 v[236:237], 0
    v_mov_b64 v[238:239], 0
    v_mov_b64 v[240:241], 0
    v_mov_b64 v[242:243], 0
    v_mov_b64 v[244:245], 0
    v_mov_b64 v[246:247], 0
    v_mov_b64 v[248:249], 0
    v_mov_b64 v[250:251], 0
    v_mov_b64 v[252:253], 0
    v_mov_b64 v[254:255], 0
    v_add_u32 v12, 20480, v13
    s_mul_i32 s70, s60, 40960
    s_mov_b32 s65, 0
    s_lshl_b32 s6, s4, 20
    s_lshl_b32 s7, s5, 13
    s_add_u32 s6, s6, s7
    s_and_b32 s7, s3, 1
    s_lshl_b32 s7, s7, 16
    s_add_u32 s6, s6, s7
    s_add_u32 s67, s6, 16777216
    s_and_b32 s6, s4, 3
    s_add_u32 s6, s6, s5
    s_sub_u32 s7, s6, 5
    s_cselect_b32 s6, s6, s7
    s_sub_u32 s7, s6, 5
    s_cselect_b32 s6, s6, s7
    s_lshl_b32 s71, s6, 20
    s_lshl_b32 s7, s4, 8
    s_add_u32 s71, s71, s7
    s_lshl_b32 s7, s6, 12
    s_add_u32 s84, s70, s7
    s_add_u32 s6, s6, 1
    s_cmp_eq_u32 s6, 5
    s_cselect_b32 s6, 0, s6
    s_lshl_b32 s7, s6, 12
    s_add_u32 s85, s70, s7
    s_add_u32 s6, s6, 1
    s_cmp_eq_u32 s6, 5
    s_cselect_b32 s6, 0, s6
    s_lshl_b32 s7, s6, 12
    s_add_u32 s86, s70, s7
    s_add_u32 s6, s6, 1
    s_cmp_eq_u32 s6, 5
    s_cselect_b32 s6, 0, s6
    s_lshl_b32 s7, s6, 12
    s_add_u32 s87, s70, s7
    s_add_u32 s6, s6, 1
    s_cmp_eq_u32 s6, 5
    s_cselect_b32 s6, 0, s6
    s_lshl_b32 s7, s6, 12
    s_add_u32 s88, s70, s7
    s_lshr_b32 s7, s3, 1
    s_and_b32 s7, s7, 1
    s_cmp_ge_u32 s3, 4
    s_cbranch_scc1 L_c_v
    s_lshl_b32 s7, s7, 11
    s_add_u32 s67, s67, s7
    s_movk_i32 s68, 3072
    s_mov_b32 s69, 125952
    s_add_u32 s71, s71, 1048576
    s_sub_u32 s75, s71, 5242880
    s_cselect_b32 s71, s71, s75
    s_lshl_b32 s74, s76, 12
    s_add_u32 s74, s74, s100
    s_branch L_c_j
L_c_v:
    s_lshl_b32 s7, s7, 12
    s_add_u32 s67, s67, s7
    s_add_u32 s67, s67, 0x80000
    s_movk_i32 s68, 1024
    s_mov_b32 s69, 128000
L_c_j:
    s_cmp_ge_u32 s3, 4
    s_cbranch_scc1 L_st_v1
    s_mov_b32 m0, s64
    s_add_u32 s72, s62, 524288
    buffer_load_dwordx4 v40, s[12:15], s62 offen offset:0 lds
    buffer_load_dwordx4 v41, s[12:15], s62 offen offset:1024 lds
    buffer_load_dwordx4 v42, s[12:15], s62 offen offset:2048 lds
    buffer_load_dwordx4 v43, s[12:15], s62 offen offset:3072 lds
    s_add_u32 m0, s64, 4096
    s_add_u32 s62, s62, 128
    s_bitset0_b32 s62, 10
    buffer_load_dwordx4 v40, s[12:15], s72 offen offset:0 lds
    buffer_load_dwordx4 v41, s[12:15], s72 offen offset:1024 lds
    buffer_load_dwordx4 v42, s[12:15], s72 offen offset:2048 lds
    buffer_load_dwordx4 v43, s[12:15], s72 offen offset:3072 lds
    s_waitcnt vmcnt(8)
    s_branch L_st_j1
L_st_v1:
    s_waitcnt vmcnt(6)
    v_lshlrev_b32 v64, 16, v16
    v_and_b32 v65, 0xffff0000, v16
    v_lshlrev_b32 v66, 16, v17
    v_and_b32 v67, 0xffff0000, v17
    v_lshlrev_b32 v68, 16, v18
    v_and_b32 v69, 0xffff0000, v18
    v_lshlrev_b32 v70, 16, v19
    v_and_b32 v71, 0xffff0000, v19
    v_lshlrev_b32 v72, 16, v20
    v_and_b32 v73, 0xffff0000, v20
    v_lshlrev_b32 v74, 16, v21
    v_and_b32 v75, 0xffff0000, v21
    v_lshlrev_b32 v76, 16, v22
    v_and_b32 v77, 0xffff0000, v22
    v_lshlrev_b32 v78, 16, v23
    v_and_b32 v79, 0xffff0000, v23
    v_lshlrev_b32 v80, 16, v24
    v_and_b32 v81, 0xffff0000, v24
    v_lshlrev_b32 v82, 16, v25
    v_and_b32 v83, 0xffff0000, v25
    v_pk_add_f32 v[2:3], v[64:65], v[66:67]
    v_pk_add_f32 v[2:3], v[2:3], v[68:69]
    v_pk_add_f32 v[2:3], v[2:3], v[70:71]
    v_pk_add_f32 v[2:3], v[2:3], v[72:73]
    v_pk_add_f32 v[2:3], v[2:3], v[74:75]
    v_pk_add_f32 v[2:3], v[2:3], v[76:77]
    v_pk_add_f32 v[2:3], v[2:3], v[78:79]
    v_pk_add_f32 v[2:3], v[2:3], v[80:81]
    v_pk_add_f32 v[2:3], v[2:3], v[82:83]
    v_add_f32 v2, v2, v3
    s_nop 1
    v_add_f32_dpp v2, v2, v2 quad_perm:[1,0,3,2] row_mask:0xf bank_mask:0xf
    s_nop 1
    v_add_f32_dpp v2, v2, v2 quad_perm:[2,3,0,1] row_mask:0xf bank_mask:0xf
    s_nop 1
    v_add_f32_dpp v2, v2, v2 row_half_mirror row_mask:0xf bank_mask:0xf
    s_nop 1
    v_add_f32_dpp v2, v2, v2 row_mirror row_mask:0xf bank_mask:0xf
    v_mov_b32 v8, v2
    s_nop 1
    v_permlane16_swap_b32 v2, v8
    s_nop 1
    v_add_f32 v2, v2, v8
    s_mov_b32 s7, 0x3acccccd
    v_mul_f32 v2, s7, v2
    v_mov_b64 v[4:5], 0
    v_pk_add_f32 v[6:7], v[64:65], v[2:3] op_sel_hi:[1,0] neg_lo:[0,1] neg_hi:[0,1]
    v_pk_fma_f32 v[4:5], v[6:7], v[6:7], v[4:5]
    v_pk_add_f32 v[6:7], v[66:67], v[2:3] op_sel_hi:[1,0] neg_lo:[0,1] neg_hi:[0,1]
    v_pk_fma_f32 v[4:5], v[6:7], v[6:7], v[4:5]
    v_pk_add_f32 v[6:7], v[68:69], v[2:3] op_sel_hi:[1,0] neg_lo:[0,1] neg_hi:[0,1]
    v_pk_fma_f32 v[4:5], v[6:7], v[6:7], v[4:5]
    v_pk_add_f32 v[6:7], v[70:71], v[2:3] op_sel_hi:[1,0] neg_lo:[0,1] neg_hi:[0,1]
    v_pk_fma_f32 v[4:5], v[6:7], v[6:7], v[4:5]
    v_pk_add_f32 v[6:7], v[72:73], v[2:3] op_sel_hi:[1,0] neg_lo:[0,1] neg_hi:[0,1]
    v_pk_fma_f32 v[4:5], v[6:7], v[6:7], v[4:5]
    v_pk_add_f32 v[6:7], v[74:75], v[2:3] op_sel_hi:[1,0] neg_lo:[0,1] neg_hi:[0,1]
    v_pk_fma_f32 v[4:5], v[6:7], v[6:7], v[4:5]
    v_pk_add_f32 v[6:7], v[76:77], v[2:3] op_sel_hi:[1,0] neg_lo:[0,1] neg_hi:[0,1]
    v_pk_fma_f32 v[4:5], v[6:7], v[6:7], v[4:5]
    v_pk_add_f32 v[6:7], v[78:79], v[2:3] op_sel_hi:[1,0] neg_lo:[0,1] neg_hi:[0,1]
    v_pk_fma_f32 v[4:5], v[6:7], v[6:7], v[4:5]
    v_pk_add_f32 v[6:7], v[80:81], v[2:3] op_sel_hi:[1,0] neg_lo:[0,1] neg_hi:[0,1]
    v_pk_fma_f32 v[4:5], v[6:7], v[6:7], v[4:5]
    v_pk_add_f32 v[6:7], v[82:83], v[2:3] op_sel_hi:[1,0] neg_lo:[0,1] neg_hi:[0,1]
    v_pk_fma_f32 v[4:5], v[6:7], v[6:7], v[4:5]
    v_add_f32 v4, v4, v5
    s_nop 1
    v_add_f32_dpp v4, v4, v4 quad_perm:[1,0,3,2] row_mask:0xf bank_mask:0xf
    s_nop 1
    v_add_f32_dpp v4, v4, v4 quad_perm:[2,3,0,1] row_mask:0xf bank_mask:0xf
    s_nop 1
    v_add_f32_dpp v4, v4, v4 row_half_mirror row_mask:0xf bank_mask:0xf
    s_nop 1
    v_add_f32_dpp v4, v4, v4 row_mirror row_mask:0xf bank_mask:0xf
    v_mov_b32 v8, v4
    s_nop 1
    v_permlane16_swap_b32 v4, v8
    s_nop 1
    v_add_f32 v4, v4, v8
    v_mul_f32 v4, s7, v4
    v_cvt_pk_bf16_f32 v2, v2, v2
    v_lshlrev_b32 v2, 16, v2
    v_cvt_pk_bf16_f32 v4, v4, v4
    v_lshlrev_b32 v4, 16, v4
    v_add_f32 v4, 0x3727c5ac, v4
    v_cvt_pk_bf16_f32 v4, v4, v4
    v_lshlrev_b32 v4, 16, v4
    v_sqrt_f32 v4, v4
    s_nop 0
    v_cvt_pk_bf16_f32 v4, v4, v4
    v_lshlrev_b32 v4, 16, v4
    v_rcp_f32 v6, v4
    s_nop 0
    v_fma_f32 v5, -v4, v6, 1.0
    v_fmac_f32 v6, v5, v6
    v_mov_b32 v9, 0
    v_pk_add_f32 v[64:65], v[64:65], v[2:3] op_sel_hi:[1,0] neg_lo:[0,1] neg_hi:[0,1]
    v_cvt_pk_bf16_f32 v5, v64, v65
    v_lshlrev_b32 v64, 16, v5
    v_and_b32 v65, 0xffff0000, v5
    v_pk_mul_f32 v[64:65], v[64:65], v[6:7] op_sel_hi:[1,0]
    v_cvt_pk_bf16_f32 v16, v64, v65
    v_pk_add_f32 v[66:67], v[66:67], v[2:3] op_sel_hi:[1,0] neg_lo:[0,1] neg_hi:[0,1]
    v_cvt_pk_bf16_f32 v5, v66, v67
    v_lshlrev_b32 v66, 16, v5
    v_and_b32 v67, 0xffff0000, v5
    v_pk_mul_f32 v[66:67], v[66:67], v[6:7] op_sel_hi:[1,0]
    v_cvt_pk_bf16_f32 v17, v66, v67
    v_pk_add_f32 v[68:69], v[68:69], v[2:3] op_sel_hi:[1,0] neg_lo:[0,1] neg_hi:[0,1]
    v_cvt_pk_bf16_f32 v5, v68, v69
    v_lshlrev_b32 v68, 16, v5
    v_and_b32 v69, 0xffff0000, v5
    v_pk_mul_f32 v[68:69], v[68:69], v[6:7] op_sel_hi:[1,0]
    v_cvt_pk_bf16_f32 v18, v68, v69
    v_pk_add_f32 v[70:71], v[70:71], v[2:3] op_sel_hi:[1,0] neg_lo:[0,1] neg_hi:[0,1]
    v_cvt_pk_bf16_f32 v5, v70, v71
    v_lshlrev_b32 v70, 16, v5
    v_and_b32 v71, 0xffff0000, v5
    v_pk_mul_f32 v[70:71], v[70:71], v[6:7] op_sel_hi:[1,0]
    v_cvt_pk_bf16_f32 v19, v70, v71
    v_pk_add_f32 v[72:73], v[72:73], v[2:3] op_sel_hi:[1,0] neg_lo:[0,1] neg_hi:[0,1]
    v_cvt_pk_bf16_f32 v5, v72, v73
    v_lshlrev_b32 v72, 16, v5
    v_and_b32 v73, 0xffff0000, v5
    v_pk_mul_f32 v[72:73], v[72:73], v[6:7] op_sel_hi:[1,0]
    v_cvt_pk_bf16_f32 v20, v72, v73
    v_pk_add_f32 v[74:75], v[74:75], v[2:3] op_sel_hi:[1,0] neg_lo:[0,1] neg_hi:[0,1]
    v_cvt_pk_bf16_f32 v5, v74, v75
    v_lshlrev_b32 v74, 16, v5
    v_and_b32 v75, 0xffff0000, v5
    v_pk_mul_f32 v[74:75], v[74:75], v[6:7] op_sel_hi:[1,0]
    v_cvt_pk_bf16_f32 v21, v74, v75
    v_pk_add_f32 v[76:77], v[76:77], v[2:3] op_sel_hi:[1,0] neg_lo:[0,1] neg_hi:[0,1]
    v_cvt_pk_bf16_f32 v5, v76, v77
    v_lshlrev_b32 v76, 16, v5
    v_and_b32 v77, 0xffff0000, v5
    v_pk_mul_f32 v[76:77], v[76:77], v[6:7] op_sel_hi:[1,0]
    v_cvt_pk_bf16_f32 v22, v76, v77
    v_pk_add_f32 v[78:79], v[78:79], v[2:3] op_sel_hi:[1,0] neg_lo:[0,1] neg_hi:[0,1]
    v_cvt_pk_bf16_f32 v5, v78, v79
    v_lshlrev_b32 v78, 16, v5
    v_and_b32 v79, 0xffff0000, v5
    v_pk_mul_f32 v[78:79], v[78:79], v[6:7] op_sel_hi:[1,0]
    v_cvt_pk_bf16_f32 v23, v78, v79
    v_pk_add_f32 v[80:81], v[80:81], v[2:3] op_sel_hi:[1,0] neg_lo:[0,1] neg_hi:[0,1]
    v_cvt_pk_bf16_f32 v5, v80, v81
    v_lshlrev_b32 v80, 16, v5
    v_and_b32 v81, 0xffff0000, v5
    v_pk_mul_f32 v[80:81], v[80:81], v[6:7] op_sel_hi:[1,0]
    v_cvt_pk_bf16_f32 v24, v80, v81
    v_pk_add_f32 v[82:83], v[82:83], v[2:3] op_sel_hi:[1,0] neg_lo:[0,1] neg_hi:[0,1]
    v_cvt_pk_bf16_f32 v5, v82, v83
    v_lshlrev_b32 v82, 16, v5
    v_and_b32 v83, 0xffff0000, v5
    v_pk_mul_f32 v[82:83], v[82:83], v[6:7] op_sel_hi:[1,0]
    v_cvt_pk_bf16_f32 v25, v82, v83
    v_add_u32 v10, 131072, v63
    ds_write_b64 v10, v[16:17] offset:0
    ds_write_b64 v10, v[18:19] offset:256
    ds_write_b64 v10, v[20:21] offset:512
    ds_write_b64 v10, v[22:23] offset:768
    ds_write_b64 v10, v[24:25] offset:1024
    s_waitcnt lgkmcnt(0)
    v_mov_b32 v2, 0
    v_lshlrev_b32 v4, 16, v16
    v_lshlrev_b32 v5, 16, v26
    v_fmac_f32 v2, v4, v5
    v_and_b32 v4, 0xffff0000, v16
    v_and_b32 v5, 0xffff0000, v26
    v_fmac_f32 v2, v4, v5
    v_lshlrev_b32 v4, 16, v17
    v_lshlrev_b32 v5, 16, v27
    v_fmac_f32 v2, v4, v5
    v_and_b32 v4, 0xffff0000, v17
    v_and_b32 v5, 0xffff0000, v27
    v_fmac_f32 v2, v4, v5
    v_lshlrev_b32 v4, 16, v18
    v_lshlrev_b32 v5, 16, v28
    v_fmac_f32 v2, v4, v5
    v_and_b32 v4, 0xffff0000, v18
    v_and_b32 v5, 0xffff0000, v28
    v_fmac_f32 v2, v4, v5
    v_lshlrev_b32 v4, 16, v19
    v_lshlrev_b32 v5, 16, v29
    v_fmac_f32 v2, v4, v5
    v_and_b32 v4, 0xffff0000, v19
    v_and_b32 v5, 0xffff0000, v29
    v_fmac_f32 v2, v4, v5
    v_lshlrev_b32 v4, 16, v20
    v_lshlrev_b32 v5, 16, v30
    v_fmac_f32 v2, v4, v5
    v_and_b32 v4, 0xffff0000, v20
    v_and_b32 v5, 0xffff0000, v30
    v_fmac_f32 v2, v4, v5
    v_lshlrev_b32 v4, 16, v21
    v_lshlrev_b32 v5, 16, v31
    v_fmac_f32 v2, v4, v5
    v_and_b32 v4, 0xffff0000, v21
    v_and_b32 v5, 0xffff0000, v31
    v_fmac_f32 v2, v4, v5
    v_lshlrev_b32 v4, 16, v22
    v_lshlrev_b32 v5, 16, v32
    v_fmac_f32 v2, v4, v5
    v_and_b32 v4, 0xffff0000, v22
    v_and_b32 v5, 0xffff0000, v32
    v_fmac_f32 v2, v4, v5
    v_lshlrev_b32 v4, 16, v23
    v_lshlrev_b32 v5, 16, v33
    v_fmac_f32 v2, v4, v5
    v_and_b32 v4, 0xffff0000, v23
    v_and_b32 v5, 0xffff0000, v33
    v_fmac_f32 v2, v4, v5
    v_lshlrev_b32 v4, 16, v24
    v_lshlrev_b32 v5, 16, v34
    v_fmac_f32 v2, v4, v5
    v_and_b32 v4, 0xffff0000, v24
    v_and_b32 v5, 0xffff0000, v34
    v_fmac_f32 v2, v4, v5
    v_lshlrev_b32 v4, 16, v25
    v_lshlrev_b32 v5, 16, v35
    v_fmac_f32 v2, v4, v5
    v_and_b32 v4, 0xffff0000, v25
    v_and_b32 v5, 0xffff0000, v35
    v_fmac_f32 v2, v4, v5
    s_nop 1
    v_add_f32_dpp v2, v2, v2 quad_perm:[1,0,3,2] row_mask:0xf bank_mask:0xf
    s_nop 1
    v_add_f32_dpp v2, v2, v2 quad_perm:[2,3,0,1] row_mask:0xf bank_mask:0xf
    s_nop 1
    v_add_f32_dpp v2, v2, v2 row_half_mirror row_mask:0xf bank_mask:0xf
    s_nop 1
    v_add_f32_dpp v2, v2, v2 row_mirror row_mask:0xf bank_mask:0xf
    v_mov_b32 v8, v2
    s_nop 1
    v_permlane16_swap_b32 v2, v8
    s_nop 1
    v_add_f32 v2, v2, v8
    v_cvt_pk_bf16_f32 v2, v2, v2
    v_and_b32 v2, 0xffff, v2
    v_bfe_i32 v3, v2, 15, 1
    v_and_b32 v3, 0x7fff, v3
    v_or_b32 v3, 0x8000, v3
    v_xor_b32 v2, v2, v3
    s_lshl_b32 s7, s2, 3
    s_sub_u32 s6, 2047, s7
    v_sub_u32 v3, s6, v62
    v_lshl_or_b32 v2, v2, 11, v3
    v_lshlrev_b32 v3, 2, v62
    v_add_u32 v3, 161792, v3
    ds_write_b32 v3, v2
    s_waitcnt lgkmcnt(0)
L_st_j1:
    s_barrier
    s_cmp_ge_u32 s3, 4
    s_cbranch_scc1 L_kv_v
    ds_read_b128 v[64:67], v48 offset:0
    ds_read_b128 v[68:71], v48 offset:2048
    ds_read_b64_tr_b16 v[96:97], v50 offset:0
    ds_read_b64_tr_b16 v[98:99], v50 offset:1024
    ds_read_b64_tr_b16 v[100:101], v51 offset:0
    ds_read_b64_tr_b16 v[102:103], v51 offset:1024
    ds_read_b128 v[72:75], v48 offset:4096
    ds_read_b64_tr_b16 v[104:105], v52 offset:0
    ds_read_b64_tr_b16 v[106:107], v52 offset:1024
    ds_read_b64_tr_b16 v[108:109], v53 offset:0
    ds_read_b64_tr_b16 v[110:111], v53 offset:1024
    ds_read_b128 v[76:79], v48 offset:6144
    ds_read_b128 v[80:83], v48 offset:8192
    ds_read_b128 v[84:87], v48 offset:10240
    ds_read_b128 v[88:91], v48 offset:12288
    ds_read_b128 v[92:95], v48 offset:14336
    s_mov_b32 m0, s73
    s_xor_b32 s64, s64, 0x10000
    buffer_load_dwordx4 v44, s[16:19], s63 offen offset:0 nt lds
    buffer_load_dwordx4 v45, s[16:19], s63 offen offset:1024 nt lds
    buffer_load_dwordx4 v46, s[16:19], s63 offen offset:2048 nt lds
    buffer_load_dwordx4 v47, s[16:19], s63 offen offset:3072 nt lds
    s_add_u32 m0, s73, 16384
    s_xor_b32 s73, s73, 0x10000
    buffer_load_dwordx4 v44, s[20:23], s63 offen offset:0 nt lds
    buffer_load_dwordx4 v45, s[20:23], s63 offen offset:1024 nt lds
    buffer_load_dwordx4 v46, s[20:23], s63 offen offset:2048 nt lds
    buffer_load_dwordx4 v47, s[20:23], s63 offen offset:3072 nt lds
    s_add_u32 s63, s63, 524288
    s_bitset0_b32 s63, 22
.p2align 4
L_kloopA:
    s_waitcnt lgkmcnt(12)
    v_mfma_f32_16x16x32_bf16 v[128:131], v[96:99], v[64:67], v[128:131]
    ds_read_b64_tr_b16 v[112:113], v50 offset:8192
    s_waitcnt lgkmcnt(11)
    v_mfma_f32_16x16x32_bf16 v[132:135], v[100:103], v[64:67], v[132:135]
    ds_read_b64_tr_b16 v[114:115], v50 offset:9216
    s_waitcnt lgkmcnt(9)
    v_mfma_f32_16x16x32_bf16 v[136:139], v[104:107], v[64:67], v[136:139]
    ds_read_b64_tr_b16 v[116:117], v51 offset:8192
    s_waitcnt lgkmcnt(8)
    v_mfma_f32_16x16x32_bf16 v[140:143], v[108:111], v[64:67], v[140:143]
    ds_read_b64_tr_b16 v[118:119], v51 offset:9216
    ds_read_b128 v[64:67], v49 offset:0
    v_mfma_f32_16x16x32_bf16 v[156:159], v[108:111], v[68:71], v[156:159]
    ds_read_b64_tr_b16 v[120:121], v52 offset:8192
    v_mfma_f32_16x16x32_bf16 v[152:155], v[104:107], v[68:71], v[152:155]
    ds_read_b64_tr_b16 v[122:123], v52 offset:9216
    v_mfma_f32_16x16x32_bf16 v[148:151], v[100:103], v[68:71], v[148:151]
    ds_read_b64_tr_b16 v[124:125], v53 offset:8192
    v_mfma_f32_16x16x32_bf16 v[144:147], v[96:99], v[68:71], v[144:147]
    ds_read_b64_tr_b16 v[126:127], v53 offset:9216
    ds_read_b128 v[68:71], v49 offset:2048
    v_mfma_f32_16x16x32_bf16 v[160:163], v[96:99], v[72:75], v[160:163]
    v_mfma_f32_16x16x32_bf16 v[164:167], v[100:103], v[72:75], v[164:167]
    v_mfma_f32_16x16x32_bf16 v[168:171], v[104:107], v[72:75], v[168:171]
    v_mfma_f32_16x16x32_bf16 v[172:175], v[108:111], v[72:75], v[172:175]
    ds_read_b128 v[72:75], v49 offset:4096
    s_waitcnt lgkmcnt(15)
    v_mfma_f32_16x16x32_bf16 v[188:191], v[108:111], v[76:79], v[188:191]
    v_mfma_f32_16x16x32_bf16 v[184:187], v[104:107], v[76:79], v[184:187]
    v_mfma_f32_16x16x32_bf16 v[180:183], v[100:103], v[76:79], v[180:183]
    v_mfma_f32_16x16x32_bf16 v[176:179], v[96:99], v[76:79], v[176:179]
    ds_read_b128 v[76:79], v49 offset:6144
    s_waitcnt lgkmcnt(15)
    v_mfma_f32_16x16x32_bf16 v[192:195], v[96:99], v[80:83], v[192:195]
    v_mfma_f32_16x16x32_bf16 v[196:199], v[100:103], v[80:83], v[196:199]
    v_mfma_f32_16x16x32_bf16 v[200:203], v[104:107], v[80:83], v[200:203]
    v_mfma_f32_16x16x32_bf16 v[204:207], v[108:111], v[80:83], v[204:207]
    ds_read_b128 v[80:83], v49 offset:8192
    s_waitcnt lgkmcnt(15)
    v_mfma_f32_16x16x32_bf16 v[220:223], v[108:111], v[84:87], v[220:223]
    v_mfma_f32_16x16x32_bf16 v[216:219], v[104:107], v[84:87], v[216:219]
    v_mfma_f32_16x16x32_bf16 v[212:215], v[100:103], v[84:87], v[212:215]
    v_mfma_f32_16x16x32_bf16 v[208:211], v[96:99], v[84:87], v[208:211]
    ds_read_b128 v[84:87], v49 offset:10240
    s_waitcnt lgkmcnt(15)
    v_mfma_f32_16x16x32_bf16 v[224:227], v[96:99], v[88:91], v[224:227]
    v_mfma_f32_16x16x32_bf16 v[228:231], v[100:103], v[88:91], v[228:231]
    v_mfma_f32_16x16x32_bf16 v[232:235], v[104:107], v[88:91], v[232:235]
    v_mfma_f32_16x16x32_bf16 v[236:239], v[108:111], v[88:91], v[236:239]
    ds_read_b128 v[88:91], v49 offset:12288
    s_waitcnt lgkmcnt(15)
    v_mfma_f32_16x16x32_bf16 v[252:255], v[108:111], v[92:95], v[252:255]
    v_mfma_f32_16x16x32_bf16 v[248:251], v[104:107], v[92:95], v[248:251]
    v_mfma_f32_16x16x32_bf16 v[244:247], v[100:103], v[92:95], v[244:247]
    v_mfma_f32_16x16x32_bf16 v[240:243], v[96:99], v[92:95], v[240:243]
    ds_read_b128 v[92:95], v49 offset:14336
    s_waitcnt lgkmcnt(11)
    v_mfma_f32_16x16x32_bf16 v[128:131], v[112:115], v[64:67], v[128:131]
    v_mfma_f32_16x16x32_bf16 v[132:135], v[116:119], v[64:67], v[132:135]
    s_waitcnt lgkmcnt(9)
    v_mfma_f32_16x16x32_bf16 v[136:139], v[120:123], v[64:67], v[136:139]
    s_waitcnt lgkmcnt(7)
    v_mfma_f32_16x16x32_bf16 v[140:143], v[124:127], v[64:67], v[140:143]
    s_waitcnt lgkmcnt(6)
    v_mfma_f32_16x16x32_bf16 v[156:159], v[124:127], v[68:71], v[156:159]
    v_mfma_f32_16x16x32_bf16 v[152:155], v[120:123], v[68:71], v[152:155]
    v_mfma_f32_16x16x32_bf16 v[148:151], v[116:119], v[68:71], v[148:151]
    v_mfma_f32_16x16x32_bf16 v[144:147], v[112:115], v[68:71], v[144:147]
    v_xor_b32 v48, 0x10000, v48
    v_xor_b32 v49, 0x10000, v49
    v_xor_b32 v50, 0x10000, v50
    v_xor_b32 v51, 0x10000, v51
    v_xor_b32 v52, 0x10000, v52
    v_xor_b32 v53, 0x10000, v53
    s_waitcnt vmcnt(0) lgkmcnt(0)
    s_barrier
    ds_read_b128 v[64:67], v48 offset:0
    ds_read_b128 v[68:71], v48 offset:2048
    v_mfma_f32_16x16x32_bf16 v[160:163], v[112:115], v[72:75], v[160:163]
    ds_read_b64_tr_b16 v[96:97], v50 offset:0
    s_mov_b32 m0, s64
    s_add_u32 s72, s62, 524288
    v_mfma_f32_16x16x32_bf16 v[164:167], v[116:119], v[72:75], v[164:167]
    ds_read_b64_tr_b16 v[98:99], v50 offset:1024
    buffer_load_dwordx4 v40, s[12:15], s62 offen offset:0 lds
    v_mfma_f32_16x16x32_bf16 v[168:171], v[120:123], v[72:75], v[168:171]
    ds_read_b64_tr_b16 v[100:101], v51 offset:0
    buffer_load_dwordx4 v41, s[12:15], s62 offen offset:1024 lds
    v_mfma_f32_16x16x32_bf16 v[172:175], v[124:127], v[72:75], v[172:175]
    ds_read_b64_tr_b16 v[102:103], v51 offset:1024
    buffer_load_dwordx4 v42, s[12:15], s62 offen offset:2048 lds
    ds_read_b128 v[72:75], v48 offset:4096
    v_mfma_f32_16x16x32_bf16 v[188:191], v[124:127], v[76:79], v[188:191]
    ds_read_b64_tr_b16 v[104:105], v52 offset:0
    buffer_load_dwordx4 v43, s[12:15], s62 offen offset:3072 lds
    v_mfma_f32_16x16x32_bf16 v[184:187], v[120:123], v[76:79], v[184:187]
    ds_read_b64_tr_b16 v[106:107], v52 offset:1024
    s_add_u32 m0, s64, 4096
    s_add_u32 s62, s62, 128
    s_bitset0_b32 s62, 10
    v_mfma_f32_16x16x32_bf16 v[180:183], v[116:119], v[76:79], v[180:183]
    ds_read_b64_tr_b16 v[108:109], v53 offset:0
    buffer_load_dwordx4 v40, s[12:15], s72 offen offset:0 lds
    v_mfma_f32_16x16x32_bf16 v[176:179], v[112:115], v[76:79], v[176:179]
    ds_read_b64_tr_b16 v[110:111], v53 offset:1024
    buffer_load_dwordx4 v41, s[12:15], s72 offen offset:1024 lds
    ds_read_b128 v[76:79], v48 offset:6144
    v_mfma_f32_16x16x32_bf16 v[192:195], v[112:115], v[80:83], v[192:195]
    buffer_load_dwordx4 v42, s[12:15], s72 offen offset:2048 lds
    v_mfma_f32_16x16x32_bf16 v[196:199], v[116:119], v[80:83], v[196:199]
    buffer_load_dwordx4 v43, s[12:15], s72 offen offset:3072 lds
    v_mfma_f32_16x16x32_bf16 v[200:203], v[120:123], v[80:83], v[200:203]
    s_mov_b32 m0, s73
    s_xor_b32 s64, s64, 0x10000
    v_mfma_f32_16x16x32_bf16 v[204:207], v[124:127], v[80:83], v[204:207]
    buffer_load_dwordx4 v44, s[16:19], s63 offen offset:0 nt lds
    ds_read_b128 v[80:83], v48 offset:8192
    v_mfma_f32_16x16x32_bf16 v[220:223], v[124:127], v[84:87], v[220:223]
    buffer_load_dwordx4 v45, s[16:19], s63 offen offset:1024 nt lds
    v_mfma_f32_16x16x32_bf16 v[216:219], v[120:123], v[84:87], v[216:219]
    buffer_load_dwordx4 v46, s[16:19], s63 offen offset:2048 nt lds
    v_mfma_f32_16x16x32_bf16 v[212:215], v[116:119], v[84:87], v[212:215]
    buffer_load_dwordx4 v47, s[16:19], s63 offen offset:3072 nt lds
    v_mfma_f32_16x16x32_bf16 v[208:211], v[112:115], v[84:87], v[208:211]
    s_add_u32 m0, s73, 16384
    s_xor_b32 s73, s73, 0x10000
    ds_read_b128 v[84:87], v48 offset:10240
    v_mfma_f32_16x16x32_bf16 v[224:227], v[112:115], v[88:91], v[224:227]
    buffer_load_dwordx4 v44, s[20:23], s63 offen offset:0 nt lds
    v_mfma_f32_16x16x32_bf16 v[228:231], v[116:119], v[88:91], v[228:231]
    buffer_load_dwordx4 v45, s[20:23], s63 offen offset:1024 nt lds
    v_mfma_f32_16x16x32_bf16 v[232:235], v[120:123], v[88:91], v[232:235]
    buffer_load_dwordx4 v46, s[20:23], s63 offen offset:2048 nt lds
    v_mfma_f32_16x16x32_bf16 v[236:239], v[124:127], v[88:91], v[236:239]
    buffer_load_dwordx4 v47, s[20:23], s63 offen offset:3072 nt lds
    ds_read_b128 v[88:91], v48 offset:12288
    v_mfma_f32_16x16x32_bf16 v[252:255], v[124:127], v[92:95], v[252:255]
    s_add_u32 s63, s63, 524288
    s_bitset0_b32 s63, 22
    v_mfma_f32_16x16x32_bf16 v[248:251], v[120:123], v[92:95], v[248:251]
    v_mfma_f32_16x16x32_bf16 v[244:247], v[116:119], v[92:95], v[244:247]
    v_mfma_f32_16x16x32_bf16 v[240:243], v[112:115], v[92:95], v[240:243]
    ds_read_b128 v[92:95], v48 offset:14336
    s_add_u32 s65, s65, 1
    s_cmp_lt_u32 s65, 6
    s_cbranch_scc1 L_kloopA
.p2align 4
L_kloopB:
    s_bitcmp1_b32 128, s65
    s_cbranch_scc1 L_khook
L_khook_back:
    s_waitcnt lgkmcnt(12)
    v_mfma_f32_16x16x32_bf16 v[128:131], v[96:99], v[64:67], v[128:131]
    ds_read_b64_tr_b16 v[112:113], v50 offset:8192
    s_waitcnt lgkmcnt(11)
    v_mfma_f32_16x16x32_bf16 v[132:135], v[100:103], v[64:67], v[132:135]
    ds_read_b64_tr_b16 v[114:115], v50 offset:9216
    s_waitcnt lgkmcnt(9)
    v_mfma_f32_16x16x32_bf16 v[136:139], v[104:107], v[64:67], v[136:139]
    ds_read_b64_tr_b16 v[116:117], v51 offset:8192
    s_waitcnt lgkmcnt(8)
    v_mfma_f32_16x16x32_bf16 v[140:143], v[108:111], v[64:67], v[140:143]
    ds_read_b64_tr_b16 v[118:119], v51 offset:9216
    ds_read_b128 v[64:67], v49 offset:0
    v_mfma_f32_16x16x32_bf16 v[156:159], v[108:111], v[68:71], v[156:159]
    ds_read_b64_tr_b16 v[120:121], v52 offset:8192
    v_mfma_f32_16x16x32_bf16 v[152:155], v[104:107], v[68:71], v[152:155]
    ds_read_b64_tr_b16 v[122:123], v52 offset:9216
    v_mfma_f32_16x16x32_bf16 v[148:151], v[100:103], v[68:71], v[148:151]
    ds_read_b64_tr_b16 v[124:125], v53 offset:8192
    v_mfma_f32_16x16x32_bf16 v[144:147], v[96:99], v[68:71], v[144:147]
    ds_read_b64_tr_b16 v[126:127], v53 offset:9216
    ds_read_b128 v[68:71], v49 offset:2048
    v_mfma_f32_16x16x32_bf16 v[160:163], v[96:99], v[72:75], v[160:163]
    v_mfma_f32_16x16x32_bf16 v[164:167], v[100:103], v[72:75], v[164:167]
    v_mfma_f32_16x16x32_bf16 v[168:171], v[104:107], v[72:75], v[168:171]
    v_mfma_f32_16x16x32_bf16 v[172:175], v[108:111], v[72:75], v[172:175]
    ds_read_b128 v[72:75], v49 offset:4096
    s_waitcnt lgkmcnt(15)
    v_mfma_f32_16x16x32_bf16 v[188:191], v[108:111], v[76:79], v[188:191]
    v_mfma_f32_16x16x32_bf16 v[184:187], v[104:107], v[76:79], v[184:187]
    v_mfma_f32_16x16x32_bf16 v[180:183], v[100:103], v[76:79], v[180:183]
    v_mfma_f32_16x16x32_bf16 v[176:179], v[96:99], v[76:79], v[176:179]
    ds_read_b128 v[76:79], v49 offset:6144
    s_waitcnt lgkmcnt(15)
    v_mfma_f32_16x16x32_bf16 v[192:195], v[96:99], v[80:83], v[192:195]
    v_mfma_f32_16x16x32_bf16 v[196:199], v[100:103], v[80:83], v[196:199]
    v_mfma_f32_16x16x32_bf16 v[200:203], v[104:107], v[80:83], v[200:203]
    v_mfma_f32_16x16x32_bf16 v[204:207], v[108:111], v[80:83], v[204:207]
    ds_read_b128 v[80:83], v49 offset:8192
    s_waitcnt lgkmcnt(15)
    v_mfma_f32_16x16x32_bf16 v[220:223], v[108:111], v[84:87], v[220:223]
    v_mfma_f32_16x16x32_bf16 v[216:219], v[104:107], v[84:87], v[216:219]
    v_mfma_f32_16x16x32_bf16 v[212:215], v[100:103], v[84:87], v[212:215]
    v_mfma_f32_16x16x32_bf16 v[208:211], v[96:99], v[84:87], v[208:211]
    ds_read_b128 v[84:87], v49 offset:10240
    s_waitcnt lgkmcnt(15)
    v_mfma_f32_16x16x32_bf16 v[224:227], v[96:99], v[88:91], v[224:227]
    v_mfma_f32_16x16x32_bf16 v[228:231], v[100:103], v[88:91], v[228:231]
    v_mfma_f32_16x16x32_bf16 v[232:235], v[104:107], v[88:91], v[232:235]
    v_mfma_f32_16x16x32_bf16 v[236:239], v[108:111], v[88:91], v[236:239]
    ds_read_b128 v[88:91], v49 offset:12288
    s_waitcnt lgkmcnt(15)
    v_mfma_f32_16x16x32_bf16 v[252:255], v[108:111], v[92:95], v[252:255]
    v_mfma_f32_16x16x32_bf16 v[248:251], v[104:107], v[92:95], v[248:251]
    v_mfma_f32_16x16x32_bf16 v[244:247], v[100:103], v[92:95], v[244:247]
    v_mfma_f32_16x16x32_bf16 v[240:243], v[96:99], v[92:95], v[240:243]
    ds_read_b128 v[92:95], v49 offset:14336
    s_waitcnt lgkmcnt(11)
    v_mfma_f32_16x16x32_bf16 v[128:131], v[112:115], v[64:67], v[128:131]
    v_mfma_f32_16x16x32_bf16 v[132:135], v[116:119], v[64:67], v[132:135]
    s_waitcnt lgkmcnt(9)
    v_mfma_f32_16x16x32_bf16 v[136:139], v[120:123], v[64:67], v[136:139]
    s_waitcnt lgkmcnt(7)
    v_mfma_f32_16x16x32_bf16 v[140:143], v[124:127], v[64:67], v[140:143]
    s_waitcnt lgkmcnt(6)
    v_mfma_f32_16x16x32_bf16 v[156:159], v[124:127], v[68:71], v[156:159]
    v_mfma_f32_16x16x32_bf16 v[152:155], v[120:123], v[68:71], v[152:155]
    v_mfma_f32_16x16x32_bf16 v[148:151], v[116:119], v[68:71], v[148:151]
    v_mfma_f32_16x16x32_bf16 v[144:147], v[112:115], v[68:71], v[144:147]
    v_xor_b32 v48, 0x10000, v48
    v_xor_b32 v49, 0x10000, v49
    v_xor_b32 v50, 0x10000, v50
    v_xor_b32 v51, 0x10000, v51
    v_xor_b32 v52, 0x10000, v52
    v_xor_b32 v53, 0x10000, v53
    s_waitcnt vmcnt(0) lgkmcnt(0)
    s_barrier
    ds_read_b128 v[64:67], v48 offset:0
    ds_read_b128 v[68:71], v48 offset:2048
    v_mfma_f32_16x16x32_bf16 v[160:163], v[112:115], v[72:75], v[160:163]
    ds_read_b64_tr_b16 v[96:97], v50 offset:0
    s_mov_b32 m0, s74
    s_add_u32 s74, s74, 16384
    s_bitset0_b32 s74, 17
    v_mfma_f32_16x16x32_bf16 v[164:167], v[116:119], v[72:75], v[164:167]
    ds_read_b64_tr_b16 v[98:99], v50 offset:1024
    buffer_load_dwordx4 v44, s[24:27], s71 offen offset:0 lds
    v_mfma_f32_16x16x32_bf16 v[168:171], v[120:123], v[72:75], v[168:171]
    ds_read_b64_tr_b16 v[100:101], v51 offset:0
    buffer_load_dwordx4 v45, s[24:27], s71 offen offset:1024 lds
    v_mfma_f32_16x16x32_bf16 v[172:175], v[124:127], v[72:75], v[172:175]
    ds_read_b64_tr_b16 v[102:103], v51 offset:1024
    buffer_load_dwordx4 v46, s[24:27], s71 offen offset:2048 lds
    ds_read_b128 v[72:75], v48 offset:4096
    v_mfma_f32_16x16x32_bf16 v[188:191], v[124:127], v[76:79], v[188:191]
    ds_read_b64_tr_b16 v[104:105], v52 offset:0
    buffer_load_dwordx4 v47, s[24:27], s71 offen offset:3072 lds
    v_mfma_f32_16x16x32_bf16 v[184:187], v[120:123], v[76:79], v[184:187]
    ds_read_b64_tr_b16 v[106:107], v52 offset:1024
    s_add_u32 s71, s71, 524288
    s_sub_u32 s75, s71, 5242880
    s_cselect_b32 s71, s71, s75
    v_mfma_f32_16x16x32_bf16 v[180:183], v[116:119], v[76:79], v[180:183]
    ds_read_b64_tr_b16 v[108:109], v53 offset:0
    s_mov_b32 m0, s74
    s_add_u32 s74, s74, 16384
    s_bitset0_b32 s74, 17
    v_mfma_f32_16x16x32_bf16 v[176:179], v[112:115], v[76:79], v[176:179]
    ds_read_b64_tr_b16 v[110:111], v53 offset:1024
    buffer_load_dwordx4 v44, s[24:27], s71 offen offset:0 lds
    ds_read_b128 v[76:79], v48 offset:6144
    v_mfma_f32_16x16x32_bf16 v[192:195], v[112:115], v[80:83], v[192:195]
    buffer_load_dwordx4 v45, s[24:27], s71 offen offset:1024 lds
    v_mfma_f32_16x16x32_bf16 v[196:199], v[116:119], v[80:83], v[196:199]
    buffer_load_dwordx4 v46, s[24:27], s71 offen offset:2048 lds
    v_mfma_f32_16x16x32_bf16 v[200:203], v[120:123], v[80:83], v[200:203]
    buffer_load_dwordx4 v47, s[24:27], s71 offen offset:3072 lds
    v_mfma_f32_16x16x32_bf16 v[204:207], v[124:127], v[80:83], v[204:207]
    s_add_u32 s71, s71, 524288
    s_sub_u32 s75, s71, 5242880
    s_cselect_b32 s71, s71, s75
    ds_read_b128 v[80:83], v48 offset:8192
    v_mfma_f32_16x16x32_bf16 v[220:223], v[124:127], v[84:87], v[220:223]
    s_mov_b32 m0, s74
    s_add_u32 s74, s74, 16384
    s_bitset0_b32 s74, 17
    v_mfma_f32_16x16x32_bf16 v[216:219], v[120:123], v[84:87], v[216:219]
    buffer_load_dwordx4 v44, s[24:27], s71 offen offset:0 lds
    v_mfma_f32_16x16x32_bf16 v[212:215], v[116:119], v[84:87], v[212:215]
    buffer_load_dwordx4 v45, s[24:27], s71 offen offset:1024 lds
    v_mfma_f32_16x16x32_bf16 v[208:211], v[112:115], v[84:87], v[208:211]
    buffer_load_dwordx4 v46, s[24:27], s71 offen offset:2048 lds
    ds_read_b128 v[84:87], v48 offset:10240
    v_mfma_f32_16x16x32_bf16 v[224:227], v[112:115], v[88:91], v[224:227]
    buffer_load_dwordx4 v47, s[24:27], s71 offen offset:3072 lds
    v_mfma_f32_16x16x32_bf16 v[228:231], v[116:119], v[88:91], v[228:231]
    s_add_u32 s71, s71, 524288
    s_sub_u32 s75, s71, 5242880
    s_cselect_b32 s71, s71, s75
    v_mfma_f32_16x16x32_bf16 v[232:235], v[120:123], v[88:91], v[232:235]
    s_mov_b32 m0, s74
    s_add_u32 s74, s74, 16384
    s_bitset0_b32 s74, 17
    v_mfma_f32_16x16x32_bf16 v[236:239], v[124:127], v[88:91], v[236:239]
    buffer_load_dwordx4 v44, s[24:27], s71 offen offset:0 lds
    ds_read_b128 v[88:91], v48 offset:12288
    v_mfma_f32_16x16x32_bf16 v[252:255], v[124:127], v[92:95], v[252:255]
    buffer_load_dwordx4 v45, s[24:27], s71 offen offset:1024 lds
    v_mfma_f32_16x16x32_bf16 v[248:251], v[120:123], v[92:95], v[248:251]
    buffer_load_dwordx4 v46, s[24:27], s71 offen offset:2048 lds
    v_mfma_f32_16x16x32_bf16 v[244:247], v[116:119], v[92:95], v[244:247]
    buffer_load_dwordx4 v47, s[24:27], s71 offen offset:3072 lds
    v_mfma_f32_16x16x32_bf16 v[240:243], v[112:115], v[92:95], v[240:243]
    s_add_u32 s71, s71, 524288
    s_sub_u32 s75, s71, 5242880
    s_cselect_b32 s71, s71, s75
    ds_read_b128 v[92:95], v48 offset:14336
    s_add_u32 s65, s65, 1
    s_cmp_lt_u32 s65, 8
    s_cbranch_scc1 L_kloopB
    s_waitcnt lgkmcnt(0)
    s_nop 7
    v_cvt_pk_bf16_f32 v128, v128, v129
    v_cvt_pk_bf16_f32 v129, v130, v131
    v_cvt_pk_bf16_f32 v130, v132, v133
    v_cvt_pk_bf16_f32 v131, v134, v135
    v_cvt_pk_bf16_f32 v132, v136, v137
    v_cvt_pk_bf16_f32 v133, v138, v139
    v_cvt_pk_bf16_f32 v134, v140, v141
    v_cvt_pk_bf16_f32 v135, v142, v143
    v_cvt_pk_bf16_f32 v136, v144, v145
    v_cvt_pk_bf16_f32 v137, v146, v147
    v_cvt_pk_bf16_f32 v138, v148, v149
    v_cvt_pk_bf16_f32 v139, v150, v151
    v_cvt_pk_bf16_f32 v140, v152, v153
    v_cvt_pk_bf16_f32 v141, v154, v155
    v_cvt_pk_bf16_f32 v142, v156, v157
    v_cvt_pk_bf16_f32 v143, v158, v159
    v_cvt_pk_bf16_f32 v144, v160, v161
    v_cvt_pk_bf16_f32 v145, v162, v163
    v_cvt_pk_bf16_f32 v146, v164, v165
    v_cvt_pk_bf16_f32 v147, v166, v167
    v_cvt_pk_bf16_f32 v148, v168, v169
    v_cvt_pk_bf16_f32 v149, v170, v171
    v_cvt_pk_bf16_f32 v150, v172, v173
    v_cvt_pk_bf16_f32 v151, v174, v175
    v_cvt_pk_bf16_f32 v152, v176, v177
    v_cvt_pk_bf16_f32 v153, v178, v179
    v_cvt_pk_bf16_f32 v154, v180, v181
    v_cvt_pk_bf16_f32 v155, v182, v183
    v_cvt_pk_bf16_f32 v156, v184, v185
    v_cvt_pk_bf16_f32 v157, v186, v187
    v_cvt_pk_bf16_f32 v158, v188, v189
    v_cvt_pk_bf16_f32 v159, v190, v191
    v_cvt_pk_bf16_f32 v160, v192, v193
    v_cvt_pk_bf16_f32 v161, v194, v195
    v_cvt_pk_bf16_f32 v162, v196, v197
    v_cvt_pk_bf16_f32 v163, v198, v199
    v_cvt_pk_bf16_f32 v164, v200, v201
    v_cvt_pk_bf16_f32 v165, v202, v203
    v_cvt_pk_bf16_f32 v166, v204, v205
    v_cvt_pk_bf16_f32 v167, v206, v207
    v_cvt_pk_bf16_f32 v168, v208, v209
    v_cvt_pk_bf16_f32 v169, v210, v211
    v_cvt_pk_bf16_f32 v170, v212, v213
    v_cvt_pk_bf16_f32 v171, v214, v215
    v_cvt_pk_bf16_f32 v172, v216, v217
    v_cvt_pk_bf16_f32 v173, v218, v219
    v_cvt_pk_bf16_f32 v174, v220, v221
    v_cvt_pk_bf16_f32 v175, v222, v223
    v_cvt_pk_bf16_f32 v176, v224, v225
    v_cvt_pk_bf16_f32 v177, v226, v227
    v_cvt_pk_bf16_f32 v178, v228, v229
    v_cvt_pk_bf16_f32 v179, v230, v231
    v_cvt_pk_bf16_f32 v180, v232, v233
    v_cvt_pk_bf16_f32 v181, v234, v235
    v_cvt_pk_bf16_f32 v182, v236, v237
    v_cvt_pk_bf16_f32 v183, v238, v239
    v_cvt_pk_bf16_f32 v184, v240, v241
    v_cvt_pk_bf16_f32 v185, v242, v243
    v_cvt_pk_bf16_f32 v186, v244, v245
    v_cvt_pk_bf16_f32 v187, v246, v247
    v_cvt_pk_bf16_f32 v188, v248, v249
    v_cvt_pk_bf16_f32 v189, v250, v251
    v_cvt_pk_bf16_f32 v190, v252, v253
    v_cvt_pk_bf16_f32 v191, v254, v255
    s_waitcnt vmcnt(16)
    s_branch L_q
L_hook:
    s_cmp_eq_u32 s65, 1
    s_cbranch_scc1 L_hook1
    s_cmp_eq_u32 s65, 2
    s_cbranch_scc1 L_hook2
    s_cmp_eq_u32 s65, 4
    s_cbranch_scc1 L_hook4
    s_cmp_eq_u32 s65, 6
    s_cbranch_scc1 L_hook6
    s_cmp_lg_u32 s65, 7
    s_cbranch_scc1 L_hook_back
    buffer_load_dwordx4 v[16:19], v13, s[8:11], s84 offen offset:0 sc1
    buffer_load_dwordx4 v[20:23], v12, s[8:11], s84 offen offset:0 sc1
    buffer_load_dwordx4 v[24:27], v13, s[8:11], s84 offen offset:1024 sc1
    buffer_load_dwordx4 v[28:31], v12, s[8:11], s84 offen offset:1024 sc1
    buffer_load_dwordx4 v[32:35], v13, s[8:11], s84 offen offset:2048 sc1
    buffer_load_dwordx4 v[36:39], v12, s[8:11], s84 offen offset:2048 sc1
    s_branch L_hook_back
L_hook1:
    s_cmp_ge_u32 s76, 2
    s_cbranch_scc1 L_tch_1a
    s_and_b32 s6, s4, 3
    s_lshl_b32 s6, s6, 19
    s_lshl_b32 s7, s5, 15
    s_add_u32 s6, s6, s7
    s_lshl_b32 s7, s76, 7
    s_add_u32 s6, s6, s7
    s_add_u32 s6, s6, 512
    v_lshrrev_b32 v6, 1, v1
    v_lshlrev_b32 v6, 10, v6
    v_and_b32 v7, 1, v1
    v_lshl_add_u32 v6, v7, 6, v6
    buffer_load_dword v11, v6, s[12:15], s6 offen
    s_add_u32 s6, s6, 262144
    buffer_load_dword v11, v6, s[12:15], s6 offen
    s_branch L_tch_1c
L_tch_1a:
    v_lshrrev_b32 v6, 5, v1
    v_lshlrev_b32 v6, 6, v6
    v_bfe_u32 v7, v1, 2, 3
    v_add_u32 v6, v6, v7
    v_lshlrev_b32 v6, 13, v6
    v_and_b32 v7, 3, v1
    v_lshl_add_u32 v6, v7, 6, v6
    s_lshl_b32 s6, s4, 8
    s_lshl_b32 s7, s5, 16
    s_add_u32 s6, s6, s7
    s_add_u32 s6, s6, 2097152
    s_cmp_lg_u32 s76, 2
    s_cbranch_scc1 L_tch_1b
    buffer_load_dword v11, v6, s[16:19], s6 offen nt
    s_branch L_tch_1c
L_tch_1b:
    buffer_load_dword v11, v6, s[20:23], s6 offen nt
L_tch_1c:
    s_branch L_hook_back
L_hook2:
    s_lshr_b32 s72, s2, 1
    s_mul_i32 s72, s72, 20480
    s_and_b32 s7, s2, 1
    s_lshl_b32 s7, s7, 7
    s_add_u32 s72, s72, s7
    v_add_u32 v2, -256, v0
    v_lshrrev_b32 v3, 3, v2
    v_and_b32 v4, 7, v2
    v_mul_u32_u24 v5, 1280, v4
    v_lshl_add_u32 v5, v3, 4, v5
    v_add_u32 v5, 131072, v5
    ds_read_b128 v[16:19], v5
    v_lshlrev_b32 v5, 8, v3
    v_lshl_add_u32 v6, v4, 4, v5
    v_add_u32 v2, 0, v0
    v_lshrrev_b32 v3, 3, v2
    v_and_b32 v4, 7, v2
    v_mul_u32_u24 v5, 1280, v4
    v_lshl_add_u32 v5, v3, 4, v5
    v_add_u32 v5, 131072, v5
    ds_read_b128 v[24:27], v5
    v_lshlrev_b32 v5, 8, v3
    v_lshl_add_u32 v7, v4, 4, v5
    v_add_u32 v2, 256, v0
    v_lshrrev_b32 v3, 3, v2
    v_and_b32 v4, 7, v2
    v_mul_u32_u24 v5, 1280, v4
    v_lshl_add_u32 v5, v3, 4, v5
    v_add_u32 v5, 131072, v5
    ds_read_b128 v[32:35], v5
    v_lshlrev_b32 v5, 8, v3
    v_lshl_add_u32 v8, v4, 4, v5
    s_waitcnt lgkmcnt(0)
    buffer_store_dwordx4 v[16:19], v6, s[8:11], s72 offen sc1
    buffer_store_dwordx4 v[24:27], v7, s[8:11], s72 offen sc1
    s_cmp_ge_u32 s3, 6
    s_cbranch_scc1 L_lns
    buffer_store_dwordx4 v[32:35], v8, s[8:11], s72 offen sc1
L_lns:
    s_cmp_lt_u32 s3, 6
    s_cbranch_scc1 L_zd
    v_mov_b64 v[36:37], 0
    v_mov_b64 v[38:39], 0
    v_lshrrev_b32 v2, 3, v1
    s_cmp_eq_u32 s3, 6
    s_cbranch_scc1 L_z6
    s_lshl_b32 s6, s5, 2
    s_sub_u32 s7, 56, s6
    v_mov_b32 v3, s6
    v_mov_b32 v4, s7
    v_cmp_gt_u32 vcc, 4, v2
    s_lshl_b32 s6, s4, 7
    s_add_u32 s6, s6, 3932160
    v_cndmask_b32 v3, v4, v3, vcc
    v_add_u32 v3, v3, v2
    v_lshl_add_u32 v3, v3, 12, s6
    s_branch L_z7
L_z6:
    v_mov_b32 v3, 0x5000000
    s_lshl_b32 s6, s4, 3
    s_add_u32 s6, s6, s5
    s_lshl_b32 s6, s6, 5
    s_add_u32 s6, s6, s3
    s_lshl_b32 s6, s6, 2
    s_add_u32 s6, s6, 3866624
    s_andn2_b32 s6, s6, 127
    v_cmp_eq_u32 vcc, 0, v2
    v_mov_b32 v4, s6
    s_nop 0
    v_cndmask_b32 v3, v3, v4, vcc
    s_lshl_b32 s6, s61, 5
    s_add_u32 s6, s6, s3
    s_lshl_b32 s6, s6, 2
    s_add_u32 s6, s6, 15859712
    s_andn2_b32 s6, s6, 127
    v_cmp_eq_u32 vcc, 1, v2
    v_mov_b32 v4, s6
    s_nop 0
    v_cndmask_b32 v3, v3, v4, vcc
    s_lshl_b32 s6, s5, 5
    s_add_u32 s6, s6, s4
    s_lshl_b32 s6, s6, 5
    s_add_u32 s6, s6, s3
    s_lshl_b32 s6, s6, 2
    s_add_u32 s6, s6, 3899392
    s_andn2_b32 s6, s6, 127
    v_cmp_eq_u32 vcc, 2, v2
    v_mov_b32 v4, s6
    s_nop 0
    v_cndmask_b32 v3, v3, v4, vcc
    s_and_b32 s6, s4, 7
    s_lshl_b32 s7, s5, 3
    s_add_u32 s6, s6, s7
    s_lshr_b32 s7, s4, 3
    s_add_u32 s7, s7, 0
    s_add_u32 s7, s7, 1
    s_and_b32 s7, s7, 3
    s_lshl_b32 s6, s6, 2
    s_add_u32 s6, s6, s7
    s_mul_i32 s6, s6, 3
    s_add_u32 s6, s6, 0
    s_lshl_b32 s6, s6, 5
    s_add_u32 s6, s6, s3
    s_lshl_b32 s6, s6, 2
    s_add_u32 s6, s6, 15728640
    s_andn2_b32 s6, s6, 127
    v_cmp_eq_u32 vcc, 3, v2
    v_mov_b32 v4, s6
    s_nop 0
    v_cndmask_b32 v3, v3, v4, vcc
    s_and_b32 s6, s4, 7
    s_lshl_b32 s7, s5, 3
    s_add_u32 s6, s6, s7
    s_lshr_b32 s7, s4, 3
    s_add_u32 s7, s7, 1
    s_add_u32 s7, s7, 1
    s_and_b32 s7, s7, 3
    s_lshl_b32 s6, s6, 2
    s_add_u32 s6, s6, s7
    s_mul_i32 s6, s6, 3
    s_add_u32 s6, s6, 1
    s_lshl_b32 s6, s6, 5
    s_add_u32 s6, s6, s3
    s_lshl_b32 s6, s6, 2
    s_add_u32 s6, s6, 15728640
    s_andn2_b32 s6, s6, 127
    v_cmp_eq_u32 vcc, 4, v2
    v_mov_b32 v4, s6
    s_nop 0
    v_cndmask_b32 v3, v3, v4, vcc
    s_and_b32 s6, s4, 7
    s_lshl_b32 s7, s5, 3
    s_add_u32 s6, s6, s7
    s_lshr_b32 s7, s4, 3
    s_add_u32 s7, s7, 2
    s_add_u32 s7, s7, 1
    s_and_b32 s7, s7, 3
    s_lshl_b32 s6, s6, 2
    s_add_u32 s6, s6, s7
    s_mul_i32 s6, s6, 3
    s_add_u32 s6, s6, 2
    s_lshl_b32 s6, s6, 5
    s_add_u32 s6, s6, s3
    s_lshl_b32 s6, s6, 2
    s_add_u32 s6, s6, 15728640
    s_andn2_b32 s6, s6, 127
    v_cmp_eq_u32 vcc, 5, v2
    v_mov_b32 v4, s6
    s_nop 0
    v_cndmask_b32 v3, v3, v4, vcc
    s_mov_b32 s6, 0x5000000
    s_cmp_eq_u32 s2, 31
    s_cmov_b32 s6, 3801088
    s_andn2_b32 s6, s6, 127
    v_cmp_eq_u32 vcc, 6, v2
    v_mov_b32 v4, s6
    s_nop 0
    v_cndmask_b32 v3, v3, v4, vcc
    s_lshl_b32 s6, s2, 7
    s_add_u32 s6, s6, 2621440
    s_andn2_b32 s6, s6, 127
    v_cmp_eq_u32 vcc, 7, v2
    v_mov_b32 v4, s6
    s_nop 0
    v_cndmask_b32 v3, v3, v4, vcc
    v_add_u32 v4, 160896, v13
    s_mov_b32 exec_lo, 0
    s_mov_b32 exec_hi, 0x03000000
    ds_read_b128 v[36:39], v4
    s_mov_b64 exec, -1
    s_waitcnt lgkmcnt(0)
L_z7:
    v_and_b32 v2, 7, v1
    v_lshl_add_u32 v3, v2, 4, v3
    buffer_store_dwordx4 v[36:39], v3, s[8:11], 0 offen sc1
L_zd:
    s_cmp_ge_u32 s76, 2
    s_cbranch_scc1 L_tch_2a
    s_and_b32 s6, s4, 3
    s_lshl_b32 s6, s6, 19
    s_lshl_b32 s7, s5, 15
    s_add_u32 s6, s6, s7
    s_lshl_b32 s7, s76, 7
    s_add_u32 s6, s6, s7
    s_add_u32 s6, s6, 768
    v_lshrrev_b32 v6, 1, v1
    v_lshlrev_b32 v6, 10, v6
    v_and_b32 v7, 1, v1
    v_lshl_add_u32 v6, v7, 6, v6
    buffer_load_dword v11, v6, s[12:15], s6 offen
    s_add_u32 s6, s6, 262144
    buffer_load_dword v11, v6, s[12:15], s6 offen
    s_branch L_tch_2c
L_tch_2a:
    v_lshrrev_b32 v6, 5, v1
    v_lshlrev_b32 v6, 6, v6
    v_bfe_u32 v7, v1, 2, 3
    v_add_u32 v6, v6, v7
    v_lshlrev_b32 v6, 13, v6
    v_and_b32 v7, 3, v1
    v_lshl_add_u32 v6, v7, 6, v6
    s_lshl_b32 s6, s4, 8
    s_lshl_b32 s7, s5, 16
    s_add_u32 s6, s6, s7
    s_add_u32 s6, s6, 3145728
    s_cmp_lg_u32 s76, 2
    s_cbranch_scc1 L_tch_2b
    buffer_load_dword v11, v6, s[16:19], s6 offen nt
    s_branch L_tch_2c
L_tch_2b:
    buffer_load_dword v11, v6, s[20:23], s6 offen nt
L_tch_2c:
    s_branch L_hook_back
L_hook4:
    s_cmp_lg_u32 s3, 4
    s_cbranch_scc1 L_hook4b
    s_mov_b32 s28, s56
    s_mov_b32 s29, s57
    s_mov_b32 s30, 0x100
    s_mov_b32 s31, 0x20000
    v_mov_b32 v2, 1
    v_lshlrev_b32 v3, 8, v1
    s_and_b32 s6, s2, 31
    s_lshl_b32 s6, s6, 2
    buffer_atomic_add v2, v3, s[28:31], s6 offen offset:0 sc1
L_hook4b:
    s_lshl_b32 s74, s76, 12
    s_add_u32 s74, s74, 131072
    s_mov_b32 m0, s74
    s_add_u32 s74, s74, 16384
    buffer_load_dwordx4 v44, s[24:27], s71 offen offset:0 lds
    buffer_load_dwordx4 v45, s[24:27], s71 offen offset:1024 lds
    buffer_load_dwordx4 v46, s[24:27], s71 offen offset:2048 lds
    buffer_load_dwordx4 v47, s[24:27], s71 offen offset:3072 lds
    s_add_u32 s71, s71, 524288
    s_sub_u32 s75, s71, 5242880
    s_cselect_b32 s71, s71, s75
    s_mov_b32 m0, s74
    s_add_u32 s74, s74, 16384
    buffer_load_dwordx4 v44, s[24:27], s71 offen offset:0 lds
    buffer_load_dwordx4 v45, s[24:27], s71 offen offset:1024 lds
    buffer_load_dwordx4 v46, s[24:27], s71 offen offset:2048 lds
    buffer_load_dwordx4 v47, s[24:27], s71 offen offset:3072 lds
    s_add_u32 s71, s71, 524288
    s_sub_u32 s75, s71, 5242880
    s_cselect_b32 s71, s71, s75
    s_branch L_hook_back
L_hook6:
    s_cmp_lg_u32 s3, 5
    s_cbranch_scc1 L_hook_back
    s_mov_b32 s28, s56
    s_mov_b32 s29, s57
    s_mov_b32 s30, 0x100
    s_mov_b32 s31, 0x20000
    v_and_b32 v3, 31, v1
    v_lshlrev_b32 v3, 2, v3
    buffer_load_dword v62, v3, s[28:31], 0 offen offset:0 sc1
    s_branch L_hook_back
L_vpre:
    s_waitcnt vmcnt(0)
    s_lshl_b32 s6, s65, 4
    s_add_u32 s6, s6, s3
    s_cmp_lg_u32 s6, 0x65
    s_cbranch_scc1 L_vnow
    v_cmp_gt_u32 vcc, 8, v62
    s_cbranch_vccz L_cntok_3
    s_mov_b32 s28, s56
    s_mov_b32 s29, s57
    s_mov_b32 s30, 0x100
    s_mov_b32 s31, 0x20000
    v_and_b32 v3, 31, v1
    v_lshlrev_b32 v3, 2, v3
    s_mov_b32 s79, 262144
L_poll_4:
    buffer_load_dword v2, v3, s[28:31], 0 offen offset:0 sc1
    s_waitcnt vmcnt(0)
    v_cmp_gt_u32 vcc, 8, v2
    s_cbranch_vccz L_polldone_5
    s_sleep 8
    s_sub_u32 s79, s79, 1
    s_cmp_lg_u32 s79, 0
    s_cbranch_scc1 L_poll_4
L_polldone_5:
L_cntok_3:
    s_branch L_vnow
L_khook:
    s_cmp_lg_u32 s65, 7
    s_cbranch_scc1 L_khook_back
    buffer_load_dwordx4 v[16:19], v13, s[8:11], s84 offen offset:0 sc1
    buffer_load_dwordx4 v[20:23], v12, s[8:11], s84 offen offset:0 sc1
    buffer_load_dwordx4 v[24:27], v13, s[8:11], s84 offen offset:1024 sc1
    buffer_load_dwordx4 v[28:31], v12, s[8:11], s84 offen offset:1024 sc1
    buffer_load_dwordx4 v[32:35], v13, s[8:11], s84 offen offset:2048 sc1
    buffer_load_dwordx4 v[36:39], v12, s[8:11], s84 offen offset:2048 sc1
    s_branch L_khook_back
L_kv_v:
    ds_read_b128 v[64:67], v48 offset:0
    ds_read_b128 v[68:71], v48 offset:2048
    ds_read_b64_tr_b16 v[96:97], v50 offset:0
    ds_read_b64_tr_b16 v[98:99], v50 offset:1024
    ds_read_b64_tr_b16 v[100:101], v51 offset:0
    ds_read_b64_tr_b16 v[102:103], v51 offset:1024
    ds_read_b128 v[72:75], v48 offset:4096
    ds_read_b64_tr_b16 v[104:105], v52 offset:0
    ds_read_b64_tr_b16 v[106:107], v52 offset:1024
    ds_read_b64_tr_b16 v[108:109], v53 offset:0
    ds_read_b64_tr_b16 v[110:111], v53 offset:1024
    ds_read_b128 v[76:79], v48 offset:6144
    ds_read_b128 v[80:83], v48 offset:8192
    ds_read_b128 v[84:87], v48 offset:10240
    ds_read_b128 v[88:91], v48 offset:12288
    ds_read_b128 v[92:95], v48 offset:14336
    s_cmp_ge_u32 s76, 2
    s_cbranch_scc1 L_tch_6a
    s_and_b32 s6, s4, 3
    s_lshl_b32 s6, s6, 19
    s_lshl_b32 s7, s5, 15
    s_add_u32 s6, s6, s7
    s_lshl_b32 s7, s76, 7
    s_add_u32 s6, s6, s7
    s_add_u32 s6, s6, 256
    v_lshrrev_b32 v6, 1, v1
    v_lshlrev_b32 v6, 10, v6
    v_and_b32 v7, 1, v1
    v_lshl_add_u32 v6, v7, 6, v6
    buffer_load_dword v11, v6, s[12:15], s6 offen
    s_add_u32 s6, s6, 262144
    buffer_load_dword v11, v6, s[12:15], s6 offen
    s_branch L_tch_6c
L_tch_6a:
    v_lshrrev_b32 v6, 5, v1
    v_lshlrev_b32 v6, 6, v6
    v_bfe_u32 v7, v1, 2, 3
    v_add_u32 v6, v6, v7
    v_lshlrev_b32 v6, 13, v6
    v_and_b32 v7, 3, v1
    v_lshl_add_u32 v6, v7, 6, v6
    s_lshl_b32 s6, s4, 8
    s_lshl_b32 s7, s5, 16
    s_add_u32 s6, s6, s7
    s_add_u32 s6, s6, 1048576
    s_cmp_lg_u32 s76, 2
    s_cbranch_scc1 L_tch_6b
    buffer_load_dword v11, v6, s[16:19], s6 offen nt
    s_branch L_tch_6c
L_tch_6b:
    buffer_load_dword v11, v6, s[20:23], s6 offen nt
L_tch_6c:
.p2align 4
L_vloop:
    s_bitcmp1_b32 214, s65
    s_cbranch_scc1 L_hook
L_hook_back:
    s_waitcnt lgkmcnt(12)
    v_mfma_f32_16x16x32_bf16 v[128:131], v[64:67], v[96:99], v[128:131]
    ds_read_b64_tr_b16 v[112:113], v50 offset:8192
    s_waitcnt lgkmcnt(11)
    v_mfma_f32_16x16x32_bf16 v[132:135], v[64:67], v[100:103], v[132:135]
    ds_read_b64_tr_b16 v[114:115], v50 offset:9216
    s_waitcnt lgkmcnt(9)
    v_mfma_f32_16x16x32_bf16 v[136:139], v[64:67], v[104:107], v[136:139]
    ds_read_b64_tr_b16 v[116:117], v51 offset:8192
    s_waitcnt lgkmcnt(8)
    v_mfma_f32_16x16x32_bf16 v[140:143], v[64:67], v[108:111], v[140:143]
    ds_read_b64_tr_b16 v[118:119], v51 offset:9216
    ds_read_b128 v[64:67], v49 offset:0
    v_mfma_f32_16x16x32_bf16 v[156:159], v[68:71], v[108:111], v[156:159]
    ds_read_b64_tr_b16 v[120:121], v52 offset:8192
    v_mfma_f32_16x16x32_bf16 v[152:155], v[68:71], v[104:107], v[152:155]
    ds_read_b64_tr_b16 v[122:123], v52 offset:9216
    v_mfma_f32_16x16x32_bf16 v[148:151], v[68:71], v[100:103], v[148:151]
    ds_read_b64_tr_b16 v[124:125], v53 offset:8192
    v_mfma_f32_16x16x32_bf16 v[144:147], v[68:71], v[96:99], v[144:147]
    ds_read_b64_tr_b16 v[126:127], v53 offset:9216
    ds_read_b128 v[68:71], v49 offset:2048
    v_mfma_f32_16x16x32_bf16 v[160:163], v[72:75], v[96:99], v[160:163]
    v_mfma_f32_16x16x32_bf16 v[164:167], v[72:75], v[100:103], v[164:167]
    v_mfma_f32_16x16x32_bf16 v[168:171], v[72:75], v[104:107], v[168:171]
    v_mfma_f32_16x16x32_bf16 v[172:175], v[72:75], v[108:111], v[172:175]
    ds_read_b128 v[72:75], v49 offset:4096
    s_waitcnt lgkmcnt(15)
    v_mfma_f32_16x16x32_bf16 v[188:191], v[76:79], v[108:111], v[188:191]
    v_mfma_f32_16x16x32_bf16 v[184:187], v[76:79], v[104:107], v[184:187]
    v_mfma_f32_16x16x32_bf16 v[180:183], v[76:79], v[100:103], v[180:183]
    v_mfma_f32_16x16x32_bf16 v[176:179], v[76:79], v[96:99], v[176:179]
    ds_read_b128 v[76:79], v49 offset:6144
    s_waitcnt lgkmcnt(15)
    v_mfma_f32_16x16x32_bf16 v[192:195], v[80:83], v[96:99], v[192:195]
    v_mfma_f32_16x16x32_bf16 v[196:199], v[80:83], v[100:103], v[196:199]
    v_mfma_f32_16x16x32_bf16 v[200:203], v[80:83], v[104:107], v[200:203]
    v_mfma_f32_16x16x32_bf16 v[204:207], v[80:83], v[108:111], v[204:207]
    ds_read_b128 v[80:83], v49 offset:8192
    s_waitcnt lgkmcnt(15)
    v_mfma_f32_16x16x32_bf16 v[220:223], v[84:87], v[108:111], v[220:223]
    v_mfma_f32_16x16x32_bf16 v[216:219], v[84:87], v[104:107], v[216:219]
    v_mfma_f32_16x16x32_bf16 v[212:215], v[84:87], v[100:103], v[212:215]
    v_mfma_f32_16x16x32_bf16 v[208:211], v[84:87], v[96:99], v[208:211]
    ds_read_b128 v[84:87], v49 offset:10240
    s_waitcnt lgkmcnt(15)
    v_mfma_f32_16x16x32_bf16 v[224:227], v[88:91], v[96:99], v[224:227]
    v_mfma_f32_16x16x32_bf16 v[228:231], v[88:91], v[100:103], v[228:231]
    v_mfma_f32_16x16x32_bf16 v[232:235], v[88:91], v[104:107], v[232:235]
    v_mfma_f32_16x16x32_bf16 v[236:239], v[88:91], v[108:111], v[236:239]
    ds_read_b128 v[88:91], v49 offset:12288
    s_waitcnt lgkmcnt(15)
    v_mfma_f32_16x16x32_bf16 v[252:255], v[92:95], v[108:111], v[252:255]
    v_mfma_f32_16x16x32_bf16 v[248:251], v[92:95], v[104:107], v[248:251]
    v_mfma_f32_16x16x32_bf16 v[244:247], v[92:95], v[100:103], v[244:247]
    v_mfma_f32_16x16x32_bf16 v[240:243], v[92:95], v[96:99], v[240:243]
    ds_read_b128 v[92:95], v49 offset:14336
    s_waitcnt lgkmcnt(11)
    v_mfma_f32_16x16x32_bf16 v[128:131], v[64:67], v[112:115], v[128:131]
    v_mfma_f32_16x16x32_bf16 v[132:135], v[64:67], v[116:119], v[132:135]
    s_waitcnt lgkmcnt(9)
    v_mfma_f32_16x16x32_bf16 v[136:139], v[64:67], v[120:123], v[136:139]
    s_waitcnt lgkmcnt(7)
    v_mfma_f32_16x16x32_bf16 v[140:143], v[64:67], v[124:127], v[140:143]
    s_waitcnt lgkmcnt(6)
    v_mfma_f32_16x16x32_bf16 v[156:159], v[68:71], v[124:127], v[156:159]
    v_mfma_f32_16x16x32_bf16 v[152:155], v[68:71], v[120:123], v[152:155]
    v_mfma_f32_16x16x32_bf16 v[148:151], v[68:71], v[116:119], v[148:151]
    v_mfma_f32_16x16x32_bf16 v[144:147], v[68:71], v[112:115], v[144:147]
    v_xor_b32 v48, 0x10000, v48
    v_xor_b32 v49, 0x10000, v49
    v_xor_b32 v50, 0x10000, v50
    v_xor_b32 v51, 0x10000, v51
    v_xor_b32 v52, 0x10000, v52
    v_xor_b32 v53, 0x10000, v53
    s_bitcmp1_b32 72, s65
    s_cbranch_scc1 L_vpre
L_vnow:
    s_waitcnt lgkmcnt(0)
    s_barrier
    ds_read_b128 v[64:67], v48 offset:0
    ds_read_b128 v[68:71], v48 offset:2048
    v_mfma_f32_16x16x32_bf16 v[160:163], v[72:75], v[112:115], v[160:163]
    ds_read_b64_tr_b16 v[96:97], v50 offset:0
    v_mfma_f32_16x16x32_bf16 v[164:167], v[72:75], v[116:119], v[164:167]
    ds_read_b64_tr_b16 v[98:99], v50 offset:1024
    v_mfma_f32_16x16x32_bf16 v[168:171], v[72:75], v[120:123], v[168:171]
    ds_read_b64_tr_b16 v[100:101], v51 offset:0
    v_mfma_f32_16x16x32_bf16 v[172:175], v[72:75], v[124:127], v[172:175]
    ds_read_b64_tr_b16 v[102:103], v51 offset:1024
    ds_read_b128 v[72:75], v48 offset:4096
    v_mfma_f32_16x16x32_bf16 v[188:191], v[76:79], v[124:127], v[188:191]
    ds_read_b64_tr_b16 v[104:105], v52 offset:0
    v_mfma_f32_16x16x32_bf16 v[184:187], v[76:79], v[120:123], v[184:187]
    ds_read_b64_tr_b16 v[106:107], v52 offset:1024
    v_mfma_f32_16x16x32_bf16 v[180:183], v[76:79], v[116:119], v[180:183]
    ds_read_b64_tr_b16 v[108:109], v53 offset:0
    v_mfma_f32_16x16x32_bf16 v[176:179], v[76:79], v[112:115], v[176:179]
    ds_read_b64_tr_b16 v[110:111], v53 offset:1024
    ds_read_b128 v[76:79], v48 offset:6144
    v_mfma_f32_16x16x32_bf16 v[192:195], v[80:83], v[112:115], v[192:195]
    v_mfma_f32_16x16x32_bf16 v[196:199], v[80:83], v[116:119], v[196:199]
    v_mfma_f32_16x16x32_bf16 v[200:203], v[80:83], v[120:123], v[200:203]
    v_mfma_f32_16x16x32_bf16 v[204:207], v[80:83], v[124:127], v[204:207]
    ds_read_b128 v[80:83], v48 offset:8192
    v_mfma_f32_16x16x32_bf16 v[220:223], v[84:87], v[124:127], v[220:223]
    v_mfma_f32_16x16x32_bf16 v[216:219], v[84:87], v[120:123], v[216:219]
    v_mfma_f32_16x16x32_bf16 v[212:215], v[84:87], v[116:119], v[212:215]
    v_mfma_f32_16x16x32_bf16 v[208:211], v[84:87], v[112:115], v[208:211]
    ds_read_b128 v[84:87], v48 offset:10240
    v_mfma_f32_16x16x32_bf16 v[224:227], v[88:91], v[112:115], v[224:227]
    v_mfma_f32_16x16x32_bf16 v[228:231], v[88:91], v[116:119], v[228:231]
    v_mfma_f32_16x16x32_bf16 v[232:235], v[88:91], v[120:123], v[232:235]
    v_mfma_f32_16x16x32_bf16 v[236:239], v[88:91], v[124:127], v[236:239]
    ds_read_b128 v[88:91], v48 offset:12288
    v_mfma_f32_16x16x32_bf16 v[252:255], v[92:95], v[124:127], v[252:255]
    v_mfma_f32_16x16x32_bf16 v[248:251], v[92:95], v[120:123], v[248:251]
    v_mfma_f32_16x16x32_bf16 v[244:247], v[92:95], v[116:119], v[244:247]
    v_mfma_f32_16x16x32_bf16 v[240:243], v[92:95], v[112:115], v[240:243]
    ds_read_b128 v[92:95], v48 offset:14336
    s_add_u32 s65, s65, 1
    s_cmp_lt_u32 s65, 8
    s_cbranch_scc1 L_vloop
    s_waitcnt lgkmcnt(0)
    s_nop 7
    v_cvt_pk_bf16_f32 v128, v128, v129
    v_cvt_pk_bf16_f32 v129, v130, v131
    v_cvt_pk_bf16_f32 v130, v144, v145
    v_cvt_pk_bf16_f32 v131, v146, v147
    v_cvt_pk_bf16_f32 v132, v132, v133
    v_cvt_pk_bf16_f32 v133, v134, v135
    v_cvt_pk_bf16_f32 v134, v148, v149
    v_cvt_pk_bf16_f32 v135, v150, v151
    v_cvt_pk_bf16_f32 v136, v136, v137
    v_cvt_pk_bf16_f32 v137, v138, v139
    v_cvt_pk_bf16_f32 v138, v152, v153
    v_cvt_pk_bf16_f32 v139, v154, v155
    v_cvt_pk_bf16_f32 v140, v140, v141
    v_cvt_pk_bf16_f32 v141, v142, v143
    v_cvt_pk_bf16_f32 v142, v156, v157
    v_cvt_pk_bf16_f32 v143, v158, v159
    v_cvt_pk_bf16_f32 v144, v160, v161
    v_cvt_pk_bf16_f32 v145, v162, v163
    v_cvt_pk_bf16_f32 v146, v176, v177
    v_cvt_pk_bf16_f32 v147, v178, v179
    v_cvt_pk_bf16_f32 v148, v164, v165
    v_cvt_pk_bf16_f32 v149, v166, v167
    v_cvt_pk_bf16_f32 v150, v180, v181
    v_cvt_pk_bf16_f32 v151, v182, v183
    v_cvt_pk_bf16_f32 v152, v168, v169
    v_cvt_pk_bf16_f32 v153, v170, v171
    v_cvt_pk_bf16_f32 v154, v184, v185
    v_cvt_pk_bf16_f32 v155, v186, v187
    v_cvt_pk_bf16_f32 v156, v172, v173
    v_cvt_pk_bf16_f32 v157, v174, v175
    v_cvt_pk_bf16_f32 v158, v188, v189
    v_cvt_pk_bf16_f32 v159, v190, v191
    v_cvt_pk_bf16_f32 v160, v192, v193
    v_cvt_pk_bf16_f32 v161, v194, v195
    v_cvt_pk_bf16_f32 v162, v208, v209
    v_cvt_pk_bf16_f32 v163, v210, v211
    v_cvt_pk_bf16_f32 v164, v196, v197
    v_cvt_pk_bf16_f32 v165, v198, v199
    v_cvt_pk_bf16_f32 v166, v212, v213
    v_cvt_pk_bf16_f32 v167, v214, v215
    v_cvt_pk_bf16_f32 v168, v200, v201
    v_cvt_pk_bf16_f32 v169, v202, v203
    v_cvt_pk_bf16_f32 v170, v216, v217
    v_cvt_pk_bf16_f32 v171, v218, v219
    v_cvt_pk_bf16_f32 v172, v204, v205
    v_cvt_pk_bf16_f32 v173, v206, v207
    v_cvt_pk_bf16_f32 v174, v220, v221
    v_cvt_pk_bf16_f32 v175, v222, v223
    v_cvt_pk_bf16_f32 v176, v224, v225
    v_cvt_pk_bf16_f32 v177, v226, v227
    v_cvt_pk_bf16_f32 v178, v240, v241
    v_cvt_pk_bf16_f32 v179, v242, v243
    v_cvt_pk_bf16_f32 v180, v228, v229
    v_cvt_pk_bf16_f32 v181, v230, v231
    v_cvt_pk_bf16_f32 v182, v244, v245
    v_cvt_pk_bf16_f32 v183, v246, v247
    v_cvt_pk_bf16_f32 v184, v232, v233
    v_cvt_pk_bf16_f32 v185, v234, v235
    v_cvt_pk_bf16_f32 v186, v248, v249
    v_cvt_pk_bf16_f32 v187, v250, v251
    v_cvt_pk_bf16_f32 v188, v236, v237
    v_cvt_pk_bf16_f32 v189, v238, v239
    v_cvt_pk_bf16_f32 v190, v252, v253
    v_cvt_pk_bf16_f32 v191, v254, v255
    s_waitcnt vmcnt(0)
L_q:
    s_mov_b32 s28, s56
    s_mov_b32 s29, s57
    s_mov_b32 s30, 0x100
    s_mov_b32 s31, 0x20000
    s_lshl_b32 s6, s76, 13
    v_add_u32 v49, s6, v13
    s_lshl_b32 s6, s76, 12
    v_add_u32 v50, s6, v13
    s_lshl_b32 s77, s4, 20
    s_add_u32 s77, s77, 16777216
    s_mov_b32 s78, s100
    s_sub_u32 s101, s100, 131072
    s_mov_b32 s90, 0
    s_cmp_lt_u32 s3, 4
    s_cselect_b32 s89, 3, 2
    ds_read_b64_tr_b16 v[96:97], v54 offset:0
    ds_read_b64_tr_b16 v[98:99], v54 offset:1024
    ds_read_b64_tr_b16 v[100:101], v55 offset:0
    ds_read_b64_tr_b16 v[102:103], v55 offset:1024
    ds_read_b64_tr_b16 v[104:105], v56 offset:0
    ds_read_b64_tr_b16 v[106:107], v56 offset:1024
    ds_read_b64_tr_b16 v[108:109], v57 offset:0
    ds_read_b64_tr_b16 v[110:111], v57 offset:1024
    ds_read_b64_tr_b16 v[112:113], v58 offset:0
    ds_read_b64_tr_b16 v[114:115], v58 offset:1024
    ds_read_b64_tr_b16 v[116:117], v59 offset:0
    ds_read_b64_tr_b16 v[118:119], v59 offset:1024
    ds_read_b64_tr_b16 v[120:121], v60 offset:0
    ds_read_b64_tr_b16 v[122:123], v60 offset:1024
    ds_read_b64_tr_b16 v[124:125], v61 offset:0
    ds_read_b64_tr_b16 v[126:127], v61 offset:1024
    buffer_load_dwordx4 v[64:67], v13, s[8:11], s84 offen offset:3072 sc1
    buffer_load_dwordx4 v[68:71], v12, s[8:11], s84 offen offset:3072 sc1
    buffer_load_dwordx4 v[72:75], v13, s[8:11], s85 offen offset:0 sc1
    buffer_load_dwordx4 v[76:79], v12, s[8:11], s85 offen offset:0 sc1
    buffer_load_dwordx4 v[80:83], v13, s[8:11], s85 offen offset:1024 sc1
    buffer_load_dwordx4 v[84:87], v12, s[8:11], s85 offen offset:1024 sc1
    buffer_load_dwordx4 v[88:91], v13, s[8:11], s85 offen offset:2048 sc1
    buffer_load_dwordx4 v[92:95], v12, s[8:11], s85 offen offset:2048 sc1
    s_waitcnt lgkmcnt(14)
    v_mfma_f32_16x16x32_bf16 v[192:195], v[96:99], v[16:19], 0
    v_mfma_f32_16x16x32_bf16 v[196:199], v[96:99], v[20:23], 0
    ds_read_b64_tr_b16 v[96:97], v54 offset:8192
    s_waitcnt lgkmcnt(13)
    v_mfma_f32_16x16x32_bf16 v[204:207], v[100:103], v[20:23], 0
    ds_read_b64_tr_b16 v[98:99], v54 offset:9216
    v_mfma_f32_16x16x32_bf16 v[200:203], v[100:103], v[16:19], 0
    ds_read_b64_tr_b16 v[100:101], v55 offset:8192
    s_waitcnt lgkmcnt(13)
    v_mfma_f32_16x16x32_bf16 v[208:211], v[104:107], v[16:19], 0
    ds_read_b64_tr_b16 v[102:103], v55 offset:9216
    v_mfma_f32_16x16x32_bf16 v[212:215], v[104:107], v[20:23], 0
    ds_read_b64_tr_b16 v[104:105], v56 offset:8192
    s_waitcnt lgkmcnt(13)
    v_mfma_f32_16x16x32_bf16 v[220:223], v[108:111], v[20:23], 0
    ds_read_b64_tr_b16 v[106:107], v56 offset:9216
    buffer_store_dwordx4 v[128:131], v13, s[8:11], s67 offen sc1
    s_add_u32 s67, s67, 1024
    v_mfma_f32_16x16x32_bf16 v[216:219], v[108:111], v[16:19], 0
    ds_read_b64_tr_b16 v[108:109], v57 offset:8192
    s_waitcnt lgkmcnt(13)
    v_mfma_f32_16x16x32_bf16 v[224:227], v[112:115], v[16:19], 0
    ds_read_b64_tr_b16 v[110:111], v57 offset:9216
    v_mfma_f32_16x16x32_bf16 v[228:231], v[112:115], v[20:23], 0
    ds_read_b64_tr_b16 v[112:113], v58 offset:8192
    s_waitcnt lgkmcnt(13)
    v_mfma_f32_16x16x32_bf16 v[236:239], v[116:119], v[20:23], 0
    ds_read_b64_tr_b16 v[114:115], v58 offset:9216
    v_mfma_f32_16x16x32_bf16 v[232:235], v[116:119], v[16:19], 0
    ds_read_b64_tr_b16 v[116:117], v59 offset:8192
    s_waitcnt lgkmcnt(13)
    v_mfma_f32_16x16x32_bf16 v[240:243], v[120:123], v[16:19], 0
    ds_read_b64_tr_b16 v[118:119], v59 offset:9216
    v_mfma_f32_16x16x32_bf16 v[244:247], v[120:123], v[20:23], 0
    ds_read_b64_tr_b16 v[120:121], v60 offset:8192
    s_waitcnt lgkmcnt(13)
    v_mfma_f32_16x16x32_bf16 v[252:255], v[124:127], v[20:23], 0
    ds_read_b64_tr_b16 v[122:123], v60 offset:9216
    v_mfma_f32_16x16x32_bf16 v[248:251], v[124:127], v[16:19], 0
    ds_read_b64_tr_b16 v[124:125], v61 offset:8192
    ds_read_b64_tr_b16 v[126:127], v61 offset:9216
    buffer_load_dwordx4 v[16:19], v13, s[8:11], s85 offen offset:3072 sc1
    buffer_load_dwordx4 v[20:23], v12, s[8:11], s85 offen offset:3072 sc1
    s_waitcnt lgkmcnt(14)
    v_mfma_f32_16x16x32_bf16 v[192:195], v[96:99], v[24:27], v[192:195]
    v_mfma_f32_16x16x32_bf16 v[196:199], v[96:99], v[28:31], v[196:199]
    ds_read_b64_tr_b16 v[96:97], v54 offset:16384
    s_waitcnt lgkmcnt(13)
    v_mfma_f32_16x16x32_bf16 v[204:207], v[100:103], v[28:31], v[204:207]
    ds_read_b64_tr_b16 v[98:99], v54 offset:17408
    v_mfma_f32_16x16x32_bf16 v[200:203], v[100:103], v[24:27], v[200:203]
    ds_read_b64_tr_b16 v[100:101], v55 offset:16384
    s_waitcnt lgkmcnt(13)
    v_mfma_f32_16x16x32_bf16 v[208:211], v[104:107], v[24:27], v[208:211]
    ds_read_b64_tr_b16 v[102:103], v55 offset:17408
    v_mfma_f32_16x16x32_bf16 v[212:215], v[104:107], v[28:31], v[212:215]
    ds_read_b64_tr_b16 v[104:105], v56 offset:16384
    s_waitcnt lgkmcnt(13)
    v_mfma_f32_16x16x32_bf16 v[220:223], v[108:111], v[28:31], v[220:223]
    ds_read_b64_tr_b16 v[106:107], v56 offset:17408
    buffer_store_dwordx4 v[132:135], v13, s[8:11], s67 offen sc1
    s_add_u32 s67, s67, s68
    v_mfma_f32_16x16x32_bf16 v[216:219], v[108:111], v[24:27], v[216:219]
    ds_read_b64_tr_b16 v[108:109], v57 offset:16384
    s_waitcnt lgkmcnt(13)
    v_mfma_f32_16x16x32_bf16 v[224:227], v[112:115], v[24:27], v[224:227]
    ds_read_b64_tr_b16 v[110:111], v57 offset:17408
    v_mfma_f32_16x16x32_bf16 v[228:231], v[112:115], v[28:31], v[228:231]
    ds_read_b64_tr_b16 v[112:113], v58 offset:16384
    s_waitcnt lgkmcnt(13)
    v_mfma_f32_16x16x32_bf16 v[236:239], v[116:119], v[28:31], v[236:239]
    ds_read_b64_tr_b16 v[114:115], v58 offset:17408
    v_mfma_f32_16x16x32_bf16 v[232:235], v[116:119], v[24:27], v[232:235]
    ds_read_b64_tr_b16 v[116:117], v59 offset:16384
    s_waitcnt lgkmcnt(13)
    v_mfma_f32_16x16x32_bf16 v[240:243], v[120:123], v[24:27], v[240:243]
    ds_read_b64_tr_b16 v[118:119], v59 offset:17408
    v_mfma_f32_16x16x32_bf16 v[244:247], v[120:123], v[28:31], v[244:247]
    ds_read_b64_tr_b16 v[120:121], v60 offset:16384
    s_waitcnt lgkmcnt(13)
    v_mfma_f32_16x16x32_bf16 v[252:255], v[124:127], v[28:31], v[252:255]
    ds_read_b64_tr_b16 v[122:123], v60 offset:17408
    v_mfma_f32_16x16x32_bf16 v[248:251], v[124:127], v[24:27], v[248:251]
    ds_read_b64_tr_b16 v[124:125], v61 offset:16384
    ds_read_b64_tr_b16 v[126:127], v61 offset:17408
    buffer_load_dwordx4 v[24:27], v13, s[8:11], s86 offen offset:0 sc1
    buffer_load_dwordx4 v[28:31], v12, s[8:11], s86 offen offset:0 sc1
    s_waitcnt lgkmcnt(14)
    v_mfma_f32_16x16x32_bf16 v[192:195], v[96:99], v[32:35], v[192:195]
    v_mfma_f32_16x16x32_bf16 v[196:199], v[96:99], v[36:39], v[196:199]
    ds_read_b64_tr_b16 v[96:97], v54 offset:24576
    s_waitcnt lgkmcnt(13)
    v_mfma_f32_16x16x32_bf16 v[204:207], v[100:103], v[36:39], v[204:207]
    ds_read_b64_tr_b16 v[98:99], v54 offset:25600
    v_mfma_f32_16x16x32_bf16 v[200:203], v[100:103], v[32:35], v[200:203]
    ds_read_b64_tr_b16 v[100:101], v55 offset:24576
    s_waitcnt lgkmcnt(13)
    v_mfma_f32_16x16x32_bf16 v[208:211], v[104:107], v[32:35], v[208:211]
    ds_read_b64_tr_b16 v[102:103], v55 offset:25600
    v_mfma_f32_16x16x32_bf16 v[212:215], v[104:107], v[36:39], v[212:215]
    ds_read_b64_tr_b16 v[104:105], v56 offset:24576
    s_waitcnt lgkmcnt(13)
    v_mfma_f32_16x16x32_bf16 v[220:223], v[108:111], v[36:39], v[220:223]
    ds_read_b64_tr_b16 v[106:107], v56 offset:25600
    buffer_store_dwordx4 v[136:139], v13, s[8:11], s67 offen sc1
    s_add_u32 s67, s67, 1024
    v_mfma_f32_16x16x32_bf16 v[216:219], v[108:111], v[32:35], v[216:219]
    ds_read_b64_tr_b16 v[108:109], v57 offset:24576
    s_waitcnt lgkmcnt(13)
    v_mfma_f32_16x16x32_bf16 v[224:227], v[112:115], v[32:35], v[224:227]
    ds_read_b64_tr_b16 v[110:111], v57 offset:25600
    v_mfma_f32_16x16x32_bf16 v[228:231], v[112:115], v[36:39], v[228:231]
    ds_read_b64_tr_b16 v[112:113], v58 offset:24576
    s_waitcnt lgkmcnt(13)
    v_mfma_f32_16x16x32_bf16 v[236:239], v[116:119], v[36:39], v[236:239]
    ds_read_b64_tr_b16 v[114:115], v58 offset:25600
    v_mfma_f32_16x16x32_bf16 v[232:235], v[116:119], v[32:35], v[232:235]
    ds_read_b64_tr_b16 v[116:117], v59 offset:24576
    s_waitcnt lgkmcnt(13)
    v_mfma_f32_16x16x32_bf16 v[240:243], v[120:123], v[32:35], v[240:243]
    ds_read_b64_tr_b16 v[118:119], v59 offset:25600
    v_mfma_f32_16x16x32_bf16 v[244:247], v[120:123], v[36:39], v[244:247]
    ds_read_b64_tr_b16 v[120:121], v60 offset:24576
    s_waitcnt lgkmcnt(13)
    v_mfma_f32_16x16x32_bf16 v[252:255], v[124:127], v[36:39], v[252:255]
    ds_read_b64_tr_b16 v[122:123], v60 offset:25600
    v_mfma_f32_16x16x32_bf16 v[248:251], v[124:127], v[32:35], v[248:251]
    ds_read_b64_tr_b16 v[124:125], v61 offset:24576
    ds_read_b64_tr_b16 v[126:127], v61 offset:25600
    buffer_load_dwordx4 v[32:35], v13, s[8:11], s86 offen offset:1024 sc1
    buffer_load_dwordx4 v[36:39], v12, s[8:11], s86 offen offset:1024 sc1
    s_waitcnt vmcnt(15)
    s_waitcnt lgkmcnt(14)
    v_mfma_f32_16x16x32_bf16 v[192:195], v[96:99], v[64:67], v[192:195]
    v_add_u32 v54, s101, v54
    v_mfma_f32_16x16x32_bf16 v[196:199], v[96:99], v[68:71], v[196:199]
    ds_read_b64_tr_b16 v[96:97], v54 offset:0
    s_waitcnt lgkmcnt(13)
    v_mfma_f32_16x16x32_bf16 v[204:207], v[100:103], v[68:71], v[204:207]
    ds_read_b64_tr_b16 v[98:99], v54 offset:1024
    v_add_u32 v55, s101, v55
    v_mfma_f32_16x16x32_bf16 v[200:203], v[100:103], v[64:67], v[200:203]
    ds_read_b64_tr_b16 v[100:101], v55 offset:0
    s_waitcnt lgkmcnt(13)
    v_mfma_f32_16x16x32_bf16 v[208:211], v[104:107], v[64:67], v[208:211]
    ds_read_b64_tr_b16 v[102:103], v55 offset:1024
    v_add_u32 v56, s101, v56
    v_mfma_f32_16x16x32_bf16 v[212:215], v[104:107], v[68:71], v[212:215]
    ds_read_b64_tr_b16 v[104:105], v56 offset:0
    s_waitcnt lgkmcnt(13)
    v_mfma_f32_16x16x32_bf16 v[220:223], v[108:111], v[68:71], v[220:223]
    ds_read_b64_tr_b16 v[106:107], v56 offset:1024
    v_add_u32 v57, s101, v57
    buffer_store_dwordx4 v[140:143], v13, s[8:11], s67 offen sc1
    s_add_u32 s67, s67, s69
    v_mfma_f32_16x16x32_bf16 v[216:219], v[108:111], v[64:67], v[216:219]
    ds_read_b64_tr_b16 v[108:109], v57 offset:0
    s_waitcnt lgkmcnt(13)
    v_mfma_f32_16x16x32_bf16 v[224:227], v[112:115], v[64:67], v[224:227]
    ds_read_b64_tr_b16 v[110:111], v57 offset:1024
    v_add_u32 v58, s101, v58
    v_mfma_f32_16x16x32_bf16 v[228:231], v[112:115], v[68:71], v[228:231]
    ds_read_b64_tr_b16 v[112:113], v58 offset:0
    s_waitcnt lgkmcnt(13)
    v_mfma_f32_16x16x32_bf16 v[236:239], v[116:119], v[68:71], v[236:239]
    ds_read_b64_tr_b16 v[114:115], v58 offset:1024
    v_add_u32 v59, s101, v59
    v_mfma_f32_16x16x32_bf16 v[232:235], v[116:119], v[64:67], v[232:235]
    ds_read_b64_tr_b16 v[116:117], v59 offset:0
    s_waitcnt lgkmcnt(13)
    v_mfma_f32_16x16x32_bf16 v[240:243], v[120:123], v[64:67], v[240:243]
    ds_read_b64_tr_b16 v[118:119], v59 offset:1024
    v_add_u32 v60, s101, v60
    v_mfma_f32_16x16x32_bf16 v[244:247], v[120:123], v[68:71], v[244:247]
    ds_read_b64_tr_b16 v[120:121], v60 offset:0
    s_waitcnt lgkmcnt(13)
    v_mfma_f32_16x16x32_bf16 v[252:255], v[124:127], v[68:71], v[252:255]
    ds_read_b64_tr_b16 v[122:123], v60 offset:1024
    v_add_u32 v61, s101, v61
    v_mfma_f32_16x16x32_bf16 v[248:251], v[124:127], v[64:67], v[248:251]
    ds_read_b64_tr_b16 v[124:125], v61 offset:0
    ds_read_b64_tr_b16 v[126:127], v61 offset:1024
    buffer_load_dwordx4 v[64:67], v13, s[8:11], s86 offen offset:2048 sc1
    buffer_load_dwordx4 v[68:71], v12, s[8:11], s86 offen offset:2048 sc1
    s_waitcnt vmcnt(16)
    s_waitcnt lgkmcnt(14)
    v_mfma_f32_16x16x32_bf16 v[192:195], v[96:99], v[72:75], v[192:195]
    v_mfma_f32_16x16x32_bf16 v[196:199], v[96:99], v[76:79], v[196:199]
    ds_read_b64_tr_b16 v[96:97], v54 offset:8192
    s_waitcnt lgkmcnt(13)
    v_mfma_f32_16x16x32_bf16 v[204:207], v[100:103], v[76:79], v[204:207]
    ds_read_b64_tr_b16 v[98:99], v54 offset:9216
    v_mfma_f32_16x16x32_bf16 v[200:203], v[100:103], v[72:75], v[200:203]
    ds_read_b64_tr_b16 v[100:101], v55 offset:8192
    s_waitcnt lgkmcnt(13)
    v_mfma_f32_16x16x32_bf16 v[208:211], v[104:107], v[72:75], v[208:211]
    ds_read_b64_tr_b16 v[102:103], v55 offset:9216
    v_mfma_f32_16x16x32_bf16 v[212:215], v[104:107], v[76:79], v[212:215]
    ds_read_b64_tr_b16 v[104:105], v56 offset:8192
    s_waitcnt lgkmcnt(13)
    v_mfma_f32_16x16x32_bf16 v[220:223], v[108:111], v[76:79], v[220:223]
    ds_read_b64_tr_b16 v[106:107], v56 offset:9216
    v_mfma_f32_16x16x32_bf16 v[216:219], v[108:111], v[72:75], v[216:219]
    ds_read_b64_tr_b16 v[108:109], v57 offset:8192
    s_waitcnt lgkmcnt(13)
    v_mfma_f32_16x16x32_bf16 v[224:227], v[112:115], v[72:75], v[224:227]
    ds_read_b64_tr_b16 v[110:111], v57 offset:9216
    v_mfma_f32_16x16x32_bf16 v[228:231], v[112:115], v[76:79], v[228:231]
    ds_read_b64_tr_b16 v[112:113], v58 offset:8192
    s_waitcnt lgkmcnt(13)
    v_mfma_f32_16x16x32_bf16 v[236:239], v[116:119], v[76:79], v[236:239]
    ds_read_b64_tr_b16 v[114:115], v58 offset:9216
    v_mfma_f32_16x16x32_bf16 v[232:235], v[116:119], v[72:75], v[232:235]
    ds_read_b64_tr_b16 v[116:117], v59 offset:8192
    s_waitcnt lgkmcnt(13)
    v_mfma_f32_16x16x32_bf16 v[240:243], v[120:123], v[72:75], v[240:243]
    ds_read_b64_tr_b16 v[118:119], v59 offset:9216
    v_mfma_f32_16x16x32_bf16 v[244:247], v[120:123], v[76:79], v[244:247]
    ds_read_b64_tr_b16 v[120:121], v60 offset:8192
    s_waitcnt lgkmcnt(13)
    v_mfma_f32_16x16x32_bf16 v[252:255], v[124:127], v[76:79], v[252:255]
    ds_read_b64_tr_b16 v[122:123], v60 offset:9216
    v_mfma_f32_16x16x32_bf16 v[248:251], v[124:127], v[72:75], v[248:251]
    ds_read_b64_tr_b16 v[124:125], v61 offset:8192
    ds_read_b64_tr_b16 v[126:127], v61 offset:9216
    buffer_load_dwordx4 v[72:75], v13, s[8:11], s86 offen offset:3072 sc1
    buffer_load_dwordx4 v[76:79], v12, s[8:11], s86 offen offset:3072 sc1
    s_waitcnt vmcnt(16)
    s_waitcnt lgkmcnt(14)
    v_mfma_f32_16x16x32_bf16 v[192:195], v[96:99], v[80:83], v[192:195]
    v_mfma_f32_16x16x32_bf16 v[196:199], v[96:99], v[84:87], v[196:199]
    ds_read_b64_tr_b16 v[96:97], v54 offset:16384
    s_waitcnt lgkmcnt(13)
    v_mfma_f32_16x16x32_bf16 v[204:207], v[100:103], v[84:87], v[204:207]
    ds_read_b64_tr_b16 v[98:99], v54 offset:17408
    v_mfma_f32_16x16x32_bf16 v[200:203], v[100:103], v[80:83], v[200:203]
    ds_read_b64_tr_b16 v[100:101], v55 offset:16384
    s_waitcnt lgkmcnt(13)
    v_mfma_f32_16x16x32_bf16 v[208:211], v[104:107], v[80:83], v[208:211]
    ds_read_b64_tr_b16 v[102:103], v55 offset:17408
    v_mfma_f32_16x16x32_bf16 v[212:215], v[104:107], v[84:87], v[212:215]
    ds_read_b64_tr_b16 v[104:105], v56 offset:16384
    s_waitcnt lgkmcnt(13)
    v_mfma_f32_16x16x32_bf16 v[220:223], v[108:111], v[84:87], v[220:223]
    ds_read_b64_tr_b16 v[106:107], v56 offset:17408
    v_mfma_f32_16x16x32_bf16 v[216:219], v[108:111], v[80:83], v[216:219]
    ds_read_b64_tr_b16 v[108:109], v57 offset:16384
    s_waitcnt lgkmcnt(13)
    v_mfma_f32_16x16x32_bf16 v[224:227], v[112:115], v[80:83], v[224:227]
    ds_read_b64_tr_b16 v[110:111], v57 offset:17408
    v_mfma_f32_16x16x32_bf16 v[228:231], v[112:115], v[84:87], v[228:231]
    ds_read_b64_tr_b16 v[112:113], v58 offset:16384
    s_waitcnt lgkmcnt(13)
    v_mfma_f32_16x16x32_bf16 v[236:239], v[116:119], v[84:87], v[236:239]
    ds_read_b64_tr_b16 v[114:115], v58 offset:17408
    v_mfma_f32_16x16x32_bf16 v[232:235], v[116:119], v[80:83], v[232:235]
    ds_read_b64_tr_b16 v[116:117], v59 offset:16384
    s_waitcnt lgkmcnt(13)
    v_mfma_f32_16x16x32_bf16 v[240:243], v[120:123], v[80:83], v[240:243]
    ds_read_b64_tr_b16 v[118:119], v59 offset:17408
    v_mfma_f32_16x16x32_bf16 v[244:247], v[120:123], v[84:87], v[244:247]
    ds_read_b64_tr_b16 v[120:121], v60 offset:16384
    s_waitcnt lgkmcnt(13)
    v_mfma_f32_16x16x32_bf16 v[252:255], v[124:127], v[84:87], v[252:255]
    ds_read_b64_tr_b16 v[122:123], v60 offset:17408
    v_mfma_f32_16x16x32_bf16 v[248:251], v[124:127], v[80:83], v[248:251]
    ds_read_b64_tr_b16 v[124:125], v61 offset:16384
    ds_read_b64_tr_b16 v[126:127], v61 offset:17408
    buffer_load_dwordx4 v[80:83], v13, s[8:11], s87 offen offset:0 sc1
    buffer_load_dwordx4 v[84:87], v12, s[8:11], s87 offen offset:0 sc1
    s_waitcnt vmcnt(16)
    s_waitcnt lgkmcnt(14)
    v_mfma_f32_16x16x32_bf16 v[192:195], v[96:99], v[88:91], v[192:195]
    v_mfma_f32_16x16x32_bf16 v[196:199], v[96:99], v[92:95], v[196:199]
    ds_read_b64_tr_b16 v[96:97], v54 offset:24576
    s_waitcnt lgkmcnt(13)
    v_mfma_f32_16x16x32_bf16 v[204:207], v[100:103], v[92:95], v[204:207]
    ds_read_b64_tr_b16 v[98:99], v54 offset:25600
    v_mfma_f32_16x16x32_bf16 v[200:203], v[100:103], v[88:91], v[200:203]
    ds_read_b64_tr_b16 v[100:101], v55 offset:24576
    s_waitcnt lgkmcnt(13)
    v_mfma_f32_16x16x32_bf16 v[208:211], v[104:107], v[88:91], v[208:211]
    ds_read_b64_tr_b16 v[102:103], v55 offset:25600
    v_mfma_f32_16x16x32_bf16 v[212:215], v[104:107], v[92:95], v[212:215]
    ds_read_b64_tr_b16 v[104:105], v56 offset:24576
    s_waitcnt lgkmcnt(13)
    v_mfma_f32_16x16x32_bf16 v[220:223], v[108:111], v[92:95], v[220:223]
    ds_read_b64_tr_b16 v[106:107], v56 offset:25600
    v_mfma_f32_16x16x32_bf16 v[216:219], v[108:111], v[88:91], v[216:219]
    ds_read_b64_tr_b16 v[108:109], v57 offset:24576
    s_waitcnt lgkmcnt(13)
    v_mfma_f32_16x16x32_bf16 v[224:227], v[112:115], v[88:91], v[224:227]
    ds_read_b64_tr_b16 v[110:111], v57 offset:25600
    v_mfma_f32_16x16x32_bf16 v[228:231], v[112:115], v[92:95], v[228:231]
    ds_read_b64_tr_b16 v[112:113], v58 offset:24576
    s_waitcnt lgkmcnt(13)
    v_mfma_f32_16x16x32_bf16 v[236:239], v[116:119], v[92:95], v[236:239]
    ds_read_b64_tr_b16 v[114:115], v58 offset:25600
    v_mfma_f32_16x16x32_bf16 v[232:235], v[116:119], v[88:91], v[232:235]
    ds_read_b64_tr_b16 v[116:117], v59 offset:24576
    s_waitcnt lgkmcnt(13)
    v_mfma_f32_16x16x32_bf16 v[240:243], v[120:123], v[88:91], v[240:243]
    ds_read_b64_tr_b16 v[118:119], v59 offset:25600
    v_mfma_f32_16x16x32_bf16 v[244:247], v[120:123], v[92:95], v[244:247]
    ds_read_b64_tr_b16 v[120:121], v60 offset:24576
    s_waitcnt lgkmcnt(13)
    v_mfma_f32_16x16x32_bf16 v[252:255], v[124:127], v[92:95], v[252:255]
    ds_read_b64_tr_b16 v[122:123], v60 offset:25600
    v_mfma_f32_16x16x32_bf16 v[248:251], v[124:127], v[88:91], v[248:251]
    ds_read_b64_tr_b16 v[124:125], v61 offset:24576
    ds_read_b64_tr_b16 v[126:127], v61 offset:25600
    buffer_load_dwordx4 v[88:91], v13, s[8:11], s87 offen offset:1024 sc1
    buffer_load_dwordx4 v[92:95], v12, s[8:11], s87 offen offset:1024 sc1
    s_waitcnt vmcnt(8)
    s_lshl_b32 s6, s4, 3
    s_add_u32 s6, s6, s5
    s_lshl_b32 s6, s6, 5
    s_add_u32 s6, s6, s3
    s_lshl_b32 s6, s6, 2
    s_add_u32 s6, s6, 3866624
    v_mov_b32 v2, 1
    v_mov_b32 v3, 0x5000000
    v_writelane_b32 v3, s6, 0
    buffer_store_dword v2, v3, s[8:11], 0 offen sc1
    s_waitcnt lgkmcnt(14)
    v_mfma_f32_16x16x32_bf16 v[192:195], v[96:99], v[16:19], v[192:195]
    v_mfma_f32_16x16x32_bf16 v[196:199], v[96:99], v[20:23], v[196:199]
    ds_read_b64_tr_b16 v[96:97], v54 offset:32768
    s_waitcnt lgkmcnt(13)
    v_mfma_f32_16x16x32_bf16 v[204:207], v[100:103], v[20:23], v[204:207]
    ds_read_b64_tr_b16 v[98:99], v54 offset:33792
    v_mfma_f32_16x16x32_bf16 v[200:203], v[100:103], v[16:19], v[200:203]
    ds_read_b64_tr_b16 v[100:101], v55 offset:32768
    s_waitcnt lgkmcnt(13)
    v_mfma_f32_16x16x32_bf16 v[208:211], v[104:107], v[16:19], v[208:211]
    ds_read_b64_tr_b16 v[102:103], v55 offset:33792
    v_mfma_f32_16x16x32_bf16 v[212:215], v[104:107], v[20:23], v[212:215]
    ds_read_b64_tr_b16 v[104:105], v56 offset:32768
    s_waitcnt lgkmcnt(13)
    v_mfma_f32_16x16x32_bf16 v[220:223], v[108:111], v[20:23], v[220:223]
    ds_read_b64_tr_b16 v[106:107], v56 offset:33792
    v_mfma_f32_16x16x32_bf16 v[216:219], v[108:111], v[16:19], v[216:219]
    ds_read_b64_tr_b16 v[108:109], v57 offset:32768
    s_waitcnt lgkmcnt(13)
    v_mfma_f32_16x16x32_bf16 v[224:227], v[112:115], v[16:19], v[224:227]
    ds_read_b64_tr_b16 v[110:111], v57 offset:33792
    v_mfma_f32_16x16x32_bf16 v[228:231], v[112:115], v[20:23], v[228:231]
    ds_read_b64_tr_b16 v[112:113], v58 offset:32768
    s_waitcnt lgkmcnt(13)
    v_mfma_f32_16x16x32_bf16 v[236:239], v[116:119], v[20:23], v[236:239]
    ds_read_b64_tr_b16 v[114:115], v58 offset:33792
    v_mfma_f32_16x16x32_bf16 v[232:235], v[116:119], v[16:19], v[232:235]
    ds_read_b64_tr_b16 v[116:117], v59 offset:32768
    s_waitcnt lgkmcnt(13)
    v_mfma_f32_16x16x32_bf16 v[240:243], v[120:123], v[16:19], v[240:243]
    ds_read_b64_tr_b16 v[118:119], v59 offset:33792
    v_mfma_f32_16x16x32_bf16 v[244:247], v[120:123], v[20:23], v[244:247]
    ds_read_b64_tr_b16 v[120:121], v60 offset:32768
    s_waitcnt lgkmcnt(13)
    v_mfma_f32_16x16x32_bf16 v[252:255], v[124:127], v[20:23], v[252:255]
    ds_read_b64_tr_b16 v[122:123], v60 offset:33792
    v_mfma_f32_16x16x32_bf16 v[248:251], v[124:127], v[16:19], v[248:251]
    ds_read_b64_tr_b16 v[124:125], v61 offset:32768
    ds_read_b64_tr_b16 v[126:127], v61 offset:33792
    buffer_load_dwordx4 v[16:19], v13, s[8:11], s87 offen offset:2048 sc1
    buffer_load_dwordx4 v[20:23], v12, s[8:11], s87 offen offset:2048 sc1
    s_waitcnt lgkmcnt(14)
    v_mfma_f32_16x16x32_bf16 v[192:195], v[96:99], v[24:27], v[192:195]
    v_mfma_f32_16x16x32_bf16 v[196:199], v[96:99], v[28:31], v[196:199]
    ds_read_b64_tr_b16 v[96:97], v54 offset:40960
    s_waitcnt lgkmcnt(13)
    v_mfma_f32_16x16x32_bf16 v[204:207], v[100:103], v[28:31], v[204:207]
    ds_read_b64_tr_b16 v[98:99], v54 offset:41984
    v_mfma_f32_16x16x32_bf16 v[200:203], v[100:103], v[24:27], v[200:203]
    ds_read_b64_tr_b16 v[100:101], v55 offset:40960
    s_waitcnt lgkmcnt(13)
    v_mfma_f32_16x16x32_bf16 v[208:211], v[104:107], v[24:27], v[208:211]
    ds_read_b64_tr_b16 v[102:103], v55 offset:41984
    v_mfma_f32_16x16x32_bf16 v[212:215], v[104:107], v[28:31], v[212:215]
    ds_read_b64_tr_b16 v[104:105], v56 offset:40960
    s_waitcnt lgkmcnt(13)
    v_mfma_f32_16x16x32_bf16 v[220:223], v[108:111], v[28:31], v[220:223]
    ds_read_b64_tr_b16 v[106:107], v56 offset:41984
    v_mfma_f32_16x16x32_bf16 v[216:219], v[108:111], v[24:27], v[216:219]
    ds_read_b64_tr_b16 v[108:109], v57 offset:40960
    s_waitcnt lgkmcnt(13)
    v_mfma_f32_16x16x32_bf16 v[224:227], v[112:115], v[24:27], v[224:227]
    ds_read_b64_tr_b16 v[110:111], v57 offset:41984
    v_mfma_f32_16x16x32_bf16 v[228:231], v[112:115], v[28:31], v[228:231]
    ds_read_b64_tr_b16 v[112:113], v58 offset:40960
    s_waitcnt lgkmcnt(13)
    v_mfma_f32_16x16x32_bf16 v[236:239], v[116:119], v[28:31], v[236:239]
    ds_read_b64_tr_b16 v[114:115], v58 offset:41984
    v_mfma_f32_16x16x32_bf16 v[232:235], v[116:119], v[24:27], v[232:235]
    ds_read_b64_tr_b16 v[116:117], v59 offset:40960
    s_waitcnt lgkmcnt(13)
    v_mfma_f32_16x16x32_bf16 v[240:243], v[120:123], v[24:27], v[240:243]
    ds_read_b64_tr_b16 v[118:119], v59 offset:41984
    v_mfma_f32_16x16x32_bf16 v[244:247], v[120:123], v[28:31], v[244:247]
    ds_read_b64_tr_b16 v[120:121], v60 offset:40960
    s_waitcnt lgkmcnt(13)
    v_mfma_f32_16x16x32_bf16 v[252:255], v[124:127], v[28:31], v[252:255]
    ds_read_b64_tr_b16 v[122:123], v60 offset:41984
    v_mfma_f32_16x16x32_bf16 v[248:251], v[124:127], v[24:27], v[248:251]
    ds_read_b64_tr_b16 v[124:125], v61 offset:40960
    ds_read_b64_tr_b16 v[126:127], v61 offset:41984
    buffer_load_dwordx4 v[24:27], v13, s[8:11], s87 offen offset:3072 sc1
    buffer_load_dwordx4 v[28:31], v12, s[8:11], s87 offen offset:3072 sc1
    s_waitcnt lgkmcnt(14)
    v_mfma_f32_16x16x32_bf16 v[192:195], v[96:99], v[32:35], v[192:195]
    v_mfma_f32_16x16x32_bf16 v[196:199], v[96:99], v[36:39], v[196:199]
    ds_read_b64_tr_b16 v[96:97], v54 offset:49152
    s_waitcnt lgkmcnt(13)
    v_mfma_f32_16x16x32_bf16 v[204:207], v[100:103], v[36:39], v[204:207]
    ds_read_b64_tr_b16 v[98:99], v54 offset:50176
    v_mfma_f32_16x16x32_bf16 v[200:203], v[100:103], v[32:35], v[200:203]
    ds_read_b64_tr_b16 v[100:101], v55 offset:49152
    s_waitcnt lgkmcnt(13)
    v_mfma_f32_16x16x32_bf16 v[208:211], v[104:107], v[32:35], v[208:211]
    ds_read_b64_tr_b16 v[102:103], v55 offset:50176
    v_mfma_f32_16x16x32_bf16 v[212:215], v[104:107], v[36:39], v[212:215]
    ds_read_b64_tr_b16 v[104:105], v56 offset:49152
    s_waitcnt lgkmcnt(13)
    v_mfma_f32_16x16x32_bf16 v[220:223], v[108:111], v[36:39], v[220:223]
    ds_read_b64_tr_b16 v[106:107], v56 offset:50176
    v_mfma_f32_16x16x32_bf16 v[216:219], v[108:111], v[32:35], v[216:219]
    ds_read_b64_tr_b16 v[108:109], v57 offset:49152
    s_waitcnt lgkmcnt(13)
    v_mfma_f32_16x16x32_bf16 v[224:227], v[112:115], v[32:35], v[224:227]
    ds_read_b64_tr_b16 v[110:111], v57 offset:50176
    v_mfma_f32_16x16x32_bf16 v[228:231], v[112:115], v[36:39], v[228:231]
    ds_read_b64_tr_b16 v[112:113], v58 offset:49152
    s_waitcnt lgkmcnt(13)
    v_mfma_f32_16x16x32_bf16 v[236:239], v[116:119], v[36:39], v[236:239]
    ds_read_b64_tr_b16 v[114:115], v58 offset:50176
    v_mfma_f32_16x16x32_bf16 v[232:235], v[116:119], v[32:35], v[232:235]
    ds_read_b64_tr_b16 v[116:117], v59 offset:49152
    s_waitcnt lgkmcnt(13)
    v_mfma_f32_16x16x32_bf16 v[240:243], v[120:123], v[32:35], v[240:243]
    ds_read_b64_tr_b16 v[118:119], v59 offset:50176
    v_mfma_f32_16x16x32_bf16 v[244:247], v[120:123], v[36:39], v[244:247]
    ds_read_b64_tr_b16 v[120:121], v60 offset:49152
    s_waitcnt lgkmcnt(13)
    v_mfma_f32_16x16x32_bf16 v[252:255], v[124:127], v[36:39], v[252:255]
    ds_read_b64_tr_b16 v[122:123], v60 offset:50176
    v_mfma_f32_16x16x32_bf16 v[248:251], v[124:127], v[32:35], v[248:251]
    ds_read_b64_tr_b16 v[124:125], v61 offset:49152
    ds_read_b64_tr_b16 v[126:127], v61 offset:50176
    buffer_load_dwordx4 v[32:35], v13, s[8:11], s88 offen offset:0 sc1
    buffer_load_dwordx4 v[36:39], v12, s[8:11], s88 offen offset:0 sc1
    s_waitcnt vmcnt(13)
    s_waitcnt lgkmcnt(14)
    v_mfma_f32_16x16x32_bf16 v[192:195], v[96:99], v[64:67], v[192:195]
    v_mfma_f32_16x16x32_bf16 v[196:199], v[96:99], v[68:71], v[196:199]
    ds_read_b64_tr_b16 v[96:97], v54 offset:57344
    s_waitcnt lgkmcnt(13)
    v_mfma_f32_16x16x32_bf16 v[204:207], v[100:103], v[68:71], v[204:207]
    ds_read_b64_tr_b16 v[98:99], v54 offset:58368
    v_mfma_f32_16x16x32_bf16 v[200:203], v[100:103], v[64:67], v[200:203]
    ds_read_b64_tr_b16 v[100:101], v55 offset:57344
    s_waitcnt lgkmcnt(13)
    v_mfma_f32_16x16x32_bf16 v[208:211], v[104:107], v[64:67], v[208:211]
    ds_read_b64_tr_b16 v[102:103], v55 offset:58368
    v_mfma_f32_16x16x32_bf16 v[212:215], v[104:107], v[68:71], v[212:215]
    ds_read_b64_tr_b16 v[104:105], v56 offset:57344
    s_waitcnt lgkmcnt(13)
    v_mfma_f32_16x16x32_bf16 v[220:223], v[108:111], v[68:71], v[220:223]
    ds_read_b64_tr_b16 v[106:107], v56 offset:58368
    v_mfma_f32_16x16x32_bf16 v[216:219], v[108:111], v[64:67], v[216:219]
    ds_read_b64_tr_b16 v[108:109], v57 offset:57344
    s_waitcnt lgkmcnt(13)
    v_mfma_f32_16x16x32_bf16 v[224:227], v[112:115], v[64:67], v[224:227]
    ds_read_b64_tr_b16 v[110:111], v57 offset:58368
    v_mfma_f32_16x16x32_bf16 v[228:231], v[112:115], v[68:71], v[228:231]
    ds_read_b64_tr_b16 v[112:113], v58 offset:57344
    s_waitcnt lgkmcnt(13)
    v_mfma_f32_16x16x32_bf16 v[236:239], v[116:119], v[68:71], v[236:239]
    ds_read_b64_tr_b16 v[114:115], v58 offset:58368
    v_mfma_f32_16x16x32_bf16 v[232:235], v[116:119], v[64:67], v[232:235]
    ds_read_b64_tr_b16 v[116:117], v59 offset:57344
    s_waitcnt lgkmcnt(13)
    v_mfma_f32_16x16x32_bf16 v[240:243], v[120:123], v[64:67], v[240:243]
    ds_read_b64_tr_b16 v[118:119], v59 offset:58368
    v_mfma_f32_16x16x32_bf16 v[244:247], v[120:123], v[68:71], v[244:247]
    ds_read_b64_tr_b16 v[120:121], v60 offset:57344
    s_waitcnt lgkmcnt(13)
    v_mfma_f32_16x16x32_bf16 v[252:255], v[124:127], v[68:71], v[252:255]
    ds_read_b64_tr_b16 v[122:123], v60 offset:58368
    v_mfma_f32_16x16x32_bf16 v[248:251], v[124:127], v[64:67], v[248:251]
    ds_read_b64_tr_b16 v[124:125], v61 offset:57344
    ds_read_b64_tr_b16 v[126:127], v61 offset:58368
    buffer_load_dwordx4 v[64:67], v13, s[8:11], s88 offen offset:1024 sc1
    buffer_load_dwordx4 v[68:71], v12, s[8:11], s88 offen offset:1024 sc1
    s_waitcnt vmcnt(13)
    s_waitcnt lgkmcnt(14)
    v_mfma_f32_16x16x32_bf16 v[192:195], v[96:99], v[72:75], v[192:195]
    v_xor_b32 v54, 0x10000, v54
    v_mfma_f32_16x16x32_bf16 v[196:199], v[96:99], v[76:79], v[196:199]
    s_waitcnt lgkmcnt(12)
    v_mfma_f32_16x16x32_bf16 v[204:207], v[100:103], v[76:79], v[204:207]
    v_xor_b32 v55, 0x10000, v55
    v_mfma_f32_16x16x32_bf16 v[200:203], v[100:103], v[72:75], v[200:203]
    s_waitcnt lgkmcnt(0)
    s_barrier
    ds_read_b64_tr_b16 v[96:97], v54 offset:0
    ds_read_b64_tr_b16 v[98:99], v54 offset:1024
    ds_read_b64_tr_b16 v[100:101], v55 offset:0
    v_mfma_f32_16x16x32_bf16 v[208:211], v[104:107], v[72:75], v[208:211]
    ds_read_b64_tr_b16 v[102:103], v55 offset:1024
    v_xor_b32 v56, 0x10000, v56
    v_mfma_f32_16x16x32_bf16 v[212:215], v[104:107], v[76:79], v[212:215]
    ds_read_b64_tr_b16 v[104:105], v56 offset:0
    v_mfma_f32_16x16x32_bf16 v[220:223], v[108:111], v[76:79], v[220:223]
    ds_read_b64_tr_b16 v[106:107], v56 offset:1024
    v_xor_b32 v57, 0x10000, v57
    v_mfma_f32_16x16x32_bf16 v[216:219], v[108:111], v[72:75], v[216:219]
    ds_read_b64_tr_b16 v[108:109], v57 offset:0
    v_mfma_f32_16x16x32_bf16 v[224:227], v[112:115], v[72:75], v[224:227]
    ds_read_b64_tr_b16 v[110:111], v57 offset:1024
    v_xor_b32 v58, 0x10000, v58
    v_mfma_f32_16x16x32_bf16 v[228:231], v[112:115], v[76:79], v[228:231]
    ds_read_b64_tr_b16 v[112:113], v58 offset:0
    v_mfma_f32_16x16x32_bf16 v[236:239], v[116:119], v[76:79], v[236:239]
    ds_read_b64_tr_b16 v[114:115], v58 offset:1024
    v_xor_b32 v59, 0x10000, v59
    v_mfma_f32_16x16x32_bf16 v[232:235], v[116:119], v[72:75], v[232:235]
    ds_read_b64_tr_b16 v[116:117], v59 offset:0
    v_mfma_f32_16x16x32_bf16 v[240:243], v[120:123], v[72:75], v[240:243]
    ds_read_b64_tr_b16 v[118:119], v59 offset:1024
    v_xor_b32 v60, 0x10000, v60
    v_mfma_f32_16x16x32_bf16 v[244:247], v[120:123], v[76:79], v[244:247]
    ds_read_b64_tr_b16 v[120:121], v60 offset:0
    v_mfma_f32_16x16x32_bf16 v[252:255], v[124:127], v[76:79], v[252:255]
    ds_read_b64_tr_b16 v[122:123], v60 offset:1024
    v_xor_b32 v61, 0x10000, v61
    v_mfma_f32_16x16x32_bf16 v[248:251], v[124:127], v[72:75], v[248:251]
    ds_read_b64_tr_b16 v[124:125], v61 offset:0
    ds_read_b64_tr_b16 v[126:127], v61 offset:1024
    buffer_load_dwordx4 v[72:75], v13, s[8:11], s88 offen offset:2048 sc1
    buffer_load_dwordx4 v[76:79], v12, s[8:11], s88 offen offset:2048 sc1
    s_waitcnt vmcnt(13)
    s_waitcnt lgkmcnt(14)
    v_mfma_f32_16x16x32_bf16 v[192:195], v[96:99], v[80:83], v[192:195]
    v_mfma_f32_16x16x32_bf16 v[196:199], v[96:99], v[84:87], v[196:199]
    ds_read_b64_tr_b16 v[96:97], v54 offset:8192
    s_waitcnt lgkmcnt(13)
    v_mfma_f32_16x16x32_bf16 v[204:207], v[100:103], v[84:87], v[204:207]
    ds_read_b64_tr_b16 v[98:99], v54 offset:9216
    v_mfma_f32_16x16x32_bf16 v[200:203], v[100:103], v[80:83], v[200:203]
    ds_read_b64_tr_b16 v[100:101], v55 offset:8192
    s_waitcnt lgkmcnt(13)
    v_mfma_f32_16x16x32_bf16 v[208:211], v[104:107], v[80:83], v[208:211]
    ds_read_b64_tr_b16 v[102:103], v55 offset:9216
    v_mfma_f32_16x16x32_bf16 v[212:215], v[104:107], v[84:87], v[212:215]
    ds_read_b64_tr_b16 v[104:105], v56 offset:8192
    s_waitcnt lgkmcnt(13)
    v_mfma_f32_16x16x32_bf16 v[220:223], v[108:111], v[84:87], v[220:223]
    ds_read_b64_tr_b16 v[106:107], v56 offset:9216
    v_mfma_f32_16x16x32_bf16 v[216:219], v[108:111], v[80:83], v[216:219]
    ds_read_b64_tr_b16 v[108:109], v57 offset:8192
    s_waitcnt lgkmcnt(13)
    v_mfma_f32_16x16x32_bf16 v[224:227], v[112:115], v[80:83], v[224:227]
    ds_read_b64_tr_b16 v[110:111], v57 offset:9216
    v_mfma_f32_16x16x32_bf16 v[228:231], v[112:115], v[84:87], v[228:231]
    ds_read_b64_tr_b16 v[112:113], v58 offset:8192
    s_waitcnt lgkmcnt(13)
    v_mfma_f32_16x16x32_bf16 v[236:239], v[116:119], v[84:87], v[236:239]
    ds_read_b64_tr_b16 v[114:115], v58 offset:9216
    v_mfma_f32_16x16x32_bf16 v[232:235], v[116:119], v[80:83], v[232:235]
    ds_read_b64_tr_b16 v[116:117], v59 offset:8192
    s_waitcnt lgkmcnt(13)
    v_mfma_f32_16x16x32_bf16 v[240:243], v[120:123], v[80:83], v[240:243]
    ds_read_b64_tr_b16 v[118:119], v59 offset:9216
    v_mfma_f32_16x16x32_bf16 v[244:247], v[120:123], v[84:87], v[244:247]
    ds_read_b64_tr_b16 v[120:121], v60 offset:8192
    s_waitcnt lgkmcnt(13)
    v_mfma_f32_16x16x32_bf16 v[252:255], v[124:127], v[84:87], v[252:255]
    ds_read_b64_tr_b16 v[122:123], v60 offset:9216
    v_mfma_f32_16x16x32_bf16 v[248:251], v[124:127], v[80:83], v[248:251]
    ds_read_b64_tr_b16 v[124:125], v61 offset:8192
    ds_read_b64_tr_b16 v[126:127], v61 offset:9216
    buffer_load_dwordx4 v[80:83], v13, s[8:11], s88 offen offset:3072 sc1
    buffer_load_dwordx4 v[84:87], v12, s[8:11], s88 offen offset:3072 sc1
    s_waitcnt vmcnt(13)
    s_waitcnt lgkmcnt(14)
    v_mfma_f32_16x16x32_bf16 v[192:195], v[96:99], v[88:91], v[192:195]
    v_mfma_f32_16x16x32_bf16 v[196:199], v[96:99], v[92:95], v[196:199]
    ds_read_b64_tr_b16 v[96:97], v54 offset:16384
    s_waitcnt lgkmcnt(13)
    v_mfma_f32_16x16x32_bf16 v[204:207], v[100:103], v[92:95], v[204:207]
    ds_read_b64_tr_b16 v[98:99], v54 offset:17408
    v_mfma_f32_16x16x32_bf16 v[200:203], v[100:103], v[88:91], v[200:203]
    ds_read_b64_tr_b16 v[100:101], v55 offset:16384
    s_waitcnt lgkmcnt(13)
    v_mfma_f32_16x16x32_bf16 v[208:211], v[104:107], v[88:91], v[208:211]
    ds_read_b64_tr_b16 v[102:103], v55 offset:17408
    v_mfma_f32_16x16x32_bf16 v[212:215], v[104:107], v[92:95], v[212:215]
    ds_read_b64_tr_b16 v[104:105], v56 offset:16384
    s_waitcnt lgkmcnt(13)
    v_mfma_f32_16x16x32_bf16 v[220:223], v[108:111], v[92:95], v[220:223]
    ds_read_b64_tr_b16 v[106:107], v56 offset:17408
    v_mfma_f32_16x16x32_bf16 v[216:219], v[108:111], v[88:91], v[216:219]
    ds_read_b64_tr_b16 v[108:109], v57 offset:16384
    s_waitcnt lgkmcnt(13)
    v_mfma_f32_16x16x32_bf16 v[224:227], v[112:115], v[88:91], v[224:227]
    ds_read_b64_tr_b16 v[110:111], v57 offset:17408
    v_mfma_f32_16x16x32_bf16 v[228:231], v[112:115], v[92:95], v[228:231]
    ds_read_b64_tr_b16 v[112:113], v58 offset:16384
    s_waitcnt lgkmcnt(13)
    v_mfma_f32_16x16x32_bf16 v[236:239], v[116:119], v[92:95], v[236:239]
    ds_read_b64_tr_b16 v[114:115], v58 offset:17408
    v_mfma_f32_16x16x32_bf16 v[232:235], v[116:119], v[88:91], v[232:235]
    ds_read_b64_tr_b16 v[116:117], v59 offset:16384
    s_waitcnt lgkmcnt(13)
    v_mfma_f32_16x16x32_bf16 v[240:243], v[120:123], v[88:91], v[240:243]
    ds_read_b64_tr_b16 v[118:119], v59 offset:17408
    v_mfma_f32_16x16x32_bf16 v[244:247], v[120:123], v[92:95], v[244:247]
    ds_read_b64_tr_b16 v[120:121], v60 offset:16384
    s_waitcnt lgkmcnt(13)
    v_mfma_f32_16x16x32_bf16 v[252:255], v[124:127], v[92:95], v[252:255]
    ds_read_b64_tr_b16 v[122:123], v60 offset:17408
    v_mfma_f32_16x16x32_bf16 v[248:251], v[124:127], v[88:91], v[248:251]
    ds_read_b64_tr_b16 v[124:125], v61 offset:16384
    ds_read_b64_tr_b16 v[126:127], v61 offset:17408
    s_waitcnt vmcnt(10)
    s_waitcnt lgkmcnt(14)
    v_mfma_f32_16x16x32_bf16 v[192:195], v[96:99], v[16:19], v[192:195]
    v_mfma_f32_16x16x32_bf16 v[196:199], v[96:99], v[20:23], v[196:199]
    ds_read_b64_tr_b16 v[96:97], v54 offset:24576
    s_waitcnt lgkmcnt(13)
    v_mfma_f32_16x16x32_bf16 v[204:207], v[100:103], v[20:23], v[204:207]
    ds_read_b64_tr_b16 v[98:99], v54 offset:25600
    v_mfma_f32_16x16x32_bf16 v[200:203], v[100:103], v[16:19], v[200:203]
    ds_read_b64_tr_b16 v[100:101], v55 offset:24576
    s_waitcnt lgkmcnt(13)
    v_mfma_f32_16x16x32_bf16 v[208:211], v[104:107], v[16:19], v[208:211]
    ds_read_b64_tr_b16 v[102:103], v55 offset:25600
    v_mfma_f32_16x16x32_bf16 v[212:215], v[104:107], v[20:23], v[212:215]
    ds_read_b64_tr_b16 v[104:105], v56 offset:24576
    s_waitcnt lgkmcnt(13)
    v_mfma_f32_16x16x32_bf16 v[220:223], v[108:111], v[20:23], v[220:223]
    ds_read_b64_tr_b16 v[106:107], v56 offset:25600
    v_mfma_f32_16x16x32_bf16 v[216:219], v[108:111], v[16:19], v[216:219]
    ds_read_b64_tr_b16 v[108:109], v57 offset:24576
    s_waitcnt lgkmcnt(13)
    v_mfma_f32_16x16x32_bf16 v[224:227], v[112:115], v[16:19], v[224:227]
    ds_read_b64_tr_b16 v[110:111], v57 offset:25600
    v_mfma_f32_16x16x32_bf16 v[228:231], v[112:115], v[20:23], v[228:231]
    ds_read_b64_tr_b16 v[112:113], v58 offset:24576
    s_waitcnt lgkmcnt(13)
    v_mfma_f32_16x16x32_bf16 v[236:239], v[116:119], v[20:23], v[236:239]
    ds_read_b64_tr_b16 v[114:115], v58 offset:25600
    v_mfma_f32_16x16x32_bf16 v[232:235], v[116:119], v[16:19], v[232:235]
    ds_read_b64_tr_b16 v[116:117], v59 offset:24576
    s_waitcnt lgkmcnt(13)
    v_mfma_f32_16x16x32_bf16 v[240:243], v[120:123], v[16:19], v[240:243]
    ds_read_b64_tr_b16 v[118:119], v59 offset:25600
    v_mfma_f32_16x16x32_bf16 v[244:247], v[120:123], v[20:23], v[244:247]
    ds_read_b64_tr_b16 v[120:121], v60 offset:24576
    s_waitcnt lgkmcnt(13)
    v_mfma_f32_16x16x32_bf16 v[252:255], v[124:127], v[20:23], v[252:255]
    ds_read_b64_tr_b16 v[122:123], v60 offset:25600
    v_mfma_f32_16x16x32_bf16 v[248:251], v[124:127], v[16:19], v[248:251]
    ds_read_b64_tr_b16 v[124:125], v61 offset:24576
    ds_read_b64_tr_b16 v[126:127], v61 offset:25600
    s_waitcnt vmcnt(8)
    s_waitcnt lgkmcnt(14)
    v_mfma_f32_16x16x32_bf16 v[192:195], v[96:99], v[24:27], v[192:195]
    v_mfma_f32_16x16x32_bf16 v[196:199], v[96:99], v[28:31], v[196:199]
    ds_read_b64_tr_b16 v[96:97], v54 offset:32768
    s_waitcnt lgkmcnt(13)
    v_mfma_f32_16x16x32_bf16 v[204:207], v[100:103], v[28:31], v[204:207]
    ds_read_b64_tr_b16 v[98:99], v54 offset:33792
    v_mfma_f32_16x16x32_bf16 v[200:203], v[100:103], v[24:27], v[200:203]
    ds_read_b64_tr_b16 v[100:101], v55 offset:32768
    s_waitcnt lgkmcnt(13)
    v_mfma_f32_16x16x32_bf16 v[208:211], v[104:107], v[24:27], v[208:211]
    ds_read_b64_tr_b16 v[102:103], v55 offset:33792
    v_mfma_f32_16x16x32_bf16 v[212:215], v[104:107], v[28:31], v[212:215]
    ds_read_b64_tr_b16 v[104:105], v56 offset:32768
    s_waitcnt lgkmcnt(13)
    v_mfma_f32_16x16x32_bf16 v[220:223], v[108:111], v[28:31], v[220:223]
    ds_read_b64_tr_b16 v[106:107], v56 offset:33792
    v_mfma_f32_16x16x32_bf16 v[216:219], v[108:111], v[24:27], v[216:219]
    ds_read_b64_tr_b16 v[108:109], v57 offset:32768
    s_waitcnt lgkmcnt(13)
    v_mfma_f32_16x16x32_bf16 v[224:227], v[112:115], v[24:27], v[224:227]
    ds_read_b64_tr_b16 v[110:111], v57 offset:33792
    v_mfma_f32_16x16x32_bf16 v[228:231], v[112:115], v[28:31], v[228:231]
    ds_read_b64_tr_b16 v[112:113], v58 offset:32768
    s_waitcnt lgkmcnt(13)
    v_mfma_f32_16x16x32_bf16 v[236:239], v[116:119], v[28:31], v[236:239]
    ds_read_b64_tr_b16 v[114:115], v58 offset:33792
    v_mfma_f32_16x16x32_bf16 v[232:235], v[116:119], v[24:27], v[232:235]
    ds_read_b64_tr_b16 v[116:117], v59 offset:32768
    s_waitcnt lgkmcnt(13)
    v_mfma_f32_16x16x32_bf16 v[240:243], v[120:123], v[24:27], v[240:243]
    ds_read_b64_tr_b16 v[118:119], v59 offset:33792
    v_mfma_f32_16x16x32_bf16 v[244:247], v[120:123], v[28:31], v[244:247]
    ds_read_b64_tr_b16 v[120:121], v60 offset:32768
    s_waitcnt lgkmcnt(13)
    v_mfma_f32_16x16x32_bf16 v[252:255], v[124:127], v[28:31], v[252:255]
    ds_read_b64_tr_b16 v[122:123], v60 offset:33792
    v_mfma_f32_16x16x32_bf16 v[248:251], v[124:127], v[24:27], v[248:251]
    ds_read_b64_tr_b16 v[124:125], v61 offset:32768
    ds_read_b64_tr_b16 v[126:127], v61 offset:33792
    s_waitcnt vmcnt(0)
    s_cmp_ge_u32 s3, 4
    s_cbranch_scc1 L_q_nold
    s_lshl_b32 s7, s4, 10
    s_add_u32 s7, s7, 3866624
    v_lshrrev_b32 v2, 3, v1
    v_and_b32 v3, 7, v1
    v_lshlrev_b32 v3, 2, v3
    v_lshl_add_u32 v3, v2, 7, v3
    s_mov_b32 s79, 262144
L_poll_7:
    buffer_load_dword v2, v3, s[8:11], s7 offen sc1
    s_waitcnt vmcnt(0)
    v_cmp_gt_u32 vcc, 1, v2
    s_cbranch_vccz L_polldone_8
    s_sleep 2
    s_sub_u32 s79, s79, 1
    s_cmp_lg_u32 s79, 0
    s_cbranch_scc1 L_poll_7
L_polldone_8:
    s_lshl_b32 s6, s76, 13
    s_add_u32 s6, s6, s78
    s_add_u32 m0, s6, 0
    s_add_u32 s7, s77, 0
    buffer_load_dwordx4 v49, s[8:11], s7 offen offset:0 sc1 lds
    buffer_load_dwordx4 v49, s[8:11], s7 offen offset:1024 sc1 lds
    buffer_load_dwordx4 v49, s[8:11], s7 offen offset:2048 sc1 lds
    buffer_load_dwordx4 v49, s[8:11], s7 offen offset:3072 sc1 lds
    s_lshl_b32 s6, s76, 13
    s_add_u32 s6, s6, s78
    s_add_u32 m0, s6, 4096
    s_add_u32 s7, s77, 4096
    buffer_load_dwordx4 v49, s[8:11], s7 offen offset:0 sc1 lds
    buffer_load_dwordx4 v49, s[8:11], s7 offen offset:1024 sc1 lds
    buffer_load_dwordx4 v49, s[8:11], s7 offen offset:2048 sc1 lds
    buffer_load_dwordx4 v49, s[8:11], s7 offen offset:3072 sc1 lds
    s_lshl_b32 s6, s76, 12
    s_add_u32 s6, s6, s78
    s_add_u32 m0, s6, 49152
    s_add_u32 s7, s77, 524288
    buffer_load_dwordx4 v50, s[8:11], s7 offen offset:0 sc1 lds
    buffer_load_dwordx4 v50, s[8:11], s7 offen offset:1024 sc1 lds
    buffer_load_dwordx4 v50, s[8:11], s7 offen offset:2048 sc1 lds
    buffer_load_dwordx4 v50, s[8:11], s7 offen offset:3072 sc1 lds
L_q_nold:
    s_waitcnt lgkmcnt(14)
    v_mfma_f32_16x16x32_bf16 v[192:195], v[96:99], v[32:35], v[192:195]
    v_mfma_f32_16x16x32_bf16 v[196:199], v[96:99], v[36:39], v[196:199]
    ds_read_b64_tr_b16 v[96:97], v54 offset:40960
    s_waitcnt lgkmcnt(13)
    v_mfma_f32_16x16x32_bf16 v[204:207], v[100:103], v[36:39], v[204:207]
    ds_read_b64_tr_b16 v[98:99], v54 offset:41984
    v_mfma_f32_16x16x32_bf16 v[200:203], v[100:103], v[32:35], v[200:203]
    ds_read_b64_tr_b16 v[100:101], v55 offset:40960
    s_waitcnt lgkmcnt(13)
    v_mfma_f32_16x16x32_bf16 v[208:211], v[104:107], v[32:35], v[208:211]
    ds_read_b64_tr_b16 v[102:103], v55 offset:41984
    v_mfma_f32_16x16x32_bf16 v[212:215], v[104:107], v[36:39], v[212:215]
    ds_read_b64_tr_b16 v[104:105], v56 offset:40960
    s_waitcnt lgkmcnt(13)
    v_mfma_f32_16x16x32_bf16 v[220:223], v[108:111], v[36:39], v[220:223]
    ds_read_b64_tr_b16 v[106:107], v56 offset:41984
    buffer_store_dwordx4 v[144:147], v13, s[8:11], s67 offen sc1
    s_add_u32 s67, s67, 1024
    v_mfma_f32_16x16x32_bf16 v[216:219], v[108:111], v[32:35], v[216:219]
    ds_read_b64_tr_b16 v[108:109], v57 offset:40960
    s_waitcnt lgkmcnt(13)
    v_mfma_f32_16x16x32_bf16 v[224:227], v[112:115], v[32:35], v[224:227]
    ds_read_b64_tr_b16 v[110:111], v57 offset:41984
    v_mfma_f32_16x16x32_bf16 v[228:231], v[112:115], v[36:39], v[228:231]
    ds_read_b64_tr_b16 v[112:113], v58 offset:40960
    s_waitcnt lgkmcnt(13)
    v_mfma_f32_16x16x32_bf16 v[236:239], v[116:119], v[36:39], v[236:239]
    ds_read_b64_tr_b16 v[114:115], v58 offset:41984
    v_mfma_f32_16x16x32_bf16 v[232:235], v[116:119], v[32:35], v[232:235]
    ds_read_b64_tr_b16 v[116:117], v59 offset:40960
    s_waitcnt lgkmcnt(13)
    v_mfma_f32_16x16x32_bf16 v[240:243], v[120:123], v[32:35], v[240:243]
    ds_read_b64_tr_b16 v[118:119], v59 offset:41984
    v_mfma_f32_16x16x32_bf16 v[244:247], v[120:123], v[36:39], v[244:247]
    ds_read_b64_tr_b16 v[120:121], v60 offset:40960
    s_waitcnt lgkmcnt(13)
    v_mfma_f32_16x16x32_bf16 v[252:255], v[124:127], v[36:39], v[252:255]
    ds_read_b64_tr_b16 v[122:123], v60 offset:41984
    v_mfma_f32_16x16x32_bf16 v[248:251], v[124:127], v[32:35], v[248:251]
    ds_read_b64_tr_b16 v[124:125], v61 offset:40960
    ds_read_b64_tr_b16 v[126:127], v61 offset:41984
    s_waitcnt lgkmcnt(14)
    v_mfma_f32_16x16x32_bf16 v[192:195], v[96:99], v[64:67], v[192:195]
    v_mfma_f32_16x16x32_bf16 v[196:199], v[96:99], v[68:71], v[196:199]
    ds_read_b64_tr_b16 v[96:97], v54 offset:49152
    s_waitcnt lgkmcnt(13)
    v_mfma_f32_16x16x32_bf16 v[204:207], v[100:103], v[68:71], v[204:207]
    ds_read_b64_tr_b16 v[98:99], v54 offset:50176
    v_mfma_f32_16x16x32_bf16 v[200:203], v[100:103], v[64:67], v[200:203]
    ds_read_b64_tr_b16 v[100:101], v55 offset:49152
    s_waitcnt lgkmcnt(13)
    v_mfma_f32_16x16x32_bf16 v[208:211], v[104:107], v[64:67], v[208:211]
    ds_read_b64_tr_b16 v[102:103], v55 offset:50176
    v_mfma_f32_16x16x32_bf16 v[212:215], v[104:107], v[68:71], v[212:215]
    ds_read_b64_tr_b16 v[104:105], v56 offset:49152
    s_waitcnt lgkmcnt(13)
    v_mfma_f32_16x16x32_bf16 v[220:223], v[108:111], v[68:71], v[220:223]
    ds_read_b64_tr_b16 v[106:107], v56 offset:50176
    buffer_store_dwordx4 v[148:151], v13, s[8:11], s67 offen sc1
    s_add_u32 s67, s67, s68
    v_mfma_f32_16x16x32_bf16 v[216:219], v[108:111], v[64:67], v[216:219]
    ds_read_b64_tr_b16 v[108:109], v57 offset:49152
    s_waitcnt lgkmcnt(13)
    v_mfma_f32_16x16x32_bf16 v[224:227], v[112:115], v[64:67], v[224:227]
    ds_read_b64_tr_b16 v[110:111], v57 offset:50176
    v_mfma_f32_16x16x32_bf16 v[228:231], v[112:115], v[68:71], v[228:231]
    ds_read_b64_tr_b16 v[112:113], v58 offset:49152
    s_waitcnt lgkmcnt(13)
    v_mfma_f32_16x16x32_bf16 v[236:239], v[116:119], v[68:71], v[236:239]
    ds_read_b64_tr_b16 v[114:115], v58 offset:50176
    v_mfma_f32_16x16x32_bf16 v[232:235], v[116:119], v[64:67], v[232:235]
    ds_read_b64_tr_b16 v[116:117], v59 offset:49152
    s_waitcnt lgkmcnt(13)
    v_mfma_f32_16x16x32_bf16 v[240:243], v[120:123], v[64:67], v[240:243]
    ds_read_b64_tr_b16 v[118:119], v59 offset:50176
    v_mfma_f32_16x16x32_bf16 v[244:247], v[120:123], v[68:71], v[244:247]
    ds_read_b64_tr_b16 v[120:121], v60 offset:49152
    s_waitcnt lgkmcnt(13)
    v_mfma_f32_16x16x32_bf16 v[252:255], v[124:127], v[68:71], v[252:255]
    ds_read_b64_tr_b16 v[122:123], v60 offset:50176
    v_mfma_f32_16x16x32_bf16 v[248:251], v[124:127], v[64:67], v[248:251]
    ds_read_b64_tr_b16 v[124:125], v61 offset:49152
    ds_read_b64_tr_b16 v[126:127], v61 offset:50176
    s_waitcnt lgkmcnt(14)
    v_mfma_f32_16x16x32_bf16 v[192:195], v[96:99], v[72:75], v[192:195]
    v_mfma_f32_16x16x32_bf16 v[196:199], v[96:99], v[76:79], v[196:199]
    ds_read_b64_tr_b16 v[96:97], v54 offset:57344
    s_waitcnt lgkmcnt(13)
    v_mfma_f32_16x16x32_bf16 v[204:207], v[100:103], v[76:79], v[204:207]
    ds_read_b64_tr_b16 v[98:99], v54 offset:58368
    v_mfma_f32_16x16x32_bf16 v[200:203], v[100:103], v[72:75], v[200:203]
    ds_read_b64_tr_b16 v[100:101], v55 offset:57344
    s_waitcnt lgkmcnt(13)
    v_mfma_f32_16x16x32_bf16 v[208:211], v[104:107], v[72:75], v[208:211]
    ds_read_b64_tr_b16 v[102:103], v55 offset:58368
    v_mfma_f32_16x16x32_bf16 v[212:215], v[104:107], v[76:79], v[212:215]
    ds_read_b64_tr_b16 v[104:105], v56 offset:57344
    s_waitcnt lgkmcnt(13)
    v_mfma_f32_16x16x32_bf16 v[220:223], v[108:111], v[76:79], v[220:223]
    ds_read_b64_tr_b16 v[106:107], v56 offset:58368
    buffer_store_dwordx4 v[152:155], v13, s[8:11], s67 offen sc1
    s_add_u32 s67, s67, 1024
    v_mfma_f32_16x16x32_bf16 v[216:219], v[108:111], v[72:75], v[216:219]
    ds_read_b64_tr_b16 v[108:109], v57 offset:57344
    s_waitcnt lgkmcnt(13)
    v_mfma_f32_16x16x32_bf16 v[224:227], v[112:115], v[72:75], v[224:227]
    ds_read_b64_tr_b16 v[110:111], v57 offset:58368
    v_mfma_f32_16x16x32_bf16 v[228:231], v[112:115], v[76:79], v[228:231]
    ds_read_b64_tr_b16 v[112:113], v58 offset:57344
    s_waitcnt lgkmcnt(13)
    v_mfma_f32_16x16x32_bf16 v[236:239], v[116:119], v[76:79], v[236:239]
    ds_read_b64_tr_b16 v[114:115], v58 offset:58368
    v_mfma_f32_16x16x32_bf16 v[232:235], v[116:119], v[72:75], v[232:235]
    ds_read_b64_tr_b16 v[116:117], v59 offset:57344
    s_waitcnt lgkmcnt(13)
    v_mfma_f32_16x16x32_bf16 v[240:243], v[120:123], v[72:75], v[240:243]
    ds_read_b64_tr_b16 v[118:119], v59 offset:58368
    v_mfma_f32_16x16x32_bf16 v[244:247], v[120:123], v[76:79], v[244:247]
    ds_read_b64_tr_b16 v[120:121], v60 offset:57344
    s_waitcnt lgkmcnt(13)
    v_mfma_f32_16x16x32_bf16 v[252:255], v[124:127], v[76:79], v[252:255]
    ds_read_b64_tr_b16 v[122:123], v60 offset:58368
    v_mfma_f32_16x16x32_bf16 v[248:251], v[124:127], v[72:75], v[248:251]
    ds_read_b64_tr_b16 v[124:125], v61 offset:57344
    ds_read_b64_tr_b16 v[126:127], v61 offset:58368
    s_waitcnt lgkmcnt(14)
    v_mfma_f32_16x16x32_bf16 v[192:195], v[96:99], v[80:83], v[192:195]
    v_mfma_f32_16x16x32_bf16 v[196:199], v[96:99], v[84:87], v[196:199]
    s_waitcnt lgkmcnt(12)
    v_mfma_f32_16x16x32_bf16 v[204:207], v[100:103], v[84:87], v[204:207]
    v_mfma_f32_16x16x32_bf16 v[200:203], v[100:103], v[80:83], v[200:203]
    s_waitcnt lgkmcnt(10)
    v_mfma_f32_16x16x32_bf16 v[208:211], v[104:107], v[80:83], v[208:211]
    v_mfma_f32_16x16x32_bf16 v[212:215], v[104:107], v[84:87], v[212:215]
    s_waitcnt lgkmcnt(8)
    v_mfma_f32_16x16x32_bf16 v[220:223], v[108:111], v[84:87], v[220:223]
    buffer_store_dwordx4 v[156:159], v13, s[8:11], s67 offen sc1
    s_add_u32 s67, s67, s69
    v_mfma_f32_16x16x32_bf16 v[216:219], v[108:111], v[80:83], v[216:219]
    s_waitcnt lgkmcnt(6)
    v_mfma_f32_16x16x32_bf16 v[224:227], v[112:115], v[80:83], v[224:227]
    v_mfma_f32_16x16x32_bf16 v[228:231], v[112:115], v[84:87], v[228:231]
    s_waitcnt lgkmcnt(4)
    v_mfma_f32_16x16x32_bf16 v[236:239], v[116:119], v[84:87], v[236:239]
    v_mfma_f32_16x16x32_bf16 v[232:235], v[116:119], v[80:83], v[232:235]
    s_waitcnt lgkmcnt(2)
    v_mfma_f32_16x16x32_bf16 v[240:243], v[120:123], v[80:83], v[240:243]
    v_mfma_f32_16x16x32_bf16 v[244:247], v[120:123], v[84:87], v[244:247]
    s_waitcnt lgkmcnt(0)
    v_mfma_f32_16x16x32_bf16 v[252:255], v[124:127], v[84:87], v[252:255]
    v_mfma_f32_16x16x32_bf16 v[248:251], v[124:127], v[80:83], v[248:251]
    s_cmp_lt_u32 s3, 4
    s_cbranch_scc1 L_qb
    s_barrier
L_qb:
    s_mov_b32 s6, 0x3e0293ee
    s_nop 7
    buffer_store_dwordx4 v[160:163], v13, s[8:11], s67 offen sc1
    s_add_u32 s67, s67, 1024
    buffer_store_dwordx4 v[164:167], v13, s[8:11], s67 offen sc1
    s_add_u32 s67, s67, s68
    buffer_store_dwordx4 v[168:171], v13, s[8:11], s67 offen sc1
    s_add_u32 s67, s67, 1024
    buffer_store_dwordx4 v[172:175], v13, s[8:11], s67 offen sc1
    s_add_u32 s67, s67, s69
    v_mul_f32 v192, s6, v192
    v_mul_f32 v193, s6, v193
    v_mul_f32 v194, s6, v194
    v_mul_f32 v195, s6, v195
    v_cvt_pk_bf16_f32 v16, v192, v193
    v_cvt_pk_bf16_f32 v17, v194, v195
    v_mul_f32 v200, s6, v200
    v_mul_f32 v201, s6, v201
    v_mul_f32 v202, s6, v202
    v_mul_f32 v203, s6, v203
    v_cvt_pk_bf16_f32 v18, v200, v201
    v_cvt_pk_bf16_f32 v19, v202, v203
    v_mul_f32 v208, s6, v208
    v_mul_f32 v209, s6, v209
    v_mul_f32 v210, s6, v210
    v_mul_f32 v211, s6, v211
    v_cvt_pk_bf16_f32 v20, v208, v209
    v_cvt_pk_bf16_f32 v21, v210, v211
    v_mul_f32 v216, s6, v216
    v_mul_f32 v217, s6, v217
    v_mul_f32 v218, s6, v218
    v_mul_f32 v219, s6, v219
    v_cvt_pk_bf16_f32 v22, v216, v217
    v_cvt_pk_bf16_f32 v23, v218, v219
    v_mul_f32 v224, s6, v224
    v_mul_f32 v225, s6, v225
    v_mul_f32 v226, s6, v226
    v_mul_f32 v227, s6, v227
    v_cvt_pk_bf16_f32 v24, v224, v225
    v_cvt_pk_bf16_f32 v25, v226, v227
    v_mul_f32 v232, s6, v232
    v_mul_f32 v233, s6, v233
    v_mul_f32 v234, s6, v234
    v_mul_f32 v235, s6, v235
    v_cvt_pk_bf16_f32 v26, v232, v233
    v_cvt_pk_bf16_f32 v27, v234, v235
    v_mul_f32 v240, s6, v240
    v_mul_f32 v241, s6, v241
    v_mul_f32 v242, s6, v242
    v_mul_f32 v243, s6, v243
    v_cvt_pk_bf16_f32 v28, v240, v241
    v_cvt_pk_bf16_f32 v29, v242, v243
    v_mul_f32 v248, s6, v248
    v_mul_f32 v249, s6, v249
    v_mul_f32 v250, s6, v250
    v_mul_f32 v251, s6, v251
    v_cvt_pk_bf16_f32 v30, v248, v249
    v_cvt_pk_bf16_f32 v31, v250, v251
    v_mul_f32 v196, s6, v196
    v_mul_f32 v197, s6, v197
    v_mul_f32 v198, s6, v198
    v_mul_f32 v199, s6, v199
    v_cvt_pk_bf16_f32 v32, v196, v197
    v_cvt_pk_bf16_f32 v33, v198, v199
    v_mul_f32 v204, s6, v204
    v_mul_f32 v205, s6, v205
    v_mul_f32 v206, s6, v206
    v_mul_f32 v207, s6, v207
    v_cvt_pk_bf16_f32 v34, v204, v205
    v_cvt_pk_bf16_f32 v35, v206, v207
    v_mul_f32 v212, s6, v212
    v_mul_f32 v213, s6, v213
    v_mul_f32 v214, s6, v214
    v_mul_f32 v215, s6, v215
    v_cvt_pk_bf16_f32 v36, v212, v213
    v_cvt_pk_bf16_f32 v37, v214, v215
    v_mul_f32 v220, s6, v220
    v_mul_f32 v221, s6, v221
    v_mul_f32 v222, s6, v222
    v_mul_f32 v223, s6, v223
    v_cvt_pk_bf16_f32 v38, v220, v221
    v_cvt_pk_bf16_f32 v39, v222, v223
    v_mul_f32 v228, s6, v228
    v_mul_f32 v229, s6, v229
    v_mul_f32 v230, s6, v230
    v_mul_f32 v231, s6, v231
    v_cvt_pk_bf16_f32 v40, v228, v229
    v_cvt_pk_bf16_f32 v41, v230, v231
    v_mul_f32 v236, s6, v236
    v_mul_f32 v237, s6, v237
    v_mul_f32 v238, s6, v238
    v_mul_f32 v239, s6, v239
    v_cvt_pk_bf16_f32 v42, v236, v237
    v_cvt_pk_bf16_f32 v43, v238, v239
    v_mul_f32 v244, s6, v244
    v_mul_f32 v245, s6, v245
    v_mul_f32 v246, s6, v246
    v_mul_f32 v247, s6, v247
    v_cvt_pk_bf16_f32 v44, v244, v245
    v_cvt_pk_bf16_f32 v45, v246, v247
    v_mul_f32 v252, s6, v252
    v_mul_f32 v253, s6, v253
    v_mul_f32 v254, s6, v254
    v_mul_f32 v255, s6, v255
    v_cvt_pk_bf16_f32 v46, v252, v253
    v_cvt_pk_bf16_f32 v47, v254, v255
    v_mov_b64 v[192:193], 0
    v_mov_b64 v[194:195], 0
    v_mov_b64 v[196:197], 0
    v_mov_b64 v[198:199], 0
    v_mov_b64 v[200:201], 0
    v_mov_b64 v[202:203], 0
    v_mov_b64 v[204:205], 0
    v_mov_b64 v[206:207], 0
    v_mov_b64 v[208:209], 0
    v_mov_b64 v[210:211], 0
    v_mov_b64 v[212:213], 0
    v_mov_b64 v[214:215], 0
    v_mov_b64 v[216:217], 0
    v_mov_b64 v[218:219], 0
    v_mov_b64 v[220:221], 0
    v_mov_b64 v[222:223], 0
    v_mov_b64 v[224:225], 0
    v_mov_b64 v[226:227], 0
    v_mov_b64 v[228:229], 0
    v_mov_b64 v[230:231], 0
    v_mov_b64 v[232:233], 0
    v_mov_b64 v[234:235], 0
    v_mov_b64 v[236:237], 0
    v_mov_b64 v[238:239], 0
    v_mov_b64 v[240:241], 0
    v_mov_b64 v[242:243], 0
    v_mov_b64 v[244:245], 0
    v_mov_b64 v[246:247], 0
    v_mov_b64 v[248:249], 0
    v_mov_b64 v[250:251], 0
    v_mov_b64 v[252:253], 0
    v_mov_b64 v[254:255], 0
    v_mov_b64 v[144:145], 0
    v_mov_b64 v[146:147], 0
    v_mov_b64 v[148:149], 0
    v_mov_b64 v[150:151], 0
    v_mov_b64 v[152:153], 0
    v_mov_b64 v[154:155], 0
    v_mov_b64 v[156:157], 0
    v_mov_b64 v[158:159], 0
    v_mov_b64 v[160:161], 0
    v_mov_b64 v[162:163], 0
    v_bfe_u32 v2, v1, 1, 1
    v_lshrrev_b32 v3, 5, v1
    v_cmp_eq_u32 vcc, v2, v3
    v_mov_b32 v2, 0x3f803f80
    v_and_b32 v3, 1, v1
    v_mul_u32_u24 v3, 0xaaaa, v3
    v_add_u32 v168, 0x4444, v3
    v_cndmask_b32 v164, 0, v2, vcc
    v_cndmask_b32 v165, 0, v2, vcc
    v_cndmask_b32 v166, 0, v2, vcc
    v_cndmask_b32 v167, 0, v2, vcc
    v_add_u32 v48, s100, v13
    s_waitcnt vmcnt(8)
    s_mov_b32 s72, 0x40004000
    s_mov_b32 s65, 0
    s_sub_u32 s63, 15, s5
    s_mov_b32 s62, -1
    s_cmp_ge_u32 s3, 4
    s_cbranch_scc1 L_qb2
    s_barrier
L_qb2:
    ds_read_b128 v[96:99], v48 offset:0
    ds_read_b128 v[100:103], v48 offset:1024
    ds_read_b128 v[104:107], v48 offset:2048
    ds_read_b128 v[108:111], v48 offset:3072
    ds_read_b128 v[112:115], v48 offset:4096
    ds_read_b128 v[116:119], v48 offset:5120
    ds_read_b128 v[120:123], v48 offset:6144
    ds_read_b128 v[124:127], v48 offset:7168
    s_cmp_lg_u32 s60, 0
    s_cbranch_scc1 L_nm0
    s_call_b64 s[82:83], L_mask
L_nm0:
    s_waitcnt lgkmcnt(7)
    v_mfma_f32_16x16x32_bf16 v[64:67], v[96:99], v[16:19], v[144:147]
    v_mfma_f32_16x16x32_bf16 v[68:71], v[96:99], v[32:35], v[148:151]
    ds_read_b128 v[96:99], v48 offset:8192
    s_waitcnt lgkmcnt(7)
    v_mfma_f32_16x16x32_bf16 v[64:67], v[100:103], v[20:23], v[64:67]
    v_mfma_f32_16x16x32_bf16 v[68:71], v[100:103], v[36:39], v[68:71]
    ds_read_b128 v[100:103], v48 offset:9216
    s_waitcnt lgkmcnt(7)
    v_mfma_f32_16x16x32_bf16 v[64:67], v[104:107], v[24:27], v[64:67]
    v_mfma_f32_16x16x32_bf16 v[68:71], v[104:107], v[40:43], v[68:71]
    ds_read_b128 v[104:107], v48 offset:10240
    s_waitcnt lgkmcnt(7)
    v_mfma_f32_16x16x32_bf16 v[64:67], v[108:111], v[28:31], v[64:67]
    v_mfma_f32_16x16x32_bf16 v[68:71], v[108:111], v[44:47], v[68:71]
    ds_read_b128 v[108:111], v48 offset:11264
    s_waitcnt lgkmcnt(7)
    v_mfma_f32_16x16x32_bf16 v[72:75], v[112:115], v[16:19], v[152:155]
    v_mfma_f32_16x16x32_bf16 v[76:79], v[112:115], v[32:35], v[156:159]
    ds_read_b128 v[112:115], v48 offset:12288
    s_waitcnt lgkmcnt(7)
    v_mfma_f32_16x16x32_bf16 v[72:75], v[116:119], v[20:23], v[72:75]
    v_mfma_f32_16x16x32_bf16 v[76:79], v[116:119], v[36:39], v[76:79]
    ds_read_b128 v[116:119], v48 offset:13312
    s_waitcnt lgkmcnt(7)
    v_mfma_f32_16x16x32_bf16 v[72:75], v[120:123], v[24:27], v[72:75]
    v_mfma_f32_16x16x32_bf16 v[76:79], v[120:123], v[40:43], v[76:79]
    ds_read_b128 v[120:123], v48 offset:14336
    s_waitcnt lgkmcnt(7)
    v_mfma_f32_16x16x32_bf16 v[72:75], v[124:127], v[28:31], v[72:75]
    v_mfma_f32_16x16x32_bf16 v[76:79], v[124:127], v[44:47], v[76:79]
    ds_read_b128 v[124:127], v48 offset:15360
    s_nop 7
    v_max3_f32 v58, v64, v65, v66
    v_max3_f32 v58, v58, v67, v72
    v_max3_f32 v58, v58, v73, v74
    v_max_f32 v58, v58, v75
    v_mov_b32 v60, v58
    s_nop 1
    v_permlane16_swap_b32 v58, v60
    s_nop 1
    v_max_f32 v58, v58, v60
    v_mov_b32 v60, v58
    s_nop 1
    v_permlane32_swap_b32 v58, v60
    s_nop 1
    v_max_f32 v58, v58, v60
    v_add_f32 v58, 0x41c00000, v58
    v_sub_f32 v64, v64, v58
    v_sub_f32 v144, 0, v58
    v_sub_f32 v65, v65, v58
    v_sub_f32 v145, 0, v58
    v_sub_f32 v66, v66, v58
    v_sub_f32 v146, 0, v58
    v_sub_f32 v67, v67, v58
    v_sub_f32 v147, 0, v58
    v_sub_f32 v72, v72, v58
    v_sub_f32 v152, 0, v58
    v_sub_f32 v73, v73, v58
    v_sub_f32 v153, 0, v58
    v_sub_f32 v74, v74, v58
    v_sub_f32 v154, 0, v58
    v_sub_f32 v75, v75, v58
    v_sub_f32 v155, 0, v58
    v_max3_f32 v59, v68, v69, v70
    v_max3_f32 v59, v59, v71, v76
    v_max3_f32 v59, v59, v77, v78
    v_max_f32 v59, v59, v79
    v_mov_b32 v60, v59
    s_nop 1
    v_permlane16_swap_b32 v59, v60
    s_nop 1
    v_max_f32 v59, v59, v60
    v_mov_b32 v60, v59
    s_nop 1
    v_permlane32_swap_b32 v59, v60
    s_nop 1
    v_max_f32 v59, v59, v60
    v_add_f32 v59, 0x41c00000, v59
    v_sub_f32 v68, v68, v59
    v_sub_f32 v148, 0, v59
    v_sub_f32 v69, v69, v59
    v_sub_f32 v149, 0, v59
    v_sub_f32 v70, v70, v59
    v_sub_f32 v150, 0, v59
    v_sub_f32 v71, v71, v59
    v_sub_f32 v151, 0, v59
    v_sub_f32 v76, v76, v59
    v_sub_f32 v156, 0, v59
    v_sub_f32 v77, v77, v59
    v_sub_f32 v157, 0, v59
    v_sub_f32 v78, v78, v59
    v_sub_f32 v158, 0, v59
    v_sub_f32 v79, v79, v59
    v_sub_f32 v159, 0, v59
    s_cmp_lg_u32 s60, 1
    s_cbranch_scc1 L_nm1
    s_call_b64 s[82:83], L_mask
L_nm1:
    v_exp_f32 v58, v64
    v_exp_f32 v59, v65
    s_waitcnt lgkmcnt(7)
    v_mfma_f32_16x16x32_bf16 v[80:83], v[96:99], v[16:19], v[144:147]
    s_waitcnt lgkmcnt(6)
    v_exp_f32 v60, v66
    v_exp_f32 v61, v67
    v_mfma_f32_16x16x32_bf16 v[84:87], v[96:99], v[32:35], v[148:151]
    ds_read_b128 v[96:99], v48 offset:49152
    v_cvt_pk_bf16_f32 v128, v58, v59
    v_cvt_pk_bf16_f32 v129, v60, v61
    v_mfma_f32_16x16x32_bf16 v[84:87], v[100:103], v[36:39], v[84:87]
    s_waitcnt lgkmcnt(6)
    v_exp_f32 v58, v68
    v_exp_f32 v59, v69
    v_mfma_f32_16x16x32_bf16 v[80:83], v[100:103], v[20:23], v[80:83]
    ds_read_b128 v[100:103], v48 offset:50176
    v_cvt_pk_bf16_f32 v132, v58, v59
    v_mfma_f32_16x16x32_bf16 v[80:83], v[104:107], v[24:27], v[80:83]
    s_waitcnt lgkmcnt(6)
    v_exp_f32 v60, v70
    v_exp_f32 v61, v71
    v_mfma_f32_16x16x32_bf16 v[84:87], v[104:107], v[40:43], v[84:87]
    ds_read_b128 v[104:107], v48 offset:51200
    v_cvt_pk_bf16_f32 v133, v60, v61
    v_mfma_f32_16x16x32_bf16 v[84:87], v[108:111], v[44:47], v[84:87]
    s_waitcnt lgkmcnt(6)
    v_exp_f32 v58, v72
    v_exp_f32 v59, v73
    v_mfma_f32_16x16x32_bf16 v[80:83], v[108:111], v[28:31], v[80:83]
    ds_read_b128 v[108:111], v48 offset:52224
    v_cvt_pk_bf16_f32 v130, v58, v59
    v_mfma_f32_16x16x32_bf16 v[88:91], v[112:115], v[16:19], v[152:155]
    s_waitcnt lgkmcnt(6)
    v_exp_f32 v60, v74
    v_exp_f32 v61, v75
    v_mfma_f32_16x16x32_bf16 v[92:95], v[112:115], v[32:35], v[156:159]
    ds_read_b128 v[112:115], v48 offset:53248
    v_cvt_pk_bf16_f32 v131, v60, v61
    v_mfma_f32_16x16x32_bf16 v[92:95], v[116:119], v[36:39], v[92:95]
    s_waitcnt lgkmcnt(6)
    v_exp_f32 v58, v76
    v_exp_f32 v59, v77
    v_mfma_f32_16x16x32_bf16 v[88:91], v[116:119], v[20:23], v[88:91]
    ds_read_b128 v[116:119], v48 offset:54272
    v_cvt_pk_bf16_f32 v134, v58, v59
    v_mfma_f32_16x16x32_bf16 v[88:91], v[120:123], v[24:27], v[88:91]
    s_waitcnt lgkmcnt(6)
    v_exp_f32 v60, v78
    v_exp_f32 v61, v79
    v_mfma_f32_16x16x32_bf16 v[92:95], v[120:123], v[40:43], v[92:95]
    ds_read_b128 v[120:123], v48 offset:55296
    v_cvt_pk_bf16_f32 v135, v60, v61
    v_mfma_f32_16x16x32_bf16 v[92:95], v[124:127], v[44:47], v[92:95]
    s_waitcnt lgkmcnt(6)
    v_or3_b32 v62, v128, v129, v132
    v_or3_b32 v62, v62, v133, v130
    v_or3_b32 v62, v62, v131, v134
    v_bitop3_b32 v62, v62, v135, s72 bitop3:0xa8
    v_cmp_ne_u32 vcc, s65, v62
    v_mfma_f32_16x16x32_bf16 v[88:91], v[124:127], v[28:31], v[88:91]
    ds_read_b128 v[124:127], v48 offset:56320
    s_cbranch_vccnz L_back_9_h
L_back_9:
    s_nop 7
    v_exp_f32 v58, v80
    v_exp_f32 v59, v81
    s_call_b64 s[82:83], L_load
    s_mov_b32 s62, 0
    buffer_store_dwordx4 v[176:179], v13, s[8:11], s67 offen sc1
    s_add_u32 s67, s67, 1024
    buffer_store_dwordx4 v[180:183], v13, s[8:11], s67 offen sc1
    s_add_u32 s67, s67, s68
    buffer_store_dwordx4 v[184:187], v13, s[8:11], s67 offen sc1
    s_add_u32 s67, s67, 1024
    buffer_store_dwordx4 v[188:191], v13, s[8:11], s67 offen sc1
    s_add_u32 s67, s67, s69
    s_sub_i32 s64, s60, 2
    s_cmp_eq_u32 s60, 0
    s_cbranch_scc1 L_pv2
    s_cmp_eq_u32 s60, 1
    s_cbranch_scc1 L_tail2
    s_cmp_lg_u32 s60, 2
    s_cbranch_scc1 L_st2
    s_call_b64 s[82:83], L_mask
    s_branch L_st2
.p2align 6
L_st0:
    v_mfma_f32_16x16x32_bf16 v[192:195], v[96:99], v[128:131], v[192:195]
    s_waitcnt lgkmcnt(6)
    v_exp_f32 v60, v82
    v_mfma_f32_16x16x32_bf16 v[196:199], v[96:99], v[132:135], v[196:199]
    ds_read_b128 v[96:99], v48 offset:0
    v_cvt_pk_bf16_f32 v136, v58, v59
    v_mfma_f32_16x16x32_bf16 v[204:207], v[100:103], v[132:135], v[204:207]
    s_waitcnt lgkmcnt(6)
    v_exp_f32 v61, v83
    v_mfma_f32_16x16x32_bf16 v[200:203], v[100:103], v[128:131], v[200:203]
    s_sub_i32 s64, s64, 1
    ds_read_b128 v[100:103], v48 offset:1024
    v_cvt_pk_bf16_f32 v137, v60, v61
    v_mfma_f32_16x16x32_bf16 v[208:211], v[104:107], v[128:131], v[208:211]
    s_waitcnt lgkmcnt(6)
    v_exp_f32 v58, v84
    v_mfma_f32_16x16x32_bf16 v[212:215], v[104:107], v[132:135], v[212:215]
    ds_read_b128 v[104:107], v48 offset:2048
    v_mfma_f32_16x16x32_bf16 v[220:223], v[108:111], v[132:135], v[220:223]
    s_waitcnt lgkmcnt(6)
    v_exp_f32 v59, v85
    v_mfma_f32_16x16x32_bf16 v[216:219], v[108:111], v[128:131], v[216:219]
    s_cmp_gt_i32 s64, 0
    ds_read_b128 v[108:111], v48 offset:3072
    v_cvt_pk_bf16_f32 v140, v58, v59
    v_mfma_f32_16x16x32_bf16 v[224:227], v[112:115], v[128:131], v[224:227]
    s_waitcnt lgkmcnt(6)
    v_exp_f32 v60, v86
    v_mfma_f32_16x16x32_bf16 v[228:231], v[112:115], v[132:135], v[228:231]
    ds_read_b128 v[112:115], v48 offset:4096
    v_or3_b32 v62, v136, v137, v140
    v_mfma_f32_16x16x32_bf16 v[236:239], v[116:119], v[132:135], v[236:239]
    s_waitcnt lgkmcnt(6)
    v_exp_f32 v61, v87
    v_mfma_f32_16x16x32_bf16 v[232:235], v[116:119], v[128:131], v[232:235]
    s_cselect_b32 s65, 0, 1
    ds_read_b128 v[116:119], v48 offset:5120
    v_cvt_pk_bf16_f32 v141, v60, v61
    v_mfma_f32_16x16x32_bf16 v[240:243], v[120:123], v[128:131], v[240:243]
    s_waitcnt lgkmcnt(6)
    v_exp_f32 v58, v88
    v_mfma_f32_16x16x32_bf16 v[244:247], v[120:123], v[132:135], v[244:247]
    ds_read_b128 v[120:123], v48 offset:6144
    v_mfma_f32_16x16x32_bf16 v[252:255], v[124:127], v[132:135], v[252:255]
    s_waitcnt lgkmcnt(6)
    v_exp_f32 v59, v89
    v_mfma_f32_16x16x32_bf16 v[248:251], v[124:127], v[128:131], v[248:251]
    ds_read_b128 v[124:127], v48 offset:7168
    v_cvt_pk_bf16_f32 v138, v58, v59
    v_mfma_f32_16x16x32_bf16 v[64:67], v[96:99], v[16:19], v[144:147]
    s_waitcnt lgkmcnt(6)
    v_exp_f32 v60, v90
    v_mfma_f32_16x16x32_bf16 v[68:71], v[96:99], v[32:35], v[148:151]
    ds_read_b128 v[96:99], v48 offset:40960
    v_or3_b32 v62, v62, v141, v138
    v_mfma_f32_16x16x32_bf16 v[68:71], v[100:103], v[36:39], v[68:71]
    s_waitcnt lgkmcnt(6)
    v_exp_f32 v61, v91
    v_mfma_f32_16x16x32_bf16 v[64:67], v[100:103], v[20:23], v[64:67]
    ds_read_b128 v[100:103], v48 offset:41984
    v_cvt_pk_bf16_f32 v139, v60, v61
    v_mfma_f32_16x16x32_bf16 v[64:67], v[104:107], v[24:27], v[64:67]
    s_waitcnt lgkmcnt(6)
    v_exp_f32 v58, v92
    v_mfma_f32_16x16x32_bf16 v[68:71], v[104:107], v[40:43], v[68:71]
    ds_read_b128 v[104:107], v48 offset:43008
    v_mfma_f32_16x16x32_bf16 v[68:71], v[108:111], v[44:47], v[68:71]
    s_waitcnt lgkmcnt(6)
    v_exp_f32 v59, v93
    v_mfma_f32_16x16x32_bf16 v[64:67], v[108:111], v[28:31], v[64:67]
    ds_read_b128 v[108:111], v48 offset:44032
    v_cvt_pk_bf16_f32 v142, v58, v59
    v_mfma_f32_16x16x32_bf16 v[72:75], v[112:115], v[16:19], v[152:155]
    s_waitcnt lgkmcnt(6)
    v_exp_f32 v60, v94
    v_mfma_f32_16x16x32_bf16 v[76:79], v[112:115], v[32:35], v[156:159]
    ds_read_b128 v[112:115], v48 offset:45056
    v_or3_b32 v62, v62, v139, v142
    v_mfma_f32_16x16x32_bf16 v[76:79], v[116:119], v[36:39], v[76:79]
    s_waitcnt lgkmcnt(6)
    v_exp_f32 v61, v95
    v_mfma_f32_16x16x32_bf16 v[72:75], v[116:119], v[20:23], v[72:75]
    ds_read_b128 v[116:119], v48 offset:46080
    v_cvt_pk_bf16_f32 v143, v60, v61
    v_smfmac_f32_16x16x64_bf16 v[160:163], v[164:167], v[128:135], v168
    v_bitop3_b32 v62, v62, v143, s72 bitop3:0xa8
    v_mfma_f32_16x16x32_bf16 v[72:75], v[120:123], v[24:27], v[72:75]
    s_waitcnt lgkmcnt(6)
    v_exp_f32 v58, v64
    v_mfma_f32_16x16x32_bf16 v[76:79], v[120:123], v[40:43], v[76:79]
    ds_read_b128 v[120:123], v48 offset:47104
    v_cmp_ne_u32 vcc, s65, v62
    v_mfma_f32_16x16x32_bf16 v[76:79], v[124:127], v[44:47], v[76:79]
    s_waitcnt lgkmcnt(6)
    v_exp_f32 v59, v65
    v_mfma_f32_16x16x32_bf16 v[72:75], v[124:127], v[28:31], v[72:75]
    ds_read_b128 v[124:127], v48 offset:48128
    s_cbranch_vccnz L_back_10_h
L_back_10:
    v_mfma_f32_16x16x32_bf16 v[192:195], v[96:99], v[136:139], v[192:195]
    s_waitcnt lgkmcnt(6)
    v_exp_f32 v60, v66
    v_mfma_f32_16x16x32_bf16 v[196:199], v[96:99], v[140:143], v[196:199]
    ds_read_b128 v[96:99], v48 offset:8192
    v_cvt_pk_bf16_f32 v128, v58, v59
    v_mfma_f32_16x16x32_bf16 v[204:207], v[100:103], v[140:143], v[204:207]
    s_waitcnt lgkmcnt(6)
    v_exp_f32 v61, v67
    v_mfma_f32_16x16x32_bf16 v[200:203], v[100:103], v[136:139], v[200:203]
    s_sub_i32 s64, s64, 1
    ds_read_b128 v[100:103], v48 offset:9216
    v_cvt_pk_bf16_f32 v129, v60, v61
    v_mfma_f32_16x16x32_bf16 v[208:211], v[104:107], v[136:139], v[208:211]
    s_waitcnt lgkmcnt(6)
    v_exp_f32 v58, v68
    v_mfma_f32_16x16x32_bf16 v[212:215], v[104:107], v[140:143], v[212:215]
    ds_read_b128 v[104:107], v48 offset:10240
    v_mfma_f32_16x16x32_bf16 v[220:223], v[108:111], v[140:143], v[220:223]
    s_waitcnt lgkmcnt(6)
    v_exp_f32 v59, v69
    v_mfma_f32_16x16x32_bf16 v[216:219], v[108:111], v[136:139], v[216:219]
    s_cmp_gt_i32 s64, 0
    ds_read_b128 v[108:111], v48 offset:11264
    v_cvt_pk_bf16_f32 v132, v58, v59
    v_mfma_f32_16x16x32_bf16 v[224:227], v[112:115], v[136:139], v[224:227]
    s_waitcnt lgkmcnt(6)
    v_exp_f32 v60, v70
    v_mfma_f32_16x16x32_bf16 v[228:231], v[112:115], v[140:143], v[228:231]
    ds_read_b128 v[112:115], v48 offset:12288
    v_or3_b32 v62, v128, v129, v132
    v_mfma_f32_16x16x32_bf16 v[236:239], v[116:119], v[140:143], v[236:239]
    s_waitcnt lgkmcnt(6)
    v_exp_f32 v61, v71
    v_mfma_f32_16x16x32_bf16 v[232:235], v[116:119], v[136:139], v[232:235]
    s_cselect_b32 s65, 0, 1
    ds_read_b128 v[116:119], v48 offset:13312
    v_cvt_pk_bf16_f32 v133, v60, v61
    v_mfma_f32_16x16x32_bf16 v[240:243], v[120:123], v[136:139], v[240:243]
    s_waitcnt lgkmcnt(6)
    v_exp_f32 v58, v72
    v_mfma_f32_16x16x32_bf16 v[244:247], v[120:123], v[140:143], v[244:247]
    ds_read_b128 v[120:123], v48 offset:14336
    v_mfma_f32_16x16x32_bf16 v[252:255], v[124:127], v[140:143], v[252:255]
    s_waitcnt lgkmcnt(6)
    v_exp_f32 v59, v73
    v_mfma_f32_16x16x32_bf16 v[248:251], v[124:127], v[136:139], v[248:251]
    ds_read_b128 v[124:127], v48 offset:15360
    v_cvt_pk_bf16_f32 v130, v58, v59
    v_mfma_f32_16x16x32_bf16 v[80:83], v[96:99], v[16:19], v[144:147]
    s_waitcnt lgkmcnt(6)
    v_exp_f32 v60, v74
    v_mfma_f32_16x16x32_bf16 v[84:87], v[96:99], v[32:35], v[148:151]
    ds_read_b128 v[96:99], v48 offset:49152
    v_or3_b32 v62, v62, v133, v130
    v_mfma_f32_16x16x32_bf16 v[84:87], v[100:103], v[36:39], v[84:87]
    s_waitcnt lgkmcnt(6)
    v_exp_f32 v61, v75
    v_mfma_f32_16x16x32_bf16 v[80:83], v[100:103], v[20:23], v[80:83]
    ds_read_b128 v[100:103], v48 offset:50176
    v_cvt_pk_bf16_f32 v131, v60, v61
    v_mfma_f32_16x16x32_bf16 v[80:83], v[104:107], v[24:27], v[80:83]
    s_waitcnt lgkmcnt(6)
    v_exp_f32 v58, v76
    v_mfma_f32_16x16x32_bf16 v[84:87], v[104:107], v[40:43], v[84:87]
    ds_read_b128 v[104:107], v48 offset:51200
    v_mfma_f32_16x16x32_bf16 v[84:87], v[108:111], v[44:47], v[84:87]
    s_waitcnt lgkmcnt(6)
    v_exp_f32 v59, v77
    v_mfma_f32_16x16x32_bf16 v[80:83], v[108:111], v[28:31], v[80:83]
    ds_read_b128 v[108:111], v48 offset:52224
    v_cvt_pk_bf16_f32 v134, v58, v59
    v_mfma_f32_16x16x32_bf16 v[88:91], v[112:115], v[16:19], v[152:155]
    s_waitcnt lgkmcnt(6)
    v_exp_f32 v60, v78
    v_mfma_f32_16x16x32_bf16 v[92:95], v[112:115], v[32:35], v[156:159]
    ds_read_b128 v[112:115], v48 offset:53248
    v_or3_b32 v62, v62, v131, v134
    v_mfma_f32_16x16x32_bf16 v[92:95], v[116:119], v[36:39], v[92:95]
    s_waitcnt lgkmcnt(6)
    v_exp_f32 v61, v79
    v_mfma_f32_16x16x32_bf16 v[88:91], v[116:119], v[20:23], v[88:91]
    ds_read_b128 v[116:119], v48 offset:54272
    v_cvt_pk_bf16_f32 v135, v60, v61
    v_smfmac_f32_16x16x64_bf16 v[160:163], v[164:167], v[136:143], v168
    v_bitop3_b32 v62, v62, v135, s72 bitop3:0xa8
    v_mfma_f32_16x16x32_bf16 v[88:91], v[120:123], v[24:27], v[88:91]
    s_waitcnt lgkmcnt(6)
    v_exp_f32 v58, v80
    v_mfma_f32_16x16x32_bf16 v[92:95], v[120:123], v[40:43], v[92:95]
    ds_read_b128 v[120:123], v48 offset:55296
    v_cmp_ne_u32 vcc, s65, v62
    v_mfma_f32_16x16x32_bf16 v[92:95], v[124:127], v[44:47], v[92:95]
    s_waitcnt lgkmcnt(6)
    v_exp_f32 v59, v81
    v_mfma_f32_16x16x32_bf16 v[88:91], v[124:127], v[28:31], v[88:91]
    ds_read_b128 v[124:127], v48 offset:56320
    s_cbranch_vccnz L_back_11_h
L_back_11:
L_st2:
    v_mfma_f32_16x16x32_bf16 v[192:195], v[96:99], v[128:131], v[192:195]
    s_waitcnt lgkmcnt(6)
    v_exp_f32 v60, v82
    v_mfma_f32_16x16x32_bf16 v[196:199], v[96:99], v[132:135], v[196:199]
    ds_read_b128 v[96:99], v48 offset:16384
    v_cvt_pk_bf16_f32 v136, v58, v59
    v_mfma_f32_16x16x32_bf16 v[204:207], v[100:103], v[132:135], v[204:207]
    s_waitcnt lgkmcnt(6)
    v_exp_f32 v61, v83
    v_mfma_f32_16x16x32_bf16 v[200:203], v[100:103], v[128:131], v[200:203]
    s_sub_i32 s64, s64, 1
    ds_read_b128 v[100:103], v48 offset:17408
    v_cvt_pk_bf16_f32 v137, v60, v61
    v_mfma_f32_16x16x32_bf16 v[208:211], v[104:107], v[128:131], v[208:211]
    s_waitcnt lgkmcnt(6)
    v_exp_f32 v58, v84
    v_mfma_f32_16x16x32_bf16 v[212:215], v[104:107], v[132:135], v[212:215]
    ds_read_b128 v[104:107], v48 offset:18432
    v_mfma_f32_16x16x32_bf16 v[220:223], v[108:111], v[132:135], v[220:223]
    s_waitcnt lgkmcnt(6)
    v_exp_f32 v59, v85
    v_mfma_f32_16x16x32_bf16 v[216:219], v[108:111], v[128:131], v[216:219]
    s_cmp_gt_i32 s64, 0
    ds_read_b128 v[108:111], v48 offset:19456
    v_cvt_pk_bf16_f32 v140, v58, v59
    v_mfma_f32_16x16x32_bf16 v[224:227], v[112:115], v[128:131], v[224:227]
    s_waitcnt lgkmcnt(6)
    v_exp_f32 v60, v86
    v_mfma_f32_16x16x32_bf16 v[228:231], v[112:115], v[132:135], v[228:231]
    ds_read_b128 v[112:115], v48 offset:20480
    v_or3_b32 v62, v136, v137, v140
    v_mfma_f32_16x16x32_bf16 v[236:239], v[116:119], v[132:135], v[236:239]
    s_waitcnt lgkmcnt(6)
    v_exp_f32 v61, v87
    v_mfma_f32_16x16x32_bf16 v[232:235], v[116:119], v[128:131], v[232:235]
    s_cselect_b32 s65, 0, 1
    ds_read_b128 v[116:119], v48 offset:21504
    v_cvt_pk_bf16_f32 v141, v60, v61
    v_mfma_f32_16x16x32_bf16 v[240:243], v[120:123], v[128:131], v[240:243]
    s_waitcnt lgkmcnt(6)
    v_exp_f32 v58, v88
    v_mfma_f32_16x16x32_bf16 v[244:247], v[120:123], v[132:135], v[244:247]
    ds_read_b128 v[120:123], v48 offset:22528
    v_mfma_f32_16x16x32_bf16 v[252:255], v[124:127], v[132:135], v[252:255]
    s_waitcnt lgkmcnt(6)
    v_exp_f32 v59, v89
    v_mfma_f32_16x16x32_bf16 v[248:251], v[124:127], v[128:131], v[248:251]
    ds_read_b128 v[124:127], v48 offset:23552
    v_cvt_pk_bf16_f32 v138, v58, v59
    v_mfma_f32_16x16x32_bf16 v[64:67], v[96:99], v[16:19], v[144:147]
    s_waitcnt lgkmcnt(6)
    v_exp_f32 v60, v90
    v_mfma_f32_16x16x32_bf16 v[68:71], v[96:99], v[32:35], v[148:151]
    ds_read_b128 v[96:99], v48 offset:57344
    v_or3_b32 v62, v62, v141, v138
    v_mfma_f32_16x16x32_bf16 v[68:71], v[100:103], v[36:39], v[68:71]
    s_waitcnt lgkmcnt(6)
    v_exp_f32 v61, v91
    v_mfma_f32_16x16x32_bf16 v[64:67], v[100:103], v[20:23], v[64:67]
    ds_read_b128 v[100:103], v48 offset:58368
    v_cvt_pk_bf16_f32 v139, v60, v61
    v_mfma_f32_16x16x32_bf16 v[64:67], v[104:107], v[24:27], v[64:67]
    s_waitcnt lgkmcnt(6)
    v_exp_f32 v58, v92
    v_mfma_f32_16x16x32_bf16 v[68:71], v[104:107], v[40:43], v[68:71]
    ds_read_b128 v[104:107], v48 offset:59392
    v_mfma_f32_16x16x32_bf16 v[68:71], v[108:111], v[44:47], v[68:71]
    s_waitcnt lgkmcnt(6)
    v_exp_f32 v59, v93
    v_mfma_f32_16x16x32_bf16 v[64:67], v[108:111], v[28:31], v[64:67]
    ds_read_b128 v[108:111], v48 offset:60416
    v_cvt_pk_bf16_f32 v142, v58, v59
    v_mfma_f32_16x16x32_bf16 v[72:75], v[112:115], v[16:19], v[152:155]
    s_waitcnt lgkmcnt(6)
    v_exp_f32 v60, v94
    v_mfma_f32_16x16x32_bf16 v[76:79], v[112:115], v[32:35], v[156:159]
    ds_read_b128 v[112:115], v48 offset:61440
    v_or3_b32 v62, v62, v139, v142
    v_mfma_f32_16x16x32_bf16 v[76:79], v[116:119], v[36:39], v[76:79]
    s_waitcnt lgkmcnt(6)
    v_exp_f32 v61, v95
    v_mfma_f32_16x16x32_bf16 v[72:75], v[116:119], v[20:23], v[72:75]
    ds_read_b128 v[116:119], v48 offset:62464
    v_cvt_pk_bf16_f32 v143, v60, v61
    v_smfmac_f32_16x16x64_bf16 v[160:163], v[164:167], v[128:135], v168
    v_bitop3_b32 v62, v62, v143, s72 bitop3:0xa8
    v_mfma_f32_16x16x32_bf16 v[72:75], v[120:123], v[24:27], v[72:75]
    s_waitcnt lgkmcnt(6)
    v_exp_f32 v58, v64
    v_mfma_f32_16x16x32_bf16 v[76:79], v[120:123], v[40:43], v[76:79]
    ds_read_b128 v[120:123], v48 offset:63488
    v_cmp_ne_u32 vcc, s65, v62
    v_mfma_f32_16x16x32_bf16 v[76:79], v[124:127], v[44:47], v[76:79]
    s_waitcnt lgkmcnt(6)
    v_exp_f32 v59, v65
    v_mfma_f32_16x16x32_bf16 v[72:75], v[124:127], v[28:31], v[72:75]
    ds_read_b128 v[124:127], v48 offset:64512
    s_cbranch_vccnz L_back_12_h
L_back_12:
    v_mfma_f32_16x16x32_bf16 v[192:195], v[96:99], v[136:139], v[192:195]
    s_waitcnt lgkmcnt(6)
    v_exp_f32 v60, v66
    v_mfma_f32_16x16x32_bf16 v[196:199], v[96:99], v[140:143], v[196:199]
    ds_read_b128 v[96:99], v48 offset:24576
    v_cvt_pk_bf16_f32 v128, v58, v59
    v_mfma_f32_16x16x32_bf16 v[204:207], v[100:103], v[140:143], v[204:207]
    s_waitcnt lgkmcnt(6)
    v_exp_f32 v61, v67
    v_mfma_f32_16x16x32_bf16 v[200:203], v[100:103], v[136:139], v[200:203]
    s_sub_i32 s64, s64, 1
    ds_read_b128 v[100:103], v48 offset:25600
    v_cvt_pk_bf16_f32 v129, v60, v61
    v_mfma_f32_16x16x32_bf16 v[208:211], v[104:107], v[136:139], v[208:211]
    s_waitcnt lgkmcnt(6)
    v_exp_f32 v58, v68
    v_mfma_f32_16x16x32_bf16 v[212:215], v[104:107], v[140:143], v[212:215]
    ds_read_b128 v[104:107], v48 offset:26624
    v_mfma_f32_16x16x32_bf16 v[220:223], v[108:111], v[140:143], v[220:223]
    s_waitcnt lgkmcnt(6)
    v_exp_f32 v59, v69
    v_mfma_f32_16x16x32_bf16 v[216:219], v[108:111], v[136:139], v[216:219]
    s_cmp_gt_i32 s64, 0
    ds_read_b128 v[108:111], v48 offset:27648
    v_cvt_pk_bf16_f32 v132, v58, v59
    v_mfma_f32_16x16x32_bf16 v[224:227], v[112:115], v[136:139], v[224:227]
    s_waitcnt lgkmcnt(6)
    v_exp_f32 v60, v70
    v_mfma_f32_16x16x32_bf16 v[228:231], v[112:115], v[140:143], v[228:231]
    ds_read_b128 v[112:115], v48 offset:28672
    v_or3_b32 v62, v128, v129, v132
    v_mfma_f32_16x16x32_bf16 v[236:239], v[116:119], v[140:143], v[236:239]
    s_waitcnt lgkmcnt(6)
    v_exp_f32 v61, v71
    v_mfma_f32_16x16x32_bf16 v[232:235], v[116:119], v[136:139], v[232:235]
    s_cselect_b32 s65, 0, 1
    ds_read_b128 v[116:119], v48 offset:29696
    v_cvt_pk_bf16_f32 v133, v60, v61
    v_mfma_f32_16x16x32_bf16 v[240:243], v[120:123], v[136:139], v[240:243]
    s_waitcnt lgkmcnt(6)
    v_exp_f32 v58, v72
    v_mfma_f32_16x16x32_bf16 v[244:247], v[120:123], v[140:143], v[244:247]
    ds_read_b128 v[120:123], v48 offset:30720
    v_mfma_f32_16x16x32_bf16 v[252:255], v[124:127], v[140:143], v[252:255]
    s_waitcnt lgkmcnt(6)
    v_exp_f32 v59, v73
    v_mfma_f32_16x16x32_bf16 v[248:251], v[124:127], v[136:139], v[248:251]
    ds_read_b128 v[124:127], v48 offset:31744
    v_cvt_pk_bf16_f32 v130, v58, v59
    v_mfma_f32_16x16x32_bf16 v[80:83], v[96:99], v[16:19], v[144:147]
    s_waitcnt lgkmcnt(6)
    v_exp_f32 v60, v74
    v_mfma_f32_16x16x32_bf16 v[84:87], v[96:99], v[32:35], v[148:151]
    s_cmp_lg_u32 s89, 0
    v_or3_b32 v62, v62, v133, v130
    v_xor_b32 v48, 0x10000, v48
    v_mfma_f32_16x16x32_bf16 v[84:87], v[100:103], v[36:39], v[84:87]
    s_waitcnt lgkmcnt(5)
    v_exp_f32 v61, v75
    v_mfma_f32_16x16x32_bf16 v[80:83], v[100:103], v[20:23], v[80:83]
    s_waitcnt lgkmcnt(0)
    v_cvt_pk_bf16_f32 v131, v60, v61
    v_smfmac_f32_16x16x64_bf16 v[160:163], v[164:167], v[136:143], v168
    s_cbranch_scc1 L_ldback_13_c
    s_barrier
L_ldback_13:
    s_add_i32 s62, s62, 1
    ds_read_b128 v[96:99], v48 offset:32768
    ds_read_b128 v[100:103], v48 offset:33792
    v_mfma_f32_16x16x32_bf16 v[80:83], v[104:107], v[24:27], v[80:83]
    v_exp_f32 v58, v76
    v_mfma_f32_16x16x32_bf16 v[84:87], v[104:107], v[40:43], v[84:87]
    ds_read_b128 v[104:107], v48 offset:34816
    v_mfma_f32_16x16x32_bf16 v[84:87], v[108:111], v[44:47], v[84:87]
    v_exp_f32 v59, v77
    v_mfma_f32_16x16x32_bf16 v[80:83], v[108:111], v[28:31], v[80:83]
    ds_read_b128 v[108:111], v48 offset:35840
    v_cvt_pk_bf16_f32 v134, v58, v59
    v_mfma_f32_16x16x32_bf16 v[88:91], v[112:115], v[16:19], v[152:155]
    v_exp_f32 v60, v78
    v_mfma_f32_16x16x32_bf16 v[92:95], v[112:115], v[32:35], v[156:159]
    ds_read_b128 v[112:115], v48 offset:36864
    v_or3_b32 v62, v62, v131, v134
    v_mfma_f32_16x16x32_bf16 v[92:95], v[116:119], v[36:39], v[92:95]
    v_exp_f32 v61, v79
    v_mfma_f32_16x16x32_bf16 v[88:91], v[116:119], v[20:23], v[88:91]
    ds_read_b128 v[116:119], v48 offset:37888
    v_cvt_pk_bf16_f32 v135, v60, v61
    v_mfma_f32_16x16x32_bf16 v[88:91], v[120:123], v[24:27], v[88:91]
    v_exp_f32 v58, v80
    v_mfma_f32_16x16x32_bf16 v[92:95], v[120:123], v[40:43], v[92:95]
    ds_read_b128 v[120:123], v48 offset:38912
    v_bitop3_b32 v62, v62, v135, s72 bitop3:0xa8
    v_cmp_ne_u32 vcc, s65, v62
    v_mfma_f32_16x16x32_bf16 v[92:95], v[124:127], v[44:47], v[92:95]
    s_waitcnt lgkmcnt(6)
    v_exp_f32 v59, v81
    v_mfma_f32_16x16x32_bf16 v[88:91], v[124:127], v[28:31], v[88:91]
    ds_read_b128 v[124:127], v48 offset:39936
    s_cbranch_vccz L_st0
    s_branch L_back_14_h
L_tail0:
    s_mov_b32 s65, 0
    v_mfma_f32_16x16x32_bf16 v[192:195], v[96:99], v[128:131], v[192:195]
    s_waitcnt lgkmcnt(6)
    v_exp_f32 v60, v82
    v_exp_f32 v61, v83
    v_mfma_f32_16x16x32_bf16 v[196:199], v[96:99], v[132:135], v[196:199]
    ds_read_b128 v[96:99], v48 offset:40960
    v_cvt_pk_bf16_f32 v136, v58, v59
    v_cvt_pk_bf16_f32 v137, v60, v61
    v_mfma_f32_16x16x32_bf16 v[204:207], v[100:103], v[132:135], v[204:207]
    s_waitcnt lgkmcnt(6)
    v_exp_f32 v58, v84
    v_exp_f32 v59, v85
    v_mfma_f32_16x16x32_bf16 v[200:203], v[100:103], v[128:131], v[200:203]
    ds_read_b128 v[100:103], v48 offset:41984
    v_cvt_pk_bf16_f32 v140, v58, v59
    v_smfmac_f32_16x16x64_bf16 v[160:163], v[164:167], v[128:135], v168
    v_mfma_f32_16x16x32_bf16 v[208:211], v[104:107], v[128:131], v[208:211]
    s_waitcnt lgkmcnt(6)
    v_exp_f32 v60, v86
    v_exp_f32 v61, v87
    v_mfma_f32_16x16x32_bf16 v[212:215], v[104:107], v[132:135], v[212:215]
    ds_read_b128 v[104:107], v48 offset:43008
    v_cvt_pk_bf16_f32 v141, v60, v61
    v_mfma_f32_16x16x32_bf16 v[220:223], v[108:111], v[132:135], v[220:223]
    s_waitcnt lgkmcnt(6)
    v_exp_f32 v58, v88
    v_exp_f32 v59, v89
    v_mfma_f32_16x16x32_bf16 v[216:219], v[108:111], v[128:131], v[216:219]
    ds_read_b128 v[108:111], v48 offset:44032
    v_cvt_pk_bf16_f32 v138, v58, v59
    v_mfma_f32_16x16x32_bf16 v[224:227], v[112:115], v[128:131], v[224:227]
    s_waitcnt lgkmcnt(6)
    v_exp_f32 v60, v90
    v_exp_f32 v61, v91
    v_mfma_f32_16x16x32_bf16 v[228:231], v[112:115], v[132:135], v[228:231]
    ds_read_b128 v[112:115], v48 offset:45056
    v_cvt_pk_bf16_f32 v139, v60, v61
    v_mfma_f32_16x16x32_bf16 v[236:239], v[116:119], v[132:135], v[236:239]
    s_waitcnt lgkmcnt(6)
    v_exp_f32 v58, v92
    v_exp_f32 v59, v93
    v_mfma_f32_16x16x32_bf16 v[232:235], v[116:119], v[128:131], v[232:235]
    ds_read_b128 v[116:119], v48 offset:46080
    v_cvt_pk_bf16_f32 v142, v58, v59
    v_mfma_f32_16x16x32_bf16 v[240:243], v[120:123], v[128:131], v[240:243]
    s_waitcnt lgkmcnt(6)
    v_exp_f32 v60, v94
    v_exp_f32 v61, v95
    v_mfma_f32_16x16x32_bf16 v[244:247], v[120:123], v[132:135], v[244:247]
    ds_read_b128 v[120:123], v48 offset:47104
    v_cvt_pk_bf16_f32 v143, v60, v61
    v_mfma_f32_16x16x32_bf16 v[252:255], v[124:127], v[132:135], v[252:255]
    s_waitcnt lgkmcnt(6)
    v_or3_b32 v62, v136, v137, v140
    v_or3_b32 v62, v62, v141, v138
    v_or3_b32 v62, v62, v139, v142
    v_bitop3_b32 v62, v62, v143, s72 bitop3:0xa8
    v_cmp_ne_u32 vcc, s65, v62
    v_mfma_f32_16x16x32_bf16 v[248:251], v[124:127], v[128:131], v[248:251]
    ds_read_b128 v[124:127], v48 offset:48128
    s_cbranch_vccnz L_back_15_h
L_back_15:
L_pv1:
    v_mfma_f32_16x16x32_bf16 v[192:195], v[96:99], v[136:139], v[192:195]
    s_waitcnt lgkmcnt(6)
    v_mfma_f32_16x16x32_bf16 v[196:199], v[96:99], v[140:143], v[196:199]
    v_mfma_f32_16x16x32_bf16 v[204:207], v[100:103], v[140:143], v[204:207]
    s_waitcnt lgkmcnt(5)
    v_mfma_f32_16x16x32_bf16 v[200:203], v[100:103], v[136:139], v[200:203]
    v_smfmac_f32_16x16x64_bf16 v[160:163], v[164:167], v[136:143], v168
    v_mfma_f32_16x16x32_bf16 v[208:211], v[104:107], v[136:139], v[208:211]
    s_waitcnt lgkmcnt(4)
    v_mfma_f32_16x16x32_bf16 v[212:215], v[104:107], v[140:143], v[212:215]
    v_mfma_f32_16x16x32_bf16 v[220:223], v[108:111], v[140:143], v[220:223]
    s_waitcnt lgkmcnt(3)
    v_mfma_f32_16x16x32_bf16 v[216:219], v[108:111], v[136:139], v[216:219]
    v_mfma_f32_16x16x32_bf16 v[224:227], v[112:115], v[136:139], v[224:227]
    s_waitcnt lgkmcnt(2)
    v_mfma_f32_16x16x32_bf16 v[228:231], v[112:115], v[140:143], v[228:231]
    v_mfma_f32_16x16x32_bf16 v[236:239], v[116:119], v[140:143], v[236:239]
    s_waitcnt lgkmcnt(1)
    v_mfma_f32_16x16x32_bf16 v[232:235], v[116:119], v[136:139], v[232:235]
    v_mfma_f32_16x16x32_bf16 v[240:243], v[120:123], v[136:139], v[240:243]
    s_waitcnt lgkmcnt(0)
    v_mfma_f32_16x16x32_bf16 v[244:247], v[120:123], v[140:143], v[244:247]
    v_mfma_f32_16x16x32_bf16 v[252:255], v[124:127], v[140:143], v[252:255]
    v_mfma_f32_16x16x32_bf16 v[248:251], v[124:127], v[136:139], v[248:251]
    s_branch L_fin
L_tail1:
    s_mov_b32 s65, 0
    v_mfma_f32_16x16x32_bf16 v[192:195], v[96:99], v[136:139], v[192:195]
    s_waitcnt lgkmcnt(6)
    v_exp_f32 v60, v66
    v_exp_f32 v61, v67
    v_mfma_f32_16x16x32_bf16 v[196:199], v[96:99], v[140:143], v[196:199]
    ds_read_b128 v[96:99], v48 offset:49152
    v_cvt_pk_bf16_f32 v128, v58, v59
    v_cvt_pk_bf16_f32 v129, v60, v61
    v_mfma_f32_16x16x32_bf16 v[204:207], v[100:103], v[140:143], v[204:207]
    s_waitcnt lgkmcnt(6)
    v_exp_f32 v58, v68
    v_exp_f32 v59, v69
    v_mfma_f32_16x16x32_bf16 v[200:203], v[100:103], v[136:139], v[200:203]
    ds_read_b128 v[100:103], v48 offset:50176
    v_cvt_pk_bf16_f32 v132, v58, v59
    v_smfmac_f32_16x16x64_bf16 v[160:163], v[164:167], v[136:143], v168
    v_mfma_f32_16x16x32_bf16 v[208:211], v[104:107], v[136:139], v[208:211]
    s_waitcnt lgkmcnt(6)
    v_exp_f32 v60, v70
    v_exp_f32 v61, v71
    v_mfma_f32_16x16x32_bf16 v[212:215], v[104:107], v[140:143], v[212:215]
    ds_read_b128 v[104:107], v48 offset:51200
    v_cvt_pk_bf16_f32 v133, v60, v61
    v_mfma_f32_16x16x32_bf16 v[220:223], v[108:111], v[140:143], v[220:223]
    s_waitcnt lgkmcnt(6)
    v_exp_f32 v58, v72
    v_exp_f32 v59, v73
    v_mfma_f32_16x16x32_bf16 v[216:219], v[108:111], v[136:139], v[216:219]
    ds_read_b128 v[108:111], v48 offset:52224
    v_cvt_pk_bf16_f32 v130, v58, v59
    v_mfma_f32_16x16x32_bf16 v[224:227], v[112:115], v[136:139], v[224:227]
    s_waitcnt lgkmcnt(6)
    v_exp_f32 v60, v74
    v_exp_f32 v61, v75
    v_mfma_f32_16x16x32_bf16 v[228:231], v[112:115], v[140:143], v[228:231]
    ds_read_b128 v[112:115], v48 offset:53248
    v_cvt_pk_bf16_f32 v131, v60, v61
    v_mfma_f32_16x16x32_bf16 v[236:239], v[116:119], v[140:143], v[236:239]
    s_waitcnt lgkmcnt(6)
    v_exp_f32 v58, v76
    v_exp_f32 v59, v77
    v_mfma_f32_16x16x32_bf16 v[232:235], v[116:119], v[136:139], v[232:235]
    ds_read_b128 v[116:119], v48 offset:54272
    v_cvt_pk_bf16_f32 v134, v58, v59
    v_mfma_f32_16x16x32_bf16 v[240:243], v[120:123], v[136:139], v[240:243]
    s_waitcnt lgkmcnt(6)
    v_exp_f32 v60, v78
    v_exp_f32 v61, v79
    v_mfma_f32_16x16x32_bf16 v[244:247], v[120:123], v[140:143], v[244:247]
    ds_read_b128 v[120:123], v48 offset:55296
    v_cvt_pk_bf16_f32 v135, v60, v61
    v_mfma_f32_16x16x32_bf16 v[252:255], v[124:127], v[140:143], v[252:255]
    s_waitcnt lgkmcnt(6)
    v_or3_b32 v62, v128, v129, v132
    v_or3_b32 v62, v62, v133, v130
    v_or3_b32 v62, v62, v131, v134
    v_bitop3_b32 v62, v62, v135, s72 bitop3:0xa8
    v_cmp_ne_u32 vcc, s65, v62
    v_mfma_f32_16x16x32_bf16 v[248:251], v[124:127], v[136:139], v[248:251]
    ds_read_b128 v[124:127], v48 offset:56320
    s_cbranch_vccnz L_back_16_h
L_back_16:
L_pv2:
    v_mfma_f32_16x16x32_bf16 v[192:195], v[96:99], v[128:131], v[192:195]
    s_waitcnt lgkmcnt(6)
    v_mfma_f32_16x16x32_bf16 v[196:199], v[96:99], v[132:135], v[196:199]
    v_mfma_f32_16x16x32_bf16 v[204:207], v[100:103], v[132:135], v[204:207]
    s_waitcnt lgkmcnt(5)
    v_mfma_f32_16x16x32_bf16 v[200:203], v[100:103], v[128:131], v[200:203]
    v_smfmac_f32_16x16x64_bf16 v[160:163], v[164:167], v[128:135], v168
    v_mfma_f32_16x16x32_bf16 v[208:211], v[104:107], v[128:131], v[208:211]
    s_waitcnt lgkmcnt(4)
    v_mfma_f32_16x16x32_bf16 v[212:215], v[104:107], v[132:135], v[212:215]
    v_mfma_f32_16x16x32_bf16 v[220:223], v[108:111], v[132:135], v[220:223]
    s_waitcnt lgkmcnt(3)
    v_mfma_f32_16x16x32_bf16 v[216:219], v[108:111], v[128:131], v[216:219]
    v_mfma_f32_16x16x32_bf16 v[224:227], v[112:115], v[128:131], v[224:227]
    s_waitcnt lgkmcnt(2)
    v_mfma_f32_16x16x32_bf16 v[228:231], v[112:115], v[132:135], v[228:231]
    v_mfma_f32_16x16x32_bf16 v[236:239], v[116:119], v[132:135], v[236:239]
    s_waitcnt lgkmcnt(1)
    v_mfma_f32_16x16x32_bf16 v[232:235], v[116:119], v[128:131], v[232:235]
    v_mfma_f32_16x16x32_bf16 v[240:243], v[120:123], v[128:131], v[240:243]
    s_waitcnt lgkmcnt(0)
    v_mfma_f32_16x16x32_bf16 v[244:247], v[120:123], v[132:135], v[244:247]
    v_mfma_f32_16x16x32_bf16 v[252:255], v[124:127], v[132:135], v[252:255]
    v_mfma_f32_16x16x32_bf16 v[248:251], v[124:127], v[128:131], v[248:251]
    s_cmp_eq_u32 s60, 0
    s_cbranch_scc1 L_fin
    s_waitcnt vmcnt(0) lgkmcnt(0)
    s_call_b64 s[82:83], L_pend
    s_barrier
    s_call_b64 s[82:83], L_load
    s_add_i32 s62, s62, 1
    s_branch L_fin
L_tail2:
    s_mov_b32 s65, 0
    v_mfma_f32_16x16x32_bf16 v[192:195], v[96:99], v[128:131], v[192:195]
    s_waitcnt lgkmcnt(6)
    v_exp_f32 v60, v82
    v_exp_f32 v61, v83
    v_mfma_f32_16x16x32_bf16 v[196:199], v[96:99], v[132:135], v[196:199]
    ds_read_b128 v[96:99], v48 offset:57344
    v_cvt_pk_bf16_f32 v136, v58, v59
    v_cvt_pk_bf16_f32 v137, v60, v61
    v_mfma_f32_16x16x32_bf16 v[204:207], v[100:103], v[132:135], v[204:207]
    s_waitcnt lgkmcnt(6)
    v_exp_f32 v58, v84
    v_exp_f32 v59, v85
    v_mfma_f32_16x16x32_bf16 v[200:203], v[100:103], v[128:131], v[200:203]
    ds_read_b128 v[100:103], v48 offset:58368
    v_cvt_pk_bf16_f32 v140, v58, v59
    v_smfmac_f32_16x16x64_bf16 v[160:163], v[164:167], v[128:135], v168
    v_mfma_f32_16x16x32_bf16 v[208:211], v[104:107], v[128:131], v[208:211]
    s_waitcnt lgkmcnt(6)
    v_exp_f32 v60, v86
    v_exp_f32 v61, v87
    v_mfma_f32_16x16x32_bf16 v[212:215], v[104:107], v[132:135], v[212:215]
    ds_read_b128 v[104:107], v48 offset:59392
    v_cvt_pk_bf16_f32 v141, v60, v61
    v_mfma_f32_16x16x32_bf16 v[220:223], v[108:111], v[132:135], v[220:223]
    s_waitcnt lgkmcnt(6)
    v_exp_f32 v58, v88
    v_exp_f32 v59, v89
    v_mfma_f32_16x16x32_bf16 v[216:219], v[108:111], v[128:131], v[216:219]
    ds_read_b128 v[108:111], v48 offset:60416
    v_cvt_pk_bf16_f32 v138, v58, v59
    v_mfma_f32_16x16x32_bf16 v[224:227], v[112:115], v[128:131], v[224:227]
    s_waitcnt lgkmcnt(6)
    v_exp_f32 v60, v90
    v_exp_f32 v61, v91
    v_mfma_f32_16x16x32_bf16 v[228:231], v[112:115], v[132:135], v[228:231]
    ds_read_b128 v[112:115], v48 offset:61440
    v_cvt_pk_bf16_f32 v139, v60, v61
    v_mfma_f32_16x16x32_bf16 v[236:239], v[116:119], v[132:135], v[236:239]
    s_waitcnt lgkmcnt(6)
    v_exp_f32 v58, v92
    v_exp_f32 v59, v93
    v_mfma_f32_16x16x32_bf16 v[232:235], v[116:119], v[128:131], v[232:235]
    ds_read_b128 v[116:119], v48 offset:62464
    v_cvt_pk_bf16_f32 v142, v58, v59
    v_mfma_f32_16x16x32_bf16 v[240:243], v[120:123], v[128:131], v[240:243]
    s_waitcnt lgkmcnt(6)
    v_exp_f32 v60, v94
    v_exp_f32 v61, v95
    v_mfma_f32_16x16x32_bf16 v[244:247], v[120:123], v[132:135], v[244:247]
    ds_read_b128 v[120:123], v48 offset:63488
    v_cvt_pk_bf16_f32 v143, v60, v61
    v_mfma_f32_16x16x32_bf16 v[252:255], v[124:127], v[132:135], v[252:255]
    s_waitcnt lgkmcnt(6)
    v_or3_b32 v62, v136, v137, v140
    v_or3_b32 v62, v62, v141, v138
    v_or3_b32 v62, v62, v139, v142
    v_bitop3_b32 v62, v62, v143, s72 bitop3:0xa8
    v_cmp_ne_u32 vcc, s65, v62
    v_mfma_f32_16x16x32_bf16 v[248:251], v[124:127], v[128:131], v[248:251]
    ds_read_b128 v[124:127], v48 offset:64512
    s_cbranch_vccnz L_back_18_h
L_back_18:
L_pv3:
    v_mfma_f32_16x16x32_bf16 v[192:195], v[96:99], v[136:139], v[192:195]
    s_waitcnt lgkmcnt(6)
    v_mfma_f32_16x16x32_bf16 v[196:199], v[96:99], v[140:143], v[196:199]
    v_xor_b32 v48, 0x10000, v48
    v_mfma_f32_16x16x32_bf16 v[204:207], v[100:103], v[140:143], v[204:207]
    s_waitcnt lgkmcnt(5)
    v_mfma_f32_16x16x32_bf16 v[200:203], v[100:103], v[136:139], v[200:203]
    v_smfmac_f32_16x16x64_bf16 v[160:163], v[164:167], v[136:143], v168
    s_waitcnt vmcnt(0) lgkmcnt(0)
    s_call_b64 s[82:83], L_pend
    s_barrier
    s_call_b64 s[82:83], L_load
    s_add_i32 s62, s62, 1
    v_mfma_f32_16x16x32_bf16 v[208:211], v[104:107], v[136:139], v[208:211]
    v_mfma_f32_16x16x32_bf16 v[212:215], v[104:107], v[140:143], v[212:215]
    v_mfma_f32_16x16x32_bf16 v[220:223], v[108:111], v[140:143], v[220:223]
    v_mfma_f32_16x16x32_bf16 v[216:219], v[108:111], v[136:139], v[216:219]
    v_mfma_f32_16x16x32_bf16 v[224:227], v[112:115], v[136:139], v[224:227]
    v_mfma_f32_16x16x32_bf16 v[228:231], v[112:115], v[140:143], v[228:231]
    v_mfma_f32_16x16x32_bf16 v[236:239], v[116:119], v[140:143], v[236:239]
    v_mfma_f32_16x16x32_bf16 v[232:235], v[116:119], v[136:139], v[232:235]
    v_mfma_f32_16x16x32_bf16 v[240:243], v[120:123], v[136:139], v[240:243]
    v_mfma_f32_16x16x32_bf16 v[244:247], v[120:123], v[140:143], v[244:247]
    v_mfma_f32_16x16x32_bf16 v[252:255], v[124:127], v[140:143], v[252:255]
    v_mfma_f32_16x16x32_bf16 v[248:251], v[124:127], v[136:139], v[248:251]
    s_branch L_fin
L_tail3:
    s_mov_b32 s65, 0
    v_mfma_f32_16x16x32_bf16 v[192:195], v[96:99], v[136:139], v[192:195]
    s_waitcnt lgkmcnt(6)
    v_exp_f32 v60, v66
    v_exp_f32 v61, v67
    v_mfma_f32_16x16x32_bf16 v[196:199], v[96:99], v[140:143], v[196:199]
    v_cvt_pk_bf16_f32 v128, v58, v59
    v_cvt_pk_bf16_f32 v129, v60, v61
    v_xor_b32 v48, 0x10000, v48
    v_mfma_f32_16x16x32_bf16 v[204:207], v[100:103], v[140:143], v[204:207]
    s_waitcnt lgkmcnt(5)
    v_exp_f32 v58, v68
    v_exp_f32 v59, v69
    v_mfma_f32_16x16x32_bf16 v[200:203], v[100:103], v[136:139], v[200:203]
    v_cvt_pk_bf16_f32 v132, v58, v59
    v_smfmac_f32_16x16x64_bf16 v[160:163], v[164:167], v[136:143], v168
    s_waitcnt vmcnt(0) lgkmcnt(0)
    s_call_b64 s[82:83], L_pend
    s_barrier
    s_call_b64 s[82:83], L_load
    s_add_i32 s62, s62, 1
    ds_read_b128 v[96:99], v48 offset:32768
    ds_read_b128 v[100:103], v48 offset:33792
    v_mfma_f32_16x16x32_bf16 v[208:211], v[104:107], v[136:139], v[208:211]
    v_exp_f32 v60, v70
    v_exp_f32 v61, v71
    v_mfma_f32_16x16x32_bf16 v[212:215], v[104:107], v[140:143], v[212:215]
    ds_read_b128 v[104:107], v48 offset:34816
    v_cvt_pk_bf16_f32 v133, v60, v61
    v_mfma_f32_16x16x32_bf16 v[220:223], v[108:111], v[140:143], v[220:223]
    v_exp_f32 v58, v72
    v_exp_f32 v59, v73
    v_mfma_f32_16x16x32_bf16 v[216:219], v[108:111], v[136:139], v[216:219]
    ds_read_b128 v[108:111], v48 offset:35840
    v_cvt_pk_bf16_f32 v130, v58, v59
    v_mfma_f32_16x16x32_bf16 v[224:227], v[112:115], v[136:139], v[224:227]
    v_exp_f32 v60, v74
    v_exp_f32 v61, v75
    v_mfma_f32_16x16x32_bf16 v[228:231], v[112:115], v[140:143], v[228:231]
    ds_read_b128 v[112:115], v48 offset:36864
    v_cvt_pk_bf16_f32 v131, v60, v61
    v_mfma_f32_16x16x32_bf16 v[236:239], v[116:119], v[140:143], v[236:239]
    v_exp_f32 v58, v76
    v_exp_f32 v59, v77
    v_mfma_f32_16x16x32_bf16 v[232:235], v[116:119], v[136:139], v[232:235]
    ds_read_b128 v[116:119], v48 offset:37888
    v_cvt_pk_bf16_f32 v134, v58, v59
    v_mfma_f32_16x16x32_bf16 v[240:243], v[120:123], v[136:139], v[240:243]
    v_exp_f32 v60, v78
    v_exp_f32 v61, v79
    v_mfma_f32_16x16x32_bf16 v[244:247], v[120:123], v[140:143], v[244:247]
    ds_read_b128 v[120:123], v48 offset:38912
    v_cvt_pk_bf16_f32 v135, v60, v61
    v_mfma_f32_16x16x32_bf16 v[252:255], v[124:127], v[140:143], v[252:255]
    s_waitcnt lgkmcnt(6)
    v_or3_b32 v62, v128, v129, v132
    v_or3_b32 v62, v62, v133, v130
    v_or3_b32 v62, v62, v131, v134
    v_bitop3_b32 v62, v62, v135, s72 bitop3:0xa8
    v_cmp_ne_u32 vcc, s65, v62
    v_mfma_f32_16x16x32_bf16 v[248:251], v[124:127], v[136:139], v[248:251]
    ds_read_b128 v[124:127], v48 offset:39936
    s_cbranch_vccnz L_back_21_h
L_back_21:
L_pv0:
    v_mfma_f32_16x16x32_bf16 v[192:195], v[96:99], v[128:131], v[192:195]
    s_waitcnt lgkmcnt(6)
    v_mfma_f32_16x16x32_bf16 v[196:199], v[96:99], v[132:135], v[196:199]
    v_mfma_f32_16x16x32_bf16 v[204:207], v[100:103], v[132:135], v[204:207]
    s_waitcnt lgkmcnt(5)
    v_mfma_f32_16x16x32_bf16 v[200:203], v[100:103], v[128:131], v[200:203]
    v_smfmac_f32_16x16x64_bf16 v[160:163], v[164:167], v[128:135], v168
    v_mfma_f32_16x16x32_bf16 v[208:211], v[104:107], v[128:131], v[208:211]
    s_waitcnt lgkmcnt(4)
    v_mfma_f32_16x16x32_bf16 v[212:215], v[104:107], v[132:135], v[212:215]
    v_mfma_f32_16x16x32_bf16 v[220:223], v[108:111], v[132:135], v[220:223]
    s_waitcnt lgkmcnt(3)
    v_mfma_f32_16x16x32_bf16 v[216:219], v[108:111], v[128:131], v[216:219]
    v_mfma_f32_16x16x32_bf16 v[224:227], v[112:115], v[128:131], v[224:227]
    s_waitcnt lgkmcnt(2)
    v_mfma_f32_16x16x32_bf16 v[228:231], v[112:115], v[132:135], v[228:231]
    v_mfma_f32_16x16x32_bf16 v[236:239], v[116:119], v[132:135], v[236:239]
    s_waitcnt lgkmcnt(1)
    v_mfma_f32_16x16x32_bf16 v[232:235], v[116:119], v[128:131], v[232:235]
    v_mfma_f32_16x16x32_bf16 v[240:243], v[120:123], v[128:131], v[240:243]
    s_waitcnt lgkmcnt(0)
    v_mfma_f32_16x16x32_bf16 v[244:247], v[120:123], v[132:135], v[244:247]
    v_mfma_f32_16x16x32_bf16 v[252:255], v[124:127], v[132:135], v[252:255]
    v_mfma_f32_16x16x32_bf16 v[248:251], v[124:127], v[128:131], v[248:251]
L_fin:
    v_and_b32 v3, 7, v1
    v_lshlrev_b32 v3, 2, v3
    s_mov_b32 s72, 0x3a0000
    buffer_load_dword v51, v3, s[8:11], s72 offen sc1
    v_add_f32 v56, v160, v161
    v_rcp_f32 v56, v56
    v_add_f32 v57, v162, v163
    v_rcp_f32 v57, v57
    s_lshl_b32 s6, s60, 18
    s_lshl_b32 s7, s4, 12
    s_add_u32 s6, s6, s7
    s_add_u32 s6, s6, 50331648
    s_nop 4
    v_mul_f32 v192, v56, v192
    v_mul_f32 v193, v56, v193
    v_mul_f32 v194, v56, v194
    v_mul_f32 v195, v56, v195
    v_cvt_pk_bf16_f32 v16, v192, v193
    v_cvt_pk_bf16_f32 v17, v194, v195
    v_mul_f32 v200, v56, v200
    v_mul_f32 v201, v56, v201
    v_mul_f32 v202, v56, v202
    v_mul_f32 v203, v56, v203
    v_cvt_pk_bf16_f32 v18, v200, v201
    v_cvt_pk_bf16_f32 v19, v202, v203
    buffer_store_dwordx4 v[16:19], v13, s[8:11], s6 offen offset:0 sc1
    v_mul_f32 v208, v56, v208
    v_mul_f32 v209, v56, v209
    v_mul_f32 v210, v56, v210
    v_mul_f32 v211, v56, v211
    v_cvt_pk_bf16_f32 v20, v208, v209
    v_cvt_pk_bf16_f32 v21, v210, v211
    v_mul_f32 v216, v56, v216
    v_mul_f32 v217, v56, v217
    v_mul_f32 v218, v56, v218
    v_mul_f32 v219, v56, v219
    v_cvt_pk_bf16_f32 v22, v216, v217
    v_cvt_pk_bf16_f32 v23, v218, v219
    buffer_store_dwordx4 v[20:23], v13, s[8:11], s6 offen offset:1024 sc1
    v_mul_f32 v224, v56, v224
    v_mul_f32 v225, v56, v225
    v_mul_f32 v226, v56, v226
    v_mul_f32 v227, v56, v227
    v_cvt_pk_bf16_f32 v24, v224, v225
    v_cvt_pk_bf16_f32 v25, v226, v227
    v_mul_f32 v232, v56, v232
    v_mul_f32 v233, v56, v233
    v_mul_f32 v234, v56, v234
    v_mul_f32 v235, v56, v235
    v_cvt_pk_bf16_f32 v26, v232, v233
    v_cvt_pk_bf16_f32 v27, v234, v235
    buffer_store_dwordx4 v[24:27], v13, s[8:11], s6 offen offset:2048 sc1
    v_mul_f32 v240, v56, v240
    v_mul_f32 v241, v56, v241
    v_mul_f32 v242, v56, v242
    v_mul_f32 v243, v56, v243
    v_cvt_pk_bf16_f32 v28, v240, v241
    v_cvt_pk_bf16_f32 v29, v242, v243
    v_mul_f32 v248, v56, v248
    v_mul_f32 v249, v56, v249
    v_mul_f32 v250, v56, v250
    v_mul_f32 v251, v56, v251
    v_cvt_pk_bf16_f32 v30, v248, v249
    v_cvt_pk_bf16_f32 v31, v250, v251
    buffer_store_dwordx4 v[28:31], v13, s[8:11], s6 offen offset:3072 sc1
    s_add_u32 s6, s6, 0x20000
    v_mul_f32 v196, v57, v196
    v_mul_f32 v197, v57, v197
    v_mul_f32 v198, v57, v198
    v_mul_f32 v199, v57, v199
    v_cvt_pk_bf16_f32 v32, v196, v197
    v_cvt_pk_bf16_f32 v33, v198, v199
    v_mul_f32 v204, v57, v204
    v_mul_f32 v205, v57, v205
    v_mul_f32 v206, v57, v206
    v_mul_f32 v207, v57, v207
    v_cvt_pk_bf16_f32 v34, v204, v205
    v_cvt_pk_bf16_f32 v35, v206, v207
    buffer_store_dwordx4 v[32:35], v13, s[8:11], s6 offen offset:0 sc1
    v_mul_f32 v212, v57, v212
    v_mul_f32 v213, v57, v213
    v_mul_f32 v214, v57, v214
    v_mul_f32 v215, v57, v215
    v_cvt_pk_bf16_f32 v36, v212, v213
    v_cvt_pk_bf16_f32 v37, v214, v215
    v_mul_f32 v220, v57, v220
    v_mul_f32 v221, v57, v221
    v_mul_f32 v222, v57, v222
    v_mul_f32 v223, v57, v223
    v_cvt_pk_bf16_f32 v38, v220, v221
    v_cvt_pk_bf16_f32 v39, v222, v223
    buffer_store_dwordx4 v[36:39], v13, s[8:11], s6 offen offset:1024 sc1
    v_mul_f32 v228, v57, v228
    v_mul_f32 v229, v57, v229
    v_mul_f32 v230, v57, v230
    v_mul_f32 v231, v57, v231
    v_cvt_pk_bf16_f32 v40, v228, v229
    v_cvt_pk_bf16_f32 v41, v230, v231
    v_mul_f32 v236, v57, v236
    v_mul_f32 v237, v57, v237
    v_mul_f32 v238, v57, v238
    v_mul_f32 v239, v57, v239
    v_cvt_pk_bf16_f32 v42, v236, v237
    v_cvt_pk_bf16_f32 v43, v238, v239
    buffer_store_dwordx4 v[40:43], v13, s[8:11], s6 offen offset:2048 sc1
    v_mul_f32 v244, v57, v244
    v_mul_f32 v245, v57, v245
    v_mul_f32 v246, v57, v246
    v_mul_f32 v247, v57, v247
    v_cvt_pk_bf16_f32 v44, v244, v245
    v_cvt_pk_bf16_f32 v45, v246, v247
    v_mul_f32 v252, v57, v252
    v_mul_f32 v253, v57, v253
    v_mul_f32 v254, v57, v254
    v_mul_f32 v255, v57, v255
    v_cvt_pk_bf16_f32 v46, v252, v253
    v_cvt_pk_bf16_f32 v47, v254, v255
    buffer_store_dwordx4 v[44:47], v13, s[8:11], s6 offen offset:3072 sc1
    s_cmp_gt_i32 s62, s63
    s_cbranch_scc1 L_pre
    s_waitcnt vmcnt(8)
    s_call_b64 s[82:83], L_pend
    s_barrier
    s_waitcnt vmcnt(0)
    s_lshl_b32 s6, s60, 5
    s_add_u32 s6, s6, s4
    s_lshl_b32 s6, s6, 7
    s_add_u32 s6, s6, 3932160
    v_mov_b32 v2, 1
    v_mov_b32 v3, 0x5000000
    v_writelane_b32 v3, s6, 0
    buffer_store_dword v2, v3, s[8:11], 0 offen sc1
    s_call_b64 s[82:83], L_load
    s_add_i32 s62, s62, 1
    s_lshl_b32 s6, s3, 8
    s_add_u32 s6, s6, s2
    s_cmp_eq_u32 s6, 31
    s_cbranch_scc1 L_top
L_idle:
    s_sub_i32 s6, s63, 5
    s_cmp_gt_i32 s62, s6
    s_cbranch_scc1 L_pre
    s_waitcnt vmcnt(0) lgkmcnt(0)
    s_call_b64 s[82:83], L_pend
    s_barrier
    s_call_b64 s[82:83], L_load
    s_add_i32 s62, s62, 1
    s_cmp_lt_u32 s61, 54
    s_cbranch_scc1 L_moe
    s_branch L_idle
L_pre:
    s_cmp_lt_u32 s3, 4
    s_cbranch_scc1 L_pre1
    s_barrier
    s_lshl_b32 s7, s76, 13
    s_add_u32 s7, s7, 0x10000
    v_add_u32 v3, s7, v13
    v_add_u32 v2, 0x10000, v3
    s_lshl_b32 s7, s76, 12
    s_add_u32 s7, s7, 0x10000
    v_add_u32 v12, s7, v13
    ds_read_b128 v[96:99], v2 offset:0
    ds_read_b128 v[100:103], v2 offset:1024
    ds_read_b128 v[104:107], v2 offset:2048
    ds_read_b128 v[108:111], v2 offset:3072
    ds_read_b128 v[112:115], v2 offset:4096
    ds_read_b128 v[116:119], v2 offset:5120
    ds_read_b128 v[120:123], v2 offset:6144
    ds_read_b128 v[124:127], v2 offset:7168
    ds_read_b128 v[128:131], v3 offset:0
    ds_read_b128 v[132:135], v3 offset:1024
    ds_read_b128 v[136:139], v3 offset:2048
    ds_read_b128 v[140:143], v3 offset:3072
    s_add_u32 s6, s76, 0
    s_and_b32 s6, s6, 3
    s_lshl_b32 s6, s6, 10
    v_add_u32 v44, s6, v13
    s_add_u32 s6, s76, 1
    s_and_b32 s6, s6, 3
    s_lshl_b32 s6, s6, 10
    v_add_u32 v45, s6, v13
    s_add_u32 s6, s76, 2
    s_and_b32 s6, s6, 3
    s_lshl_b32 s6, s6, 10
    v_add_u32 v46, s6, v13
    s_add_u32 s6, s76, 3
    s_and_b32 s6, s6, 3
    s_lshl_b32 s6, s6, 10
    v_add_u32 v47, s6, v13
    v_add_u32 v52, 4096, v13
    s_lshr_b32 s69, s4, 3
    s_lshl_b32 s69, s69, 2
    s_add_u32 s69, s69, s76
    s_mul_i32 s69, s69, 327680
    s_and_b32 s7, s4, 3
    s_mul_i32 s7, s7, 10240
    s_add_u32 s69, s69, s7
    s_add_u32 s69, s69, 4199424
    s_and_b32 s6, s4, 4
    s_lshr_b32 s7, s4, 3
    s_add_u32 s6, s6, s7
    s_lshl_b32 s7, s5, 3
    s_add_u32 s68, s6, s7
    s_sub_u32 s7, 120, s7
    s_add_u32 s61, s6, s7
    s_lshr_b32 s6, s4, 3
    s_lshl_b32 s6, s6, 15
    s_lshl_b32 s99, s3, 12
    s_add_u32 s66, s6, s99
    s_add_u32 s66, s66, 50331648
    s_lshl_b32 s6, s76, 13
    v_add_u32 v4, s6, v13
    v_add_u32 v7, 65536, v4
    ds_read_b128 v[144:147], v3 offset:4096
    ds_read_b128 v[148:151], v3 offset:5120
    ds_read_b128 v[152:155], v3 offset:6144
    ds_read_b128 v[156:159], v3 offset:7168
    ds_read_b128 v[160:163], v12 offset:49152
    ds_read_b128 v[164:167], v12 offset:50176
    ds_read_b128 v[168:171], v12 offset:51200
    ds_read_b128 v[172:175], v12 offset:52224
    s_waitcnt lgkmcnt(0)
    s_barrier
    s_add_u32 s75, s69, 163840
    buffer_load_dwordx4 v[176:179], v44, s[8:11], s75 offen sc1
    buffer_load_dwordx4 v[180:183], v45, s[8:11], s75 offen sc1
    buffer_load_dwordx4 v[184:187], v46, s[8:11], s75 offen sc1
    buffer_load_dwordx4 v[188:191], v47, s[8:11], s75 offen sc1
    buffer_load_dwordx4 v[192:195], v52, s[8:11], s75 offen sc1
    s_branch L_adone
L_pre1:
    s_mov_b32 s28, s56
    s_mov_b32 s29, s57
    s_mov_b32 s30, 0x100
    s_mov_b32 s31, 0x20000
    v_and_b32 v3, 31, v1
    v_lshlrev_b32 v3, 2, v3
    buffer_load_dword v12, v3, s[28:31], 0 offen offset:128 sc1
    v_and_b32 v3, 7, v1
    v_lshlrev_b32 v3, 2, v3
    s_mov_b32 s72, 0x3a0000
    buffer_load_dword v51, v3, s[8:11], s72 offen sc1
    s_add_u32 s6, s76, 0
    s_and_b32 s6, s6, 3
    s_lshl_b32 s6, s6, 10
    v_add_u32 v44, s6, v13
    s_add_u32 s6, s76, 1
    s_and_b32 s6, s6, 3
    s_lshl_b32 s6, s6, 10
    v_add_u32 v45, s6, v13
    s_add_u32 s6, s76, 2
    s_and_b32 s6, s6, 3
    s_lshl_b32 s6, s6, 10
    v_add_u32 v46, s6, v13
    s_add_u32 s6, s76, 3
    s_and_b32 s6, s6, 3
    s_lshl_b32 s6, s6, 10
    v_add_u32 v47, s6, v13
    v_add_u32 v52, 4096, v13
    s_lshr_b32 s69, s4, 3
    s_lshl_b32 s69, s69, 2
    s_add_u32 s69, s69, s76
    s_mul_i32 s69, s69, 327680
    s_and_b32 s7, s4, 3
    s_mul_i32 s7, s7, 10240
    s_add_u32 s69, s69, s7
    s_add_u32 s69, s69, 4194304
    s_and_b32 s6, s4, 4
    s_lshr_b32 s7, s4, 3
    s_add_u32 s6, s6, s7
    s_lshl_b32 s7, s5, 3
    s_add_u32 s68, s6, s7
    s_sub_u32 s7, 120, s7
    s_add_u32 s61, s6, s7
    s_sub_i32 s6, s63, 4
    s_cmp_gt_i32 s62, s6
    s_cbranch_scc1 L_wpoll
    s_cmp_eq_i32 s62, s63
    s_cbranch_scc1 L_lw0
    s_waitcnt vmcnt(0)
L_lw0:
    s_waitcnt vmcnt(20)
    s_call_b64 s[82:83], L_pend
    s_barrier
    s_call_b64 s[82:83], L_load
    s_add_i32 s62, s62, 1
L_e2:
    v_cmp_gt_u32 vcc, 4, v12
    s_cbranch_vccz L_wok
L_wpoll:
    s_mov_b32 s28, s56
    s_mov_b32 s29, s57
    s_mov_b32 s30, 0x100
    s_mov_b32 s31, 0x20000
    v_and_b32 v3, 31, v1
    v_lshlrev_b32 v3, 2, v3
    s_mov_b32 s79, 262144
L_poll_25:
    buffer_load_dword v2, v3, s[28:31], 0 offen offset:128 sc1
    s_waitcnt vmcnt(0)
    v_cmp_gt_u32 vcc, 4, v2
    s_cbranch_vccz L_polldone_26
    s_sleep 8
    s_sub_u32 s79, s79, 1
    s_cmp_lg_u32 s79, 0
    s_cbranch_scc1 L_poll_25
L_polldone_26:
L_wok:
    s_mov_b32 s90, 1
    s_add_u32 s75, s69, 0
    buffer_load_dwordx4 v[96:99], v44, s[8:11], s75 offen sc1
    buffer_load_dwordx4 v[100:103], v45, s[8:11], s75 offen sc1
    buffer_load_dwordx4 v[104:107], v46, s[8:11], s75 offen sc1
    buffer_load_dwordx4 v[108:111], v47, s[8:11], s75 offen sc1
    buffer_load_dwordx4 v[112:115], v52, s[8:11], s75 offen sc1
    s_add_u32 s75, s69, 40960
    buffer_load_dwordx4 v[116:119], v44, s[8:11], s75 offen sc1
    buffer_load_dwordx4 v[120:123], v45, s[8:11], s75 offen sc1
    buffer_load_dwordx4 v[124:127], v46, s[8:11], s75 offen sc1
    buffer_load_dwordx4 v[128:131], v47, s[8:11], s75 offen sc1
    buffer_load_dwordx4 v[132:135], v52, s[8:11], s75 offen sc1
    s_add_u32 s75, s69, 81920
    buffer_load_dwordx4 v[136:139], v44, s[8:11], s75 offen sc1
    buffer_load_dwordx4 v[140:143], v45, s[8:11], s75 offen sc1
    buffer_load_dwordx4 v[144:147], v46, s[8:11], s75 offen sc1
    buffer_load_dwordx4 v[148:151], v47, s[8:11], s75 offen sc1
    buffer_load_dwordx4 v[152:155], v52, s[8:11], s75 offen sc1
    s_cmp_gt_i32 s62, s63
    s_cbranch_scc1 L_e3
    s_cmp_eq_i32 s62, s63
    s_cbranch_scc1 L_lw1
    s_waitcnt vmcnt(15)
L_lw1:
    s_waitcnt vmcnt(20)
    s_call_b64 s[82:83], L_pend
    s_barrier
    s_call_b64 s[82:83], L_load
    s_add_i32 s62, s62, 1
L_e3:
    s_add_u32 s75, s69, 122880
    buffer_load_dwordx4 v[156:159], v44, s[8:11], s75 offen sc1
    buffer_load_dwordx4 v[160:163], v45, s[8:11], s75 offen sc1
    buffer_load_dwordx4 v[164:167], v46, s[8:11], s75 offen sc1
    buffer_load_dwordx4 v[168:171], v47, s[8:11], s75 offen sc1
    buffer_load_dwordx4 v[172:175], v52, s[8:11], s75 offen sc1
    s_add_u32 s75, s69, 163840
    buffer_load_dwordx4 v[176:179], v44, s[8:11], s75 offen sc1
    buffer_load_dwordx4 v[180:183], v45, s[8:11], s75 offen sc1
    buffer_load_dwordx4 v[184:187], v46, s[8:11], s75 offen sc1
    buffer_load_dwordx4 v[188:191], v47, s[8:11], s75 offen sc1
    buffer_load_dwordx4 v[192:195], v52, s[8:11], s75 offen sc1
    s_add_u32 s75, s69, 204800
    buffer_load_dwordx4 v[196:199], v44, s[8:11], s75 offen sc1
    buffer_load_dwordx4 v[200:203], v45, s[8:11], s75 offen sc1
    buffer_load_dwordx4 v[204:207], v46, s[8:11], s75 offen sc1
    buffer_load_dwordx4 v[208:211], v47, s[8:11], s75 offen sc1
    buffer_load_dwordx4 v[212:215], v52, s[8:11], s75 offen sc1
    s_cmp_gt_i32 s62, s63
    s_cbranch_scc1 L_e4
    s_cmp_eq_i32 s62, s63
    s_cbranch_scc1 L_lw2
    s_waitcnt vmcnt(15)
L_lw2:
    s_waitcnt vmcnt(20)
    s_call_b64 s[82:83], L_pend
    s_barrier
    s_call_b64 s[82:83], L_load
    s_add_i32 s62, s62, 1
L_e4:
    s_lshr_b32 s7, s3, 1
    s_lshl_b32 s7, s7, 4
    s_add_u32 s6, s5, s7
    s_cmp_lg_u32 s6, 2
    s_cbranch_scc1 L_yl0
    v_min_u32 v3, 53, v1
    v_lshlrev_b32 v3, 7, v3
    s_mov_b32 s72, 0xf20000
    buffer_load_dwordx4 v[16:19], v3, s[8:11], s72 offen sc1
L_yl0:
    s_add_u32 s75, s69, 245760
    buffer_load_dwordx4 v[216:219], v44, s[8:11], s75 offen sc1
    buffer_load_dwordx4 v[220:223], v45, s[8:11], s75 offen sc1
    buffer_load_dwordx4 v[224:227], v46, s[8:11], s75 offen sc1
    buffer_load_dwordx4 v[228:231], v47, s[8:11], s75 offen sc1
    buffer_load_dwordx4 v[232:235], v52, s[8:11], s75 offen sc1
    s_add_u32 s75, s69, 286720
    buffer_load_dwordx4 v[236:239], v44, s[8:11], s75 offen sc1
    buffer_load_dwordx4 v[240:243], v45, s[8:11], s75 offen sc1
    buffer_load_dwordx4 v[244:247], v46, s[8:11], s75 offen sc1
    buffer_load_dwordx4 v[248:251], v47, s[8:11], s75 offen sc1
    buffer_load_dwordx4 v[252:255], v52, s[8:11], s75 offen sc1
    s_cmp_gt_i32 s62, s63
    s_cbranch_scc1 L_e5
    s_cmp_eq_i32 s62, s63
    s_cbranch_scc1 L_lw3
    s_waitcnt vmcnt(10)
L_lw3:
    s_waitcnt vmcnt(20)
    s_call_b64 s[82:83], L_pend
    s_barrier
    s_call_b64 s[82:83], L_load
    s_add_i32 s62, s62, 1
L_e5:
    s_mov_b32 s101, 0
    s_lshr_b32 s7, s3, 1
    s_lshl_b32 s7, s7, 4
    s_add_u32 s6, s5, s7
    s_cmp_lg_u32 s6, 2
    s_cbranch_scc1 L_yl1
    v_and_b32 v16, v16, v17
    v_and_b32 v16, v16, v18
    v_and_b32 v16, v16, v19
    v_cmp_ne_u32 vcc, 1, v16
    s_cbranch_vccnz L_yl1
    s_call_b64 s[80:81], L_yld
L_yl1:
    v_and_b32 v3, 1, v1
    v_lshlrev_b32 v3, 12, v3
    v_and_b32 v2, 2, v1
    v_lshl_add_u32 v3, v2, 8, v3
    s_lshr_b32 s72, s68, 2
    s_lshl_b32 s72, s72, 6
    s_andn2_b32 s6, s4, 7
    s_add_u32 s72, s72, s6
    s_add_u32 s72, s72, s3
    s_lshl_b32 s72, s72, 7
    s_add_u32 s72, s72, 3932160
    buffer_load_dword v50, v3, s[8:11], s72 offen sc1
    s_cmp_gt_i32 s62, s63
    s_cbranch_scc1 L_e6
    s_waitcnt vmcnt(20)
    s_call_b64 s[82:83], L_pend
    s_barrier
    s_call_b64 s[82:83], L_load
    s_add_i32 s62, s62, 1
L_e6:
    s_lshr_b32 s7, s3, 1
    s_lshl_b32 s7, s7, 4
    s_add_u32 s6, s5, s7
    s_cmp_lg_u32 s6, 2
    s_cbranch_scc1 L_yd
    s_cmp_lg_u32 s101, 0
    s_cbranch_scc1 L_yf
    v_min_u32 v3, 53, v1
    v_lshlrev_b32 v3, 7, v3
    s_mov_b32 s72, 0xf20000
    s_mov_b32 s79, 262144
L_poll_31:
    buffer_load_dwordx4 v[16:19], v3, s[8:11], s72 offen sc1
    s_waitcnt vmcnt(0)
    v_and_b32 v16, v16, v17
    v_and_b32 v16, v16, v18
    v_and_b32 v16, v16, v19
    v_cmp_ne_u32 vcc, 1, v16
    s_cbranch_vccz L_polldone_32
    s_sleep 16
    s_sub_u32 s79, s79, 1
    s_cmp_lg_u32 s79, 0
    s_cbranch_scc1 L_poll_31
L_polldone_32:
    s_call_b64 s[80:81], L_yld
L_yf:
    s_bfe_u32 s6, s98, 0x10000b
    s_xor_b32 s7, s6, 0xffff
    s_bitcmp1_b32 s6, 15
    s_bitset0_b32 s6, 15
    s_cselect_b32 s6, s6, s7
    s_lshl_b32 s6, s6, 16
    v_mov_b32 v9, s6
    v_mul_f32 v9, 0xbfb8aa3b, v9
    v_exp_f32 v9, v9
    s_nop 0
    v_add_f32 v9, 1.0, v9
    v_rcp_f32 v9, v9
    s_nop 0
    v_cvt_pk_bf16_f32 v9, v9, v9
    v_lshlrev_b32 v9, 16, v9
    v_lshlrev_b32 v10, 2, v1
    v_mov_b32 v3, 0x5000000
    s_waitcnt vmcnt(0)
    v_pk_add_f32 v[16:17], v[16:17], v[20:21]
    v_pk_add_f32 v[18:19], v[18:19], v[22:23]
    v_pk_add_f32 v[16:17], v[16:17], v[24:25]
    v_pk_add_f32 v[18:19], v[18:19], v[26:27]
    v_pk_add_f32 v[16:17], v[16:17], v[28:29]
    v_pk_add_f32 v[18:19], v[18:19], v[30:31]
    v_pk_add_f32 v[16:17], v[16:17], v[32:33]
    v_pk_add_f32 v[18:19], v[18:19], v[34:35]
    v_pk_add_f32 v[16:17], v[16:17], v[36:37]
    v_pk_add_f32 v[18:19], v[18:19], v[38:39]
    v_pk_add_f32 v[16:17], v[16:17], v[40:41]
    v_pk_add_f32 v[18:19], v[18:19], v[42:43]
    v_pk_add_f32 v[16:17], v[16:17], v[56:57]
    v_pk_add_f32 v[18:19], v[18:19], v[58:59]
    v_pk_add_f32 v[16:17], v[16:17], v[60:61]
    v_pk_add_f32 v[18:19], v[18:19], v[62:63]
    v_pk_add_f32 v[16:17], v[16:17], v[64:65]
    v_pk_add_f32 v[18:19], v[18:19], v[66:67]
    v_pk_add_f32 v[16:17], v[16:17], v[68:69]
    v_pk_add_f32 v[18:19], v[18:19], v[70:71]
    v_pk_add_f32 v[16:17], v[16:17], v[72:73]
    v_pk_add_f32 v[18:19], v[18:19], v[74:75]
    v_pk_add_f32 v[16:17], v[16:17], v[76:77]
    v_pk_add_f32 v[18:19], v[18:19], v[78:79]
    v_pk_add_f32 v[16:17], v[16:17], v[80:81]
    v_pk_add_f32 v[18:19], v[18:19], v[82:83]
    v_pk_add_f32 v[16:17], v[16:17], v[84:85]
    v_pk_add_f32 v[18:19], v[18:19], v[86:87]
    v_pk_add_f32 v[16:17], v[16:17], v[88:89]
    v_pk_add_f32 v[18:19], v[18:19], v[90:91]
    v_pk_add_f32 v[16:17], v[16:17], v[92:93]
    v_pk_add_f32 v[18:19], v[18:19], v[94:95]
    v_pk_add_f32 v[16:17], v[16:17], v[4:5]
    v_pk_add_f32 v[18:19], v[18:19], v[6:7]
    ds_bpermute_b32 v20, v10, v16 offset:80
    ds_bpermute_b32 v21, v10, v17 offset:80
    ds_bpermute_b32 v22, v10, v18 offset:80
    ds_bpermute_b32 v23, v10, v19 offset:80
    ds_bpermute_b32 v24, v10, v16 offset:160
    ds_bpermute_b32 v25, v10, v17 offset:160
    ds_bpermute_b32 v26, v10, v18 offset:160
    ds_bpermute_b32 v27, v10, v19 offset:160
    s_waitcnt lgkmcnt(0)
    v_add_f32 v16, v16, v20
    v_add_f32 v16, v16, v24
    v_cvt_pk_bf16_f32 v16, v16, v16
    v_lshlrev_b32 v16, 16, v16
    v_mul_f32 v16, v16, v9
    v_cvt_pk_bf16_f32 v16, v16, v16
    v_lshlrev_b32 v16, 16, v16
    v_lshlrev_b32 v8, 16, v54
    v_add_f32 v16, v16, v8
    v_add_f32 v17, v17, v21
    v_add_f32 v17, v17, v25
    v_cvt_pk_bf16_f32 v17, v17, v17
    v_lshlrev_b32 v17, 16, v17
    v_mul_f32 v17, v17, v9
    v_cvt_pk_bf16_f32 v17, v17, v17
    v_lshlrev_b32 v17, 16, v17
    v_and_b32 v8, 0xffff0000, v54
    v_add_f32 v17, v17, v8
    v_add_f32 v18, v18, v22
    v_add_f32 v18, v18, v26
    v_cvt_pk_bf16_f32 v18, v18, v18
    v_lshlrev_b32 v18, 16, v18
    v_mul_f32 v18, v18, v9
    v_cvt_pk_bf16_f32 v18, v18, v18
    v_lshlrev_b32 v18, 16, v18
    v_lshlrev_b32 v8, 16, v55
    v_add_f32 v18, v18, v8
    v_add_f32 v19, v19, v23
    v_add_f32 v19, v19, v27
    v_cvt_pk_bf16_f32 v19, v19, v19
    v_lshlrev_b32 v19, 16, v19
    v_mul_f32 v19, v19, v9
    v_cvt_pk_bf16_f32 v19, v19, v19
    v_lshlrev_b32 v19, 16, v19
    v_and_b32 v8, 0xffff0000, v55
    v_add_f32 v19, v19, v8
    v_cvt_pk_bf16_f32 v20, v16, v17
    v_cvt_pk_bf16_f32 v21, v18, v19
    v_lshlrev_b32 v2, 3, v1
    v_cmp_lt_u32 vcc, 19, v1
    s_mul_i32 s6, s96, 1280
    s_mul_i32 s7, s97, 160
    v_cndmask_b32 v2, v2, v3, vcc
    s_add_u32 s6, s6, s7
    s_add_u32 s6, s6, 3837952
    buffer_store_dwordx2 v[20:21], v2, s[8:11], s6 offen sc1
L_yd:
    s_lshr_b32 s6, s4, 3
    s_lshl_b32 s6, s6, 15
    s_lshl_b32 s99, s3, 12
    s_add_u32 s66, s6, s99
    s_add_u32 s66, s66, 50331648
    s_lshl_b32 s6, s76, 13
    v_add_u32 v4, s6, v13
    v_add_u32 v7, 65536, v4
    s_waitcnt vmcnt(0)
    v_cmp_ne_u32 vcc, 1, v50
    s_cbranch_vccz L_ce
    v_and_b32 v3, 1, v1
    v_lshlrev_b32 v3, 12, v3
    v_and_b32 v2, 2, v1
    v_lshl_add_u32 v3, v2, 8, v3
    s_lshr_b32 s72, s68, 2
    s_lshl_b32 s72, s72, 6
    s_andn2_b32 s6, s4, 7
    s_add_u32 s72, s72, s6
    s_add_u32 s72, s72, s3
    s_lshl_b32 s72, s72, 7
    s_add_u32 s72, s72, 3932160
    s_mov_b32 s79, 262144
L_poll_33:
    buffer_load_dword v2, v3, s[8:11], s72 offen sc1
    s_waitcnt vmcnt(0)
    v_cmp_ne_u32 vcc, 1, v2
    s_cbranch_vccz L_polldone_34
    s_sleep 4
    s_sub_u32 s79, s79, 1
    s_cmp_lg_u32 s79, 0
    s_cbranch_scc1 L_poll_33
L_polldone_34:
L_ce:
    s_add_u32 s65, s68, 1
    s_and_b32 s65, s65, 3
    s_andn2_b32 s7, s68, 3
    s_add_u32 s65, s65, s7
    s_lshl_b32 s65, s65, 17
    s_add_u32 s65, s65, s66
    s_add_u32 m0, s99, 0
    s_add_u32 s65, s65, 0
    buffer_load_dwordx4 v13, s[8:11], s65 offen offset:0 sc1 lds
    buffer_load_dwordx4 v13, s[8:11], s65 offen offset:1024 sc1 lds
    buffer_load_dwordx4 v13, s[8:11], s65 offen offset:2048 sc1 lds
    buffer_load_dwordx4 v13, s[8:11], s65 offen offset:3072 sc1 lds
    s_add_u32 s65, s68, 1
    s_and_b32 s65, s65, 3
    s_andn2_b32 s7, s68, 3
    s_add_u32 s65, s65, s7
    s_lshl_b32 s65, s65, 17
    s_add_u32 s65, s65, s66
    s_add_u32 m0, s99, 16384
    s_add_u32 s65, s65, 16384
    buffer_load_dwordx4 v13, s[8:11], s65 offen offset:0 sc1 lds
    buffer_load_dwordx4 v13, s[8:11], s65 offen offset:1024 sc1 lds
    buffer_load_dwordx4 v13, s[8:11], s65 offen offset:2048 sc1 lds
    buffer_load_dwordx4 v13, s[8:11], s65 offen offset:3072 sc1 lds
    s_add_u32 s65, s68, 2
    s_and_b32 s65, s65, 3
    s_andn2_b32 s7, s68, 3
    s_add_u32 s65, s65, s7
    s_lshl_b32 s65, s65, 17
    s_add_u32 s65, s65, s66
    s_add_u32 m0, s99, 32768
    s_add_u32 s65, s65, 0
    buffer_load_dwordx4 v13, s[8:11], s65 offen offset:0 sc1 lds
    buffer_load_dwordx4 v13, s[8:11], s65 offen offset:1024 sc1 lds
    buffer_load_dwordx4 v13, s[8:11], s65 offen offset:2048 sc1 lds
    buffer_load_dwordx4 v13, s[8:11], s65 offen offset:3072 sc1 lds
    s_add_u32 s65, s68, 2
    s_and_b32 s65, s65, 3
    s_andn2_b32 s7, s68, 3
    s_add_u32 s65, s65, s7
    s_lshl_b32 s65, s65, 17
    s_add_u32 s65, s65, s66
    s_add_u32 m0, s99, 49152
    s_add_u32 s65, s65, 16384
    buffer_load_dwordx4 v13, s[8:11], s65 offen offset:0 sc1 lds
    buffer_load_dwordx4 v13, s[8:11], s65 offen offset:1024 sc1 lds
    buffer_load_dwordx4 v13, s[8:11], s65 offen offset:2048 sc1 lds
    buffer_load_dwordx4 v13, s[8:11], s65 offen offset:3072 sc1 lds
    s_lshr_b32 s7, s3, 1
    s_lshl_b32 s7, s7, 4
    s_add_u32 s6, s5, s7
    s_cmp_lg_u32 s6, 2
    s_cbranch_scc1 L_yg
    s_lshl_b32 s6, s5, 5
    s_add_u32 s6, s6, s4
    s_lshl_b32 s6, s6, 5
    s_add_u32 s6, s6, s3
    s_lshl_b32 s6, s6, 2
    s_add_u32 s6, s6, 3899392
    v_mov_b32 v2, 1
    v_mov_b32 v3, 0x5000000
    v_writelane_b32 v3, s6, 0
    buffer_store_dword v2, v3, s[8:11], 0 offen sc1
    s_waitcnt vmcnt(1)
    s_branch L_ye
L_yg:
    s_waitcnt vmcnt(0)
L_ye:
    s_setprio 0
    s_barrier
    s_branch L_adone
L_yld:
    v_cmp_le_i32 vcc, 0, v51
    s_cbranch_vccz L_idx_oka
    v_and_b32 v3, 7, v1
    v_lshlrev_b32 v3, 2, v3
    s_mov_b32 s72, 0x3a0000
    s_mov_b32 s79, 262144
L_poll_35:
    buffer_load_dword v51, v3, s[8:11], s72 offen sc1
    s_waitcnt vmcnt(0)
    v_cmp_le_i32 vcc, 0, v51
    s_cbranch_vccz L_polldone_36
    s_sleep 2
    s_sub_u32 s79, s79, 1
    s_cmp_lg_u32 s79, 0
    s_cbranch_scc1 L_poll_35
L_polldone_36:
L_idx_oka:
    s_lshr_b32 s96, s4, 2
    s_and_b32 s97, s4, 3
    s_lshl_b32 s97, s97, 1
    s_add_u32 s97, s97, s3
    s_mov_b32 m0, s96
    s_nop 3
    v_readlane_b32 s98, v51, m0
    s_nop 3
    s_and_b32 s100, s98, 0x7ff
    s_sub_u32 s100, 0x7ff, s100
    v_mul_u32_u24 v2, 13, v1
    v_lshrrev_b32 v2, 8, v2
    v_mul_u32_u24 v3, 20, v2
    v_sub_u32 v8, v1, v3
    s_mov_b32 s6, 368640
    v_mul_lo_u32 v2, v2, s6
    v_lshl_add_u32 v2, v8, 4, v2
    v_cmp_lt_u32 vcc, 59, v1
    v_mov_b32 v3, 0x5000000
    s_nop 0
    v_cndmask_b32 v2, v2, v3, vcc
    s_mul_i32 s6, s96, 2560
    s_mul_i32 s7, s97, 320
    s_add_u32 s6, s6, s7
    s_add_u32 s6, s6, 2686976
    buffer_load_dwordx4 v[16:19], v2, s[8:11], s6 offen sc1
    s_add_u32 s6, s6, 20480
    buffer_load_dwordx4 v[20:23], v2, s[8:11], s6 offen sc1
    s_add_u32 s6, s6, 20480
    buffer_load_dwordx4 v[24:27], v2, s[8:11], s6 offen sc1
    s_add_u32 s6, s6, 20480
    buffer_load_dwordx4 v[28:31], v2, s[8:11], s6 offen sc1
    s_add_u32 s6, s6, 20480
    buffer_load_dwordx4 v[32:35], v2, s[8:11], s6 offen sc1
    s_add_u32 s6, s6, 20480
    buffer_load_dwordx4 v[36:39], v2, s[8:11], s6 offen sc1
    s_add_u32 s6, s6, 20480
    buffer_load_dwordx4 v[40:43], v2, s[8:11], s6 offen sc1
    s_add_u32 s6, s6, 20480
    buffer_load_dwordx4 v[56:59], v2, s[8:11], s6 offen sc1
    s_add_u32 s6, s6, 20480
    buffer_load_dwordx4 v[60:63], v2, s[8:11], s6 offen sc1
    s_add_u32 s6, s6, 20480
    buffer_load_dwordx4 v[64:67], v2, s[8:11], s6 offen sc1
    s_add_u32 s6, s6, 20480
    buffer_load_dwordx4 v[68:71], v2, s[8:11], s6 offen sc1
    s_add_u32 s6, s6, 20480
    buffer_load_dwordx4 v[72:75], v2, s[8:11], s6 offen sc1
    s_add_u32 s6, s6, 20480
    buffer_load_dwordx4 v[76:79], v2, s[8:11], s6 offen sc1
    s_add_u32 s6, s6, 20480
    buffer_load_dwordx4 v[80:83], v2, s[8:11], s6 offen sc1
    s_add_u32 s6, s6, 20480
    buffer_load_dwordx4 v[84:87], v2, s[8:11], s6 offen sc1
    s_add_u32 s6, s6, 20480
    buffer_load_dwordx4 v[88:91], v2, s[8:11], s6 offen sc1
    s_add_u32 s6, s6, 20480
    buffer_load_dwordx4 v[92:95], v2, s[8:11], s6 offen sc1
    s_add_u32 s6, s6, 20480
    buffer_load_dwordx4 v[4:7], v2, s[8:11], s6 offen sc1
    s_add_u32 s6, s6, 20480
    s_lshr_b32 s6, s100, 4
    s_mul_i32 s6, s6, 20480
    s_and_b32 s7, s100, 15
    s_lshl_b32 s7, s7, 4
    s_add_u32 s6, s6, s7
    s_mul_i32 s7, s97, 2560
    s_add_u32 s6, s6, s7
    v_lshrrev_b32 v9, 1, v8
    v_lshlrev_b32 v9, 8, v9
    v_and_b32 v10, 1, v8
    v_lshl_add_u32 v9, v10, 3, v9
    buffer_load_dwordx2 v[54:55], v9, s[8:11], s6 offen sc1
    s_mov_b32 s101, 1
    s_setpc_b64 s[80:81]
L_moe:
    s_add_u32 s6, s62, s5
    s_cmp_lg_u32 s6, 5
    s_cbranch_scc1 L_idle
    s_mov_b32 s12, s48
    s_mov_b32 s13, s49
    s_mov_b32 s14, 0x21c000
    s_mov_b32 s15, 0x20000
    s_cmp_ge_u32 s3, 2
    s_cselect_b32 s12, s50, s12
    s_cselect_b32 s13, s51, s13
    s_mov_b32 s16, s52
    s_mov_b32 s17, s53
    s_mov_b32 s18, 0x21c000
    s_mov_b32 s19, 0x20000
    v_lshrrev_b32 v3, 2, v1
    v_mul_u32_u24 v3, 3456, v3
    v_and_b32 v4, 3, v1
    v_lshl_add_u32 v16, v4, 4, v3
    v_lshrrev_b32 v3, 3, v1
    v_mul_u32_u24 v3, 1280, v3
    v_and_b32 v4, 7, v1
    v_lshl_add_u32 v18, v4, 4, v3
    s_and_b32 s7, s3, 1
    s_mul_i32 s84, s7, 1105920
    s_lshl_b32 s6, s61, 6
    s_add_u32 s84, s84, s6
    s_lshl_b32 s85, s3, 13
    s_add_u32 s85, s85, 131072
    s_mul_i32 s86, s61, 40960
    s_lshl_b32 s6, s3, 7
    s_add_u32 s86, s86, s6
    s_add_u32 m0, s85, 0
    s_nop 0
    buffer_load_dwordx4 v16, s[12:15], s84 offen lds
    s_add_u32 s84, s84, 55296
    s_add_u32 m0, s85, 1024
    s_nop 0
    buffer_load_dwordx4 v16, s[12:15], s84 offen lds
    s_add_u32 s84, s84, 55296
    s_add_u32 m0, s85, 2048
    s_nop 0
    buffer_load_dwordx4 v16, s[12:15], s84 offen lds
    s_add_u32 s84, s84, 55296
    s_add_u32 m0, s85, 3072
    s_nop 0
    buffer_load_dwordx4 v16, s[12:15], s84 offen lds
    s_add_u32 s84, s84, 55296
    s_add_u32 m0, s85, 4096
    s_nop 0
    buffer_load_dwordx4 v16, s[12:15], s84 offen lds
    s_add_u32 s84, s84, 55296
    s_add_u32 m0, s85, 5120
    s_nop 0
    buffer_load_dwordx4 v16, s[12:15], s84 offen lds
    s_add_u32 s84, s84, 55296
    s_add_u32 m0, s85, 6144
    s_nop 0
    buffer_load_dwordx4 v16, s[12:15], s84 offen lds
    s_add_u32 s84, s84, 55296
    s_add_u32 m0, s85, 7168
    s_nop 0
    buffer_load_dwordx4 v16, s[12:15], s84 offen lds
    s_add_u32 s84, s84, 55296
    v_lshrrev_b32 v7, 4, v1
    v_and_b32 v2, 15, v1
    v_lshrrev_b32 v3, 2, v2
    v_lshl_add_u32 v8, v7, 3, v3
    v_lshlrev_b32 v8, 6, v8
    v_and_b32 v4, 3, v2
    v_lshl_add_u32 v8, v4, 3, v8
    v_add_u32 v17, s85, v8
    v_lshl_add_u32 v8, v7, 2, v3
    v_lshlrev_b32 v8, 7, v8
    v_lshl_add_u32 v8, v4, 3, v8
    s_add_u32 s6, s85, 4096
    v_add_u32 v19, s6, v8
    v_mul_u32_u24 v3, 2560, v2
    v_lshl_add_u32 v3, v7, 4, v3
    v_mov_b32 v4, 0x5000000
    v_cmp_gt_u32 vcc, 8, v2
    s_mul_i32 s87, s61, 20480
    s_lshl_b32 s7, s3, 8
    s_add_u32 s87, s87, s7
    s_add_u32 s87, s87, 2686976
    v_cndmask_b32 v20, v4, v3, vcc
    s_and_b32 s7, s3, 1
    s_mul_i32 s88, s7, 10240
    s_add_u32 s88, s88, 12582912
    s_waitcnt vmcnt(0) lgkmcnt(0)
    s_call_b64 s[82:83], L_pend
    s_barrier
    ds_read_b64_tr_b16 v[104:105], v17 offset:0
    ds_read_b64_tr_b16 v[106:107], v17 offset:256
    ds_read_b64_tr_b16 v[108:109], v17 offset:32
    ds_read_b64_tr_b16 v[110:111], v17 offset:288
    ds_read_b64_tr_b16 v[112:113], v17 offset:2048
    ds_read_b64_tr_b16 v[114:115], v17 offset:2304
    ds_read_b64_tr_b16 v[116:117], v17 offset:2080
    ds_read_b64_tr_b16 v[118:119], v17 offset:2336
    s_waitcnt lgkmcnt(0)
    ds_read_b64_tr_b16 v[120:121], v17 offset:4096
    ds_read_b64_tr_b16 v[122:123], v17 offset:4352
    ds_read_b64_tr_b16 v[124:125], v17 offset:4128
    ds_read_b64_tr_b16 v[126:127], v17 offset:4384
    ds_read_b64_tr_b16 v[128:129], v17 offset:6144
    ds_read_b64_tr_b16 v[130:131], v17 offset:6400
    ds_read_b64_tr_b16 v[132:133], v17 offset:6176
    ds_read_b64_tr_b16 v[134:135], v17 offset:6432
    s_waitcnt lgkmcnt(0)
    s_add_u32 m0, s85, 0
    s_nop 0
    buffer_load_dwordx4 v16, s[12:15], s84 offen lds
    s_add_u32 s84, s84, 55296
    s_add_u32 m0, s85, 1024
    s_nop 0
    buffer_load_dwordx4 v16, s[12:15], s84 offen lds
    s_add_u32 s84, s84, 55296
    s_add_u32 m0, s85, 2048
    s_nop 0
    buffer_load_dwordx4 v16, s[12:15], s84 offen lds
    s_add_u32 s84, s84, 55296
    s_add_u32 m0, s85, 3072
    s_nop 0
    buffer_load_dwordx4 v16, s[12:15], s84 offen lds
    s_add_u32 s84, s84, 55296
    s_add_u32 m0, s85, 4096
    s_nop 0
    buffer_load_dwordx4 v16, s[12:15], s84 offen lds
    s_add_u32 s84, s84, 55296
    s_add_u32 m0, s85, 5120
    s_nop 0
    buffer_load_dwordx4 v16, s[12:15], s84 offen lds
    s_add_u32 s84, s84, 55296
    s_add_u32 m0, s85, 6144
    s_nop 0
    buffer_load_dwordx4 v16, s[12:15], s84 offen lds
    s_add_u32 s84, s84, 55296
    s_add_u32 m0, s85, 7168
    s_nop 0
    buffer_load_dwordx4 v16, s[12:15], s84 offen lds
    s_add_u32 s84, s84, 55296
    s_call_b64 s[82:83], L_load
    s_add_i32 s62, s62, 1
    v_and_b32 v3, 7, v1
    v_lshlrev_b32 v3, 2, v3
    s_mov_b32 s72, 0x3a0000
    buffer_load_dword v51, v3, s[8:11], s72 offen sc1
    s_waitcnt vmcnt(0) lgkmcnt(0)
    s_call_b64 s[82:83], L_pend
    s_barrier
    ds_read_b64_tr_b16 v[136:137], v17 offset:0
    ds_read_b64_tr_b16 v[138:139], v17 offset:256
    ds_read_b64_tr_b16 v[140:141], v17 offset:32
    ds_read_b64_tr_b16 v[142:143], v17 offset:288
    ds_read_b64_tr_b16 v[144:145], v17 offset:2048
    ds_read_b64_tr_b16 v[146:147], v17 offset:2304
    ds_read_b64_tr_b16 v[148:149], v17 offset:2080
    ds_read_b64_tr_b16 v[150:151], v17 offset:2336
    s_waitcnt lgkmcnt(0)
    ds_read_b64_tr_b16 v[152:153], v17 offset:4096
    ds_read_b64_tr_b16 v[154:155], v17 offset:4352
    ds_read_b64_tr_b16 v[156:157], v17 offset:4128
    ds_read_b64_tr_b16 v[158:159], v17 offset:4384
    ds_read_b64_tr_b16 v[160:161], v17 offset:6144
    ds_read_b64_tr_b16 v[162:163], v17 offset:6400
    ds_read_b64_tr_b16 v[164:165], v17 offset:6176
    ds_read_b64_tr_b16 v[166:167], v17 offset:6432
    s_waitcnt lgkmcnt(0)
    s_add_u32 m0, s85, 0
    s_nop 0
    buffer_load_dwordx4 v16, s[12:15], s84 offen lds
    s_add_u32 s84, s84, 55296
    s_add_u32 m0, s85, 1024
    s_nop 0
    buffer_load_dwordx4 v16, s[12:15], s84 offen lds
    s_add_u32 s84, s84, 55296
    s_add_u32 m0, s85, 2048
    s_nop 0
    buffer_load_dwordx4 v16, s[12:15], s84 offen lds
    s_add_u32 s84, s84, 55296
    s_add_u32 m0, s85, 3072
    s_nop 0
    buffer_load_dwordx4 v16, s[12:15], s84 offen lds
    s_add_u32 s84, s84, 55296
    s_add_u32 m0, s85, 4096
    s_add_u32 s6, s86, 0
    buffer_load_dwordx4 v18, s[16:19], s6 offen lds
    s_add_u32 m0, s85, 5120
    s_add_u32 s6, s86, 10240
    buffer_load_dwordx4 v18, s[16:19], s6 offen lds
    s_add_u32 m0, s85, 6144
    s_add_u32 s6, s86, 20480
    buffer_load_dwordx4 v18, s[16:19], s6 offen lds
    s_add_u32 m0, s85, 7168
    s_add_u32 s6, s86, 30720
    buffer_load_dwordx4 v18, s[16:19], s6 offen lds
    s_add_u32 s86, s86, 512
    s_call_b64 s[82:83], L_load
    s_add_i32 s62, s62, 1
    v_cmp_le_i32 vcc, 0, v51
    s_cbranch_vccz L_idx_okm
    v_and_b32 v3, 7, v1
    v_lshlrev_b32 v3, 2, v3
    s_mov_b32 s72, 0x3a0000
    s_mov_b32 s79, 262144
L_poll_39:
    buffer_load_dword v51, v3, s[8:11], s72 offen sc1
    s_waitcnt vmcnt(0)
    v_cmp_le_i32 vcc, 0, v51
    s_cbranch_vccz L_polldone_40
    s_sleep 2
    s_sub_u32 s79, s79, 1
    s_cmp_lg_u32 s79, 0
    s_cbranch_scc1 L_poll_39
L_polldone_40:
L_idx_okm:
    buffer_load_dwordx4 v[64:67], v13, s[8:11], s88 offen sc1
    s_add_u32 s88, s88, 1024
    buffer_load_dwordx4 v[68:71], v13, s[8:11], s88 offen sc1
    s_add_u32 s88, s88, 1024
    buffer_load_dwordx4 v[72:75], v13, s[8:11], s88 offen sc1
    s_add_u32 s88, s88, 1024
    buffer_load_dwordx4 v[76:79], v13, s[8:11], s88 offen sc1
    s_add_u32 s88, s88, 1024
    buffer_load_dwordx4 v[80:83], v13, s[8:11], s88 offen sc1
    s_add_u32 s88, s88, 1024
    buffer_load_dwordx4 v[84:87], v13, s[8:11], s88 offen sc1
    s_add_u32 s88, s88, 1024
    buffer_load_dwordx4 v[88:91], v13, s[8:11], s88 offen sc1
    s_add_u32 s88, s88, 1024
    buffer_load_dwordx4 v[92:95], v13, s[8:11], s88 offen sc1
    s_add_u32 s88, s88, 1024
    buffer_load_dwordx4 v[96:99], v13, s[8:11], s88 offen sc1
    s_add_u32 s88, s88, 1024
    buffer_load_dwordx4 v[100:103], v13, s[8:11], s88 offen sc1
    s_add_u32 s88, s88, 1024
    s_waitcnt vmcnt(10) lgkmcnt(0)
    s_call_b64 s[82:83], L_pend
    s_barrier
    ds_read_b64_tr_b16 v[168:169], v17 offset:0
    ds_read_b64_tr_b16 v[170:171], v17 offset:256
    ds_read_b64_tr_b16 v[172:173], v17 offset:32
    ds_read_b64_tr_b16 v[174:175], v17 offset:288
    ds_read_b64_tr_b16 v[176:177], v17 offset:2048
    ds_read_b64_tr_b16 v[178:179], v17 offset:2304
    ds_read_b64_tr_b16 v[180:181], v17 offset:2080
    ds_read_b64_tr_b16 v[182:183], v17 offset:2336
    s_waitcnt lgkmcnt(0)
    ds_read_b64_tr_b16 v[32:33], v19 offset:0
    ds_read_b64_tr_b16 v[34:35], v19 offset:2048
    ds_read_b64_tr_b16 v[36:37], v19 offset:32
    ds_read_b64_tr_b16 v[38:39], v19 offset:2080
    ds_read_b64_tr_b16 v[40:41], v19 offset:64
    ds_read_b64_tr_b16 v[42:43], v19 offset:2112
    ds_read_b64_tr_b16 v[44:45], v19 offset:96
    ds_read_b64_tr_b16 v[46:47], v19 offset:2144
    s_waitcnt lgkmcnt(0)
    s_add_u32 m0, s85, 4096
    s_add_u32 s6, s86, 0
    buffer_load_dwordx4 v18, s[16:19], s6 offen lds
    s_add_u32 m0, s85, 5120
    s_add_u32 s6, s86, 10240
    buffer_load_dwordx4 v18, s[16:19], s6 offen lds
    s_add_u32 m0, s85, 6144
    s_add_u32 s6, s86, 20480
    buffer_load_dwordx4 v18, s[16:19], s6 offen lds
    s_add_u32 m0, s85, 7168
    s_add_u32 s6, s86, 30720
    buffer_load_dwordx4 v18, s[16:19], s6 offen lds
    s_add_u32 s86, s86, 512
    s_call_b64 s[82:83], L_load
    s_add_i32 s62, s62, 1
    s_waitcnt vmcnt(20)
    v_mfma_f32_16x16x32_bf16 v[24:27], v[104:107], v[64:67], 0
    v_mfma_f32_16x16x32_bf16 v[28:31], v[108:111], v[64:67], 0
    v_mfma_f32_16x16x32_bf16 v[24:27], v[112:115], v[68:71], v[24:27]
    v_mfma_f32_16x16x32_bf16 v[28:31], v[116:119], v[68:71], v[28:31]
    v_mfma_f32_16x16x32_bf16 v[24:27], v[120:123], v[72:75], v[24:27]
    v_mfma_f32_16x16x32_bf16 v[28:31], v[124:127], v[72:75], v[28:31]
    v_mfma_f32_16x16x32_bf16 v[24:27], v[128:131], v[76:79], v[24:27]
    v_mfma_f32_16x16x32_bf16 v[28:31], v[132:135], v[76:79], v[28:31]
    v_mfma_f32_16x16x32_bf16 v[24:27], v[136:139], v[80:83], v[24:27]
    v_mfma_f32_16x16x32_bf16 v[28:31], v[140:143], v[80:83], v[28:31]
    v_mfma_f32_16x16x32_bf16 v[24:27], v[144:147], v[84:87], v[24:27]
    v_mfma_f32_16x16x32_bf16 v[28:31], v[148:151], v[84:87], v[28:31]
    v_mfma_f32_16x16x32_bf16 v[24:27], v[152:155], v[88:91], v[24:27]
    v_mfma_f32_16x16x32_bf16 v[28:31], v[156:159], v[88:91], v[28:31]
    v_mfma_f32_16x16x32_bf16 v[24:27], v[160:163], v[92:95], v[24:27]
    v_mfma_f32_16x16x32_bf16 v[28:31], v[164:167], v[92:95], v[28:31]
    v_mfma_f32_16x16x32_bf16 v[24:27], v[168:171], v[96:99], v[24:27]
    v_mfma_f32_16x16x32_bf16 v[28:31], v[172:175], v[96:99], v[28:31]
    v_mfma_f32_16x16x32_bf16 v[24:27], v[176:179], v[100:103], v[24:27]
    v_mfma_f32_16x16x32_bf16 v[28:31], v[180:183], v[100:103], v[28:31]
    v_add_u32 v10, s85, v13
    s_nop 7
    ds_write_b128 v10, v[24:27]
    ds_write_b128 v10, v[28:31] offset:1024
    s_waitcnt vmcnt(0) lgkmcnt(0)
    s_call_b64 s[82:83], L_pend
    s_barrier
    ds_read_b64_tr_b16 v[240:241], v19 offset:0
    ds_read_b64_tr_b16 v[242:243], v19 offset:2048
    ds_read_b64_tr_b16 v[244:245], v19 offset:32
    ds_read_b64_tr_b16 v[246:247], v19 offset:2080
    ds_read_b64_tr_b16 v[248:249], v19 offset:64
    ds_read_b64_tr_b16 v[250:251], v19 offset:2112
    ds_read_b64_tr_b16 v[252:253], v19 offset:96
    ds_read_b64_tr_b16 v[254:255], v19 offset:2144
    v_add_u32 v10, 131072, v13
    s_waitcnt lgkmcnt(0)
    ds_read_b128 v[184:187], v10 offset:0
    ds_read_b128 v[188:191], v10 offset:1024
    ds_read_b128 v[192:195], v10 offset:8192
    ds_read_b128 v[196:199], v10 offset:9216
    ds_read_b128 v[200:203], v10 offset:16384
    ds_read_b128 v[204:207], v10 offset:17408
    ds_read_b128 v[208:211], v10 offset:24576
    ds_read_b128 v[212:215], v10 offset:25600
    s_cmp_ge_u32 s3, 2
    s_cbranch_scc1 L_moe4b
    s_add_u32 m0, s85, 4096
    s_add_u32 s6, s86, 0
    buffer_load_dwordx4 v18, s[16:19], s6 offen lds
    s_add_u32 m0, s85, 5120
    s_add_u32 s6, s86, 10240
    buffer_load_dwordx4 v18, s[16:19], s6 offen lds
    s_add_u32 m0, s85, 6144
    s_add_u32 s6, s86, 20480
    buffer_load_dwordx4 v18, s[16:19], s6 offen lds
    s_add_u32 m0, s85, 7168
    s_add_u32 s6, s86, 30720
    buffer_load_dwordx4 v18, s[16:19], s6 offen lds
    s_add_u32 s86, s86, 512
L_moe4b:
    s_call_b64 s[82:83], L_load
    s_add_i32 s62, s62, 1
    s_waitcnt lgkmcnt(0)
    s_mov_b32 s6, 0xbfb8aa3b
    v_add_f32 v184, v184, v192
    v_add_f32 v200, v200, v208
    v_add_f32 v185, v185, v193
    v_add_f32 v201, v201, v209
    v_cvt_pk_bf16_f32 v185, v184, v185
    v_lshlrev_b32 v184, 16, v185
    v_and_b32 v185, 0xffff0000, v185
    v_cvt_pk_bf16_f32 v201, v200, v201
    v_lshlrev_b32 v200, 16, v201
    v_and_b32 v201, 0xffff0000, v201
    v_mul_f32 v2, s6, v184
    v_mul_f32 v3, s6, v185
    v_exp_f32 v2, v2
    v_exp_f32 v3, v3
    s_nop 0
    v_add_f32 v2, 1.0, v2
    v_add_f32 v3, 1.0, v3
    v_rcp_f32 v2, v2
    v_rcp_f32 v3, v3
    s_nop 0
    v_mul_f32 v184, v184, v2
    v_mul_f32 v185, v185, v3
    v_cvt_pk_bf16_f32 v185, v184, v185
    v_lshlrev_b32 v184, 16, v185
    v_and_b32 v185, 0xffff0000, v185
    v_mul_f32 v184, v184, v200
    v_mul_f32 v185, v185, v201
    v_cvt_pk_bf16_f32 v24, v184, v185
    v_add_f32 v186, v186, v194
    v_add_f32 v202, v202, v210
    v_add_f32 v187, v187, v195
    v_add_f32 v203, v203, v211
    v_cvt_pk_bf16_f32 v187, v186, v187
    v_lshlrev_b32 v186, 16, v187
    v_and_b32 v187, 0xffff0000, v187
    v_cvt_pk_bf16_f32 v203, v202, v203
    v_lshlrev_b32 v202, 16, v203
    v_and_b32 v203, 0xffff0000, v203
    v_mul_f32 v2, s6, v186
    v_mul_f32 v3, s6, v187
    v_exp_f32 v2, v2
    v_exp_f32 v3, v3
    s_nop 0
    v_add_f32 v2, 1.0, v2
    v_add_f32 v3, 1.0, v3
    v_rcp_f32 v2, v2
    v_rcp_f32 v3, v3
    s_nop 0
    v_mul_f32 v186, v186, v2
    v_mul_f32 v187, v187, v3
    v_cvt_pk_bf16_f32 v187, v186, v187
    v_lshlrev_b32 v186, 16, v187
    v_and_b32 v187, 0xffff0000, v187
    v_mul_f32 v186, v186, v202
    v_mul_f32 v187, v187, v203
    v_cvt_pk_bf16_f32 v25, v186, v187
    v_add_f32 v188, v188, v196
    v_add_f32 v204, v204, v212
    v_add_f32 v189, v189, v197
    v_add_f32 v205, v205, v213
    v_cvt_pk_bf16_f32 v189, v188, v189
    v_lshlrev_b32 v188, 16, v189
    v_and_b32 v189, 0xffff0000, v189
    v_cvt_pk_bf16_f32 v205, v204, v205
    v_lshlrev_b32 v204, 16, v205
    v_and_b32 v205, 0xffff0000, v205
    v_mul_f32 v2, s6, v188
    v_mul_f32 v3, s6, v189
    v_exp_f32 v2, v2
    v_exp_f32 v3, v3
    s_nop 0
    v_add_f32 v2, 1.0, v2
    v_add_f32 v3, 1.0, v3
    v_rcp_f32 v2, v2
    v_rcp_f32 v3, v3
    s_nop 0
    v_mul_f32 v188, v188, v2
    v_mul_f32 v189, v189, v3
    v_cvt_pk_bf16_f32 v189, v188, v189
    v_lshlrev_b32 v188, 16, v189
    v_and_b32 v189, 0xffff0000, v189
    v_mul_f32 v188, v188, v204
    v_mul_f32 v189, v189, v205
    v_cvt_pk_bf16_f32 v26, v188, v189
    v_add_f32 v190, v190, v198
    v_add_f32 v206, v206, v214
    v_add_f32 v191, v191, v199
    v_add_f32 v207, v207, v215
    v_cvt_pk_bf16_f32 v191, v190, v191
    v_lshlrev_b32 v190, 16, v191
    v_and_b32 v191, 0xffff0000, v191
    v_cvt_pk_bf16_f32 v207, v206, v207
    v_lshlrev_b32 v206, 16, v207
    v_and_b32 v207, 0xffff0000, v207
    v_mul_f32 v2, s6, v190
    v_mul_f32 v3, s6, v191
    v_exp_f32 v2, v2
    v_exp_f32 v3, v3
    s_nop 0
    v_add_f32 v2, 1.0, v2
    v_add_f32 v3, 1.0, v3
    v_rcp_f32 v2, v2
    v_rcp_f32 v3, v3
    s_nop 0
    v_mul_f32 v190, v190, v2
    v_mul_f32 v191, v191, v3
    v_cvt_pk_bf16_f32 v191, v190, v191
    v_lshlrev_b32 v190, 16, v191
    v_and_b32 v191, 0xffff0000, v191
    v_mul_f32 v190, v190, v206
    v_mul_f32 v191, v191, v207
    v_cvt_pk_bf16_f32 v27, v190, v191
    s_nop 1
    v_mfma_f32_16x16x32_bf16 v[216:219], v[32:35], v[24:27], 0
    v_mfma_f32_16x16x32_bf16 v[220:223], v[36:39], v[24:27], 0
    v_mfma_f32_16x16x32_bf16 v[224:227], v[40:43], v[24:27], 0
    v_mfma_f32_16x16x32_bf16 v[228:231], v[44:47], v[24:27], 0
    s_nop 7
    buffer_store_dwordx4 v[216:219], v20, s[8:11], s87 offen offset:0 sc1
    buffer_store_dwordx4 v[220:223], v20, s[8:11], s87 offen offset:64 sc1
    buffer_store_dwordx4 v[224:227], v20, s[8:11], s87 offen offset:128 sc1
    buffer_store_dwordx4 v[228:231], v20, s[8:11], s87 offen offset:192 sc1
    s_nop 1
    s_waitcnt vmcnt(4) lgkmcnt(0)
    s_call_b64 s[82:83], L_pend
    s_barrier
    s_call_b64 s[82:83], L_load
    s_add_i32 s62, s62, 1
    v_mfma_f32_16x16x32_bf16 v[216:219], v[240:243], v[24:27], 0
    v_mfma_f32_16x16x32_bf16 v[220:223], v[244:247], v[24:27], 0
    v_mfma_f32_16x16x32_bf16 v[224:227], v[248:251], v[24:27], 0
    v_mfma_f32_16x16x32_bf16 v[228:231], v[252:255], v[24:27], 0
    s_nop 7
    buffer_store_dwordx4 v[216:219], v20, s[8:11], s87 offen offset:1024 sc1
    buffer_store_dwordx4 v[220:223], v20, s[8:11], s87 offen offset:1088 sc1
    buffer_store_dwordx4 v[224:227], v20, s[8:11], s87 offen offset:1152 sc1
    buffer_store_dwordx4 v[228:231], v20, s[8:11], s87 offen offset:1216 sc1
    s_nop 1
    s_cmp_ge_u32 s3, 2
    s_cbranch_scc1 L_moe5b
    ds_read_b64_tr_b16 v[32:33], v19 offset:0
    ds_read_b64_tr_b16 v[34:35], v19 offset:2048
    ds_read_b64_tr_b16 v[36:37], v19 offset:32
    ds_read_b64_tr_b16 v[38:39], v19 offset:2080
    ds_read_b64_tr_b16 v[40:41], v19 offset:64
    ds_read_b64_tr_b16 v[42:43], v19 offset:2112
    ds_read_b64_tr_b16 v[44:45], v19 offset:96
    ds_read_b64_tr_b16 v[46:47], v19 offset:2144
    s_waitcnt lgkmcnt(0)
    v_mfma_f32_16x16x32_bf16 v[216:219], v[32:35], v[24:27], 0
    v_mfma_f32_16x16x32_bf16 v[220:223], v[36:39], v[24:27], 0
    v_mfma_f32_16x16x32_bf16 v[224:227], v[40:43], v[24:27], 0
    v_mfma_f32_16x16x32_bf16 v[228:231], v[44:47], v[24:27], 0
    s_nop 7
    buffer_store_dwordx4 v[216:219], v20, s[8:11], s87 offen offset:2048 sc1
    buffer_store_dwordx4 v[220:223], v20, s[8:11], s87 offen offset:2112 sc1
    buffer_store_dwordx4 v[224:227], v20, s[8:11], s87 offen offset:2176 sc1
    buffer_store_dwordx4 v[228:231], v20, s[8:11], s87 offen offset:2240 sc1
    s_nop 1
L_moe5b:
    s_waitcnt vmcnt(4) lgkmcnt(0)
    s_call_b64 s[82:83], L_pend
    s_barrier
    s_waitcnt vmcnt(0)
    s_lshl_b32 s6, s61, 5
    s_add_u32 s6, s6, s3
    s_lshl_b32 s6, s6, 2
    s_add_u32 s6, s6, 15859712
    v_mov_b32 v2, 1
    v_mov_b32 v3, 0x5000000
    v_writelane_b32 v3, s6, 0
    buffer_store_dword v2, v3, s[8:11], 0 offen sc1
    s_call_b64 s[82:83], L_load
    s_add_i32 s62, s62, 1
    s_branch L_idle
L_top:
    s_mov_b32 s6, 0x280000
    v_lshrrev_b32 v2, 1, v1
    v_and_b32 v3, 1, v1
    v_lshlrev_b32 v3, 4, v3
    v_lshl_add_u32 v2, v2, 7, v3
    buffer_load_dwordx4 v[64:67], v2, s[8:11], s6 offen sc1
    s_add_u32 s6, s6, 4096
    buffer_load_dwordx4 v[68:71], v2, s[8:11], s6 offen sc1
    s_add_u32 s6, s6, 4096
    buffer_load_dwordx4 v[72:75], v2, s[8:11], s6 offen sc1
    s_add_u32 s6, s6, 4096
    buffer_load_dwordx4 v[76:79], v2, s[8:11], s6 offen sc1
    s_add_u32 s6, s6, 4096
    buffer_load_dwordx4 v[80:83], v2, s[8:11], s6 offen sc1
    s_add_u32 s6, s6, 4096
    buffer_load_dwordx4 v[84:87], v2, s[8:11], s6 offen sc1
    s_add_u32 s6, s6, 4096
    buffer_load_dwordx4 v[88:91], v2, s[8:11], s6 offen sc1
    s_add_u32 s6, s6, 4096
    buffer_load_dwordx4 v[92:95], v2, s[8:11], s6 offen sc1
    s_add_u32 s6, s6, 4096
    s_waitcnt vmcnt(0)
    v_mov_b32 v24, 0
    s_mov_b32 s7, 0
    s_mov_b32 s84, 0
L_top_l:
    v_max3_u32 v4, v64, v65, v66
    v_max3_u32 v5, v67, v68, v69
    v_max3_u32 v4, v4, v70, v71
    v_max3_u32 v5, v5, v72, v73
    v_max3_u32 v4, v4, v74, v75
    v_max3_u32 v5, v5, v76, v77
    v_max3_u32 v4, v4, v78, v79
    v_max3_u32 v5, v5, v80, v81
    v_max3_u32 v4, v4, v82, v83
    v_max3_u32 v5, v5, v84, v85
    v_max3_u32 v4, v4, v86, v87
    v_max3_u32 v5, v5, v88, v89
    v_max3_u32 v4, v4, v90, v91
    v_max3_u32 v5, v5, v92, v93
    v_max3_u32 v4, v4, v94, v95
    v_max_u32 v4, v4, v5
    s_nop 1
    v_max_u32_dpp v4, v4, v4 quad_perm:[1,0,3,2] row_mask:0xf bank_mask:0xf
    s_nop 1
    v_max_u32_dpp v4, v4, v4 quad_perm:[2,3,0,1] row_mask:0xf bank_mask:0xf
    s_nop 1
    v_max_u32_dpp v4, v4, v4 row_half_mirror row_mask:0xf bank_mask:0xf
    s_nop 1
    v_max_u32_dpp v4, v4, v4 row_mirror row_mask:0xf bank_mask:0xf
    s_nop 1
    v_max_u32_dpp v4, v4, v4 row_bcast:15 row_mask:0xa bank_mask:0xf
    s_nop 1
    v_max_u32_dpp v4, v4, v4 row_bcast:31 row_mask:0xc bank_mask:0xf
    s_nop 1
    v_readlane_b32 s6, v4, 63
    s_mov_b32 m0, s7
    s_nop 3
    s_add_u32 s84, s84, s6
    v_writelane_b32 v24, s84, m0
    v_subrev_u32 v64, s6, v64
    v_subrev_u32 v65, s6, v65
    v_subrev_u32 v66, s6, v66
    v_subrev_u32 v67, s6, v67
    v_subrev_u32 v68, s6, v68
    v_subrev_u32 v69, s6, v69
    v_subrev_u32 v70, s6, v70
    v_subrev_u32 v71, s6, v71
    v_subrev_u32 v72, s6, v72
    v_subrev_u32 v73, s6, v73
    v_subrev_u32 v74, s6, v74
    v_subrev_u32 v75, s6, v75
    v_subrev_u32 v76, s6, v76
    v_subrev_u32 v77, s6, v77
    v_subrev_u32 v78, s6, v78
    v_subrev_u32 v79, s6, v79
    v_subrev_u32 v80, s6, v80
    v_subrev_u32 v81, s6, v81
    v_subrev_u32 v82, s6, v82
    v_subrev_u32 v83, s6, v83
    v_subrev_u32 v84, s6, v84
    v_subrev_u32 v85, s6, v85
    v_subrev_u32 v86, s6, v86
    v_subrev_u32 v87, s6, v87
    v_subrev_u32 v88, s6, v88
    v_subrev_u32 v89, s6, v89
    v_subrev_u32 v90, s6, v90
    v_subrev_u32 v91, s6, v91
    v_subrev_u32 v92, s6, v92
    v_subrev_u32 v93, s6, v93
    v_subrev_u32 v94, s6, v94
    v_subrev_u32 v95, s6, v95
    s_add_u32 s7, s7, 1
    s_cmp_lt_u32 s7, 8
    s_cbranch_scc1 L_top_l
    v_and_b32 v2, 7, v1
    v_lshlrev_b32 v2, 2, v2
    ds_bpermute_b32 v4, v2, v24
    s_waitcnt lgkmcnt(0)
    v_and_b32 v4, 0x7ff, v4
    v_sub_u32 v4, 0x7ff, v4
    v_lshrrev_b32 v5, 4, v4
    v_mul_u32_u24 v5, 20480, v5
    v_and_b32 v4, 15, v4
    v_lshl_add_u32 v5, v4, 4, v5
    v_lshrrev_b32 v7, 4, v1
    v_lshl_add_u32 v5, v7, 8, v5
    v_mov_b32 v6, 0x5000000
    v_and_b32 v2, 8, v1
    v_cmp_eq_u32 vcc, 0, v2
    s_mov_b32 s6, 0
    s_nop 0
    v_cndmask_b32 v5, v6, v5, vcc
    buffer_load_dwordx4 v[64:67], v5, s[8:11], s6 offen offset:0 sc1
    buffer_load_dwordx4 v[68:71], v5, s[8:11], s6 offen offset:1024 sc1
    buffer_load_dwordx4 v[72:75], v5, s[8:11], s6 offen offset:2048 sc1
    buffer_load_dwordx4 v[76:79], v5, s[8:11], s6 offen offset:3072 sc1
    s_add_u32 s6, s6, 4096
    buffer_load_dwordx4 v[80:83], v5, s[8:11], s6 offen offset:0 sc1
    buffer_load_dwordx4 v[84:87], v5, s[8:11], s6 offen offset:1024 sc1
    buffer_load_dwordx4 v[88:91], v5, s[8:11], s6 offen offset:2048 sc1
    buffer_load_dwordx4 v[92:95], v5, s[8:11], s6 offen offset:3072 sc1
    s_add_u32 s6, s6, 4096
    buffer_load_dwordx4 v[96:99], v5, s[8:11], s6 offen offset:0 sc1
    buffer_load_dwordx4 v[100:103], v5, s[8:11], s6 offen offset:1024 sc1
    buffer_load_dwordx4 v[104:107], v5, s[8:11], s6 offen offset:2048 sc1
    buffer_load_dwordx4 v[108:111], v5, s[8:11], s6 offen offset:3072 sc1
    s_add_u32 s6, s6, 4096
    buffer_load_dwordx4 v[112:115], v5, s[8:11], s6 offen offset:0 sc1
    buffer_load_dwordx4 v[116:119], v5, s[8:11], s6 offen offset:1024 sc1
    buffer_load_dwordx4 v[120:123], v5, s[8:11], s6 offen offset:2048 sc1
    buffer_load_dwordx4 v[124:127], v5, s[8:11], s6 offen offset:3072 sc1
    s_add_u32 s6, s6, 4096
    buffer_load_dwordx4 v[128:131], v5, s[8:11], s6 offen offset:0 sc1
    buffer_load_dwordx4 v[132:135], v5, s[8:11], s6 offen offset:1024 sc1
    buffer_load_dwordx4 v[136:139], v5, s[8:11], s6 offen offset:2048 sc1
    buffer_load_dwordx4 v[140:143], v5, s[8:11], s6 offen offset:3072 sc1
    s_waitcnt vmcnt(20)
    s_call_b64 s[82:83], L_pend
    s_barrier
    s_waitcnt vmcnt(0)
    s_mov_b32 s6, 0xc00000
    buffer_store_dwordx4 v[64:67], v13, s[8:11], s6 offen offset:0 sc1
    buffer_store_dwordx4 v[68:71], v13, s[8:11], s6 offen offset:1024 sc1
    buffer_store_dwordx4 v[72:75], v13, s[8:11], s6 offen offset:2048 sc1
    buffer_store_dwordx4 v[76:79], v13, s[8:11], s6 offen offset:3072 sc1
    s_add_u32 s6, s6, 4096
    buffer_store_dwordx4 v[80:83], v13, s[8:11], s6 offen offset:0 sc1
    buffer_store_dwordx4 v[84:87], v13, s[8:11], s6 offen offset:1024 sc1
    buffer_store_dwordx4 v[88:91], v13, s[8:11], s6 offen offset:2048 sc1
    buffer_store_dwordx4 v[92:95], v13, s[8:11], s6 offen offset:3072 sc1
    s_add_u32 s6, s6, 4096
    buffer_store_dwordx4 v[96:99], v13, s[8:11], s6 offen offset:0 sc1
    buffer_store_dwordx4 v[100:103], v13, s[8:11], s6 offen offset:1024 sc1
    buffer_store_dwordx4 v[104:107], v13, s[8:11], s6 offen offset:2048 sc1
    buffer_store_dwordx4 v[108:111], v13, s[8:11], s6 offen offset:3072 sc1
    s_add_u32 s6, s6, 4096
    buffer_store_dwordx4 v[112:115], v13, s[8:11], s6 offen offset:0 sc1
    buffer_store_dwordx4 v[116:119], v13, s[8:11], s6 offen offset:1024 sc1
    buffer_store_dwordx4 v[120:123], v13, s[8:11], s6 offen offset:2048 sc1
    buffer_store_dwordx4 v[124:127], v13, s[8:11], s6 offen offset:3072 sc1
    s_add_u32 s6, s6, 4096
    buffer_store_dwordx4 v[128:131], v13, s[8:11], s6 offen offset:0 sc1
    buffer_store_dwordx4 v[132:135], v13, s[8:11], s6 offen offset:1024 sc1
    buffer_store_dwordx4 v[136:139], v13, s[8:11], s6 offen offset:2048 sc1
    buffer_store_dwordx4 v[140:143], v13, s[8:11], s6 offen offset:3072 sc1
    s_call_b64 s[82:83], L_load
    s_add_i32 s62, s62, 1
    s_waitcnt vmcnt(16)
    v_or_b32 v24, 0x80000000, v24
    v_lshlrev_b32 v5, 2, v1
    v_mov_b32 v6, 0x5000000
    v_cmp_gt_u32 vcc, 8, v1
    s_mov_b32 s6, 0x3a0000
    s_nop 0
    v_cndmask_b32 v5, v6, v5, vcc
    buffer_store_dword v24, v5, s[8:11], s6 offen sc1
    s_branch L_idle
L_back_9_h:
    v_cmp_ne_u32 vcc, 0, v62
    s_cbranch_vccz L_back_9_n
    s_call_b64 s[80:81], L_rare0
L_back_9_n:
    s_branch L_back_9
L_back_10_h:
    v_cmp_ne_u32 vcc, 0, v62
    s_cbranch_vccz L_back_10_n
    s_call_b64 s[80:81], L_rare1
    v_exp_f32 v58, v64
    v_exp_f32 v59, v65
L_back_10_n:
    s_cmp_lt_i32 s64, 0
    s_cbranch_scc1 L_tail1
    s_cmp_gt_i32 s64, 0
    s_cbranch_scc1 L_back_10
    s_call_b64 s[82:83], L_mask
    s_branch L_back_10
L_back_11_h:
    v_cmp_ne_u32 vcc, 0, v62
    s_cbranch_vccz L_back_11_n
    s_call_b64 s[80:81], L_rare0
    v_exp_f32 v58, v80
    v_exp_f32 v59, v81
L_back_11_n:
    s_cmp_lt_i32 s64, 0
    s_cbranch_scc1 L_tail2
    s_cmp_gt_i32 s64, 0
    s_cbranch_scc1 L_back_11
    s_call_b64 s[82:83], L_mask
    s_branch L_back_11
L_back_12_h:
    v_cmp_ne_u32 vcc, 0, v62
    s_cbranch_vccz L_back_12_n
    s_call_b64 s[80:81], L_rare1
    v_exp_f32 v58, v64
    v_exp_f32 v59, v65
L_back_12_n:
    s_cmp_lt_i32 s64, 0
    s_cbranch_scc1 L_tail3
    s_cmp_gt_i32 s64, 0
    s_cbranch_scc1 L_back_12
    s_call_b64 s[82:83], L_mask
    s_branch L_back_12
L_ldback_13_c:
    s_waitcnt vmcnt(0) lgkmcnt(0)
    s_call_b64 s[82:83], L_pend
    s_barrier
    s_call_b64 s[82:83], L_load
    s_branch L_ldback_13
L_back_14_h:
    v_cmp_ne_u32 vcc, 0, v62
    s_cbranch_vccz L_back_14_n
    s_call_b64 s[80:81], L_rare0
    v_exp_f32 v58, v80
    v_exp_f32 v59, v81
L_back_14_n:
    s_cmp_lt_i32 s64, 0
    s_cbranch_scc1 L_tail0
    s_cmp_gt_i32 s64, 0
    s_cbranch_scc1 L_st0
    s_call_b64 s[82:83], L_mask
    s_branch L_st0
L_back_15_h:
    v_cmp_ne_u32 vcc, 0, v62
    s_cbranch_vccz L_back_15_n
    s_call_b64 s[80:81], L_rare1
L_back_15_n:
    s_branch L_back_15
L_back_16_h:
    v_cmp_ne_u32 vcc, 0, v62
    s_cbranch_vccz L_back_16_n
    s_call_b64 s[80:81], L_rare0
L_back_16_n:
    s_branch L_back_16
L_back_18_h:
    v_cmp_ne_u32 vcc, 0, v62
    s_cbranch_vccz L_back_18_n
    s_call_b64 s[80:81], L_rare1
L_back_18_n:
    s_branch L_back_18
L_back_21_h:
    v_cmp_ne_u32 vcc, 0, v62
    s_cbranch_vccz L_back_21_n
    s_call_b64 s[80:81], L_rare0
L_back_21_n:
    s_branch L_back_21
L_load:
    s_bitcmp1_b32 s89, 0
    s_cbranch_scc0 L_load_r
    s_add_u32 s77, s77, 32768
    s_xor_b32 s78, s78, 0x10000
    s_add_i32 s73, s62, 1
    s_cmp_gt_i32 s73, s63
    s_cbranch_scc1 L_load_r
    s_cmp_eq_i32 s73, s63
    s_cbranch_scc1 L_load_v
    s_cmp_lg_i32 s73, 3
    s_cbranch_scc1 L_load_k
    v_cmp_gt_u32 vcc, 2, v12
    s_cbranch_vccz L_load_k
    s_lshl_b32 s7, s4, 10
    s_add_u32 s7, s7, 3866624
    v_lshrrev_b32 v2, 3, v1
    v_and_b32 v3, 7, v1
    v_lshlrev_b32 v3, 2, v3
    v_lshl_add_u32 v3, v2, 7, v3
    s_mov_b32 s79, 262144
L_poll_46:
    buffer_load_dword v2, v3, s[8:11], s7 offen sc1
    s_waitcnt vmcnt(0)
    v_cmp_gt_u32 vcc, 2, v2
    s_cbranch_vccz L_polldone_47
    s_sleep 2
    s_sub_u32 s79, s79, 1
    s_cmp_lg_u32 s79, 0
    s_cbranch_scc1 L_poll_46
L_polldone_47:
L_load_k:
    s_lshl_b32 s6, s76, 13
    s_add_u32 s6, s6, s78
    s_add_u32 m0, s6, 0
    s_add_u32 s7, s77, 0
    buffer_load_dwordx4 v49, s[8:11], s7 offen offset:0 sc1 lds
    buffer_load_dwordx4 v49, s[8:11], s7 offen offset:1024 sc1 lds
    buffer_load_dwordx4 v49, s[8:11], s7 offen offset:2048 sc1 lds
    buffer_load_dwordx4 v49, s[8:11], s7 offen offset:3072 sc1 lds
    s_lshl_b32 s6, s76, 13
    s_add_u32 s6, s6, s78
    s_add_u32 m0, s6, 4096
    s_add_u32 s7, s77, 4096
    buffer_load_dwordx4 v49, s[8:11], s7 offen offset:0 sc1 lds
    buffer_load_dwordx4 v49, s[8:11], s7 offen offset:1024 sc1 lds
    buffer_load_dwordx4 v49, s[8:11], s7 offen offset:2048 sc1 lds
    buffer_load_dwordx4 v49, s[8:11], s7 offen offset:3072 sc1 lds
    s_lshl_b32 s6, s76, 12
    s_add_u32 s6, s6, s78
    s_add_u32 m0, s6, 49152
    s_add_u32 s7, s77, 524288
    buffer_load_dwordx4 v50, s[8:11], s7 offen offset:0 sc1 lds
    buffer_load_dwordx4 v50, s[8:11], s7 offen offset:1024 sc1 lds
    buffer_load_dwordx4 v50, s[8:11], s7 offen offset:2048 sc1 lds
    buffer_load_dwordx4 v50, s[8:11], s7 offen offset:3072 sc1 lds
L_load_v:
    s_lshl_b32 s6, s76, 12
    s_add_u32 s6, s6, s78
    s_add_u32 m0, s6, 32768
    s_add_u32 s7, s77, 507904
    buffer_load_dwordx4 v50, s[8:11], s7 offen offset:0 sc1 lds
    buffer_load_dwordx4 v50, s[8:11], s7 offen offset:1024 sc1 lds
    buffer_load_dwordx4 v50, s[8:11], s7 offen offset:2048 sc1 lds
    buffer_load_dwordx4 v50, s[8:11], s7 offen offset:3072 sc1 lds
    s_cmp_eq_i32 s73, s63
    s_cbranch_scc1 L_xa
    s_cmp_lg_i32 s73, 2
    s_cbranch_scc1 L_nolook
    s_lshl_b32 s7, s4, 10
    s_add_u32 s7, s7, 3866624
    v_lshrrev_b32 v2, 3, v1
    v_and_b32 v3, 7, v1
    v_lshlrev_b32 v3, 2, v3
    v_lshl_add_u32 v3, v2, 7, v3
    buffer_load_dword v12, v3, s[8:11], s7 offen sc1
L_nolook:
    s_bitcmp1_b32 120, s5
    s_cbranch_scc0 L_wb
    s_sub_i32 s6, s62, 0
    s_cmp_gt_u32 s6, 4
    s_cbranch_scc0 L_wsel
L_wb:
    s_cmp_lt_u32 s5, 4
    s_cbranch_scc1 L_load_r
    s_sub_i32 s79, s73, 1
    s_cmp_lt_u32 s79, 2
    s_cbranch_scc1 L_x3
L_load_r:
    s_setpc_b64 s[82:83]
L_pend:
    s_bitcmp1_b32 s89, 1
    s_cbranch_scc0 L_load_a
    s_cmp_lt_i32 s62, 0
    s_cbranch_scc1 L_load_a
    s_lshl_b32 s6, s4, 3
    s_add_u32 s6, s6, s5
    s_lshl_b32 s6, s6, 5
    s_add_u32 s6, s6, s3
    s_lshl_b32 s6, s6, 2
    s_add_u32 s6, s6, 3866624
    v_mov_b32 v2, 2
    v_mov_b32 v3, 0x5000000
    v_writelane_b32 v3, s6, 0
    buffer_store_dword v2, v3, s[8:11], 0 offen sc1
    s_and_b32 s89, s89, 1
L_load_a:
    s_setpc_b64 s[82:83]
L_wsel:
    s_bfm_b32 s7, s5, 0
    s_and_b32 s7, s7, 120
    s_bcnt1_i32_b32 s7, s7
    s_lshl_b32 s7, s7, 5
    s_and_b32 s91, s2, 31
    s_add_u32 s91, s91, s7
    s_lshl_b32 s91, s91, 1
    s_lshr_b32 s7, s6, 1
    s_add_u32 s91, s91, s7
    s_cmp_eq_u32 s6, 4
    s_cbranch_scc1 L_w2
    s_bitcmp1_b32 s6, 0
    s_cbranch_scc1 L_w1
L_w0:
    s_mov_b32 s28, s42
    s_mov_b32 s29, s43
    s_mov_b32 s30, 0x500000
    s_mov_b32 s31, 0x20000
    s_lshr_b32 s75, s91, 1
    s_mul_i32 s75, s75, 40960
    s_and_b32 s6, s91, 1
    s_mul_i32 s6, s6, 640
    s_add_u32 s75, s75, s6
    s_movk_i32 s7, 1639
    s_mul_i32 s74, s76, 5120
    s_add_u32 s74, s74, 141312
    s_mul_i32 s6, s76, 320
    v_add_u32 v9, s6, v1
    v_add_u32 v2, 0, v9
    v_mul_lo_u32 v3, v2, s7
    v_lshrrev_b32 v3, 16, v3
    v_mul_u32_u24 v4, 40, v3
    v_sub_u32 v4, v2, v4
    v_mul_u32_u24 v3, 1280, v3
    v_lshl_add_u32 v3, v4, 4, v3
    s_add_u32 m0, s74, 0
    s_nop 0
    buffer_load_dwordx4 v3, s[28:31], s75 offen nt lds
    v_add_u32 v2, 64, v9
    v_mul_lo_u32 v3, v2, s7
    v_lshrrev_b32 v3, 16, v3
    v_mul_u32_u24 v4, 40, v3
    v_sub_u32 v4, v2, v4
    v_mul_u32_u24 v3, 1280, v3
    v_lshl_add_u32 v3, v4, 4, v3
    s_add_u32 m0, s74, 1024
    s_nop 0
    buffer_load_dwordx4 v3, s[28:31], s75 offen nt lds
    v_add_u32 v2, 128, v9
    v_mul_lo_u32 v3, v2, s7
    v_lshrrev_b32 v3, 16, v3
    v_mul_u32_u24 v4, 40, v3
    v_sub_u32 v4, v2, v4
    v_mul_u32_u24 v3, 1280, v3
    v_lshl_add_u32 v3, v4, 4, v3
    s_add_u32 m0, s74, 2048
    s_nop 0
    buffer_load_dwordx4 v3, s[28:31], s75 offen nt lds
    v_add_u32 v2, 192, v9
    v_mul_lo_u32 v3, v2, s7
    v_lshrrev_b32 v3, 16, v3
    v_mul_u32_u24 v4, 40, v3
    v_sub_u32 v4, v2, v4
    v_mul_u32_u24 v3, 1280, v3
    v_lshl_add_u32 v3, v4, 4, v3
    s_add_u32 m0, s74, 3072
    s_nop 0
    buffer_load_dwordx4 v3, s[28:31], s75 offen nt lds
    v_add_u32 v2, 256, v9
    v_mul_lo_u32 v3, v2, s7
    v_lshrrev_b32 v3, 16, v3
    v_mul_u32_u24 v4, 40, v3
    v_sub_u32 v4, v2, v4
    v_mul_u32_u24 v3, 1280, v3
    v_lshl_add_u32 v3, v4, 4, v3
    s_add_u32 m0, s74, 4096
    s_nop 0
    buffer_load_dwordx4 v3, s[28:31], s75 offen nt lds
    s_branch L_wb
L_w1:
    v_and_b32 v2, 15, v1
    v_lshrrev_b32 v3, 4, v1
    v_lshrrev_b32 v4, 2, v2
    v_lshl_add_u32 v4, v3, 2, v4
    v_mul_u32_u24 v4, 640, v4
    v_and_b32 v2, 3, v2
    v_lshl_add_u32 v4, v2, 3, v4
    s_mul_i32 s6, s76, 160
    s_add_u32 s6, s6, 141312
    v_add_u32 v4, s6, v4
    s_mul_i32 s6, s91, 20480
    s_mul_i32 s7, s76, 5120
    s_add_u32 s6, s6, s7
    s_add_u32 s6, s6, 4194304
    s_add_u32 s7, s6, 4096
    ds_read_b64_tr_b16 v[172:173], v4 offset:0
    ds_read_b64_tr_b16 v[174:175], v4 offset:10240
    ds_read_b64_tr_b16 v[176:177], v4 offset:32
    ds_read_b64_tr_b16 v[178:179], v4 offset:10272
    ds_read_b64_tr_b16 v[180:181], v4 offset:64
    ds_read_b64_tr_b16 v[182:183], v4 offset:10304
    ds_read_b64_tr_b16 v[184:185], v4 offset:96
    ds_read_b64_tr_b16 v[186:187], v4 offset:10336
    ds_read_b64_tr_b16 v[188:189], v4 offset:128
    ds_read_b64_tr_b16 v[190:191], v4 offset:10368
    s_waitcnt lgkmcnt(0)
    buffer_store_dwordx4 v[172:175], v13, s[8:11], s6 offen offset:0 sc1
    buffer_store_dwordx4 v[176:179], v13, s[8:11], s6 offen offset:1024 sc1
    buffer_store_dwordx4 v[180:183], v13, s[8:11], s6 offen offset:2048 sc1
    buffer_store_dwordx4 v[184:187], v13, s[8:11], s6 offen offset:3072 sc1
    buffer_store_dwordx4 v[188:191], v13, s[8:11], s7 offen offset:0 sc1
    s_branch L_wb
L_w2:
    s_cmp_lg_u32 s3, 0
    s_cbranch_scc1 L_wb
    s_mov_b32 s28, s56
    s_mov_b32 s29, s57
    s_mov_b32 s30, 0x100
    s_mov_b32 s31, 0x20000
    v_mov_b32 v2, 1
    v_lshlrev_b32 v3, 8, v1
    s_and_b32 s6, s2, 31
    s_lshl_b32 s6, s6, 2
    buffer_atomic_add v2, v3, s[28:31], s6 offen offset:128 sc1
    s_branch L_wb
L_xa:
    s_cmp_lg_u32 s90, 0
    s_cbranch_scc1 L_xa1
    s_mov_b32 s28, s56
    s_mov_b32 s29, s57
    s_mov_b32 s30, 0x100
    s_mov_b32 s31, 0x20000
    v_and_b32 v3, 31, v1
    v_lshlrev_b32 v3, 2, v3
    s_mov_b32 s79, 262144
L_poll_48:
    buffer_load_dword v2, v3, s[28:31], 0 offen offset:128 sc1
    s_waitcnt vmcnt(0)
    v_cmp_gt_u32 vcc, 4, v2
    s_cbranch_vccz L_polldone_49
    s_sleep 8
    s_sub_u32 s79, s79, 1
    s_cmp_lg_u32 s79, 0
    s_cbranch_scc1 L_poll_48
L_polldone_49:
L_xa1:
    s_lshr_b32 s74, s4, 3
    s_lshl_b32 s74, s74, 2
    s_add_u32 s74, s74, s76
    s_mul_i32 s74, s74, 327680
    s_and_b32 s7, s4, 3
    s_mul_i32 s7, s7, 10240
    s_add_u32 s74, s74, s7
    s_add_u32 s74, s74, 4199424
    s_add_u32 s6, s76, 0
    s_and_b32 s6, s6, 3
    s_lshl_b32 s6, s6, 10
    s_add_u32 s84, s6, s74
    s_add_u32 s6, s76, 1
    s_and_b32 s6, s6, 3
    s_lshl_b32 s6, s6, 10
    s_add_u32 s85, s6, s74
    s_add_u32 s6, s76, 2
    s_and_b32 s6, s6, 3
    s_lshl_b32 s6, s6, 10
    s_add_u32 s86, s6, s74
    s_add_u32 s6, s76, 3
    s_and_b32 s6, s6, 3
    s_lshl_b32 s6, s6, 10
    s_add_u32 s87, s6, s74
    s_add_u32 s88, s74, 4096
    s_lshl_b32 s73, s3, 13
    s_add_u32 s75, s73, s78
    s_add_u32 m0, s73, 131072
    s_add_u32 s7, s84, 0
    buffer_load_dwordx4 v13, s[8:11], s7 offen sc1 lds
    s_add_u32 m0, s73, 132096
    s_add_u32 s7, s85, 0
    buffer_load_dwordx4 v13, s[8:11], s7 offen sc1 lds
    s_add_u32 m0, s73, 133120
    s_add_u32 s7, s86, 0
    buffer_load_dwordx4 v13, s[8:11], s7 offen sc1 lds
    s_add_u32 m0, s73, 134144
    s_add_u32 s7, s87, 0
    buffer_load_dwordx4 v13, s[8:11], s7 offen sc1 lds
    s_add_u32 m0, s73, 135168
    s_add_u32 s7, s88, 0
    buffer_load_dwordx4 v13, s[8:11], s7 offen sc1 lds
    s_add_u32 m0, s73, 136192
    s_add_u32 s7, s84, 40960
    buffer_load_dwordx4 v13, s[8:11], s7 offen sc1 lds
    s_add_u32 m0, s73, 137216
    s_add_u32 s7, s85, 40960
    buffer_load_dwordx4 v13, s[8:11], s7 offen sc1 lds
    s_add_u32 m0, s73, 138240
    s_add_u32 s7, s86, 40960
    buffer_load_dwordx4 v13, s[8:11], s7 offen sc1 lds
    s_add_u32 m0, s75, 0
    s_add_u32 s7, s87, 40960
    buffer_load_dwordx4 v13, s[8:11], s7 offen sc1 lds
    s_add_u32 m0, s75, 1024
    s_add_u32 s7, s88, 40960
    buffer_load_dwordx4 v13, s[8:11], s7 offen sc1 lds
    s_add_u32 m0, s75, 2048
    s_add_u32 s7, s84, 81920
    buffer_load_dwordx4 v13, s[8:11], s7 offen sc1 lds
    s_add_u32 m0, s75, 3072
    s_add_u32 s7, s85, 81920
    buffer_load_dwordx4 v13, s[8:11], s7 offen sc1 lds
    s_add_u32 m0, s75, 4096
    s_add_u32 s7, s86, 81920
    buffer_load_dwordx4 v13, s[8:11], s7 offen sc1 lds
    s_add_u32 m0, s75, 5120
    s_add_u32 s7, s87, 81920
    buffer_load_dwordx4 v13, s[8:11], s7 offen sc1 lds
    s_add_u32 m0, s75, 6144
    s_add_u32 s7, s88, 81920
    buffer_load_dwordx4 v13, s[8:11], s7 offen sc1 lds
    s_add_u32 m0, s75, 7168
    s_add_u32 s7, s84, 122880
    buffer_load_dwordx4 v13, s[8:11], s7 offen sc1 lds
    s_lshl_b32 s75, s3, 12
    s_add_u32 s75, s75, s78
    s_add_u32 m0, s75, 49152
    s_add_u32 s7, s85, 122880
    buffer_load_dwordx4 v13, s[8:11], s7 offen sc1 lds
    s_add_u32 m0, s75, 50176
    s_add_u32 s7, s86, 122880
    buffer_load_dwordx4 v13, s[8:11], s7 offen sc1 lds
    s_add_u32 m0, s75, 51200
    s_add_u32 s7, s87, 122880
    buffer_load_dwordx4 v13, s[8:11], s7 offen sc1 lds
    s_add_u32 m0, s75, 52224
    s_add_u32 s7, s88, 122880
    buffer_load_dwordx4 v13, s[8:11], s7 offen sc1 lds
    s_setpc_b64 s[82:83]
L_x3:
    s_mov_b32 s12, s48
    s_mov_b32 s13, s49
    s_mov_b32 s14, 0x21c000
    s_mov_b32 s15, 0x20000
    s_cmp_eq_u32 s3, 3
    s_cbranch_scc1 L_load_r
    s_cmp_eq_u32 s3, 1
    s_cselect_b32 s12, s50, s12
    s_cselect_b32 s13, s51, s13
    s_cmp_eq_u32 s3, 2
    s_cselect_b32 s12, s52, s12
    s_cselect_b32 s13, s53, s13
    s_mov_b32 s73, 3456
    s_cmov_b32 s73, 256
    s_mov_b32 s75, 256
    s_cmov_b32 s75, 163840
    s_lshr_b32 s6, s2, 3
    s_sub_u32 s6, s6, 16
    s_mul_i32 s6, s6, 40
    v_lshrrev_b32 v2, 2, v1
    v_add_u32 v2, s6, v2
    v_mul_lo_u32 v2, v2, s73
    v_and_b32 v3, 3, v1
    v_lshl_add_u32 v2, v3, 6, v2
    s_xor_b32 s79, s79, 1
    s_lshl_b32 s6, s79, 3
    s_lshr_b32 s7, s4, 2
    s_add_u32 s6, s6, s7
    s_mul_i32 s6, s6, s75
    v_mov_b32 v3, 0x5000000
    v_cmp_gt_u32 vcc, 32, v1
    s_lshl_b32 s73, s73, 4
    s_nop 0
    v_cndmask_b32 v3, v3, v2, vcc
    buffer_load_dword v11, v2, s[12:15], s6 offen
    s_add_u32 s7, s6, s73
    buffer_load_dword v11, v2, s[12:15], s7 offen
    s_add_u32 s7, s7, s73
    buffer_load_dword v11, v3, s[12:15], s7 offen
    s_setpc_b64 s[82:83]
L_mask:
    v_and_b32 v2, 15, v1
    v_lshrrev_b32 v3, 4, v1
    v_lshlrev_b32 v3, 2, v3
    v_sub_u32 v2, v2, v3
    v_mov_b32 v3, 0xff800000
    v_cmp_gt_i32 vcc, 0, v2
    v_mov_b32 v152, v3
    s_nop 0
    v_cndmask_b32 v144, v144, v3, vcc
    v_cndmask_b32 v156, v156, v3, vcc
    v_cmp_gt_i32 vcc, 1, v2
    v_mov_b32 v153, v3
    s_nop 0
    v_cndmask_b32 v145, v145, v3, vcc
    v_cndmask_b32 v157, v157, v3, vcc
    v_cmp_gt_i32 vcc, 2, v2
    v_mov_b32 v154, v3
    s_nop 0
    v_cndmask_b32 v146, v146, v3, vcc
    v_cndmask_b32 v158, v158, v3, vcc
    v_cmp_gt_i32 vcc, 3, v2
    v_mov_b32 v155, v3
    s_nop 0
    v_cndmask_b32 v147, v147, v3, vcc
    v_cndmask_b32 v159, v159, v3, vcc
    s_nop 1
    s_setpc_b64 s[82:83]
L_rare0:
    s_nop 15
    v_max_f32 v62, v64, v65
    v_max3_f32 v62, v62, v66, v67
    v_max3_f32 v62, v62, v72, v73
    v_max3_f32 v62, v62, v74, v75
    v_mov_b32 v58, v62
    s_nop 1
    v_permlane16_swap_b32 v62, v58
    s_nop 1
    v_max_f32 v62, v62, v58
    v_mov_b32 v58, v62
    s_nop 1
    v_permlane32_swap_b32 v62, v58
    s_nop 1
    v_max_f32 v62, v62, v58
    v_add_f32 v62, 0x41c00000, v62
    v_max_f32 v62, 0, v62
    v_exp_f32 v58, -v62
    v_sub_f32 v64, v64, v62
    v_sub_f32 v80, v80, v62
    v_sub_f32 v144, v144, v62
    v_sub_f32 v65, v65, v62
    v_sub_f32 v81, v81, v62
    v_sub_f32 v145, v145, v62
    v_sub_f32 v66, v66, v62
    v_sub_f32 v82, v82, v62
    v_sub_f32 v146, v146, v62
    v_sub_f32 v67, v67, v62
    v_sub_f32 v83, v83, v62
    v_sub_f32 v147, v147, v62
    v_sub_f32 v72, v72, v62
    v_sub_f32 v88, v88, v62
    v_sub_f32 v152, v152, v62
    v_sub_f32 v73, v73, v62
    v_sub_f32 v89, v89, v62
    v_sub_f32 v153, v153, v62
    v_sub_f32 v74, v74, v62
    v_sub_f32 v90, v90, v62
    v_sub_f32 v154, v154, v62
    v_sub_f32 v75, v75, v62
    v_sub_f32 v91, v91, v62
    v_sub_f32 v155, v155, v62
    v_mul_f32 v160, v58, v160
    v_mul_f32 v161, v58, v161
    v_mul_f32 v192, v58, v192
    v_mul_f32 v193, v58, v193
    v_mul_f32 v194, v58, v194
    v_mul_f32 v195, v58, v195
    v_mul_f32 v200, v58, v200
    v_mul_f32 v201, v58, v201
    v_mul_f32 v202, v58, v202
    v_mul_f32 v203, v58, v203
    v_mul_f32 v208, v58, v208
    v_mul_f32 v209, v58, v209
    v_mul_f32 v210, v58, v210
    v_mul_f32 v211, v58, v211
    v_mul_f32 v216, v58, v216
    v_mul_f32 v217, v58, v217
    v_mul_f32 v218, v58, v218
    v_mul_f32 v219, v58, v219
    v_mul_f32 v224, v58, v224
    v_mul_f32 v225, v58, v225
    v_mul_f32 v226, v58, v226
    v_mul_f32 v227, v58, v227
    v_mul_f32 v232, v58, v232
    v_mul_f32 v233, v58, v233
    v_mul_f32 v234, v58, v234
    v_mul_f32 v235, v58, v235
    v_mul_f32 v240, v58, v240
    v_mul_f32 v241, v58, v241
    v_mul_f32 v242, v58, v242
    v_mul_f32 v243, v58, v243
    v_mul_f32 v248, v58, v248
    v_mul_f32 v249, v58, v249
    v_mul_f32 v250, v58, v250
    v_mul_f32 v251, v58, v251
    v_max_f32 v62, v68, v69
    v_max3_f32 v62, v62, v70, v71
    v_max3_f32 v62, v62, v76, v77
    v_max3_f32 v62, v62, v78, v79
    v_mov_b32 v58, v62
    s_nop 1
    v_permlane16_swap_b32 v62, v58
    s_nop 1
    v_max_f32 v62, v62, v58
    v_mov_b32 v58, v62
    s_nop 1
    v_permlane32_swap_b32 v62, v58
    s_nop 1
    v_max_f32 v62, v62, v58
    v_add_f32 v62, 0x41c00000, v62
    v_max_f32 v62, 0, v62
    v_exp_f32 v58, -v62
    v_sub_f32 v68, v68, v62
    v_sub_f32 v84, v84, v62
    v_sub_f32 v148, v148, v62
    v_sub_f32 v69, v69, v62
    v_sub_f32 v85, v85, v62
    v_sub_f32 v149, v149, v62
    v_sub_f32 v70, v70, v62
    v_sub_f32 v86, v86, v62
    v_sub_f32 v150, v150, v62
    v_sub_f32 v71, v71, v62
    v_sub_f32 v87, v87, v62
    v_sub_f32 v151, v151, v62
    v_sub_f32 v76, v76, v62
    v_sub_f32 v92, v92, v62
    v_sub_f32 v156, v156, v62
    v_sub_f32 v77, v77, v62
    v_sub_f32 v93, v93, v62
    v_sub_f32 v157, v157, v62
    v_sub_f32 v78, v78, v62
    v_sub_f32 v94, v94, v62
    v_sub_f32 v158, v158, v62
    v_sub_f32 v79, v79, v62
    v_sub_f32 v95, v95, v62
    v_sub_f32 v159, v159, v62
    v_mul_f32 v162, v58, v162
    v_mul_f32 v163, v58, v163
    v_mul_f32 v196, v58, v196
    v_mul_f32 v197, v58, v197
    v_mul_f32 v198, v58, v198
    v_mul_f32 v199, v58, v199
    v_mul_f32 v204, v58, v204
    v_mul_f32 v205, v58, v205
    v_mul_f32 v206, v58, v206
    v_mul_f32 v207, v58, v207
    v_mul_f32 v212, v58, v212
    v_mul_f32 v213, v58, v213
    v_mul_f32 v214, v58, v214
    v_mul_f32 v215, v58, v215
    v_mul_f32 v220, v58, v220
    v_mul_f32 v221, v58, v221
    v_mul_f32 v222, v58, v222
    v_mul_f32 v223, v58, v223
    v_mul_f32 v228, v58, v228
    v_mul_f32 v229, v58, v229
    v_mul_f32 v230, v58, v230
    v_mul_f32 v231, v58, v231
    v_mul_f32 v236, v58, v236
    v_mul_f32 v237, v58, v237
    v_mul_f32 v238, v58, v238
    v_mul_f32 v239, v58, v239
    v_mul_f32 v244, v58, v244
    v_mul_f32 v245, v58, v245
    v_mul_f32 v246, v58, v246
    v_mul_f32 v247, v58, v247
    v_mul_f32 v252, v58, v252
    v_mul_f32 v253, v58, v253
    v_mul_f32 v254, v58, v254
    v_mul_f32 v255, v58, v255
    v_exp_f32 v58, v64
    s_nop 0
    v_exp_f32 v59, v65
    s_nop 0
    v_cvt_pk_bf16_f32 v128, v58, v59
    v_exp_f32 v60, v66
    s_nop 0
    v_exp_f32 v61, v67
    s_nop 0
    v_cvt_pk_bf16_f32 v129, v60, v61
    v_exp_f32 v58, v68
    s_nop 0
    v_exp_f32 v59, v69
    s_nop 0
    v_cvt_pk_bf16_f32 v132, v58, v59
    v_exp_f32 v60, v70
    s_nop 0
    v_exp_f32 v61, v71
    s_nop 0
    v_cvt_pk_bf16_f32 v133, v60, v61
    v_exp_f32 v58, v72
    s_nop 0
    v_exp_f32 v59, v73
    s_nop 0
    v_cvt_pk_bf16_f32 v130, v58, v59
    v_exp_f32 v60, v74
    s_nop 0
    v_exp_f32 v61, v75
    s_nop 0
    v_cvt_pk_bf16_f32 v131, v60, v61
    v_exp_f32 v58, v76
    s_nop 0
    v_exp_f32 v59, v77
    s_nop 0
    v_cvt_pk_bf16_f32 v134, v58, v59
    v_exp_f32 v60, v78
    s_nop 0
    v_exp_f32 v61, v79
    s_nop 0
    v_cvt_pk_bf16_f32 v135, v60, v61
    s_nop 1
    s_setpc_b64 s[80:81]
L_rare1:
    s_nop 15
    v_max_f32 v62, v80, v81
    v_max3_f32 v62, v62, v82, v83
    v_max3_f32 v62, v62, v88, v89
    v_max3_f32 v62, v62, v90, v91
    v_mov_b32 v58, v62
    s_nop 1
    v_permlane16_swap_b32 v62, v58
    s_nop 1
    v_max_f32 v62, v62, v58
    v_mov_b32 v58, v62
    s_nop 1
    v_permlane32_swap_b32 v62, v58
    s_nop 1
    v_max_f32 v62, v62, v58
    v_add_f32 v62, 0x41c00000, v62
    v_max_f32 v62, 0, v62
    v_exp_f32 v58, -v62
    v_sub_f32 v64, v64, v62
    v_sub_f32 v80, v80, v62
    v_sub_f32 v144, v144, v62
    v_sub_f32 v65, v65, v62
    v_sub_f32 v81, v81, v62
    v_sub_f32 v145, v145, v62
    v_sub_f32 v66, v66, v62
    v_sub_f32 v82, v82, v62
    v_sub_f32 v146, v146, v62
    v_sub_f32 v67, v67, v62
    v_sub_f32 v83, v83, v62
    v_sub_f32 v147, v147, v62
    v_sub_f32 v72, v72, v62
    v_sub_f32 v88, v88, v62
    v_sub_f32 v152, v152, v62
    v_sub_f32 v73, v73, v62
    v_sub_f32 v89, v89, v62
    v_sub_f32 v153, v153, v62
    v_sub_f32 v74, v74, v62
    v_sub_f32 v90, v90, v62
    v_sub_f32 v154, v154, v62
    v_sub_f32 v75, v75, v62
    v_sub_f32 v91, v91, v62
    v_sub_f32 v155, v155, v62
    v_mul_f32 v160, v58, v160
    v_mul_f32 v161, v58, v161
    v_mul_f32 v192, v58, v192
    v_mul_f32 v193, v58, v193
    v_mul_f32 v194, v58, v194
    v_mul_f32 v195, v58, v195
    v_mul_f32 v200, v58, v200
    v_mul_f32 v201, v58, v201
    v_mul_f32 v202, v58, v202
    v_mul_f32 v203, v58, v203
    v_mul_f32 v208, v58, v208
    v_mul_f32 v209, v58, v209
    v_mul_f32 v210, v58, v210
    v_mul_f32 v211, v58, v211
    v_mul_f32 v216, v58, v216
    v_mul_f32 v217, v58, v217
    v_mul_f32 v218, v58, v218
    v_mul_f32 v219, v58, v219
    v_mul_f32 v224, v58, v224
    v_mul_f32 v225, v58, v225
    v_mul_f32 v226, v58, v226
    v_mul_f32 v227, v58, v227
    v_mul_f32 v232, v58, v232
    v_mul_f32 v233, v58, v233
    v_mul_f32 v234, v58, v234
    v_mul_f32 v235, v58, v235
    v_mul_f32 v240, v58, v240
    v_mul_f32 v241, v58, v241
    v_mul_f32 v242, v58, v242
    v_mul_f32 v243, v58, v243
    v_mul_f32 v248, v58, v248
    v_mul_f32 v249, v58, v249
    v_mul_f32 v250, v58, v250
    v_mul_f32 v251, v58, v251
    v_max_f32 v62, v84, v85
    v_max3_f32 v62, v62, v86, v87
    v_max3_f32 v62, v62, v92, v93
    v_max3_f32 v62, v62, v94, v95
    v_mov_b32 v58, v62
    s_nop 1
    v_permlane16_swap_b32 v62, v58
    s_nop 1
    v_max_f32 v62, v62, v58
    v_mov_b32 v58, v62
    s_nop 1
    v_permlane32_swap_b32 v62, v58
    s_nop 1
    v_max_f32 v62, v62, v58
    v_add_f32 v62, 0x41c00000, v62
    v_max_f32 v62, 0, v62
    v_exp_f32 v58, -v62
    v_sub_f32 v68, v68, v62
    v_sub_f32 v84, v84, v62
    v_sub_f32 v148, v148, v62
    v_sub_f32 v69, v69, v62
    v_sub_f32 v85, v85, v62
    v_sub_f32 v149, v149, v62
    v_sub_f32 v70, v70, v62
    v_sub_f32 v86, v86, v62
    v_sub_f32 v150, v150, v62
    v_sub_f32 v71, v71, v62
    v_sub_f32 v87, v87, v62
    v_sub_f32 v151, v151, v62
    v_sub_f32 v76, v76, v62
    v_sub_f32 v92, v92, v62
    v_sub_f32 v156, v156, v62
    v_sub_f32 v77, v77, v62
    v_sub_f32 v93, v93, v62
    v_sub_f32 v157, v157, v62
    v_sub_f32 v78, v78, v62
    v_sub_f32 v94, v94, v62
    v_sub_f32 v158, v158, v62
    v_sub_f32 v79, v79, v62
    v_sub_f32 v95, v95, v62
    v_sub_f32 v159, v159, v62
    v_mul_f32 v162, v58, v162
    v_mul_f32 v163, v58, v163
    v_mul_f32 v196, v58, v196
    v_mul_f32 v197, v58, v197
    v_mul_f32 v198, v58, v198
    v_mul_f32 v199, v58, v199
    v_mul_f32 v204, v58, v204
    v_mul_f32 v205, v58, v205
    v_mul_f32 v206, v58, v206
    v_mul_f32 v207, v58, v207
    v_mul_f32 v212, v58, v212
    v_mul_f32 v213, v58, v213
    v_mul_f32 v214, v58, v214
    v_mul_f32 v215, v58, v215
    v_mul_f32 v220, v58, v220
    v_mul_f32 v221, v58, v221
    v_mul_f32 v222, v58, v222
    v_mul_f32 v223, v58, v223
    v_mul_f32 v228, v58, v228
    v_mul_f32 v229, v58, v229
    v_mul_f32 v230, v58, v230
    v_mul_f32 v231, v58, v231
    v_mul_f32 v236, v58, v236
    v_mul_f32 v237, v58, v237
    v_mul_f32 v238, v58, v238
    v_mul_f32 v239, v58, v239
    v_mul_f32 v244, v58, v244
    v_mul_f32 v245, v58, v245
    v_mul_f32 v246, v58, v246
    v_mul_f32 v247, v58, v247
    v_mul_f32 v252, v58, v252
    v_mul_f32 v253, v58, v253
    v_mul_f32 v254, v58, v254
    v_mul_f32 v255, v58, v255
    v_exp_f32 v58, v80
    s_nop 0
    v_exp_f32 v59, v81
    s_nop 0
    v_cvt_pk_bf16_f32 v136, v58, v59
    v_exp_f32 v60, v82
    s_nop 0
    v_exp_f32 v61, v83
    s_nop 0
    v_cvt_pk_bf16_f32 v137, v60, v61
    v_exp_f32 v58, v84
    s_nop 0
    v_exp_f32 v59, v85
    s_nop 0
    v_cvt_pk_bf16_f32 v140, v58, v59
    v_exp_f32 v60, v86
    s_nop 0
    v_exp_f32 v61, v87
    s_nop 0
    v_cvt_pk_bf16_f32 v141, v60, v61
    v_exp_f32 v58, v88
    s_nop 0
    v_exp_f32 v59, v89
    s_nop 0
    v_cvt_pk_bf16_f32 v138, v58, v59
    v_exp_f32 v60, v90
    s_nop 0
    v_exp_f32 v61, v91
    s_nop 0
    v_cvt_pk_bf16_f32 v139, v60, v61
    v_exp_f32 v58, v92
    s_nop 0
    v_exp_f32 v59, v93
    s_nop 0
    v_cvt_pk_bf16_f32 v142, v58, v59
    v_exp_f32 v60, v94
    s_nop 0
    v_exp_f32 v61, v95
    s_nop 0
    v_cvt_pk_bf16_f32 v143, v60, v61
    s_nop 1
    s_setpc_b64 s[80:81]
L_adone:
    ds_read_b128 v[16:19], v4 offset:0
    ds_read_b128 v[20:23], v4 offset:1024
    ds_read_b128 v[24:27], v4 offset:2048
    ds_read_b128 v[28:31], v4 offset:3072
    s_waitcnt lgkmcnt(3)
    v_mfma_f32_16x16x32_bf16 v[56:59], v[96:99], v[16:19], 0
    s_cmp_lt_u32 s3, 4
    s_cbranch_scc1 L_nowl_50
    s_waitcnt vmcnt(5)
    s_lshl_b32 s6, s60, 5
    s_add_u32 s6, s6, s4
    s_lshl_b32 s6, s6, 7
    s_add_u32 s6, s6, 3932160
    v_mov_b32 v2, 1
    v_mov_b32 v3, 0x5000000
    v_writelane_b32 v3, s6, 0
    buffer_store_dword v2, v3, s[8:11], 0 offen sc1
    s_add_u32 s75, s69, 204800
    buffer_load_dwordx4 v[196:199], v44, s[8:11], s75 offen sc1
    buffer_load_dwordx4 v[200:203], v45, s[8:11], s75 offen sc1
    buffer_load_dwordx4 v[204:207], v46, s[8:11], s75 offen sc1
    buffer_load_dwordx4 v[208:211], v47, s[8:11], s75 offen sc1
    buffer_load_dwordx4 v[212:215], v52, s[8:11], s75 offen sc1
L_nowl_50:
    v_mfma_f32_16x16x32_bf16 v[60:63], v[100:103], v[16:19], 0
    s_cmp_lt_u32 s3, 4
    s_cbranch_scc1 L_nowl_51
    s_add_u32 s75, s69, 245760
    buffer_load_dwordx4 v[216:219], v44, s[8:11], s75 offen sc1
    buffer_load_dwordx4 v[220:223], v45, s[8:11], s75 offen sc1
    buffer_load_dwordx4 v[224:227], v46, s[8:11], s75 offen sc1
    buffer_load_dwordx4 v[228:231], v47, s[8:11], s75 offen sc1
    buffer_load_dwordx4 v[232:235], v52, s[8:11], s75 offen sc1
L_nowl_51:
    v_mfma_f32_16x16x32_bf16 v[64:67], v[104:107], v[16:19], 0
    s_cmp_lt_u32 s3, 4
    s_cbranch_scc1 L_nowl_52
    s_add_u32 s75, s69, 286720
    buffer_load_dwordx4 v[236:239], v44, s[8:11], s75 offen sc1
    buffer_load_dwordx4 v[240:243], v45, s[8:11], s75 offen sc1
    buffer_load_dwordx4 v[244:247], v46, s[8:11], s75 offen sc1
    buffer_load_dwordx4 v[248:251], v47, s[8:11], s75 offen sc1
    buffer_load_dwordx4 v[252:255], v52, s[8:11], s75 offen sc1
L_nowl_52:
    v_mfma_f32_16x16x32_bf16 v[68:71], v[108:111], v[16:19], 0
    s_waitcnt lgkmcnt(2)
    s_cmp_ge_u32 s3, 4
    s_cbranch_scc1 L_o0
    s_waitcnt vmcnt(0)
    s_barrier
L_o0:
    v_mfma_f32_16x16x32_bf16 v[72:75], v[112:115], v[16:19], 0
    ds_read_b128 v[16:19], v4 offset:4096
    s_lshr_b32 s6, s3, 2
    s_mul_i32 s67, s6, 15360
    s_add_u32 s67, s67, 98304
    v_add_u32 v6, s67, v44
    v_mfma_f32_16x16x32_bf16 v[56:59], v[116:119], v[20:23], v[56:59]
    s_mul_i32 s73, s6, 5120
    s_add_u32 s73, s73, 67108864
    s_lshl_b32 s6, s6, 1
    s_sub_u32 s71, s76, s6
    v_mfma_f32_16x16x32_bf16 v[60:63], v[120:123], v[20:23], v[60:63]
    s_and_b32 s71, s71, 3
    v_mov_b32 v11, 0x5000000
    s_lshl_b32 s74, s3, 2
    s_add_u32 s74, s74, 15728640
    v_mfma_f32_16x16x32_bf16 v[64:67], v[124:127], v[20:23], v[64:67]
    s_and_b32 s72, s4, 7
    s_lshl_b32 s7, s5, 3
    s_add_u32 s72, s72, s7
    s_mul_i32 s72, s72, 12
    v_mfma_f32_16x16x32_bf16 v[68:71], v[128:131], v[20:23], v[68:71]
    s_waitcnt lgkmcnt(2)
    s_lshr_b32 s75, s4, 3
    s_mul_i32 s7, s75, 3
    s_add_u32 s7, s7, s72
    s_mul_i32 s62, s7, 20480
    v_mfma_f32_16x16x32_bf16 v[72:75], v[132:135], v[20:23], v[72:75]
    ds_read_b128 v[20:23], v4 offset:5120
    s_add_u32 s62, s62, 67108864
    s_lshl_b32 s7, s7, 7
    s_add_u32 s63, s7, 15728640
    s_add_u32 s6, s75, 1
    v_mfma_f32_16x16x32_bf16 v[72:75], v[152:155], v[24:27], v[72:75]
    s_and_b32 s6, s6, 3
    s_mul_i32 s6, s6, 3
    s_add_u32 s6, s6, s72
    s_add_u32 s6, s6, 0
    v_mfma_f32_16x16x32_bf16 v[68:71], v[148:151], v[24:27], v[68:71]
    s_mul_i32 s7, s6, 20480
    s_add_u32 s96, s7, s73
    s_lshl_b32 s6, s6, 7
    s_add_u32 s6, s6, s74
    v_mfma_f32_16x16x32_bf16 v[64:67], v[144:147], v[24:27], v[64:67]
    v_writelane_b32 v11, s6, 0
    s_add_u32 s6, s75, 2
    s_and_b32 s6, s6, 3
    s_mul_i32 s6, s6, 3
    v_mfma_f32_16x16x32_bf16 v[60:63], v[140:143], v[24:27], v[60:63]
    s_waitcnt lgkmcnt(2)
    s_add_u32 s6, s6, s72
    s_add_u32 s6, s6, 1
    s_mul_i32 s7, s6, 20480
    s_add_u32 s97, s7, s73
    v_mfma_f32_16x16x32_bf16 v[56:59], v[136:139], v[24:27], v[56:59]
    ds_read_b128 v[24:27], v4 offset:6144
    s_lshl_b32 s6, s6, 7
    s_add_u32 s6, s6, s74
    v_writelane_b32 v11, s6, 1
    s_add_u32 s6, s75, 3
    v_mfma_f32_16x16x32_bf16 v[56:59], v[156:159], v[28:31], v[56:59]
    s_and_b32 s6, s6, 3
    s_mul_i32 s6, s6, 3
    s_add_u32 s6, s6, s72
    s_add_u32 s6, s6, 2
    v_mfma_f32_16x16x32_bf16 v[60:63], v[160:163], v[28:31], v[60:63]
    s_mul_i32 s7, s6, 20480
    s_add_u32 s98, s7, s73
    s_lshl_b32 s6, s6, 7
    s_add_u32 s6, s6, s74
    v_mfma_f32_16x16x32_bf16 v[64:67], v[164:167], v[28:31], v[64:67]
    v_writelane_b32 v11, s6, 2
    v_mfma_f32_16x16x32_bf16 v[68:71], v[168:171], v[28:31], v[68:71]
    s_waitcnt lgkmcnt(2)
    v_mfma_f32_16x16x32_bf16 v[72:75], v[172:175], v[28:31], v[72:75]
    ds_read_b128 v[28:31], v4 offset:7168
    s_waitcnt vmcnt(16)
    v_mfma_f32_16x16x32_bf16 v[72:75], v[192:195], v[16:19], v[72:75]
    v_mfma_f32_16x16x32_bf16 v[68:71], v[188:191], v[16:19], v[68:71]
    s_add_u32 s65, s68, 3
    s_and_b32 s65, s65, 3
    s_andn2_b32 s7, s68, 3
    v_mfma_f32_16x16x32_bf16 v[64:67], v[184:187], v[16:19], v[64:67]
    s_add_u32 s65, s65, s7
    s_lshl_b32 s65, s65, 17
    s_add_u32 s65, s65, s66
    v_mfma_f32_16x16x32_bf16 v[60:63], v[180:183], v[16:19], v[60:63]
    s_waitcnt lgkmcnt(2)
    s_add_u32 m0, s99, 65536
    v_mfma_f32_16x16x32_bf16 v[56:59], v[176:179], v[16:19], v[56:59]
    ds_read_b128 v[16:19], v4 offset:32768
    s_waitcnt vmcnt(10)
    v_mfma_f32_16x16x32_bf16 v[56:59], v[196:199], v[20:23], v[56:59]
    buffer_load_dwordx4 v13, s[8:11], s65 offen offset:0 sc1 lds
    v_mfma_f32_16x16x32_bf16 v[60:63], v[200:203], v[20:23], v[60:63]
    buffer_load_dwordx4 v13, s[8:11], s65 offen offset:1024 sc1 lds
    v_mfma_f32_16x16x32_bf16 v[64:67], v[204:207], v[20:23], v[64:67]
    v_mfma_f32_16x16x32_bf16 v[68:71], v[208:211], v[20:23], v[68:71]
    buffer_load_dwordx4 v13, s[8:11], s65 offen offset:2048 sc1 lds
    s_waitcnt lgkmcnt(2)
    v_mfma_f32_16x16x32_bf16 v[72:75], v[212:215], v[20:23], v[72:75]
    ds_read_b128 v[20:23], v4 offset:33792
    s_waitcnt vmcnt(8)
    v_mfma_f32_16x16x32_bf16 v[72:75], v[232:235], v[24:27], v[72:75]
    buffer_load_dwordx4 v13, s[8:11], s65 offen offset:3072 sc1 lds
    v_mfma_f32_16x16x32_bf16 v[68:71], v[228:231], v[24:27], v[68:71]
    v_mfma_f32_16x16x32_bf16 v[64:67], v[224:227], v[24:27], v[64:67]
    v_mfma_f32_16x16x32_bf16 v[60:63], v[220:223], v[24:27], v[60:63]
    s_waitcnt lgkmcnt(2)
    v_mfma_f32_16x16x32_bf16 v[56:59], v[216:219], v[24:27], v[56:59]
    ds_read_b128 v[24:27], v4 offset:34816
    s_waitcnt vmcnt(4)
    v_mfma_f32_16x16x32_bf16 v[56:59], v[236:239], v[28:31], v[56:59]
    v_mfma_f32_16x16x32_bf16 v[60:63], v[240:243], v[28:31], v[60:63]
    v_mfma_f32_16x16x32_bf16 v[64:67], v[244:247], v[28:31], v[64:67]
    v_mfma_f32_16x16x32_bf16 v[68:71], v[248:251], v[28:31], v[68:71]
    s_waitcnt lgkmcnt(2)
    v_mfma_f32_16x16x32_bf16 v[72:75], v[252:255], v[28:31], v[72:75]
    ds_read_b128 v[28:31], v4 offset:35840
    v_mfma_f32_16x16x32_bf16 v[76:79], v[96:99], v[16:19], 0
    s_sub_u32 s6, s71, 1
    s_and_b32 s6, s6, 3
    s_mul_i32 s7, s6, 5120
    v_mfma_f32_16x16x32_bf16 v[80:83], v[100:103], v[16:19], 0
    s_add_u32 s7, s7, s67
    s_cmp_eq_u32 s6, 3
    s_cselect_b32 s7, 155648, s7
    v_mfma_f32_16x16x32_bf16 v[84:87], v[104:107], v[16:19], 0
    v_add_u32 v12, s7, v52
    v_add_u32 v5, s67, v45
    v_mfma_f32_16x16x32_bf16 v[88:91], v[108:111], v[16:19], 0
    s_waitcnt lgkmcnt(2)
    v_mfma_f32_16x16x32_bf16 v[92:95], v[112:115], v[16:19], 0
    ds_read_b128 v[16:19], v4 offset:36864
    v_mfma_f32_16x16x32_bf16 v[76:79], v[116:119], v[20:23], v[76:79]
    ds_write_b128 v5, v[60:63] offset:0
    v_add_u32 v5, s67, v46
    v_mfma_f32_16x16x32_bf16 v[80:83], v[120:123], v[20:23], v[80:83]
    v_and_b32 v3, 1, v1
    v_lshlrev_b32 v3, 12, v3
    s_lshr_b32 s72, s61, 2
    s_lshl_b32 s72, s72, 6
    s_andn2_b32 s6, s4, 7
    s_add_u32 s72, s72, s6
    s_add_u32 s72, s72, s3
    s_lshl_b32 s72, s72, 7
    s_add_u32 s72, s72, 3932160
    v_mfma_f32_16x16x32_bf16 v[84:87], v[124:127], v[20:23], v[84:87]
    v_mfma_f32_16x16x32_bf16 v[88:91], v[128:131], v[20:23], v[88:91]
    s_waitcnt lgkmcnt(3)
    v_mfma_f32_16x16x32_bf16 v[92:95], v[132:135], v[20:23], v[92:95]
    ds_read_b128 v[20:23], v4 offset:37888
    v_mfma_f32_16x16x32_bf16 v[92:95], v[152:155], v[24:27], v[92:95]
    ds_write_b128 v5, v[64:67] offset:5120
    v_add_u32 v5, s67, v47
    v_mfma_f32_16x16x32_bf16 v[88:91], v[148:151], v[24:27], v[88:91]
    v_mfma_f32_16x16x32_bf16 v[84:87], v[144:147], v[24:27], v[84:87]
    buffer_load_dword v50, v3, s[8:11], s72 offen sc1
    v_mfma_f32_16x16x32_bf16 v[80:83], v[140:143], v[24:27], v[80:83]
    s_waitcnt lgkmcnt(4)
    v_mfma_f32_16x16x32_bf16 v[76:79], v[136:139], v[24:27], v[76:79]
    ds_read_b128 v[24:27], v4 offset:38912
    v_mfma_f32_16x16x32_bf16 v[76:79], v[156:159], v[28:31], v[76:79]
    ds_write_b128 v5, v[68:71] offset:10240
    v_add_u32 v5, s67, v52
    v_mfma_f32_16x16x32_bf16 v[80:83], v[160:163], v[28:31], v[80:83]
    v_mfma_f32_16x16x32_bf16 v[84:87], v[164:167], v[28:31], v[84:87]
    v_mfma_f32_16x16x32_bf16 v[88:91], v[168:171], v[28:31], v[88:91]
    s_waitcnt lgkmcnt(5)
    v_mfma_f32_16x16x32_bf16 v[92:95], v[172:175], v[28:31], v[92:95]
    ds_read_b128 v[28:31], v4 offset:39936
    v_mfma_f32_16x16x32_bf16 v[92:95], v[192:195], v[16:19], v[92:95]
    ds_write_b128 v12, v[72:75] offset:0
    v_mfma_f32_16x16x32_bf16 v[88:91], v[188:191], v[16:19], v[88:91]
    v_mfma_f32_16x16x32_bf16 v[84:87], v[184:187], v[16:19], v[84:87]
    v_mfma_f32_16x16x32_bf16 v[80:83], v[180:183], v[16:19], v[80:83]
    s_waitcnt lgkmcnt(5)
    v_mfma_f32_16x16x32_bf16 v[76:79], v[176:179], v[16:19], v[76:79]
    s_waitcnt vmcnt(0)
    s_waitcnt lgkmcnt(0)
    s_barrier
    ds_read_b128 v[32:35], v6 offset:0
    ds_read_b128 v[36:39], v6 offset:5120
    ds_read_b128 v[40:43], v6 offset:10240
    ds_read_b128 v[16:19], v7 offset:0
    v_mfma_f32_16x16x32_bf16 v[76:79], v[196:199], v[20:23], v[76:79]
    v_cmp_ne_u32 vcc, 1, v50
    s_mov_b32 s91, 0
    s_cbranch_vccnz L_t3n
    s_add_u32 s65, s61, 1
    s_and_b32 s65, s65, 3
    s_andn2_b32 s7, s61, 3
    s_add_u32 s65, s65, s7
    s_lshl_b32 s65, s65, 17
    s_add_u32 s65, s65, s66
    s_add_u32 m0, s99, 0
    s_add_u32 s65, s65, 0
    buffer_load_dwordx4 v13, s[8:11], s65 offen offset:0 sc1 lds
    buffer_load_dwordx4 v13, s[8:11], s65 offen offset:1024 sc1 lds
    buffer_load_dwordx4 v13, s[8:11], s65 offen offset:2048 sc1 lds
    buffer_load_dwordx4 v13, s[8:11], s65 offen offset:3072 sc1 lds
    s_mov_b32 s91, 1
    s_branch L_t3j
L_t3n:
    buffer_load_dword v50, v3, s[8:11], s72 offen sc1
L_t3j:
    v_mfma_f32_16x16x32_bf16 v[80:83], v[200:203], v[20:23], v[80:83]
    v_mfma_f32_16x16x32_bf16 v[84:87], v[204:207], v[20:23], v[84:87]
    s_waitcnt lgkmcnt(3)
    v_add_f32 v56, v56, v32
    v_add_f32 v57, v57, v33
    v_mfma_f32_16x16x32_bf16 v[88:91], v[208:211], v[20:23], v[88:91]
    v_add_f32 v58, v58, v34
    v_add_f32 v59, v59, v35
    v_mfma_f32_16x16x32_bf16 v[92:95], v[212:215], v[20:23], v[92:95]
    s_waitcnt lgkmcnt(2)
    ds_read_b128 v[32:35], v5 offset:0
    ds_read_b128 v[20:23], v7 offset:1024
    v_add_f32 v56, v56, v36
    v_add_f32 v57, v57, v37
    v_mfma_f32_16x16x32_bf16 v[92:95], v[232:235], v[24:27], v[92:95]
    v_add_f32 v58, v58, v38
    v_add_f32 v59, v59, v39
    v_mfma_f32_16x16x32_bf16 v[88:91], v[228:231], v[24:27], v[88:91]
    s_waitcnt lgkmcnt(3)
    ds_read_b128 v[36:39], v5 offset:5120
    v_add_f32 v56, v56, v40
    v_add_f32 v57, v57, v41
    v_mfma_f32_16x16x32_bf16 v[84:87], v[224:227], v[24:27], v[84:87]
    v_add_f32 v58, v58, v42
    v_add_f32 v59, v59, v43
    v_mfma_f32_16x16x32_bf16 v[80:83], v[220:223], v[24:27], v[80:83]
    ds_read_b128 v[40:43], v5 offset:10240
    s_waitcnt lgkmcnt(3)
    v_add_f32 v72, v72, v32
    v_add_f32 v73, v73, v33
    s_add_u32 s6, s96, 0
    v_mfma_f32_16x16x32_bf16 v[76:79], v[216:219], v[24:27], v[76:79]
    ds_read_b128 v[24:27], v7 offset:2048
    v_add_f32 v74, v74, v34
    v_add_f32 v75, v75, v35
    v_mfma_f32_16x16x32_bf16 v[76:79], v[236:239], v[28:31], v[76:79]
    buffer_store_dwordx4 v[56:59], v44, s[8:11], s6 offen sc1
    s_waitcnt lgkmcnt(2)
    v_add_f32 v72, v72, v36
    v_add_f32 v73, v73, v37
    v_mfma_f32_16x16x32_bf16 v[80:83], v[240:243], v[28:31], v[80:83]
    v_add_f32 v74, v74, v38
    v_add_f32 v75, v75, v39
    v_mfma_f32_16x16x32_bf16 v[84:87], v[244:247], v[28:31], v[84:87]
    s_waitcnt lgkmcnt(1)
    v_add_f32 v72, v72, v40
    v_add_f32 v73, v73, v41
    v_mfma_f32_16x16x32_bf16 v[88:91], v[248:251], v[28:31], v[88:91]
    v_add_f32 v74, v74, v42
    v_add_f32 v75, v75, v43
    s_cmp_lg_u32 s71, 0
    v_mfma_f32_16x16x32_bf16 v[92:95], v[252:255], v[28:31], v[92:95]
    s_cbranch_scc1 L_nost_53
    buffer_store_dwordx4 v[72:75], v52, s[8:11], s6 offen sc1
L_nost_53:
    ds_read_b128 v[28:31], v7 offset:3072
    v_mfma_f32_16x16x32_bf16 v[56:59], v[96:99], v[16:19], 0
    s_sub_u32 s6, s71, 2
    s_and_b32 s6, s6, 3
    s_mul_i32 s7, s6, 5120
    v_mfma_f32_16x16x32_bf16 v[60:63], v[100:103], v[16:19], 0
    s_add_u32 s7, s7, s67
    s_cmp_eq_u32 s6, 3
    s_cselect_b32 s7, 124928, s7
    v_mfma_f32_16x16x32_bf16 v[64:67], v[104:107], v[16:19], 0
    v_add_u32 v12, s7, v52
    v_add_u32 v5, s67, v45
    s_cmp_lg_u32 s91, 0
    s_cbranch_scc1 L_o2
    s_waitcnt vmcnt(1)
    v_cmp_ne_u32 vcc, 1, v50
    s_cbranch_vccz L_o1
    s_mov_b32 s79, 262144
L_poll_55:
    buffer_load_dword v2, v3, s[8:11], s72 offen sc1
    s_waitcnt vmcnt(0)
    v_cmp_ne_u32 vcc, 1, v2
    s_cbranch_vccz L_polldone_56
    s_sleep 1
    s_sub_u32 s79, s79, 1
    s_cmp_lg_u32 s79, 0
    s_cbranch_scc1 L_poll_55
L_polldone_56:
L_o1:
    s_add_u32 s65, s61, 1
    s_and_b32 s65, s65, 3
    s_andn2_b32 s7, s61, 3
    s_add_u32 s65, s65, s7
    s_lshl_b32 s65, s65, 17
    s_add_u32 s65, s65, s66
    s_add_u32 m0, s99, 0
    s_add_u32 s65, s65, 0
    buffer_load_dwordx4 v13, s[8:11], s65 offen offset:0 sc1 lds
    buffer_load_dwordx4 v13, s[8:11], s65 offen offset:1024 sc1 lds
    buffer_load_dwordx4 v13, s[8:11], s65 offen offset:2048 sc1 lds
    buffer_load_dwordx4 v13, s[8:11], s65 offen offset:3072 sc1 lds
L_o2:
    v_mfma_f32_16x16x32_bf16 v[68:71], v[108:111], v[16:19], 0
    v_mfma_f32_16x16x32_bf16 v[72:75], v[112:115], v[16:19], 0
    ds_read_b128 v[16:19], v7 offset:4096
    v_mfma_f32_16x16x32_bf16 v[56:59], v[116:119], v[20:23], v[56:59]
    ds_write_b128 v5, v[80:83] offset:30720
    v_add_u32 v5, s67, v46
    v_mfma_f32_16x16x32_bf16 v[60:63], v[120:123], v[20:23], v[60:63]
    s_add_u32 s65, s61, 2
    s_and_b32 s65, s65, 3
    s_andn2_b32 s7, s61, 3
    v_mfma_f32_16x16x32_bf16 v[64:67], v[124:127], v[20:23], v[64:67]
    s_add_u32 s65, s65, s7
    s_lshl_b32 s65, s65, 17
    s_add_u32 s65, s65, s66
    v_mfma_f32_16x16x32_bf16 v[68:71], v[128:131], v[20:23], v[68:71]
    s_waitcnt lgkmcnt(3)
    s_add_u32 m0, s99, 32768
    v_mfma_f32_16x16x32_bf16 v[72:75], v[132:135], v[20:23], v[72:75]
    buffer_load_dwordx4 v13, s[8:11], s65 offen offset:0 sc1 lds
    ds_read_b128 v[20:23], v7 offset:5120
    v_mfma_f32_16x16x32_bf16 v[72:75], v[152:155], v[24:27], v[72:75]
    ds_write_b128 v5, v[84:87] offset:35840
    v_add_u32 v5, s67, v47
    v_mfma_f32_16x16x32_bf16 v[68:71], v[148:151], v[24:27], v[68:71]
    buffer_load_dwordx4 v13, s[8:11], s65 offen offset:1024 sc1 lds
    v_mfma_f32_16x16x32_bf16 v[64:67], v[144:147], v[24:27], v[64:67]
    buffer_load_dwordx4 v13, s[8:11], s65 offen offset:2048 sc1 lds
    v_mfma_f32_16x16x32_bf16 v[60:63], v[140:143], v[24:27], v[60:63]
    buffer_load_dwordx4 v13, s[8:11], s65 offen offset:3072 sc1 lds
    s_waitcnt lgkmcnt(4)
    v_mfma_f32_16x16x32_bf16 v[56:59], v[136:139], v[24:27], v[56:59]
    ds_read_b128 v[24:27], v7 offset:6144
    v_mfma_f32_16x16x32_bf16 v[56:59], v[156:159], v[28:31], v[56:59]
    ds_write_b128 v5, v[88:91] offset:40960
    v_add_u32 v5, s67, v52
    v_mfma_f32_16x16x32_bf16 v[60:63], v[160:163], v[28:31], v[60:63]
    v_mfma_f32_16x16x32_bf16 v[64:67], v[164:167], v[28:31], v[64:67]
    v_mfma_f32_16x16x32_bf16 v[68:71], v[168:171], v[28:31], v[68:71]
    s_waitcnt lgkmcnt(5)
    v_mfma_f32_16x16x32_bf16 v[72:75], v[172:175], v[28:31], v[72:75]
    ds_read_b128 v[28:31], v7 offset:7168
    v_mfma_f32_16x16x32_bf16 v[72:75], v[192:195], v[16:19], v[72:75]
    ds_write_b128 v12, v[92:95] offset:30720
    v_mfma_f32_16x16x32_bf16 v[68:71], v[188:191], v[16:19], v[68:71]
    s_add_u32 s65, s61, 3
    s_and_b32 s65, s65, 3
    s_andn2_b32 s7, s61, 3
    v_mfma_f32_16x16x32_bf16 v[64:67], v[184:187], v[16:19], v[64:67]
    s_add_u32 s65, s65, s7
    s_lshl_b32 s65, s65, 17
    s_add_u32 s65, s65, s66
    v_mfma_f32_16x16x32_bf16 v[60:63], v[180:183], v[16:19], v[60:63]
    s_waitcnt lgkmcnt(5)
    s_add_u32 m0, s99, 65536
    v_mfma_f32_16x16x32_bf16 v[56:59], v[176:179], v[16:19], v[56:59]
    s_waitcnt vmcnt(4)
    s_waitcnt lgkmcnt(0)
    s_barrier
    ds_read_b128 v[32:35], v6 offset:30720
    ds_read_b128 v[36:39], v6 offset:35840
    ds_read_b128 v[40:43], v6 offset:40960
    ds_read_b128 v[16:19], v4 offset:0
    v_mfma_f32_16x16x32_bf16 v[56:59], v[196:199], v[20:23], v[56:59]
    buffer_load_dwordx4 v13, s[8:11], s65 offen offset:0 sc1 lds
    v_mfma_f32_16x16x32_bf16 v[60:63], v[200:203], v[20:23], v[60:63]
    buffer_load_dwordx4 v13, s[8:11], s65 offen offset:1024 sc1 lds
    v_mfma_f32_16x16x32_bf16 v[64:67], v[204:207], v[20:23], v[64:67]
    s_waitcnt lgkmcnt(3)
    v_add_f32 v76, v76, v32
    v_add_f32 v77, v77, v33
    v_mfma_f32_16x16x32_bf16 v[68:71], v[208:211], v[20:23], v[68:71]
    buffer_load_dwordx4 v13, s[8:11], s65 offen offset:2048 sc1 lds
    v_add_f32 v78, v78, v34
    v_add_f32 v79, v79, v35
    v_mfma_f32_16x16x32_bf16 v[72:75], v[212:215], v[20:23], v[72:75]
    s_waitcnt lgkmcnt(2)
    ds_read_b128 v[32:35], v5 offset:30720
    ds_read_b128 v[20:23], v4 offset:1024
    v_add_f32 v76, v76, v36
    v_add_f32 v77, v77, v37
    v_mfma_f32_16x16x32_bf16 v[72:75], v[232:235], v[24:27], v[72:75]
    buffer_load_dwordx4 v13, s[8:11], s65 offen offset:3072 sc1 lds
    v_add_f32 v78, v78, v38
    v_add_f32 v79, v79, v39
    v_mfma_f32_16x16x32_bf16 v[68:71], v[228:231], v[24:27], v[68:71]
    s_waitcnt lgkmcnt(3)
    ds_read_b128 v[36:39], v5 offset:35840
    v_add_f32 v76, v76, v40
    v_add_f32 v77, v77, v41
    v_mfma_f32_16x16x32_bf16 v[64:67], v[224:227], v[24:27], v[64:67]
    v_add_f32 v78, v78, v42
    v_add_f32 v79, v79, v43
    v_mfma_f32_16x16x32_bf16 v[60:63], v[220:223], v[24:27], v[60:63]
    ds_read_b128 v[40:43], v5 offset:40960
    s_waitcnt lgkmcnt(3)
    v_add_f32 v92, v92, v32
    v_add_f32 v93, v93, v33
    s_add_u32 s6, s97, 0
    v_mfma_f32_16x16x32_bf16 v[56:59], v[216:219], v[24:27], v[56:59]
    ds_read_b128 v[24:27], v4 offset:2048
    v_add_f32 v94, v94, v34
    v_add_f32 v95, v95, v35
    v_mfma_f32_16x16x32_bf16 v[56:59], v[236:239], v[28:31], v[56:59]
    buffer_store_dwordx4 v[76:79], v44, s[8:11], s6 offen sc1
    s_waitcnt lgkmcnt(2)
    v_add_f32 v92, v92, v36
    v_add_f32 v93, v93, v37
    v_mfma_f32_16x16x32_bf16 v[60:63], v[240:243], v[28:31], v[60:63]
    v_add_f32 v94, v94, v38
    v_add_f32 v95, v95, v39
    v_mfma_f32_16x16x32_bf16 v[64:67], v[244:247], v[28:31], v[64:67]
    s_waitcnt lgkmcnt(1)
    v_add_f32 v92, v92, v40
    v_add_f32 v93, v93, v41
    v_mfma_f32_16x16x32_bf16 v[68:71], v[248:251], v[28:31], v[68:71]
    v_add_f32 v94, v94, v42
    v_add_f32 v95, v95, v43
    s_cmp_lg_u32 s71, 1
    v_mfma_f32_16x16x32_bf16 v[72:75], v[252:255], v[28:31], v[72:75]
    s_cbranch_scc1 L_nost_54
    buffer_store_dwordx4 v[92:95], v52, s[8:11], s6 offen sc1
L_nost_54:
    ds_read_b128 v[28:31], v4 offset:3072
    v_mfma_f32_16x16x32_bf16 v[76:79], v[96:99], v[16:19], 0
    s_sub_u32 s6, s71, 3
    s_and_b32 s6, s6, 3
    s_mul_i32 s7, s6, 5120
    v_mfma_f32_16x16x32_bf16 v[80:83], v[100:103], v[16:19], 0
    s_add_u32 s7, s7, s67
    s_cmp_eq_u32 s6, 3
    s_cselect_b32 s7, 155648, s7
    v_mfma_f32_16x16x32_bf16 v[84:87], v[104:107], v[16:19], 0
    v_add_u32 v12, s7, v52
    v_add_u32 v5, s67, v45
    v_mfma_f32_16x16x32_bf16 v[88:91], v[108:111], v[16:19], 0
    s_mov_b32 s12, s32
    s_mov_b32 s13, s33
    s_mov_b32 s14, 0x280000
    s_mov_b32 s15, 0x20000
    v_mfma_f32_16x16x32_bf16 v[92:95], v[112:115], v[16:19], 0
    ds_read_b128 v[16:19], v4 offset:4096
    s_and_b32 s75, s4, 3
    s_mul_i32 s70, s75, 320
    s_add_u32 s73, s70, 3837952
    s_mul_i32 s72, s75, 5120
    v_mfma_f32_16x16x32_bf16 v[76:79], v[116:119], v[20:23], v[76:79]
    ds_write_b128 v5, v[60:63] offset:0
    v_add_u32 v5, s67, v46
    v_mfma_f32_16x16x32_bf16 v[80:83], v[120:123], v[20:23], v[80:83]
    v_lshrrev_b32 v2, 4, v1
    v_and_b32 v3, 15, v1
    v_mul_u32_u24 v54, 1280, v3
    v_lshl_add_u32 v54, v2, 4, v54
    v_mfma_f32_16x16x32_bf16 v[84:87], v[124:127], v[20:23], v[84:87]
    v_lshlrev_b32 v3, 4, v3
    v_lshl_add_u32 v9, v2, 9, v3
    s_lshr_b32 s100, s3, 2
    s_cselect_b32 s6, s61, s68
    v_mfma_f32_16x16x32_bf16 v[88:91], v[128:131], v[20:23], v[88:91]
    s_waitcnt lgkmcnt(3)
    s_mul_i32 s6, s6, 20480
    s_lshl_b32 s7, s76, 6
    s_add_u32 s7, s7, s6
    v_add_u32 v53, s7, v54
    v_mfma_f32_16x16x32_bf16 v[92:95], v[132:135], v[20:23], v[92:95]
    ds_read_b128 v[20:23], v4 offset:5120
    s_lshl_b32 s7, s76, 10
    s_add_u32 s7, s7, s6
    s_add_u32 s7, s7, s72
    v_add_u32 v48, s7, v13
    v_mfma_f32_16x16x32_bf16 v[92:95], v[152:155], v[24:27], v[92:95]
    ds_write_b128 v5, v[64:67] offset:5120
    v_add_u32 v5, s67, v47
    v_mfma_f32_16x16x32_bf16 v[88:91], v[148:151], v[24:27], v[88:91]
    s_mul_i32 s6, s100, 10240
    s_lshl_b32 s7, s76, 11
    s_add_u32 s6, s6, s7
    v_add_u32 v8, s6, v9
    v_mfma_f32_16x16x32_bf16 v[84:87], v[144:147], v[24:27], v[84:87]
    s_mul_i32 s6, s100, 75776
    s_sub_u32 s6, 65536, s6
    v_add_u32 v10, s6, v8
    s_lshl_b32 s7, s76, 2
    v_mfma_f32_16x16x32_bf16 v[80:83], v[140:143], v[24:27], v[80:83]
    s_waitcnt lgkmcnt(4)
    v_add_u32 v2, s7, v2
    v_cmp_lt_u32 vcc, 9, v2
    s_mul_i32 s6, s100, 86016
    s_add_u32 s6, s6, 15360
    v_mfma_f32_16x16x32_bf16 v[76:79], v[136:139], v[24:27], v[76:79]
    ds_read_b128 v[24:27], v4 offset:6144
    v_add_u32 v3, s6, v10
    v_cndmask_b32 v10, v10, v3, vcc
    s_and_b32 s100, s3, 1
    s_cselect_b32 s6, s61, s68
    v_mfma_f32_16x16x32_bf16 v[76:79], v[156:159], v[28:31], v[76:79]
    ds_write_b128 v5, v[68:71] offset:10240
    v_add_u32 v5, s67, v52
    v_mfma_f32_16x16x32_bf16 v[80:83], v[160:163], v[28:31], v[80:83]
    s_mul_i32 s6, s6, 20480
    s_add_u32 s7, s6, 256
    v_add_u32 v54, s7, v54
    s_add_u32 s7, s6, s72
    v_mfma_f32_16x16x32_bf16 v[84:87], v[164:167], v[28:31], v[84:87]
    s_add_u32 s7, s7, 4096
    v_add_u32 v49, s7, v13
    s_mul_i32 s6, s100, 10240
    s_add_u32 s6, s6, 8192
    v_mfma_f32_16x16x32_bf16 v[88:91], v[168:171], v[28:31], v[88:91]
    s_waitcnt lgkmcnt(5)
    v_add_u32 v9, s6, v9
    s_mul_i32 s6, s100, 10240
    s_add_u32 s6, s6, 80896
    v_add_u32 v55, s6, v9
    v_mfma_f32_16x16x32_bf16 v[92:95], v[172:175], v[28:31], v[92:95]
    ds_read_b128 v[28:31], v4 offset:7168
    v_mfma_f32_16x16x32_bf16 v[92:95], v[192:195], v[16:19], v[92:95]
    ds_write_b128 v12, v[72:75] offset:0
    v_mfma_f32_16x16x32_bf16 v[88:91], v[188:191], v[16:19], v[88:91]
    s_add_u32 s65, s68, 0
    s_and_b32 s65, s65, 3
    s_andn2_b32 s7, s68, 3
    v_mfma_f32_16x16x32_bf16 v[84:87], v[184:187], v[16:19], v[84:87]
    s_add_u32 s65, s65, s7
    s_lshl_b32 s65, s65, 17
    s_add_u32 s65, s65, s66
    v_mfma_f32_16x16x32_bf16 v[80:83], v[180:183], v[16:19], v[80:83]
    s_waitcnt lgkmcnt(5)
    s_add_u32 m0, s99, 0
    v_mfma_f32_16x16x32_bf16 v[76:79], v[176:179], v[16:19], v[76:79]
    s_waitcnt vmcnt(5)
    s_waitcnt lgkmcnt(0)
    s_barrier
    ds_read_b128 v[32:35], v6 offset:0
    ds_read_b128 v[36:39], v6 offset:5120
    ds_read_b128 v[40:43], v6 offset:10240
    ds_read_b128 v[16:19], v4 offset:32768
    v_mfma_f32_16x16x32_bf16 v[76:79], v[196:199], v[20:23], v[76:79]
    buffer_load_dwordx4 v13, s[8:11], s65 offen offset:0 sc1 lds
    v_mfma_f32_16x16x32_bf16 v[80:83], v[200:203], v[20:23], v[80:83]
    buffer_load_dwordx4 v13, s[8:11], s65 offen offset:1024 sc1 lds
    v_mfma_f32_16x16x32_bf16 v[84:87], v[204:207], v[20:23], v[84:87]
    s_waitcnt lgkmcnt(3)
    v_add_f32 v56, v56, v32
    v_add_f32 v57, v57, v33
    v_mfma_f32_16x16x32_bf16 v[88:91], v[208:211], v[20:23], v[88:91]
    buffer_load_dwordx4 v13, s[8:11], s65 offen offset:2048 sc1 lds
    v_add_f32 v58, v58, v34
    v_add_f32 v59, v59, v35
    v_mfma_f32_16x16x32_bf16 v[92:95], v[212:215], v[20:23], v[92:95]
    s_waitcnt lgkmcnt(2)
    ds_read_b128 v[32:35], v5 offset:0
    ds_read_b128 v[20:23], v4 offset:33792
    v_add_f32 v56, v56, v36
    v_add_f32 v57, v57, v37
    v_mfma_f32_16x16x32_bf16 v[92:95], v[232:235], v[24:27], v[92:95]
    buffer_load_dwordx4 v13, s[8:11], s65 offen offset:3072 sc1 lds
    v_add_f32 v58, v58, v38
    v_add_f32 v59, v59, v39
    v_mfma_f32_16x16x32_bf16 v[88:91], v[228:231], v[24:27], v[88:91]
    s_waitcnt lgkmcnt(3)
    ds_read_b128 v[36:39], v5 offset:5120
    v_add_f32 v56, v56, v40
    v_add_f32 v57, v57, v41
    v_mfma_f32_16x16x32_bf16 v[84:87], v[224:227], v[24:27], v[84:87]
    v_add_f32 v58, v58, v42
    v_add_f32 v59, v59, v43
    v_mfma_f32_16x16x32_bf16 v[80:83], v[220:223], v[24:27], v[80:83]
    ds_read_b128 v[40:43], v5 offset:10240
    s_waitcnt lgkmcnt(3)
    v_add_f32 v72, v72, v32
    v_add_f32 v73, v73, v33
    s_add_u32 s6, s98, 0
    v_mfma_f32_16x16x32_bf16 v[76:79], v[216:219], v[24:27], v[76:79]
    ds_read_b128 v[24:27], v4 offset:34816
    v_add_f32 v74, v74, v34
    v_add_f32 v75, v75, v35
    v_mfma_f32_16x16x32_bf16 v[76:79], v[236:239], v[28:31], v[76:79]
    buffer_store_dwordx4 v[56:59], v44, s[8:11], s6 offen sc1
    s_waitcnt lgkmcnt(2)
    v_add_f32 v72, v72, v36
    v_add_f32 v73, v73, v37
    v_mfma_f32_16x16x32_bf16 v[80:83], v[240:243], v[28:31], v[80:83]
    v_add_f32 v74, v74, v38
    v_add_f32 v75, v75, v39
    v_mfma_f32_16x16x32_bf16 v[84:87], v[244:247], v[28:31], v[84:87]
    s_waitcnt lgkmcnt(1)
    v_add_f32 v72, v72, v40
    v_add_f32 v73, v73, v41
    v_mfma_f32_16x16x32_bf16 v[88:91], v[248:251], v[28:31], v[88:91]
    v_add_f32 v74, v74, v42
    v_add_f32 v75, v75, v43
    s_cmp_lg_u32 s71, 2
    v_mfma_f32_16x16x32_bf16 v[92:95], v[252:255], v[28:31], v[92:95]
    s_cbranch_scc1 L_nost_57
    buffer_store_dwordx4 v[72:75], v52, s[8:11], s6 offen sc1
L_nost_57:
    ds_read_b128 v[28:31], v4 offset:35840
    v_mfma_f32_16x16x32_bf16 v[56:59], v[96:99], v[16:19], 0
    s_sub_u32 s6, s71, 4
    s_and_b32 s6, s6, 3
    s_mul_i32 s7, s6, 5120
    v_mfma_f32_16x16x32_bf16 v[60:63], v[100:103], v[16:19], 0
    s_add_u32 s7, s7, s67
    s_cmp_eq_u32 s6, 3
    s_cselect_b32 s7, 124928, s7
    v_mfma_f32_16x16x32_bf16 v[64:67], v[104:107], v[16:19], 0
    v_add_u32 v12, s7, v52
    v_add_u32 v5, s67, v45
    v_mfma_f32_16x16x32_bf16 v[68:71], v[108:111], v[16:19], 0
    v_mfma_f32_16x16x32_bf16 v[72:75], v[112:115], v[16:19], 0
    ds_read_b128 v[16:19], v4 offset:36864
    v_mfma_f32_16x16x32_bf16 v[56:59], v[116:119], v[20:23], v[56:59]
    ds_write_b128 v5, v[80:83] offset:30720
    v_add_u32 v5, s67, v46
    v_mfma_f32_16x16x32_bf16 v[60:63], v[120:123], v[20:23], v[60:63]
    v_mfma_f32_16x16x32_bf16 v[64:67], v[124:127], v[20:23], v[64:67]
    v_cmp_le_i32 vcc, 0, v51
    s_cbranch_vccz L_idx_okb
    v_and_b32 v3, 7, v1
    v_lshlrev_b32 v3, 2, v3
    s_mov_b32 s72, 0x3a0000
    s_mov_b32 s79, 262144
L_poll_59:
    buffer_load_dword v51, v3, s[8:11], s72 offen sc1
    s_waitcnt vmcnt(0)
    v_cmp_le_i32 vcc, 0, v51
    s_cbranch_vccz L_polldone_60
    s_sleep 2
    s_sub_u32 s79, s79, 1
    s_cmp_lg_u32 s79, 0
    s_cbranch_scc1 L_poll_59
L_polldone_60:
L_idx_okb:
    s_mov_b32 s64, 0
    v_and_b32 v2, 0x7ff, v51
    v_sub_u32 v2, 0x7ff, v2
    v_lshrrev_b32 v3, 4, v2
    v_cmp_eq_u32 vcc, s68, v3
    v_cmp_eq_u32 s[74:75], s61, v3
    s_nop 3
    s_or_b64 vcc, vcc, s[74:75]
    s_cbranch_scc0 L_notok_61
    v_readlane_b32 s84, v2, 0
    v_readlane_b32 s85, v2, 1
    v_readlane_b32 s86, v2, 2
    v_readlane_b32 s87, v2, 3
    v_readlane_b32 s88, v2, 4
    v_readlane_b32 s65, v2, 5
    v_readlane_b32 s91, v2, 6
    v_readlane_b32 s101, v2, 7
    s_lshl_b32 s7, s76, 6
    s_lshr_b32 s100, s3, 2
    s_cselect_b32 s6, s61, s68
    s_lshl_b32 s6, s6, 4
    v_and_b32 v2, 15, v1
    v_add_u32 v2, s6, v2
    s_add_u32 s7, s7, s73
    v_and_b32 v3, 48, v1
    v_add_u32 v3, s7, v3
    v_cmp_eq_u32 vcc, s84, v2
    s_nop 1
    v_cndmask_b32 v48, v48, v3, vcc
    v_add_u32 v3, 1280, v3
    v_cmp_eq_u32 vcc, s85, v2
    s_nop 1
    v_cndmask_b32 v48, v48, v3, vcc
    v_add_u32 v3, 1280, v3
    v_cmp_eq_u32 vcc, s86, v2
    s_nop 1
    v_cndmask_b32 v48, v48, v3, vcc
    v_add_u32 v3, 1280, v3
    v_cmp_eq_u32 vcc, s87, v2
    s_nop 1
    v_cndmask_b32 v48, v48, v3, vcc
    v_add_u32 v3, 1280, v3
    v_cmp_eq_u32 vcc, s88, v2
    s_nop 1
    v_cndmask_b32 v48, v48, v3, vcc
    v_add_u32 v3, 1280, v3
    v_cmp_eq_u32 vcc, s65, v2
    s_nop 1
    v_cndmask_b32 v48, v48, v3, vcc
    v_add_u32 v3, 1280, v3
    v_cmp_eq_u32 vcc, s91, v2
    s_nop 1
    v_cndmask_b32 v48, v48, v3, vcc
    v_add_u32 v3, 1280, v3
    v_cmp_eq_u32 vcc, s101, v2
    s_nop 1
    v_cndmask_b32 v48, v48, v3, vcc
    s_movk_i32 s7, 256
    s_and_b32 s100, s3, 1
    s_cselect_b32 s6, s61, s68
    s_lshl_b32 s6, s6, 4
    v_and_b32 v2, 15, v1
    v_add_u32 v2, s6, v2
    s_add_u32 s7, s7, s73
    v_and_b32 v3, 48, v1
    v_add_u32 v3, s7, v3
    v_cmp_eq_u32 vcc, s84, v2
    s_nop 1
    v_cndmask_b32 v49, v49, v3, vcc
    v_add_u32 v3, 1280, v3
    v_cmp_eq_u32 vcc, s85, v2
    s_nop 1
    v_cndmask_b32 v49, v49, v3, vcc
    v_add_u32 v3, 1280, v3
    v_cmp_eq_u32 vcc, s86, v2
    s_nop 1
    v_cndmask_b32 v49, v49, v3, vcc
    v_add_u32 v3, 1280, v3
    v_cmp_eq_u32 vcc, s87, v2
    s_nop 1
    v_cndmask_b32 v49, v49, v3, vcc
    v_add_u32 v3, 1280, v3
    v_cmp_eq_u32 vcc, s88, v2
    s_nop 1
    v_cndmask_b32 v49, v49, v3, vcc
    v_add_u32 v3, 1280, v3
    v_cmp_eq_u32 vcc, s65, v2
    s_nop 1
    v_cndmask_b32 v49, v49, v3, vcc
    v_add_u32 v3, 1280, v3
    v_cmp_eq_u32 vcc, s91, v2
    s_nop 1
    v_cndmask_b32 v49, v49, v3, vcc
    v_add_u32 v3, 1280, v3
    v_cmp_eq_u32 vcc, s101, v2
    s_nop 1
    v_cndmask_b32 v49, v49, v3, vcc
    s_mov_b32 s64, 1
L_notok_61:
    v_mfma_f32_16x16x32_bf16 v[68:71], v[128:131], v[20:23], v[68:71]
    s_waitcnt lgkmcnt(3)
    v_mfma_f32_16x16x32_bf16 v[72:75], v[132:135], v[20:23], v[72:75]
    ds_read_b128 v[20:23], v4 offset:37888
    v_mfma_f32_16x16x32_bf16 v[72:75], v[152:155], v[24:27], v[72:75]
    ds_write_b128 v5, v[84:87] offset:35840
    v_add_u32 v5, s67, v47
    v_mfma_f32_16x16x32_bf16 v[68:71], v[148:151], v[24:27], v[68:71]
    v_mfma_f32_16x16x32_bf16 v[64:67], v[144:147], v[24:27], v[64:67]
    v_mfma_f32_16x16x32_bf16 v[60:63], v[140:143], v[24:27], v[60:63]
    s_waitcnt lgkmcnt(4)
    v_mfma_f32_16x16x32_bf16 v[56:59], v[136:139], v[24:27], v[56:59]
    ds_read_b128 v[24:27], v4 offset:38912
    v_mfma_f32_16x16x32_bf16 v[56:59], v[156:159], v[28:31], v[56:59]
    ds_write_b128 v5, v[88:91] offset:40960
    v_add_u32 v5, s67, v52
    v_mfma_f32_16x16x32_bf16 v[60:63], v[160:163], v[28:31], v[60:63]
    v_mfma_f32_16x16x32_bf16 v[64:67], v[164:167], v[28:31], v[64:67]
    v_mfma_f32_16x16x32_bf16 v[68:71], v[168:171], v[28:31], v[68:71]
    s_waitcnt lgkmcnt(5)
    v_mfma_f32_16x16x32_bf16 v[72:75], v[172:175], v[28:31], v[72:75]
    ds_read_b128 v[28:31], v4 offset:39936
    v_mfma_f32_16x16x32_bf16 v[72:75], v[192:195], v[16:19], v[72:75]
    ds_write_b128 v12, v[92:95] offset:30720
    v_mfma_f32_16x16x32_bf16 v[68:71], v[188:191], v[16:19], v[68:71]
    s_add_u32 s65, s61, 0
    s_and_b32 s65, s65, 3
    s_andn2_b32 s7, s61, 3
    v_mfma_f32_16x16x32_bf16 v[64:67], v[184:187], v[16:19], v[64:67]
    s_add_u32 s65, s65, s7
    s_lshl_b32 s65, s65, 17
    s_add_u32 s65, s65, s66
    v_mfma_f32_16x16x32_bf16 v[60:63], v[180:183], v[16:19], v[60:63]
    s_waitcnt lgkmcnt(5)
    s_add_u32 m0, s99, 32768
    v_mfma_f32_16x16x32_bf16 v[56:59], v[176:179], v[16:19], v[56:59]
    s_waitcnt vmcnt(5)
    s_waitcnt lgkmcnt(0)
    s_barrier
    ds_read_b128 v[32:35], v6 offset:30720
    ds_read_b128 v[36:39], v6 offset:35840
    ds_read_b128 v[40:43], v6 offset:40960
    ds_read_b128 v[16:19], v7 offset:0
    v_mfma_f32_16x16x32_bf16 v[56:59], v[196:199], v[20:23], v[56:59]
    buffer_load_dwordx4 v13, s[8:11], s65 offen offset:0 sc1 lds
    v_mfma_f32_16x16x32_bf16 v[60:63], v[200:203], v[20:23], v[60:63]
    buffer_load_dwordx4 v13, s[8:11], s65 offen offset:1024 sc1 lds
    v_mfma_f32_16x16x32_bf16 v[64:67], v[204:207], v[20:23], v[64:67]
    s_waitcnt lgkmcnt(3)
    v_add_f32 v76, v76, v32
    v_add_f32 v77, v77, v33
    v_mfma_f32_16x16x32_bf16 v[68:71], v[208:211], v[20:23], v[68:71]
    buffer_load_dwordx4 v13, s[8:11], s65 offen offset:2048 sc1 lds
    v_add_f32 v78, v78, v34
    v_add_f32 v79, v79, v35
    v_mfma_f32_16x16x32_bf16 v[72:75], v[212:215], v[20:23], v[72:75]
    s_waitcnt lgkmcnt(2)
    ds_read_b128 v[32:35], v5 offset:30720
    ds_read_b128 v[20:23], v7 offset:1024
    v_add_f32 v76, v76, v36
    v_add_f32 v77, v77, v37
    v_mfma_f32_16x16x32_bf16 v[72:75], v[232:235], v[24:27], v[72:75]
    buffer_load_dwordx4 v13, s[8:11], s65 offen offset:3072 sc1 lds
    v_add_f32 v78, v78, v38
    v_add_f32 v79, v79, v39
    v_mfma_f32_16x16x32_bf16 v[68:71], v[228:231], v[24:27], v[68:71]
    s_waitcnt lgkmcnt(3)
    ds_read_b128 v[36:39], v5 offset:35840
    v_add_f32 v76, v76, v40
    v_add_f32 v77, v77, v41
    v_mfma_f32_16x16x32_bf16 v[64:67], v[224:227], v[24:27], v[64:67]
    v_add_f32 v78, v78, v42
    v_add_f32 v79, v79, v43
    v_mfma_f32_16x16x32_bf16 v[60:63], v[220:223], v[24:27], v[60:63]
    ds_read_b128 v[40:43], v5 offset:40960
    s_waitcnt lgkmcnt(3)
    v_add_f32 v92, v92, v32
    v_add_f32 v93, v93, v33
    s_add_u32 s6, s96, 10240
    v_mfma_f32_16x16x32_bf16 v[56:59], v[216:219], v[24:27], v[56:59]
    ds_read_b128 v[24:27], v7 offset:2048
    v_add_f32 v94, v94, v34
    v_add_f32 v95, v95, v35
    v_mfma_f32_16x16x32_bf16 v[56:59], v[236:239], v[28:31], v[56:59]
    buffer_store_dwordx4 v[76:79], v44, s[8:11], s6 offen sc1
    s_waitcnt lgkmcnt(2)
    v_add_f32 v92, v92, v36
    v_add_f32 v93, v93, v37
    v_mfma_f32_16x16x32_bf16 v[60:63], v[240:243], v[28:31], v[60:63]
    v_add_f32 v94, v94, v38
    v_add_f32 v95, v95, v39
    v_mfma_f32_16x16x32_bf16 v[64:67], v[244:247], v[28:31], v[64:67]
    s_waitcnt lgkmcnt(1)
    v_add_f32 v92, v92, v40
    v_add_f32 v93, v93, v41
    v_mfma_f32_16x16x32_bf16 v[68:71], v[248:251], v[28:31], v[68:71]
    v_add_f32 v94, v94, v42
    v_add_f32 v95, v95, v43
    s_cmp_lg_u32 s71, 3
    v_mfma_f32_16x16x32_bf16 v[72:75], v[252:255], v[28:31], v[72:75]
    s_cbranch_scc1 L_nost_58
    buffer_store_dwordx4 v[92:95], v52, s[8:11], s6 offen sc1
L_nost_58:
    ds_read_b128 v[28:31], v7 offset:3072
    v_mfma_f32_16x16x32_bf16 v[76:79], v[96:99], v[16:19], 0
    s_sub_u32 s6, s71, 5
    s_and_b32 s6, s6, 3
    s_mul_i32 s7, s6, 5120
    v_mfma_f32_16x16x32_bf16 v[80:83], v[100:103], v[16:19], 0
    s_add_u32 s7, s7, s67
    s_cmp_eq_u32 s6, 3
    s_cselect_b32 s7, 155648, s7
    v_mfma_f32_16x16x32_bf16 v[84:87], v[104:107], v[16:19], 0
    v_add_u32 v12, s7, v52
    v_add_u32 v5, s67, v45
    v_mfma_f32_16x16x32_bf16 v[88:91], v[108:111], v[16:19], 0
    v_mfma_f32_16x16x32_bf16 v[92:95], v[112:115], v[16:19], 0
    ds_read_b128 v[16:19], v7 offset:4096
    v_mfma_f32_16x16x32_bf16 v[76:79], v[116:119], v[20:23], v[76:79]
    ds_write_b128 v5, v[60:63] offset:0
    v_add_u32 v5, s67, v46
    v_mfma_f32_16x16x32_bf16 v[80:83], v[120:123], v[20:23], v[80:83]
    v_mfma_f32_16x16x32_bf16 v[84:87], v[124:127], v[20:23], v[84:87]
    v_mfma_f32_16x16x32_bf16 v[88:91], v[128:131], v[20:23], v[88:91]
    s_waitcnt lgkmcnt(3)
    v_mfma_f32_16x16x32_bf16 v[92:95], v[132:135], v[20:23], v[92:95]
    ds_read_b128 v[20:23], v7 offset:5120
    v_mfma_f32_16x16x32_bf16 v[92:95], v[152:155], v[24:27], v[92:95]
    ds_write_b128 v5, v[64:67] offset:5120
    v_add_u32 v5, s67, v47
    v_mfma_f32_16x16x32_bf16 v[88:91], v[148:151], v[24:27], v[88:91]
    v_mfma_f32_16x16x32_bf16 v[84:87], v[144:147], v[24:27], v[84:87]
    v_mfma_f32_16x16x32_bf16 v[80:83], v[140:143], v[24:27], v[80:83]
    s_waitcnt lgkmcnt(4)
    v_mfma_f32_16x16x32_bf16 v[76:79], v[136:139], v[24:27], v[76:79]
    ds_read_b128 v[24:27], v7 offset:6144
    v_mfma_f32_16x16x32_bf16 v[76:79], v[156:159], v[28:31], v[76:79]
    ds_write_b128 v5, v[68:71] offset:10240
    v_add_u32 v5, s67, v52
    v_mfma_f32_16x16x32_bf16 v[80:83], v[160:163], v[28:31], v[80:83]
    v_mfma_f32_16x16x32_bf16 v[84:87], v[164:167], v[28:31], v[84:87]
    v_mfma_f32_16x16x32_bf16 v[88:91], v[168:171], v[28:31], v[88:91]
    s_waitcnt lgkmcnt(5)
    v_mfma_f32_16x16x32_bf16 v[92:95], v[172:175], v[28:31], v[92:95]
    ds_read_b128 v[28:31], v7 offset:7168
    v_mfma_f32_16x16x32_bf16 v[92:95], v[192:195], v[16:19], v[92:95]
    ds_write_b128 v12, v[72:75] offset:0
    v_mfma_f32_16x16x32_bf16 v[88:91], v[188:191], v[16:19], v[88:91]
    v_mfma_f32_16x16x32_bf16 v[84:87], v[184:187], v[16:19], v[84:87]
    v_mfma_f32_16x16x32_bf16 v[80:83], v[180:183], v[16:19], v[80:83]
    s_waitcnt lgkmcnt(5)
    v_mfma_f32_16x16x32_bf16 v[76:79], v[176:179], v[16:19], v[76:79]
    s_waitcnt vmcnt(5)
    s_waitcnt lgkmcnt(0)
    s_barrier
    ds_read_b128 v[32:35], v6 offset:0
    ds_read_b128 v[36:39], v6 offset:5120
    ds_read_b128 v[40:43], v6 offset:10240
    ds_read_b128 v[16:19], v4 offset:0
    v_mfma_f32_16x16x32_bf16 v[76:79], v[196:199], v[20:23], v[76:79]
    v_mfma_f32_16x16x32_bf16 v[80:83], v[200:203], v[20:23], v[80:83]
    v_mfma_f32_16x16x32_bf16 v[84:87], v[204:207], v[20:23], v[84:87]
    s_waitcnt lgkmcnt(3)
    v_add_f32 v56, v56, v32
    v_add_f32 v57, v57, v33
    v_mfma_f32_16x16x32_bf16 v[88:91], v[208:211], v[20:23], v[88:91]
    v_add_f32 v58, v58, v34
    v_add_f32 v59, v59, v35
    v_mfma_f32_16x16x32_bf16 v[92:95], v[212:215], v[20:23], v[92:95]
    s_waitcnt lgkmcnt(2)
    ds_read_b128 v[32:35], v5 offset:0
    ds_read_b128 v[20:23], v4 offset:1024
    v_add_f32 v56, v56, v36
    v_add_f32 v57, v57, v37
    v_mfma_f32_16x16x32_bf16 v[92:95], v[232:235], v[24:27], v[92:95]
    v_add_f32 v58, v58, v38
    v_add_f32 v59, v59, v39
    v_mfma_f32_16x16x32_bf16 v[88:91], v[228:231], v[24:27], v[88:91]
    s_waitcnt lgkmcnt(3)
    ds_read_b128 v[36:39], v5 offset:5120
    v_add_f32 v56, v56, v40
    v_add_f32 v57, v57, v41
    v_mfma_f32_16x16x32_bf16 v[84:87], v[224:227], v[24:27], v[84:87]
    v_add_f32 v58, v58, v42
    v_add_f32 v59, v59, v43
    v_mfma_f32_16x16x32_bf16 v[80:83], v[220:223], v[24:27], v[80:83]
    ds_read_b128 v[40:43], v5 offset:10240
    s_waitcnt lgkmcnt(3)
    v_add_f32 v72, v72, v32
    v_add_f32 v73, v73, v33
    s_add_u32 s6, s97, 10240
    v_mfma_f32_16x16x32_bf16 v[76:79], v[216:219], v[24:27], v[76:79]
    ds_read_b128 v[24:27], v4 offset:2048
    v_add_f32 v74, v74, v34
    v_add_f32 v75, v75, v35
    v_mfma_f32_16x16x32_bf16 v[76:79], v[236:239], v[28:31], v[76:79]
    buffer_store_dwordx4 v[56:59], v44, s[8:11], s6 offen sc1
    s_waitcnt lgkmcnt(2)
    v_add_f32 v72, v72, v36
    v_add_f32 v73, v73, v37
    v_mfma_f32_16x16x32_bf16 v[80:83], v[240:243], v[28:31], v[80:83]
    v_add_f32 v74, v74, v38
    v_add_f32 v75, v75, v39
    v_mfma_f32_16x16x32_bf16 v[84:87], v[244:247], v[28:31], v[84:87]
    s_waitcnt lgkmcnt(1)
    v_add_f32 v72, v72, v40
    v_add_f32 v73, v73, v41
    v_mfma_f32_16x16x32_bf16 v[88:91], v[248:251], v[28:31], v[88:91]
    v_add_f32 v74, v74, v42
    v_add_f32 v75, v75, v43
    s_cmp_lg_u32 s71, 0
    v_mfma_f32_16x16x32_bf16 v[92:95], v[252:255], v[28:31], v[92:95]
    s_cbranch_scc1 L_nost_62
    buffer_store_dwordx4 v[72:75], v52, s[8:11], s6 offen sc1
L_nost_62:
    ds_read_b128 v[28:31], v4 offset:3072
    v_mfma_f32_16x16x32_bf16 v[56:59], v[96:99], v[16:19], 0
    s_sub_u32 s6, s71, 6
    s_and_b32 s6, s6, 3
    s_mul_i32 s7, s6, 5120
    v_mfma_f32_16x16x32_bf16 v[60:63], v[100:103], v[16:19], 0
    s_add_u32 s7, s7, s67
    s_cmp_eq_u32 s6, 3
    s_cselect_b32 s7, 124928, s7
    v_mfma_f32_16x16x32_bf16 v[64:67], v[104:107], v[16:19], 0
    v_add_u32 v12, s7, v52
    v_add_u32 v5, s67, v45
    v_mfma_f32_16x16x32_bf16 v[68:71], v[108:111], v[16:19], 0
    v_mfma_f32_16x16x32_bf16 v[72:75], v[112:115], v[16:19], 0
    ds_read_b128 v[16:19], v4 offset:4096
    v_mfma_f32_16x16x32_bf16 v[56:59], v[116:119], v[20:23], v[56:59]
    ds_write_b128 v5, v[80:83] offset:30720
    v_add_u32 v5, s67, v46
    v_mfma_f32_16x16x32_bf16 v[60:63], v[120:123], v[20:23], v[60:63]
    v_mfma_f32_16x16x32_bf16 v[64:67], v[124:127], v[20:23], v[64:67]
    v_mfma_f32_16x16x32_bf16 v[68:71], v[128:131], v[20:23], v[68:71]
    s_waitcnt lgkmcnt(3)
    v_mfma_f32_16x16x32_bf16 v[72:75], v[132:135], v[20:23], v[72:75]
    ds_read_b128 v[20:23], v4 offset:5120
    v_mfma_f32_16x16x32_bf16 v[72:75], v[152:155], v[24:27], v[72:75]
    ds_write_b128 v5, v[84:87] offset:35840
    v_add_u32 v5, s67, v47
    v_mfma_f32_16x16x32_bf16 v[68:71], v[148:151], v[24:27], v[68:71]
    v_mfma_f32_16x16x32_bf16 v[64:67], v[144:147], v[24:27], v[64:67]
    v_mfma_f32_16x16x32_bf16 v[60:63], v[140:143], v[24:27], v[60:63]
    s_waitcnt lgkmcnt(4)
    v_mfma_f32_16x16x32_bf16 v[56:59], v[136:139], v[24:27], v[56:59]
    ds_read_b128 v[24:27], v4 offset:6144
    v_mfma_f32_16x16x32_bf16 v[56:59], v[156:159], v[28:31], v[56:59]
    ds_write_b128 v5, v[88:91] offset:40960
    v_add_u32 v5, s67, v52
    v_mfma_f32_16x16x32_bf16 v[60:63], v[160:163], v[28:31], v[60:63]
    v_mfma_f32_16x16x32_bf16 v[64:67], v[164:167], v[28:31], v[64:67]
    v_mfma_f32_16x16x32_bf16 v[68:71], v[168:171], v[28:31], v[68:71]
    s_waitcnt lgkmcnt(5)
    v_mfma_f32_16x16x32_bf16 v[72:75], v[172:175], v[28:31], v[72:75]
    ds_read_b128 v[28:31], v4 offset:7168
    v_mfma_f32_16x16x32_bf16 v[72:75], v[192:195], v[16:19], v[72:75]
    ds_write_b128 v12, v[92:95] offset:30720
    v_mfma_f32_16x16x32_bf16 v[68:71], v[188:191], v[16:19], v[68:71]
    v_mfma_f32_16x16x32_bf16 v[64:67], v[184:187], v[16:19], v[64:67]
    v_mov_b32 v2, 1
    v_writelane_b32 v2, 2, 0
    v_mfma_f32_16x16x32_bf16 v[60:63], v[180:183], v[16:19], v[60:63]
    s_waitcnt lgkmcnt(5)
    v_mfma_f32_16x16x32_bf16 v[56:59], v[176:179], v[16:19], v[56:59]
    s_waitcnt vmcnt(1)
    buffer_store_dword v2, v11, s[8:11], 0 offen sc1
    s_waitcnt lgkmcnt(0)
    s_barrier
    ds_read_b128 v[32:35], v6 offset:30720
    ds_read_b128 v[36:39], v6 offset:35840
    ds_read_b128 v[40:43], v6 offset:40960
    ds_read_b128 v[16:19], v4 offset:32768
    v_mfma_f32_16x16x32_bf16 v[56:59], v[196:199], v[20:23], v[56:59]
    v_mfma_f32_16x16x32_bf16 v[60:63], v[200:203], v[20:23], v[60:63]
    v_mfma_f32_16x16x32_bf16 v[64:67], v[204:207], v[20:23], v[64:67]
    s_waitcnt lgkmcnt(3)
    v_add_f32 v76, v76, v32
    v_add_f32 v77, v77, v33
    v_mfma_f32_16x16x32_bf16 v[68:71], v[208:211], v[20:23], v[68:71]
    v_add_f32 v78, v78, v34
    v_add_f32 v79, v79, v35
    v_mfma_f32_16x16x32_bf16 v[72:75], v[212:215], v[20:23], v[72:75]
    s_waitcnt lgkmcnt(2)
    ds_read_b128 v[32:35], v5 offset:30720
    ds_read_b128 v[20:23], v4 offset:33792
    v_add_f32 v76, v76, v36
    v_add_f32 v77, v77, v37
    v_mfma_f32_16x16x32_bf16 v[72:75], v[232:235], v[24:27], v[72:75]
    v_add_f32 v78, v78, v38
    v_add_f32 v79, v79, v39
    v_mfma_f32_16x16x32_bf16 v[68:71], v[228:231], v[24:27], v[68:71]
    s_waitcnt lgkmcnt(3)
    ds_read_b128 v[36:39], v5 offset:35840
    v_add_f32 v76, v76, v40
    v_add_f32 v77, v77, v41
    v_mfma_f32_16x16x32_bf16 v[64:67], v[224:227], v[24:27], v[64:67]
    v_add_f32 v78, v78, v42
    v_add_f32 v79, v79, v43
    v_mfma_f32_16x16x32_bf16 v[60:63], v[220:223], v[24:27], v[60:63]
    ds_read_b128 v[40:43], v5 offset:40960
    s_waitcnt lgkmcnt(3)
    v_add_f32 v92, v92, v32
    v_add_f32 v93, v93, v33
    s_add_u32 s6, s98, 10240
    v_mfma_f32_16x16x32_bf16 v[56:59], v[216:219], v[24:27], v[56:59]
    ds_read_b128 v[24:27], v4 offset:34816
    v_add_f32 v94, v94, v34
    v_add_f32 v95, v95, v35
    v_mfma_f32_16x16x32_bf16 v[56:59], v[236:239], v[28:31], v[56:59]
    buffer_store_dwordx4 v[76:79], v44, s[8:11], s6 offen sc1
    s_waitcnt lgkmcnt(2)
    v_add_f32 v92, v92, v36
    v_add_f32 v93, v93, v37
    v_mfma_f32_16x16x32_bf16 v[60:63], v[240:243], v[28:31], v[60:63]
    v_add_f32 v94, v94, v38
    v_add_f32 v95, v95, v39
    v_mfma_f32_16x16x32_bf16 v[64:67], v[244:247], v[28:31], v[64:67]
    s_waitcnt lgkmcnt(1)
    v_add_f32 v92, v92, v40
    v_add_f32 v93, v93, v41
    v_mfma_f32_16x16x32_bf16 v[68:71], v[248:251], v[28:31], v[68:71]
    v_add_f32 v94, v94, v42
    v_add_f32 v95, v95, v43
    s_cmp_lg_u32 s71, 1
    v_mfma_f32_16x16x32_bf16 v[72:75], v[252:255], v[28:31], v[72:75]
    s_cbranch_scc1 L_nost_63
    buffer_store_dwordx4 v[92:95], v52, s[8:11], s6 offen sc1
L_nost_63:
    ds_read_b128 v[28:31], v4 offset:35840
    v_mfma_f32_16x16x32_bf16 v[76:79], v[96:99], v[16:19], 0
    v_mfma_f32_16x16x32_bf16 v[80:83], v[100:103], v[16:19], 0
    v_mfma_f32_16x16x32_bf16 v[84:87], v[104:107], v[16:19], 0
    s_mul_i32 s73, s3, 5120
    s_add_u32 s6, s73, 65536
    v_mfma_f32_16x16x32_bf16 v[88:91], v[108:111], v[16:19], 0
    v_add_u32 v5, s6, v44
    v_mfma_f32_16x16x32_bf16 v[92:95], v[112:115], v[16:19], 0
    ds_read_b128 v[16:19], v4 offset:36864
    v_mfma_f32_16x16x32_bf16 v[76:79], v[116:119], v[20:23], v[76:79]
    ds_write_b128 v5, v[56:59]
    s_add_u32 s6, s73, 65536
    v_add_u32 v5, s6, v45
    v_mfma_f32_16x16x32_bf16 v[80:83], v[120:123], v[20:23], v[80:83]
    v_mfma_f32_16x16x32_bf16 v[84:87], v[124:127], v[20:23], v[84:87]
    v_mfma_f32_16x16x32_bf16 v[88:91], v[128:131], v[20:23], v[88:91]
    s_waitcnt lgkmcnt(3)
    v_mfma_f32_16x16x32_bf16 v[92:95], v[132:135], v[20:23], v[92:95]
    ds_read_b128 v[20:23], v4 offset:37888
    v_mfma_f32_16x16x32_bf16 v[92:95], v[152:155], v[24:27], v[92:95]
    ds_write_b128 v5, v[60:63]
    s_add_u32 s6, s73, 65536
    v_add_u32 v5, s6, v46
    v_mfma_f32_16x16x32_bf16 v[88:91], v[148:151], v[24:27], v[88:91]
    v_mfma_f32_16x16x32_bf16 v[84:87], v[144:147], v[24:27], v[84:87]
    v_mov_b32 v2, 2
    s_waitcnt vmcnt(0)
    buffer_store_dword v2, v11, s[8:11], 0 offen sc1
    v_mfma_f32_16x16x32_bf16 v[80:83], v[140:143], v[24:27], v[80:83]
    s_waitcnt lgkmcnt(4)
    v_mfma_f32_16x16x32_bf16 v[76:79], v[136:139], v[24:27], v[76:79]
    ds_read_b128 v[24:27], v4 offset:38912
    s_cmp_eq_u32 s64, 0
    s_cbranch_scc1 L_nb
    v_bfe_u32 v2, v1, 1, 3
    v_and_b32 v3, 1, v1
    v_lshl_add_u32 v3, v2, 7, v3
    v_lshlrev_b32 v3, 2, v3
    s_and_b32 s6, s4, 3
    s_lshl_b32 s6, s6, 7
    s_add_u32 s6, s6, 3907584
    s_mov_b32 s79, 262144
L_poll_64:
    buffer_load_dword v2, v3, s[8:11], s6 offen sc1
    s_waitcnt vmcnt(0)
    v_cmp_ne_u32 vcc, 1, v2
    s_cbranch_vccz L_polldone_65
    s_sleep 2
    s_sub_u32 s79, s79, 1
    s_cmp_lg_u32 s79, 0
    s_cbranch_scc1 L_poll_64
L_polldone_65:
L_nb:
    buffer_load_dwordx4 v[96:99], v53, s[12:15], s70 offen
    buffer_load_dwordx4 v[100:103], v48, s[8:11], 0 offen sc1
    s_cmp_ge_u32 s3, 2
    s_cbranch_scc1 L_itskip_66
    buffer_load_dwordx4 v[104:107], v54, s[12:15], s70 offen
    buffer_load_dwordx4 v[108:111], v49, s[8:11], 0 offen sc1
L_itskip_66:
    v_mfma_f32_16x16x32_bf16 v[76:79], v[156:159], v[28:31], v[76:79]
    ds_write_b128 v5, v[64:67]
    s_add_u32 s6, s73, 65536
    v_add_u32 v5, s6, v47
    v_mfma_f32_16x16x32_bf16 v[80:83], v[160:163], v[28:31], v[80:83]
    v_mfma_f32_16x16x32_bf16 v[84:87], v[164:167], v[28:31], v[84:87]
    v_mfma_f32_16x16x32_bf16 v[88:91], v[168:171], v[28:31], v[88:91]
    s_waitcnt lgkmcnt(5)
    v_mfma_f32_16x16x32_bf16 v[92:95], v[172:175], v[28:31], v[92:95]
    ds_read_b128 v[28:31], v4 offset:39936
    v_mfma_f32_16x16x32_bf16 v[92:95], v[192:195], v[16:19], v[92:95]
    ds_write_b128 v5, v[68:71]
    s_add_u32 s6, s73, 65536
    v_add_u32 v5, s6, v52
    v_mfma_f32_16x16x32_bf16 v[88:91], v[188:191], v[16:19], v[88:91]
    v_bfe_u32 v2, v1, 3, 2
    v_min_u32 v2, 2, v2
    v_and_b32 v3, 7, v1
    v_lshlrev_b32 v3, 2, v3
    v_lshl_add_u32 v3, v2, 7, v3
    v_mfma_f32_16x16x32_bf16 v[84:87], v[184:187], v[16:19], v[84:87]
    s_bitcmp1_b32 13, s3
    s_cselect_b32 s77, 1, 2
    buffer_load_dword v50, v3, s[8:11], s63 offen sc1
    v_mfma_f32_16x16x32_bf16 v[80:83], v[180:183], v[16:19], v[80:83]
    s_waitcnt lgkmcnt(5)
    v_mfma_f32_16x16x32_bf16 v[76:79], v[176:179], v[16:19], v[76:79]
    v_mfma_f32_16x16x32_bf16 v[76:79], v[196:199], v[20:23], v[76:79]
    ds_write_b128 v5, v[72:75]
    v_mfma_f32_16x16x32_bf16 v[80:83], v[200:203], v[20:23], v[80:83]
    v_mfma_f32_16x16x32_bf16 v[84:87], v[204:207], v[20:23], v[84:87]
    v_mfma_f32_16x16x32_bf16 v[88:91], v[208:211], v[20:23], v[88:91]
    s_waitcnt lgkmcnt(4)
    v_mfma_f32_16x16x32_bf16 v[92:95], v[212:215], v[20:23], v[92:95]
    v_mfma_f32_16x16x32_bf16 v[92:95], v[232:235], v[24:27], v[92:95]
    v_mfma_f32_16x16x32_bf16 v[88:91], v[228:231], v[24:27], v[88:91]
    v_mfma_f32_16x16x32_bf16 v[84:87], v[224:227], v[24:27], v[84:87]
    v_mfma_f32_16x16x32_bf16 v[80:83], v[220:223], v[24:27], v[80:83]
    s_waitcnt lgkmcnt(2)
    s_add_u32 s6, s73, 86016
    s_cmp_lt_u32 s3, 4
    s_cselect_b32 s73, s73, s6
    v_mfma_f32_16x16x32_bf16 v[76:79], v[216:219], v[24:27], v[76:79]
    s_waitcnt vmcnt(0)
    v_cmp_gt_u32 vcc, s77, v50
    s_mov_b32 s91, 0
    s_cbranch_vccnz L_x1n
    s_add_u32 s6, s62, 0
    buffer_load_dwordx4 v[112:115], v8, s[8:11], s6 offen offset:0 sc1
    buffer_load_dwordx4 v[116:119], v8, s[8:11], s6 offen offset:256 sc1
    s_add_u32 s6, s62, 20480
    buffer_load_dwordx4 v[120:123], v8, s[8:11], s6 offen offset:0 sc1
    buffer_load_dwordx4 v[124:127], v8, s[8:11], s6 offen offset:256 sc1
    s_add_u32 s6, s62, 40960
    buffer_load_dwordx4 v[128:131], v8, s[8:11], s6 offen offset:0 sc1
    buffer_load_dwordx4 v[132:135], v8, s[8:11], s6 offen offset:256 sc1
    s_cmp_ge_u32 s3, 2
    s_cbranch_scc1 L_xi_67
    s_add_u32 s6, s62, 0
    buffer_load_dwordx4 v[136:139], v9, s[8:11], s6 offen offset:0 sc1
    buffer_load_dwordx4 v[140:143], v9, s[8:11], s6 offen offset:256 sc1
    s_add_u32 s6, s62, 20480
    buffer_load_dwordx4 v[144:147], v9, s[8:11], s6 offen offset:0 sc1
    buffer_load_dwordx4 v[148:151], v9, s[8:11], s6 offen offset:256 sc1
    s_add_u32 s6, s62, 40960
    buffer_load_dwordx4 v[152:155], v9, s[8:11], s6 offen offset:0 sc1
    buffer_load_dwordx4 v[156:159], v9, s[8:11], s6 offen offset:256 sc1
L_xi_67:
    s_mov_b32 s91, 1
    s_branch L_x1j
L_x1n:
    buffer_load_dword v50, v3, s[8:11], s63 offen sc1
L_x1j:
    v_mfma_f32_16x16x32_bf16 v[76:79], v[236:239], v[28:31], v[76:79]
    v_mfma_f32_16x16x32_bf16 v[80:83], v[240:243], v[28:31], v[80:83]
    v_mfma_f32_16x16x32_bf16 v[84:87], v[244:247], v[28:31], v[84:87]
    v_mfma_f32_16x16x32_bf16 v[88:91], v[248:251], v[28:31], v[88:91]
    v_mfma_f32_16x16x32_bf16 v[92:95], v[252:255], v[28:31], v[92:95]
    s_nop 4
    v_add_u32 v5, s73, v44
    ds_write_b128 v5, v[76:79]
    v_add_u32 v5, s73, v45
    ds_write_b128 v5, v[80:83]
    v_add_u32 v5, s73, v46
    ds_write_b128 v5, v[84:87]
    v_add_u32 v5, s73, v47
    ds_write_b128 v5, v[88:91]
    v_add_u32 v5, s73, v52
    ds_write_b128 v5, v[92:95]
    s_mov_b64 s[78:79], 0
    s_cmp_lg_u32 s91, 0
    s_cbranch_scc1 L_x2a
    s_waitcnt vmcnt(0)
    v_cmp_gt_u32 s[78:79], s77, v50
    s_nop 3
    s_cmp_lg_u64 s[78:79], 0
    s_cbranch_scc1 L_x2a
    s_add_u32 s6, s62, 0
    buffer_load_dwordx4 v[112:115], v8, s[8:11], s6 offen offset:0 sc1
    buffer_load_dwordx4 v[116:119], v8, s[8:11], s6 offen offset:256 sc1
    s_add_u32 s6, s62, 20480
    buffer_load_dwordx4 v[120:123], v8, s[8:11], s6 offen offset:0 sc1
    buffer_load_dwordx4 v[124:127], v8, s[8:11], s6 offen offset:256 sc1
    s_add_u32 s6, s62, 40960
    buffer_load_dwordx4 v[128:131], v8, s[8:11], s6 offen offset:0 sc1
    buffer_load_dwordx4 v[132:135], v8, s[8:11], s6 offen offset:256 sc1
    s_cmp_ge_u32 s3, 2
    s_cbranch_scc1 L_xi_68
    s_add_u32 s6, s62, 0
    buffer_load_dwordx4 v[136:139], v9, s[8:11], s6 offen offset:0 sc1
    buffer_load_dwordx4 v[140:143], v9, s[8:11], s6 offen offset:256 sc1
    s_add_u32 s6, s62, 20480
    buffer_load_dwordx4 v[144:147], v9, s[8:11], s6 offen offset:0 sc1
    buffer_load_dwordx4 v[148:151], v9, s[8:11], s6 offen offset:256 sc1
    s_add_u32 s6, s62, 40960
    buffer_load_dwordx4 v[152:155], v9, s[8:11], s6 offen offset:0 sc1
    buffer_load_dwordx4 v[156:159], v9, s[8:11], s6 offen offset:256 sc1
L_xi_68:
L_x2a:
    s_waitcnt lgkmcnt(0)
    s_barrier
    ds_read_b128 v[160:163], v10 offset:0
    ds_read_b128 v[164:167], v10 offset:256
    ds_read_b128 v[168:171], v10 offset:5120
    ds_read_b128 v[172:175], v10 offset:5376
    ds_read_b128 v[176:179], v10 offset:10240
    ds_read_b128 v[180:183], v10 offset:10496
    ds_read_b128 v[184:187], v10 offset:15360
    ds_read_b128 v[188:191], v10 offset:15616
    ds_read_b128 v[192:195], v55 offset:0
    ds_read_b128 v[196:199], v55 offset:256
    ds_read_b128 v[200:203], v55 offset:5120
    ds_read_b128 v[204:207], v55 offset:5376
    ds_read_b128 v[208:211], v55 offset:10240
    ds_read_b128 v[212:215], v55 offset:10496
    ds_read_b128 v[216:219], v55 offset:15360
    ds_read_b128 v[220:223], v55 offset:15616
    s_cmp_eq_u64 s[78:79], 0
    s_cbranch_scc1 L_x2b
    s_mov_b32 s79, 262144
L_poll_69:
    buffer_load_dword v2, v3, s[8:11], s63 offen sc1
    s_waitcnt vmcnt(0)
    v_cmp_gt_u32 vcc, s77, v2
    s_cbranch_vccz L_polldone_70
    s_sleep 1
    s_sub_u32 s79, s79, 1
    s_cmp_lg_u32 s79, 0
    s_cbranch_scc1 L_poll_69
L_polldone_70:
    s_add_u32 s6, s62, 0
    buffer_load_dwordx4 v[112:115], v8, s[8:11], s6 offen offset:0 sc1
    buffer_load_dwordx4 v[116:119], v8, s[8:11], s6 offen offset:256 sc1
    s_add_u32 s6, s62, 20480
    buffer_load_dwordx4 v[120:123], v8, s[8:11], s6 offen offset:0 sc1
    buffer_load_dwordx4 v[124:127], v8, s[8:11], s6 offen offset:256 sc1
    s_add_u32 s6, s62, 40960
    buffer_load_dwordx4 v[128:131], v8, s[8:11], s6 offen offset:0 sc1
    buffer_load_dwordx4 v[132:135], v8, s[8:11], s6 offen offset:256 sc1
    s_cmp_ge_u32 s3, 2
    s_cbranch_scc1 L_xi_71
    s_add_u32 s6, s62, 0
    buffer_load_dwordx4 v[136:139], v9, s[8:11], s6 offen offset:0 sc1
    buffer_load_dwordx4 v[140:143], v9, s[8:11], s6 offen offset:256 sc1
    s_add_u32 s6, s62, 20480
    buffer_load_dwordx4 v[144:147], v9, s[8:11], s6 offen offset:0 sc1
    buffer_load_dwordx4 v[148:151], v9, s[8:11], s6 offen offset:256 sc1
    s_add_u32 s6, s62, 40960
    buffer_load_dwordx4 v[152:155], v9, s[8:11], s6 offen offset:0 sc1
    buffer_load_dwordx4 v[156:159], v9, s[8:11], s6 offen offset:256 sc1
L_xi_71:
L_x2b:
    s_mov_b32 s16, s54
    s_mov_b32 s17, s55
    s_mov_b32 s18, 0x280000
    s_mov_b32 s19, 0x20000
    s_waitcnt lgkmcnt(8)
    v_pk_add_f32 v[160:161], v[160:161], v[168:169]
    v_pk_add_f32 v[162:163], v[162:163], v[170:171]
    v_pk_add_f32 v[164:165], v[164:165], v[172:173]
    v_pk_add_f32 v[166:167], v[166:167], v[174:175]
    v_pk_add_f32 v[160:161], v[160:161], v[176:177]
    v_pk_add_f32 v[162:163], v[162:163], v[178:179]
    v_pk_add_f32 v[164:165], v[164:165], v[180:181]
    v_pk_add_f32 v[166:167], v[166:167], v[182:183]
    v_pk_add_f32 v[160:161], v[160:161], v[184:185]
    v_pk_add_f32 v[162:163], v[162:163], v[186:187]
    v_pk_add_f32 v[164:165], v[164:165], v[188:189]
    v_pk_add_f32 v[166:167], v[166:167], v[190:191]
    s_waitcnt vmcnt(0)
    v_pk_add_f32 v[160:161], v[160:161], v[112:113]
    v_pk_add_f32 v[162:163], v[162:163], v[114:115]
    v_pk_add_f32 v[164:165], v[164:165], v[116:117]
    v_pk_add_f32 v[166:167], v[166:167], v[118:119]
    v_pk_add_f32 v[160:161], v[160:161], v[120:121]
    v_pk_add_f32 v[162:163], v[162:163], v[122:123]
    v_pk_add_f32 v[164:165], v[164:165], v[124:125]
    v_pk_add_f32 v[166:167], v[166:167], v[126:127]
    v_pk_add_f32 v[160:161], v[160:161], v[128:129]
    v_pk_add_f32 v[162:163], v[162:163], v[130:131]
    v_pk_add_f32 v[164:165], v[164:165], v[132:133]
    v_pk_add_f32 v[166:167], v[166:167], v[134:135]
    v_cvt_pk_bf16_f32 v2, v160, v161
    v_lshlrev_b32 v160, 16, v2
    v_and_b32 v161, 0xffff0000, v2
    v_lshlrev_b32 v2, 16, v96
    v_and_b32 v3, 0xffff0000, v96
    v_pk_add_f32 v[160:161], v[160:161], v[2:3]
    v_cvt_pk_bf16_f32 v2, v160, v161
    v_lshlrev_b32 v160, 16, v2
    v_and_b32 v161, 0xffff0000, v2
    v_lshlrev_b32 v2, 16, v100
    v_and_b32 v3, 0xffff0000, v100
    v_pk_add_f32 v[160:161], v[160:161], v[2:3]
    v_cvt_pk_bf16_f32 v224, v160, v161
    v_cvt_pk_bf16_f32 v2, v162, v163
    v_lshlrev_b32 v162, 16, v2
    v_and_b32 v163, 0xffff0000, v2
    v_lshlrev_b32 v2, 16, v97
    v_and_b32 v3, 0xffff0000, v97
    v_pk_add_f32 v[162:163], v[162:163], v[2:3]
    v_cvt_pk_bf16_f32 v2, v162, v163
    v_lshlrev_b32 v162, 16, v2
    v_and_b32 v163, 0xffff0000, v2
    v_lshlrev_b32 v2, 16, v101
    v_and_b32 v3, 0xffff0000, v101
    v_pk_add_f32 v[162:163], v[162:163], v[2:3]
    v_cvt_pk_bf16_f32 v225, v162, v163
    v_cvt_pk_bf16_f32 v2, v164, v165
    v_lshlrev_b32 v164, 16, v2
    v_and_b32 v165, 0xffff0000, v2
    v_lshlrev_b32 v2, 16, v98
    v_and_b32 v3, 0xffff0000, v98
    v_pk_add_f32 v[164:165], v[164:165], v[2:3]
    v_cvt_pk_bf16_f32 v2, v164, v165
    v_lshlrev_b32 v164, 16, v2
    v_and_b32 v165, 0xffff0000, v2
    v_lshlrev_b32 v2, 16, v102
    v_and_b32 v3, 0xffff0000, v102
    v_pk_add_f32 v[164:165], v[164:165], v[2:3]
    v_cvt_pk_bf16_f32 v226, v164, v165
    v_cvt_pk_bf16_f32 v2, v166, v167
    v_lshlrev_b32 v166, 16, v2
    v_and_b32 v167, 0xffff0000, v2
    v_lshlrev_b32 v2, 16, v99
    v_and_b32 v3, 0xffff0000, v99
    v_pk_add_f32 v[166:167], v[166:167], v[2:3]
    v_cvt_pk_bf16_f32 v2, v166, v167
    v_lshlrev_b32 v166, 16, v2
    v_and_b32 v167, 0xffff0000, v2
    v_lshlrev_b32 v2, 16, v103
    v_and_b32 v3, 0xffff0000, v103
    v_pk_add_f32 v[166:167], v[166:167], v[2:3]
    v_cvt_pk_bf16_f32 v227, v166, v167
    buffer_store_dwordx4 v[224:227], v53, s[16:19], s70 offen
    s_cmp_ge_u32 s3, 2
    s_cbranch_scc1 L_end
    s_waitcnt lgkmcnt(0)
    v_pk_add_f32 v[192:193], v[192:193], v[200:201]
    v_pk_add_f32 v[194:195], v[194:195], v[202:203]
    v_pk_add_f32 v[196:197], v[196:197], v[204:205]
    v_pk_add_f32 v[198:199], v[198:199], v[206:207]
    v_pk_add_f32 v[192:193], v[192:193], v[208:209]
    v_pk_add_f32 v[194:195], v[194:195], v[210:211]
    v_pk_add_f32 v[196:197], v[196:197], v[212:213]
    v_pk_add_f32 v[198:199], v[198:199], v[214:215]
    v_pk_add_f32 v[192:193], v[192:193], v[216:217]
    v_pk_add_f32 v[194:195], v[194:195], v[218:219]
    v_pk_add_f32 v[196:197], v[196:197], v[220:221]
    v_pk_add_f32 v[198:199], v[198:199], v[222:223]
    s_nop 0
    v_pk_add_f32 v[192:193], v[192:193], v[136:137]
    v_pk_add_f32 v[194:195], v[194:195], v[138:139]
    v_pk_add_f32 v[196:197], v[196:197], v[140:141]
    v_pk_add_f32 v[198:199], v[198:199], v[142:143]
    v_pk_add_f32 v[192:193], v[192:193], v[144:145]
    v_pk_add_f32 v[194:195], v[194:195], v[146:147]
    v_pk_add_f32 v[196:197], v[196:197], v[148:149]
    v_pk_add_f32 v[198:199], v[198:199], v[150:151]
    v_pk_add_f32 v[192:193], v[192:193], v[152:153]
    v_pk_add_f32 v[194:195], v[194:195], v[154:155]
    v_pk_add_f32 v[196:197], v[196:197], v[156:157]
    v_pk_add_f32 v[198:199], v[198:199], v[158:159]
    v_cvt_pk_bf16_f32 v2, v192, v193
    v_lshlrev_b32 v192, 16, v2
    v_and_b32 v193, 0xffff0000, v2
    v_lshlrev_b32 v2, 16, v104
    v_and_b32 v3, 0xffff0000, v104
    v_pk_add_f32 v[192:193], v[192:193], v[2:3]
    v_cvt_pk_bf16_f32 v2, v192, v193
    v_lshlrev_b32 v192, 16, v2
    v_and_b32 v193, 0xffff0000, v2
    v_lshlrev_b32 v2, 16, v108
    v_and_b32 v3, 0xffff0000, v108
    v_pk_add_f32 v[192:193], v[192:193], v[2:3]
    v_cvt_pk_bf16_f32 v228, v192, v193
    v_cvt_pk_bf16_f32 v2, v194, v195
    v_lshlrev_b32 v194, 16, v2
    v_and_b32 v195, 0xffff0000, v2
    v_lshlrev_b32 v2, 16, v105
    v_and_b32 v3, 0xffff0000, v105
    v_pk_add_f32 v[194:195], v[194:195], v[2:3]
    v_cvt_pk_bf16_f32 v2, v194, v195
    v_lshlrev_b32 v194, 16, v2
    v_and_b32 v195, 0xffff0000, v2
    v_lshlrev_b32 v2, 16, v109
    v_and_b32 v3, 0xffff0000, v109
    v_pk_add_f32 v[194:195], v[194:195], v[2:3]
    v_cvt_pk_bf16_f32 v229, v194, v195
    v_cvt_pk_bf16_f32 v2, v196, v197
    v_lshlrev_b32 v196, 16, v2
    v_and_b32 v197, 0xffff0000, v2
    v_lshlrev_b32 v2, 16, v106
    v_and_b32 v3, 0xffff0000, v106
    v_pk_add_f32 v[196:197], v[196:197], v[2:3]
    v_cvt_pk_bf16_f32 v2, v196, v197
    v_lshlrev_b32 v196, 16, v2
    v_and_b32 v197, 0xffff0000, v2
    v_lshlrev_b32 v2, 16, v110
    v_and_b32 v3, 0xffff0000, v110
    v_pk_add_f32 v[196:197], v[196:197], v[2:3]
    v_cvt_pk_bf16_f32 v230, v196, v197
    v_cvt_pk_bf16_f32 v2, v198, v199
    v_lshlrev_b32 v198, 16, v2
    v_and_b32 v199, 0xffff0000, v2
    v_lshlrev_b32 v2, 16, v107
    v_and_b32 v3, 0xffff0000, v107
    v_pk_add_f32 v[198:199], v[198:199], v[2:3]
    v_cvt_pk_bf16_f32 v2, v198, v199
    v_lshlrev_b32 v198, 16, v2
    v_and_b32 v199, 0xffff0000, v2
    v_lshlrev_b32 v2, 16, v111
    v_and_b32 v3, 0xffff0000, v111
    v_pk_add_f32 v[198:199], v[198:199], v[2:3]
    v_cvt_pk_bf16_f32 v231, v198, v199
    buffer_store_dwordx4 v[228:231], v54, s[16:19], s70 offen
L_end:
L_exit:
    s_endpgm
.section .rodata,"a"
.p2align 6
.amdhsa_kernel parallel_sum__compressed_kv_cla__moe_arch_mod__prompt_kernel
  .amdhsa_next_free_vgpr 256
  .amdhsa_next_free_sgpr 102
  .amdhsa_accum_offset 256
  .amdhsa_group_segment_fixed_size 0
  .amdhsa_kernarg_size 112
  .amdhsa_user_sgpr_count 2
  .amdhsa_user_sgpr_kernarg_segment_ptr 1
  .amdhsa_system_sgpr_workgroup_id_x 1
  .amdhsa_float_denorm_mode_32 3
.end_amdhsa_kernel
```

```asm
; @launch grid=(256,1,1) block=(512,1,1) lds=163840
.amdgcn_target "amdgcn-amd-amdhsa--gfx950"
.text
.globl parallel_sum__compressed_kv_cla__moe_arch_mod__prompt_kernel
.p2align 8
.type parallel_sum__compressed_kv_cla__moe_arch_mod__prompt_kernel,@function
parallel_sum__compressed_kv_cla__moe_arch_mod__prompt_kernel:
    s_cmp_ge_u32 s2, 256
    s_cbranch_scc1 L_exit
    s_load_dwordx16 s[32:47], s[0:1], 0
    s_load_dwordx8 s[48:55], s[0:1], 64
    s_load_dwordx4 s[56:59], s[0:1], 96
    v_lshrrev_b32 v2, 6, v0
    v_and_b32 v1, 63, v0
    v_readfirstlane_b32 s3, v2
    s_getpc_b64 s[80:81]
L_pc:
    s_lshr_b32 s6, s2, 3
    s_and_b32 s6, s6, 15
    s_lshl_b32 s6, s6, 12
    s_cmp_lt_u32 s3, 2
    s_cselect_b32 s6, 0, s6
    v_lshl_add_u32 v3, v0, 6, s6
    v_min_u32 v3, L_exit-L_pc, v3
    s_cmp_ge_u32 s3, 3
    s_cbranch_scc1 L_noct
    global_load_dword v11, v3, s[80:81]
L_noct:
    v_lshrrev_b32 v62, 5, v0
    v_and_b32 v62, 7, v62
    v_and_b32 v2, 31, v0
    v_lshlrev_b32 v2, 3, v2
    v_mul_u32_u24 v63, 1280, v62
    v_add_u32 v63, v63, v2
    s_mul_i32 s6, s2, 10240
    v_add_u32 v10, s6, v63
    s_cmp_lt_u32 s3, 4
    s_cbranch_scc1 L_st_k0
    s_waitcnt lgkmcnt(0)
    global_load_dwordx2 v[16:17], v10, s[32:33] offset:0
    global_load_dwordx2 v[18:19], v10, s[32:33] offset:256
    global_load_dwordx2 v[20:21], v10, s[32:33] offset:512
    global_load_dwordx2 v[22:23], v10, s[32:33] offset:768
    global_load_dwordx2 v[24:25], v10, s[32:33] offset:1024
    global_load_dwordx2 v[26:27], v2, s[46:47] offset:0
    global_load_dwordx2 v[28:29], v2, s[46:47] offset:256
    global_load_dwordx2 v[30:31], v2, s[46:47] offset:512
    global_load_dwordx2 v[32:33], v2, s[46:47] offset:768
    global_load_dwordx2 v[34:35], v2, s[46:47] offset:1024
    s_bfe_u32 s6, s2, 0x20003
    s_lshl_b32 s6, s6, 9
    s_bfe_u32 s7, s3, 0x10001
    s_lshl_b32 s7, s7, 8
    s_add_u32 s6, s6, s7
    s_andn2_b32 s7, s2, 31
    s_add_u32 s6, s6, s7
    s_and_b32 s72, s3, 1
    s_lshl_b32 s7, s72, 4
    s_add_u32 s6, s6, s7
    v_lshrrev_b32 v4, 3, v1
    v_add_u32 v4, s6, v4
    v_and_b32 v5, 7, v1
    v_lshlrev_b32 v5, 4, v5
    v_lshl_add_u32 v4, v4, 10, v5
    v_add_u32 v5, 8192, v4
    s_lshr_b32 s6, s2, 5
    s_lshl_b32 s6, s6, 1
    s_add_u32 s6, s6, s72
    s_lshl_b32 s6, s6, 15
    s_and_b32 s7, s2, 7
    s_lshl_b32 s7, s7, 10
    s_add_u32 s6, s6, s7
    s_bfe_u32 s7, s2, 0x20003
    s_lshl_b32 s7, s7, 8
    s_add_u32 s6, s6, s7
    v_lshrrev_b32 v6, 4, v1
    v_and_b32 v7, 15, v1
    v_lshlrev_b32 v7, 4, v7
    v_lshl_add_u32 v6, v6, 13, v7
    v_add_u32 v6, s6, v6
    s_cmp_ge_u32 s3, 6
    s_cselect_b32 s74, s40, s38
    s_cselect_b32 s75, s41, s39
    global_load_dwordx4 v[36:39], v4, s[34:35] offset:0
    global_load_dwordx4 v[36:39], v5, s[34:35] offset:0
    global_load_dwordx4 v[36:39], v6, s[74:75] nt
    v_add_u32 v6, 524288, v6
    global_load_dwordx4 v[36:39], v4, s[34:35] offset:128
    global_load_dwordx4 v[36:39], v5, s[34:35] offset:128
    global_load_dwordx4 v[36:39], v6, s[74:75] nt
    v_add_u32 v6, 524288, v6
    s_barrier
L_st_k0:
    s_and_b32 s6, s2, 7
    s_lshl_b32 s6, s6, 2
    s_lshr_b32 s7, s2, 3
    s_and_b32 s7, s7, 3
    s_add_u32 s4, s6, s7
    s_lshr_b32 s5, s2, 5
    s_and_b32 s76, s3, 3
    v_lshrrev_b32 v2, 3, v1
    v_and_b32 v3, 7, v1
    v_lshrrev_b32 v4, 4, v1
    v_xor_b32 v5, v3, v4
    v_lshlrev_b32 v5, 4, v5
    v_lshl_add_u32 v40, v2, 10, v5
    v_xor_b32 v5, 64, v40
    v_add_u32 v41, 7168, v5
    v_add_u32 v42, 14336, v40
    v_add_u32 v43, 14336, v41
    v_and_b32 v6, 15, v1
    s_lshl_b32 s6, s76, 4
    v_add_u32 v7, s6, v4
    v_lshlrev_b32 v5, 1, v4
    v_xor_b32 v5, v6, v5
    v_lshlrev_b32 v5, 4, v5
    v_lshl_add_u32 v44, v7, 13, v5
    v_add_u32 v45, 31744, v44
    v_xor_b32 v5, 0x80, v44
    v_add_u32 v46, 63488, v5
    v_add_u32 v47, 31744, v46
    s_and_b32 s6, s76, 1
    s_lshl_b32 s6, s6, 20
    s_lshr_b32 s7, s76, 1
    s_lshl_b32 s7, s7, 18
    s_add_u32 s6, s6, s7
    s_lshl_b32 s62, s5, 15
    s_add_u32 s62, s62, s6
    s_lshl_b32 s63, s4, 8
    s_lshl_b32 s64, s76, 13
    s_lshl_b32 s73, s76, 12
    s_add_u32 s73, s73, 32768
    s_andn2_b32 s100, 1, s5
    s_lshl_b32 s100, s100, 16
    s_add_u32 s64, s64, s100
    s_add_u32 s73, s73, s100
    s_waitcnt lgkmcnt(0)
    s_mov_b32 s12, s34
    s_mov_b32 s13, s35
    s_mov_b32 s14, 0x200000
    s_mov_b32 s15, 0x20000
    s_mov_b32 s16, s38
    s_mov_b32 s17, s39
    s_mov_b32 s18, 0x400000
    s_mov_b32 s19, 0x20000
    s_mov_b32 s20, s40
    s_mov_b32 s21, s41
    s_mov_b32 s22, 0x400000
    s_mov_b32 s23, 0x20000
    s_cmp_ge_u32 s3, 4
    s_cbranch_scc1 L_st_v0
    s_barrier
    s_mov_b32 m0, s64
    s_add_u32 s72, s62, 524288
    buffer_load_dwordx4 v40, s[12:15], s62 offen offset:0 lds
    buffer_load_dwordx4 v41, s[12:15], s62 offen offset:1024 lds
    buffer_load_dwordx4 v42, s[12:15], s62 offen offset:2048 lds
    buffer_load_dwordx4 v43, s[12:15], s62 offen offset:3072 lds
    s_add_u32 m0, s64, 4096
    s_add_u32 s62, s62, 128
    s_bitset0_b32 s62, 10
    buffer_load_dwordx4 v40, s[12:15], s72 offen offset:0 lds
    buffer_load_dwordx4 v41, s[12:15], s72 offen offset:1024 lds
    buffer_load_dwordx4 v42, s[12:15], s72 offen offset:2048 lds
    buffer_load_dwordx4 v43, s[12:15], s72 offen offset:3072 lds
    s_mov_b32 m0, s73
    s_xor_b32 s64, s64, 0x10000
    buffer_load_dwordx4 v44, s[16:19], s63 offen offset:0 nt lds
    buffer_load_dwordx4 v45, s[16:19], s63 offen offset:1024 nt lds
    buffer_load_dwordx4 v46, s[16:19], s63 offen offset:2048 nt lds
    buffer_load_dwordx4 v47, s[16:19], s63 offen offset:3072 nt lds
    s_add_u32 m0, s73, 16384
    s_xor_b32 s73, s73, 0x10000
    buffer_load_dwordx4 v44, s[20:23], s63 offen offset:0 nt lds
    buffer_load_dwordx4 v45, s[20:23], s63 offen offset:1024 nt lds
    buffer_load_dwordx4 v46, s[20:23], s63 offen offset:2048 nt lds
    buffer_load_dwordx4 v47, s[20:23], s63 offen offset:3072 nt lds
    s_add_u32 s63, s63, 524288
    s_bitset0_b32 s63, 22
    s_setprio 1
L_st_v0:
    s_mov_b32 s8, s58
    s_mov_b32 s9, s59
    s_mov_b32 s10, 0x5000000
    s_mov_b32 s11, 0x20000
    s_mov_b32 s24, s36
    s_mov_b32 s25, s37
    s_mov_b32 s26, 0x500000
    s_mov_b32 s27, 0x20000
    v_lshlrev_b32 v13, 4, v1
    s_lshl_b32 s6, s5, 2
    s_add_u32 s7, s6, s3
    s_sub_u32 s6, 56, s6
    s_add_u32 s6, s6, s3
    s_cmp_lt_u32 s3, 4
    s_cselect_b32 s60, s7, s6
    s_sub_u32 s6, 1, s5
    s_and_b32 s6, s6, 7
    s_lshl_b32 s6, s6, 5
    s_add_u32 s61, s6, s4
    v_and_b32 v2, 15, v1
    v_lshrrev_b32 v3, 4, v1
    s_and_b32 s6, s3, 1
    s_lshl_b32 s6, s6, 7
    v_add_u32 v4, s6, v2
    v_lshlrev_b32 v4, 7, v4
    v_add_u32 v4, s100, v4
    v_lshrrev_b32 v5, 1, v2
    v_add_u32 v6, 0, v3
    v_xor_b32 v6, v6, v5
    v_lshl_add_u32 v48, v6, 4, v4
    v_add_u32 v6, 4, v3
    v_xor_b32 v6, v6, v5
    v_lshl_add_u32 v49, v6, 4, v4
    v_lshrrev_b32 v4, 2, v2
    v_lshl_add_u32 v5, v3, 3, v4
    v_lshlrev_b32 v5, 8, v5
    v_and_b32 v6, 1, v2
    v_lshl_add_u32 v5, v6, 3, v5
    v_and_b32 v6, 1, v3
    v_lshl_or_b32 v4, v6, 2, v4
    v_lshlrev_b32 v4, 1, v4
    v_bfe_u32 v6, v2, 1, 1
    v_add_u32 v8, 131072, v5
    v_add_u32 v7, 0, v6
    v_xor_b32 v7, v7, v4
    v_lshl_add_u32 v54, v7, 4, v8
    v_add_u32 v7, 2, v6
    v_xor_b32 v7, v7, v4
    v_lshl_add_u32 v55, v7, 4, v8
    v_add_u32 v7, 4, v6
    v_xor_b32 v7, v7, v4
    v_lshl_add_u32 v56, v7, 4, v8
    v_add_u32 v7, 6, v6
    v_xor_b32 v7, v7, v4
    v_lshl_add_u32 v57, v7, 4, v8
    v_add_u32 v7, 8, v6
    v_xor_b32 v7, v7, v4
    v_lshl_add_u32 v58, v7, 4, v8
    v_add_u32 v7, 10, v6
    v_xor_b32 v7, v7, v4
    v_lshl_add_u32 v59, v7, 4, v8
    v_add_u32 v7, 12, v6
    v_xor_b32 v7, v7, v4
    v_lshl_add_u32 v60, v7, 4, v8
    v_add_u32 v7, 14, v6
    v_xor_b32 v7, v7, v4
    v_lshl_add_u32 v61, v7, 4, v8
    s_lshr_b32 s6, s3, 2
    s_lshl_b32 s6, s6, 14
    s_add_u32 s6, s6, 32768
    s_add_u32 s6, s6, s100
    v_add_u32 v5, s6, v5
    s_lshr_b32 s7, s3, 1
    s_and_b32 s7, s7, 1
    s_lshl_b32 s7, s7, 3
    s_add_u32 s6, s7, 0
    v_add_u32 v7, s6, v6
    v_xor_b32 v7, v7, v4
    v_lshl_add_u32 v50, v7, 4, v5
    s_add_u32 s6, s7, 2
    v_add_u32 v7, s6, v6
    v_xor_b32 v7, v7, v4
    v_lshl_add_u32 v51, v7, 4, v5
    s_add_u32 s6, s7, 4
    v_add_u32 v7, s6, v6
    v_xor_b32 v7, v7, v4
    v_lshl_add_u32 v52, v7, 4, v5
    s_add_u32 s6, s7, 6
    v_add_u32 v7, s6, v6
    v_xor_b32 v7, v7, v4
    v_lshl_add_u32 v53, v7, 4, v5
    v_mov_b64 v[128:129], 0
    v_mov_b64 v[130:131], 0
    v_mov_b64 v[132:133], 0
    v_mov_b64 v[134:135], 0
    v_mov_b64 v[136:137], 0
    v_mov_b64 v[138:139], 0
    v_mov_b64 v[140:141], 0
    v_mov_b64 v[142:143], 0
    v_mov_b64 v[144:145], 0
    v_mov_b64 v[146:147], 0
    v_mov_b64 v[148:149], 0
    v_mov_b64 v[150:151], 0
    v_mov_b64 v[152:153], 0
    v_mov_b64 v[154:155], 0
    v_mov_b64 v[156:157], 0
    v_mov_b64 v[158:159], 0
    v_mov_b64 v[160:161], 0
    v_mov_b64 v[162:163], 0
    v_mov_b64 v[164:165], 0
    v_mov_b64 v[166:167], 0
    v_mov_b64 v[168:169], 0
    v_mov_b64 v[170:171], 0
    v_mov_b64 v[172:173], 0
    v_mov_b64 v[174:175], 0
    v_mov_b64 v[176:177], 0
    v_mov_b64 v[178:179], 0
    v_mov_b64 v[180:181], 0
    v_mov_b64 v[182:183], 0
    v_mov_b64 v[184:185], 0
    v_mov_b64 v[186:187], 0
    v_mov_b64 v[188:189], 0
    v_mov_b64 v[190:191], 0
    v_mov_b64 v[192:193], 0
    v_mov_b64 v[194:195], 0
    v_mov_b64 v[196:197], 0
    v_mov_b64 v[198:199], 0
    v_mov_b64 v[200:201], 0
    v_mov_b64 v[202:203], 0
    v_mov_b64 v[204:205], 0
    v_mov_b64 v[206:207], 0
    v_mov_b64 v[208:209], 0
    v_mov_b64 v[210:211], 0
    v_mov_b64 v[212:213], 0
    v_mov_b64 v[214:215], 0
    v_mov_b64 v[216:217], 0
    v_mov_b64 v[218:219], 0
    v_mov_b64 v[220:221], 0
    v_mov_b64 v[222:223], 0
    v_mov_b64 v[224:225], 0
    v_mov_b64 v[226:227], 0
    v_mov_b64 v[228:229], 0
    v_mov_b64 v[230:231], 0
    v_mov_b64 v[232:233], 0
    v_mov_b64 v[234:235], 0
    v_mov_b64 v[236:237], 0
    v_mov_b64 v[238:239], 0
    v_mov_b64 v[240:241], 0
    v_mov_b64 v[242:243], 0
    v_mov_b64 v[244:245], 0
    v_mov_b64 v[246:247], 0
    v_mov_b64 v[248:249], 0
    v_mov_b64 v[250:251], 0
    v_mov_b64 v[252:253], 0
    v_mov_b64 v[254:255], 0
    v_add_u32 v12, 20480, v13
    s_mul_i32 s70, s60, 40960
    s_mov_b32 s65, 0
    s_lshl_b32 s6, s4, 20
    s_lshl_b32 s7, s5, 13
    s_add_u32 s6, s6, s7
    s_and_b32 s7, s3, 1
    s_lshl_b32 s7, s7, 16
    s_add_u32 s6, s6, s7
    s_add_u32 s67, s6, 16777216
    s_and_b32 s6, s4, 3
    s_add_u32 s6, s6, s5
    s_sub_u32 s7, s6, 5
    s_cselect_b32 s6, s6, s7
    s_sub_u32 s7, s6, 5
    s_cselect_b32 s6, s6, s7
    s_lshl_b32 s71, s6, 20
    s_lshl_b32 s7, s4, 8
    s_add_u32 s71, s71, s7
    s_lshl_b32 s7, s6, 12
    s_add_u32 s84, s70, s7
    s_add_u32 s6, s6, 1
    s_cmp_eq_u32 s6, 5
    s_cselect_b32 s6, 0, s6
    s_lshl_b32 s7, s6, 12
    s_add_u32 s85, s70, s7
    s_add_u32 s6, s6, 1
    s_cmp_eq_u32 s6, 5
    s_cselect_b32 s6, 0, s6
    s_lshl_b32 s7, s6, 12
    s_add_u32 s86, s70, s7
    s_add_u32 s6, s6, 1
    s_cmp_eq_u32 s6, 5
    s_cselect_b32 s6, 0, s6
    s_lshl_b32 s7, s6, 12
    s_add_u32 s87, s70, s7
    s_add_u32 s6, s6, 1
    s_cmp_eq_u32 s6, 5
    s_cselect_b32 s6, 0, s6
    s_lshl_b32 s7, s6, 12
    s_add_u32 s88, s70, s7
    s_lshr_b32 s7, s3, 1
    s_and_b32 s7, s7, 1
    s_cmp_ge_u32 s3, 4
    s_cbranch_scc1 L_c_v
    s_lshl_b32 s7, s7, 11
    s_add_u32 s67, s67, s7
    s_movk_i32 s68, 3072
    s_mov_b32 s69, 125952
    s_add_u32 s71, s71, 1048576
    s_sub_u32 s75, s71, 5242880
    s_cselect_b32 s71, s71, s75
    s_lshl_b32 s74, s76, 12
    s_add_u32 s74, s74, s100
    s_branch L_c_j
L_c_v:
    s_lshl_b32 s7, s7, 12
    s_add_u32 s67, s67, s7
    s_add_u32 s67, s67, 0x80000
    s_movk_i32 s68, 1024
    s_mov_b32 s69, 128000
L_c_j:
    s_cmp_ge_u32 s3, 4
    s_cbranch_scc1 L_st_v1
    s_mov_b32 m0, s64
    s_add_u32 s72, s62, 524288
    buffer_load_dwordx4 v40, s[12:15], s62 offen offset:0 lds
    buffer_load_dwordx4 v41, s[12:15], s62 offen offset:1024 lds
    buffer_load_dwordx4 v42, s[12:15], s62 offen offset:2048 lds
    buffer_load_dwordx4 v43, s[12:15], s62 offen offset:3072 lds
    s_add_u32 m0, s64, 4096
    s_add_u32 s62, s62, 128
    s_bitset0_b32 s62, 10
    buffer_load_dwordx4 v40, s[12:15], s72 offen offset:0 lds
    buffer_load_dwordx4 v41, s[12:15], s72 offen offset:1024 lds
    buffer_load_dwordx4 v42, s[12:15], s72 offen offset:2048 lds
    buffer_load_dwordx4 v43, s[12:15], s72 offen offset:3072 lds
    s_waitcnt vmcnt(8)
    s_branch L_st_j1
L_st_v1:
    s_waitcnt vmcnt(6)
    v_lshlrev_b32 v64, 16, v16
    v_and_b32 v65, 0xffff0000, v16
    v_lshlrev_b32 v66, 16, v17
    v_and_b32 v67, 0xffff0000, v17
    v_lshlrev_b32 v68, 16, v18
    v_and_b32 v69, 0xffff0000, v18
    v_lshlrev_b32 v70, 16, v19
    v_and_b32 v71, 0xffff0000, v19
    v_lshlrev_b32 v72, 16, v20
    v_and_b32 v73, 0xffff0000, v20
    v_lshlrev_b32 v74, 16, v21
    v_and_b32 v75, 0xffff0000, v21
    v_lshlrev_b32 v76, 16, v22
    v_and_b32 v77, 0xffff0000, v22
    v_lshlrev_b32 v78, 16, v23
    v_and_b32 v79, 0xffff0000, v23
    v_lshlrev_b32 v80, 16, v24
    v_and_b32 v81, 0xffff0000, v24
    v_lshlrev_b32 v82, 16, v25
    v_and_b32 v83, 0xffff0000, v25
    v_pk_add_f32 v[2:3], v[64:65], v[66:67]
    v_pk_add_f32 v[2:3], v[2:3], v[68:69]
    v_pk_add_f32 v[2:3], v[2:3], v[70:71]
    v_pk_add_f32 v[2:3], v[2:3], v[72:73]
    v_pk_add_f32 v[2:3], v[2:3], v[74:75]
    v_pk_add_f32 v[2:3], v[2:3], v[76:77]
    v_pk_add_f32 v[2:3], v[2:3], v[78:79]
    v_pk_add_f32 v[2:3], v[2:3], v[80:81]
    v_pk_add_f32 v[2:3], v[2:3], v[82:83]
    v_add_f32 v2, v2, v3
    s_nop 1
    v_add_f32_dpp v2, v2, v2 quad_perm:[1,0,3,2] row_mask:0xf bank_mask:0xf
    s_nop 1
    v_add_f32_dpp v2, v2, v2 quad_perm:[2,3,0,1] row_mask:0xf bank_mask:0xf
    s_nop 1
    v_add_f32_dpp v2, v2, v2 row_half_mirror row_mask:0xf bank_mask:0xf
    s_nop 1
    v_add_f32_dpp v2, v2, v2 row_mirror row_mask:0xf bank_mask:0xf
    v_mov_b32 v8, v2
    s_nop 1
    v_permlane16_swap_b32 v2, v8
    s_nop 1
    v_add_f32 v2, v2, v8
    s_mov_b32 s7, 0x3acccccd
    v_mul_f32 v2, s7, v2
    v_mov_b64 v[4:5], 0
    v_pk_add_f32 v[6:7], v[64:65], v[2:3] op_sel_hi:[1,0] neg_lo:[0,1] neg_hi:[0,1]
    v_pk_fma_f32 v[4:5], v[6:7], v[6:7], v[4:5]
    v_pk_add_f32 v[6:7], v[66:67], v[2:3] op_sel_hi:[1,0] neg_lo:[0,1] neg_hi:[0,1]
    v_pk_fma_f32 v[4:5], v[6:7], v[6:7], v[4:5]
    v_pk_add_f32 v[6:7], v[68:69], v[2:3] op_sel_hi:[1,0] neg_lo:[0,1] neg_hi:[0,1]
    v_pk_fma_f32 v[4:5], v[6:7], v[6:7], v[4:5]
    v_pk_add_f32 v[6:7], v[70:71], v[2:3] op_sel_hi:[1,0] neg_lo:[0,1] neg_hi:[0,1]
    v_pk_fma_f32 v[4:5], v[6:7], v[6:7], v[4:5]
    v_pk_add_f32 v[6:7], v[72:73], v[2:3] op_sel_hi:[1,0] neg_lo:[0,1] neg_hi:[0,1]
    v_pk_fma_f32 v[4:5], v[6:7], v[6:7], v[4:5]
    v_pk_add_f32 v[6:7], v[74:75], v[2:3] op_sel_hi:[1,0] neg_lo:[0,1] neg_hi:[0,1]
    v_pk_fma_f32 v[4:5], v[6:7], v[6:7], v[4:5]
    v_pk_add_f32 v[6:7], v[76:77], v[2:3] op_sel_hi:[1,0] neg_lo:[0,1] neg_hi:[0,1]
    v_pk_fma_f32 v[4:5], v[6:7], v[6:7], v[4:5]
    v_pk_add_f32 v[6:7], v[78:79], v[2:3] op_sel_hi:[1,0] neg_lo:[0,1] neg_hi:[0,1]
    v_pk_fma_f32 v[4:5], v[6:7], v[6:7], v[4:5]
    v_pk_add_f32 v[6:7], v[80:81], v[2:3] op_sel_hi:[1,0] neg_lo:[0,1] neg_hi:[0,1]
    v_pk_fma_f32 v[4:5], v[6:7], v[6:7], v[4:5]
    v_pk_add_f32 v[6:7], v[82:83], v[2:3] op_sel_hi:[1,0] neg_lo:[0,1] neg_hi:[0,1]
    v_pk_fma_f32 v[4:5], v[6:7], v[6:7], v[4:5]
    v_add_f32 v4, v4, v5
    s_nop 1
    v_add_f32_dpp v4, v4, v4 quad_perm:[1,0,3,2] row_mask:0xf bank_mask:0xf
    s_nop 1
    v_add_f32_dpp v4, v4, v4 quad_perm:[2,3,0,1] row_mask:0xf bank_mask:0xf
    s_nop 1
    v_add_f32_dpp v4, v4, v4 row_half_mirror row_mask:0xf bank_mask:0xf
    s_nop 1
    v_add_f32_dpp v4, v4, v4 row_mirror row_mask:0xf bank_mask:0xf
    v_mov_b32 v8, v4
    s_nop 1
    v_permlane16_swap_b32 v4, v8
    s_nop 1
    v_add_f32 v4, v4, v8
    v_mul_f32 v4, s7, v4
    v_cvt_pk_bf16_f32 v2, v2, v2
    v_lshlrev_b32 v2, 16, v2
    v_cvt_pk_bf16_f32 v4, v4, v4
    v_lshlrev_b32 v4, 16, v4
    v_add_f32 v4, 0x3727c5ac, v4
    v_cvt_pk_bf16_f32 v4, v4, v4
    v_lshlrev_b32 v4, 16, v4
    v_sqrt_f32 v4, v4
    s_nop 0
    v_cvt_pk_bf16_f32 v4, v4, v4
    v_lshlrev_b32 v4, 16, v4
    v_rcp_f32 v6, v4
    s_nop 0
    v_fma_f32 v5, -v4, v6, 1.0
    v_fmac_f32 v6, v5, v6
    v_mov_b32 v9, 0
    v_pk_add_f32 v[64:65], v[64:65], v[2:3] op_sel_hi:[1,0] neg_lo:[0,1] neg_hi:[0,1]
    v_cvt_pk_bf16_f32 v5, v64, v65
    v_lshlrev_b32 v64, 16, v5
    v_and_b32 v65, 0xffff0000, v5
    v_pk_mul_f32 v[64:65], v[64:65], v[6:7] op_sel_hi:[1,0]
    v_cvt_pk_bf16_f32 v16, v64, v65
    v_pk_add_f32 v[66:67], v[66:67], v[2:3] op_sel_hi:[1,0] neg_lo:[0,1] neg_hi:[0,1]
    v_cvt_pk_bf16_f32 v5, v66, v67
    v_lshlrev_b32 v66, 16, v5
    v_and_b32 v67, 0xffff0000, v5
    v_pk_mul_f32 v[66:67], v[66:67], v[6:7] op_sel_hi:[1,0]
    v_cvt_pk_bf16_f32 v17, v66, v67
    v_pk_add_f32 v[68:69], v[68:69], v[2:3] op_sel_hi:[1,0] neg_lo:[0,1] neg_hi:[0,1]
    v_cvt_pk_bf16_f32 v5, v68, v69
    v_lshlrev_b32 v68, 16, v5
    v_and_b32 v69, 0xffff0000, v5
    v_pk_mul_f32 v[68:69], v[68:69], v[6:7] op_sel_hi:[1,0]
    v_cvt_pk_bf16_f32 v18, v68, v69
    v_pk_add_f32 v[70:71], v[70:71], v[2:3] op_sel_hi:[1,0] neg_lo:[0,1] neg_hi:[0,1]
    v_cvt_pk_bf16_f32 v5, v70, v71
    v_lshlrev_b32 v70, 16, v5
    v_and_b32 v71, 0xffff0000, v5
    v_pk_mul_f32 v[70:71], v[70:71], v[6:7] op_sel_hi:[1,0]
    v_cvt_pk_bf16_f32 v19, v70, v71
    v_pk_add_f32 v[72:73], v[72:73], v[2:3] op_sel_hi:[1,0] neg_lo:[0,1] neg_hi:[0,1]
    v_cvt_pk_bf16_f32 v5, v72, v73
    v_lshlrev_b32 v72, 16, v5
    v_and_b32 v73, 0xffff0000, v5
    v_pk_mul_f32 v[72:73], v[72:73], v[6:7] op_sel_hi:[1,0]
    v_cvt_pk_bf16_f32 v20, v72, v73
    v_pk_add_f32 v[74:75], v[74:75], v[2:3] op_sel_hi:[1,0] neg_lo:[0,1] neg_hi:[0,1]
    v_cvt_pk_bf16_f32 v5, v74, v75
    v_lshlrev_b32 v74, 16, v5
    v_and_b32 v75, 0xffff0000, v5
    v_pk_mul_f32 v[74:75], v[74:75], v[6:7] op_sel_hi:[1,0]
    v_cvt_pk_bf16_f32 v21, v74, v75
    v_pk_add_f32 v[76:77], v[76:77], v[2:3] op_sel_hi:[1,0] neg_lo:[0,1] neg_hi:[0,1]
    v_cvt_pk_bf16_f32 v5, v76, v77
    v_lshlrev_b32 v76, 16, v5
    v_and_b32 v77, 0xffff0000, v5
    v_pk_mul_f32 v[76:77], v[76:77], v[6:7] op_sel_hi:[1,0]
    v_cvt_pk_bf16_f32 v22, v76, v77
    v_pk_add_f32 v[78:79], v[78:79], v[2:3] op_sel_hi:[1,0] neg_lo:[0,1] neg_hi:[0,1]
    v_cvt_pk_bf16_f32 v5, v78, v79
    v_lshlrev_b32 v78, 16, v5
    v_and_b32 v79, 0xffff0000, v5
    v_pk_mul_f32 v[78:79], v[78:79], v[6:7] op_sel_hi:[1,0]
    v_cvt_pk_bf16_f32 v23, v78, v79
    v_pk_add_f32 v[80:81], v[80:81], v[2:3] op_sel_hi:[1,0] neg_lo:[0,1] neg_hi:[0,1]
    v_cvt_pk_bf16_f32 v5, v80, v81
    v_lshlrev_b32 v80, 16, v5
    v_and_b32 v81, 0xffff0000, v5
    v_pk_mul_f32 v[80:81], v[80:81], v[6:7] op_sel_hi:[1,0]
    v_cvt_pk_bf16_f32 v24, v80, v81
    v_pk_add_f32 v[82:83], v[82:83], v[2:3] op_sel_hi:[1,0] neg_lo:[0,1] neg_hi:[0,1]
    v_cvt_pk_bf16_f32 v5, v82, v83
    v_lshlrev_b32 v82, 16, v5
    v_and_b32 v83, 0xffff0000, v5
    v_pk_mul_f32 v[82:83], v[82:83], v[6:7] op_sel_hi:[1,0]
    v_cvt_pk_bf16_f32 v25, v82, v83
    v_add_u32 v10, 131072, v63
    ds_write_b64 v10, v[16:17] offset:0
    ds_write_b64 v10, v[18:19] offset:256
    ds_write_b64 v10, v[20:21] offset:512
    ds_write_b64 v10, v[22:23] offset:768
    ds_write_b64 v10, v[24:25] offset:1024
    s_waitcnt lgkmcnt(0)
    v_mov_b32 v2, 0
    v_lshlrev_b32 v4, 16, v16
    v_lshlrev_b32 v5, 16, v26
    v_fmac_f32 v2, v4, v5
    v_and_b32 v4, 0xffff0000, v16
    v_and_b32 v5, 0xffff0000, v26
    v_fmac_f32 v2, v4, v5
    v_lshlrev_b32 v4, 16, v17
    v_lshlrev_b32 v5, 16, v27
    v_fmac_f32 v2, v4, v5
    v_and_b32 v4, 0xffff0000, v17
    v_and_b32 v5, 0xffff0000, v27
    v_fmac_f32 v2, v4, v5
    v_lshlrev_b32 v4, 16, v18
    v_lshlrev_b32 v5, 16, v28
    v_fmac_f32 v2, v4, v5
    v_and_b32 v4, 0xffff0000, v18
    v_and_b32 v5, 0xffff0000, v28
    v_fmac_f32 v2, v4, v5
    v_lshlrev_b32 v4, 16, v19
    v_lshlrev_b32 v5, 16, v29
    v_fmac_f32 v2, v4, v5
    v_and_b32 v4, 0xffff0000, v19
    v_and_b32 v5, 0xffff0000, v29
    v_fmac_f32 v2, v4, v5
    v_lshlrev_b32 v4, 16, v20
    v_lshlrev_b32 v5, 16, v30
    v_fmac_f32 v2, v4, v5
    v_and_b32 v4, 0xffff0000, v20
    v_and_b32 v5, 0xffff0000, v30
    v_fmac_f32 v2, v4, v5
    v_lshlrev_b32 v4, 16, v21
    v_lshlrev_b32 v5, 16, v31
    v_fmac_f32 v2, v4, v5
    v_and_b32 v4, 0xffff0000, v21
    v_and_b32 v5, 0xffff0000, v31
    v_fmac_f32 v2, v4, v5
    v_lshlrev_b32 v4, 16, v22
    v_lshlrev_b32 v5, 16, v32
    v_fmac_f32 v2, v4, v5
    v_and_b32 v4, 0xffff0000, v22
    v_and_b32 v5, 0xffff0000, v32
    v_fmac_f32 v2, v4, v5
    v_lshlrev_b32 v4, 16, v23
    v_lshlrev_b32 v5, 16, v33
    v_fmac_f32 v2, v4, v5
    v_and_b32 v4, 0xffff0000, v23
    v_and_b32 v5, 0xffff0000, v33
    v_fmac_f32 v2, v4, v5
    v_lshlrev_b32 v4, 16, v24
    v_lshlrev_b32 v5, 16, v34
    v_fmac_f32 v2, v4, v5
    v_and_b32 v4, 0xffff0000, v24
    v_and_b32 v5, 0xffff0000, v34
    v_fmac_f32 v2, v4, v5
    v_lshlrev_b32 v4, 16, v25
    v_lshlrev_b32 v5, 16, v35
    v_fmac_f32 v2, v4, v5
    v_and_b32 v4, 0xffff0000, v25
    v_and_b32 v5, 0xffff0000, v35
    v_fmac_f32 v2, v4, v5
    s_nop 1
    v_add_f32_dpp v2, v2, v2 quad_perm:[1,0,3,2] row_mask:0xf bank_mask:0xf
    s_nop 1
    v_add_f32_dpp v2, v2, v2 quad_perm:[2,3,0,1] row_mask:0xf bank_mask:0xf
    s_nop 1
    v_add_f32_dpp v2, v2, v2 row_half_mirror row_mask:0xf bank_mask:0xf
    s_nop 1
    v_add_f32_dpp v2, v2, v2 row_mirror row_mask:0xf bank_mask:0xf
    v_mov_b32 v8, v2
    s_nop 1
    v_permlane16_swap_b32 v2, v8
    s_nop 1
    v_add_f32 v2, v2, v8
    v_cvt_pk_bf16_f32 v2, v2, v2
    v_and_b32 v2, 0xffff, v2
    v_bfe_i32 v3, v2, 15, 1
    v_and_b32 v3, 0x7fff, v3
    v_or_b32 v3, 0x8000, v3
    v_xor_b32 v2, v2, v3
    s_lshl_b32 s7, s2, 3
    s_sub_u32 s6, 2047, s7
    v_sub_u32 v3, s6, v62
    v_lshl_or_b32 v2, v2, 11, v3
    v_lshlrev_b32 v3, 2, v62
    v_add_u32 v3, 161792, v3
    ds_write_b32 v3, v2
    s_waitcnt lgkmcnt(0)
L_st_j1:
    s_barrier
    s_cmp_ge_u32 s3, 4
    s_cbranch_scc1 L_kv_v
    ds_read_b128 v[64:67], v48 offset:0
    ds_read_b128 v[68:71], v48 offset:2048
    ds_read_b64_tr_b16 v[96:97], v50 offset:0
    ds_read_b64_tr_b16 v[98:99], v50 offset:1024
    ds_read_b64_tr_b16 v[100:101], v51 offset:0
    ds_read_b64_tr_b16 v[102:103], v51 offset:1024
    ds_read_b128 v[72:75], v48 offset:4096
    ds_read_b64_tr_b16 v[104:105], v52 offset:0
    ds_read_b64_tr_b16 v[106:107], v52 offset:1024
    ds_read_b64_tr_b16 v[108:109], v53 offset:0
    ds_read_b64_tr_b16 v[110:111], v53 offset:1024
    ds_read_b128 v[76:79], v48 offset:6144
    ds_read_b128 v[80:83], v48 offset:8192
    ds_read_b128 v[84:87], v48 offset:10240
    ds_read_b128 v[88:91], v48 offset:12288
    ds_read_b128 v[92:95], v48 offset:14336
    s_mov_b32 m0, s73
    s_xor_b32 s64, s64, 0x10000
    buffer_load_dwordx4 v44, s[16:19], s63 offen offset:0 nt lds
    buffer_load_dwordx4 v45, s[16:19], s63 offen offset:1024 nt lds
    buffer_load_dwordx4 v46, s[16:19], s63 offen offset:2048 nt lds
    buffer_load_dwordx4 v47, s[16:19], s63 offen offset:3072 nt lds
    s_add_u32 m0, s73, 16384
    s_xor_b32 s73, s73, 0x10000
    buffer_load_dwordx4 v44, s[20:23], s63 offen offset:0 nt lds
    buffer_load_dwordx4 v45, s[20:23], s63 offen offset:1024 nt lds
    buffer_load_dwordx4 v46, s[20:23], s63 offen offset:2048 nt lds
    buffer_load_dwordx4 v47, s[20:23], s63 offen offset:3072 nt lds
    s_add_u32 s63, s63, 524288
    s_bitset0_b32 s63, 22
.p2align 4
L_kloopA:
    s_waitcnt lgkmcnt(12)
    v_mfma_f32_16x16x32_bf16 v[128:131], v[96:99], v[64:67], v[128:131]
    ds_read_b64_tr_b16 v[112:113], v50 offset:8192
    s_waitcnt lgkmcnt(11)
    v_mfma_f32_16x16x32_bf16 v[132:135], v[100:103], v[64:67], v[132:135]
    ds_read_b64_tr_b16 v[114:115], v50 offset:9216
    s_waitcnt lgkmcnt(9)
    v_mfma_f32_16x16x32_bf16 v[136:139], v[104:107], v[64:67], v[136:139]
    ds_read_b64_tr_b16 v[116:117], v51 offset:8192
    s_waitcnt lgkmcnt(8)
    v_mfma_f32_16x16x32_bf16 v[140:143], v[108:111], v[64:67], v[140:143]
    ds_read_b64_tr_b16 v[118:119], v51 offset:9216
    ds_read_b128 v[64:67], v49 offset:0
    v_mfma_f32_16x16x32_bf16 v[156:159], v[108:111], v[68:71], v[156:159]
    ds_read_b64_tr_b16 v[120:121], v52 offset:8192
    v_mfma_f32_16x16x32_bf16 v[152:155], v[104:107], v[68:71], v[152:155]
    ds_read_b64_tr_b16 v[122:123], v52 offset:9216
    v_mfma_f32_16x16x32_bf16 v[148:151], v[100:103], v[68:71], v[148:151]
    ds_read_b64_tr_b16 v[124:125], v53 offset:8192
    v_mfma_f32_16x16x32_bf16 v[144:147], v[96:99], v[68:71], v[144:147]
    ds_read_b64_tr_b16 v[126:127], v53 offset:9216
    ds_read_b128 v[68:71], v49 offset:2048
    v_mfma_f32_16x16x32_bf16 v[160:163], v[96:99], v[72:75], v[160:163]
    v_mfma_f32_16x16x32_bf16 v[164:167], v[100:103], v[72:75], v[164:167]
    v_mfma_f32_16x16x32_bf16 v[168:171], v[104:107], v[72:75], v[168:171]
    v_mfma_f32_16x16x32_bf16 v[172:175], v[108:111], v[72:75], v[172:175]
    ds_read_b128 v[72:75], v49 offset:4096
    s_waitcnt lgkmcnt(15)
    v_mfma_f32_16x16x32_bf16 v[188:191], v[108:111], v[76:79], v[188:191]
    v_mfma_f32_16x16x32_bf16 v[184:187], v[104:107], v[76:79], v[184:187]
    v_mfma_f32_16x16x32_bf16 v[180:183], v[100:103], v[76:79], v[180:183]
    v_mfma_f32_16x16x32_bf16 v[176:179], v[96:99], v[76:79], v[176:179]
    ds_read_b128 v[76:79], v49 offset:6144
    s_waitcnt lgkmcnt(15)
    v_mfma_f32_16x16x32_bf16 v[192:195], v[96:99], v[80:83], v[192:195]
    v_mfma_f32_16x16x32_bf16 v[196:199], v[100:103], v[80:83], v[196:199]
    v_mfma_f32_16x16x32_bf16 v[200:203], v[104:107], v[80:83], v[200:203]
    v_mfma_f32_16x16x32_bf16 v[204:207], v[108:111], v[80:83], v[204:207]
    ds_read_b128 v[80:83], v49 offset:8192
    s_waitcnt lgkmcnt(15)
    v_mfma_f32_16x16x32_bf16 v[220:223], v[108:111], v[84:87], v[220:223]
    v_mfma_f32_16x16x32_bf16 v[216:219], v[104:107], v[84:87], v[216:219]
    v_mfma_f32_16x16x32_bf16 v[212:215], v[100:103], v[84:87], v[212:215]
    v_mfma_f32_16x16x32_bf16 v[208:211], v[96:99], v[84:87], v[208:211]
    ds_read_b128 v[84:87], v49 offset:10240
    s_waitcnt lgkmcnt(15)
    v_mfma_f32_16x16x32_bf16 v[224:227], v[96:99], v[88:91], v[224:227]
    v_mfma_f32_16x16x32_bf16 v[228:231], v[100:103], v[88:91], v[228:231]
    v_mfma_f32_16x16x32_bf16 v[232:235], v[104:107], v[88:91], v[232:235]
    v_mfma_f32_16x16x32_bf16 v[236:239], v[108:111], v[88:91], v[236:239]
    ds_read_b128 v[88:91], v49 offset:12288
    s_waitcnt lgkmcnt(15)
    v_mfma_f32_16x16x32_bf16 v[252:255], v[108:111], v[92:95], v[252:255]
    v_mfma_f32_16x16x32_bf16 v[248:251], v[104:107], v[92:95], v[248:251]
    v_mfma_f32_16x16x32_bf16 v[244:247], v[100:103], v[92:95], v[244:247]
    v_mfma_f32_16x16x32_bf16 v[240:243], v[96:99], v[92:95], v[240:243]
    ds_read_b128 v[92:95], v49 offset:14336
    s_waitcnt lgkmcnt(11)
    v_mfma_f32_16x16x32_bf16 v[128:131], v[112:115], v[64:67], v[128:131]
    v_mfma_f32_16x16x32_bf16 v[132:135], v[116:119], v[64:67], v[132:135]
    s_waitcnt lgkmcnt(9)
    v_mfma_f32_16x16x32_bf16 v[136:139], v[120:123], v[64:67], v[136:139]
    s_waitcnt lgkmcnt(7)
    v_mfma_f32_16x16x32_bf16 v[140:143], v[124:127], v[64:67], v[140:143]
    s_waitcnt lgkmcnt(6)
    v_mfma_f32_16x16x32_bf16 v[156:159], v[124:127], v[68:71], v[156:159]
    v_mfma_f32_16x16x32_bf16 v[152:155], v[120:123], v[68:71], v[152:155]
    v_mfma_f32_16x16x32_bf16 v[148:151], v[116:119], v[68:71], v[148:151]
    v_mfma_f32_16x16x32_bf16 v[144:147], v[112:115], v[68:71], v[144:147]
    v_xor_b32 v48, 0x10000, v48
    v_xor_b32 v49, 0x10000, v49
    v_xor_b32 v50, 0x10000, v50
    v_xor_b32 v51, 0x10000, v51
    v_xor_b32 v52, 0x10000, v52
    v_xor_b32 v53, 0x10000, v53
    s_waitcnt vmcnt(0) lgkmcnt(0)
    s_barrier
    ds_read_b128 v[64:67], v48 offset:0
    ds_read_b128 v[68:71], v48 offset:2048
    v_mfma_f32_16x16x32_bf16 v[160:163], v[112:115], v[72:75], v[160:163]
    ds_read_b64_tr_b16 v[96:97], v50 offset:0
    s_mov_b32 m0, s64
    s_add_u32 s72, s62, 524288
    v_mfma_f32_16x16x32_bf16 v[164:167], v[116:119], v[72:75], v[164:167]
    ds_read_b64_tr_b16 v[98:99], v50 offset:1024
    buffer_load_dwordx4 v40, s[12:15], s62 offen offset:0 lds
    v_mfma_f32_16x16x32_bf16 v[168:171], v[120:123], v[72:75], v[168:171]
    ds_read_b64_tr_b16 v[100:101], v51 offset:0
    buffer_load_dwordx4 v41, s[12:15], s62 offen offset:1024 lds
    v_mfma_f32_16x16x32_bf16 v[172:175], v[124:127], v[72:75], v[172:175]
    ds_read_b64_tr_b16 v[102:103], v51 offset:1024
    buffer_load_dwordx4 v42, s[12:15], s62 offen offset:2048 lds
    ds_read_b128 v[72:75], v48 offset:4096
    v_mfma_f32_16x16x32_bf16 v[188:191], v[124:127], v[76:79], v[188:191]
    ds_read_b64_tr_b16 v[104:105], v52 offset:0
    buffer_load_dwordx4 v43, s[12:15], s62 offen offset:3072 lds
    v_mfma_f32_16x16x32_bf16 v[184:187], v[120:123], v[76:79], v[184:187]
    ds_read_b64_tr_b16 v[106:107], v52 offset:1024
    s_add_u32 m0, s64, 4096
    s_add_u32 s62, s62, 128
    s_bitset0_b32 s62, 10
    v_mfma_f32_16x16x32_bf16 v[180:183], v[116:119], v[76:79], v[180:183]
    ds_read_b64_tr_b16 v[108:109], v53 offset:0
    buffer_load_dwordx4 v40, s[12:15], s72 offen offset:0 lds
    v_mfma_f32_16x16x32_bf16 v[176:179], v[112:115], v[76:79], v[176:179]
    ds_read_b64_tr_b16 v[110:111], v53 offset:1024
    buffer_load_dwordx4 v41, s[12:15], s72 offen offset:1024 lds
    ds_read_b128 v[76:79], v48 offset:6144
    v_mfma_f32_16x16x32_bf16 v[192:195], v[112:115], v[80:83], v[192:195]
    buffer_load_dwordx4 v42, s[12:15], s72 offen offset:2048 lds
    v_mfma_f32_16x16x32_bf16 v[196:199], v[116:119], v[80:83], v[196:199]
    buffer_load_dwordx4 v43, s[12:15], s72 offen offset:3072 lds
    v_mfma_f32_16x16x32_bf16 v[200:203], v[120:123], v[80:83], v[200:203]
    s_mov_b32 m0, s73
    s_xor_b32 s64, s64, 0x10000
    v_mfma_f32_16x16x32_bf16 v[204:207], v[124:127], v[80:83], v[204:207]
    buffer_load_dwordx4 v44, s[16:19], s63 offen offset:0 nt lds
    ds_read_b128 v[80:83], v48 offset:8192
    v_mfma_f32_16x16x32_bf16 v[220:223], v[124:127], v[84:87], v[220:223]
    buffer_load_dwordx4 v45, s[16:19], s63 offen offset:1024 nt lds
    v_mfma_f32_16x16x32_bf16 v[216:219], v[120:123], v[84:87], v[216:219]
    buffer_load_dwordx4 v46, s[16:19], s63 offen offset:2048 nt lds
    v_mfma_f32_16x16x32_bf16 v[212:215], v[116:119], v[84:87], v[212:215]
    buffer_load_dwordx4 v47, s[16:19], s63 offen offset:3072 nt lds
    v_mfma_f32_16x16x32_bf16 v[208:211], v[112:115], v[84:87], v[208:211]
    s_add_u32 m0, s73, 16384
    s_xor_b32 s73, s73, 0x10000
    ds_read_b128 v[84:87], v48 offset:10240
    v_mfma_f32_16x16x32_bf16 v[224:227], v[112:115], v[88:91], v[224:227]
    buffer_load_dwordx4 v44, s[20:23], s63 offen offset:0 nt lds
    v_mfma_f32_16x16x32_bf16 v[228:231], v[116:119], v[88:91], v[228:231]
    buffer_load_dwordx4 v45, s[20:23], s63 offen offset:1024 nt lds
    v_mfma_f32_16x16x32_bf16 v[232:235], v[120:123], v[88:91], v[232:235]
    buffer_load_dwordx4 v46, s[20:23], s63 offen offset:2048 nt lds
    v_mfma_f32_16x16x32_bf16 v[236:239], v[124:127], v[88:91], v[236:239]
    buffer_load_dwordx4 v47, s[20:23], s63 offen offset:3072 nt lds
    ds_read_b128 v[88:91], v48 offset:12288
    v_mfma_f32_16x16x32_bf16 v[252:255], v[124:127], v[92:95], v[252:255]
    s_add_u32 s63, s63, 524288
    s_bitset0_b32 s63, 22
    v_mfma_f32_16x16x32_bf16 v[248:251], v[120:123], v[92:95], v[248:251]
    v_mfma_f32_16x16x32_bf16 v[244:247], v[116:119], v[92:95], v[244:247]
    v_mfma_f32_16x16x32_bf16 v[240:243], v[112:115], v[92:95], v[240:243]
    ds_read_b128 v[92:95], v48 offset:14336
    s_add_u32 s65, s65, 1
    s_cmp_lt_u32 s65, 6
    s_cbranch_scc1 L_kloopA
.p2align 4
L_kloopB:
    s_bitcmp1_b32 128, s65
    s_cbranch_scc1 L_khook
L_khook_back:
    s_waitcnt lgkmcnt(12)
    v_mfma_f32_16x16x32_bf16 v[128:131], v[96:99], v[64:67], v[128:131]
    ds_read_b64_tr_b16 v[112:113], v50 offset:8192
    s_waitcnt lgkmcnt(11)
    v_mfma_f32_16x16x32_bf16 v[132:135], v[100:103], v[64:67], v[132:135]
    ds_read_b64_tr_b16 v[114:115], v50 offset:9216
    s_waitcnt lgkmcnt(9)
    v_mfma_f32_16x16x32_bf16 v[136:139], v[104:107], v[64:67], v[136:139]
    ds_read_b64_tr_b16 v[116:117], v51 offset:8192
    s_waitcnt lgkmcnt(8)
    v_mfma_f32_16x16x32_bf16 v[140:143], v[108:111], v[64:67], v[140:143]
    ds_read_b64_tr_b16 v[118:119], v51 offset:9216
    ds_read_b128 v[64:67], v49 offset:0
    v_mfma_f32_16x16x32_bf16 v[156:159], v[108:111], v[68:71], v[156:159]
    ds_read_b64_tr_b16 v[120:121], v52 offset:8192
    v_mfma_f32_16x16x32_bf16 v[152:155], v[104:107], v[68:71], v[152:155]
    ds_read_b64_tr_b16 v[122:123], v52 offset:9216
    v_mfma_f32_16x16x32_bf16 v[148:151], v[100:103], v[68:71], v[148:151]
    ds_read_b64_tr_b16 v[124:125], v53 offset:8192
    v_mfma_f32_16x16x32_bf16 v[144:147], v[96:99], v[68:71], v[144:147]
    ds_read_b64_tr_b16 v[126:127], v53 offset:9216
    ds_read_b128 v[68:71], v49 offset:2048
    v_mfma_f32_16x16x32_bf16 v[160:163], v[96:99], v[72:75], v[160:163]
    v_mfma_f32_16x16x32_bf16 v[164:167], v[100:103], v[72:75], v[164:167]
    v_mfma_f32_16x16x32_bf16 v[168:171], v[104:107], v[72:75], v[168:171]
    v_mfma_f32_16x16x32_bf16 v[172:175], v[108:111], v[72:75], v[172:175]
    ds_read_b128 v[72:75], v49 offset:4096
    s_waitcnt lgkmcnt(15)
    v_mfma_f32_16x16x32_bf16 v[188:191], v[108:111], v[76:79], v[188:191]
    v_mfma_f32_16x16x32_bf16 v[184:187], v[104:107], v[76:79], v[184:187]
    v_mfma_f32_16x16x32_bf16 v[180:183], v[100:103], v[76:79], v[180:183]
    v_mfma_f32_16x16x32_bf16 v[176:179], v[96:99], v[76:79], v[176:179]
    ds_read_b128 v[76:79], v49 offset:6144
    s_waitcnt lgkmcnt(15)
    v_mfma_f32_16x16x32_bf16 v[192:195], v[96:99], v[80:83], v[192:195]
    v_mfma_f32_16x16x32_bf16 v[196:199], v[100:103], v[80:83], v[196:199]
    v_mfma_f32_16x16x32_bf16 v[200:203], v[104:107], v[80:83], v[200:203]
    v_mfma_f32_16x16x32_bf16 v[204:207], v[108:111], v[80:83], v[204:207]
    ds_read_b128 v[80:83], v49 offset:8192
    s_waitcnt lgkmcnt(15)
    v_mfma_f32_16x16x32_bf16 v[220:223], v[108:111], v[84:87], v[220:223]
    v_mfma_f32_16x16x32_bf16 v[216:219], v[104:107], v[84:87], v[216:219]
    v_mfma_f32_16x16x32_bf16 v[212:215], v[100:103], v[84:87], v[212:215]
    v_mfma_f32_16x16x32_bf16 v[208:211], v[96:99], v[84:87], v[208:211]
    ds_read_b128 v[84:87], v49 offset:10240
    s_waitcnt lgkmcnt(15)
    v_mfma_f32_16x16x32_bf16 v[224:227], v[96:99], v[88:91], v[224:227]
    v_mfma_f32_16x16x32_bf16 v[228:231], v[100:103], v[88:91], v[228:231]
    v_mfma_f32_16x16x32_bf16 v[232:235], v[104:107], v[88:91], v[232:235]
    v_mfma_f32_16x16x32_bf16 v[236:239], v[108:111], v[88:91], v[236:239]
    ds_read_b128 v[88:91], v49 offset:12288
    s_waitcnt lgkmcnt(15)
    v_mfma_f32_16x16x32_bf16 v[252:255], v[108:111], v[92:95], v[252:255]
    v_mfma_f32_16x16x32_bf16 v[248:251], v[104:107], v[92:95], v[248:251]
    v_mfma_f32_16x16x32_bf16 v[244:247], v[100:103], v[92:95], v[244:247]
    v_mfma_f32_16x16x32_bf16 v[240:243], v[96:99], v[92:95], v[240:243]
    ds_read_b128 v[92:95], v49 offset:14336
    s_waitcnt lgkmcnt(11)
    v_mfma_f32_16x16x32_bf16 v[128:131], v[112:115], v[64:67], v[128:131]
    v_mfma_f32_16x16x32_bf16 v[132:135], v[116:119], v[64:67], v[132:135]
    s_waitcnt lgkmcnt(9)
    v_mfma_f32_16x16x32_bf16 v[136:139], v[120:123], v[64:67], v[136:139]
    s_waitcnt lgkmcnt(7)
    v_mfma_f32_16x16x32_bf16 v[140:143], v[124:127], v[64:67], v[140:143]
    s_waitcnt lgkmcnt(6)
    v_mfma_f32_16x16x32_bf16 v[156:159], v[124:127], v[68:71], v[156:159]
    v_mfma_f32_16x16x32_bf16 v[152:155], v[120:123], v[68:71], v[152:155]
    v_mfma_f32_16x16x32_bf16 v[148:151], v[116:119], v[68:71], v[148:151]
    v_mfma_f32_16x16x32_bf16 v[144:147], v[112:115], v[68:71], v[144:147]
    v_xor_b32 v48, 0x10000, v48
    v_xor_b32 v49, 0x10000, v49
    v_xor_b32 v50, 0x10000, v50
    v_xor_b32 v51, 0x10000, v51
    v_xor_b32 v52, 0x10000, v52
    v_xor_b32 v53, 0x10000, v53
    s_waitcnt vmcnt(0) lgkmcnt(0)
    s_barrier
    ds_read_b128 v[64:67], v48 offset:0
    ds_read_b128 v[68:71], v48 offset:2048
    v_mfma_f32_16x16x32_bf16 v[160:163], v[112:115], v[72:75], v[160:163]
    ds_read_b64_tr_b16 v[96:97], v50 offset:0
    s_mov_b32 m0, s74
    s_add_u32 s74, s74, 16384
    s_bitset0_b32 s74, 17
    v_mfma_f32_16x16x32_bf16 v[164:167], v[116:119], v[72:75], v[164:167]
    ds_read_b64_tr_b16 v[98:99], v50 offset:1024
    buffer_load_dwordx4 v44, s[24:27], s71 offen offset:0 lds
    v_mfma_f32_16x16x32_bf16 v[168:171], v[120:123], v[72:75], v[168:171]
    ds_read_b64_tr_b16 v[100:101], v51 offset:0
    buffer_load_dwordx4 v45, s[24:27], s71 offen offset:1024 lds
    v_mfma_f32_16x16x32_bf16 v[172:175], v[124:127], v[72:75], v[172:175]
    ds_read_b64_tr_b16 v[102:103], v51 offset:1024
    buffer_load_dwordx4 v46, s[24:27], s71 offen offset:2048 lds
    ds_read_b128 v[72:75], v48 offset:4096
    v_mfma_f32_16x16x32_bf16 v[188:191], v[124:127], v[76:79], v[188:191]
    ds_read_b64_tr_b16 v[104:105], v52 offset:0
    buffer_load_dwordx4 v47, s[24:27], s71 offen offset:3072 lds
    v_mfma_f32_16x16x32_bf16 v[184:187], v[120:123], v[76:79], v[184:187]
    ds_read_b64_tr_b16 v[106:107], v52 offset:1024
    s_add_u32 s71, s71, 524288
    s_sub_u32 s75, s71, 5242880
    s_cselect_b32 s71, s71, s75
    v_mfma_f32_16x16x32_bf16 v[180:183], v[116:119], v[76:79], v[180:183]
    ds_read_b64_tr_b16 v[108:109], v53 offset:0
    s_mov_b32 m0, s74
    s_add_u32 s74, s74, 16384
    s_bitset0_b32 s74, 17
    v_mfma_f32_16x16x32_bf16 v[176:179], v[112:115], v[76:79], v[176:179]
    ds_read_b64_tr_b16 v[110:111], v53 offset:1024
    buffer_load_dwordx4 v44, s[24:27], s71 offen offset:0 lds
    ds_read_b128 v[76:79], v48 offset:6144
    v_mfma_f32_16x16x32_bf16 v[192:195], v[112:115], v[80:83], v[192:195]
    buffer_load_dwordx4 v45, s[24:27], s71 offen offset:1024 lds
    v_mfma_f32_16x16x32_bf16 v[196:199], v[116:119], v[80:83], v[196:199]
    buffer_load_dwordx4 v46, s[24:27], s71 offen offset:2048 lds
    v_mfma_f32_16x16x32_bf16 v[200:203], v[120:123], v[80:83], v[200:203]
    buffer_load_dwordx4 v47, s[24:27], s71 offen offset:3072 lds
    v_mfma_f32_16x16x32_bf16 v[204:207], v[124:127], v[80:83], v[204:207]
    s_add_u32 s71, s71, 524288
    s_sub_u32 s75, s71, 5242880
    s_cselect_b32 s71, s71, s75
    ds_read_b128 v[80:83], v48 offset:8192
    v_mfma_f32_16x16x32_bf16 v[220:223], v[124:127], v[84:87], v[220:223]
    s_mov_b32 m0, s74
    s_add_u32 s74, s74, 16384
    s_bitset0_b32 s74, 17
    v_mfma_f32_16x16x32_bf16 v[216:219], v[120:123], v[84:87], v[216:219]
    buffer_load_dwordx4 v44, s[24:27], s71 offen offset:0 lds
    v_mfma_f32_16x16x32_bf16 v[212:215], v[116:119], v[84:87], v[212:215]
    buffer_load_dwordx4 v45, s[24:27], s71 offen offset:1024 lds
    v_mfma_f32_16x16x32_bf16 v[208:211], v[112:115], v[84:87], v[208:211]
    buffer_load_dwordx4 v46, s[24:27], s71 offen offset:2048 lds
    ds_read_b128 v[84:87], v48 offset:10240
    v_mfma_f32_16x16x32_bf16 v[224:227], v[112:115], v[88:91], v[224:227]
    buffer_load_dwordx4 v47, s[24:27], s71 offen offset:3072 lds
    v_mfma_f32_16x16x32_bf16 v[228:231], v[116:119], v[88:91], v[228:231]
    s_add_u32 s71, s71, 524288
    s_sub_u32 s75, s71, 5242880
    s_cselect_b32 s71, s71, s75
    v_mfma_f32_16x16x32_bf16 v[232:235], v[120:123], v[88:91], v[232:235]
    s_mov_b32 m0, s74
    s_add_u32 s74, s74, 16384
    s_bitset0_b32 s74, 17
    v_mfma_f32_16x16x32_bf16 v[236:239], v[124:127], v[88:91], v[236:239]
    buffer_load_dwordx4 v44, s[24:27], s71 offen offset:0 lds
    ds_read_b128 v[88:91], v48 offset:12288
    v_mfma_f32_16x16x32_bf16 v[252:255], v[124:127], v[92:95], v[252:255]
    buffer_load_dwordx4 v45, s[24:27], s71 offen offset:1024 lds
    v_mfma_f32_16x16x32_bf16 v[248:251], v[120:123], v[92:95], v[248:251]
    buffer_load_dwordx4 v46, s[24:27], s71 offen offset:2048 lds
    v_mfma_f32_16x16x32_bf16 v[244:247], v[116:119], v[92:95], v[244:247]
    buffer_load_dwordx4 v47, s[24:27], s71 offen offset:3072 lds
    v_mfma_f32_16x16x32_bf16 v[240:243], v[112:115], v[92:95], v[240:243]
    s_add_u32 s71, s71, 524288
    s_sub_u32 s75, s71, 5242880
    s_cselect_b32 s71, s71, s75
    ds_read_b128 v[92:95], v48 offset:14336
    s_add_u32 s65, s65, 1
    s_cmp_lt_u32 s65, 8
    s_cbranch_scc1 L_kloopB
    s_waitcnt lgkmcnt(0)
    s_nop 7
    v_cvt_pk_bf16_f32 v128, v128, v129
    v_cvt_pk_bf16_f32 v129, v130, v131
    v_cvt_pk_bf16_f32 v130, v132, v133
    v_cvt_pk_bf16_f32 v131, v134, v135
    v_cvt_pk_bf16_f32 v132, v136, v137
    v_cvt_pk_bf16_f32 v133, v138, v139
    v_cvt_pk_bf16_f32 v134, v140, v141
    v_cvt_pk_bf16_f32 v135, v142, v143
    v_cvt_pk_bf16_f32 v136, v144, v145
    v_cvt_pk_bf16_f32 v137, v146, v147
    v_cvt_pk_bf16_f32 v138, v148, v149
    v_cvt_pk_bf16_f32 v139, v150, v151
    v_cvt_pk_bf16_f32 v140, v152, v153
    v_cvt_pk_bf16_f32 v141, v154, v155
    v_cvt_pk_bf16_f32 v142, v156, v157
    v_cvt_pk_bf16_f32 v143, v158, v159
    v_cvt_pk_bf16_f32 v144, v160, v161
    v_cvt_pk_bf16_f32 v145, v162, v163
    v_cvt_pk_bf16_f32 v146, v164, v165
    v_cvt_pk_bf16_f32 v147, v166, v167
    v_cvt_pk_bf16_f32 v148, v168, v169
    v_cvt_pk_bf16_f32 v149, v170, v171
    v_cvt_pk_bf16_f32 v150, v172, v173
    v_cvt_pk_bf16_f32 v151, v174, v175
    v_cvt_pk_bf16_f32 v152, v176, v177
    v_cvt_pk_bf16_f32 v153, v178, v179
    v_cvt_pk_bf16_f32 v154, v180, v181
    v_cvt_pk_bf16_f32 v155, v182, v183
    v_cvt_pk_bf16_f32 v156, v184, v185
    v_cvt_pk_bf16_f32 v157, v186, v187
    v_cvt_pk_bf16_f32 v158, v188, v189
    v_cvt_pk_bf16_f32 v159, v190, v191
    v_cvt_pk_bf16_f32 v160, v192, v193
    v_cvt_pk_bf16_f32 v161, v194, v195
    v_cvt_pk_bf16_f32 v162, v196, v197
    v_cvt_pk_bf16_f32 v163, v198, v199
    v_cvt_pk_bf16_f32 v164, v200, v201
    v_cvt_pk_bf16_f32 v165, v202, v203
    v_cvt_pk_bf16_f32 v166, v204, v205
    v_cvt_pk_bf16_f32 v167, v206, v207
    v_cvt_pk_bf16_f32 v168, v208, v209
    v_cvt_pk_bf16_f32 v169, v210, v211
    v_cvt_pk_bf16_f32 v170, v212, v213
    v_cvt_pk_bf16_f32 v171, v214, v215
    v_cvt_pk_bf16_f32 v172, v216, v217
    v_cvt_pk_bf16_f32 v173, v218, v219
    v_cvt_pk_bf16_f32 v174, v220, v221
    v_cvt_pk_bf16_f32 v175, v222, v223
    v_cvt_pk_bf16_f32 v176, v224, v225
    v_cvt_pk_bf16_f32 v177, v226, v227
    v_cvt_pk_bf16_f32 v178, v228, v229
    v_cvt_pk_bf16_f32 v179, v230, v231
    v_cvt_pk_bf16_f32 v180, v232, v233
    v_cvt_pk_bf16_f32 v181, v234, v235
    v_cvt_pk_bf16_f32 v182, v236, v237
    v_cvt_pk_bf16_f32 v183, v238, v239
    v_cvt_pk_bf16_f32 v184, v240, v241
    v_cvt_pk_bf16_f32 v185, v242, v243
    v_cvt_pk_bf16_f32 v186, v244, v245
    v_cvt_pk_bf16_f32 v187, v246, v247
    v_cvt_pk_bf16_f32 v188, v248, v249
    v_cvt_pk_bf16_f32 v189, v250, v251
    v_cvt_pk_bf16_f32 v190, v252, v253
    v_cvt_pk_bf16_f32 v191, v254, v255
    s_waitcnt vmcnt(16)
    s_branch L_q
L_hook:
    s_cmp_eq_u32 s65, 1
    s_cbranch_scc1 L_hook1
    s_cmp_eq_u32 s65, 2
    s_cbranch_scc1 L_hook2
    s_cmp_eq_u32 s65, 4
    s_cbranch_scc1 L_hook4
    s_cmp_eq_u32 s65, 6
    s_cbranch_scc1 L_hook6
    s_cmp_lg_u32 s65, 7
    s_cbranch_scc1 L_hook_back
    buffer_load_dwordx4 v[16:19], v13, s[8:11], s84 offen offset:0 sc1
    buffer_load_dwordx4 v[20:23], v12, s[8:11], s84 offen offset:0 sc1
    buffer_load_dwordx4 v[24:27], v13, s[8:11], s84 offen offset:1024 sc1
    buffer_load_dwordx4 v[28:31], v12, s[8:11], s84 offen offset:1024 sc1
    buffer_load_dwordx4 v[32:35], v13, s[8:11], s84 offen offset:2048 sc1
    buffer_load_dwordx4 v[36:39], v12, s[8:11], s84 offen offset:2048 sc1
    s_branch L_hook_back
L_hook1:
    s_cmp_ge_u32 s76, 2
    s_cbranch_scc1 L_tch_1a
    s_and_b32 s6, s4, 3
    s_lshl_b32 s6, s6, 19
    s_lshl_b32 s7, s5, 15
    s_add_u32 s6, s6, s7
    s_lshl_b32 s7, s76, 7
    s_add_u32 s6, s6, s7
    s_add_u32 s6, s6, 512
    v_lshrrev_b32 v6, 1, v1
    v_lshlrev_b32 v6, 10, v6
    v_and_b32 v7, 1, v1
    v_lshl_add_u32 v6, v7, 6, v6
    buffer_load_dword v11, v6, s[12:15], s6 offen
    s_add_u32 s6, s6, 262144
    buffer_load_dword v11, v6, s[12:15], s6 offen
    s_branch L_tch_1c
L_tch_1a:
    v_lshrrev_b32 v6, 5, v1
    v_lshlrev_b32 v6, 6, v6
    v_bfe_u32 v7, v1, 2, 3
    v_add_u32 v6, v6, v7
    v_lshlrev_b32 v6, 13, v6
    v_and_b32 v7, 3, v1
    v_lshl_add_u32 v6, v7, 6, v6
    s_lshl_b32 s6, s4, 8
    s_lshl_b32 s7, s5, 16
    s_add_u32 s6, s6, s7
    s_add_u32 s6, s6, 2097152
    s_cmp_lg_u32 s76, 2
    s_cbranch_scc1 L_tch_1b
    buffer_load_dword v11, v6, s[16:19], s6 offen nt
    s_branch L_tch_1c
L_tch_1b:
    buffer_load_dword v11, v6, s[20:23], s6 offen nt
L_tch_1c:
    s_branch L_hook_back
L_hook2:
    s_lshr_b32 s72, s2, 1
    s_mul_i32 s72, s72, 20480
    s_and_b32 s7, s2, 1
    s_lshl_b32 s7, s7, 7
    s_add_u32 s72, s72, s7
    v_add_u32 v2, -256, v0
    v_lshrrev_b32 v3, 3, v2
    v_and_b32 v4, 7, v2
    v_mul_u32_u24 v5, 1280, v4
    v_lshl_add_u32 v5, v3, 4, v5
    v_add_u32 v5, 131072, v5
    ds_read_b128 v[16:19], v5
    v_lshlrev_b32 v5, 8, v3
    v_lshl_add_u32 v6, v4, 4, v5
    v_add_u32 v2, 0, v0
    v_lshrrev_b32 v3, 3, v2
    v_and_b32 v4, 7, v2
    v_mul_u32_u24 v5, 1280, v4
    v_lshl_add_u32 v5, v3, 4, v5
    v_add_u32 v5, 131072, v5
    ds_read_b128 v[24:27], v5
    v_lshlrev_b32 v5, 8, v3
    v_lshl_add_u32 v7, v4, 4, v5
    v_add_u32 v2, 256, v0
    v_lshrrev_b32 v3, 3, v2
    v_and_b32 v4, 7, v2
    v_mul_u32_u24 v5, 1280, v4
    v_lshl_add_u32 v5, v3, 4, v5
    v_add_u32 v5, 131072, v5
    ds_read_b128 v[32:35], v5
    v_lshlrev_b32 v5, 8, v3
    v_lshl_add_u32 v8, v4, 4, v5
    s_waitcnt lgkmcnt(0)
    buffer_store_dwordx4 v[16:19], v6, s[8:11], s72 offen sc1
    buffer_store_dwordx4 v[24:27], v7, s[8:11], s72 offen sc1
    s_cmp_ge_u32 s3, 6
    s_cbranch_scc1 L_lns
    buffer_store_dwordx4 v[32:35], v8, s[8:11], s72 offen sc1
L_lns:
    s_cmp_lt_u32 s3, 6
    s_cbranch_scc1 L_zd
    v_mov_b64 v[36:37], 0
    v_mov_b64 v[38:39], 0
    v_lshrrev_b32 v2, 3, v1
    s_cmp_eq_u32 s3, 6
    s_cbranch_scc1 L_z6
    s_lshl_b32 s6, s5, 2
    s_sub_u32 s7, 56, s6
    v_mov_b32 v3, s6
    v_mov_b32 v4, s7
    v_cmp_gt_u32 vcc, 4, v2
    s_lshl_b32 s6, s4, 7
    s_add_u32 s6, s6, 3932160
    v_cndmask_b32 v3, v4, v3, vcc
    v_add_u32 v3, v3, v2
    v_lshl_add_u32 v3, v3, 12, s6
    s_branch L_z7
L_z6:
    v_mov_b32 v3, 0x5000000
    s_lshl_b32 s6, s4, 3
    s_add_u32 s6, s6, s5
    s_lshl_b32 s6, s6, 5
    s_add_u32 s6, s6, s3
    s_lshl_b32 s6, s6, 2
    s_add_u32 s6, s6, 3866624
    s_andn2_b32 s6, s6, 127
    v_cmp_eq_u32 vcc, 0, v2
    v_mov_b32 v4, s6
    s_nop 0
    v_cndmask_b32 v3, v3, v4, vcc
    s_lshl_b32 s6, s61, 5
    s_add_u32 s6, s6, s3
    s_lshl_b32 s6, s6, 2
    s_add_u32 s6, s6, 15859712
    s_andn2_b32 s6, s6, 127
    v_cmp_eq_u32 vcc, 1, v2
    v_mov_b32 v4, s6
    s_nop 0
    v_cndmask_b32 v3, v3, v4, vcc
    s_lshl_b32 s6, s5, 5
    s_add_u32 s6, s6, s4
    s_lshl_b32 s6, s6, 5
    s_add_u32 s6, s6, s3
    s_lshl_b32 s6, s6, 2
    s_add_u32 s6, s6, 3899392
    s_andn2_b32 s6, s6, 127
    v_cmp_eq_u32 vcc, 2, v2
    v_mov_b32 v4, s6
    s_nop 0
    v_cndmask_b32 v3, v3, v4, vcc
    s_and_b32 s6, s4, 7
    s_lshl_b32 s7, s5, 3
    s_add_u32 s6, s6, s7
    s_lshr_b32 s7, s4, 3
    s_add_u32 s7, s7, 0
    s_add_u32 s7, s7, 1
    s_and_b32 s7, s7, 3
    s_lshl_b32 s6, s6, 2
    s_add_u32 s6, s6, s7
    s_mul_i32 s6, s6, 3
    s_add_u32 s6, s6, 0
    s_lshl_b32 s6, s6, 5
    s_add_u32 s6, s6, s3
    s_lshl_b32 s6, s6, 2
    s_add_u32 s6, s6, 15728640
    s_andn2_b32 s6, s6, 127
    v_cmp_eq_u32 vcc, 3, v2
    v_mov_b32 v4, s6
    s_nop 0
    v_cndmask_b32 v3, v3, v4, vcc
    s_and_b32 s6, s4, 7
    s_lshl_b32 s7, s5, 3
    s_add_u32 s6, s6, s7
    s_lshr_b32 s7, s4, 3
    s_add_u32 s7, s7, 1
    s_add_u32 s7, s7, 1
    s_and_b32 s7, s7, 3
    s_lshl_b32 s6, s6, 2
    s_add_u32 s6, s6, s7
    s_mul_i32 s6, s6, 3
    s_add_u32 s6, s6, 1
    s_lshl_b32 s6, s6, 5
    s_add_u32 s6, s6, s3
    s_lshl_b32 s6, s6, 2
    s_add_u32 s6, s6, 15728640
    s_andn2_b32 s6, s6, 127
    v_cmp_eq_u32 vcc, 4, v2
    v_mov_b32 v4, s6
    s_nop 0
    v_cndmask_b32 v3, v3, v4, vcc
    s_and_b32 s6, s4, 7
    s_lshl_b32 s7, s5, 3
    s_add_u32 s6, s6, s7
    s_lshr_b32 s7, s4, 3
    s_add_u32 s7, s7, 2
    s_add_u32 s7, s7, 1
    s_and_b32 s7, s7, 3
    s_lshl_b32 s6, s6, 2
    s_add_u32 s6, s6, s7
    s_mul_i32 s6, s6, 3
    s_add_u32 s6, s6, 2
    s_lshl_b32 s6, s6, 5
    s_add_u32 s6, s6, s3
    s_lshl_b32 s6, s6, 2
    s_add_u32 s6, s6, 15728640
    s_andn2_b32 s6, s6, 127
    v_cmp_eq_u32 vcc, 5, v2
    v_mov_b32 v4, s6
    s_nop 0
    v_cndmask_b32 v3, v3, v4, vcc
    s_mov_b32 s6, 0x5000000
    s_cmp_eq_u32 s2, 31
    s_cmov_b32 s6, 3801088
    s_andn2_b32 s6, s6, 127
    v_cmp_eq_u32 vcc, 6, v2
    v_mov_b32 v4, s6
    s_nop 0
    v_cndmask_b32 v3, v3, v4, vcc
    s_lshl_b32 s6, s2, 7
    s_add_u32 s6, s6, 2621440
    s_andn2_b32 s6, s6, 127
    v_cmp_eq_u32 vcc, 7, v2
    v_mov_b32 v4, s6
    s_nop 0
    v_cndmask_b32 v3, v3, v4, vcc
    v_add_u32 v4, 160896, v13
    s_mov_b32 exec_lo, 0
    s_mov_b32 exec_hi, 0x03000000
    ds_read_b128 v[36:39], v4
    s_mov_b64 exec, -1
    s_waitcnt lgkmcnt(0)
L_z7:
    v_and_b32 v2, 7, v1
    v_lshl_add_u32 v3, v2, 4, v3
    buffer_store_dwordx4 v[36:39], v3, s[8:11], 0 offen sc1
L_zd:
    s_cmp_ge_u32 s76, 2
    s_cbranch_scc1 L_tch_2a
    s_and_b32 s6, s4, 3
    s_lshl_b32 s6, s6, 19
    s_lshl_b32 s7, s5, 15
    s_add_u32 s6, s6, s7
    s_lshl_b32 s7, s76, 7
    s_add_u32 s6, s6, s7
    s_add_u32 s6, s6, 768
    v_lshrrev_b32 v6, 1, v1
    v_lshlrev_b32 v6, 10, v6
    v_and_b32 v7, 1, v1
    v_lshl_add_u32 v6, v7, 6, v6
    buffer_load_dword v11, v6, s[12:15], s6 offen
    s_add_u32 s6, s6, 262144
    buffer_load_dword v11, v6, s[12:15], s6 offen
    s_branch L_tch_2c
L_tch_2a:
    v_lshrrev_b32 v6, 5, v1
    v_lshlrev_b32 v6, 6, v6
    v_bfe_u32 v7, v1, 2, 3
    v_add_u32 v6, v6, v7
    v_lshlrev_b32 v6, 13, v6
    v_and_b32 v7, 3, v1
    v_lshl_add_u32 v6, v7, 6, v6
    s_lshl_b32 s6, s4, 8
    s_lshl_b32 s7, s5, 16
    s_add_u32 s6, s6, s7
    s_add_u32 s6, s6, 3145728
    s_cmp_lg_u32 s76, 2
    s_cbranch_scc1 L_tch_2b
    buffer_load_dword v11, v6, s[16:19], s6 offen nt
    s_branch L_tch_2c
L_tch_2b:
    buffer_load_dword v11, v6, s[20:23], s6 offen nt
L_tch_2c:
    s_branch L_hook_back
L_hook4:
    s_cmp_lg_u32 s3, 4
    s_cbranch_scc1 L_hook4b
    s_mov_b32 s28, s56
    s_mov_b32 s29, s57
    s_mov_b32 s30, 0x100
    s_mov_b32 s31, 0x20000
    v_mov_b32 v2, 1
    v_lshlrev_b32 v3, 8, v1
    s_and_b32 s6, s2, 31
    s_lshl_b32 s6, s6, 2
    buffer_atomic_add v2, v3, s[28:31], s6 offen offset:0 sc1
L_hook4b:
    s_lshl_b32 s74, s76, 12
    s_add_u32 s74, s74, 131072
    s_mov_b32 m0, s74
    s_add_u32 s74, s74, 16384
    buffer_load_dwordx4 v44, s[24:27], s71 offen offset:0 lds
    buffer_load_dwordx4 v45, s[24:27], s71 offen offset:1024 lds
    buffer_load_dwordx4 v46, s[24:27], s71 offen offset:2048 lds
    buffer_load_dwordx4 v47, s[24:27], s71 offen offset:3072 lds
    s_add_u32 s71, s71, 524288
    s_sub_u32 s75, s71, 5242880
    s_cselect_b32 s71, s71, s75
    s_mov_b32 m0, s74
    s_add_u32 s74, s74, 16384
    buffer_load_dwordx4 v44, s[24:27], s71 offen offset:0 lds
    buffer_load_dwordx4 v45, s[24:27], s71 offen offset:1024 lds
    buffer_load_dwordx4 v46, s[24:27], s71 offen offset:2048 lds
    buffer_load_dwordx4 v47, s[24:27], s71 offen offset:3072 lds
    s_add_u32 s71, s71, 524288
    s_sub_u32 s75, s71, 5242880
    s_cselect_b32 s71, s71, s75
    s_branch L_hook_back
L_hook6:
    s_cmp_lg_u32 s3, 5
    s_cbranch_scc1 L_hook_back
    s_mov_b32 s28, s56
    s_mov_b32 s29, s57
    s_mov_b32 s30, 0x100
    s_mov_b32 s31, 0x20000
    v_and_b32 v3, 31, v1
    v_lshlrev_b32 v3, 2, v3
    buffer_load_dword v62, v3, s[28:31], 0 offen offset:0 sc1
    s_branch L_hook_back
L_vpre:
    s_waitcnt vmcnt(0)
    s_lshl_b32 s6, s65, 4
    s_add_u32 s6, s6, s3
    s_cmp_lg_u32 s6, 0x65
    s_cbranch_scc1 L_vnow
    v_cmp_gt_u32 vcc, 8, v62
    s_cbranch_vccz L_cntok_3
    s_mov_b32 s28, s56
    s_mov_b32 s29, s57
    s_mov_b32 s30, 0x100
    s_mov_b32 s31, 0x20000
    v_and_b32 v3, 31, v1
    v_lshlrev_b32 v3, 2, v3
    s_mov_b32 s79, 262144
L_poll_4:
    buffer_load_dword v2, v3, s[28:31], 0 offen offset:0 sc1
    s_waitcnt vmcnt(0)
    v_cmp_gt_u32 vcc, 8, v2
    s_cbranch_vccz L_polldone_5
    s_sleep 8
    s_sub_u32 s79, s79, 1
    s_cmp_lg_u32 s79, 0
    s_cbranch_scc1 L_poll_4
L_polldone_5:
L_cntok_3:
    s_branch L_vnow
L_khook:
    s_cmp_lg_u32 s65, 7
    s_cbranch_scc1 L_khook_back
    buffer_load_dwordx4 v[16:19], v13, s[8:11], s84 offen offset:0 sc1
    buffer_load_dwordx4 v[20:23], v12, s[8:11], s84 offen offset:0 sc1
    buffer_load_dwordx4 v[24:27], v13, s[8:11], s84 offen offset:1024 sc1
    buffer_load_dwordx4 v[28:31], v12, s[8:11], s84 offen offset:1024 sc1
    buffer_load_dwordx4 v[32:35], v13, s[8:11], s84 offen offset:2048 sc1
    buffer_load_dwordx4 v[36:39], v12, s[8:11], s84 offen offset:2048 sc1
    s_branch L_khook_back
L_kv_v:
    ds_read_b128 v[64:67], v48 offset:0
    ds_read_b128 v[68:71], v48 offset:2048
    ds_read_b64_tr_b16 v[96:97], v50 offset:0
    ds_read_b64_tr_b16 v[98:99], v50 offset:1024
    ds_read_b64_tr_b16 v[100:101], v51 offset:0
    ds_read_b64_tr_b16 v[102:103], v51 offset:1024
    ds_read_b128 v[72:75], v48 offset:4096
    ds_read_b64_tr_b16 v[104:105], v52 offset:0
    ds_read_b64_tr_b16 v[106:107], v52 offset:1024
    ds_read_b64_tr_b16 v[108:109], v53 offset:0
    ds_read_b64_tr_b16 v[110:111], v53 offset:1024
    ds_read_b128 v[76:79], v48 offset:6144
    ds_read_b128 v[80:83], v48 offset:8192
    ds_read_b128 v[84:87], v48 offset:10240
    ds_read_b128 v[88:91], v48 offset:12288
    ds_read_b128 v[92:95], v48 offset:14336
    s_cmp_ge_u32 s76, 2
    s_cbranch_scc1 L_tch_6a
    s_and_b32 s6, s4, 3
    s_lshl_b32 s6, s6, 19
    s_lshl_b32 s7, s5, 15
    s_add_u32 s6, s6, s7
    s_lshl_b32 s7, s76, 7
    s_add_u32 s6, s6, s7
    s_add_u32 s6, s6, 256
    v_lshrrev_b32 v6, 1, v1
    v_lshlrev_b32 v6, 10, v6
    v_and_b32 v7, 1, v1
    v_lshl_add_u32 v6, v7, 6, v6
    buffer_load_dword v11, v6, s[12:15], s6 offen
    s_add_u32 s6, s6, 262144
    buffer_load_dword v11, v6, s[12:15], s6 offen
    s_branch L_tch_6c
L_tch_6a:
    v_lshrrev_b32 v6, 5, v1
    v_lshlrev_b32 v6, 6, v6
    v_bfe_u32 v7, v1, 2, 3
    v_add_u32 v6, v6, v7
    v_lshlrev_b32 v6, 13, v6
    v_and_b32 v7, 3, v1
    v_lshl_add_u32 v6, v7, 6, v6
    s_lshl_b32 s6, s4, 8
    s_lshl_b32 s7, s5, 16
    s_add_u32 s6, s6, s7
    s_add_u32 s6, s6, 1048576
    s_cmp_lg_u32 s76, 2
    s_cbranch_scc1 L_tch_6b
    buffer_load_dword v11, v6, s[16:19], s6 offen nt
    s_branch L_tch_6c
L_tch_6b:
    buffer_load_dword v11, v6, s[20:23], s6 offen nt
L_tch_6c:
.p2align 4
L_vloop:
    s_bitcmp1_b32 214, s65
    s_cbranch_scc1 L_hook
L_hook_back:
    s_waitcnt lgkmcnt(12)
    v_mfma_f32_16x16x32_bf16 v[128:131], v[64:67], v[96:99], v[128:131]
    ds_read_b64_tr_b16 v[112:113], v50 offset:8192
    s_waitcnt lgkmcnt(11)
    v_mfma_f32_16x16x32_bf16 v[132:135], v[64:67], v[100:103], v[132:135]
    ds_read_b64_tr_b16 v[114:115], v50 offset:9216
    s_waitcnt lgkmcnt(9)
    v_mfma_f32_16x16x32_bf16 v[136:139], v[64:67], v[104:107], v[136:139]
    ds_read_b64_tr_b16 v[116:117], v51 offset:8192
    s_waitcnt lgkmcnt(8)
    v_mfma_f32_16x16x32_bf16 v[140:143], v[64:67], v[108:111], v[140:143]
    ds_read_b64_tr_b16 v[118:119], v51 offset:9216
    ds_read_b128 v[64:67], v49 offset:0
    v_mfma_f32_16x16x32_bf16 v[156:159], v[68:71], v[108:111], v[156:159]
    ds_read_b64_tr_b16 v[120:121], v52 offset:8192
    v_mfma_f32_16x16x32_bf16 v[152:155], v[68:71], v[104:107], v[152:155]
    ds_read_b64_tr_b16 v[122:123], v52 offset:9216
    v_mfma_f32_16x16x32_bf16 v[148:151], v[68:71], v[100:103], v[148:151]
    ds_read_b64_tr_b16 v[124:125], v53 offset:8192
    v_mfma_f32_16x16x32_bf16 v[144:147], v[68:71], v[96:99], v[144:147]
    ds_read_b64_tr_b16 v[126:127], v53 offset:9216
    ds_read_b128 v[68:71], v49 offset:2048
    v_mfma_f32_16x16x32_bf16 v[160:163], v[72:75], v[96:99], v[160:163]
    v_mfma_f32_16x16x32_bf16 v[164:167], v[72:75], v[100:103], v[164:167]
    v_mfma_f32_16x16x32_bf16 v[168:171], v[72:75], v[104:107], v[168:171]
    v_mfma_f32_16x16x32_bf16 v[172:175], v[72:75], v[108:111], v[172:175]
    ds_read_b128 v[72:75], v49 offset:4096
    s_waitcnt lgkmcnt(15)
    v_mfma_f32_16x16x32_bf16 v[188:191], v[76:79], v[108:111], v[188:191]
    v_mfma_f32_16x16x32_bf16 v[184:187], v[76:79], v[104:107], v[184:187]
    v_mfma_f32_16x16x32_bf16 v[180:183], v[76:79], v[100:103], v[180:183]
    v_mfma_f32_16x16x32_bf16 v[176:179], v[76:79], v[96:99], v[176:179]
    ds_read_b128 v[76:79], v49 offset:6144
    s_waitcnt lgkmcnt(15)
    v_mfma_f32_16x16x32_bf16 v[192:195], v[80:83], v[96:99], v[192:195]
    v_mfma_f32_16x16x32_bf16 v[196:199], v[80:83], v[100:103], v[196:199]
    v_mfma_f32_16x16x32_bf16 v[200:203], v[80:83], v[104:107], v[200:203]
    v_mfma_f32_16x16x32_bf16 v[204:207], v[80:83], v[108:111], v[204:207]
    ds_read_b128 v[80:83], v49 offset:8192
    s_waitcnt lgkmcnt(15)
    v_mfma_f32_16x16x32_bf16 v[220:223], v[84:87], v[108:111], v[220:223]
    v_mfma_f32_16x16x32_bf16 v[216:219], v[84:87], v[104:107], v[216:219]
    v_mfma_f32_16x16x32_bf16 v[212:215], v[84:87], v[100:103], v[212:215]
    v_mfma_f32_16x16x32_bf16 v[208:211], v[84:87], v[96:99], v[208:211]
    ds_read_b128 v[84:87], v49 offset:10240
    s_waitcnt lgkmcnt(15)
    v_mfma_f32_16x16x32_bf16 v[224:227], v[88:91], v[96:99], v[224:227]
    v_mfma_f32_16x16x32_bf16 v[228:231], v[88:91], v[100:103], v[228:231]
    v_mfma_f32_16x16x32_bf16 v[232:235], v[88:91], v[104:107], v[232:235]
    v_mfma_f32_16x16x32_bf16 v[236:239], v[88:91], v[108:111], v[236:239]
    ds_read_b128 v[88:91], v49 offset:12288
    s_waitcnt lgkmcnt(15)
    v_mfma_f32_16x16x32_bf16 v[252:255], v[92:95], v[108:111], v[252:255]
    v_mfma_f32_16x16x32_bf16 v[248:251], v[92:95], v[104:107], v[248:251]
    v_mfma_f32_16x16x32_bf16 v[244:247], v[92:95], v[100:103], v[244:247]
    v_mfma_f32_16x16x32_bf16 v[240:243], v[92:95], v[96:99], v[240:243]
    ds_read_b128 v[92:95], v49 offset:14336
    s_waitcnt lgkmcnt(11)
    v_mfma_f32_16x16x32_bf16 v[128:131], v[64:67], v[112:115], v[128:131]
    v_mfma_f32_16x16x32_bf16 v[132:135], v[64:67], v[116:119], v[132:135]
    s_waitcnt lgkmcnt(9)
    v_mfma_f32_16x16x32_bf16 v[136:139], v[64:67], v[120:123], v[136:139]
    s_waitcnt lgkmcnt(7)
    v_mfma_f32_16x16x32_bf16 v[140:143], v[64:67], v[124:127], v[140:143]
    s_waitcnt lgkmcnt(6)
    v_mfma_f32_16x16x32_bf16 v[156:159], v[68:71], v[124:127], v[156:159]
    v_mfma_f32_16x16x32_bf16 v[152:155], v[68:71], v[120:123], v[152:155]
    v_mfma_f32_16x16x32_bf16 v[148:151], v[68:71], v[116:119], v[148:151]
    v_mfma_f32_16x16x32_bf16 v[144:147], v[68:71], v[112:115], v[144:147]
    v_xor_b32 v48, 0x10000, v48
    v_xor_b32 v49, 0x10000, v49
    v_xor_b32 v50, 0x10000, v50
    v_xor_b32 v51, 0x10000, v51
    v_xor_b32 v52, 0x10000, v52
    v_xor_b32 v53, 0x10000, v53
    s_bitcmp1_b32 72, s65
    s_cbranch_scc1 L_vpre
L_vnow:
    s_waitcnt lgkmcnt(0)
    s_barrier
    ds_read_b128 v[64:67], v48 offset:0
    ds_read_b128 v[68:71], v48 offset:2048
    v_mfma_f32_16x16x32_bf16 v[160:163], v[72:75], v[112:115], v[160:163]
    ds_read_b64_tr_b16 v[96:97], v50 offset:0
    v_mfma_f32_16x16x32_bf16 v[164:167], v[72:75], v[116:119], v[164:167]
    ds_read_b64_tr_b16 v[98:99], v50 offset:1024
    v_mfma_f32_16x16x32_bf16 v[168:171], v[72:75], v[120:123], v[168:171]
    ds_read_b64_tr_b16 v[100:101], v51 offset:0
    v_mfma_f32_16x16x32_bf16 v[172:175], v[72:75], v[124:127], v[172:175]
    ds_read_b64_tr_b16 v[102:103], v51 offset:1024
    ds_read_b128 v[72:75], v48 offset:4096
    v_mfma_f32_16x16x32_bf16 v[188:191], v[76:79], v[124:127], v[188:191]
    ds_read_b64_tr_b16 v[104:105], v52 offset:0
    v_mfma_f32_16x16x32_bf16 v[184:187], v[76:79], v[120:123], v[184:187]
    ds_read_b64_tr_b16 v[106:107], v52 offset:1024
    v_mfma_f32_16x16x32_bf16 v[180:183], v[76:79], v[116:119], v[180:183]
    ds_read_b64_tr_b16 v[108:109], v53 offset:0
    v_mfma_f32_16x16x32_bf16 v[176:179], v[76:79], v[112:115], v[176:179]
    ds_read_b64_tr_b16 v[110:111], v53 offset:1024
    ds_read_b128 v[76:79], v48 offset:6144
    v_mfma_f32_16x16x32_bf16 v[192:195], v[80:83], v[112:115], v[192:195]
    v_mfma_f32_16x16x32_bf16 v[196:199], v[80:83], v[116:119], v[196:199]
    v_mfma_f32_16x16x32_bf16 v[200:203], v[80:83], v[120:123], v[200:203]
    v_mfma_f32_16x16x32_bf16 v[204:207], v[80:83], v[124:127], v[204:207]
    ds_read_b128 v[80:83], v48 offset:8192
    v_mfma_f32_16x16x32_bf16 v[220:223], v[84:87], v[124:127], v[220:223]
    v_mfma_f32_16x16x32_bf16 v[216:219], v[84:87], v[120:123], v[216:219]
    v_mfma_f32_16x16x32_bf16 v[212:215], v[84:87], v[116:119], v[212:215]
    v_mfma_f32_16x16x32_bf16 v[208:211], v[84:87], v[112:115], v[208:211]
    ds_read_b128 v[84:87], v48 offset:10240
    v_mfma_f32_16x16x32_bf16 v[224:227], v[88:91], v[112:115], v[224:227]
    v_mfma_f32_16x16x32_bf16 v[228:231], v[88:91], v[116:119], v[228:231]
    v_mfma_f32_16x16x32_bf16 v[232:235], v[88:91], v[120:123], v[232:235]
    v_mfma_f32_16x16x32_bf16 v[236:239], v[88:91], v[124:127], v[236:239]
    ds_read_b128 v[88:91], v48 offset:12288
    v_mfma_f32_16x16x32_bf16 v[252:255], v[92:95], v[124:127], v[252:255]
    v_mfma_f32_16x16x32_bf16 v[248:251], v[92:95], v[120:123], v[248:251]
    v_mfma_f32_16x16x32_bf16 v[244:247], v[92:95], v[116:119], v[244:247]
    v_mfma_f32_16x16x32_bf16 v[240:243], v[92:95], v[112:115], v[240:243]
    ds_read_b128 v[92:95], v48 offset:14336
    s_add_u32 s65, s65, 1
    s_cmp_lt_u32 s65, 8
    s_cbranch_scc1 L_vloop
    s_waitcnt lgkmcnt(0)
    s_nop 7
    v_cvt_pk_bf16_f32 v128, v128, v129
    v_cvt_pk_bf16_f32 v129, v130, v131
    v_cvt_pk_bf16_f32 v130, v144, v145
    v_cvt_pk_bf16_f32 v131, v146, v147
    v_cvt_pk_bf16_f32 v132, v132, v133
    v_cvt_pk_bf16_f32 v133, v134, v135
    v_cvt_pk_bf16_f32 v134, v148, v149
    v_cvt_pk_bf16_f32 v135, v150, v151
    v_cvt_pk_bf16_f32 v136, v136, v137
    v_cvt_pk_bf16_f32 v137, v138, v139
    v_cvt_pk_bf16_f32 v138, v152, v153
    v_cvt_pk_bf16_f32 v139, v154, v155
    v_cvt_pk_bf16_f32 v140, v140, v141
    v_cvt_pk_bf16_f32 v141, v142, v143
    v_cvt_pk_bf16_f32 v142, v156, v157
    v_cvt_pk_bf16_f32 v143, v158, v159
    v_cvt_pk_bf16_f32 v144, v160, v161
    v_cvt_pk_bf16_f32 v145, v162, v163
    v_cvt_pk_bf16_f32 v146, v176, v177
    v_cvt_pk_bf16_f32 v147, v178, v179
    v_cvt_pk_bf16_f32 v148, v164, v165
    v_cvt_pk_bf16_f32 v149, v166, v167
    v_cvt_pk_bf16_f32 v150, v180, v181
    v_cvt_pk_bf16_f32 v151, v182, v183
    v_cvt_pk_bf16_f32 v152, v168, v169
    v_cvt_pk_bf16_f32 v153, v170, v171
    v_cvt_pk_bf16_f32 v154, v184, v185
    v_cvt_pk_bf16_f32 v155, v186, v187
    v_cvt_pk_bf16_f32 v156, v172, v173
    v_cvt_pk_bf16_f32 v157, v174, v175
    v_cvt_pk_bf16_f32 v158, v188, v189
    v_cvt_pk_bf16_f32 v159, v190, v191
    v_cvt_pk_bf16_f32 v160, v192, v193
    v_cvt_pk_bf16_f32 v161, v194, v195
    v_cvt_pk_bf16_f32 v162, v208, v209
    v_cvt_pk_bf16_f32 v163, v210, v211
    v_cvt_pk_bf16_f32 v164, v196, v197
    v_cvt_pk_bf16_f32 v165, v198, v199
    v_cvt_pk_bf16_f32 v166, v212, v213
    v_cvt_pk_bf16_f32 v167, v214, v215
    v_cvt_pk_bf16_f32 v168, v200, v201
    v_cvt_pk_bf16_f32 v169, v202, v203
    v_cvt_pk_bf16_f32 v170, v216, v217
    v_cvt_pk_bf16_f32 v171, v218, v219
    v_cvt_pk_bf16_f32 v172, v204, v205
    v_cvt_pk_bf16_f32 v173, v206, v207
    v_cvt_pk_bf16_f32 v174, v220, v221
    v_cvt_pk_bf16_f32 v175, v222, v223
    v_cvt_pk_bf16_f32 v176, v224, v225
    v_cvt_pk_bf16_f32 v177, v226, v227
    v_cvt_pk_bf16_f32 v178, v240, v241
    v_cvt_pk_bf16_f32 v179, v242, v243
    v_cvt_pk_bf16_f32 v180, v228, v229
    v_cvt_pk_bf16_f32 v181, v230, v231
    v_cvt_pk_bf16_f32 v182, v244, v245
    v_cvt_pk_bf16_f32 v183, v246, v247
    v_cvt_pk_bf16_f32 v184, v232, v233
    v_cvt_pk_bf16_f32 v185, v234, v235
    v_cvt_pk_bf16_f32 v186, v248, v249
    v_cvt_pk_bf16_f32 v187, v250, v251
    v_cvt_pk_bf16_f32 v188, v236, v237
    v_cvt_pk_bf16_f32 v189, v238, v239
    v_cvt_pk_bf16_f32 v190, v252, v253
    v_cvt_pk_bf16_f32 v191, v254, v255
    s_waitcnt vmcnt(0)
L_q:
    s_mov_b32 s28, s56
    s_mov_b32 s29, s57
    s_mov_b32 s30, 0x100
    s_mov_b32 s31, 0x20000
    s_lshl_b32 s6, s76, 13
    v_add_u32 v49, s6, v13
    s_lshl_b32 s6, s76, 12
    v_add_u32 v50, s6, v13
    s_lshl_b32 s77, s4, 20
    s_add_u32 s77, s77, 16777216
    s_mov_b32 s78, s100
    s_sub_u32 s101, s100, 131072
    s_mov_b32 s90, 0
    s_cmp_lt_u32 s3, 4
    s_cselect_b32 s89, 3, 2
    ds_read_b64_tr_b16 v[96:97], v54 offset:0
    ds_read_b64_tr_b16 v[98:99], v54 offset:1024
    ds_read_b64_tr_b16 v[100:101], v55 offset:0
    ds_read_b64_tr_b16 v[102:103], v55 offset:1024
    ds_read_b64_tr_b16 v[104:105], v56 offset:0
    ds_read_b64_tr_b16 v[106:107], v56 offset:1024
    ds_read_b64_tr_b16 v[108:109], v57 offset:0
    ds_read_b64_tr_b16 v[110:111], v57 offset:1024
    ds_read_b64_tr_b16 v[112:113], v58 offset:0
    ds_read_b64_tr_b16 v[114:115], v58 offset:1024
    ds_read_b64_tr_b16 v[116:117], v59 offset:0
    ds_read_b64_tr_b16 v[118:119], v59 offset:1024
    ds_read_b64_tr_b16 v[120:121], v60 offset:0
    ds_read_b64_tr_b16 v[122:123], v60 offset:1024
    ds_read_b64_tr_b16 v[124:125], v61 offset:0
    ds_read_b64_tr_b16 v[126:127], v61 offset:1024
    buffer_load_dwordx4 v[64:67], v13, s[8:11], s84 offen offset:3072 sc1
    buffer_load_dwordx4 v[68:71], v12, s[8:11], s84 offen offset:3072 sc1
    buffer_load_dwordx4 v[72:75], v13, s[8:11], s85 offen offset:0 sc1
    buffer_load_dwordx4 v[76:79], v12, s[8:11], s85 offen offset:0 sc1
    buffer_load_dwordx4 v[80:83], v13, s[8:11], s85 offen offset:1024 sc1
    buffer_load_dwordx4 v[84:87], v12, s[8:11], s85 offen offset:1024 sc1
    buffer_load_dwordx4 v[88:91], v13, s[8:11], s85 offen offset:2048 sc1
    buffer_load_dwordx4 v[92:95], v12, s[8:11], s85 offen offset:2048 sc1
    s_waitcnt lgkmcnt(14)
    v_mfma_f32_16x16x32_bf16 v[192:195], v[96:99], v[16:19], 0
    v_mfma_f32_16x16x32_bf16 v[196:199], v[96:99], v[20:23], 0
    ds_read_b64_tr_b16 v[96:97], v54 offset:8192
    s_waitcnt lgkmcnt(13)
    v_mfma_f32_16x16x32_bf16 v[204:207], v[100:103], v[20:23], 0
    ds_read_b64_tr_b16 v[98:99], v54 offset:9216
    v_mfma_f32_16x16x32_bf16 v[200:203], v[100:103], v[16:19], 0
    ds_read_b64_tr_b16 v[100:101], v55 offset:8192
    s_waitcnt lgkmcnt(13)
    v_mfma_f32_16x16x32_bf16 v[208:211], v[104:107], v[16:19], 0
    ds_read_b64_tr_b16 v[102:103], v55 offset:9216
    v_mfma_f32_16x16x32_bf16 v[212:215], v[104:107], v[20:23], 0
    ds_read_b64_tr_b16 v[104:105], v56 offset:8192
    s_waitcnt lgkmcnt(13)
    v_mfma_f32_16x16x32_bf16 v[220:223], v[108:111], v[20:23], 0
    ds_read_b64_tr_b16 v[106:107], v56 offset:9216
    buffer_store_dwordx4 v[128:131], v13, s[8:11], s67 offen sc1
    s_add_u32 s67, s67, 1024
    v_mfma_f32_16x16x32_bf16 v[216:219], v[108:111], v[16:19], 0
    ds_read_b64_tr_b16 v[108:109], v57 offset:8192
    s_waitcnt lgkmcnt(13)
    v_mfma_f32_16x16x32_bf16 v[224:227], v[112:115], v[16:19], 0
    ds_read_b64_tr_b16 v[110:111], v57 offset:9216
    v_mfma_f32_16x16x32_bf16 v[228:231], v[112:115], v[20:23], 0
    ds_read_b64_tr_b16 v[112:113], v58 offset:8192
    s_waitcnt lgkmcnt(13)
    v_mfma_f32_16x16x32_bf16 v[236:239], v[116:119], v[20:23], 0
    ds_read_b64_tr_b16 v[114:115], v58 offset:9216
    v_mfma_f32_16x16x32_bf16 v[232:235], v[116:119], v[16:19], 0
    ds_read_b64_tr_b16 v[116:117], v59 offset:8192
    s_waitcnt lgkmcnt(13)
    v_mfma_f32_16x16x32_bf16 v[240:243], v[120:123], v[16:19], 0
    ds_read_b64_tr_b16 v[118:119], v59 offset:9216
    v_mfma_f32_16x16x32_bf16 v[244:247], v[120:123], v[20:23], 0
    ds_read_b64_tr_b16 v[120:121], v60 offset:8192
    s_waitcnt lgkmcnt(13)
    v_mfma_f32_16x16x32_bf16 v[252:255], v[124:127], v[20:23], 0
    ds_read_b64_tr_b16 v[122:123], v60 offset:9216
    v_mfma_f32_16x16x32_bf16 v[248:251], v[124:127], v[16:19], 0
    ds_read_b64_tr_b16 v[124:125], v61 offset:8192
    ds_read_b64_tr_b16 v[126:127], v61 offset:9216
    buffer_load_dwordx4 v[16:19], v13, s[8:11], s85 offen offset:3072 sc1
    buffer_load_dwordx4 v[20:23], v12, s[8:11], s85 offen offset:3072 sc1
    s_waitcnt lgkmcnt(14)
    v_mfma_f32_16x16x32_bf16 v[192:195], v[96:99], v[24:27], v[192:195]
    v_mfma_f32_16x16x32_bf16 v[196:199], v[96:99], v[28:31], v[196:199]
    ds_read_b64_tr_b16 v[96:97], v54 offset:16384
    s_waitcnt lgkmcnt(13)
    v_mfma_f32_16x16x32_bf16 v[204:207], v[100:103], v[28:31], v[204:207]
    ds_read_b64_tr_b16 v[98:99], v54 offset:17408
    v_mfma_f32_16x16x32_bf16 v[200:203], v[100:103], v[24:27], v[200:203]
    ds_read_b64_tr_b16 v[100:101], v55 offset:16384
    s_waitcnt lgkmcnt(13)
    v_mfma_f32_16x16x32_bf16 v[208:211], v[104:107], v[24:27], v[208:211]
    ds_read_b64_tr_b16 v[102:103], v55 offset:17408
    v_mfma_f32_16x16x32_bf16 v[212:215], v[104:107], v[28:31], v[212:215]
    ds_read_b64_tr_b16 v[104:105], v56 offset:16384
    s_waitcnt lgkmcnt(13)
    v_mfma_f32_16x16x32_bf16 v[220:223], v[108:111], v[28:31], v[220:223]
    ds_read_b64_tr_b16 v[106:107], v56 offset:17408
    buffer_store_dwordx4 v[132:135], v13, s[8:11], s67 offen sc1
    s_add_u32 s67, s67, s68
    v_mfma_f32_16x16x32_bf16 v[216:219], v[108:111], v[24:27], v[216:219]
    ds_read_b64_tr_b16 v[108:109], v57 offset:16384
    s_waitcnt lgkmcnt(13)
    v_mfma_f32_16x16x32_bf16 v[224:227], v[112:115], v[24:27], v[224:227]
    ds_read_b64_tr_b16 v[110:111], v57 offset:17408
    v_mfma_f32_16x16x32_bf16 v[228:231], v[112:115], v[28:31], v[228:231]
    ds_read_b64_tr_b16 v[112:113], v58 offset:16384
    s_waitcnt lgkmcnt(13)
    v_mfma_f32_16x16x32_bf16 v[236:239], v[116:119], v[28:31], v[236:239]
    ds_read_b64_tr_b16 v[114:115], v58 offset:17408
    v_mfma_f32_16x16x32_bf16 v[232:235], v[116:119], v[24:27], v[232:235]
    ds_read_b64_tr_b16 v[116:117], v59 offset:16384
    s_waitcnt lgkmcnt(13)
    v_mfma_f32_16x16x32_bf16 v[240:243], v[120:123], v[24:27], v[240:243]
    ds_read_b64_tr_b16 v[118:119], v59 offset:17408
    v_mfma_f32_16x16x32_bf16 v[244:247], v[120:123], v[28:31], v[244:247]
    ds_read_b64_tr_b16 v[120:121], v60 offset:16384
    s_waitcnt lgkmcnt(13)
    v_mfma_f32_16x16x32_bf16 v[252:255], v[124:127], v[28:31], v[252:255]
    ds_read_b64_tr_b16 v[122:123], v60 offset:17408
    v_mfma_f32_16x16x32_bf16 v[248:251], v[124:127], v[24:27], v[248:251]
    ds_read_b64_tr_b16 v[124:125], v61 offset:16384
    ds_read_b64_tr_b16 v[126:127], v61 offset:17408
    buffer_load_dwordx4 v[24:27], v13, s[8:11], s86 offen offset:0 sc1
    buffer_load_dwordx4 v[28:31], v12, s[8:11], s86 offen offset:0 sc1
    s_waitcnt lgkmcnt(14)
    v_mfma_f32_16x16x32_bf16 v[192:195], v[96:99], v[32:35], v[192:195]
    v_mfma_f32_16x16x32_bf16 v[196:199], v[96:99], v[36:39], v[196:199]
    ds_read_b64_tr_b16 v[96:97], v54 offset:24576
    s_waitcnt lgkmcnt(13)
    v_mfma_f32_16x16x32_bf16 v[204:207], v[100:103], v[36:39], v[204:207]
    ds_read_b64_tr_b16 v[98:99], v54 offset:25600
    v_mfma_f32_16x16x32_bf16 v[200:203], v[100:103], v[32:35], v[200:203]
    ds_read_b64_tr_b16 v[100:101], v55 offset:24576
    s_waitcnt lgkmcnt(13)
    v_mfma_f32_16x16x32_bf16 v[208:211], v[104:107], v[32:35], v[208:211]
    ds_read_b64_tr_b16 v[102:103], v55 offset:25600
    v_mfma_f32_16x16x32_bf16 v[212:215], v[104:107], v[36:39], v[212:215]
    ds_read_b64_tr_b16 v[104:105], v56 offset:24576
    s_waitcnt lgkmcnt(13)
    v_mfma_f32_16x16x32_bf16 v[220:223], v[108:111], v[36:39], v[220:223]
    ds_read_b64_tr_b16 v[106:107], v56 offset:25600
    buffer_store_dwordx4 v[136:139], v13, s[8:11], s67 offen sc1
    s_add_u32 s67, s67, 1024
    v_mfma_f32_16x16x32_bf16 v[216:219], v[108:111], v[32:35], v[216:219]
    ds_read_b64_tr_b16 v[108:109], v57 offset:24576
    s_waitcnt lgkmcnt(13)
    v_mfma_f32_16x16x32_bf16 v[224:227], v[112:115], v[32:35], v[224:227]
    ds_read_b64_tr_b16 v[110:111], v57 offset:25600
    v_mfma_f32_16x16x32_bf16 v[228:231], v[112:115], v[36:39], v[228:231]
    ds_read_b64_tr_b16 v[112:113], v58 offset:24576
    s_waitcnt lgkmcnt(13)
    v_mfma_f32_16x16x32_bf16 v[236:239], v[116:119], v[36:39], v[236:239]
    ds_read_b64_tr_b16 v[114:115], v58 offset:25600
    v_mfma_f32_16x16x32_bf16 v[232:235], v[116:119], v[32:35], v[232:235]
    ds_read_b64_tr_b16 v[116:117], v59 offset:24576
    s_waitcnt lgkmcnt(13)
    v_mfma_f32_16x16x32_bf16 v[240:243], v[120:123], v[32:35], v[240:243]
    ds_read_b64_tr_b16 v[118:119], v59 offset:25600
    v_mfma_f32_16x16x32_bf16 v[244:247], v[120:123], v[36:39], v[244:247]
    ds_read_b64_tr_b16 v[120:121], v60 offset:24576
    s_waitcnt lgkmcnt(13)
    v_mfma_f32_16x16x32_bf16 v[252:255], v[124:127], v[36:39], v[252:255]
    ds_read_b64_tr_b16 v[122:123], v60 offset:25600
    v_mfma_f32_16x16x32_bf16 v[248:251], v[124:127], v[32:35], v[248:251]
    ds_read_b64_tr_b16 v[124:125], v61 offset:24576
    ds_read_b64_tr_b16 v[126:127], v61 offset:25600
    buffer_load_dwordx4 v[32:35], v13, s[8:11], s86 offen offset:1024 sc1
    buffer_load_dwordx4 v[36:39], v12, s[8:11], s86 offen offset:1024 sc1
    s_waitcnt vmcnt(15)
    s_waitcnt lgkmcnt(14)
    v_mfma_f32_16x16x32_bf16 v[192:195], v[96:99], v[64:67], v[192:195]
    v_add_u32 v54, s101, v54
    v_mfma_f32_16x16x32_bf16 v[196:199], v[96:99], v[68:71], v[196:199]
    ds_read_b64_tr_b16 v[96:97], v54 offset:0
    s_waitcnt lgkmcnt(13)
    v_mfma_f32_16x16x32_bf16 v[204:207], v[100:103], v[68:71], v[204:207]
    ds_read_b64_tr_b16 v[98:99], v54 offset:1024
    v_add_u32 v55, s101, v55
    v_mfma_f32_16x16x32_bf16 v[200:203], v[100:103], v[64:67], v[200:203]
    ds_read_b64_tr_b16 v[100:101], v55 offset:0
    s_waitcnt lgkmcnt(13)
    v_mfma_f32_16x16x32_bf16 v[208:211], v[104:107], v[64:67], v[208:211]
    ds_read_b64_tr_b16 v[102:103], v55 offset:1024
    v_add_u32 v56, s101, v56
    v_mfma_f32_16x16x32_bf16 v[212:215], v[104:107], v[68:71], v[212:215]
    ds_read_b64_tr_b16 v[104:105], v56 offset:0
    s_waitcnt lgkmcnt(13)
    v_mfma_f32_16x16x32_bf16 v[220:223], v[108:111], v[68:71], v[220:223]
    ds_read_b64_tr_b16 v[106:107], v56 offset:1024
    v_add_u32 v57, s101, v57
    buffer_store_dwordx4 v[140:143], v13, s[8:11], s67 offen sc1
    s_add_u32 s67, s67, s69
    v_mfma_f32_16x16x32_bf16 v[216:219], v[108:111], v[64:67], v[216:219]
    ds_read_b64_tr_b16 v[108:109], v57 offset:0
    s_waitcnt lgkmcnt(13)
    v_mfma_f32_16x16x32_bf16 v[224:227], v[112:115], v[64:67], v[224:227]
    ds_read_b64_tr_b16 v[110:111], v57 offset:1024
    v_add_u32 v58, s101, v58
    v_mfma_f32_16x16x32_bf16 v[228:231], v[112:115], v[68:71], v[228:231]
    ds_read_b64_tr_b16 v[112:113], v58 offset:0
    s_waitcnt lgkmcnt(13)
    v_mfma_f32_16x16x32_bf16 v[236:239], v[116:119], v[68:71], v[236:239]
    ds_read_b64_tr_b16 v[114:115], v58 offset:1024
    v_add_u32 v59, s101, v59
    v_mfma_f32_16x16x32_bf16 v[232:235], v[116:119], v[64:67], v[232:235]
    ds_read_b64_tr_b16 v[116:117], v59 offset:0
    s_waitcnt lgkmcnt(13)
    v_mfma_f32_16x16x32_bf16 v[240:243], v[120:123], v[64:67], v[240:243]
    ds_read_b64_tr_b16 v[118:119], v59 offset:1024
    v_add_u32 v60, s101, v60
    v_mfma_f32_16x16x32_bf16 v[244:247], v[120:123], v[68:71], v[244:247]
    ds_read_b64_tr_b16 v[120:121], v60 offset:0
    s_waitcnt lgkmcnt(13)
    v_mfma_f32_16x16x32_bf16 v[252:255], v[124:127], v[68:71], v[252:255]
    ds_read_b64_tr_b16 v[122:123], v60 offset:1024
    v_add_u32 v61, s101, v61
    v_mfma_f32_16x16x32_bf16 v[248:251], v[124:127], v[64:67], v[248:251]
    ds_read_b64_tr_b16 v[124:125], v61 offset:0
    ds_read_b64_tr_b16 v[126:127], v61 offset:1024
    buffer_load_dwordx4 v[64:67], v13, s[8:11], s86 offen offset:2048 sc1
    buffer_load_dwordx4 v[68:71], v12, s[8:11], s86 offen offset:2048 sc1
    s_waitcnt vmcnt(16)
    s_waitcnt lgkmcnt(14)
    v_mfma_f32_16x16x32_bf16 v[192:195], v[96:99], v[72:75], v[192:195]
    v_mfma_f32_16x16x32_bf16 v[196:199], v[96:99], v[76:79], v[196:199]
    ds_read_b64_tr_b16 v[96:97], v54 offset:8192
    s_waitcnt lgkmcnt(13)
    v_mfma_f32_16x16x32_bf16 v[204:207], v[100:103], v[76:79], v[204:207]
    ds_read_b64_tr_b16 v[98:99], v54 offset:9216
    v_mfma_f32_16x16x32_bf16 v[200:203], v[100:103], v[72:75], v[200:203]
    ds_read_b64_tr_b16 v[100:101], v55 offset:8192
    s_waitcnt lgkmcnt(13)
    v_mfma_f32_16x16x32_bf16 v[208:211], v[104:107], v[72:75], v[208:211]
    ds_read_b64_tr_b16 v[102:103], v55 offset:9216
    v_mfma_f32_16x16x32_bf16 v[212:215], v[104:107], v[76:79], v[212:215]
    ds_read_b64_tr_b16 v[104:105], v56 offset:8192
    s_waitcnt lgkmcnt(13)
    v_mfma_f32_16x16x32_bf16 v[220:223], v[108:111], v[76:79], v[220:223]
    ds_read_b64_tr_b16 v[106:107], v56 offset:9216
    v_mfma_f32_16x16x32_bf16 v[216:219], v[108:111], v[72:75], v[216:219]
    ds_read_b64_tr_b16 v[108:109], v57 offset:8192
    s_waitcnt lgkmcnt(13)
    v_mfma_f32_16x16x32_bf16 v[224:227], v[112:115], v[72:75], v[224:227]
    ds_read_b64_tr_b16 v[110:111], v57 offset:9216
    v_mfma_f32_16x16x32_bf16 v[228:231], v[112:115], v[76:79], v[228:231]
    ds_read_b64_tr_b16 v[112:113], v58 offset:8192
    s_waitcnt lgkmcnt(13)
    v_mfma_f32_16x16x32_bf16 v[236:239], v[116:119], v[76:79], v[236:239]
    ds_read_b64_tr_b16 v[114:115], v58 offset:9216
    v_mfma_f32_16x16x32_bf16 v[232:235], v[116:119], v[72:75], v[232:235]
    ds_read_b64_tr_b16 v[116:117], v59 offset:8192
    s_waitcnt lgkmcnt(13)
    v_mfma_f32_16x16x32_bf16 v[240:243], v[120:123], v[72:75], v[240:243]
    ds_read_b64_tr_b16 v[118:119], v59 offset:9216
    v_mfma_f32_16x16x32_bf16 v[244:247], v[120:123], v[76:79], v[244:247]
    ds_read_b64_tr_b16 v[120:121], v60 offset:8192
    s_waitcnt lgkmcnt(13)
    v_mfma_f32_16x16x32_bf16 v[252:255], v[124:127], v[76:79], v[252:255]
    ds_read_b64_tr_b16 v[122:123], v60 offset:9216
    v_mfma_f32_16x16x32_bf16 v[248:251], v[124:127], v[72:75], v[248:251]
    ds_read_b64_tr_b16 v[124:125], v61 offset:8192
    ds_read_b64_tr_b16 v[126:127], v61 offset:9216
    buffer_load_dwordx4 v[72:75], v13, s[8:11], s86 offen offset:3072 sc1
    buffer_load_dwordx4 v[76:79], v12, s[8:11], s86 offen offset:3072 sc1
    s_waitcnt vmcnt(16)
    s_waitcnt lgkmcnt(14)
    v_mfma_f32_16x16x32_bf16 v[192:195], v[96:99], v[80:83], v[192:195]
    v_mfma_f32_16x16x32_bf16 v[196:199], v[96:99], v[84:87], v[196:199]
    ds_read_b64_tr_b16 v[96:97], v54 offset:16384
    s_waitcnt lgkmcnt(13)
    v_mfma_f32_16x16x32_bf16 v[204:207], v[100:103], v[84:87], v[204:207]
    ds_read_b64_tr_b16 v[98:99], v54 offset:17408
    v_mfma_f32_16x16x32_bf16 v[200:203], v[100:103], v[80:83], v[200:203]
    ds_read_b64_tr_b16 v[100:101], v55 offset:16384
    s_waitcnt lgkmcnt(13)
    v_mfma_f32_16x16x32_bf16 v[208:211], v[104:107], v[80:83], v[208:211]
    ds_read_b64_tr_b16 v[102:103], v55 offset:17408
    v_mfma_f32_16x16x32_bf16 v[212:215], v[104:107], v[84:87], v[212:215]
    ds_read_b64_tr_b16 v[104:105], v56 offset:16384
    s_waitcnt lgkmcnt(13)
    v_mfma_f32_16x16x32_bf16 v[220:223], v[108:111], v[84:87], v[220:223]
    ds_read_b64_tr_b16 v[106:107], v56 offset:17408
    v_mfma_f32_16x16x32_bf16 v[216:219], v[108:111], v[80:83], v[216:219]
    ds_read_b64_tr_b16 v[108:109], v57 offset:16384
    s_waitcnt lgkmcnt(13)
    v_mfma_f32_16x16x32_bf16 v[224:227], v[112:115], v[80:83], v[224:227]
    ds_read_b64_tr_b16 v[110:111], v57 offset:17408
    v_mfma_f32_16x16x32_bf16 v[228:231], v[112:115], v[84:87], v[228:231]
    ds_read_b64_tr_b16 v[112:113], v58 offset:16384
    s_waitcnt lgkmcnt(13)
    v_mfma_f32_16x16x32_bf16 v[236:239], v[116:119], v[84:87], v[236:239]
    ds_read_b64_tr_b16 v[114:115], v58 offset:17408
    v_mfma_f32_16x16x32_bf16 v[232:235], v[116:119], v[80:83], v[232:235]
    ds_read_b64_tr_b16 v[116:117], v59 offset:16384
    s_waitcnt lgkmcnt(13)
    v_mfma_f32_16x16x32_bf16 v[240:243], v[120:123], v[80:83], v[240:243]
    ds_read_b64_tr_b16 v[118:119], v59 offset:17408
    v_mfma_f32_16x16x32_bf16 v[244:247], v[120:123], v[84:87], v[244:247]
    ds_read_b64_tr_b16 v[120:121], v60 offset:16384
    s_waitcnt lgkmcnt(13)
    v_mfma_f32_16x16x32_bf16 v[252:255], v[124:127], v[84:87], v[252:255]
    ds_read_b64_tr_b16 v[122:123], v60 offset:17408
    v_mfma_f32_16x16x32_bf16 v[248:251], v[124:127], v[80:83], v[248:251]
    ds_read_b64_tr_b16 v[124:125], v61 offset:16384
    ds_read_b64_tr_b16 v[126:127], v61 offset:17408
    buffer_load_dwordx4 v[80:83], v13, s[8:11], s87 offen offset:0 sc1
    buffer_load_dwordx4 v[84:87], v12, s[8:11], s87 offen offset:0 sc1
    s_waitcnt vmcnt(16)
    s_waitcnt lgkmcnt(14)
    v_mfma_f32_16x16x32_bf16 v[192:195], v[96:99], v[88:91], v[192:195]
    v_mfma_f32_16x16x32_bf16 v[196:199], v[96:99], v[92:95], v[196:199]
    ds_read_b64_tr_b16 v[96:97], v54 offset:24576
    s_waitcnt lgkmcnt(13)
    v_mfma_f32_16x16x32_bf16 v[204:207], v[100:103], v[92:95], v[204:207]
    ds_read_b64_tr_b16 v[98:99], v54 offset:25600
    v_mfma_f32_16x16x32_bf16 v[200:203], v[100:103], v[88:91], v[200:203]
    ds_read_b64_tr_b16 v[100:101], v55 offset:24576
    s_waitcnt lgkmcnt(13)
    v_mfma_f32_16x16x32_bf16 v[208:211], v[104:107], v[88:91], v[208:211]
    ds_read_b64_tr_b16 v[102:103], v55 offset:25600
    v_mfma_f32_16x16x32_bf16 v[212:215], v[104:107], v[92:95], v[212:215]
    ds_read_b64_tr_b16 v[104:105], v56 offset:24576
    s_waitcnt lgkmcnt(13)
    v_mfma_f32_16x16x32_bf16 v[220:223], v[108:111], v[92:95], v[220:223]
    ds_read_b64_tr_b16 v[106:107], v56 offset:25600
    v_mfma_f32_16x16x32_bf16 v[216:219], v[108:111], v[88:91], v[216:219]
    ds_read_b64_tr_b16 v[108:109], v57 offset:24576
    s_waitcnt lgkmcnt(13)
    v_mfma_f32_16x16x32_bf16 v[224:227], v[112:115], v[88:91], v[224:227]
    ds_read_b64_tr_b16 v[110:111], v57 offset:25600
    v_mfma_f32_16x16x32_bf16 v[228:231], v[112:115], v[92:95], v[228:231]
    ds_read_b64_tr_b16 v[112:113], v58 offset:24576
    s_waitcnt lgkmcnt(13)
    v_mfma_f32_16x16x32_bf16 v[236:239], v[116:119], v[92:95], v[236:239]
    ds_read_b64_tr_b16 v[114:115], v58 offset:25600
    v_mfma_f32_16x16x32_bf16 v[232:235], v[116:119], v[88:91], v[232:235]
    ds_read_b64_tr_b16 v[116:117], v59 offset:24576
    s_waitcnt lgkmcnt(13)
    v_mfma_f32_16x16x32_bf16 v[240:243], v[120:123], v[88:91], v[240:243]
    ds_read_b64_tr_b16 v[118:119], v59 offset:25600
    v_mfma_f32_16x16x32_bf16 v[244:247], v[120:123], v[92:95], v[244:247]
    ds_read_b64_tr_b16 v[120:121], v60 offset:24576
    s_waitcnt lgkmcnt(13)
    v_mfma_f32_16x16x32_bf16 v[252:255], v[124:127], v[92:95], v[252:255]
    ds_read_b64_tr_b16 v[122:123], v60 offset:25600
    v_mfma_f32_16x16x32_bf16 v[248:251], v[124:127], v[88:91], v[248:251]
    ds_read_b64_tr_b16 v[124:125], v61 offset:24576
    ds_read_b64_tr_b16 v[126:127], v61 offset:25600
    buffer_load_dwordx4 v[88:91], v13, s[8:11], s87 offen offset:1024 sc1
    buffer_load_dwordx4 v[92:95], v12, s[8:11], s87 offen offset:1024 sc1
    s_waitcnt vmcnt(8)
    s_lshl_b32 s6, s4, 3
    s_add_u32 s6, s6, s5
    s_lshl_b32 s6, s6, 5
    s_add_u32 s6, s6, s3
    s_lshl_b32 s6, s6, 2
    s_add_u32 s6, s6, 3866624
    v_mov_b32 v2, 1
    v_mov_b32 v3, 0x5000000
    v_writelane_b32 v3, s6, 0
    buffer_store_dword v2, v3, s[8:11], 0 offen sc1
    s_waitcnt lgkmcnt(14)
    v_mfma_f32_16x16x32_bf16 v[192:195], v[96:99], v[16:19], v[192:195]
    v_mfma_f32_16x16x32_bf16 v[196:199], v[96:99], v[20:23], v[196:199]
    ds_read_b64_tr_b16 v[96:97], v54 offset:32768
    s_waitcnt lgkmcnt(13)
    v_mfma_f32_16x16x32_bf16 v[204:207], v[100:103], v[20:23], v[204:207]
    ds_read_b64_tr_b16 v[98:99], v54 offset:33792
    v_mfma_f32_16x16x32_bf16 v[200:203], v[100:103], v[16:19], v[200:203]
    ds_read_b64_tr_b16 v[100:101], v55 offset:32768
    s_waitcnt lgkmcnt(13)
    v_mfma_f32_16x16x32_bf16 v[208:211], v[104:107], v[16:19], v[208:211]
    ds_read_b64_tr_b16 v[102:103], v55 offset:33792
    v_mfma_f32_16x16x32_bf16 v[212:215], v[104:107], v[20:23], v[212:215]
    ds_read_b64_tr_b16 v[104:105], v56 offset:32768
    s_waitcnt lgkmcnt(13)
    v_mfma_f32_16x16x32_bf16 v[220:223], v[108:111], v[20:23], v[220:223]
    ds_read_b64_tr_b16 v[106:107], v56 offset:33792
    v_mfma_f32_16x16x32_bf16 v[216:219], v[108:111], v[16:19], v[216:219]
    ds_read_b64_tr_b16 v[108:109], v57 offset:32768
    s_waitcnt lgkmcnt(13)
    v_mfma_f32_16x16x32_bf16 v[224:227], v[112:115], v[16:19], v[224:227]
    ds_read_b64_tr_b16 v[110:111], v57 offset:33792
    v_mfma_f32_16x16x32_bf16 v[228:231], v[112:115], v[20:23], v[228:231]
    ds_read_b64_tr_b16 v[112:113], v58 offset:32768
    s_waitcnt lgkmcnt(13)
    v_mfma_f32_16x16x32_bf16 v[236:239], v[116:119], v[20:23], v[236:239]
    ds_read_b64_tr_b16 v[114:115], v58 offset:33792
    v_mfma_f32_16x16x32_bf16 v[232:235], v[116:119], v[16:19], v[232:235]
    ds_read_b64_tr_b16 v[116:117], v59 offset:32768
    s_waitcnt lgkmcnt(13)
    v_mfma_f32_16x16x32_bf16 v[240:243], v[120:123], v[16:19], v[240:243]
    ds_read_b64_tr_b16 v[118:119], v59 offset:33792
    v_mfma_f32_16x16x32_bf16 v[244:247], v[120:123], v[20:23], v[244:247]
    ds_read_b64_tr_b16 v[120:121], v60 offset:32768
    s_waitcnt lgkmcnt(13)
    v_mfma_f32_16x16x32_bf16 v[252:255], v[124:127], v[20:23], v[252:255]
    ds_read_b64_tr_b16 v[122:123], v60 offset:33792
    v_mfma_f32_16x16x32_bf16 v[248:251], v[124:127], v[16:19], v[248:251]
    ds_read_b64_tr_b16 v[124:125], v61 offset:32768
    ds_read_b64_tr_b16 v[126:127], v61 offset:33792
    buffer_load_dwordx4 v[16:19], v13, s[8:11], s87 offen offset:2048 sc1
    buffer_load_dwordx4 v[20:23], v12, s[8:11], s87 offen offset:2048 sc1
    s_waitcnt lgkmcnt(14)
    v_mfma_f32_16x16x32_bf16 v[192:195], v[96:99], v[24:27], v[192:195]
    v_mfma_f32_16x16x32_bf16 v[196:199], v[96:99], v[28:31], v[196:199]
    ds_read_b64_tr_b16 v[96:97], v54 offset:40960
    s_waitcnt lgkmcnt(13)
    v_mfma_f32_16x16x32_bf16 v[204:207], v[100:103], v[28:31], v[204:207]
    ds_read_b64_tr_b16 v[98:99], v54 offset:41984
    v_mfma_f32_16x16x32_bf16 v[200:203], v[100:103], v[24:27], v[200:203]
    ds_read_b64_tr_b16 v[100:101], v55 offset:40960
    s_waitcnt lgkmcnt(13)
    v_mfma_f32_16x16x32_bf16 v[208:211], v[104:107], v[24:27], v[208:211]
    ds_read_b64_tr_b16 v[102:103], v55 offset:41984
    v_mfma_f32_16x16x32_bf16 v[212:215], v[104:107], v[28:31], v[212:215]
    ds_read_b64_tr_b16 v[104:105], v56 offset:40960
    s_waitcnt lgkmcnt(13)
    v_mfma_f32_16x16x32_bf16 v[220:223], v[108:111], v[28:31], v[220:223]
    ds_read_b64_tr_b16 v[106:107], v56 offset:41984
    v_mfma_f32_16x16x32_bf16 v[216:219], v[108:111], v[24:27], v[216:219]
    ds_read_b64_tr_b16 v[108:109], v57 offset:40960
    s_waitcnt lgkmcnt(13)
    v_mfma_f32_16x16x32_bf16 v[224:227], v[112:115], v[24:27], v[224:227]
    ds_read_b64_tr_b16 v[110:111], v57 offset:41984
    v_mfma_f32_16x16x32_bf16 v[228:231], v[112:115], v[28:31], v[228:231]
    ds_read_b64_tr_b16 v[112:113], v58 offset:40960
    s_waitcnt lgkmcnt(13)
    v_mfma_f32_16x16x32_bf16 v[236:239], v[116:119], v[28:31], v[236:239]
    ds_read_b64_tr_b16 v[114:115], v58 offset:41984
    v_mfma_f32_16x16x32_bf16 v[232:235], v[116:119], v[24:27], v[232:235]
    ds_read_b64_tr_b16 v[116:117], v59 offset:40960
    s_waitcnt lgkmcnt(13)
    v_mfma_f32_16x16x32_bf16 v[240:243], v[120:123], v[24:27], v[240:243]
    ds_read_b64_tr_b16 v[118:119], v59 offset:41984
    v_mfma_f32_16x16x32_bf16 v[244:247], v[120:123], v[28:31], v[244:247]
    ds_read_b64_tr_b16 v[120:121], v60 offset:40960
    s_waitcnt lgkmcnt(13)
    v_mfma_f32_16x16x32_bf16 v[252:255], v[124:127], v[28:31], v[252:255]
    ds_read_b64_tr_b16 v[122:123], v60 offset:41984
    v_mfma_f32_16x16x32_bf16 v[248:251], v[124:127], v[24:27], v[248:251]
    ds_read_b64_tr_b16 v[124:125], v61 offset:40960
    ds_read_b64_tr_b16 v[126:127], v61 offset:41984
    buffer_load_dwordx4 v[24:27], v13, s[8:11], s87 offen offset:3072 sc1
    buffer_load_dwordx4 v[28:31], v12, s[8:11], s87 offen offset:3072 sc1
    s_waitcnt lgkmcnt(14)
    v_mfma_f32_16x16x32_bf16 v[192:195], v[96:99], v[32:35], v[192:195]
    v_mfma_f32_16x16x32_bf16 v[196:199], v[96:99], v[36:39], v[196:199]
    ds_read_b64_tr_b16 v[96:97], v54 offset:49152
    s_waitcnt lgkmcnt(13)
    v_mfma_f32_16x16x32_bf16 v[204:207], v[100:103], v[36:39], v[204:207]
    ds_read_b64_tr_b16 v[98:99], v54 offset:50176
    v_mfma_f32_16x16x32_bf16 v[200:203], v[100:103], v[32:35], v[200:203]
    ds_read_b64_tr_b16 v[100:101], v55 offset:49152
    s_waitcnt lgkmcnt(13)
    v_mfma_f32_16x16x32_bf16 v[208:211], v[104:107], v[32:35], v[208:211]
    ds_read_b64_tr_b16 v[102:103], v55 offset:50176
    v_mfma_f32_16x16x32_bf16 v[212:215], v[104:107], v[36:39], v[212:215]
    ds_read_b64_tr_b16 v[104:105], v56 offset:49152
    s_waitcnt lgkmcnt(13)
    v_mfma_f32_16x16x32_bf16 v[220:223], v[108:111], v[36:39], v[220:223]
    ds_read_b64_tr_b16 v[106:107], v56 offset:50176
    v_mfma_f32_16x16x32_bf16 v[216:219], v[108:111], v[32:35], v[216:219]
    ds_read_b64_tr_b16 v[108:109], v57 offset:49152
    s_waitcnt lgkmcnt(13)
    v_mfma_f32_16x16x32_bf16 v[224:227], v[112:115], v[32:35], v[224:227]
    ds_read_b64_tr_b16 v[110:111], v57 offset:50176
    v_mfma_f32_16x16x32_bf16 v[228:231], v[112:115], v[36:39], v[228:231]
    ds_read_b64_tr_b16 v[112:113], v58 offset:49152
    s_waitcnt lgkmcnt(13)
    v_mfma_f32_16x16x32_bf16 v[236:239], v[116:119], v[36:39], v[236:239]
    ds_read_b64_tr_b16 v[114:115], v58 offset:50176
    v_mfma_f32_16x16x32_bf16 v[232:235], v[116:119], v[32:35], v[232:235]
    ds_read_b64_tr_b16 v[116:117], v59 offset:49152
    s_waitcnt lgkmcnt(13)
    v_mfma_f32_16x16x32_bf16 v[240:243], v[120:123], v[32:35], v[240:243]
    ds_read_b64_tr_b16 v[118:119], v59 offset:50176
    v_mfma_f32_16x16x32_bf16 v[244:247], v[120:123], v[36:39], v[244:247]
    ds_read_b64_tr_b16 v[120:121], v60 offset:49152
    s_waitcnt lgkmcnt(13)
    v_mfma_f32_16x16x32_bf16 v[252:255], v[124:127], v[36:39], v[252:255]
    ds_read_b64_tr_b16 v[122:123], v60 offset:50176
    v_mfma_f32_16x16x32_bf16 v[248:251], v[124:127], v[32:35], v[248:251]
    ds_read_b64_tr_b16 v[124:125], v61 offset:49152
    ds_read_b64_tr_b16 v[126:127], v61 offset:50176
    buffer_load_dwordx4 v[32:35], v13, s[8:11], s88 offen offset:0 sc1
    buffer_load_dwordx4 v[36:39], v12, s[8:11], s88 offen offset:0 sc1
    s_waitcnt vmcnt(13)
    s_waitcnt lgkmcnt(14)
    v_mfma_f32_16x16x32_bf16 v[192:195], v[96:99], v[64:67], v[192:195]
    v_mfma_f32_16x16x32_bf16 v[196:199], v[96:99], v[68:71], v[196:199]
    ds_read_b64_tr_b16 v[96:97], v54 offset:57344
    s_waitcnt lgkmcnt(13)
    v_mfma_f32_16x16x32_bf16 v[204:207], v[100:103], v[68:71], v[204:207]
    ds_read_b64_tr_b16 v[98:99], v54 offset:58368
    v_mfma_f32_16x16x32_bf16 v[200:203], v[100:103], v[64:67], v[200:203]
    ds_read_b64_tr_b16 v[100:101], v55 offset:57344
    s_waitcnt lgkmcnt(13)
    v_mfma_f32_16x16x32_bf16 v[208:211], v[104:107], v[64:67], v[208:211]
    ds_read_b64_tr_b16 v[102:103], v55 offset:58368
    v_mfma_f32_16x16x32_bf16 v[212:215], v[104:107], v[68:71], v[212:215]
    ds_read_b64_tr_b16 v[104:105], v56 offset:57344
    s_waitcnt lgkmcnt(13)
    v_mfma_f32_16x16x32_bf16 v[220:223], v[108:111], v[68:71], v[220:223]
    ds_read_b64_tr_b16 v[106:107], v56 offset:58368
    v_mfma_f32_16x16x32_bf16 v[216:219], v[108:111], v[64:67], v[216:219]
    ds_read_b64_tr_b16 v[108:109], v57 offset:57344
    s_waitcnt lgkmcnt(13)
    v_mfma_f32_16x16x32_bf16 v[224:227], v[112:115], v[64:67], v[224:227]
    ds_read_b64_tr_b16 v[110:111], v57 offset:58368
    v_mfma_f32_16x16x32_bf16 v[228:231], v[112:115], v[68:71], v[228:231]
    ds_read_b64_tr_b16 v[112:113], v58 offset:57344
    s_waitcnt lgkmcnt(13)
    v_mfma_f32_16x16x32_bf16 v[236:239], v[116:119], v[68:71], v[236:239]
    ds_read_b64_tr_b16 v[114:115], v58 offset:58368
    v_mfma_f32_16x16x32_bf16 v[232:235], v[116:119], v[64:67], v[232:235]
    ds_read_b64_tr_b16 v[116:117], v59 offset:57344
    s_waitcnt lgkmcnt(13)
    v_mfma_f32_16x16x32_bf16 v[240:243], v[120:123], v[64:67], v[240:243]
    ds_read_b64_tr_b16 v[118:119], v59 offset:58368
    v_mfma_f32_16x16x32_bf16 v[244:247], v[120:123], v[68:71], v[244:247]
    ds_read_b64_tr_b16 v[120:121], v60 offset:57344
    s_waitcnt lgkmcnt(13)
    v_mfma_f32_16x16x32_bf16 v[252:255], v[124:127], v[68:71], v[252:255]
    ds_read_b64_tr_b16 v[122:123], v60 offset:58368
    v_mfma_f32_16x16x32_bf16 v[248:251], v[124:127], v[64:67], v[248:251]
    ds_read_b64_tr_b16 v[124:125], v61 offset:57344
    ds_read_b64_tr_b16 v[126:127], v61 offset:58368
    buffer_load_dwordx4 v[64:67], v13, s[8:11], s88 offen offset:1024 sc1
    buffer_load_dwordx4 v[68:71], v12, s[8:11], s88 offen offset:1024 sc1
    s_waitcnt vmcnt(13)
    s_waitcnt lgkmcnt(14)
    v_mfma_f32_16x16x32_bf16 v[192:195], v[96:99], v[72:75], v[192:195]
    v_xor_b32 v54, 0x10000, v54
    v_mfma_f32_16x16x32_bf16 v[196:199], v[96:99], v[76:79], v[196:199]
    s_waitcnt lgkmcnt(12)
    v_mfma_f32_16x16x32_bf16 v[204:207], v[100:103], v[76:79], v[204:207]
    v_xor_b32 v55, 0x10000, v55
    v_mfma_f32_16x16x32_bf16 v[200:203], v[100:103], v[72:75], v[200:203]
    s_waitcnt lgkmcnt(0)
    s_barrier
    ds_read_b64_tr_b16 v[96:97], v54 offset:0
    ds_read_b64_tr_b16 v[98:99], v54 offset:1024
    ds_read_b64_tr_b16 v[100:101], v55 offset:0
    v_mfma_f32_16x16x32_bf16 v[208:211], v[104:107], v[72:75], v[208:211]
    ds_read_b64_tr_b16 v[102:103], v55 offset:1024
    v_xor_b32 v56, 0x10000, v56
    v_mfma_f32_16x16x32_bf16 v[212:215], v[104:107], v[76:79], v[212:215]
    ds_read_b64_tr_b16 v[104:105], v56 offset:0
    v_mfma_f32_16x16x32_bf16 v[220:223], v[108:111], v[76:79], v[220:223]
    ds_read_b64_tr_b16 v[106:107], v56 offset:1024
    v_xor_b32 v57, 0x10000, v57
    v_mfma_f32_16x16x32_bf16 v[216:219], v[108:111], v[72:75], v[216:219]
    ds_read_b64_tr_b16 v[108:109], v57 offset:0
    v_mfma_f32_16x16x32_bf16 v[224:227], v[112:115], v[72:75], v[224:227]
    ds_read_b64_tr_b16 v[110:111], v57 offset:1024
    v_xor_b32 v58, 0x10000, v58
    v_mfma_f32_16x16x32_bf16 v[228:231], v[112:115], v[76:79], v[228:231]
    ds_read_b64_tr_b16 v[112:113], v58 offset:0
    v_mfma_f32_16x16x32_bf16 v[236:239], v[116:119], v[76:79], v[236:239]
    ds_read_b64_tr_b16 v[114:115], v58 offset:1024
    v_xor_b32 v59, 0x10000, v59
    v_mfma_f32_16x16x32_bf16 v[232:235], v[116:119], v[72:75], v[232:235]
    ds_read_b64_tr_b16 v[116:117], v59 offset:0
    v_mfma_f32_16x16x32_bf16 v[240:243], v[120:123], v[72:75], v[240:243]
    ds_read_b64_tr_b16 v[118:119], v59 offset:1024
    v_xor_b32 v60, 0x10000, v60
    v_mfma_f32_16x16x32_bf16 v[244:247], v[120:123], v[76:79], v[244:247]
    ds_read_b64_tr_b16 v[120:121], v60 offset:0
    v_mfma_f32_16x16x32_bf16 v[252:255], v[124:127], v[76:79], v[252:255]
    ds_read_b64_tr_b16 v[122:123], v60 offset:1024
    v_xor_b32 v61, 0x10000, v61
    v_mfma_f32_16x16x32_bf16 v[248:251], v[124:127], v[72:75], v[248:251]
    ds_read_b64_tr_b16 v[124:125], v61 offset:0
    ds_read_b64_tr_b16 v[126:127], v61 offset:1024
    buffer_load_dwordx4 v[72:75], v13, s[8:11], s88 offen offset:2048 sc1
    buffer_load_dwordx4 v[76:79], v12, s[8:11], s88 offen offset:2048 sc1
    s_waitcnt vmcnt(13)
    s_waitcnt lgkmcnt(14)
    v_mfma_f32_16x16x32_bf16 v[192:195], v[96:99], v[80:83], v[192:195]
    v_mfma_f32_16x16x32_bf16 v[196:199], v[96:99], v[84:87], v[196:199]
    ds_read_b64_tr_b16 v[96:97], v54 offset:8192
    s_waitcnt lgkmcnt(13)
    v_mfma_f32_16x16x32_bf16 v[204:207], v[100:103], v[84:87], v[204:207]
    ds_read_b64_tr_b16 v[98:99], v54 offset:9216
    v_mfma_f32_16x16x32_bf16 v[200:203], v[100:103], v[80:83], v[200:203]
    ds_read_b64_tr_b16 v[100:101], v55 offset:8192
    s_waitcnt lgkmcnt(13)
    v_mfma_f32_16x16x32_bf16 v[208:211], v[104:107], v[80:83], v[208:211]
    ds_read_b64_tr_b16 v[102:103], v55 offset:9216
    v_mfma_f32_16x16x32_bf16 v[212:215], v[104:107], v[84:87], v[212:215]
    ds_read_b64_tr_b16 v[104:105], v56 offset:8192
    s_waitcnt lgkmcnt(13)
    v_mfma_f32_16x16x32_bf16 v[220:223], v[108:111], v[84:87], v[220:223]
    ds_read_b64_tr_b16 v[106:107], v56 offset:9216
    v_mfma_f32_16x16x32_bf16 v[216:219], v[108:111], v[80:83], v[216:219]
    ds_read_b64_tr_b16 v[108:109], v57 offset:8192
    s_waitcnt lgkmcnt(13)
    v_mfma_f32_16x16x32_bf16 v[224:227], v[112:115], v[80:83], v[224:227]
    ds_read_b64_tr_b16 v[110:111], v57 offset:9216
    v_mfma_f32_16x16x32_bf16 v[228:231], v[112:115], v[84:87], v[228:231]
    ds_read_b64_tr_b16 v[112:113], v58 offset:8192
    s_waitcnt lgkmcnt(13)
    v_mfma_f32_16x16x32_bf16 v[236:239], v[116:119], v[84:87], v[236:239]
    ds_read_b64_tr_b16 v[114:115], v58 offset:9216
    v_mfma_f32_16x16x32_bf16 v[232:235], v[116:119], v[80:83], v[232:235]
    ds_read_b64_tr_b16 v[116:117], v59 offset:8192
    s_waitcnt lgkmcnt(13)
    v_mfma_f32_16x16x32_bf16 v[240:243], v[120:123], v[80:83], v[240:243]
    ds_read_b64_tr_b16 v[118:119], v59 offset:9216
    v_mfma_f32_16x16x32_bf16 v[244:247], v[120:123], v[84:87], v[244:247]
    ds_read_b64_tr_b16 v[120:121], v60 offset:8192
    s_waitcnt lgkmcnt(13)
    v_mfma_f32_16x16x32_bf16 v[252:255], v[124:127], v[84:87], v[252:255]
    ds_read_b64_tr_b16 v[122:123], v60 offset:9216
    v_mfma_f32_16x16x32_bf16 v[248:251], v[124:127], v[80:83], v[248:251]
    ds_read_b64_tr_b16 v[124:125], v61 offset:8192
    ds_read_b64_tr_b16 v[126:127], v61 offset:9216
    buffer_load_dwordx4 v[80:83], v13, s[8:11], s88 offen offset:3072 sc1
    buffer_load_dwordx4 v[84:87], v12, s[8:11], s88 offen offset:3072 sc1
    s_waitcnt vmcnt(13)
    s_waitcnt lgkmcnt(14)
    v_mfma_f32_16x16x32_bf16 v[192:195], v[96:99], v[88:91], v[192:195]
    v_mfma_f32_16x16x32_bf16 v[196:199], v[96:99], v[92:95], v[196:199]
    ds_read_b64_tr_b16 v[96:97], v54 offset:16384
    s_waitcnt lgkmcnt(13)
    v_mfma_f32_16x16x32_bf16 v[204:207], v[100:103], v[92:95], v[204:207]
    ds_read_b64_tr_b16 v[98:99], v54 offset:17408
    v_mfma_f32_16x16x32_bf16 v[200:203], v[100:103], v[88:91], v[200:203]
    ds_read_b64_tr_b16 v[100:101], v55 offset:16384
    s_waitcnt lgkmcnt(13)
    v_mfma_f32_16x16x32_bf16 v[208:211], v[104:107], v[88:91], v[208:211]
    ds_read_b64_tr_b16 v[102:103], v55 offset:17408
    v_mfma_f32_16x16x32_bf16 v[212:215], v[104:107], v[92:95], v[212:215]
    ds_read_b64_tr_b16 v[104:105], v56 offset:16384
    s_waitcnt lgkmcnt(13)
    v_mfma_f32_16x16x32_bf16 v[220:223], v[108:111], v[92:95], v[220:223]
    ds_read_b64_tr_b16 v[106:107], v56 offset:17408
    v_mfma_f32_16x16x32_bf16 v[216:219], v[108:111], v[88:91], v[216:219]
    ds_read_b64_tr_b16 v[108:109], v57 offset:16384
    s_waitcnt lgkmcnt(13)
    v_mfma_f32_16x16x32_bf16 v[224:227], v[112:115], v[88:91], v[224:227]
    ds_read_b64_tr_b16 v[110:111], v57 offset:17408
    v_mfma_f32_16x16x32_bf16 v[228:231], v[112:115], v[92:95], v[228:231]
    ds_read_b64_tr_b16 v[112:113], v58 offset:16384
    s_waitcnt lgkmcnt(13)
    v_mfma_f32_16x16x32_bf16 v[236:239], v[116:119], v[92:95], v[236:239]
    ds_read_b64_tr_b16 v[114:115], v58 offset:17408
    v_mfma_f32_16x16x32_bf16 v[232:235], v[116:119], v[88:91], v[232:235]
    ds_read_b64_tr_b16 v[116:117], v59 offset:16384
    s_waitcnt lgkmcnt(13)
    v_mfma_f32_16x16x32_bf16 v[240:243], v[120:123], v[88:91], v[240:243]
    ds_read_b64_tr_b16 v[118:119], v59 offset:17408
    v_mfma_f32_16x16x32_bf16 v[244:247], v[120:123], v[92:95], v[244:247]
    ds_read_b64_tr_b16 v[120:121], v60 offset:16384
    s_waitcnt lgkmcnt(13)
    v_mfma_f32_16x16x32_bf16 v[252:255], v[124:127], v[92:95], v[252:255]
    ds_read_b64_tr_b16 v[122:123], v60 offset:17408
    v_mfma_f32_16x16x32_bf16 v[248:251], v[124:127], v[88:91], v[248:251]
    ds_read_b64_tr_b16 v[124:125], v61 offset:16384
    ds_read_b64_tr_b16 v[126:127], v61 offset:17408
    s_waitcnt vmcnt(10)
    s_waitcnt lgkmcnt(14)
    v_mfma_f32_16x16x32_bf16 v[192:195], v[96:99], v[16:19], v[192:195]
    v_mfma_f32_16x16x32_bf16 v[196:199], v[96:99], v[20:23], v[196:199]
    ds_read_b64_tr_b16 v[96:97], v54 offset:24576
    s_waitcnt lgkmcnt(13)
    v_mfma_f32_16x16x32_bf16 v[204:207], v[100:103], v[20:23], v[204:207]
    ds_read_b64_tr_b16 v[98:99], v54 offset:25600
    v_mfma_f32_16x16x32_bf16 v[200:203], v[100:103], v[16:19], v[200:203]
    ds_read_b64_tr_b16 v[100:101], v55 offset:24576
    s_waitcnt lgkmcnt(13)
    v_mfma_f32_16x16x32_bf16 v[208:211], v[104:107], v[16:19], v[208:211]
    ds_read_b64_tr_b16 v[102:103], v55 offset:25600
    v_mfma_f32_16x16x32_bf16 v[212:215], v[104:107], v[20:23], v[212:215]
    ds_read_b64_tr_b16 v[104:105], v56 offset:24576
    s_waitcnt lgkmcnt(13)
    v_mfma_f32_16x16x32_bf16 v[220:223], v[108:111], v[20:23], v[220:223]
    ds_read_b64_tr_b16 v[106:107], v56 offset:25600
    v_mfma_f32_16x16x32_bf16 v[216:219], v[108:111], v[16:19], v[216:219]
    ds_read_b64_tr_b16 v[108:109], v57 offset:24576
    s_waitcnt lgkmcnt(13)
    v_mfma_f32_16x16x32_bf16 v[224:227], v[112:115], v[16:19], v[224:227]
    ds_read_b64_tr_b16 v[110:111], v57 offset:25600
    v_mfma_f32_16x16x32_bf16 v[228:231], v[112:115], v[20:23], v[228:231]
    ds_read_b64_tr_b16 v[112:113], v58 offset:24576
    s_waitcnt lgkmcnt(13)
    v_mfma_f32_16x16x32_bf16 v[236:239], v[116:119], v[20:23], v[236:239]
    ds_read_b64_tr_b16 v[114:115], v58 offset:25600
    v_mfma_f32_16x16x32_bf16 v[232:235], v[116:119], v[16:19], v[232:235]
    ds_read_b64_tr_b16 v[116:117], v59 offset:24576
    s_waitcnt lgkmcnt(13)
    v_mfma_f32_16x16x32_bf16 v[240:243], v[120:123], v[16:19], v[240:243]
    ds_read_b64_tr_b16 v[118:119], v59 offset:25600
    v_mfma_f32_16x16x32_bf16 v[244:247], v[120:123], v[20:23], v[244:247]
    ds_read_b64_tr_b16 v[120:121], v60 offset:24576
    s_waitcnt lgkmcnt(13)
    v_mfma_f32_16x16x32_bf16 v[252:255], v[124:127], v[20:23], v[252:255]
    ds_read_b64_tr_b16 v[122:123], v60 offset:25600
    v_mfma_f32_16x16x32_bf16 v[248:251], v[124:127], v[16:19], v[248:251]
    ds_read_b64_tr_b16 v[124:125], v61 offset:24576
    ds_read_b64_tr_b16 v[126:127], v61 offset:25600
    s_waitcnt vmcnt(8)
    s_waitcnt lgkmcnt(14)
    v_mfma_f32_16x16x32_bf16 v[192:195], v[96:99], v[24:27], v[192:195]
    v_mfma_f32_16x16x32_bf16 v[196:199], v[96:99], v[28:31], v[196:199]
    ds_read_b64_tr_b16 v[96:97], v54 offset:32768
    s_waitcnt lgkmcnt(13)
    v_mfma_f32_16x16x32_bf16 v[204:207], v[100:103], v[28:31], v[204:207]
    ds_read_b64_tr_b16 v[98:99], v54 offset:33792
    v_mfma_f32_16x16x32_bf16 v[200:203], v[100:103], v[24:27], v[200:203]
    ds_read_b64_tr_b16 v[100:101], v55 offset:32768
    s_waitcnt lgkmcnt(13)
    v_mfma_f32_16x16x32_bf16 v[208:211], v[104:107], v[24:27], v[208:211]
    ds_read_b64_tr_b16 v[102:103], v55 offset:33792
    v_mfma_f32_16x16x32_bf16 v[212:215], v[104:107], v[28:31], v[212:215]
    ds_read_b64_tr_b16 v[104:105], v56 offset:32768
    s_waitcnt lgkmcnt(13)
    v_mfma_f32_16x16x32_bf16 v[220:223], v[108:111], v[28:31], v[220:223]
    ds_read_b64_tr_b16 v[106:107], v56 offset:33792
    v_mfma_f32_16x16x32_bf16 v[216:219], v[108:111], v[24:27], v[216:219]
    ds_read_b64_tr_b16 v[108:109], v57 offset:32768
    s_waitcnt lgkmcnt(13)
    v_mfma_f32_16x16x32_bf16 v[224:227], v[112:115], v[24:27], v[224:227]
    ds_read_b64_tr_b16 v[110:111], v57 offset:33792
    v_mfma_f32_16x16x32_bf16 v[228:231], v[112:115], v[28:31], v[228:231]
    ds_read_b64_tr_b16 v[112:113], v58 offset:32768
    s_waitcnt lgkmcnt(13)
    v_mfma_f32_16x16x32_bf16 v[236:239], v[116:119], v[28:31], v[236:239]
    ds_read_b64_tr_b16 v[114:115], v58 offset:33792
    v_mfma_f32_16x16x32_bf16 v[232:235], v[116:119], v[24:27], v[232:235]
    ds_read_b64_tr_b16 v[116:117], v59 offset:32768
    s_waitcnt lgkmcnt(13)
    v_mfma_f32_16x16x32_bf16 v[240:243], v[120:123], v[24:27], v[240:243]
    ds_read_b64_tr_b16 v[118:119], v59 offset:33792
    v_mfma_f32_16x16x32_bf16 v[244:247], v[120:123], v[28:31], v[244:247]
    ds_read_b64_tr_b16 v[120:121], v60 offset:32768
    s_waitcnt lgkmcnt(13)
    v_mfma_f32_16x16x32_bf16 v[252:255], v[124:127], v[28:31], v[252:255]
    ds_read_b64_tr_b16 v[122:123], v60 offset:33792
    v_mfma_f32_16x16x32_bf16 v[248:251], v[124:127], v[24:27], v[248:251]
    ds_read_b64_tr_b16 v[124:125], v61 offset:32768
    ds_read_b64_tr_b16 v[126:127], v61 offset:33792
    s_waitcnt vmcnt(0)
    s_cmp_ge_u32 s3, 4
    s_cbranch_scc1 L_q_nold
    s_lshl_b32 s7, s4, 10
    s_add_u32 s7, s7, 3866624
    v_lshrrev_b32 v2, 3, v1
    v_and_b32 v3, 7, v1
    v_lshlrev_b32 v3, 2, v3
    v_lshl_add_u32 v3, v2, 7, v3
    s_mov_b32 s79, 262144
L_poll_7:
    buffer_load_dword v2, v3, s[8:11], s7 offen sc1
    s_waitcnt vmcnt(0)
    v_cmp_gt_u32 vcc, 1, v2
    s_cbranch_vccz L_polldone_8
    s_sleep 2
    s_sub_u32 s79, s79, 1
    s_cmp_lg_u32 s79, 0
    s_cbranch_scc1 L_poll_7
L_polldone_8:
    s_lshl_b32 s6, s76, 13
    s_add_u32 s6, s6, s78
    s_add_u32 m0, s6, 0
    s_add_u32 s7, s77, 0
    buffer_load_dwordx4 v49, s[8:11], s7 offen offset:0 sc1 lds
    buffer_load_dwordx4 v49, s[8:11], s7 offen offset:1024 sc1 lds
    buffer_load_dwordx4 v49, s[8:11], s7 offen offset:2048 sc1 lds
    buffer_load_dwordx4 v49, s[8:11], s7 offen offset:3072 sc1 lds
    s_lshl_b32 s6, s76, 13
    s_add_u32 s6, s6, s78
    s_add_u32 m0, s6, 4096
    s_add_u32 s7, s77, 4096
    buffer_load_dwordx4 v49, s[8:11], s7 offen offset:0 sc1 lds
    buffer_load_dwordx4 v49, s[8:11], s7 offen offset:1024 sc1 lds
    buffer_load_dwordx4 v49, s[8:11], s7 offen offset:2048 sc1 lds
    buffer_load_dwordx4 v49, s[8:11], s7 offen offset:3072 sc1 lds
    s_lshl_b32 s6, s76, 12
    s_add_u32 s6, s6, s78
    s_add_u32 m0, s6, 49152
    s_add_u32 s7, s77, 524288
    buffer_load_dwordx4 v50, s[8:11], s7 offen offset:0 sc1 lds
    buffer_load_dwordx4 v50, s[8:11], s7 offen offset:1024 sc1 lds
    buffer_load_dwordx4 v50, s[8:11], s7 offen offset:2048 sc1 lds
    buffer_load_dwordx4 v50, s[8:11], s7 offen offset:3072 sc1 lds
L_q_nold:
    s_waitcnt lgkmcnt(14)
    v_mfma_f32_16x16x32_bf16 v[192:195], v[96:99], v[32:35], v[192:195]
    v_mfma_f32_16x16x32_bf16 v[196:199], v[96:99], v[36:39], v[196:199]
    ds_read_b64_tr_b16 v[96:97], v54 offset:40960
    s_waitcnt lgkmcnt(13)
    v_mfma_f32_16x16x32_bf16 v[204:207], v[100:103], v[36:39], v[204:207]
    ds_read_b64_tr_b16 v[98:99], v54 offset:41984
    v_mfma_f32_16x16x32_bf16 v[200:203], v[100:103], v[32:35], v[200:203]
    ds_read_b64_tr_b16 v[100:101], v55 offset:40960
    s_waitcnt lgkmcnt(13)
    v_mfma_f32_16x16x32_bf16 v[208:211], v[104:107], v[32:35], v[208:211]
    ds_read_b64_tr_b16 v[102:103], v55 offset:41984
    v_mfma_f32_16x16x32_bf16 v[212:215], v[104:107], v[36:39], v[212:215]
    ds_read_b64_tr_b16 v[104:105], v56 offset:40960
    s_waitcnt lgkmcnt(13)
    v_mfma_f32_16x16x32_bf16 v[220:223], v[108:111], v[36:39], v[220:223]
    ds_read_b64_tr_b16 v[106:107], v56 offset:41984
    buffer_store_dwordx4 v[144:147], v13, s[8:11], s67 offen sc1
    s_add_u32 s67, s67, 1024
    v_mfma_f32_16x16x32_bf16 v[216:219], v[108:111], v[32:35], v[216:219]
    ds_read_b64_tr_b16 v[108:109], v57 offset:40960
    s_waitcnt lgkmcnt(13)
    v_mfma_f32_16x16x32_bf16 v[224:227], v[112:115], v[32:35], v[224:227]
    ds_read_b64_tr_b16 v[110:111], v57 offset:41984
    v_mfma_f32_16x16x32_bf16 v[228:231], v[112:115], v[36:39], v[228:231]
    ds_read_b64_tr_b16 v[112:113], v58 offset:40960
    s_waitcnt lgkmcnt(13)
    v_mfma_f32_16x16x32_bf16 v[236:239], v[116:119], v[36:39], v[236:239]
    ds_read_b64_tr_b16 v[114:115], v58 offset:41984
    v_mfma_f32_16x16x32_bf16 v[232:235], v[116:119], v[32:35], v[232:235]
    ds_read_b64_tr_b16 v[116:117], v59 offset:40960
    s_waitcnt lgkmcnt(13)
    v_mfma_f32_16x16x32_bf16 v[240:243], v[120:123], v[32:35], v[240:243]
    ds_read_b64_tr_b16 v[118:119], v59 offset:41984
    v_mfma_f32_16x16x32_bf16 v[244:247], v[120:123], v[36:39], v[244:247]
    ds_read_b64_tr_b16 v[120:121], v60 offset:40960
    s_waitcnt lgkmcnt(13)
    v_mfma_f32_16x16x32_bf16 v[252:255], v[124:127], v[36:39], v[252:255]
    ds_read_b64_tr_b16 v[122:123], v60 offset:41984
    v_mfma_f32_16x16x32_bf16 v[248:251], v[124:127], v[32:35], v[248:251]
    ds_read_b64_tr_b16 v[124:125], v61 offset:40960
    ds_read_b64_tr_b16 v[126:127], v61 offset:41984
    s_waitcnt lgkmcnt(14)
    v_mfma_f32_16x16x32_bf16 v[192:195], v[96:99], v[64:67], v[192:195]
    v_mfma_f32_16x16x32_bf16 v[196:199], v[96:99], v[68:71], v[196:199]
    ds_read_b64_tr_b16 v[96:97], v54 offset:49152
    s_waitcnt lgkmcnt(13)
    v_mfma_f32_16x16x32_bf16 v[204:207], v[100:103], v[68:71], v[204:207]
    ds_read_b64_tr_b16 v[98:99], v54 offset:50176
    v_mfma_f32_16x16x32_bf16 v[200:203], v[100:103], v[64:67], v[200:203]
    ds_read_b64_tr_b16 v[100:101], v55 offset:49152
    s_waitcnt lgkmcnt(13)
    v_mfma_f32_16x16x32_bf16 v[208:211], v[104:107], v[64:67], v[208:211]
    ds_read_b64_tr_b16 v[102:103], v55 offset:50176
    v_mfma_f32_16x16x32_bf16 v[212:215], v[104:107], v[68:71], v[212:215]
    ds_read_b64_tr_b16 v[104:105], v56 offset:49152
    s_waitcnt lgkmcnt(13)
    v_mfma_f32_16x16x32_bf16 v[220:223], v[108:111], v[68:71], v[220:223]
    ds_read_b64_tr_b16 v[106:107], v56 offset:50176
    buffer_store_dwordx4 v[148:151], v13, s[8:11], s67 offen sc1
    s_add_u32 s67, s67, s68
    v_mfma_f32_16x16x32_bf16 v[216:219], v[108:111], v[64:67], v[216:219]
    ds_read_b64_tr_b16 v[108:109], v57 offset:49152
    s_waitcnt lgkmcnt(13)
    v_mfma_f32_16x16x32_bf16 v[224:227], v[112:115], v[64:67], v[224:227]
    ds_read_b64_tr_b16 v[110:111], v57 offset:50176
    v_mfma_f32_16x16x32_bf16 v[228:231], v[112:115], v[68:71], v[228:231]
    ds_read_b64_tr_b16 v[112:113], v58 offset:49152
    s_waitcnt lgkmcnt(13)
    v_mfma_f32_16x16x32_bf16 v[236:239], v[116:119], v[68:71], v[236:239]
    ds_read_b64_tr_b16 v[114:115], v58 offset:50176
    v_mfma_f32_16x16x32_bf16 v[232:235], v[116:119], v[64:67], v[232:235]
    ds_read_b64_tr_b16 v[116:117], v59 offset:49152
    s_waitcnt lgkmcnt(13)
    v_mfma_f32_16x16x32_bf16 v[240:243], v[120:123], v[64:67], v[240:243]
    ds_read_b64_tr_b16 v[118:119], v59 offset:50176
    v_mfma_f32_16x16x32_bf16 v[244:247], v[120:123], v[68:71], v[244:247]
    ds_read_b64_tr_b16 v[120:121], v60 offset:49152
    s_waitcnt lgkmcnt(13)
    v_mfma_f32_16x16x32_bf16 v[252:255], v[124:127], v[68:71], v[252:255]
    ds_read_b64_tr_b16 v[122:123], v60 offset:50176
    v_mfma_f32_16x16x32_bf16 v[248:251], v[124:127], v[64:67], v[248:251]
    ds_read_b64_tr_b16 v[124:125], v61 offset:49152
    ds_read_b64_tr_b16 v[126:127], v61 offset:50176
    s_waitcnt lgkmcnt(14)
    v_mfma_f32_16x16x32_bf16 v[192:195], v[96:99], v[72:75], v[192:195]
    v_mfma_f32_16x16x32_bf16 v[196:199], v[96:99], v[76:79], v[196:199]
    ds_read_b64_tr_b16 v[96:97], v54 offset:57344
    s_waitcnt lgkmcnt(13)
    v_mfma_f32_16x16x32_bf16 v[204:207], v[100:103], v[76:79], v[204:207]
    ds_read_b64_tr_b16 v[98:99], v54 offset:58368
    v_mfma_f32_16x16x32_bf16 v[200:203], v[100:103], v[72:75], v[200:203]
    ds_read_b64_tr_b16 v[100:101], v55 offset:57344
    s_waitcnt lgkmcnt(13)
    v_mfma_f32_16x16x32_bf16 v[208:211], v[104:107], v[72:75], v[208:211]
    ds_read_b64_tr_b16 v[102:103], v55 offset:58368
    v_mfma_f32_16x16x32_bf16 v[212:215], v[104:107], v[76:79], v[212:215]
    ds_read_b64_tr_b16 v[104:105], v56 offset:57344
    s_waitcnt lgkmcnt(13)
    v_mfma_f32_16x16x32_bf16 v[220:223], v[108:111], v[76:79], v[220:223]
    ds_read_b64_tr_b16 v[106:107], v56 offset:58368
    buffer_store_dwordx4 v[152:155], v13, s[8:11], s67 offen sc1
    s_add_u32 s67, s67, 1024
    v_mfma_f32_16x16x32_bf16 v[216:219], v[108:111], v[72:75], v[216:219]
    ds_read_b64_tr_b16 v[108:109], v57 offset:57344
    s_waitcnt lgkmcnt(13)
    v_mfma_f32_16x16x32_bf16 v[224:227], v[112:115], v[72:75], v[224:227]
    ds_read_b64_tr_b16 v[110:111], v57 offset:58368
    v_mfma_f32_16x16x32_bf16 v[228:231], v[112:115], v[76:79], v[228:231]
    ds_read_b64_tr_b16 v[112:113], v58 offset:57344
    s_waitcnt lgkmcnt(13)
    v_mfma_f32_16x16x32_bf16 v[236:239], v[116:119], v[76:79], v[236:239]
    ds_read_b64_tr_b16 v[114:115], v58 offset:58368
    v_mfma_f32_16x16x32_bf16 v[232:235], v[116:119], v[72:75], v[232:235]
    ds_read_b64_tr_b16 v[116:117], v59 offset:57344
    s_waitcnt lgkmcnt(13)
    v_mfma_f32_16x16x32_bf16 v[240:243], v[120:123], v[72:75], v[240:243]
    ds_read_b64_tr_b16 v[118:119], v59 offset:58368
    v_mfma_f32_16x16x32_bf16 v[244:247], v[120:123], v[76:79], v[244:247]
    ds_read_b64_tr_b16 v[120:121], v60 offset:57344
    s_waitcnt lgkmcnt(13)
    v_mfma_f32_16x16x32_bf16 v[252:255], v[124:127], v[76:79], v[252:255]
    ds_read_b64_tr_b16 v[122:123], v60 offset:58368
    v_mfma_f32_16x16x32_bf16 v[248:251], v[124:127], v[72:75], v[248:251]
    ds_read_b64_tr_b16 v[124:125], v61 offset:57344
    ds_read_b64_tr_b16 v[126:127], v61 offset:58368
    s_waitcnt lgkmcnt(14)
    v_mfma_f32_16x16x32_bf16 v[192:195], v[96:99], v[80:83], v[192:195]
    v_mfma_f32_16x16x32_bf16 v[196:199], v[96:99], v[84:87], v[196:199]
    s_waitcnt lgkmcnt(12)
    v_mfma_f32_16x16x32_bf16 v[204:207], v[100:103], v[84:87], v[204:207]
    v_mfma_f32_16x16x32_bf16 v[200:203], v[100:103], v[80:83], v[200:203]
    s_waitcnt lgkmcnt(10)
    v_mfma_f32_16x16x32_bf16 v[208:211], v[104:107], v[80:83], v[208:211]
    v_mfma_f32_16x16x32_bf16 v[212:215], v[104:107], v[84:87], v[212:215]
    s_waitcnt lgkmcnt(8)
    v_mfma_f32_16x16x32_bf16 v[220:223], v[108:111], v[84:87], v[220:223]
    buffer_store_dwordx4 v[156:159], v13, s[8:11], s67 offen sc1
    s_add_u32 s67, s67, s69
    v_mfma_f32_16x16x32_bf16 v[216:219], v[108:111], v[80:83], v[216:219]
    s_waitcnt lgkmcnt(6)
    v_mfma_f32_16x16x32_bf16 v[224:227], v[112:115], v[80:83], v[224:227]
    v_mfma_f32_16x16x32_bf16 v[228:231], v[112:115], v[84:87], v[228:231]
    s_waitcnt lgkmcnt(4)
    v_mfma_f32_16x16x32_bf16 v[236:239], v[116:119], v[84:87], v[236:239]
    v_mfma_f32_16x16x32_bf16 v[232:235], v[116:119], v[80:83], v[232:235]
    s_waitcnt lgkmcnt(2)
    v_mfma_f32_16x16x32_bf16 v[240:243], v[120:123], v[80:83], v[240:243]
    v_mfma_f32_16x16x32_bf16 v[244:247], v[120:123], v[84:87], v[244:247]
    s_waitcnt lgkmcnt(0)
    v_mfma_f32_16x16x32_bf16 v[252:255], v[124:127], v[84:87], v[252:255]
    v_mfma_f32_16x16x32_bf16 v[248:251], v[124:127], v[80:83], v[248:251]
    s_cmp_lt_u32 s3, 4
    s_cbranch_scc1 L_qb
    s_barrier
L_qb:
    s_mov_b32 s6, 0x3e0293ee
    s_nop 7
    buffer_store_dwordx4 v[160:163], v13, s[8:11], s67 offen sc1
    s_add_u32 s67, s67, 1024
    buffer_store_dwordx4 v[164:167], v13, s[8:11], s67 offen sc1
    s_add_u32 s67, s67, s68
    buffer_store_dwordx4 v[168:171], v13, s[8:11], s67 offen sc1
    s_add_u32 s67, s67, 1024
    buffer_store_dwordx4 v[172:175], v13, s[8:11], s67 offen sc1
    s_add_u32 s67, s67, s69
    v_mul_f32 v192, s6, v192
    v_mul_f32 v193, s6, v193
    v_mul_f32 v194, s6, v194
    v_mul_f32 v195, s6, v195
    v_cvt_pk_bf16_f32 v16, v192, v193
    v_cvt_pk_bf16_f32 v17, v194, v195
    v_mul_f32 v200, s6, v200
    v_mul_f32 v201, s6, v201
    v_mul_f32 v202, s6, v202
    v_mul_f32 v203, s6, v203
    v_cvt_pk_bf16_f32 v18, v200, v201
    v_cvt_pk_bf16_f32 v19, v202, v203
    v_mul_f32 v208, s6, v208
    v_mul_f32 v209, s6, v209
    v_mul_f32 v210, s6, v210
    v_mul_f32 v211, s6, v211
    v_cvt_pk_bf16_f32 v20, v208, v209
    v_cvt_pk_bf16_f32 v21, v210, v211
    v_mul_f32 v216, s6, v216
    v_mul_f32 v217, s6, v217
    v_mul_f32 v218, s6, v218
    v_mul_f32 v219, s6, v219
    v_cvt_pk_bf16_f32 v22, v216, v217
    v_cvt_pk_bf16_f32 v23, v218, v219
    v_mul_f32 v224, s6, v224
    v_mul_f32 v225, s6, v225
    v_mul_f32 v226, s6, v226
    v_mul_f32 v227, s6, v227
    v_cvt_pk_bf16_f32 v24, v224, v225
    v_cvt_pk_bf16_f32 v25, v226, v227
    v_mul_f32 v232, s6, v232
    v_mul_f32 v233, s6, v233
    v_mul_f32 v234, s6, v234
    v_mul_f32 v235, s6, v235
    v_cvt_pk_bf16_f32 v26, v232, v233
    v_cvt_pk_bf16_f32 v27, v234, v235
    v_mul_f32 v240, s6, v240
    v_mul_f32 v241, s6, v241
    v_mul_f32 v242, s6, v242
    v_mul_f32 v243, s6, v243
    v_cvt_pk_bf16_f32 v28, v240, v241
    v_cvt_pk_bf16_f32 v29, v242, v243
    v_mul_f32 v248, s6, v248
    v_mul_f32 v249, s6, v249
    v_mul_f32 v250, s6, v250
    v_mul_f32 v251, s6, v251
    v_cvt_pk_bf16_f32 v30, v248, v249
    v_cvt_pk_bf16_f32 v31, v250, v251
    v_mul_f32 v196, s6, v196
    v_mul_f32 v197, s6, v197
    v_mul_f32 v198, s6, v198
    v_mul_f32 v199, s6, v199
    v_cvt_pk_bf16_f32 v32, v196, v197
    v_cvt_pk_bf16_f32 v33, v198, v199
    v_mul_f32 v204, s6, v204
    v_mul_f32 v205, s6, v205
    v_mul_f32 v206, s6, v206
    v_mul_f32 v207, s6, v207
    v_cvt_pk_bf16_f32 v34, v204, v205
    v_cvt_pk_bf16_f32 v35, v206, v207
    v_mul_f32 v212, s6, v212
    v_mul_f32 v213, s6, v213
    v_mul_f32 v214, s6, v214
    v_mul_f32 v215, s6, v215
    v_cvt_pk_bf16_f32 v36, v212, v213
    v_cvt_pk_bf16_f32 v37, v214, v215
    v_mul_f32 v220, s6, v220
    v_mul_f32 v221, s6, v221
    v_mul_f32 v222, s6, v222
    v_mul_f32 v223, s6, v223
    v_cvt_pk_bf16_f32 v38, v220, v221
    v_cvt_pk_bf16_f32 v39, v222, v223
    v_mul_f32 v228, s6, v228
    v_mul_f32 v229, s6, v229
    v_mul_f32 v230, s6, v230
    v_mul_f32 v231, s6, v231
    v_cvt_pk_bf16_f32 v40, v228, v229
    v_cvt_pk_bf16_f32 v41, v230, v231
    v_mul_f32 v236, s6, v236
    v_mul_f32 v237, s6, v237
    v_mul_f32 v238, s6, v238
    v_mul_f32 v239, s6, v239
    v_cvt_pk_bf16_f32 v42, v236, v237
    v_cvt_pk_bf16_f32 v43, v238, v239
    v_mul_f32 v244, s6, v244
    v_mul_f32 v245, s6, v245
    v_mul_f32 v246, s6, v246
    v_mul_f32 v247, s6, v247
    v_cvt_pk_bf16_f32 v44, v244, v245
    v_cvt_pk_bf16_f32 v45, v246, v247
    v_mul_f32 v252, s6, v252
    v_mul_f32 v253, s6, v253
    v_mul_f32 v254, s6, v254
    v_mul_f32 v255, s6, v255
    v_cvt_pk_bf16_f32 v46, v252, v253
    v_cvt_pk_bf16_f32 v47, v254, v255
    v_mov_b64 v[192:193], 0
    v_mov_b64 v[194:195], 0
    v_mov_b64 v[196:197], 0
    v_mov_b64 v[198:199], 0
    v_mov_b64 v[200:201], 0
    v_mov_b64 v[202:203], 0
    v_mov_b64 v[204:205], 0
    v_mov_b64 v[206:207], 0
    v_mov_b64 v[208:209], 0
    v_mov_b64 v[210:211], 0
    v_mov_b64 v[212:213], 0
    v_mov_b64 v[214:215], 0
    v_mov_b64 v[216:217], 0
    v_mov_b64 v[218:219], 0
    v_mov_b64 v[220:221], 0
    v_mov_b64 v[222:223], 0
    v_mov_b64 v[224:225], 0
    v_mov_b64 v[226:227], 0
    v_mov_b64 v[228:229], 0
    v_mov_b64 v[230:231], 0
    v_mov_b64 v[232:233], 0
    v_mov_b64 v[234:235], 0
    v_mov_b64 v[236:237], 0
    v_mov_b64 v[238:239], 0
    v_mov_b64 v[240:241], 0
    v_mov_b64 v[242:243], 0
    v_mov_b64 v[244:245], 0
    v_mov_b64 v[246:247], 0
    v_mov_b64 v[248:249], 0
    v_mov_b64 v[250:251], 0
    v_mov_b64 v[252:253], 0
    v_mov_b64 v[254:255], 0
    v_mov_b64 v[144:145], 0
    v_mov_b64 v[146:147], 0
    v_mov_b64 v[148:149], 0
    v_mov_b64 v[150:151], 0
    v_mov_b64 v[152:153], 0
    v_mov_b64 v[154:155], 0
    v_mov_b64 v[156:157], 0
    v_mov_b64 v[158:159], 0
    v_mov_b64 v[160:161], 0
    v_mov_b64 v[162:163], 0
    v_bfe_u32 v2, v1, 1, 1
    v_lshrrev_b32 v3, 5, v1
    v_cmp_eq_u32 vcc, v2, v3
    v_mov_b32 v2, 0x3f803f80
    v_and_b32 v3, 1, v1
    v_mul_u32_u24 v3, 0xaaaa, v3
    v_add_u32 v168, 0x4444, v3
    v_cndmask_b32 v164, 0, v2, vcc
    v_cndmask_b32 v165, 0, v2, vcc
    v_cndmask_b32 v166, 0, v2, vcc
    v_cndmask_b32 v167, 0, v2, vcc
    v_add_u32 v48, s100, v13
    s_waitcnt vmcnt(8)
    s_mov_b32 s72, 0x40004000
    s_mov_b32 s65, 0
    s_sub_u32 s63, 15, s5
    s_mov_b32 s62, -1
    s_cmp_ge_u32 s3, 4
    s_cbranch_scc1 L_qb2
    s_barrier
L_qb2:
    ds_read_b128 v[96:99], v48 offset:0
    ds_read_b128 v[100:103], v48 offset:1024
    ds_read_b128 v[104:107], v48 offset:2048
    ds_read_b128 v[108:111], v48 offset:3072
    ds_read_b128 v[112:115], v48 offset:4096
    ds_read_b128 v[116:119], v48 offset:5120
    ds_read_b128 v[120:123], v48 offset:6144
    ds_read_b128 v[124:127], v48 offset:7168
    s_cmp_lg_u32 s60, 0
    s_cbranch_scc1 L_nm0
    s_call_b64 s[82:83], L_mask
L_nm0:
    s_waitcnt lgkmcnt(7)
    v_mfma_f32_16x16x32_bf16 v[64:67], v[96:99], v[16:19], v[144:147]
    v_mfma_f32_16x16x32_bf16 v[68:71], v[96:99], v[32:35], v[148:151]
    ds_read_b128 v[96:99], v48 offset:8192
    s_waitcnt lgkmcnt(7)
    v_mfma_f32_16x16x32_bf16 v[64:67], v[100:103], v[20:23], v[64:67]
    v_mfma_f32_16x16x32_bf16 v[68:71], v[100:103], v[36:39], v[68:71]
    ds_read_b128 v[100:103], v48 offset:9216
    s_waitcnt lgkmcnt(7)
    v_mfma_f32_16x16x32_bf16 v[64:67], v[104:107], v[24:27], v[64:67]
    v_mfma_f32_16x16x32_bf16 v[68:71], v[104:107], v[40:43], v[68:71]
    ds_read_b128 v[104:107], v48 offset:10240
    s_waitcnt lgkmcnt(7)
    v_mfma_f32_16x16x32_bf16 v[64:67], v[108:111], v[28:31], v[64:67]
    v_mfma_f32_16x16x32_bf16 v[68:71], v[108:111], v[44:47], v[68:71]
    ds_read_b128 v[108:111], v48 offset:11264
    s_waitcnt lgkmcnt(7)
    v_mfma_f32_16x16x32_bf16 v[72:75], v[112:115], v[16:19], v[152:155]
    v_mfma_f32_16x16x32_bf16 v[76:79], v[112:115], v[32:35], v[156:159]
    ds_read_b128 v[112:115], v48 offset:12288
    s_waitcnt lgkmcnt(7)
    v_mfma_f32_16x16x32_bf16 v[72:75], v[116:119], v[20:23], v[72:75]
    v_mfma_f32_16x16x32_bf16 v[76:79], v[116:119], v[36:39], v[76:79]
    ds_read_b128 v[116:119], v48 offset:13312
    s_waitcnt lgkmcnt(7)
    v_mfma_f32_16x16x32_bf16 v[72:75], v[120:123], v[24:27], v[72:75]
    v_mfma_f32_16x16x32_bf16 v[76:79], v[120:123], v[40:43], v[76:79]
    ds_read_b128 v[120:123], v48 offset:14336
    s_waitcnt lgkmcnt(7)
    v_mfma_f32_16x16x32_bf16 v[72:75], v[124:127], v[28:31], v[72:75]
    v_mfma_f32_16x16x32_bf16 v[76:79], v[124:127], v[44:47], v[76:79]
    ds_read_b128 v[124:127], v48 offset:15360
    s_nop 7
    v_max3_f32 v58, v64, v65, v66
    v_max3_f32 v58, v58, v67, v72
    v_max3_f32 v58, v58, v73, v74
    v_max_f32 v58, v58, v75
    v_mov_b32 v60, v58
    s_nop 1
    v_permlane16_swap_b32 v58, v60
    s_nop 1
    v_max_f32 v58, v58, v60
    v_mov_b32 v60, v58
    s_nop 1
    v_permlane32_swap_b32 v58, v60
    s_nop 1
    v_max_f32 v58, v58, v60
    v_add_f32 v58, 0x41c00000, v58
    v_sub_f32 v64, v64, v58
    v_sub_f32 v144, 0, v58
    v_sub_f32 v65, v65, v58
    v_sub_f32 v145, 0, v58
    v_sub_f32 v66, v66, v58
    v_sub_f32 v146, 0, v58
    v_sub_f32 v67, v67, v58
    v_sub_f32 v147, 0, v58
    v_sub_f32 v72, v72, v58
    v_sub_f32 v152, 0, v58
    v_sub_f32 v73, v73, v58
    v_sub_f32 v153, 0, v58
    v_sub_f32 v74, v74, v58
    v_sub_f32 v154, 0, v58
    v_sub_f32 v75, v75, v58
    v_sub_f32 v155, 0, v58
    v_max3_f32 v59, v68, v69, v70
    v_max3_f32 v59, v59, v71, v76
    v_max3_f32 v59, v59, v77, v78
    v_max_f32 v59, v59, v79
    v_mov_b32 v60, v59
    s_nop 1
    v_permlane16_swap_b32 v59, v60
    s_nop 1
    v_max_f32 v59, v59, v60
    v_mov_b32 v60, v59
    s_nop 1
    v_permlane32_swap_b32 v59, v60
    s_nop 1
    v_max_f32 v59, v59, v60
    v_add_f32 v59, 0x41c00000, v59
    v_sub_f32 v68, v68, v59
    v_sub_f32 v148, 0, v59
    v_sub_f32 v69, v69, v59
    v_sub_f32 v149, 0, v59
    v_sub_f32 v70, v70, v59
    v_sub_f32 v150, 0, v59
    v_sub_f32 v71, v71, v59
    v_sub_f32 v151, 0, v59
    v_sub_f32 v76, v76, v59
    v_sub_f32 v156, 0, v59
    v_sub_f32 v77, v77, v59
    v_sub_f32 v157, 0, v59
    v_sub_f32 v78, v78, v59
    v_sub_f32 v158, 0, v59
    v_sub_f32 v79, v79, v59
    v_sub_f32 v159, 0, v59
    s_cmp_lg_u32 s60, 1
    s_cbranch_scc1 L_nm1
    s_call_b64 s[82:83], L_mask
L_nm1:
    v_exp_f32 v58, v64
    v_exp_f32 v59, v65
    s_waitcnt lgkmcnt(7)
    v_mfma_f32_16x16x32_bf16 v[80:83], v[96:99], v[16:19], v[144:147]
    s_waitcnt lgkmcnt(6)
    v_exp_f32 v60, v66
    v_exp_f32 v61, v67
    v_mfma_f32_16x16x32_bf16 v[84:87], v[96:99], v[32:35], v[148:151]
    ds_read_b128 v[96:99], v48 offset:49152
    v_cvt_pk_bf16_f32 v128, v58, v59
    v_cvt_pk_bf16_f32 v129, v60, v61
    v_mfma_f32_16x16x32_bf16 v[84:87], v[100:103], v[36:39], v[84:87]
    s_waitcnt lgkmcnt(6)
    v_exp_f32 v58, v68
    v_exp_f32 v59, v69
    v_mfma_f32_16x16x32_bf16 v[80:83], v[100:103], v[20:23], v[80:83]
    ds_read_b128 v[100:103], v48 offset:50176
    v_cvt_pk_bf16_f32 v132, v58, v59
    v_mfma_f32_16x16x32_bf16 v[80:83], v[104:107], v[24:27], v[80:83]
    s_waitcnt lgkmcnt(6)
    v_exp_f32 v60, v70
    v_exp_f32 v61, v71
    v_mfma_f32_16x16x32_bf16 v[84:87], v[104:107], v[40:43], v[84:87]
    ds_read_b128 v[104:107], v48 offset:51200
    v_cvt_pk_bf16_f32 v133, v60, v61
    v_mfma_f32_16x16x32_bf16 v[84:87], v[108:111], v[44:47], v[84:87]
    s_waitcnt lgkmcnt(6)
    v_exp_f32 v58, v72
    v_exp_f32 v59, v73
    v_mfma_f32_16x16x32_bf16 v[80:83], v[108:111], v[28:31], v[80:83]
    ds_read_b128 v[108:111], v48 offset:52224
    v_cvt_pk_bf16_f32 v130, v58, v59
    v_mfma_f32_16x16x32_bf16 v[88:91], v[112:115], v[16:19], v[152:155]
    s_waitcnt lgkmcnt(6)
    v_exp_f32 v60, v74
    v_exp_f32 v61, v75
    v_mfma_f32_16x16x32_bf16 v[92:95], v[112:115], v[32:35], v[156:159]
    ds_read_b128 v[112:115], v48 offset:53248
    v_cvt_pk_bf16_f32 v131, v60, v61
    v_mfma_f32_16x16x32_bf16 v[92:95], v[116:119], v[36:39], v[92:95]
    s_waitcnt lgkmcnt(6)
    v_exp_f32 v58, v76
    v_exp_f32 v59, v77
    v_mfma_f32_16x16x32_bf16 v[88:91], v[116:119], v[20:23], v[88:91]
    ds_read_b128 v[116:119], v48 offset:54272
    v_cvt_pk_bf16_f32 v134, v58, v59
    v_mfma_f32_16x16x32_bf16 v[88:91], v[120:123], v[24:27], v[88:91]
    s_waitcnt lgkmcnt(6)
    v_exp_f32 v60, v78
    v_exp_f32 v61, v79
    v_mfma_f32_16x16x32_bf16 v[92:95], v[120:123], v[40:43], v[92:95]
    ds_read_b128 v[120:123], v48 offset:55296
    v_cvt_pk_bf16_f32 v135, v60, v61
    v_mfma_f32_16x16x32_bf16 v[92:95], v[124:127], v[44:47], v[92:95]
    s_waitcnt lgkmcnt(6)
    v_or3_b32 v62, v128, v129, v132
    v_or3_b32 v62, v62, v133, v130
    v_or3_b32 v62, v62, v131, v134
    v_bitop3_b32 v62, v62, v135, s72 bitop3:0xa8
    v_cmp_ne_u32 vcc, s65, v62
    v_mfma_f32_16x16x32_bf16 v[88:91], v[124:127], v[28:31], v[88:91]
    ds_read_b128 v[124:127], v48 offset:56320
    s_cbranch_vccnz L_back_9_h
L_back_9:
    s_nop 7
    v_exp_f32 v58, v80
    v_exp_f32 v59, v81
    s_call_b64 s[82:83], L_load
    s_mov_b32 s62, 0
    buffer_store_dwordx4 v[176:179], v13, s[8:11], s67 offen sc1
    s_add_u32 s67, s67, 1024
    buffer_store_dwordx4 v[180:183], v13, s[8:11], s67 offen sc1
    s_add_u32 s67, s67, s68
    buffer_store_dwordx4 v[184:187], v13, s[8:11], s67 offen sc1
    s_add_u32 s67, s67, 1024
    buffer_store_dwordx4 v[188:191], v13, s[8:11], s67 offen sc1
    s_add_u32 s67, s67, s69
    s_sub_i32 s64, s60, 2
    s_cmp_eq_u32 s60, 0
    s_cbranch_scc1 L_pv2
    s_cmp_eq_u32 s60, 1
    s_cbranch_scc1 L_tail2
    s_cmp_lg_u32 s60, 2
    s_cbranch_scc1 L_st2
    s_call_b64 s[82:83], L_mask
    s_branch L_st2
.p2align 6
L_st0:
    v_mfma_f32_16x16x32_bf16 v[192:195], v[96:99], v[128:131], v[192:195]
    s_waitcnt lgkmcnt(6)
    v_exp_f32 v60, v82
    v_mfma_f32_16x16x32_bf16 v[196:199], v[96:99], v[132:135], v[196:199]
    ds_read_b128 v[96:99], v48 offset:0
    v_cvt_pk_bf16_f32 v136, v58, v59
    v_mfma_f32_16x16x32_bf16 v[204:207], v[100:103], v[132:135], v[204:207]
    s_waitcnt lgkmcnt(6)
    v_exp_f32 v61, v83
    v_mfma_f32_16x16x32_bf16 v[200:203], v[100:103], v[128:131], v[200:203]
    s_sub_i32 s64, s64, 1
    ds_read_b128 v[100:103], v48 offset:1024
    v_cvt_pk_bf16_f32 v137, v60, v61
    v_mfma_f32_16x16x32_bf16 v[208:211], v[104:107], v[128:131], v[208:211]
    s_waitcnt lgkmcnt(6)
    v_exp_f32 v58, v84
    v_mfma_f32_16x16x32_bf16 v[212:215], v[104:107], v[132:135], v[212:215]
    ds_read_b128 v[104:107], v48 offset:2048
    v_mfma_f32_16x16x32_bf16 v[220:223], v[108:111], v[132:135], v[220:223]
    s_waitcnt lgkmcnt(6)
    v_exp_f32 v59, v85
    v_mfma_f32_16x16x32_bf16 v[216:219], v[108:111], v[128:131], v[216:219]
    s_cmp_gt_i32 s64, 0
    ds_read_b128 v[108:111], v48 offset:3072
    v_cvt_pk_bf16_f32 v140, v58, v59
    v_mfma_f32_16x16x32_bf16 v[224:227], v[112:115], v[128:131], v[224:227]
    s_waitcnt lgkmcnt(6)
    v_exp_f32 v60, v86
    v_mfma_f32_16x16x32_bf16 v[228:231], v[112:115], v[132:135], v[228:231]
    ds_read_b128 v[112:115], v48 offset:4096
    v_or3_b32 v62, v136, v137, v140
    v_mfma_f32_16x16x32_bf16 v[236:239], v[116:119], v[132:135], v[236:239]
    s_waitcnt lgkmcnt(6)
    v_exp_f32 v61, v87
    v_mfma_f32_16x16x32_bf16 v[232:235], v[116:119], v[128:131], v[232:235]
    s_cselect_b32 s65, 0, 1
    ds_read_b128 v[116:119], v48 offset:5120
    v_cvt_pk_bf16_f32 v141, v60, v61
    v_mfma_f32_16x16x32_bf16 v[240:243], v[120:123], v[128:131], v[240:243]
    s_waitcnt lgkmcnt(6)
    v_exp_f32 v58, v88
    v_mfma_f32_16x16x32_bf16 v[244:247], v[120:123], v[132:135], v[244:247]
    ds_read_b128 v[120:123], v48 offset:6144
    v_mfma_f32_16x16x32_bf16 v[252:255], v[124:127], v[132:135], v[252:255]
    s_waitcnt lgkmcnt(6)
    v_exp_f32 v59, v89
    v_mfma_f32_16x16x32_bf16 v[248:251], v[124:127], v[128:131], v[248:251]
    ds_read_b128 v[124:127], v48 offset:7168
    v_cvt_pk_bf16_f32 v138, v58, v59
    v_mfma_f32_16x16x32_bf16 v[64:67], v[96:99], v[16:19], v[144:147]
    s_waitcnt lgkmcnt(6)
    v_exp_f32 v60, v90
    v_mfma_f32_16x16x32_bf16 v[68:71], v[96:99], v[32:35], v[148:151]
    ds_read_b128 v[96:99], v48 offset:40960
    v_or3_b32 v62, v62, v141, v138
    v_mfma_f32_16x16x32_bf16 v[68:71], v[100:103], v[36:39], v[68:71]
    s_waitcnt lgkmcnt(6)
    v_exp_f32 v61, v91
    v_mfma_f32_16x16x32_bf16 v[64:67], v[100:103], v[20:23], v[64:67]
    ds_read_b128 v[100:103], v48 offset:41984
    v_cvt_pk_bf16_f32 v139, v60, v61
    v_mfma_f32_16x16x32_bf16 v[64:67], v[104:107], v[24:27], v[64:67]
    s_waitcnt lgkmcnt(6)
    v_exp_f32 v58, v92
    v_mfma_f32_16x16x32_bf16 v[68:71], v[104:107], v[40:43], v[68:71]
    ds_read_b128 v[104:107], v48 offset:43008
    v_mfma_f32_16x16x32_bf16 v[68:71], v[108:111], v[44:47], v[68:71]
    s_waitcnt lgkmcnt(6)
    v_exp_f32 v59, v93
    v_mfma_f32_16x16x32_bf16 v[64:67], v[108:111], v[28:31], v[64:67]
    ds_read_b128 v[108:111], v48 offset:44032
    v_cvt_pk_bf16_f32 v142, v58, v59
    v_mfma_f32_16x16x32_bf16 v[72:75], v[112:115], v[16:19], v[152:155]
    s_waitcnt lgkmcnt(6)
    v_exp_f32 v60, v94
    v_mfma_f32_16x16x32_bf16 v[76:79], v[112:115], v[32:35], v[156:159]
    ds_read_b128 v[112:115], v48 offset:45056
    v_or3_b32 v62, v62, v139, v142
    v_mfma_f32_16x16x32_bf16 v[76:79], v[116:119], v[36:39], v[76:79]
    s_waitcnt lgkmcnt(6)
    v_exp_f32 v61, v95
    v_mfma_f32_16x16x32_bf16 v[72:75], v[116:119], v[20:23], v[72:75]
    ds_read_b128 v[116:119], v48 offset:46080
    v_cvt_pk_bf16_f32 v143, v60, v61
    v_smfmac_f32_16x16x64_bf16 v[160:163], v[164:167], v[128:135], v168
    v_bitop3_b32 v62, v62, v143, s72 bitop3:0xa8
    v_mfma_f32_16x16x32_bf16 v[72:75], v[120:123], v[24:27], v[72:75]
    s_waitcnt lgkmcnt(6)
    v_exp_f32 v58, v64
    v_mfma_f32_16x16x32_bf16 v[76:79], v[120:123], v[40:43], v[76:79]
    ds_read_b128 v[120:123], v48 offset:47104
    v_cmp_ne_u32 vcc, s65, v62
    v_mfma_f32_16x16x32_bf16 v[76:79], v[124:127], v[44:47], v[76:79]
    s_waitcnt lgkmcnt(6)
    v_exp_f32 v59, v65
    v_mfma_f32_16x16x32_bf16 v[72:75], v[124:127], v[28:31], v[72:75]
    ds_read_b128 v[124:127], v48 offset:48128
    s_cbranch_vccnz L_back_10_h
L_back_10:
    v_mfma_f32_16x16x32_bf16 v[192:195], v[96:99], v[136:139], v[192:195]
    s_waitcnt lgkmcnt(6)
    v_exp_f32 v60, v66
    v_mfma_f32_16x16x32_bf16 v[196:199], v[96:99], v[140:143], v[196:199]
    ds_read_b128 v[96:99], v48 offset:8192
    v_cvt_pk_bf16_f32 v128, v58, v59
    v_mfma_f32_16x16x32_bf16 v[204:207], v[100:103], v[140:143], v[204:207]
    s_waitcnt lgkmcnt(6)
    v_exp_f32 v61, v67
    v_mfma_f32_16x16x32_bf16 v[200:203], v[100:103], v[136:139], v[200:203]
    s_sub_i32 s64, s64, 1
    ds_read_b128 v[100:103], v48 offset:9216
    v_cvt_pk_bf16_f32 v129, v60, v61
    v_mfma_f32_16x16x32_bf16 v[208:211], v[104:107], v[136:139], v[208:211]
    s_waitcnt lgkmcnt(6)
    v_exp_f32 v58, v68
    v_mfma_f32_16x16x32_bf16 v[212:215], v[104:107], v[140:143], v[212:215]
    ds_read_b128 v[104:107], v48 offset:10240
    v_mfma_f32_16x16x32_bf16 v[220:223], v[108:111], v[140:143], v[220:223]
    s_waitcnt lgkmcnt(6)
    v_exp_f32 v59, v69
    v_mfma_f32_16x16x32_bf16 v[216:219], v[108:111], v[136:139], v[216:219]
    s_cmp_gt_i32 s64, 0
    ds_read_b128 v[108:111], v48 offset:11264
    v_cvt_pk_bf16_f32 v132, v58, v59
    v_mfma_f32_16x16x32_bf16 v[224:227], v[112:115], v[136:139], v[224:227]
    s_waitcnt lgkmcnt(6)
    v_exp_f32 v60, v70
    v_mfma_f32_16x16x32_bf16 v[228:231], v[112:115], v[140:143], v[228:231]
    ds_read_b128 v[112:115], v48 offset:12288
    v_or3_b32 v62, v128, v129, v132
    v_mfma_f32_16x16x32_bf16 v[236:239], v[116:119], v[140:143], v[236:239]
    s_waitcnt lgkmcnt(6)
    v_exp_f32 v61, v71
    v_mfma_f32_16x16x32_bf16 v[232:235], v[116:119], v[136:139], v[232:235]
    s_cselect_b32 s65, 0, 1
    ds_read_b128 v[116:119], v48 offset:13312
    v_cvt_pk_bf16_f32 v133, v60, v61
    v_mfma_f32_16x16x32_bf16 v[240:243], v[120:123], v[136:139], v[240:243]
    s_waitcnt lgkmcnt(6)
    v_exp_f32 v58, v72
    v_mfma_f32_16x16x32_bf16 v[244:247], v[120:123], v[140:143], v[244:247]
    ds_read_b128 v[120:123], v48 offset:14336
    v_mfma_f32_16x16x32_bf16 v[252:255], v[124:127], v[140:143], v[252:255]
    s_waitcnt lgkmcnt(6)
    v_exp_f32 v59, v73
    v_mfma_f32_16x16x32_bf16 v[248:251], v[124:127], v[136:139], v[248:251]
    ds_read_b128 v[124:127], v48 offset:15360
    v_cvt_pk_bf16_f32 v130, v58, v59
    v_mfma_f32_16x16x32_bf16 v[80:83], v[96:99], v[16:19], v[144:147]
    s_waitcnt lgkmcnt(6)
    v_exp_f32 v60, v74
    v_mfma_f32_16x16x32_bf16 v[84:87], v[96:99], v[32:35], v[148:151]
    ds_read_b128 v[96:99], v48 offset:49152
    v_or3_b32 v62, v62, v133, v130
    v_mfma_f32_16x16x32_bf16 v[84:87], v[100:103], v[36:39], v[84:87]
    s_waitcnt lgkmcnt(6)
    v_exp_f32 v61, v75
    v_mfma_f32_16x16x32_bf16 v[80:83], v[100:103], v[20:23], v[80:83]
    ds_read_b128 v[100:103], v48 offset:50176
    v_cvt_pk_bf16_f32 v131, v60, v61
    v_mfma_f32_16x16x32_bf16 v[80:83], v[104:107], v[24:27], v[80:83]
    s_waitcnt lgkmcnt(6)
    v_exp_f32 v58, v76
    v_mfma_f32_16x16x32_bf16 v[84:87], v[104:107], v[40:43], v[84:87]
    ds_read_b128 v[104:107], v48 offset:51200
    v_mfma_f32_16x16x32_bf16 v[84:87], v[108:111], v[44:47], v[84:87]
    s_waitcnt lgkmcnt(6)
    v_exp_f32 v59, v77
    v_mfma_f32_16x16x32_bf16 v[80:83], v[108:111], v[28:31], v[80:83]
    ds_read_b128 v[108:111], v48 offset:52224
    v_cvt_pk_bf16_f32 v134, v58, v59
    v_mfma_f32_16x16x32_bf16 v[88:91], v[112:115], v[16:19], v[152:155]
    s_waitcnt lgkmcnt(6)
    v_exp_f32 v60, v78
    v_mfma_f32_16x16x32_bf16 v[92:95], v[112:115], v[32:35], v[156:159]
    ds_read_b128 v[112:115], v48 offset:53248
    v_or3_b32 v62, v62, v131, v134
    v_mfma_f32_16x16x32_bf16 v[92:95], v[116:119], v[36:39], v[92:95]
    s_waitcnt lgkmcnt(6)
    v_exp_f32 v61, v79
    v_mfma_f32_16x16x32_bf16 v[88:91], v[116:119], v[20:23], v[88:91]
    ds_read_b128 v[116:119], v48 offset:54272
    v_cvt_pk_bf16_f32 v135, v60, v61
    v_smfmac_f32_16x16x64_bf16 v[160:163], v[164:167], v[136:143], v168
    v_bitop3_b32 v62, v62, v135, s72 bitop3:0xa8
    v_mfma_f32_16x16x32_bf16 v[88:91], v[120:123], v[24:27], v[88:91]
    s_waitcnt lgkmcnt(6)
    v_exp_f32 v58, v80
    v_mfma_f32_16x16x32_bf16 v[92:95], v[120:123], v[40:43], v[92:95]
    ds_read_b128 v[120:123], v48 offset:55296
    v_cmp_ne_u32 vcc, s65, v62
    v_mfma_f32_16x16x32_bf16 v[92:95], v[124:127], v[44:47], v[92:95]
    s_waitcnt lgkmcnt(6)
    v_exp_f32 v59, v81
    v_mfma_f32_16x16x32_bf16 v[88:91], v[124:127], v[28:31], v[88:91]
    ds_read_b128 v[124:127], v48 offset:56320
    s_cbranch_vccnz L_back_11_h
L_back_11:
L_st2:
    v_mfma_f32_16x16x32_bf16 v[192:195], v[96:99], v[128:131], v[192:195]
    s_waitcnt lgkmcnt(6)
    v_exp_f32 v60, v82
    v_mfma_f32_16x16x32_bf16 v[196:199], v[96:99], v[132:135], v[196:199]
    ds_read_b128 v[96:99], v48 offset:16384
    v_cvt_pk_bf16_f32 v136, v58, v59
    v_mfma_f32_16x16x32_bf16 v[204:207], v[100:103], v[132:135], v[204:207]
    s_waitcnt lgkmcnt(6)
    v_exp_f32 v61, v83
    v_mfma_f32_16x16x32_bf16 v[200:203], v[100:103], v[128:131], v[200:203]
    s_sub_i32 s64, s64, 1
    ds_read_b128 v[100:103], v48 offset:17408
    v_cvt_pk_bf16_f32 v137, v60, v61
    v_mfma_f32_16x16x32_bf16 v[208:211], v[104:107], v[128:131], v[208:211]
    s_waitcnt lgkmcnt(6)
    v_exp_f32 v58, v84
    v_mfma_f32_16x16x32_bf16 v[212:215], v[104:107], v[132:135], v[212:215]
    ds_read_b128 v[104:107], v48 offset:18432
    v_mfma_f32_16x16x32_bf16 v[220:223], v[108:111], v[132:135], v[220:223]
    s_waitcnt lgkmcnt(6)
    v_exp_f32 v59, v85
    v_mfma_f32_16x16x32_bf16 v[216:219], v[108:111], v[128:131], v[216:219]
    s_cmp_gt_i32 s64, 0
    ds_read_b128 v[108:111], v48 offset:19456
    v_cvt_pk_bf16_f32 v140, v58, v59
    v_mfma_f32_16x16x32_bf16 v[224:227], v[112:115], v[128:131], v[224:227]
    s_waitcnt lgkmcnt(6)
    v_exp_f32 v60, v86
    v_mfma_f32_16x16x32_bf16 v[228:231], v[112:115], v[132:135], v[228:231]
    ds_read_b128 v[112:115], v48 offset:20480
    v_or3_b32 v62, v136, v137, v140
    v_mfma_f32_16x16x32_bf16 v[236:239], v[116:119], v[132:135], v[236:239]
    s_waitcnt lgkmcnt(6)
    v_exp_f32 v61, v87
    v_mfma_f32_16x16x32_bf16 v[232:235], v[116:119], v[128:131], v[232:235]
    s_cselect_b32 s65, 0, 1
    ds_read_b128 v[116:119], v48 offset:21504
    v_cvt_pk_bf16_f32 v141, v60, v61
    v_mfma_f32_16x16x32_bf16 v[240:243], v[120:123], v[128:131], v[240:243]
    s_waitcnt lgkmcnt(6)
    v_exp_f32 v58, v88
    v_mfma_f32_16x16x32_bf16 v[244:247], v[120:123], v[132:135], v[244:247]
    ds_read_b128 v[120:123], v48 offset:22528
    v_mfma_f32_16x16x32_bf16 v[252:255], v[124:127], v[132:135], v[252:255]
    s_waitcnt lgkmcnt(6)
    v_exp_f32 v59, v89
    v_mfma_f32_16x16x32_bf16 v[248:251], v[124:127], v[128:131], v[248:251]
    ds_read_b128 v[124:127], v48 offset:23552
    v_cvt_pk_bf16_f32 v138, v58, v59
    v_mfma_f32_16x16x32_bf16 v[64:67], v[96:99], v[16:19], v[144:147]
    s_waitcnt lgkmcnt(6)
    v_exp_f32 v60, v90
    v_mfma_f32_16x16x32_bf16 v[68:71], v[96:99], v[32:35], v[148:151]
    ds_read_b128 v[96:99], v48 offset:57344
    v_or3_b32 v62, v62, v141, v138
    v_mfma_f32_16x16x32_bf16 v[68:71], v[100:103], v[36:39], v[68:71]
    s_waitcnt lgkmcnt(6)
    v_exp_f32 v61, v91
    v_mfma_f32_16x16x32_bf16 v[64:67], v[100:103], v[20:23], v[64:67]
    ds_read_b128 v[100:103], v48 offset:58368
    v_cvt_pk_bf16_f32 v139, v60, v61
    v_mfma_f32_16x16x32_bf16 v[64:67], v[104:107], v[24:27], v[64:67]
    s_waitcnt lgkmcnt(6)
    v_exp_f32 v58, v92
    v_mfma_f32_16x16x32_bf16 v[68:71], v[104:107], v[40:43], v[68:71]
    ds_read_b128 v[104:107], v48 offset:59392
    v_mfma_f32_16x16x32_bf16 v[68:71], v[108:111], v[44:47], v[68:71]
    s_waitcnt lgkmcnt(6)
    v_exp_f32 v59, v93
    v_mfma_f32_16x16x32_bf16 v[64:67], v[108:111], v[28:31], v[64:67]
    ds_read_b128 v[108:111], v48 offset:60416
    v_cvt_pk_bf16_f32 v142, v58, v59
    v_mfma_f32_16x16x32_bf16 v[72:75], v[112:115], v[16:19], v[152:155]
    s_waitcnt lgkmcnt(6)
    v_exp_f32 v60, v94
    v_mfma_f32_16x16x32_bf16 v[76:79], v[112:115], v[32:35], v[156:159]
    ds_read_b128 v[112:115], v48 offset:61440
    v_or3_b32 v62, v62, v139, v142
    v_mfma_f32_16x16x32_bf16 v[76:79], v[116:119], v[36:39], v[76:79]
    s_waitcnt lgkmcnt(6)
    v_exp_f32 v61, v95
    v_mfma_f32_16x16x32_bf16 v[72:75], v[116:119], v[20:23], v[72:75]
    ds_read_b128 v[116:119], v48 offset:62464
    v_cvt_pk_bf16_f32 v143, v60, v61
    v_smfmac_f32_16x16x64_bf16 v[160:163], v[164:167], v[128:135], v168
    v_bitop3_b32 v62, v62, v143, s72 bitop3:0xa8
    v_mfma_f32_16x16x32_bf16 v[72:75], v[120:123], v[24:27], v[72:75]
    s_waitcnt lgkmcnt(6)
    v_exp_f32 v58, v64
    v_mfma_f32_16x16x32_bf16 v[76:79], v[120:123], v[40:43], v[76:79]
    ds_read_b128 v[120:123], v48 offset:63488
    v_cmp_ne_u32 vcc, s65, v62
    v_mfma_f32_16x16x32_bf16 v[76:79], v[124:127], v[44:47], v[76:79]
    s_waitcnt lgkmcnt(6)
    v_exp_f32 v59, v65
    v_mfma_f32_16x16x32_bf16 v[72:75], v[124:127], v[28:31], v[72:75]
    ds_read_b128 v[124:127], v48 offset:64512
    s_cbranch_vccnz L_back_12_h
L_back_12:
    v_mfma_f32_16x16x32_bf16 v[192:195], v[96:99], v[136:139], v[192:195]
    s_waitcnt lgkmcnt(6)
    v_exp_f32 v60, v66
    v_mfma_f32_16x16x32_bf16 v[196:199], v[96:99], v[140:143], v[196:199]
    ds_read_b128 v[96:99], v48 offset:24576
    v_cvt_pk_bf16_f32 v128, v58, v59
    v_mfma_f32_16x16x32_bf16 v[204:207], v[100:103], v[140:143], v[204:207]
    s_waitcnt lgkmcnt(6)
    v_exp_f32 v61, v67
    v_mfma_f32_16x16x32_bf16 v[200:203], v[100:103], v[136:139], v[200:203]
    s_sub_i32 s64, s64, 1
    ds_read_b128 v[100:103], v48 offset:25600
    v_cvt_pk_bf16_f32 v129, v60, v61
    v_mfma_f32_16x16x32_bf16 v[208:211], v[104:107], v[136:139], v[208:211]
    s_waitcnt lgkmcnt(6)
    v_exp_f32 v58, v68
    v_mfma_f32_16x16x32_bf16 v[212:215], v[104:107], v[140:143], v[212:215]
    ds_read_b128 v[104:107], v48 offset:26624
    v_mfma_f32_16x16x32_bf16 v[220:223], v[108:111], v[140:143], v[220:223]
    s_waitcnt lgkmcnt(6)
    v_exp_f32 v59, v69
    v_mfma_f32_16x16x32_bf16 v[216:219], v[108:111], v[136:139], v[216:219]
    s_cmp_gt_i32 s64, 0
    ds_read_b128 v[108:111], v48 offset:27648
    v_cvt_pk_bf16_f32 v132, v58, v59
    v_mfma_f32_16x16x32_bf16 v[224:227], v[112:115], v[136:139], v[224:227]
    s_waitcnt lgkmcnt(6)
    v_exp_f32 v60, v70
    v_mfma_f32_16x16x32_bf16 v[228:231], v[112:115], v[140:143], v[228:231]
    ds_read_b128 v[112:115], v48 offset:28672
    v_or3_b32 v62, v128, v129, v132
    v_mfma_f32_16x16x32_bf16 v[236:239], v[116:119], v[140:143], v[236:239]
    s_waitcnt lgkmcnt(6)
    v_exp_f32 v61, v71
    v_mfma_f32_16x16x32_bf16 v[232:235], v[116:119], v[136:139], v[232:235]
    s_cselect_b32 s65, 0, 1
    ds_read_b128 v[116:119], v48 offset:29696
    v_cvt_pk_bf16_f32 v133, v60, v61
    v_mfma_f32_16x16x32_bf16 v[240:243], v[120:123], v[136:139], v[240:243]
    s_waitcnt lgkmcnt(6)
    v_exp_f32 v58, v72
    v_mfma_f32_16x16x32_bf16 v[244:247], v[120:123], v[140:143], v[244:247]
    ds_read_b128 v[120:123], v48 offset:30720
    v_mfma_f32_16x16x32_bf16 v[252:255], v[124:127], v[140:143], v[252:255]
    s_waitcnt lgkmcnt(6)
    v_exp_f32 v59, v73
    v_mfma_f32_16x16x32_bf16 v[248:251], v[124:127], v[136:139], v[248:251]
    ds_read_b128 v[124:127], v48 offset:31744
    v_cvt_pk_bf16_f32 v130, v58, v59
    v_mfma_f32_16x16x32_bf16 v[80:83], v[96:99], v[16:19], v[144:147]
    s_waitcnt lgkmcnt(6)
    v_exp_f32 v60, v74
    v_mfma_f32_16x16x32_bf16 v[84:87], v[96:99], v[32:35], v[148:151]
    s_cmp_lg_u32 s89, 0
    v_or3_b32 v62, v62, v133, v130
    v_xor_b32 v48, 0x10000, v48
    v_mfma_f32_16x16x32_bf16 v[84:87], v[100:103], v[36:39], v[84:87]
    s_waitcnt lgkmcnt(5)
    v_exp_f32 v61, v75
    v_mfma_f32_16x16x32_bf16 v[80:83], v[100:103], v[20:23], v[80:83]
    s_waitcnt lgkmcnt(0)
    v_cvt_pk_bf16_f32 v131, v60, v61
    v_smfmac_f32_16x16x64_bf16 v[160:163], v[164:167], v[136:143], v168
    s_cbranch_scc1 L_ldback_13_c
    s_barrier
L_ldback_13:
    s_add_i32 s62, s62, 1
    ds_read_b128 v[96:99], v48 offset:32768
    ds_read_b128 v[100:103], v48 offset:33792
    v_mfma_f32_16x16x32_bf16 v[80:83], v[104:107], v[24:27], v[80:83]
    v_exp_f32 v58, v76
    v_mfma_f32_16x16x32_bf16 v[84:87], v[104:107], v[40:43], v[84:87]
    ds_read_b128 v[104:107], v48 offset:34816
    v_mfma_f32_16x16x32_bf16 v[84:87], v[108:111], v[44:47], v[84:87]
    v_exp_f32 v59, v77
    v_mfma_f32_16x16x32_bf16 v[80:83], v[108:111], v[28:31], v[80:83]
    ds_read_b128 v[108:111], v48 offset:35840
    v_cvt_pk_bf16_f32 v134, v58, v59
    v_mfma_f32_16x16x32_bf16 v[88:91], v[112:115], v[16:19], v[152:155]
    v_exp_f32 v60, v78
    v_mfma_f32_16x16x32_bf16 v[92:95], v[112:115], v[32:35], v[156:159]
    ds_read_b128 v[112:115], v48 offset:36864
    v_or3_b32 v62, v62, v131, v134
    v_mfma_f32_16x16x32_bf16 v[92:95], v[116:119], v[36:39], v[92:95]
    v_exp_f32 v61, v79
    v_mfma_f32_16x16x32_bf16 v[88:91], v[116:119], v[20:23], v[88:91]
    ds_read_b128 v[116:119], v48 offset:37888
    v_cvt_pk_bf16_f32 v135, v60, v61
    v_mfma_f32_16x16x32_bf16 v[88:91], v[120:123], v[24:27], v[88:91]
    v_exp_f32 v58, v80
    v_mfma_f32_16x16x32_bf16 v[92:95], v[120:123], v[40:43], v[92:95]
    ds_read_b128 v[120:123], v48 offset:38912
    v_bitop3_b32 v62, v62, v135, s72 bitop3:0xa8
    v_cmp_ne_u32 vcc, s65, v62
    v_mfma_f32_16x16x32_bf16 v[92:95], v[124:127], v[44:47], v[92:95]
    s_waitcnt lgkmcnt(6)
    v_exp_f32 v59, v81
    v_mfma_f32_16x16x32_bf16 v[88:91], v[124:127], v[28:31], v[88:91]
    ds_read_b128 v[124:127], v48 offset:39936
    s_cbranch_vccz L_st0
    s_branch L_back_14_h
L_tail0:
    s_mov_b32 s65, 0
    v_mfma_f32_16x16x32_bf16 v[192:195], v[96:99], v[128:131], v[192:195]
    s_waitcnt lgkmcnt(6)
    v_exp_f32 v60, v82
    v_exp_f32 v61, v83
    v_mfma_f32_16x16x32_bf16 v[196:199], v[96:99], v[132:135], v[196:199]
    ds_read_b128 v[96:99], v48 offset:40960
    v_cvt_pk_bf16_f32 v136, v58, v59
    v_cvt_pk_bf16_f32 v137, v60, v61
    v_mfma_f32_16x16x32_bf16 v[204:207], v[100:103], v[132:135], v[204:207]
    s_waitcnt lgkmcnt(6)
    v_exp_f32 v58, v84
    v_exp_f32 v59, v85
    v_mfma_f32_16x16x32_bf16 v[200:203], v[100:103], v[128:131], v[200:203]
    ds_read_b128 v[100:103], v48 offset:41984
    v_cvt_pk_bf16_f32 v140, v58, v59
    v_smfmac_f32_16x16x64_bf16 v[160:163], v[164:167], v[128:135], v168
    v_mfma_f32_16x16x32_bf16 v[208:211], v[104:107], v[128:131], v[208:211]
    s_waitcnt lgkmcnt(6)
    v_exp_f32 v60, v86
    v_exp_f32 v61, v87
    v_mfma_f32_16x16x32_bf16 v[212:215], v[104:107], v[132:135], v[212:215]
    ds_read_b128 v[104:107], v48 offset:43008
    v_cvt_pk_bf16_f32 v141, v60, v61
    v_mfma_f32_16x16x32_bf16 v[220:223], v[108:111], v[132:135], v[220:223]
    s_waitcnt lgkmcnt(6)
    v_exp_f32 v58, v88
    v_exp_f32 v59, v89
    v_mfma_f32_16x16x32_bf16 v[216:219], v[108:111], v[128:131], v[216:219]
    ds_read_b128 v[108:111], v48 offset:44032
    v_cvt_pk_bf16_f32 v138, v58, v59
    v_mfma_f32_16x16x32_bf16 v[224:227], v[112:115], v[128:131], v[224:227]
    s_waitcnt lgkmcnt(6)
    v_exp_f32 v60, v90
    v_exp_f32 v61, v91
    v_mfma_f32_16x16x32_bf16 v[228:231], v[112:115], v[132:135], v[228:231]
    ds_read_b128 v[112:115], v48 offset:45056
    v_cvt_pk_bf16_f32 v139, v60, v61
    v_mfma_f32_16x16x32_bf16 v[236:239], v[116:119], v[132:135], v[236:239]
    s_waitcnt lgkmcnt(6)
    v_exp_f32 v58, v92
    v_exp_f32 v59, v93
    v_mfma_f32_16x16x32_bf16 v[232:235], v[116:119], v[128:131], v[232:235]
    ds_read_b128 v[116:119], v48 offset:46080
    v_cvt_pk_bf16_f32 v142, v58, v59
    v_mfma_f32_16x16x32_bf16 v[240:243], v[120:123], v[128:131], v[240:243]
    s_waitcnt lgkmcnt(6)
    v_exp_f32 v60, v94
    v_exp_f32 v61, v95
    v_mfma_f32_16x16x32_bf16 v[244:247], v[120:123], v[132:135], v[244:247]
    ds_read_b128 v[120:123], v48 offset:47104
    v_cvt_pk_bf16_f32 v143, v60, v61
    v_mfma_f32_16x16x32_bf16 v[252:255], v[124:127], v[132:135], v[252:255]
    s_waitcnt lgkmcnt(6)
    v_or3_b32 v62, v136, v137, v140
    v_or3_b32 v62, v62, v141, v138
    v_or3_b32 v62, v62, v139, v142
    v_bitop3_b32 v62, v62, v143, s72 bitop3:0xa8
    v_cmp_ne_u32 vcc, s65, v62
    v_mfma_f32_16x16x32_bf16 v[248:251], v[124:127], v[128:131], v[248:251]
    ds_read_b128 v[124:127], v48 offset:48128
    s_cbranch_vccnz L_back_15_h
L_back_15:
L_pv1:
    v_mfma_f32_16x16x32_bf16 v[192:195], v[96:99], v[136:139], v[192:195]
    s_waitcnt lgkmcnt(6)
    v_mfma_f32_16x16x32_bf16 v[196:199], v[96:99], v[140:143], v[196:199]
    v_mfma_f32_16x16x32_bf16 v[204:207], v[100:103], v[140:143], v[204:207]
    s_waitcnt lgkmcnt(5)
    v_mfma_f32_16x16x32_bf16 v[200:203], v[100:103], v[136:139], v[200:203]
    v_smfmac_f32_16x16x64_bf16 v[160:163], v[164:167], v[136:143], v168
    v_mfma_f32_16x16x32_bf16 v[208:211], v[104:107], v[136:139], v[208:211]
    s_waitcnt lgkmcnt(4)
    v_mfma_f32_16x16x32_bf16 v[212:215], v[104:107], v[140:143], v[212:215]
    v_mfma_f32_16x16x32_bf16 v[220:223], v[108:111], v[140:143], v[220:223]
    s_waitcnt lgkmcnt(3)
    v_mfma_f32_16x16x32_bf16 v[216:219], v[108:111], v[136:139], v[216:219]
    v_mfma_f32_16x16x32_bf16 v[224:227], v[112:115], v[136:139], v[224:227]
    s_waitcnt lgkmcnt(2)
    v_mfma_f32_16x16x32_bf16 v[228:231], v[112:115], v[140:143], v[228:231]
    v_mfma_f32_16x16x32_bf16 v[236:239], v[116:119], v[140:143], v[236:239]
    s_waitcnt lgkmcnt(1)
    v_mfma_f32_16x16x32_bf16 v[232:235], v[116:119], v[136:139], v[232:235]
    v_mfma_f32_16x16x32_bf16 v[240:243], v[120:123], v[136:139], v[240:243]
    s_waitcnt lgkmcnt(0)
    v_mfma_f32_16x16x32_bf16 v[244:247], v[120:123], v[140:143], v[244:247]
    v_mfma_f32_16x16x32_bf16 v[252:255], v[124:127], v[140:143], v[252:255]
    v_mfma_f32_16x16x32_bf16 v[248:251], v[124:127], v[136:139], v[248:251]
    s_branch L_fin
L_tail1:
    s_mov_b32 s65, 0
    v_mfma_f32_16x16x32_bf16 v[192:195], v[96:99], v[136:139], v[192:195]
    s_waitcnt lgkmcnt(6)
    v_exp_f32 v60, v66
    v_exp_f32 v61, v67
    v_mfma_f32_16x16x32_bf16 v[196:199], v[96:99], v[140:143], v[196:199]
    ds_read_b128 v[96:99], v48 offset:49152
    v_cvt_pk_bf16_f32 v128, v58, v59
    v_cvt_pk_bf16_f32 v129, v60, v61
    v_mfma_f32_16x16x32_bf16 v[204:207], v[100:103], v[140:143], v[204:207]
    s_waitcnt lgkmcnt(6)
    v_exp_f32 v58, v68
    v_exp_f32 v59, v69
    v_mfma_f32_16x16x32_bf16 v[200:203], v[100:103], v[136:139], v[200:203]
    ds_read_b128 v[100:103], v48 offset:50176
    v_cvt_pk_bf16_f32 v132, v58, v59
    v_smfmac_f32_16x16x64_bf16 v[160:163], v[164:167], v[136:143], v168
    v_mfma_f32_16x16x32_bf16 v[208:211], v[104:107], v[136:139], v[208:211]
    s_waitcnt lgkmcnt(6)
    v_exp_f32 v60, v70
    v_exp_f32 v61, v71
    v_mfma_f32_16x16x32_bf16 v[212:215], v[104:107], v[140:143], v[212:215]
    ds_read_b128 v[104:107], v48 offset:51200
    v_cvt_pk_bf16_f32 v133, v60, v61
    v_mfma_f32_16x16x32_bf16 v[220:223], v[108:111], v[140:143], v[220:223]
    s_waitcnt lgkmcnt(6)
    v_exp_f32 v58, v72
    v_exp_f32 v59, v73
    v_mfma_f32_16x16x32_bf16 v[216:219], v[108:111], v[136:139], v[216:219]
    ds_read_b128 v[108:111], v48 offset:52224
    v_cvt_pk_bf16_f32 v130, v58, v59
    v_mfma_f32_16x16x32_bf16 v[224:227], v[112:115], v[136:139], v[224:227]
    s_waitcnt lgkmcnt(6)
    v_exp_f32 v60, v74
    v_exp_f32 v61, v75
    v_mfma_f32_16x16x32_bf16 v[228:231], v[112:115], v[140:143], v[228:231]
    ds_read_b128 v[112:115], v48 offset:53248
    v_cvt_pk_bf16_f32 v131, v60, v61
    v_mfma_f32_16x16x32_bf16 v[236:239], v[116:119], v[140:143], v[236:239]
    s_waitcnt lgkmcnt(6)
    v_exp_f32 v58, v76
    v_exp_f32 v59, v77
    v_mfma_f32_16x16x32_bf16 v[232:235], v[116:119], v[136:139], v[232:235]
    ds_read_b128 v[116:119], v48 offset:54272
    v_cvt_pk_bf16_f32 v134, v58, v59
    v_mfma_f32_16x16x32_bf16 v[240:243], v[120:123], v[136:139], v[240:243]
    s_waitcnt lgkmcnt(6)
    v_exp_f32 v60, v78
    v_exp_f32 v61, v79
    v_mfma_f32_16x16x32_bf16 v[244:247], v[120:123], v[140:143], v[244:247]
    ds_read_b128 v[120:123], v48 offset:55296
    v_cvt_pk_bf16_f32 v135, v60, v61
    v_mfma_f32_16x16x32_bf16 v[252:255], v[124:127], v[140:143], v[252:255]
    s_waitcnt lgkmcnt(6)
    v_or3_b32 v62, v128, v129, v132
    v_or3_b32 v62, v62, v133, v130
    v_or3_b32 v62, v62, v131, v134
    v_bitop3_b32 v62, v62, v135, s72 bitop3:0xa8
    v_cmp_ne_u32 vcc, s65, v62
    v_mfma_f32_16x16x32_bf16 v[248:251], v[124:127], v[136:139], v[248:251]
    ds_read_b128 v[124:127], v48 offset:56320
    s_cbranch_vccnz L_back_16_h
L_back_16:
L_pv2:
    v_mfma_f32_16x16x32_bf16 v[192:195], v[96:99], v[128:131], v[192:195]
    s_waitcnt lgkmcnt(6)
    v_mfma_f32_16x16x32_bf16 v[196:199], v[96:99], v[132:135], v[196:199]
    v_mfma_f32_16x16x32_bf16 v[204:207], v[100:103], v[132:135], v[204:207]
    s_waitcnt lgkmcnt(5)
    v_mfma_f32_16x16x32_bf16 v[200:203], v[100:103], v[128:131], v[200:203]
    v_smfmac_f32_16x16x64_bf16 v[160:163], v[164:167], v[128:135], v168
    v_mfma_f32_16x16x32_bf16 v[208:211], v[104:107], v[128:131], v[208:211]
    s_waitcnt lgkmcnt(4)
    v_mfma_f32_16x16x32_bf16 v[212:215], v[104:107], v[132:135], v[212:215]
    v_mfma_f32_16x16x32_bf16 v[220:223], v[108:111], v[132:135], v[220:223]
    s_waitcnt lgkmcnt(3)
    v_mfma_f32_16x16x32_bf16 v[216:219], v[108:111], v[128:131], v[216:219]
    v_mfma_f32_16x16x32_bf16 v[224:227], v[112:115], v[128:131], v[224:227]
    s_waitcnt lgkmcnt(2)
    v_mfma_f32_16x16x32_bf16 v[228:231], v[112:115], v[132:135], v[228:231]
    v_mfma_f32_16x16x32_bf16 v[236:239], v[116:119], v[132:135], v[236:239]
    s_waitcnt lgkmcnt(1)
    v_mfma_f32_16x16x32_bf16 v[232:235], v[116:119], v[128:131], v[232:235]
    v_mfma_f32_16x16x32_bf16 v[240:243], v[120:123], v[128:131], v[240:243]
    s_waitcnt lgkmcnt(0)
    v_mfma_f32_16x16x32_bf16 v[244:247], v[120:123], v[132:135], v[244:247]
    v_mfma_f32_16x16x32_bf16 v[252:255], v[124:127], v[132:135], v[252:255]
    v_mfma_f32_16x16x32_bf16 v[248:251], v[124:127], v[128:131], v[248:251]
    s_cmp_eq_u32 s60, 0
    s_cbranch_scc1 L_fin
    s_waitcnt vmcnt(0) lgkmcnt(0)
    s_call_b64 s[82:83], L_pend
    s_barrier
    s_call_b64 s[82:83], L_load
    s_add_i32 s62, s62, 1
    s_branch L_fin
L_tail2:
    s_mov_b32 s65, 0
    v_mfma_f32_16x16x32_bf16 v[192:195], v[96:99], v[128:131], v[192:195]
    s_waitcnt lgkmcnt(6)
    v_exp_f32 v60, v82
    v_exp_f32 v61, v83
    v_mfma_f32_16x16x32_bf16 v[196:199], v[96:99], v[132:135], v[196:199]
    ds_read_b128 v[96:99], v48 offset:57344
    v_cvt_pk_bf16_f32 v136, v58, v59
    v_cvt_pk_bf16_f32 v137, v60, v61
    v_mfma_f32_16x16x32_bf16 v[204:207], v[100:103], v[132:135], v[204:207]
    s_waitcnt lgkmcnt(6)
    v_exp_f32 v58, v84
    v_exp_f32 v59, v85
    v_mfma_f32_16x16x32_bf16 v[200:203], v[100:103], v[128:131], v[200:203]
    ds_read_b128 v[100:103], v48 offset:58368
    v_cvt_pk_bf16_f32 v140, v58, v59
    v_smfmac_f32_16x16x64_bf16 v[160:163], v[164:167], v[128:135], v168
    v_mfma_f32_16x16x32_bf16 v[208:211], v[104:107], v[128:131], v[208:211]
    s_waitcnt lgkmcnt(6)
    v_exp_f32 v60, v86
    v_exp_f32 v61, v87
    v_mfma_f32_16x16x32_bf16 v[212:215], v[104:107], v[132:135], v[212:215]
    ds_read_b128 v[104:107], v48 offset:59392
    v_cvt_pk_bf16_f32 v141, v60, v61
    v_mfma_f32_16x16x32_bf16 v[220:223], v[108:111], v[132:135], v[220:223]
    s_waitcnt lgkmcnt(6)
    v_exp_f32 v58, v88
    v_exp_f32 v59, v89
    v_mfma_f32_16x16x32_bf16 v[216:219], v[108:111], v[128:131], v[216:219]
    ds_read_b128 v[108:111], v48 offset:60416
    v_cvt_pk_bf16_f32 v138, v58, v59
    v_mfma_f32_16x16x32_bf16 v[224:227], v[112:115], v[128:131], v[224:227]
    s_waitcnt lgkmcnt(6)
    v_exp_f32 v60, v90
    v_exp_f32 v61, v91
    v_mfma_f32_16x16x32_bf16 v[228:231], v[112:115], v[132:135], v[228:231]
    ds_read_b128 v[112:115], v48 offset:61440
    v_cvt_pk_bf16_f32 v139, v60, v61
    v_mfma_f32_16x16x32_bf16 v[236:239], v[116:119], v[132:135], v[236:239]
    s_waitcnt lgkmcnt(6)
    v_exp_f32 v58, v92
    v_exp_f32 v59, v93
    v_mfma_f32_16x16x32_bf16 v[232:235], v[116:119], v[128:131], v[232:235]
    ds_read_b128 v[116:119], v48 offset:62464
    v_cvt_pk_bf16_f32 v142, v58, v59
    v_mfma_f32_16x16x32_bf16 v[240:243], v[120:123], v[128:131], v[240:243]
    s_waitcnt lgkmcnt(6)
    v_exp_f32 v60, v94
    v_exp_f32 v61, v95
    v_mfma_f32_16x16x32_bf16 v[244:247], v[120:123], v[132:135], v[244:247]
    ds_read_b128 v[120:123], v48 offset:63488
    v_cvt_pk_bf16_f32 v143, v60, v61
    v_mfma_f32_16x16x32_bf16 v[252:255], v[124:127], v[132:135], v[252:255]
    s_waitcnt lgkmcnt(6)
    v_or3_b32 v62, v136, v137, v140
    v_or3_b32 v62, v62, v141, v138
    v_or3_b32 v62, v62, v139, v142
    v_bitop3_b32 v62, v62, v143, s72 bitop3:0xa8
    v_cmp_ne_u32 vcc, s65, v62
    v_mfma_f32_16x16x32_bf16 v[248:251], v[124:127], v[128:131], v[248:251]
    ds_read_b128 v[124:127], v48 offset:64512
    s_cbranch_vccnz L_back_18_h
L_back_18:
L_pv3:
    v_mfma_f32_16x16x32_bf16 v[192:195], v[96:99], v[136:139], v[192:195]
    s_waitcnt lgkmcnt(6)
    v_mfma_f32_16x16x32_bf16 v[196:199], v[96:99], v[140:143], v[196:199]
    v_xor_b32 v48, 0x10000, v48
    v_mfma_f32_16x16x32_bf16 v[204:207], v[100:103], v[140:143], v[204:207]
    s_waitcnt lgkmcnt(5)
    v_mfma_f32_16x16x32_bf16 v[200:203], v[100:103], v[136:139], v[200:203]
    v_smfmac_f32_16x16x64_bf16 v[160:163], v[164:167], v[136:143], v168
    s_waitcnt vmcnt(0) lgkmcnt(0)
    s_call_b64 s[82:83], L_pend
    s_barrier
    s_call_b64 s[82:83], L_load
    s_add_i32 s62, s62, 1
    v_mfma_f32_16x16x32_bf16 v[208:211], v[104:107], v[136:139], v[208:211]
    v_mfma_f32_16x16x32_bf16 v[212:215], v[104:107], v[140:143], v[212:215]
    v_mfma_f32_16x16x32_bf16 v[220:223], v[108:111], v[140:143], v[220:223]
    v_mfma_f32_16x16x32_bf16 v[216:219], v[108:111], v[136:139], v[216:219]
    v_mfma_f32_16x16x32_bf16 v[224:227], v[112:115], v[136:139], v[224:227]
    v_mfma_f32_16x16x32_bf16 v[228:231], v[112:115], v[140:143], v[228:231]
    v_mfma_f32_16x16x32_bf16 v[236:239], v[116:119], v[140:143], v[236:239]
    v_mfma_f32_16x16x32_bf16 v[232:235], v[116:119], v[136:139], v[232:235]
    v_mfma_f32_16x16x32_bf16 v[240:243], v[120:123], v[136:139], v[240:243]
    v_mfma_f32_16x16x32_bf16 v[244:247], v[120:123], v[140:143], v[244:247]
    v_mfma_f32_16x16x32_bf16 v[252:255], v[124:127], v[140:143], v[252:255]
    v_mfma_f32_16x16x32_bf16 v[248:251], v[124:127], v[136:139], v[248:251]
    s_branch L_fin
L_tail3:
    s_mov_b32 s65, 0
    v_mfma_f32_16x16x32_bf16 v[192:195], v[96:99], v[136:139], v[192:195]
    s_waitcnt lgkmcnt(6)
    v_exp_f32 v60, v66
    v_exp_f32 v61, v67
    v_mfma_f32_16x16x32_bf16 v[196:199], v[96:99], v[140:143], v[196:199]
    v_cvt_pk_bf16_f32 v128, v58, v59
    v_cvt_pk_bf16_f32 v129, v60, v61
    v_xor_b32 v48, 0x10000, v48
    v_mfma_f32_16x16x32_bf16 v[204:207], v[100:103], v[140:143], v[204:207]
    s_waitcnt lgkmcnt(5)
    v_exp_f32 v58, v68
    v_exp_f32 v59, v69
    v_mfma_f32_16x16x32_bf16 v[200:203], v[100:103], v[136:139], v[200:203]
    v_cvt_pk_bf16_f32 v132, v58, v59
    v_smfmac_f32_16x16x64_bf16 v[160:163], v[164:167], v[136:143], v168
    s_waitcnt vmcnt(0) lgkmcnt(0)
    s_call_b64 s[82:83], L_pend
    s_barrier
    s_call_b64 s[82:83], L_load
    s_add_i32 s62, s62, 1
    ds_read_b128 v[96:99], v48 offset:32768
    ds_read_b128 v[100:103], v48 offset:33792
    v_mfma_f32_16x16x32_bf16 v[208:211], v[104:107], v[136:139], v[208:211]
    v_exp_f32 v60, v70
    v_exp_f32 v61, v71
    v_mfma_f32_16x16x32_bf16 v[212:215], v[104:107], v[140:143], v[212:215]
    ds_read_b128 v[104:107], v48 offset:34816
    v_cvt_pk_bf16_f32 v133, v60, v61
    v_mfma_f32_16x16x32_bf16 v[220:223], v[108:111], v[140:143], v[220:223]
    v_exp_f32 v58, v72
    v_exp_f32 v59, v73
    v_mfma_f32_16x16x32_bf16 v[216:219], v[108:111], v[136:139], v[216:219]
    ds_read_b128 v[108:111], v48 offset:35840
    v_cvt_pk_bf16_f32 v130, v58, v59
    v_mfma_f32_16x16x32_bf16 v[224:227], v[112:115], v[136:139], v[224:227]
    v_exp_f32 v60, v74
    v_exp_f32 v61, v75
    v_mfma_f32_16x16x32_bf16 v[228:231], v[112:115], v[140:143], v[228:231]
    ds_read_b128 v[112:115], v48 offset:36864
    v_cvt_pk_bf16_f32 v131, v60, v61
    v_mfma_f32_16x16x32_bf16 v[236:239], v[116:119], v[140:143], v[236:239]
    v_exp_f32 v58, v76
    v_exp_f32 v59, v77
    v_mfma_f32_16x16x32_bf16 v[232:235], v[116:119], v[136:139], v[232:235]
    ds_read_b128 v[116:119], v48 offset:37888
    v_cvt_pk_bf16_f32 v134, v58, v59
    v_mfma_f32_16x16x32_bf16 v[240:243], v[120:123], v[136:139], v[240:243]
    v_exp_f32 v60, v78
    v_exp_f32 v61, v79
    v_mfma_f32_16x16x32_bf16 v[244:247], v[120:123], v[140:143], v[244:247]
    ds_read_b128 v[120:123], v48 offset:38912
    v_cvt_pk_bf16_f32 v135, v60, v61
    v_mfma_f32_16x16x32_bf16 v[252:255], v[124:127], v[140:143], v[252:255]
    s_waitcnt lgkmcnt(6)
    v_or3_b32 v62, v128, v129, v132
    v_or3_b32 v62, v62, v133, v130
    v_or3_b32 v62, v62, v131, v134
    v_bitop3_b32 v62, v62, v135, s72 bitop3:0xa8
    v_cmp_ne_u32 vcc, s65, v62
    v_mfma_f32_16x16x32_bf16 v[248:251], v[124:127], v[136:139], v[248:251]
    ds_read_b128 v[124:127], v48 offset:39936
    s_cbranch_vccnz L_back_21_h
L_back_21:
L_pv0:
    v_mfma_f32_16x16x32_bf16 v[192:195], v[96:99], v[128:131], v[192:195]
    s_waitcnt lgkmcnt(6)
    v_mfma_f32_16x16x32_bf16 v[196:199], v[96:99], v[132:135], v[196:199]
    v_mfma_f32_16x16x32_bf16 v[204:207], v[100:103], v[132:135], v[204:207]
    s_waitcnt lgkmcnt(5)
    v_mfma_f32_16x16x32_bf16 v[200:203], v[100:103], v[128:131], v[200:203]
    v_smfmac_f32_16x16x64_bf16 v[160:163], v[164:167], v[128:135], v168
    v_mfma_f32_16x16x32_bf16 v[208:211], v[104:107], v[128:131], v[208:211]
    s_waitcnt lgkmcnt(4)
    v_mfma_f32_16x16x32_bf16 v[212:215], v[104:107], v[132:135], v[212:215]
    v_mfma_f32_16x16x32_bf16 v[220:223], v[108:111], v[132:135], v[220:223]
    s_waitcnt lgkmcnt(3)
    v_mfma_f32_16x16x32_bf16 v[216:219], v[108:111], v[128:131], v[216:219]
    v_mfma_f32_16x16x32_bf16 v[224:227], v[112:115], v[128:131], v[224:227]
    s_waitcnt lgkmcnt(2)
    v_mfma_f32_16x16x32_bf16 v[228:231], v[112:115], v[132:135], v[228:231]
    v_mfma_f32_16x16x32_bf16 v[236:239], v[116:119], v[132:135], v[236:239]
    s_waitcnt lgkmcnt(1)
    v_mfma_f32_16x16x32_bf16 v[232:235], v[116:119], v[128:131], v[232:235]
    v_mfma_f32_16x16x32_bf16 v[240:243], v[120:123], v[128:131], v[240:243]
    s_waitcnt lgkmcnt(0)
    v_mfma_f32_16x16x32_bf16 v[244:247], v[120:123], v[132:135], v[244:247]
    v_mfma_f32_16x16x32_bf16 v[252:255], v[124:127], v[132:135], v[252:255]
    v_mfma_f32_16x16x32_bf16 v[248:251], v[124:127], v[128:131], v[248:251]
L_fin:
    v_and_b32 v3, 7, v1
    v_lshlrev_b32 v3, 2, v3
    s_mov_b32 s72, 0x3a0000
    buffer_load_dword v51, v3, s[8:11], s72 offen sc1
    v_add_f32 v56, v160, v161
    v_rcp_f32 v56, v56
    v_add_f32 v57, v162, v163
    v_rcp_f32 v57, v57
    s_lshl_b32 s6, s60, 18
    s_lshl_b32 s7, s4, 12
    s_add_u32 s6, s6, s7
    s_add_u32 s6, s6, 50331648
    s_nop 4
    v_mul_f32 v192, v56, v192
    v_mul_f32 v193, v56, v193
    v_mul_f32 v194, v56, v194
    v_mul_f32 v195, v56, v195
    v_cvt_pk_bf16_f32 v16, v192, v193
    v_cvt_pk_bf16_f32 v17, v194, v195
    v_mul_f32 v200, v56, v200
    v_mul_f32 v201, v56, v201
    v_mul_f32 v202, v56, v202
    v_mul_f32 v203, v56, v203
    v_cvt_pk_bf16_f32 v18, v200, v201
    v_cvt_pk_bf16_f32 v19, v202, v203
    buffer_store_dwordx4 v[16:19], v13, s[8:11], s6 offen offset:0 sc1
    v_mul_f32 v208, v56, v208
    v_mul_f32 v209, v56, v209
    v_mul_f32 v210, v56, v210
    v_mul_f32 v211, v56, v211
    v_cvt_pk_bf16_f32 v20, v208, v209
    v_cvt_pk_bf16_f32 v21, v210, v211
    v_mul_f32 v216, v56, v216
    v_mul_f32 v217, v56, v217
    v_mul_f32 v218, v56, v218
    v_mul_f32 v219, v56, v219
    v_cvt_pk_bf16_f32 v22, v216, v217
    v_cvt_pk_bf16_f32 v23, v218, v219
    buffer_store_dwordx4 v[20:23], v13, s[8:11], s6 offen offset:1024 sc1
    v_mul_f32 v224, v56, v224
    v_mul_f32 v225, v56, v225
    v_mul_f32 v226, v56, v226
    v_mul_f32 v227, v56, v227
    v_cvt_pk_bf16_f32 v24, v224, v225
    v_cvt_pk_bf16_f32 v25, v226, v227
    v_mul_f32 v232, v56, v232
    v_mul_f32 v233, v56, v233
    v_mul_f32 v234, v56, v234
    v_mul_f32 v235, v56, v235
    v_cvt_pk_bf16_f32 v26, v232, v233
    v_cvt_pk_bf16_f32 v27, v234, v235
    buffer_store_dwordx4 v[24:27], v13, s[8:11], s6 offen offset:2048 sc1
    v_mul_f32 v240, v56, v240
    v_mul_f32 v241, v56, v241
    v_mul_f32 v242, v56, v242
    v_mul_f32 v243, v56, v243
    v_cvt_pk_bf16_f32 v28, v240, v241
    v_cvt_pk_bf16_f32 v29, v242, v243
    v_mul_f32 v248, v56, v248
    v_mul_f32 v249, v56, v249
    v_mul_f32 v250, v56, v250
    v_mul_f32 v251, v56, v251
    v_cvt_pk_bf16_f32 v30, v248, v249
    v_cvt_pk_bf16_f32 v31, v250, v251
    buffer_store_dwordx4 v[28:31], v13, s[8:11], s6 offen offset:3072 sc1
    s_add_u32 s6, s6, 0x20000
    v_mul_f32 v196, v57, v196
    v_mul_f32 v197, v57, v197
    v_mul_f32 v198, v57, v198
    v_mul_f32 v199, v57, v199
    v_cvt_pk_bf16_f32 v32, v196, v197
    v_cvt_pk_bf16_f32 v33, v198, v199
    v_mul_f32 v204, v57, v204
    v_mul_f32 v205, v57, v205
    v_mul_f32 v206, v57, v206
    v_mul_f32 v207, v57, v207
    v_cvt_pk_bf16_f32 v34, v204, v205
    v_cvt_pk_bf16_f32 v35, v206, v207
    buffer_store_dwordx4 v[32:35], v13, s[8:11], s6 offen offset:0 sc1
    v_mul_f32 v212, v57, v212
    v_mul_f32 v213, v57, v213
    v_mul_f32 v214, v57, v214
    v_mul_f32 v215, v57, v215
    v_cvt_pk_bf16_f32 v36, v212, v213
    v_cvt_pk_bf16_f32 v37, v214, v215
    v_mul_f32 v220, v57, v220
    v_mul_f32 v221, v57, v221
    v_mul_f32 v222, v57, v222
    v_mul_f32 v223, v57, v223
    v_cvt_pk_bf16_f32 v38, v220, v221
    v_cvt_pk_bf16_f32 v39, v222, v223
    buffer_store_dwordx4 v[36:39], v13, s[8:11], s6 offen offset:1024 sc1
    v_mul_f32 v228, v57, v228
    v_mul_f32 v229, v57, v229
    v_mul_f32 v230, v57, v230
    v_mul_f32 v231, v57, v231
    v_cvt_pk_bf16_f32 v40, v228, v229
    v_cvt_pk_bf16_f32 v41, v230, v231
    v_mul_f32 v236, v57, v236
    v_mul_f32 v237, v57, v237
    v_mul_f32 v238, v57, v238
    v_mul_f32 v239, v57, v239
    v_cvt_pk_bf16_f32 v42, v236, v237
    v_cvt_pk_bf16_f32 v43, v238, v239
    buffer_store_dwordx4 v[40:43], v13, s[8:11], s6 offen offset:2048 sc1
    v_mul_f32 v244, v57, v244
    v_mul_f32 v245, v57, v245
    v_mul_f32 v246, v57, v246
    v_mul_f32 v247, v57, v247
    v_cvt_pk_bf16_f32 v44, v244, v245
    v_cvt_pk_bf16_f32 v45, v246, v247
    v_mul_f32 v252, v57, v252
    v_mul_f32 v253, v57, v253
    v_mul_f32 v254, v57, v254
    v_mul_f32 v255, v57, v255
    v_cvt_pk_bf16_f32 v46, v252, v253
    v_cvt_pk_bf16_f32 v47, v254, v255
    buffer_store_dwordx4 v[44:47], v13, s[8:11], s6 offen offset:3072 sc1
    s_sub_i32 s6, s63, 4
    s_cmp_gt_i32 s62, s6
    s_cbranch_scc1 L_pre
    s_waitcnt vmcnt(8)
    s_call_b64 s[82:83], L_pend
    s_barrier
    s_waitcnt vmcnt(0)
    s_lshl_b32 s6, s60, 5
    s_add_u32 s6, s6, s4
    s_lshl_b32 s6, s6, 7
    s_add_u32 s6, s6, 3932160
    v_mov_b32 v2, 1
    v_mov_b32 v3, 0x5000000
    v_writelane_b32 v3, s6, 0
    buffer_store_dword v2, v3, s[8:11], 0 offen sc1
    s_call_b64 s[82:83], L_load
    s_add_i32 s62, s62, 1
    s_lshl_b32 s6, s3, 8
    s_add_u32 s6, s6, s2
    s_cmp_eq_u32 s6, 31
    s_cbranch_scc1 L_top
L_idle:
    s_sub_i32 s6, s63, 5
    s_cmp_gt_i32 s62, s6
    s_cbranch_scc1 L_pre
    s_waitcnt vmcnt(0) lgkmcnt(0)
    s_call_b64 s[82:83], L_pend
    s_barrier
    s_call_b64 s[82:83], L_load
    s_add_i32 s62, s62, 1
    s_cmp_lt_u32 s61, 54
    s_cbranch_scc1 L_moe
    s_branch L_idle
L_pre:
    s_cmp_lt_u32 s3, 4
    s_cbranch_scc1 L_pre1
    s_barrier
    s_lshl_b32 s7, s76, 13
    s_add_u32 s7, s7, 0x10000
    v_add_u32 v3, s7, v13
    v_add_u32 v2, 0x10000, v3
    s_lshl_b32 s7, s76, 12
    s_add_u32 s7, s7, 0x10000
    v_add_u32 v12, s7, v13
    ds_read_b128 v[96:99], v2 offset:0
    ds_read_b128 v[100:103], v2 offset:1024
    ds_read_b128 v[104:107], v2 offset:2048
    ds_read_b128 v[108:111], v2 offset:3072
    ds_read_b128 v[112:115], v2 offset:4096
    ds_read_b128 v[116:119], v2 offset:5120
    ds_read_b128 v[120:123], v2 offset:6144
    ds_read_b128 v[124:127], v2 offset:7168
    ds_read_b128 v[128:131], v3 offset:0
    ds_read_b128 v[132:135], v3 offset:1024
    ds_read_b128 v[136:139], v3 offset:2048
    ds_read_b128 v[140:143], v3 offset:3072
    s_add_u32 s6, s76, 0
    s_and_b32 s6, s6, 3
    s_lshl_b32 s6, s6, 10
    v_add_u32 v44, s6, v13
    s_add_u32 s6, s76, 1
    s_and_b32 s6, s6, 3
    s_lshl_b32 s6, s6, 10
    v_add_u32 v45, s6, v13
    s_add_u32 s6, s76, 2
    s_and_b32 s6, s6, 3
    s_lshl_b32 s6, s6, 10
    v_add_u32 v46, s6, v13
    s_add_u32 s6, s76, 3
    s_and_b32 s6, s6, 3
    s_lshl_b32 s6, s6, 10
    v_add_u32 v47, s6, v13
    v_add_u32 v52, 4096, v13
    s_lshr_b32 s69, s4, 3
    s_lshl_b32 s69, s69, 2
    s_add_u32 s69, s69, s76
    s_mul_i32 s69, s69, 327680
    s_and_b32 s7, s4, 3
    s_mul_i32 s7, s7, 10240
    s_add_u32 s69, s69, s7
    s_add_u32 s69, s69, 4199424
    s_and_b32 s6, s4, 4
    s_lshr_b32 s7, s4, 3
    s_add_u32 s6, s6, s7
    s_lshl_b32 s7, s5, 3
    s_add_u32 s68, s6, s7
    s_sub_u32 s7, 120, s7
    s_add_u32 s61, s6, s7
    s_lshr_b32 s6, s4, 3
    s_lshl_b32 s6, s6, 15
    s_lshl_b32 s99, s3, 12
    s_add_u32 s66, s6, s99
    s_add_u32 s66, s66, 50331648
    s_lshl_b32 s6, s76, 13
    v_add_u32 v4, s6, v13
    v_add_u32 v7, 65536, v4
    ds_read_b128 v[144:147], v3 offset:4096
    ds_read_b128 v[148:151], v3 offset:5120
    ds_read_b128 v[152:155], v3 offset:6144
    ds_read_b128 v[156:159], v3 offset:7168
    ds_read_b128 v[160:163], v12 offset:49152
    ds_read_b128 v[164:167], v12 offset:50176
    ds_read_b128 v[168:171], v12 offset:51200
    ds_read_b128 v[172:175], v12 offset:52224
    s_waitcnt lgkmcnt(0)
    s_barrier
    s_add_u32 s75, s69, 163840
    buffer_load_dwordx4 v[176:179], v44, s[8:11], s75 offen sc1
    buffer_load_dwordx4 v[180:183], v45, s[8:11], s75 offen sc1
    buffer_load_dwordx4 v[184:187], v46, s[8:11], s75 offen sc1
    buffer_load_dwordx4 v[188:191], v47, s[8:11], s75 offen sc1
    buffer_load_dwordx4 v[192:195], v52, s[8:11], s75 offen sc1
    s_branch L_adone
L_pre1:
    s_mov_b32 s28, s56
    s_mov_b32 s29, s57
    s_mov_b32 s30, 0x100
    s_mov_b32 s31, 0x20000
    v_and_b32 v3, 31, v1
    v_lshlrev_b32 v3, 2, v3
    buffer_load_dword v12, v3, s[28:31], 0 offen offset:128 sc1
    v_and_b32 v3, 7, v1
    v_lshlrev_b32 v3, 2, v3
    s_mov_b32 s72, 0x3a0000
    buffer_load_dword v51, v3, s[8:11], s72 offen sc1
    s_add_u32 s6, s76, 0
    s_and_b32 s6, s6, 3
    s_lshl_b32 s6, s6, 10
    v_add_u32 v44, s6, v13
    s_add_u32 s6, s76, 1
    s_and_b32 s6, s6, 3
    s_lshl_b32 s6, s6, 10
    v_add_u32 v45, s6, v13
    s_add_u32 s6, s76, 2
    s_and_b32 s6, s6, 3
    s_lshl_b32 s6, s6, 10
    v_add_u32 v46, s6, v13
    s_add_u32 s6, s76, 3
    s_and_b32 s6, s6, 3
    s_lshl_b32 s6, s6, 10
    v_add_u32 v47, s6, v13
    v_add_u32 v52, 4096, v13
    s_lshr_b32 s69, s4, 3
    s_lshl_b32 s69, s69, 2
    s_add_u32 s69, s69, s76
    s_mul_i32 s69, s69, 327680
    s_and_b32 s7, s4, 3
    s_mul_i32 s7, s7, 10240
    s_add_u32 s69, s69, s7
    s_add_u32 s69, s69, 4194304
    s_and_b32 s6, s4, 4
    s_lshr_b32 s7, s4, 3
    s_add_u32 s6, s6, s7
    s_lshl_b32 s7, s5, 3
    s_add_u32 s68, s6, s7
    s_sub_u32 s7, 120, s7
    s_add_u32 s61, s6, s7
    s_sub_i32 s6, s63, 4
    s_cmp_gt_i32 s62, s6
    s_cbranch_scc1 L_wpoll
    s_cmp_eq_i32 s62, s63
    s_cbranch_scc1 L_lw0
    s_waitcnt vmcnt(0)
L_lw0:
    s_waitcnt vmcnt(20)
    s_call_b64 s[82:83], L_pend
    s_barrier
    s_call_b64 s[82:83], L_load
    s_add_i32 s62, s62, 1
L_e2:
    v_cmp_gt_u32 vcc, 4, v12
    s_cbranch_vccz L_wok
L_wpoll:
    s_mov_b32 s28, s56
    s_mov_b32 s29, s57
    s_mov_b32 s30, 0x100
    s_mov_b32 s31, 0x20000
    v_and_b32 v3, 31, v1
    v_lshlrev_b32 v3, 2, v3
    s_mov_b32 s79, 262144
L_poll_25:
    buffer_load_dword v2, v3, s[28:31], 0 offen offset:128 sc1
    s_waitcnt vmcnt(0)
    v_cmp_gt_u32 vcc, 4, v2
    s_cbranch_vccz L_polldone_26
    s_sleep 8
    s_sub_u32 s79, s79, 1
    s_cmp_lg_u32 s79, 0
    s_cbranch_scc1 L_poll_25
L_polldone_26:
    s_lshl_b32 s6, s60, 5
    s_add_u32 s6, s6, s4
    s_lshl_b32 s6, s6, 7
    s_add_u32 s6, s6, 3932160
    v_mov_b32 v2, 1
    v_mov_b32 v3, 0x5000000
    v_writelane_b32 v3, s6, 0
    buffer_store_dword v2, v3, s[8:11], 0 offen sc1
L_wok:
    s_mov_b32 s90, 1
    s_add_u32 s75, s69, 0
    buffer_load_dwordx4 v[96:99], v44, s[8:11], s75 offen sc1
    buffer_load_dwordx4 v[100:103], v45, s[8:11], s75 offen sc1
    buffer_load_dwordx4 v[104:107], v46, s[8:11], s75 offen sc1
    buffer_load_dwordx4 v[108:111], v47, s[8:11], s75 offen sc1
    buffer_load_dwordx4 v[112:115], v52, s[8:11], s75 offen sc1
    s_add_u32 s75, s69, 40960
    buffer_load_dwordx4 v[116:119], v44, s[8:11], s75 offen sc1
    buffer_load_dwordx4 v[120:123], v45, s[8:11], s75 offen sc1
    buffer_load_dwordx4 v[124:127], v46, s[8:11], s75 offen sc1
    buffer_load_dwordx4 v[128:131], v47, s[8:11], s75 offen sc1
    buffer_load_dwordx4 v[132:135], v52, s[8:11], s75 offen sc1
    s_add_u32 s75, s69, 81920
    buffer_load_dwordx4 v[136:139], v44, s[8:11], s75 offen sc1
    buffer_load_dwordx4 v[140:143], v45, s[8:11], s75 offen sc1
    buffer_load_dwordx4 v[144:147], v46, s[8:11], s75 offen sc1
    buffer_load_dwordx4 v[148:151], v47, s[8:11], s75 offen sc1
    buffer_load_dwordx4 v[152:155], v52, s[8:11], s75 offen sc1
    s_add_u32 s75, s69, 122880
    buffer_load_dwordx4 v[156:159], v44, s[8:11], s75 offen sc1
    buffer_load_dwordx4 v[160:163], v45, s[8:11], s75 offen sc1
    buffer_load_dwordx4 v[164:167], v46, s[8:11], s75 offen sc1
    buffer_load_dwordx4 v[168:171], v47, s[8:11], s75 offen sc1
    buffer_load_dwordx4 v[172:175], v52, s[8:11], s75 offen sc1
    s_cmp_gt_i32 s62, s63
    s_cbranch_scc1 L_e3
    s_cmp_eq_i32 s62, s63
    s_cbranch_scc1 L_lw1
    s_waitcnt vmcnt(20)
L_lw1:
    s_waitcnt vmcnt(20)
    s_call_b64 s[82:83], L_pend
    s_barrier
    s_call_b64 s[82:83], L_load
    s_add_i32 s62, s62, 1
L_e3:
    s_add_u32 s75, s69, 163840
    buffer_load_dwordx4 v[176:179], v44, s[8:11], s75 offen sc1
    buffer_load_dwordx4 v[180:183], v45, s[8:11], s75 offen sc1
    buffer_load_dwordx4 v[184:187], v46, s[8:11], s75 offen sc1
    buffer_load_dwordx4 v[188:191], v47, s[8:11], s75 offen sc1
    buffer_load_dwordx4 v[192:195], v52, s[8:11], s75 offen sc1
    s_add_u32 s75, s69, 204800
    buffer_load_dwordx4 v[196:199], v44, s[8:11], s75 offen sc1
    buffer_load_dwordx4 v[200:203], v45, s[8:11], s75 offen sc1
    buffer_load_dwordx4 v[204:207], v46, s[8:11], s75 offen sc1
    buffer_load_dwordx4 v[208:211], v47, s[8:11], s75 offen sc1
    buffer_load_dwordx4 v[212:215], v52, s[8:11], s75 offen sc1
    s_cmp_gt_i32 s62, s63
    s_cbranch_scc1 L_e4
    s_cmp_eq_i32 s62, s63
    s_cbranch_scc1 L_lw2
    s_waitcnt vmcnt(10)
L_lw2:
    s_waitcnt vmcnt(20)
    s_call_b64 s[82:83], L_pend
    s_barrier
    s_call_b64 s[82:83], L_load
    s_add_i32 s62, s62, 1
L_e4:
    s_lshr_b32 s7, s3, 1
    s_lshl_b32 s7, s7, 4
    s_add_u32 s6, s5, s7
    s_cmp_lg_u32 s6, 2
    s_cbranch_scc1 L_yl0
    v_min_u32 v3, 53, v1
    v_lshlrev_b32 v3, 7, v3
    s_mov_b32 s72, 0xf20000
    buffer_load_dwordx4 v[16:19], v3, s[8:11], s72 offen sc1
L_yl0:
    s_add_u32 s75, s69, 245760
    buffer_load_dwordx4 v[216:219], v44, s[8:11], s75 offen sc1
    buffer_load_dwordx4 v[220:223], v45, s[8:11], s75 offen sc1
    buffer_load_dwordx4 v[224:227], v46, s[8:11], s75 offen sc1
    buffer_load_dwordx4 v[228:231], v47, s[8:11], s75 offen sc1
    buffer_load_dwordx4 v[232:235], v52, s[8:11], s75 offen sc1
    s_add_u32 s75, s69, 286720
    buffer_load_dwordx4 v[236:239], v44, s[8:11], s75 offen sc1
    buffer_load_dwordx4 v[240:243], v45, s[8:11], s75 offen sc1
    buffer_load_dwordx4 v[244:247], v46, s[8:11], s75 offen sc1
    buffer_load_dwordx4 v[248:251], v47, s[8:11], s75 offen sc1
    buffer_load_dwordx4 v[252:255], v52, s[8:11], s75 offen sc1
    s_cmp_gt_i32 s62, s63
    s_cbranch_scc1 L_e5
    s_cmp_eq_i32 s62, s63
    s_cbranch_scc1 L_lw3
    s_waitcnt vmcnt(10)
L_lw3:
    s_waitcnt vmcnt(20)
    s_call_b64 s[82:83], L_pend
    s_barrier
    s_call_b64 s[82:83], L_load
    s_add_i32 s62, s62, 1
L_e5:
    s_mov_b32 s101, 0
    s_lshr_b32 s7, s3, 1
    s_lshl_b32 s7, s7, 4
    s_add_u32 s6, s5, s7
    s_cmp_lg_u32 s6, 2
    s_cbranch_scc1 L_yl1
    v_and_b32 v16, v16, v17
    v_and_b32 v16, v16, v18
    v_and_b32 v16, v16, v19
    v_cmp_ne_u32 vcc, 1, v16
    s_cbranch_vccnz L_yl1
    s_call_b64 s[80:81], L_yld
L_yl1:
    v_and_b32 v3, 1, v1
    v_lshlrev_b32 v3, 12, v3
    v_and_b32 v2, 2, v1
    v_lshl_add_u32 v3, v2, 8, v3
    s_lshr_b32 s72, s68, 2
    s_lshl_b32 s72, s72, 6
    s_andn2_b32 s6, s4, 7
    s_add_u32 s72, s72, s6
    s_add_u32 s72, s72, s3
    s_lshl_b32 s72, s72, 7
    s_add_u32 s72, s72, 3932160
    buffer_load_dword v50, v3, s[8:11], s72 offen sc1
    s_cmp_gt_i32 s62, s63
    s_cbranch_scc1 L_e6
    s_waitcnt vmcnt(20)
    s_call_b64 s[82:83], L_pend
    s_barrier
    s_call_b64 s[82:83], L_load
    s_add_i32 s62, s62, 1
L_e6:
    s_lshr_b32 s7, s3, 1
    s_lshl_b32 s7, s7, 4
    s_add_u32 s6, s5, s7
    s_cmp_lg_u32 s6, 2
    s_cbranch_scc1 L_yd
    s_cmp_lg_u32 s101, 0
    s_cbranch_scc1 L_yf
    v_min_u32 v3, 53, v1
    v_lshlrev_b32 v3, 7, v3
    s_mov_b32 s72, 0xf20000
    s_mov_b32 s79, 262144
L_poll_31:
    buffer_load_dwordx4 v[16:19], v3, s[8:11], s72 offen sc1
    s_waitcnt vmcnt(0)
    v_and_b32 v16, v16, v17
    v_and_b32 v16, v16, v18
    v_and_b32 v16, v16, v19
    v_cmp_ne_u32 vcc, 1, v16
    s_cbranch_vccz L_polldone_32
    s_sleep 16
    s_sub_u32 s79, s79, 1
    s_cmp_lg_u32 s79, 0
    s_cbranch_scc1 L_poll_31
L_polldone_32:
    s_call_b64 s[80:81], L_yld
L_yf:
    s_bfe_u32 s6, s98, 0x10000b
    s_xor_b32 s7, s6, 0xffff
    s_bitcmp1_b32 s6, 15
    s_bitset0_b32 s6, 15
    s_cselect_b32 s6, s6, s7
    s_lshl_b32 s6, s6, 16
    v_mov_b32 v9, s6
    v_mul_f32 v9, 0xbfb8aa3b, v9
    v_exp_f32 v9, v9
    s_nop 0
    v_add_f32 v9, 1.0, v9
    v_rcp_f32 v9, v9
    s_nop 0
    v_cvt_pk_bf16_f32 v9, v9, v9
    v_lshlrev_b32 v9, 16, v9
    v_lshlrev_b32 v10, 2, v1
    v_mov_b32 v3, 0x5000000
    s_waitcnt vmcnt(0)
    v_pk_add_f32 v[16:17], v[16:17], v[20:21]
    v_pk_add_f32 v[18:19], v[18:19], v[22:23]
    v_pk_add_f32 v[16:17], v[16:17], v[24:25]
    v_pk_add_f32 v[18:19], v[18:19], v[26:27]
    v_pk_add_f32 v[16:17], v[16:17], v[28:29]
    v_pk_add_f32 v[18:19], v[18:19], v[30:31]
    v_pk_add_f32 v[16:17], v[16:17], v[32:33]
    v_pk_add_f32 v[18:19], v[18:19], v[34:35]
    v_pk_add_f32 v[16:17], v[16:17], v[36:37]
    v_pk_add_f32 v[18:19], v[18:19], v[38:39]
    v_pk_add_f32 v[16:17], v[16:17], v[40:41]
    v_pk_add_f32 v[18:19], v[18:19], v[42:43]
    v_pk_add_f32 v[16:17], v[16:17], v[56:57]
    v_pk_add_f32 v[18:19], v[18:19], v[58:59]
    v_pk_add_f32 v[16:17], v[16:17], v[60:61]
    v_pk_add_f32 v[18:19], v[18:19], v[62:63]
    v_pk_add_f32 v[16:17], v[16:17], v[64:65]
    v_pk_add_f32 v[18:19], v[18:19], v[66:67]
    v_pk_add_f32 v[16:17], v[16:17], v[68:69]
    v_pk_add_f32 v[18:19], v[18:19], v[70:71]
    v_pk_add_f32 v[16:17], v[16:17], v[72:73]
    v_pk_add_f32 v[18:19], v[18:19], v[74:75]
    v_pk_add_f32 v[16:17], v[16:17], v[76:77]
    v_pk_add_f32 v[18:19], v[18:19], v[78:79]
    v_pk_add_f32 v[16:17], v[16:17], v[80:81]
    v_pk_add_f32 v[18:19], v[18:19], v[82:83]
    v_pk_add_f32 v[16:17], v[16:17], v[84:85]
    v_pk_add_f32 v[18:19], v[18:19], v[86:87]
    v_pk_add_f32 v[16:17], v[16:17], v[88:89]
    v_pk_add_f32 v[18:19], v[18:19], v[90:91]
    v_pk_add_f32 v[16:17], v[16:17], v[92:93]
    v_pk_add_f32 v[18:19], v[18:19], v[94:95]
    v_pk_add_f32 v[16:17], v[16:17], v[4:5]
    v_pk_add_f32 v[18:19], v[18:19], v[6:7]
    ds_bpermute_b32 v20, v10, v16 offset:80
    ds_bpermute_b32 v21, v10, v17 offset:80
    ds_bpermute_b32 v22, v10, v18 offset:80
    ds_bpermute_b32 v23, v10, v19 offset:80
    ds_bpermute_b32 v24, v10, v16 offset:160
    ds_bpermute_b32 v25, v10, v17 offset:160
    ds_bpermute_b32 v26, v10, v18 offset:160
    ds_bpermute_b32 v27, v10, v19 offset:160
    s_waitcnt lgkmcnt(0)
    v_add_f32 v16, v16, v20
    v_add_f32 v16, v16, v24
    v_cvt_pk_bf16_f32 v16, v16, v16
    v_lshlrev_b32 v16, 16, v16
    v_mul_f32 v16, v16, v9
    v_cvt_pk_bf16_f32 v16, v16, v16
    v_lshlrev_b32 v16, 16, v16
    v_lshlrev_b32 v8, 16, v54
    v_add_f32 v16, v16, v8
    v_add_f32 v17, v17, v21
    v_add_f32 v17, v17, v25
    v_cvt_pk_bf16_f32 v17, v17, v17
    v_lshlrev_b32 v17, 16, v17
    v_mul_f32 v17, v17, v9
    v_cvt_pk_bf16_f32 v17, v17, v17
    v_lshlrev_b32 v17, 16, v17
    v_and_b32 v8, 0xffff0000, v54
    v_add_f32 v17, v17, v8
    v_add_f32 v18, v18, v22
    v_add_f32 v18, v18, v26
    v_cvt_pk_bf16_f32 v18, v18, v18
    v_lshlrev_b32 v18, 16, v18
    v_mul_f32 v18, v18, v9
    v_cvt_pk_bf16_f32 v18, v18, v18
    v_lshlrev_b32 v18, 16, v18
    v_lshlrev_b32 v8, 16, v55
    v_add_f32 v18, v18, v8
    v_add_f32 v19, v19, v23
    v_add_f32 v19, v19, v27
    v_cvt_pk_bf16_f32 v19, v19, v19
    v_lshlrev_b32 v19, 16, v19
    v_mul_f32 v19, v19, v9
    v_cvt_pk_bf16_f32 v19, v19, v19
    v_lshlrev_b32 v19, 16, v19
    v_and_b32 v8, 0xffff0000, v55
    v_add_f32 v19, v19, v8
    v_cvt_pk_bf16_f32 v20, v16, v17
    v_cvt_pk_bf16_f32 v21, v18, v19
    v_lshlrev_b32 v2, 3, v1
    v_cmp_lt_u32 vcc, 19, v1
    s_mul_i32 s6, s96, 1280
    s_mul_i32 s7, s97, 160
    v_cndmask_b32 v2, v2, v3, vcc
    s_add_u32 s6, s6, s7
    s_add_u32 s6, s6, 3837952
    buffer_store_dwordx2 v[20:21], v2, s[8:11], s6 offen sc1
L_yd:
    s_lshr_b32 s6, s4, 3
    s_lshl_b32 s6, s6, 15
    s_lshl_b32 s99, s3, 12
    s_add_u32 s66, s6, s99
    s_add_u32 s66, s66, 50331648
    s_lshl_b32 s6, s76, 13
    v_add_u32 v4, s6, v13
    v_add_u32 v7, 65536, v4
    s_waitcnt vmcnt(0)
    v_cmp_ne_u32 vcc, 1, v50
    s_cbranch_vccz L_ce
    v_and_b32 v3, 1, v1
    v_lshlrev_b32 v3, 12, v3
    v_and_b32 v2, 2, v1
    v_lshl_add_u32 v3, v2, 8, v3
    s_lshr_b32 s72, s68, 2
    s_lshl_b32 s72, s72, 6
    s_andn2_b32 s6, s4, 7
    s_add_u32 s72, s72, s6
    s_add_u32 s72, s72, s3
    s_lshl_b32 s72, s72, 7
    s_add_u32 s72, s72, 3932160
    s_mov_b32 s79, 262144
L_poll_33:
    buffer_load_dword v2, v3, s[8:11], s72 offen sc1
    s_waitcnt vmcnt(0)
    v_cmp_ne_u32 vcc, 1, v2
    s_cbranch_vccz L_polldone_34
    s_sleep 4
    s_sub_u32 s79, s79, 1
    s_cmp_lg_u32 s79, 0
    s_cbranch_scc1 L_poll_33
L_polldone_34:
L_ce:
    s_add_u32 s65, s68, 1
    s_and_b32 s65, s65, 3
    s_andn2_b32 s7, s68, 3
    s_add_u32 s65, s65, s7
    s_lshl_b32 s65, s65, 17
    s_add_u32 s65, s65, s66
    s_add_u32 m0, s99, 0
    s_add_u32 s65, s65, 0
    buffer_load_dwordx4 v13, s[8:11], s65 offen offset:0 sc1 lds
    buffer_load_dwordx4 v13, s[8:11], s65 offen offset:1024 sc1 lds
    buffer_load_dwordx4 v13, s[8:11], s65 offen offset:2048 sc1 lds
    buffer_load_dwordx4 v13, s[8:11], s65 offen offset:3072 sc1 lds
    s_add_u32 s65, s68, 1
    s_and_b32 s65, s65, 3
    s_andn2_b32 s7, s68, 3
    s_add_u32 s65, s65, s7
    s_lshl_b32 s65, s65, 17
    s_add_u32 s65, s65, s66
    s_add_u32 m0, s99, 16384
    s_add_u32 s65, s65, 16384
    buffer_load_dwordx4 v13, s[8:11], s65 offen offset:0 sc1 lds
    buffer_load_dwordx4 v13, s[8:11], s65 offen offset:1024 sc1 lds
    buffer_load_dwordx4 v13, s[8:11], s65 offen offset:2048 sc1 lds
    buffer_load_dwordx4 v13, s[8:11], s65 offen offset:3072 sc1 lds
    s_add_u32 s65, s68, 2
    s_and_b32 s65, s65, 3
    s_andn2_b32 s7, s68, 3
    s_add_u32 s65, s65, s7
    s_lshl_b32 s65, s65, 17
    s_add_u32 s65, s65, s66
    s_add_u32 m0, s99, 32768
    s_add_u32 s65, s65, 0
    buffer_load_dwordx4 v13, s[8:11], s65 offen offset:0 sc1 lds
    buffer_load_dwordx4 v13, s[8:11], s65 offen offset:1024 sc1 lds
    buffer_load_dwordx4 v13, s[8:11], s65 offen offset:2048 sc1 lds
    buffer_load_dwordx4 v13, s[8:11], s65 offen offset:3072 sc1 lds
    s_add_u32 s65, s68, 2
    s_and_b32 s65, s65, 3
    s_andn2_b32 s7, s68, 3
    s_add_u32 s65, s65, s7
    s_lshl_b32 s65, s65, 17
    s_add_u32 s65, s65, s66
    s_add_u32 m0, s99, 49152
    s_add_u32 s65, s65, 16384
    buffer_load_dwordx4 v13, s[8:11], s65 offen offset:0 sc1 lds
    buffer_load_dwordx4 v13, s[8:11], s65 offen offset:1024 sc1 lds
    buffer_load_dwordx4 v13, s[8:11], s65 offen offset:2048 sc1 lds
    buffer_load_dwordx4 v13, s[8:11], s65 offen offset:3072 sc1 lds
    s_lshr_b32 s7, s3, 1
    s_lshl_b32 s7, s7, 4
    s_add_u32 s6, s5, s7
    s_cmp_lg_u32 s6, 2
    s_cbranch_scc1 L_yg
    s_lshl_b32 s6, s5, 5
    s_add_u32 s6, s6, s4
    s_lshl_b32 s6, s6, 5
    s_add_u32 s6, s6, s3
    s_lshl_b32 s6, s6, 2
    s_add_u32 s6, s6, 3899392
    v_mov_b32 v2, 1
    v_mov_b32 v3, 0x5000000
    v_writelane_b32 v3, s6, 0
    buffer_store_dword v2, v3, s[8:11], 0 offen sc1
    s_waitcnt vmcnt(1)
    s_branch L_ye
L_yg:
    s_waitcnt vmcnt(0)
L_ye:
    s_setprio 0
    s_barrier
    s_branch L_adone
L_yld:
    v_cmp_le_i32 vcc, 0, v51
    s_cbranch_vccz L_idx_oka
    v_and_b32 v3, 7, v1
    v_lshlrev_b32 v3, 2, v3
    s_mov_b32 s72, 0x3a0000
    s_mov_b32 s79, 262144
L_poll_35:
    buffer_load_dword v51, v3, s[8:11], s72 offen sc1
    s_waitcnt vmcnt(0)
    v_cmp_le_i32 vcc, 0, v51
    s_cbranch_vccz L_polldone_36
    s_sleep 2
    s_sub_u32 s79, s79, 1
    s_cmp_lg_u32 s79, 0
    s_cbranch_scc1 L_poll_35
L_polldone_36:
L_idx_oka:
    s_lshr_b32 s96, s4, 2
    s_and_b32 s97, s4, 3
    s_lshl_b32 s97, s97, 1
    s_add_u32 s97, s97, s3
    s_mov_b32 m0, s96
    s_nop 3
    v_readlane_b32 s98, v51, m0
    s_nop 3
    s_and_b32 s100, s98, 0x7ff
    s_sub_u32 s100, 0x7ff, s100
    v_mul_u32_u24 v2, 13, v1
    v_lshrrev_b32 v2, 8, v2
    v_mul_u32_u24 v3, 20, v2
    v_sub_u32 v8, v1, v3
    s_mov_b32 s6, 368640
    v_mul_lo_u32 v2, v2, s6
    v_lshl_add_u32 v2, v8, 4, v2
    v_cmp_lt_u32 vcc, 59, v1
    v_mov_b32 v3, 0x5000000
    s_nop 0
    v_cndmask_b32 v2, v2, v3, vcc
    s_mul_i32 s6, s96, 2560
    s_mul_i32 s7, s97, 320
    s_add_u32 s6, s6, s7
    s_add_u32 s6, s6, 2686976
    buffer_load_dwordx4 v[16:19], v2, s[8:11], s6 offen sc1
    s_add_u32 s6, s6, 20480
    buffer_load_dwordx4 v[20:23], v2, s[8:11], s6 offen sc1
    s_add_u32 s6, s6, 20480
    buffer_load_dwordx4 v[24:27], v2, s[8:11], s6 offen sc1
    s_add_u32 s6, s6, 20480
    buffer_load_dwordx4 v[28:31], v2, s[8:11], s6 offen sc1
    s_add_u32 s6, s6, 20480
    buffer_load_dwordx4 v[32:35], v2, s[8:11], s6 offen sc1
    s_add_u32 s6, s6, 20480
    buffer_load_dwordx4 v[36:39], v2, s[8:11], s6 offen sc1
    s_add_u32 s6, s6, 20480
    buffer_load_dwordx4 v[40:43], v2, s[8:11], s6 offen sc1
    s_add_u32 s6, s6, 20480
    buffer_load_dwordx4 v[56:59], v2, s[8:11], s6 offen sc1
    s_add_u32 s6, s6, 20480
    buffer_load_dwordx4 v[60:63], v2, s[8:11], s6 offen sc1
    s_add_u32 s6, s6, 20480
    buffer_load_dwordx4 v[64:67], v2, s[8:11], s6 offen sc1
    s_add_u32 s6, s6, 20480
    buffer_load_dwordx4 v[68:71], v2, s[8:11], s6 offen sc1
    s_add_u32 s6, s6, 20480
    buffer_load_dwordx4 v[72:75], v2, s[8:11], s6 offen sc1
    s_add_u32 s6, s6, 20480
    buffer_load_dwordx4 v[76:79], v2, s[8:11], s6 offen sc1
    s_add_u32 s6, s6, 20480
    buffer_load_dwordx4 v[80:83], v2, s[8:11], s6 offen sc1
    s_add_u32 s6, s6, 20480
    buffer_load_dwordx4 v[84:87], v2, s[8:11], s6 offen sc1
    s_add_u32 s6, s6, 20480
    buffer_load_dwordx4 v[88:91], v2, s[8:11], s6 offen sc1
    s_add_u32 s6, s6, 20480
    buffer_load_dwordx4 v[92:95], v2, s[8:11], s6 offen sc1
    s_add_u32 s6, s6, 20480
    buffer_load_dwordx4 v[4:7], v2, s[8:11], s6 offen sc1
    s_add_u32 s6, s6, 20480
    s_lshr_b32 s6, s100, 4
    s_mul_i32 s6, s6, 20480
    s_and_b32 s7, s100, 15
    s_lshl_b32 s7, s7, 4
    s_add_u32 s6, s6, s7
    s_mul_i32 s7, s97, 2560
    s_add_u32 s6, s6, s7
    v_lshrrev_b32 v9, 1, v8
    v_lshlrev_b32 v9, 8, v9
    v_and_b32 v10, 1, v8
    v_lshl_add_u32 v9, v10, 3, v9
    buffer_load_dwordx2 v[54:55], v9, s[8:11], s6 offen sc1
    s_mov_b32 s101, 1
    s_setpc_b64 s[80:81]
L_moe:
    s_add_u32 s6, s62, s5
    s_cmp_lg_u32 s6, 5
    s_cbranch_scc1 L_idle
    s_mov_b32 s12, s48
    s_mov_b32 s13, s49
    s_mov_b32 s14, 0x21c000
    s_mov_b32 s15, 0x20000
    s_cmp_ge_u32 s3, 2
    s_cselect_b32 s12, s50, s12
    s_cselect_b32 s13, s51, s13
    s_mov_b32 s16, s52
    s_mov_b32 s17, s53
    s_mov_b32 s18, 0x21c000
    s_mov_b32 s19, 0x20000
    v_lshrrev_b32 v3, 2, v1
    v_mul_u32_u24 v3, 3456, v3
    v_and_b32 v4, 3, v1
    v_lshl_add_u32 v16, v4, 4, v3
    v_lshrrev_b32 v3, 3, v1
    v_mul_u32_u24 v3, 1280, v3
    v_and_b32 v4, 7, v1
    v_lshl_add_u32 v18, v4, 4, v3
    s_and_b32 s7, s3, 1
    s_mul_i32 s84, s7, 1105920
    s_lshl_b32 s6, s61, 6
    s_add_u32 s84, s84, s6
    s_lshl_b32 s85, s3, 13
    s_add_u32 s85, s85, 131072
    s_mul_i32 s86, s61, 40960
    s_lshl_b32 s6, s3, 7
    s_add_u32 s86, s86, s6
    s_add_u32 m0, s85, 0
    s_nop 0
    buffer_load_dwordx4 v16, s[12:15], s84 offen lds
    s_add_u32 s84, s84, 55296
    s_add_u32 m0, s85, 1024
    s_nop 0
    buffer_load_dwordx4 v16, s[12:15], s84 offen lds
    s_add_u32 s84, s84, 55296
    s_add_u32 m0, s85, 2048
    s_nop 0
    buffer_load_dwordx4 v16, s[12:15], s84 offen lds
    s_add_u32 s84, s84, 55296
    s_add_u32 m0, s85, 3072
    s_nop 0
    buffer_load_dwordx4 v16, s[12:15], s84 offen lds
    s_add_u32 s84, s84, 55296
    s_add_u32 m0, s85, 4096
    s_nop 0
    buffer_load_dwordx4 v16, s[12:15], s84 offen lds
    s_add_u32 s84, s84, 55296
    s_add_u32 m0, s85, 5120
    s_nop 0
    buffer_load_dwordx4 v16, s[12:15], s84 offen lds
    s_add_u32 s84, s84, 55296
    s_add_u32 m0, s85, 6144
    s_nop 0
    buffer_load_dwordx4 v16, s[12:15], s84 offen lds
    s_add_u32 s84, s84, 55296
    s_add_u32 m0, s85, 7168
    s_nop 0
    buffer_load_dwordx4 v16, s[12:15], s84 offen lds
    s_add_u32 s84, s84, 55296
    v_lshrrev_b32 v7, 4, v1
    v_and_b32 v2, 15, v1
    v_lshrrev_b32 v3, 2, v2
    v_lshl_add_u32 v8, v7, 3, v3
    v_lshlrev_b32 v8, 6, v8
    v_and_b32 v4, 3, v2
    v_lshl_add_u32 v8, v4, 3, v8
    v_add_u32 v17, s85, v8
    v_lshl_add_u32 v8, v7, 2, v3
    v_lshlrev_b32 v8, 7, v8
    v_lshl_add_u32 v8, v4, 3, v8
    s_add_u32 s6, s85, 4096
    v_add_u32 v19, s6, v8
    v_mul_u32_u24 v3, 2560, v2
    v_lshl_add_u32 v3, v7, 4, v3
    v_mov_b32 v4, 0x5000000
    v_cmp_gt_u32 vcc, 8, v2
    s_mul_i32 s87, s61, 20480
    s_lshl_b32 s7, s3, 8
    s_add_u32 s87, s87, s7
    s_add_u32 s87, s87, 2686976
    v_cndmask_b32 v20, v4, v3, vcc
    s_and_b32 s7, s3, 1
    s_mul_i32 s88, s7, 10240
    s_add_u32 s88, s88, 12582912
    s_waitcnt vmcnt(0) lgkmcnt(0)
    s_call_b64 s[82:83], L_pend
    s_barrier
    ds_read_b64_tr_b16 v[104:105], v17 offset:0
    ds_read_b64_tr_b16 v[106:107], v17 offset:256
    ds_read_b64_tr_b16 v[108:109], v17 offset:32
    ds_read_b64_tr_b16 v[110:111], v17 offset:288
    ds_read_b64_tr_b16 v[112:113], v17 offset:2048
    ds_read_b64_tr_b16 v[114:115], v17 offset:2304
    ds_read_b64_tr_b16 v[116:117], v17 offset:2080
    ds_read_b64_tr_b16 v[118:119], v17 offset:2336
    s_waitcnt lgkmcnt(0)
    ds_read_b64_tr_b16 v[120:121], v17 offset:4096
    ds_read_b64_tr_b16 v[122:123], v17 offset:4352
    ds_read_b64_tr_b16 v[124:125], v17 offset:4128
    ds_read_b64_tr_b16 v[126:127], v17 offset:4384
    ds_read_b64_tr_b16 v[128:129], v17 offset:6144
    ds_read_b64_tr_b16 v[130:131], v17 offset:6400
    ds_read_b64_tr_b16 v[132:133], v17 offset:6176
    ds_read_b64_tr_b16 v[134:135], v17 offset:6432
    s_waitcnt lgkmcnt(0)
    s_add_u32 m0, s85, 0
    s_nop 0
    buffer_load_dwordx4 v16, s[12:15], s84 offen lds
    s_add_u32 s84, s84, 55296
    s_add_u32 m0, s85, 1024
    s_nop 0
    buffer_load_dwordx4 v16, s[12:15], s84 offen lds
    s_add_u32 s84, s84, 55296
    s_add_u32 m0, s85, 2048
    s_nop 0
    buffer_load_dwordx4 v16, s[12:15], s84 offen lds
    s_add_u32 s84, s84, 55296
    s_add_u32 m0, s85, 3072
    s_nop 0
    buffer_load_dwordx4 v16, s[12:15], s84 offen lds
    s_add_u32 s84, s84, 55296
    s_add_u32 m0, s85, 4096
    s_nop 0
    buffer_load_dwordx4 v16, s[12:15], s84 offen lds
    s_add_u32 s84, s84, 55296
    s_add_u32 m0, s85, 5120
    s_nop 0
    buffer_load_dwordx4 v16, s[12:15], s84 offen lds
    s_add_u32 s84, s84, 55296
    s_add_u32 m0, s85, 6144
    s_nop 0
    buffer_load_dwordx4 v16, s[12:15], s84 offen lds
    s_add_u32 s84, s84, 55296
    s_add_u32 m0, s85, 7168
    s_nop 0
    buffer_load_dwordx4 v16, s[12:15], s84 offen lds
    s_add_u32 s84, s84, 55296
    s_call_b64 s[82:83], L_load
    s_add_i32 s62, s62, 1
    v_and_b32 v3, 7, v1
    v_lshlrev_b32 v3, 2, v3
    s_mov_b32 s72, 0x3a0000
    buffer_load_dword v51, v3, s[8:11], s72 offen sc1
    s_waitcnt vmcnt(0) lgkmcnt(0)
    s_call_b64 s[82:83], L_pend
    s_barrier
    ds_read_b64_tr_b16 v[136:137], v17 offset:0
    ds_read_b64_tr_b16 v[138:139], v17 offset:256
    ds_read_b64_tr_b16 v[140:141], v17 offset:32
    ds_read_b64_tr_b16 v[142:143], v17 offset:288
    ds_read_b64_tr_b16 v[144:145], v17 offset:2048
    ds_read_b64_tr_b16 v[146:147], v17 offset:2304
    ds_read_b64_tr_b16 v[148:149], v17 offset:2080
    ds_read_b64_tr_b16 v[150:151], v17 offset:2336
    s_waitcnt lgkmcnt(0)
    ds_read_b64_tr_b16 v[152:153], v17 offset:4096
    ds_read_b64_tr_b16 v[154:155], v17 offset:4352
    ds_read_b64_tr_b16 v[156:157], v17 offset:4128
    ds_read_b64_tr_b16 v[158:159], v17 offset:4384
    ds_read_b64_tr_b16 v[160:161], v17 offset:6144
    ds_read_b64_tr_b16 v[162:163], v17 offset:6400
    ds_read_b64_tr_b16 v[164:165], v17 offset:6176
    ds_read_b64_tr_b16 v[166:167], v17 offset:6432
    s_waitcnt lgkmcnt(0)
    s_add_u32 m0, s85, 0
    s_nop 0
    buffer_load_dwordx4 v16, s[12:15], s84 offen lds
    s_add_u32 s84, s84, 55296
    s_add_u32 m0, s85, 1024
    s_nop 0
    buffer_load_dwordx4 v16, s[12:15], s84 offen lds
    s_add_u32 s84, s84, 55296
    s_add_u32 m0, s85, 2048
    s_nop 0
    buffer_load_dwordx4 v16, s[12:15], s84 offen lds
    s_add_u32 s84, s84, 55296
    s_add_u32 m0, s85, 3072
    s_nop 0
    buffer_load_dwordx4 v16, s[12:15], s84 offen lds
    s_add_u32 s84, s84, 55296
    s_add_u32 m0, s85, 4096
    s_add_u32 s6, s86, 0
    buffer_load_dwordx4 v18, s[16:19], s6 offen lds
    s_add_u32 m0, s85, 5120
    s_add_u32 s6, s86, 10240
    buffer_load_dwordx4 v18, s[16:19], s6 offen lds
    s_add_u32 m0, s85, 6144
    s_add_u32 s6, s86, 20480
    buffer_load_dwordx4 v18, s[16:19], s6 offen lds
    s_add_u32 m0, s85, 7168
    s_add_u32 s6, s86, 30720
    buffer_load_dwordx4 v18, s[16:19], s6 offen lds
    s_add_u32 s86, s86, 512
    s_call_b64 s[82:83], L_load
    s_add_i32 s62, s62, 1
    v_cmp_le_i32 vcc, 0, v51
    s_cbranch_vccz L_idx_okm
    v_and_b32 v3, 7, v1
    v_lshlrev_b32 v3, 2, v3
    s_mov_b32 s72, 0x3a0000
    s_mov_b32 s79, 262144
L_poll_39:
    buffer_load_dword v51, v3, s[8:11], s72 offen sc1
    s_waitcnt vmcnt(0)
    v_cmp_le_i32 vcc, 0, v51
    s_cbranch_vccz L_polldone_40
    s_sleep 2
    s_sub_u32 s79, s79, 1
    s_cmp_lg_u32 s79, 0
    s_cbranch_scc1 L_poll_39
L_polldone_40:
L_idx_okm:
    buffer_load_dwordx4 v[64:67], v13, s[8:11], s88 offen sc1
    s_add_u32 s88, s88, 1024
    buffer_load_dwordx4 v[68:71], v13, s[8:11], s88 offen sc1
    s_add_u32 s88, s88, 1024
    buffer_load_dwordx4 v[72:75], v13, s[8:11], s88 offen sc1
    s_add_u32 s88, s88, 1024
    buffer_load_dwordx4 v[76:79], v13, s[8:11], s88 offen sc1
    s_add_u32 s88, s88, 1024
    buffer_load_dwordx4 v[80:83], v13, s[8:11], s88 offen sc1
    s_add_u32 s88, s88, 1024
    buffer_load_dwordx4 v[84:87], v13, s[8:11], s88 offen sc1
    s_add_u32 s88, s88, 1024
    buffer_load_dwordx4 v[88:91], v13, s[8:11], s88 offen sc1
    s_add_u32 s88, s88, 1024
    buffer_load_dwordx4 v[92:95], v13, s[8:11], s88 offen sc1
    s_add_u32 s88, s88, 1024
    buffer_load_dwordx4 v[96:99], v13, s[8:11], s88 offen sc1
    s_add_u32 s88, s88, 1024
    buffer_load_dwordx4 v[100:103], v13, s[8:11], s88 offen sc1
    s_add_u32 s88, s88, 1024
    s_waitcnt vmcnt(10) lgkmcnt(0)
    s_call_b64 s[82:83], L_pend
    s_barrier
    ds_read_b64_tr_b16 v[168:169], v17 offset:0
    ds_read_b64_tr_b16 v[170:171], v17 offset:256
    ds_read_b64_tr_b16 v[172:173], v17 offset:32
    ds_read_b64_tr_b16 v[174:175], v17 offset:288
    ds_read_b64_tr_b16 v[176:177], v17 offset:2048
    ds_read_b64_tr_b16 v[178:179], v17 offset:2304
    ds_read_b64_tr_b16 v[180:181], v17 offset:2080
    ds_read_b64_tr_b16 v[182:183], v17 offset:2336
    s_waitcnt lgkmcnt(0)
    ds_read_b64_tr_b16 v[32:33], v19 offset:0
    ds_read_b64_tr_b16 v[34:35], v19 offset:2048
    ds_read_b64_tr_b16 v[36:37], v19 offset:32
    ds_read_b64_tr_b16 v[38:39], v19 offset:2080
    ds_read_b64_tr_b16 v[40:41], v19 offset:64
    ds_read_b64_tr_b16 v[42:43], v19 offset:2112
    ds_read_b64_tr_b16 v[44:45], v19 offset:96
    ds_read_b64_tr_b16 v[46:47], v19 offset:2144
    s_waitcnt lgkmcnt(0)
    s_add_u32 m0, s85, 4096
    s_add_u32 s6, s86, 0
    buffer_load_dwordx4 v18, s[16:19], s6 offen lds
    s_add_u32 m0, s85, 5120
    s_add_u32 s6, s86, 10240
    buffer_load_dwordx4 v18, s[16:19], s6 offen lds
    s_add_u32 m0, s85, 6144
    s_add_u32 s6, s86, 20480
    buffer_load_dwordx4 v18, s[16:19], s6 offen lds
    s_add_u32 m0, s85, 7168
    s_add_u32 s6, s86, 30720
    buffer_load_dwordx4 v18, s[16:19], s6 offen lds
    s_add_u32 s86, s86, 512
    s_call_b64 s[82:83], L_load
    s_add_i32 s62, s62, 1
    s_waitcnt vmcnt(20)
    v_mfma_f32_16x16x32_bf16 v[24:27], v[104:107], v[64:67], 0
    v_mfma_f32_16x16x32_bf16 v[28:31], v[108:111], v[64:67], 0
    v_mfma_f32_16x16x32_bf16 v[24:27], v[112:115], v[68:71], v[24:27]
    v_mfma_f32_16x16x32_bf16 v[28:31], v[116:119], v[68:71], v[28:31]
    v_mfma_f32_16x16x32_bf16 v[24:27], v[120:123], v[72:75], v[24:27]
    v_mfma_f32_16x16x32_bf16 v[28:31], v[124:127], v[72:75], v[28:31]
    v_mfma_f32_16x16x32_bf16 v[24:27], v[128:131], v[76:79], v[24:27]
    v_mfma_f32_16x16x32_bf16 v[28:31], v[132:135], v[76:79], v[28:31]
    v_mfma_f32_16x16x32_bf16 v[24:27], v[136:139], v[80:83], v[24:27]
    v_mfma_f32_16x16x32_bf16 v[28:31], v[140:143], v[80:83], v[28:31]
    v_mfma_f32_16x16x32_bf16 v[24:27], v[144:147], v[84:87], v[24:27]
    v_mfma_f32_16x16x32_bf16 v[28:31], v[148:151], v[84:87], v[28:31]
    v_mfma_f32_16x16x32_bf16 v[24:27], v[152:155], v[88:91], v[24:27]
    v_mfma_f32_16x16x32_bf16 v[28:31], v[156:159], v[88:91], v[28:31]
    v_mfma_f32_16x16x32_bf16 v[24:27], v[160:163], v[92:95], v[24:27]
    v_mfma_f32_16x16x32_bf16 v[28:31], v[164:167], v[92:95], v[28:31]
    v_mfma_f32_16x16x32_bf16 v[24:27], v[168:171], v[96:99], v[24:27]
    v_mfma_f32_16x16x32_bf16 v[28:31], v[172:175], v[96:99], v[28:31]
    v_mfma_f32_16x16x32_bf16 v[24:27], v[176:179], v[100:103], v[24:27]
    v_mfma_f32_16x16x32_bf16 v[28:31], v[180:183], v[100:103], v[28:31]
    v_add_u32 v10, s85, v13
    s_nop 7
    ds_write_b128 v10, v[24:27]
    ds_write_b128 v10, v[28:31] offset:1024
    s_waitcnt vmcnt(0) lgkmcnt(0)
    s_call_b64 s[82:83], L_pend
    s_barrier
    ds_read_b64_tr_b16 v[240:241], v19 offset:0
    ds_read_b64_tr_b16 v[242:243], v19 offset:2048
    ds_read_b64_tr_b16 v[244:245], v19 offset:32
    ds_read_b64_tr_b16 v[246:247], v19 offset:2080
    ds_read_b64_tr_b16 v[248:249], v19 offset:64
    ds_read_b64_tr_b16 v[250:251], v19 offset:2112
    ds_read_b64_tr_b16 v[252:253], v19 offset:96
    ds_read_b64_tr_b16 v[254:255], v19 offset:2144
    s_lshr_b32 s6, s3, 1
    s_lshl_b32 s6, s6, 10
    s_and_b32 s7, s3, 1
    s_lshl_b32 s7, s7, 3
    s_add_u32 s6, s6, s7
    s_add_u32 s6, s6, 131072
    v_add_u32 v10, s6, v13
    s_waitcnt lgkmcnt(0)
    ds_read_b64 v[184:185], v10 offset:0
    ds_read_b64 v[186:187], v10 offset:8192
    ds_read_b64 v[188:189], v10 offset:16384
    ds_read_b64 v[190:191], v10 offset:24576
    s_cmp_ge_u32 s3, 2
    s_cbranch_scc1 L_moe4b
    s_add_u32 m0, s85, 4096
    s_add_u32 s6, s86, 0
    buffer_load_dwordx4 v18, s[16:19], s6 offen lds
    s_add_u32 m0, s85, 5120
    s_add_u32 s6, s86, 10240
    buffer_load_dwordx4 v18, s[16:19], s6 offen lds
    s_add_u32 m0, s85, 6144
    s_add_u32 s6, s86, 20480
    buffer_load_dwordx4 v18, s[16:19], s6 offen lds
    s_add_u32 m0, s85, 7168
    s_add_u32 s6, s86, 30720
    buffer_load_dwordx4 v18, s[16:19], s6 offen lds
    s_add_u32 s86, s86, 512
L_moe4b:
    s_call_b64 s[82:83], L_load
    s_add_i32 s62, s62, 1
    s_waitcnt lgkmcnt(0)
    s_mov_b32 s6, 0xbfb8aa3b
    v_add_f32 v184, v184, v186
    v_add_f32 v188, v188, v190
    v_add_f32 v185, v185, v187
    v_add_f32 v189, v189, v191
    v_cvt_pk_bf16_f32 v185, v184, v185
    v_lshlrev_b32 v184, 16, v185
    v_and_b32 v185, 0xffff0000, v185
    v_cvt_pk_bf16_f32 v189, v188, v189
    v_lshlrev_b32 v188, 16, v189
    v_and_b32 v189, 0xffff0000, v189
    v_mul_f32 v2, s6, v184
    v_mul_f32 v3, s6, v185
    v_exp_f32 v2, v2
    v_exp_f32 v3, v3
    s_nop 0
    v_add_f32 v2, 1.0, v2
    v_add_f32 v3, 1.0, v3
    v_rcp_f32 v2, v2
    v_rcp_f32 v3, v3
    s_nop 0
    v_mul_f32 v184, v184, v2
    v_mul_f32 v185, v185, v3
    v_cvt_pk_bf16_f32 v185, v184, v185
    v_lshlrev_b32 v184, 16, v185
    v_and_b32 v185, 0xffff0000, v185
    v_mul_f32 v184, v184, v188
    v_mul_f32 v185, v185, v189
    v_cvt_pk_bf16_f32 v2, v184, v185
    s_lshl_b32 s6, s3, 2
    s_add_u32 s6, s6, 133120
    v_add_u32 v10, s6, v13
    ds_write_b32 v10, v2
    s_waitcnt vmcnt(0) lgkmcnt(0)
    s_call_b64 s[82:83], L_pend
    s_barrier
    v_add_u32 v10, 133120, v13
    ds_read_b128 v[24:27], v10
    ds_read_b64_tr_b16 v[104:105], v19 offset:0
    ds_read_b64_tr_b16 v[106:107], v19 offset:2048
    ds_read_b64_tr_b16 v[108:109], v19 offset:32
    ds_read_b64_tr_b16 v[110:111], v19 offset:2080
    ds_read_b64_tr_b16 v[112:113], v19 offset:64
    ds_read_b64_tr_b16 v[114:115], v19 offset:2112
    ds_read_b64_tr_b16 v[116:117], v19 offset:96
    ds_read_b64_tr_b16 v[118:119], v19 offset:2144
    s_call_b64 s[82:83], L_load
    s_add_i32 s62, s62, 1
    s_waitcnt lgkmcnt(0)
    v_mfma_f32_16x16x32_bf16 v[216:219], v[32:35], v[24:27], 0
    v_mfma_f32_16x16x32_bf16 v[220:223], v[36:39], v[24:27], 0
    v_mfma_f32_16x16x32_bf16 v[224:227], v[40:43], v[24:27], 0
    v_mfma_f32_16x16x32_bf16 v[228:231], v[44:47], v[24:27], 0
    s_nop 7
    buffer_store_dwordx4 v[216:219], v20, s[8:11], s87 offen offset:0 sc1
    buffer_store_dwordx4 v[220:223], v20, s[8:11], s87 offen offset:64 sc1
    buffer_store_dwordx4 v[224:227], v20, s[8:11], s87 offen offset:128 sc1
    buffer_store_dwordx4 v[228:231], v20, s[8:11], s87 offen offset:192 sc1
    s_nop 1
    v_mfma_f32_16x16x32_bf16 v[216:219], v[240:243], v[24:27], 0
    v_mfma_f32_16x16x32_bf16 v[220:223], v[244:247], v[24:27], 0
    v_mfma_f32_16x16x32_bf16 v[224:227], v[248:251], v[24:27], 0
    v_mfma_f32_16x16x32_bf16 v[228:231], v[252:255], v[24:27], 0
    s_nop 7
    buffer_store_dwordx4 v[216:219], v20, s[8:11], s87 offen offset:1024 sc1
    buffer_store_dwordx4 v[220:223], v20, s[8:11], s87 offen offset:1088 sc1
    buffer_store_dwordx4 v[224:227], v20, s[8:11], s87 offen offset:1152 sc1
    buffer_store_dwordx4 v[228:231], v20, s[8:11], s87 offen offset:1216 sc1
    s_nop 1
    s_cmp_ge_u32 s3, 2
    s_cbranch_scc1 L_moe5b
    v_mfma_f32_16x16x32_bf16 v[216:219], v[104:107], v[24:27], 0
    v_mfma_f32_16x16x32_bf16 v[220:223], v[108:111], v[24:27], 0
    v_mfma_f32_16x16x32_bf16 v[224:227], v[112:115], v[24:27], 0
    v_mfma_f32_16x16x32_bf16 v[228:231], v[116:119], v[24:27], 0
    s_nop 7
    buffer_store_dwordx4 v[216:219], v20, s[8:11], s87 offen offset:2048 sc1
    buffer_store_dwordx4 v[220:223], v20, s[8:11], s87 offen offset:2112 sc1
    buffer_store_dwordx4 v[224:227], v20, s[8:11], s87 offen offset:2176 sc1
    buffer_store_dwordx4 v[228:231], v20, s[8:11], s87 offen offset:2240 sc1
    s_nop 1
L_moe5b:
    s_waitcnt vmcnt(8) lgkmcnt(0)
    s_call_b64 s[82:83], L_pend
    s_barrier
    s_waitcnt vmcnt(0)
    s_lshl_b32 s6, s61, 5
    s_add_u32 s6, s6, s3
    s_lshl_b32 s6, s6, 2
    s_add_u32 s6, s6, 15859712
    v_mov_b32 v2, 1
    v_mov_b32 v3, 0x5000000
    v_writelane_b32 v3, s6, 0
    buffer_store_dword v2, v3, s[8:11], 0 offen sc1
    s_call_b64 s[82:83], L_load
    s_add_i32 s62, s62, 1
    s_branch L_idle
L_top:
    s_mov_b32 s6, 0x280000
    v_lshrrev_b32 v2, 1, v1
    v_and_b32 v3, 1, v1
    v_lshlrev_b32 v3, 4, v3
    v_lshl_add_u32 v2, v2, 7, v3
    buffer_load_dwordx4 v[64:67], v2, s[8:11], s6 offen sc1
    s_add_u32 s6, s6, 4096
    buffer_load_dwordx4 v[68:71], v2, s[8:11], s6 offen sc1
    s_add_u32 s6, s6, 4096
    buffer_load_dwordx4 v[72:75], v2, s[8:11], s6 offen sc1
    s_add_u32 s6, s6, 4096
    buffer_load_dwordx4 v[76:79], v2, s[8:11], s6 offen sc1
    s_add_u32 s6, s6, 4096
    buffer_load_dwordx4 v[80:83], v2, s[8:11], s6 offen sc1
    s_add_u32 s6, s6, 4096
    buffer_load_dwordx4 v[84:87], v2, s[8:11], s6 offen sc1
    s_add_u32 s6, s6, 4096
    buffer_load_dwordx4 v[88:91], v2, s[8:11], s6 offen sc1
    s_add_u32 s6, s6, 4096
    buffer_load_dwordx4 v[92:95], v2, s[8:11], s6 offen sc1
    s_add_u32 s6, s6, 4096
    s_waitcnt vmcnt(0)
    v_mov_b32 v24, 0
    s_mov_b32 s7, 0
    s_mov_b32 s84, 0
L_top_l:
    v_max3_u32 v4, v64, v65, v66
    v_max3_u32 v5, v67, v68, v69
    v_max3_u32 v4, v4, v70, v71
    v_max3_u32 v5, v5, v72, v73
    v_max3_u32 v4, v4, v74, v75
    v_max3_u32 v5, v5, v76, v77
    v_max3_u32 v4, v4, v78, v79
    v_max3_u32 v5, v5, v80, v81
    v_max3_u32 v4, v4, v82, v83
    v_max3_u32 v5, v5, v84, v85
    v_max3_u32 v4, v4, v86, v87
    v_max3_u32 v5, v5, v88, v89
    v_max3_u32 v4, v4, v90, v91
    v_max3_u32 v5, v5, v92, v93
    v_max3_u32 v4, v4, v94, v95
    v_max_u32 v4, v4, v5
    s_nop 1
    v_max_u32_dpp v4, v4, v4 quad_perm:[1,0,3,2] row_mask:0xf bank_mask:0xf
    s_nop 1
    v_max_u32_dpp v4, v4, v4 quad_perm:[2,3,0,1] row_mask:0xf bank_mask:0xf
    s_nop 1
    v_max_u32_dpp v4, v4, v4 row_half_mirror row_mask:0xf bank_mask:0xf
    s_nop 1
    v_max_u32_dpp v4, v4, v4 row_mirror row_mask:0xf bank_mask:0xf
    s_nop 1
    v_max_u32_dpp v4, v4, v4 row_bcast:15 row_mask:0xa bank_mask:0xf
    s_nop 1
    v_max_u32_dpp v4, v4, v4 row_bcast:31 row_mask:0xc bank_mask:0xf
    s_nop 1
    v_readlane_b32 s6, v4, 63
    s_mov_b32 m0, s7
    s_nop 3
    s_add_u32 s84, s84, s6
    v_writelane_b32 v24, s84, m0
    v_subrev_u32 v64, s6, v64
    v_subrev_u32 v65, s6, v65
    v_subrev_u32 v66, s6, v66
    v_subrev_u32 v67, s6, v67
    v_subrev_u32 v68, s6, v68
    v_subrev_u32 v69, s6, v69
    v_subrev_u32 v70, s6, v70
    v_subrev_u32 v71, s6, v71
    v_subrev_u32 v72, s6, v72
    v_subrev_u32 v73, s6, v73
    v_subrev_u32 v74, s6, v74
    v_subrev_u32 v75, s6, v75
    v_subrev_u32 v76, s6, v76
    v_subrev_u32 v77, s6, v77
    v_subrev_u32 v78, s6, v78
    v_subrev_u32 v79, s6, v79
    v_subrev_u32 v80, s6, v80
    v_subrev_u32 v81, s6, v81
    v_subrev_u32 v82, s6, v82
    v_subrev_u32 v83, s6, v83
    v_subrev_u32 v84, s6, v84
    v_subrev_u32 v85, s6, v85
    v_subrev_u32 v86, s6, v86
    v_subrev_u32 v87, s6, v87
    v_subrev_u32 v88, s6, v88
    v_subrev_u32 v89, s6, v89
    v_subrev_u32 v90, s6, v90
    v_subrev_u32 v91, s6, v91
    v_subrev_u32 v92, s6, v92
    v_subrev_u32 v93, s6, v93
    v_subrev_u32 v94, s6, v94
    v_subrev_u32 v95, s6, v95
    s_add_u32 s7, s7, 1
    s_cmp_lt_u32 s7, 8
    s_cbranch_scc1 L_top_l
    v_and_b32 v2, 7, v1
    v_lshlrev_b32 v2, 2, v2
    ds_bpermute_b32 v4, v2, v24
    s_waitcnt lgkmcnt(0)
    v_and_b32 v4, 0x7ff, v4
    v_sub_u32 v4, 0x7ff, v4
    v_lshrrev_b32 v5, 4, v4
    v_mul_u32_u24 v5, 20480, v5
    v_and_b32 v4, 15, v4
    v_lshl_add_u32 v5, v4, 4, v5
    v_lshrrev_b32 v7, 4, v1
    v_lshl_add_u32 v5, v7, 8, v5
    v_mov_b32 v6, 0x5000000
    v_and_b32 v2, 8, v1
    v_cmp_eq_u32 vcc, 0, v2
    s_mov_b32 s6, 0
    s_nop 0
    v_cndmask_b32 v5, v6, v5, vcc
    buffer_load_dwordx4 v[64:67], v5, s[8:11], s6 offen offset:0 sc1
    buffer_load_dwordx4 v[68:71], v5, s[8:11], s6 offen offset:1024 sc1
    buffer_load_dwordx4 v[72:75], v5, s[8:11], s6 offen offset:2048 sc1
    buffer_load_dwordx4 v[76:79], v5, s[8:11], s6 offen offset:3072 sc1
    s_add_u32 s6, s6, 4096
    buffer_load_dwordx4 v[80:83], v5, s[8:11], s6 offen offset:0 sc1
    buffer_load_dwordx4 v[84:87], v5, s[8:11], s6 offen offset:1024 sc1
    buffer_load_dwordx4 v[88:91], v5, s[8:11], s6 offen offset:2048 sc1
    buffer_load_dwordx4 v[92:95], v5, s[8:11], s6 offen offset:3072 sc1
    s_add_u32 s6, s6, 4096
    buffer_load_dwordx4 v[96:99], v5, s[8:11], s6 offen offset:0 sc1
    buffer_load_dwordx4 v[100:103], v5, s[8:11], s6 offen offset:1024 sc1
    buffer_load_dwordx4 v[104:107], v5, s[8:11], s6 offen offset:2048 sc1
    buffer_load_dwordx4 v[108:111], v5, s[8:11], s6 offen offset:3072 sc1
    s_add_u32 s6, s6, 4096
    buffer_load_dwordx4 v[112:115], v5, s[8:11], s6 offen offset:0 sc1
    buffer_load_dwordx4 v[116:119], v5, s[8:11], s6 offen offset:1024 sc1
    buffer_load_dwordx4 v[120:123], v5, s[8:11], s6 offen offset:2048 sc1
    buffer_load_dwordx4 v[124:127], v5, s[8:11], s6 offen offset:3072 sc1
    s_add_u32 s6, s6, 4096
    buffer_load_dwordx4 v[128:131], v5, s[8:11], s6 offen offset:0 sc1
    buffer_load_dwordx4 v[132:135], v5, s[8:11], s6 offen offset:1024 sc1
    buffer_load_dwordx4 v[136:139], v5, s[8:11], s6 offen offset:2048 sc1
    buffer_load_dwordx4 v[140:143], v5, s[8:11], s6 offen offset:3072 sc1
    s_waitcnt vmcnt(20)
    s_call_b64 s[82:83], L_pend
    s_barrier
    s_waitcnt vmcnt(0)
    s_mov_b32 s6, 0xc00000
    buffer_store_dwordx4 v[64:67], v13, s[8:11], s6 offen offset:0 sc1
    buffer_store_dwordx4 v[68:71], v13, s[8:11], s6 offen offset:1024 sc1
    buffer_store_dwordx4 v[72:75], v13, s[8:11], s6 offen offset:2048 sc1
    buffer_store_dwordx4 v[76:79], v13, s[8:11], s6 offen offset:3072 sc1
    s_add_u32 s6, s6, 4096
    buffer_store_dwordx4 v[80:83], v13, s[8:11], s6 offen offset:0 sc1
    buffer_store_dwordx4 v[84:87], v13, s[8:11], s6 offen offset:1024 sc1
    buffer_store_dwordx4 v[88:91], v13, s[8:11], s6 offen offset:2048 sc1
    buffer_store_dwordx4 v[92:95], v13, s[8:11], s6 offen offset:3072 sc1
    s_add_u32 s6, s6, 4096
    buffer_store_dwordx4 v[96:99], v13, s[8:11], s6 offen offset:0 sc1
    buffer_store_dwordx4 v[100:103], v13, s[8:11], s6 offen offset:1024 sc1
    buffer_store_dwordx4 v[104:107], v13, s[8:11], s6 offen offset:2048 sc1
    buffer_store_dwordx4 v[108:111], v13, s[8:11], s6 offen offset:3072 sc1
    s_add_u32 s6, s6, 4096
    buffer_store_dwordx4 v[112:115], v13, s[8:11], s6 offen offset:0 sc1
    buffer_store_dwordx4 v[116:119], v13, s[8:11], s6 offen offset:1024 sc1
    buffer_store_dwordx4 v[120:123], v13, s[8:11], s6 offen offset:2048 sc1
    buffer_store_dwordx4 v[124:127], v13, s[8:11], s6 offen offset:3072 sc1
    s_add_u32 s6, s6, 4096
    buffer_store_dwordx4 v[128:131], v13, s[8:11], s6 offen offset:0 sc1
    buffer_store_dwordx4 v[132:135], v13, s[8:11], s6 offen offset:1024 sc1
    buffer_store_dwordx4 v[136:139], v13, s[8:11], s6 offen offset:2048 sc1
    buffer_store_dwordx4 v[140:143], v13, s[8:11], s6 offen offset:3072 sc1
    s_call_b64 s[82:83], L_load
    s_add_i32 s62, s62, 1
    s_waitcnt vmcnt(16)
    v_or_b32 v24, 0x80000000, v24
    v_lshlrev_b32 v5, 2, v1
    v_mov_b32 v6, 0x5000000
    v_cmp_gt_u32 vcc, 8, v1
    s_mov_b32 s6, 0x3a0000
    s_nop 0
    v_cndmask_b32 v5, v6, v5, vcc
    buffer_store_dword v24, v5, s[8:11], s6 offen sc1
    s_branch L_idle
L_back_9_h:
    v_cmp_ne_u32 vcc, 0, v62
    s_cbranch_vccz L_back_9_n
    s_call_b64 s[80:81], L_rare0
L_back_9_n:
    s_branch L_back_9
L_back_10_h:
    v_cmp_ne_u32 vcc, 0, v62
    s_cbranch_vccz L_back_10_n
    s_call_b64 s[80:81], L_rare1
    v_exp_f32 v58, v64
    v_exp_f32 v59, v65
L_back_10_n:
    s_cmp_lt_i32 s64, 0
    s_cbranch_scc1 L_tail1
    s_cmp_gt_i32 s64, 0
    s_cbranch_scc1 L_back_10
    s_call_b64 s[82:83], L_mask
    s_branch L_back_10
L_back_11_h:
    v_cmp_ne_u32 vcc, 0, v62
    s_cbranch_vccz L_back_11_n
    s_call_b64 s[80:81], L_rare0
    v_exp_f32 v58, v80
    v_exp_f32 v59, v81
L_back_11_n:
    s_cmp_lt_i32 s64, 0
    s_cbranch_scc1 L_tail2
    s_cmp_gt_i32 s64, 0
    s_cbranch_scc1 L_back_11
    s_call_b64 s[82:83], L_mask
    s_branch L_back_11
L_back_12_h:
    v_cmp_ne_u32 vcc, 0, v62
    s_cbranch_vccz L_back_12_n
    s_call_b64 s[80:81], L_rare1
    v_exp_f32 v58, v64
    v_exp_f32 v59, v65
L_back_12_n:
    s_cmp_lt_i32 s64, 0
    s_cbranch_scc1 L_tail3
    s_cmp_gt_i32 s64, 0
    s_cbranch_scc1 L_back_12
    s_call_b64 s[82:83], L_mask
    s_branch L_back_12
L_ldback_13_c:
    s_waitcnt vmcnt(0) lgkmcnt(0)
    s_call_b64 s[82:83], L_pend
    s_barrier
    s_call_b64 s[82:83], L_load
    s_branch L_ldback_13
L_back_14_h:
    v_cmp_ne_u32 vcc, 0, v62
    s_cbranch_vccz L_back_14_n
    s_call_b64 s[80:81], L_rare0
    v_exp_f32 v58, v80
    v_exp_f32 v59, v81
L_back_14_n:
    s_cmp_lt_i32 s64, 0
    s_cbranch_scc1 L_tail0
    s_cmp_gt_i32 s64, 0
    s_cbranch_scc1 L_st0
    s_call_b64 s[82:83], L_mask
    s_branch L_st0
L_back_15_h:
    v_cmp_ne_u32 vcc, 0, v62
    s_cbranch_vccz L_back_15_n
    s_call_b64 s[80:81], L_rare1
L_back_15_n:
    s_branch L_back_15
L_back_16_h:
    v_cmp_ne_u32 vcc, 0, v62
    s_cbranch_vccz L_back_16_n
    s_call_b64 s[80:81], L_rare0
L_back_16_n:
    s_branch L_back_16
L_back_18_h:
    v_cmp_ne_u32 vcc, 0, v62
    s_cbranch_vccz L_back_18_n
    s_call_b64 s[80:81], L_rare1
L_back_18_n:
    s_branch L_back_18
L_back_21_h:
    v_cmp_ne_u32 vcc, 0, v62
    s_cbranch_vccz L_back_21_n
    s_call_b64 s[80:81], L_rare0
L_back_21_n:
    s_branch L_back_21
L_load:
    s_bitcmp1_b32 s89, 0
    s_cbranch_scc0 L_load_r
    s_add_u32 s77, s77, 32768
    s_xor_b32 s78, s78, 0x10000
    s_add_i32 s73, s62, 1
    s_cmp_gt_i32 s73, s63
    s_cbranch_scc1 L_load_r
    s_cmp_eq_i32 s73, s63
    s_cbranch_scc1 L_load_v
    s_cmp_lg_i32 s73, 3
    s_cbranch_scc1 L_load_k
    v_cmp_gt_u32 vcc, 2, v12
    s_cbranch_vccz L_load_k
    s_lshl_b32 s7, s4, 10
    s_add_u32 s7, s7, 3866624
    v_lshrrev_b32 v2, 3, v1
    v_and_b32 v3, 7, v1
    v_lshlrev_b32 v3, 2, v3
    v_lshl_add_u32 v3, v2, 7, v3
    s_mov_b32 s79, 262144
L_poll_46:
    buffer_load_dword v2, v3, s[8:11], s7 offen sc1
    s_waitcnt vmcnt(0)
    v_cmp_gt_u32 vcc, 2, v2
    s_cbranch_vccz L_polldone_47
    s_sleep 2
    s_sub_u32 s79, s79, 1
    s_cmp_lg_u32 s79, 0
    s_cbranch_scc1 L_poll_46
L_polldone_47:
L_load_k:
    s_lshl_b32 s6, s76, 13
    s_add_u32 s6, s6, s78
    s_add_u32 m0, s6, 0
    s_add_u32 s7, s77, 0
    buffer_load_dwordx4 v49, s[8:11], s7 offen offset:0 sc1 lds
    buffer_load_dwordx4 v49, s[8:11], s7 offen offset:1024 sc1 lds
    buffer_load_dwordx4 v49, s[8:11], s7 offen offset:2048 sc1 lds
    buffer_load_dwordx4 v49, s[8:11], s7 offen offset:3072 sc1 lds
    s_lshl_b32 s6, s76, 13
    s_add_u32 s6, s6, s78
    s_add_u32 m0, s6, 4096
    s_add_u32 s7, s77, 4096
    buffer_load_dwordx4 v49, s[8:11], s7 offen offset:0 sc1 lds
    buffer_load_dwordx4 v49, s[8:11], s7 offen offset:1024 sc1 lds
    buffer_load_dwordx4 v49, s[8:11], s7 offen offset:2048 sc1 lds
    buffer_load_dwordx4 v49, s[8:11], s7 offen offset:3072 sc1 lds
    s_lshl_b32 s6, s76, 12
    s_add_u32 s6, s6, s78
    s_add_u32 m0, s6, 49152
    s_add_u32 s7, s77, 524288
    buffer_load_dwordx4 v50, s[8:11], s7 offen offset:0 sc1 lds
    buffer_load_dwordx4 v50, s[8:11], s7 offen offset:1024 sc1 lds
    buffer_load_dwordx4 v50, s[8:11], s7 offen offset:2048 sc1 lds
    buffer_load_dwordx4 v50, s[8:11], s7 offen offset:3072 sc1 lds
L_load_v:
    s_lshl_b32 s6, s76, 12
    s_add_u32 s6, s6, s78
    s_add_u32 m0, s6, 32768
    s_add_u32 s7, s77, 507904
    buffer_load_dwordx4 v50, s[8:11], s7 offen offset:0 sc1 lds
    buffer_load_dwordx4 v50, s[8:11], s7 offen offset:1024 sc1 lds
    buffer_load_dwordx4 v50, s[8:11], s7 offen offset:2048 sc1 lds
    buffer_load_dwordx4 v50, s[8:11], s7 offen offset:3072 sc1 lds
    s_cmp_eq_i32 s73, s63
    s_cbranch_scc1 L_xa
    s_cmp_lg_i32 s73, 2
    s_cbranch_scc1 L_nolook
    s_lshl_b32 s7, s4, 10
    s_add_u32 s7, s7, 3866624
    v_lshrrev_b32 v2, 3, v1
    v_and_b32 v3, 7, v1
    v_lshlrev_b32 v3, 2, v3
    v_lshl_add_u32 v3, v2, 7, v3
    buffer_load_dword v12, v3, s[8:11], s7 offen sc1
L_nolook:
    s_bitcmp1_b32 120, s5
    s_cbranch_scc0 L_wb
    s_sub_i32 s6, s62, 0
    s_cmp_gt_u32 s6, 4
    s_cbranch_scc0 L_wsel
L_wb:
    s_sub_u32 s6, s5, 4
    s_cmp_ge_u32 s6, 4
    s_cbranch_scc1 L_load_r
    s_sub_i32 s79, s73, 1
    s_cmp_lt_u32 s79, 2
    s_cbranch_scc1 L_x3
L_load_r:
    s_setpc_b64 s[82:83]
L_pend:
    s_bitcmp1_b32 s89, 1
    s_cbranch_scc0 L_load_a
    s_cmp_lt_i32 s62, 0
    s_cbranch_scc1 L_load_a
    s_lshl_b32 s6, s4, 3
    s_add_u32 s6, s6, s5
    s_lshl_b32 s6, s6, 5
    s_add_u32 s6, s6, s3
    s_lshl_b32 s6, s6, 2
    s_add_u32 s6, s6, 3866624
    v_mov_b32 v2, 2
    v_mov_b32 v3, 0x5000000
    v_writelane_b32 v3, s6, 0
    buffer_store_dword v2, v3, s[8:11], 0 offen sc1
    s_and_b32 s89, s89, 1
L_load_a:
    s_setpc_b64 s[82:83]
L_wsel:
    s_bfm_b32 s7, s5, 0
    s_and_b32 s7, s7, 120
    s_bcnt1_i32_b32 s7, s7
    s_lshl_b32 s7, s7, 5
    s_and_b32 s91, s2, 31
    s_add_u32 s91, s91, s7
    s_lshl_b32 s91, s91, 1
    s_lshr_b32 s7, s6, 1
    s_add_u32 s91, s91, s7
    s_cmp_eq_u32 s6, 4
    s_cbranch_scc1 L_w2
    s_bitcmp1_b32 s6, 0
    s_cbranch_scc1 L_w1
L_w0:
    s_mov_b32 s28, s42
    s_mov_b32 s29, s43
    s_mov_b32 s30, 0x500000
    s_mov_b32 s31, 0x20000
    s_lshr_b32 s75, s91, 1
    s_mul_i32 s75, s75, 40960
    s_and_b32 s6, s91, 1
    s_mul_i32 s6, s6, 640
    s_add_u32 s75, s75, s6
    s_movk_i32 s7, 1639
    s_mul_i32 s74, s76, 5120
    s_add_u32 s74, s74, 141312
    s_mul_i32 s6, s76, 320
    v_add_u32 v9, s6, v1
    v_add_u32 v2, 0, v9
    v_mul_lo_u32 v3, v2, s7
    v_lshrrev_b32 v3, 16, v3
    v_mul_u32_u24 v4, 40, v3
    v_sub_u32 v4, v2, v4
    v_mul_u32_u24 v3, 1280, v3
    v_lshl_add_u32 v3, v4, 4, v3
    s_add_u32 m0, s74, 0
    s_nop 0
    buffer_load_dwordx4 v3, s[28:31], s75 offen nt lds
    v_add_u32 v2, 64, v9
    v_mul_lo_u32 v3, v2, s7
    v_lshrrev_b32 v3, 16, v3
    v_mul_u32_u24 v4, 40, v3
    v_sub_u32 v4, v2, v4
    v_mul_u32_u24 v3, 1280, v3
    v_lshl_add_u32 v3, v4, 4, v3
    s_add_u32 m0, s74, 1024
    s_nop 0
    buffer_load_dwordx4 v3, s[28:31], s75 offen nt lds
    v_add_u32 v2, 128, v9
    v_mul_lo_u32 v3, v2, s7
    v_lshrrev_b32 v3, 16, v3
    v_mul_u32_u24 v4, 40, v3
    v_sub_u32 v4, v2, v4
    v_mul_u32_u24 v3, 1280, v3
    v_lshl_add_u32 v3, v4, 4, v3
    s_add_u32 m0, s74, 2048
    s_nop 0
    buffer_load_dwordx4 v3, s[28:31], s75 offen nt lds
    v_add_u32 v2, 192, v9
    v_mul_lo_u32 v3, v2, s7
    v_lshrrev_b32 v3, 16, v3
    v_mul_u32_u24 v4, 40, v3
    v_sub_u32 v4, v2, v4
    v_mul_u32_u24 v3, 1280, v3
    v_lshl_add_u32 v3, v4, 4, v3
    s_add_u32 m0, s74, 3072
    s_nop 0
    buffer_load_dwordx4 v3, s[28:31], s75 offen nt lds
    v_add_u32 v2, 256, v9
    v_mul_lo_u32 v3, v2, s7
    v_lshrrev_b32 v3, 16, v3
    v_mul_u32_u24 v4, 40, v3
    v_sub_u32 v4, v2, v4
    v_mul_u32_u24 v3, 1280, v3
    v_lshl_add_u32 v3, v4, 4, v3
    s_add_u32 m0, s74, 4096
    s_nop 0
    buffer_load_dwordx4 v3, s[28:31], s75 offen nt lds
    s_branch L_wb
L_w1:
    v_and_b32 v2, 15, v1
    v_lshrrev_b32 v3, 4, v1
    v_lshrrev_b32 v4, 2, v2
    v_lshl_add_u32 v4, v3, 2, v4
    v_mul_u32_u24 v4, 640, v4
    v_and_b32 v2, 3, v2
    v_lshl_add_u32 v4, v2, 3, v4
    s_mul_i32 s6, s76, 160
    s_add_u32 s6, s6, 141312
    v_add_u32 v4, s6, v4
    s_mul_i32 s6, s91, 20480
    s_mul_i32 s7, s76, 5120
    s_add_u32 s6, s6, s7
    s_add_u32 s6, s6, 4194304
    s_add_u32 s7, s6, 4096
    ds_read_b64_tr_b16 v[172:173], v4 offset:0
    ds_read_b64_tr_b16 v[174:175], v4 offset:10240
    ds_read_b64_tr_b16 v[176:177], v4 offset:32
    ds_read_b64_tr_b16 v[178:179], v4 offset:10272
    ds_read_b64_tr_b16 v[180:181], v4 offset:64
    ds_read_b64_tr_b16 v[182:183], v4 offset:10304
    ds_read_b64_tr_b16 v[184:185], v4 offset:96
    ds_read_b64_tr_b16 v[186:187], v4 offset:10336
    ds_read_b64_tr_b16 v[188:189], v4 offset:128
    ds_read_b64_tr_b16 v[190:191], v4 offset:10368
    s_waitcnt lgkmcnt(0)
    buffer_store_dwordx4 v[172:175], v13, s[8:11], s6 offen offset:0 sc1
    buffer_store_dwordx4 v[176:179], v13, s[8:11], s6 offen offset:1024 sc1
    buffer_store_dwordx4 v[180:183], v13, s[8:11], s6 offen offset:2048 sc1
    buffer_store_dwordx4 v[184:187], v13, s[8:11], s6 offen offset:3072 sc1
    buffer_store_dwordx4 v[188:191], v13, s[8:11], s7 offen offset:0 sc1
    s_branch L_wb
L_w2:
    s_cmp_lg_u32 s3, 0
    s_cbranch_scc1 L_wb
    s_mov_b32 s28, s56
    s_mov_b32 s29, s57
    s_mov_b32 s30, 0x100
    s_mov_b32 s31, 0x20000
    v_mov_b32 v2, 1
    v_lshlrev_b32 v3, 8, v1
    s_and_b32 s6, s2, 31
    s_lshl_b32 s6, s6, 2
    buffer_atomic_add v2, v3, s[28:31], s6 offen offset:128 sc1
    s_branch L_wb
L_xa:
    s_cmp_lg_u32 s90, 0
    s_cbranch_scc1 L_xa1
    s_mov_b32 s28, s56
    s_mov_b32 s29, s57
    s_mov_b32 s30, 0x100
    s_mov_b32 s31, 0x20000
    v_and_b32 v3, 31, v1
    v_lshlrev_b32 v3, 2, v3
    s_mov_b32 s79, 262144
L_poll_48:
    buffer_load_dword v2, v3, s[28:31], 0 offen offset:128 sc1
    s_waitcnt vmcnt(0)
    v_cmp_gt_u32 vcc, 4, v2
    s_cbranch_vccz L_polldone_49
    s_sleep 8
    s_sub_u32 s79, s79, 1
    s_cmp_lg_u32 s79, 0
    s_cbranch_scc1 L_poll_48
L_polldone_49:
L_xa1:
    s_lshr_b32 s74, s4, 3
    s_lshl_b32 s74, s74, 2
    s_add_u32 s74, s74, s76
    s_mul_i32 s74, s74, 327680
    s_and_b32 s7, s4, 3
    s_mul_i32 s7, s7, 10240
    s_add_u32 s74, s74, s7
    s_add_u32 s74, s74, 4199424
    s_add_u32 s6, s76, 0
    s_and_b32 s6, s6, 3
    s_lshl_b32 s6, s6, 10
    s_add_u32 s84, s6, s74
    s_add_u32 s6, s76, 1
    s_and_b32 s6, s6, 3
    s_lshl_b32 s6, s6, 10
    s_add_u32 s85, s6, s74
    s_add_u32 s6, s76, 2
    s_and_b32 s6, s6, 3
    s_lshl_b32 s6, s6, 10
    s_add_u32 s86, s6, s74
    s_add_u32 s6, s76, 3
    s_and_b32 s6, s6, 3
    s_lshl_b32 s6, s6, 10
    s_add_u32 s87, s6, s74
    s_add_u32 s88, s74, 4096
    s_lshl_b32 s73, s3, 13
    s_add_u32 s75, s73, s78
    s_add_u32 m0, s73, 131072
    s_add_u32 s7, s84, 0
    buffer_load_dwordx4 v13, s[8:11], s7 offen sc1 lds
    s_add_u32 m0, s73, 132096
    s_add_u32 s7, s85, 0
    buffer_load_dwordx4 v13, s[8:11], s7 offen sc1 lds
    s_add_u32 m0, s73, 133120
    s_add_u32 s7, s86, 0
    buffer_load_dwordx4 v13, s[8:11], s7 offen sc1 lds
    s_add_u32 m0, s73, 134144
    s_add_u32 s7, s87, 0
    buffer_load_dwordx4 v13, s[8:11], s7 offen sc1 lds
    s_add_u32 m0, s73, 135168
    s_add_u32 s7, s88, 0
    buffer_load_dwordx4 v13, s[8:11], s7 offen sc1 lds
    s_add_u32 m0, s73, 136192
    s_add_u32 s7, s84, 40960
    buffer_load_dwordx4 v13, s[8:11], s7 offen sc1 lds
    s_add_u32 m0, s73, 137216
    s_add_u32 s7, s85, 40960
    buffer_load_dwordx4 v13, s[8:11], s7 offen sc1 lds
    s_add_u32 m0, s73, 138240
    s_add_u32 s7, s86, 40960
    buffer_load_dwordx4 v13, s[8:11], s7 offen sc1 lds
    s_add_u32 m0, s75, 0
    s_add_u32 s7, s87, 40960
    buffer_load_dwordx4 v13, s[8:11], s7 offen sc1 lds
    s_add_u32 m0, s75, 1024
    s_add_u32 s7, s88, 40960
    buffer_load_dwordx4 v13, s[8:11], s7 offen sc1 lds
    s_add_u32 m0, s75, 2048
    s_add_u32 s7, s84, 81920
    buffer_load_dwordx4 v13, s[8:11], s7 offen sc1 lds
    s_add_u32 m0, s75, 3072
    s_add_u32 s7, s85, 81920
    buffer_load_dwordx4 v13, s[8:11], s7 offen sc1 lds
    s_add_u32 m0, s75, 4096
    s_add_u32 s7, s86, 81920
    buffer_load_dwordx4 v13, s[8:11], s7 offen sc1 lds
    s_add_u32 m0, s75, 5120
    s_add_u32 s7, s87, 81920
    buffer_load_dwordx4 v13, s[8:11], s7 offen sc1 lds
    s_add_u32 m0, s75, 6144
    s_add_u32 s7, s88, 81920
    buffer_load_dwordx4 v13, s[8:11], s7 offen sc1 lds
    s_add_u32 m0, s75, 7168
    s_add_u32 s7, s84, 122880
    buffer_load_dwordx4 v13, s[8:11], s7 offen sc1 lds
    s_lshl_b32 s75, s3, 12
    s_add_u32 s75, s75, s78
    s_add_u32 m0, s75, 49152
    s_add_u32 s7, s85, 122880
    buffer_load_dwordx4 v13, s[8:11], s7 offen sc1 lds
    s_add_u32 m0, s75, 50176
    s_add_u32 s7, s86, 122880
    buffer_load_dwordx4 v13, s[8:11], s7 offen sc1 lds
    s_add_u32 m0, s75, 51200
    s_add_u32 s7, s87, 122880
    buffer_load_dwordx4 v13, s[8:11], s7 offen sc1 lds
    s_add_u32 m0, s75, 52224
    s_add_u32 s7, s88, 122880
    buffer_load_dwordx4 v13, s[8:11], s7 offen sc1 lds
    s_setpc_b64 s[82:83]
L_x3:
    s_mov_b32 s12, s48
    s_mov_b32 s13, s49
    s_mov_b32 s14, 0x21c000
    s_mov_b32 s15, 0x20000
    s_cmp_eq_u32 s3, 3
    s_cbranch_scc1 L_load_r
    s_cmp_eq_u32 s3, 1
    s_cselect_b32 s12, s50, s12
    s_cselect_b32 s13, s51, s13
    s_cmp_eq_u32 s3, 2
    s_cselect_b32 s12, s52, s12
    s_cselect_b32 s13, s53, s13
    s_mov_b32 s73, 3456
    s_cmov_b32 s73, 256
    s_mov_b32 s75, 256
    s_cmov_b32 s75, 163840
    s_lshr_b32 s6, s2, 3
    s_sub_u32 s6, s6, 16
    s_mul_i32 s6, s6, 40
    v_lshrrev_b32 v2, 2, v1
    v_add_u32 v2, s6, v2
    v_mul_lo_u32 v2, v2, s73
    v_and_b32 v3, 3, v1
    v_lshl_add_u32 v2, v3, 6, v2
    s_xor_b32 s79, s79, 1
    s_lshl_b32 s6, s79, 3
    s_lshr_b32 s7, s4, 2
    s_add_u32 s6, s6, s7
    s_mul_i32 s6, s6, s75
    v_mov_b32 v3, 0x5000000
    v_cmp_gt_u32 vcc, 32, v1
    s_lshl_b32 s73, s73, 4
    s_nop 0
    v_cndmask_b32 v3, v3, v2, vcc
    buffer_load_dword v11, v2, s[12:15], s6 offen
    s_add_u32 s7, s6, s73
    buffer_load_dword v11, v2, s[12:15], s7 offen
    s_add_u32 s7, s7, s73
    buffer_load_dword v11, v3, s[12:15], s7 offen
    s_setpc_b64 s[82:83]
L_mask:
    v_and_b32 v2, 15, v1
    v_lshrrev_b32 v3, 4, v1
    v_lshlrev_b32 v3, 2, v3
    v_sub_u32 v2, v2, v3
    v_mov_b32 v3, 0xff800000
    v_cmp_gt_i32 vcc, 0, v2
    v_mov_b32 v152, v3
    s_nop 0
    v_cndmask_b32 v144, v144, v3, vcc
    v_cndmask_b32 v156, v156, v3, vcc
    v_cmp_gt_i32 vcc, 1, v2
    v_mov_b32 v153, v3
    s_nop 0
    v_cndmask_b32 v145, v145, v3, vcc
    v_cndmask_b32 v157, v157, v3, vcc
    v_cmp_gt_i32 vcc, 2, v2
    v_mov_b32 v154, v3
    s_nop 0
    v_cndmask_b32 v146, v146, v3, vcc
    v_cndmask_b32 v158, v158, v3, vcc
    v_cmp_gt_i32 vcc, 3, v2
    v_mov_b32 v155, v3
    s_nop 0
    v_cndmask_b32 v147, v147, v3, vcc
    v_cndmask_b32 v159, v159, v3, vcc
    s_nop 1
    s_setpc_b64 s[82:83]
L_rare0:
    s_nop 15
    v_max_f32 v62, v64, v65
    v_max3_f32 v62, v62, v66, v67
    v_max3_f32 v62, v62, v72, v73
    v_max3_f32 v62, v62, v74, v75
    v_mov_b32 v58, v62
    s_nop 1
    v_permlane16_swap_b32 v62, v58
    s_nop 1
    v_max_f32 v62, v62, v58
    v_mov_b32 v58, v62
    s_nop 1
    v_permlane32_swap_b32 v62, v58
    s_nop 1
    v_max_f32 v62, v62, v58
    v_add_f32 v62, 0x41c00000, v62
    v_max_f32 v62, 0, v62
    v_exp_f32 v58, -v62
    v_sub_f32 v64, v64, v62
    v_sub_f32 v80, v80, v62
    v_sub_f32 v144, v144, v62
    v_sub_f32 v65, v65, v62
    v_sub_f32 v81, v81, v62
    v_sub_f32 v145, v145, v62
    v_sub_f32 v66, v66, v62
    v_sub_f32 v82, v82, v62
    v_sub_f32 v146, v146, v62
    v_sub_f32 v67, v67, v62
    v_sub_f32 v83, v83, v62
    v_sub_f32 v147, v147, v62
    v_sub_f32 v72, v72, v62
    v_sub_f32 v88, v88, v62
    v_sub_f32 v152, v152, v62
    v_sub_f32 v73, v73, v62
    v_sub_f32 v89, v89, v62
    v_sub_f32 v153, v153, v62
    v_sub_f32 v74, v74, v62
    v_sub_f32 v90, v90, v62
    v_sub_f32 v154, v154, v62
    v_sub_f32 v75, v75, v62
    v_sub_f32 v91, v91, v62
    v_sub_f32 v155, v155, v62
    v_mul_f32 v160, v58, v160
    v_mul_f32 v161, v58, v161
    v_mul_f32 v192, v58, v192
    v_mul_f32 v193, v58, v193
    v_mul_f32 v194, v58, v194
    v_mul_f32 v195, v58, v195
    v_mul_f32 v200, v58, v200
    v_mul_f32 v201, v58, v201
    v_mul_f32 v202, v58, v202
    v_mul_f32 v203, v58, v203
    v_mul_f32 v208, v58, v208
    v_mul_f32 v209, v58, v209
    v_mul_f32 v210, v58, v210
    v_mul_f32 v211, v58, v211
    v_mul_f32 v216, v58, v216
    v_mul_f32 v217, v58, v217
    v_mul_f32 v218, v58, v218
    v_mul_f32 v219, v58, v219
    v_mul_f32 v224, v58, v224
    v_mul_f32 v225, v58, v225
    v_mul_f32 v226, v58, v226
    v_mul_f32 v227, v58, v227
    v_mul_f32 v232, v58, v232
    v_mul_f32 v233, v58, v233
    v_mul_f32 v234, v58, v234
    v_mul_f32 v235, v58, v235
    v_mul_f32 v240, v58, v240
    v_mul_f32 v241, v58, v241
    v_mul_f32 v242, v58, v242
    v_mul_f32 v243, v58, v243
    v_mul_f32 v248, v58, v248
    v_mul_f32 v249, v58, v249
    v_mul_f32 v250, v58, v250
    v_mul_f32 v251, v58, v251
    v_max_f32 v62, v68, v69
    v_max3_f32 v62, v62, v70, v71
    v_max3_f32 v62, v62, v76, v77
    v_max3_f32 v62, v62, v78, v79
    v_mov_b32 v58, v62
    s_nop 1
    v_permlane16_swap_b32 v62, v58
    s_nop 1
    v_max_f32 v62, v62, v58
    v_mov_b32 v58, v62
    s_nop 1
    v_permlane32_swap_b32 v62, v58
    s_nop 1
    v_max_f32 v62, v62, v58
    v_add_f32 v62, 0x41c00000, v62
    v_max_f32 v62, 0, v62
    v_exp_f32 v58, -v62
    v_sub_f32 v68, v68, v62
    v_sub_f32 v84, v84, v62
    v_sub_f32 v148, v148, v62
    v_sub_f32 v69, v69, v62
    v_sub_f32 v85, v85, v62
    v_sub_f32 v149, v149, v62
    v_sub_f32 v70, v70, v62
    v_sub_f32 v86, v86, v62
    v_sub_f32 v150, v150, v62
    v_sub_f32 v71, v71, v62
    v_sub_f32 v87, v87, v62
    v_sub_f32 v151, v151, v62
    v_sub_f32 v76, v76, v62
    v_sub_f32 v92, v92, v62
    v_sub_f32 v156, v156, v62
    v_sub_f32 v77, v77, v62
    v_sub_f32 v93, v93, v62
    v_sub_f32 v157, v157, v62
    v_sub_f32 v78, v78, v62
    v_sub_f32 v94, v94, v62
    v_sub_f32 v158, v158, v62
    v_sub_f32 v79, v79, v62
    v_sub_f32 v95, v95, v62
    v_sub_f32 v159, v159, v62
    v_mul_f32 v162, v58, v162
    v_mul_f32 v163, v58, v163
    v_mul_f32 v196, v58, v196
    v_mul_f32 v197, v58, v197
    v_mul_f32 v198, v58, v198
    v_mul_f32 v199, v58, v199
    v_mul_f32 v204, v58, v204
    v_mul_f32 v205, v58, v205
    v_mul_f32 v206, v58, v206
    v_mul_f32 v207, v58, v207
    v_mul_f32 v212, v58, v212
    v_mul_f32 v213, v58, v213
    v_mul_f32 v214, v58, v214
    v_mul_f32 v215, v58, v215
    v_mul_f32 v220, v58, v220
    v_mul_f32 v221, v58, v221
    v_mul_f32 v222, v58, v222
    v_mul_f32 v223, v58, v223
    v_mul_f32 v228, v58, v228
    v_mul_f32 v229, v58, v229
    v_mul_f32 v230, v58, v230
    v_mul_f32 v231, v58, v231
    v_mul_f32 v236, v58, v236
    v_mul_f32 v237, v58, v237
    v_mul_f32 v238, v58, v238
    v_mul_f32 v239, v58, v239
    v_mul_f32 v244, v58, v244
    v_mul_f32 v245, v58, v245
    v_mul_f32 v246, v58, v246
    v_mul_f32 v247, v58, v247
    v_mul_f32 v252, v58, v252
    v_mul_f32 v253, v58, v253
    v_mul_f32 v254, v58, v254
    v_mul_f32 v255, v58, v255
    v_exp_f32 v58, v64
    s_nop 0
    v_exp_f32 v59, v65
    s_nop 0
    v_cvt_pk_bf16_f32 v128, v58, v59
    v_exp_f32 v60, v66
    s_nop 0
    v_exp_f32 v61, v67
    s_nop 0
    v_cvt_pk_bf16_f32 v129, v60, v61
    v_exp_f32 v58, v68
    s_nop 0
    v_exp_f32 v59, v69
    s_nop 0
    v_cvt_pk_bf16_f32 v132, v58, v59
    v_exp_f32 v60, v70
    s_nop 0
    v_exp_f32 v61, v71
    s_nop 0
    v_cvt_pk_bf16_f32 v133, v60, v61
    v_exp_f32 v58, v72
    s_nop 0
    v_exp_f32 v59, v73
    s_nop 0
    v_cvt_pk_bf16_f32 v130, v58, v59
    v_exp_f32 v60, v74
    s_nop 0
    v_exp_f32 v61, v75
    s_nop 0
    v_cvt_pk_bf16_f32 v131, v60, v61
    v_exp_f32 v58, v76
    s_nop 0
    v_exp_f32 v59, v77
    s_nop 0
    v_cvt_pk_bf16_f32 v134, v58, v59
    v_exp_f32 v60, v78
    s_nop 0
    v_exp_f32 v61, v79
    s_nop 0
    v_cvt_pk_bf16_f32 v135, v60, v61
    s_nop 1
    s_setpc_b64 s[80:81]
L_rare1:
    s_nop 15
    v_max_f32 v62, v80, v81
    v_max3_f32 v62, v62, v82, v83
    v_max3_f32 v62, v62, v88, v89
    v_max3_f32 v62, v62, v90, v91
    v_mov_b32 v58, v62
    s_nop 1
    v_permlane16_swap_b32 v62, v58
    s_nop 1
    v_max_f32 v62, v62, v58
    v_mov_b32 v58, v62
    s_nop 1
    v_permlane32_swap_b32 v62, v58
    s_nop 1
    v_max_f32 v62, v62, v58
    v_add_f32 v62, 0x41c00000, v62
    v_max_f32 v62, 0, v62
    v_exp_f32 v58, -v62
    v_sub_f32 v64, v64, v62
    v_sub_f32 v80, v80, v62
    v_sub_f32 v144, v144, v62
    v_sub_f32 v65, v65, v62
    v_sub_f32 v81, v81, v62
    v_sub_f32 v145, v145, v62
    v_sub_f32 v66, v66, v62
    v_sub_f32 v82, v82, v62
    v_sub_f32 v146, v146, v62
    v_sub_f32 v67, v67, v62
    v_sub_f32 v83, v83, v62
    v_sub_f32 v147, v147, v62
    v_sub_f32 v72, v72, v62
    v_sub_f32 v88, v88, v62
    v_sub_f32 v152, v152, v62
    v_sub_f32 v73, v73, v62
    v_sub_f32 v89, v89, v62
    v_sub_f32 v153, v153, v62
    v_sub_f32 v74, v74, v62
    v_sub_f32 v90, v90, v62
    v_sub_f32 v154, v154, v62
    v_sub_f32 v75, v75, v62
    v_sub_f32 v91, v91, v62
    v_sub_f32 v155, v155, v62
    v_mul_f32 v160, v58, v160
    v_mul_f32 v161, v58, v161
    v_mul_f32 v192, v58, v192
    v_mul_f32 v193, v58, v193
    v_mul_f32 v194, v58, v194
    v_mul_f32 v195, v58, v195
    v_mul_f32 v200, v58, v200
    v_mul_f32 v201, v58, v201
    v_mul_f32 v202, v58, v202
    v_mul_f32 v203, v58, v203
    v_mul_f32 v208, v58, v208
    v_mul_f32 v209, v58, v209
    v_mul_f32 v210, v58, v210
    v_mul_f32 v211, v58, v211
    v_mul_f32 v216, v58, v216
    v_mul_f32 v217, v58, v217
    v_mul_f32 v218, v58, v218
    v_mul_f32 v219, v58, v219
    v_mul_f32 v224, v58, v224
    v_mul_f32 v225, v58, v225
    v_mul_f32 v226, v58, v226
    v_mul_f32 v227, v58, v227
    v_mul_f32 v232, v58, v232
    v_mul_f32 v233, v58, v233
    v_mul_f32 v234, v58, v234
    v_mul_f32 v235, v58, v235
    v_mul_f32 v240, v58, v240
    v_mul_f32 v241, v58, v241
    v_mul_f32 v242, v58, v242
    v_mul_f32 v243, v58, v243
    v_mul_f32 v248, v58, v248
    v_mul_f32 v249, v58, v249
    v_mul_f32 v250, v58, v250
    v_mul_f32 v251, v58, v251
    v_max_f32 v62, v84, v85
    v_max3_f32 v62, v62, v86, v87
    v_max3_f32 v62, v62, v92, v93
    v_max3_f32 v62, v62, v94, v95
    v_mov_b32 v58, v62
    s_nop 1
    v_permlane16_swap_b32 v62, v58
    s_nop 1
    v_max_f32 v62, v62, v58
    v_mov_b32 v58, v62
    s_nop 1
    v_permlane32_swap_b32 v62, v58
    s_nop 1
    v_max_f32 v62, v62, v58
    v_add_f32 v62, 0x41c00000, v62
    v_max_f32 v62, 0, v62
    v_exp_f32 v58, -v62
    v_sub_f32 v68, v68, v62
    v_sub_f32 v84, v84, v62
    v_sub_f32 v148, v148, v62
    v_sub_f32 v69, v69, v62
    v_sub_f32 v85, v85, v62
    v_sub_f32 v149, v149, v62
    v_sub_f32 v70, v70, v62
    v_sub_f32 v86, v86, v62
    v_sub_f32 v150, v150, v62
    v_sub_f32 v71, v71, v62
    v_sub_f32 v87, v87, v62
    v_sub_f32 v151, v151, v62
    v_sub_f32 v76, v76, v62
    v_sub_f32 v92, v92, v62
    v_sub_f32 v156, v156, v62
    v_sub_f32 v77, v77, v62
    v_sub_f32 v93, v93, v62
    v_sub_f32 v157, v157, v62
    v_sub_f32 v78, v78, v62
    v_sub_f32 v94, v94, v62
    v_sub_f32 v158, v158, v62
    v_sub_f32 v79, v79, v62
    v_sub_f32 v95, v95, v62
    v_sub_f32 v159, v159, v62
    v_mul_f32 v162, v58, v162
    v_mul_f32 v163, v58, v163
    v_mul_f32 v196, v58, v196
    v_mul_f32 v197, v58, v197
    v_mul_f32 v198, v58, v198
    v_mul_f32 v199, v58, v199
    v_mul_f32 v204, v58, v204
    v_mul_f32 v205, v58, v205
    v_mul_f32 v206, v58, v206
    v_mul_f32 v207, v58, v207
    v_mul_f32 v212, v58, v212
    v_mul_f32 v213, v58, v213
    v_mul_f32 v214, v58, v214
    v_mul_f32 v215, v58, v215
    v_mul_f32 v220, v58, v220
    v_mul_f32 v221, v58, v221
    v_mul_f32 v222, v58, v222
    v_mul_f32 v223, v58, v223
    v_mul_f32 v228, v58, v228
    v_mul_f32 v229, v58, v229
    v_mul_f32 v230, v58, v230
    v_mul_f32 v231, v58, v231
    v_mul_f32 v236, v58, v236
    v_mul_f32 v237, v58, v237
    v_mul_f32 v238, v58, v238
    v_mul_f32 v239, v58, v239
    v_mul_f32 v244, v58, v244
    v_mul_f32 v245, v58, v245
    v_mul_f32 v246, v58, v246
    v_mul_f32 v247, v58, v247
    v_mul_f32 v252, v58, v252
    v_mul_f32 v253, v58, v253
    v_mul_f32 v254, v58, v254
    v_mul_f32 v255, v58, v255
    v_exp_f32 v58, v80
    s_nop 0
    v_exp_f32 v59, v81
    s_nop 0
    v_cvt_pk_bf16_f32 v136, v58, v59
    v_exp_f32 v60, v82
    s_nop 0
    v_exp_f32 v61, v83
    s_nop 0
    v_cvt_pk_bf16_f32 v137, v60, v61
    v_exp_f32 v58, v84
    s_nop 0
    v_exp_f32 v59, v85
    s_nop 0
    v_cvt_pk_bf16_f32 v140, v58, v59
    v_exp_f32 v60, v86
    s_nop 0
    v_exp_f32 v61, v87
    s_nop 0
    v_cvt_pk_bf16_f32 v141, v60, v61
    v_exp_f32 v58, v88
    s_nop 0
    v_exp_f32 v59, v89
    s_nop 0
    v_cvt_pk_bf16_f32 v138, v58, v59
    v_exp_f32 v60, v90
    s_nop 0
    v_exp_f32 v61, v91
    s_nop 0
    v_cvt_pk_bf16_f32 v139, v60, v61
    v_exp_f32 v58, v92
    s_nop 0
    v_exp_f32 v59, v93
    s_nop 0
    v_cvt_pk_bf16_f32 v142, v58, v59
    v_exp_f32 v60, v94
    s_nop 0
    v_exp_f32 v61, v95
    s_nop 0
    v_cvt_pk_bf16_f32 v143, v60, v61
    s_nop 1
    s_setpc_b64 s[80:81]
L_adone:
    ds_read_b128 v[16:19], v4 offset:0
    ds_read_b128 v[20:23], v4 offset:1024
    ds_read_b128 v[24:27], v4 offset:2048
    ds_read_b128 v[28:31], v4 offset:3072
    s_waitcnt lgkmcnt(3)
    v_mfma_f32_16x16x32_bf16 v[56:59], v[96:99], v[16:19], 0
    s_cmp_lt_u32 s3, 4
    s_cbranch_scc1 L_nowl_50
    s_waitcnt vmcnt(5)
    s_lshl_b32 s6, s60, 5
    s_add_u32 s6, s6, s4
    s_lshl_b32 s6, s6, 7
    s_add_u32 s6, s6, 3932160
    v_mov_b32 v2, 1
    v_mov_b32 v3, 0x5000000
    v_writelane_b32 v3, s6, 0
    buffer_store_dword v2, v3, s[8:11], 0 offen sc1
    s_add_u32 s75, s69, 204800
    buffer_load_dwordx4 v[196:199], v44, s[8:11], s75 offen sc1
    buffer_load_dwordx4 v[200:203], v45, s[8:11], s75 offen sc1
    buffer_load_dwordx4 v[204:207], v46, s[8:11], s75 offen sc1
    buffer_load_dwordx4 v[208:211], v47, s[8:11], s75 offen sc1
    buffer_load_dwordx4 v[212:215], v52, s[8:11], s75 offen sc1
L_nowl_50:
    v_mfma_f32_16x16x32_bf16 v[60:63], v[100:103], v[16:19], 0
    s_cmp_lt_u32 s3, 4
    s_cbranch_scc1 L_nowl_51
    s_add_u32 s75, s69, 245760
    buffer_load_dwordx4 v[216:219], v44, s[8:11], s75 offen sc1
    buffer_load_dwordx4 v[220:223], v45, s[8:11], s75 offen sc1
    buffer_load_dwordx4 v[224:227], v46, s[8:11], s75 offen sc1
    buffer_load_dwordx4 v[228:231], v47, s[8:11], s75 offen sc1
    buffer_load_dwordx4 v[232:235], v52, s[8:11], s75 offen sc1
L_nowl_51:
    v_mfma_f32_16x16x32_bf16 v[64:67], v[104:107], v[16:19], 0
    s_cmp_lt_u32 s3, 4
    s_cbranch_scc1 L_nowl_52
    s_add_u32 s75, s69, 286720
    buffer_load_dwordx4 v[236:239], v44, s[8:11], s75 offen sc1
    buffer_load_dwordx4 v[240:243], v45, s[8:11], s75 offen sc1
    buffer_load_dwordx4 v[244:247], v46, s[8:11], s75 offen sc1
    buffer_load_dwordx4 v[248:251], v47, s[8:11], s75 offen sc1
    buffer_load_dwordx4 v[252:255], v52, s[8:11], s75 offen sc1
L_nowl_52:
    v_mfma_f32_16x16x32_bf16 v[68:71], v[108:111], v[16:19], 0
    s_waitcnt lgkmcnt(2)
    s_cmp_ge_u32 s3, 4
    s_cbranch_scc1 L_o0
    s_waitcnt vmcnt(0)
    s_barrier
L_o0:
    v_mfma_f32_16x16x32_bf16 v[72:75], v[112:115], v[16:19], 0
    ds_read_b128 v[16:19], v4 offset:4096
    s_lshr_b32 s6, s3, 2
    s_mul_i32 s67, s6, 15360
    s_add_u32 s67, s67, 98304
    v_add_u32 v6, s67, v44
    v_mfma_f32_16x16x32_bf16 v[56:59], v[116:119], v[20:23], v[56:59]
    s_mul_i32 s73, s6, 5120
    s_add_u32 s73, s73, 67108864
    s_lshl_b32 s6, s6, 1
    s_sub_u32 s71, s76, s6
    v_mfma_f32_16x16x32_bf16 v[60:63], v[120:123], v[20:23], v[60:63]
    s_and_b32 s71, s71, 3
    v_mov_b32 v11, 0x5000000
    s_lshl_b32 s74, s3, 2
    s_add_u32 s74, s74, 15728640
    v_mfma_f32_16x16x32_bf16 v[64:67], v[124:127], v[20:23], v[64:67]
    s_and_b32 s72, s4, 7
    s_lshl_b32 s7, s5, 3
    s_add_u32 s72, s72, s7
    s_mul_i32 s72, s72, 12
    v_mfma_f32_16x16x32_bf16 v[68:71], v[128:131], v[20:23], v[68:71]
    s_waitcnt lgkmcnt(2)
    s_lshr_b32 s75, s4, 3
    s_mul_i32 s7, s75, 3
    s_add_u32 s7, s7, s72
    s_mul_i32 s62, s7, 20480
    v_mfma_f32_16x16x32_bf16 v[72:75], v[132:135], v[20:23], v[72:75]
    ds_read_b128 v[20:23], v4 offset:5120
    s_add_u32 s62, s62, 67108864
    s_lshl_b32 s7, s7, 7
    s_add_u32 s63, s7, 15728640
    s_add_u32 s6, s75, 1
    v_mfma_f32_16x16x32_bf16 v[72:75], v[152:155], v[24:27], v[72:75]
    s_and_b32 s6, s6, 3
    s_mul_i32 s6, s6, 3
    s_add_u32 s6, s6, s72
    s_add_u32 s6, s6, 0
    v_mfma_f32_16x16x32_bf16 v[68:71], v[148:151], v[24:27], v[68:71]
    s_mul_i32 s7, s6, 20480
    s_add_u32 s96, s7, s73
    s_lshl_b32 s6, s6, 7
    s_add_u32 s6, s6, s74
    v_mfma_f32_16x16x32_bf16 v[64:67], v[144:147], v[24:27], v[64:67]
    v_writelane_b32 v11, s6, 0
    s_add_u32 s6, s75, 2
    s_and_b32 s6, s6, 3
    s_mul_i32 s6, s6, 3
    v_mfma_f32_16x16x32_bf16 v[60:63], v[140:143], v[24:27], v[60:63]
    s_waitcnt lgkmcnt(2)
    s_add_u32 s6, s6, s72
    s_add_u32 s6, s6, 1
    s_mul_i32 s7, s6, 20480
    s_add_u32 s97, s7, s73
    v_mfma_f32_16x16x32_bf16 v[56:59], v[136:139], v[24:27], v[56:59]
    ds_read_b128 v[24:27], v4 offset:6144
    s_lshl_b32 s6, s6, 7
    s_add_u32 s6, s6, s74
    v_writelane_b32 v11, s6, 1
    s_add_u32 s6, s75, 3
    v_mfma_f32_16x16x32_bf16 v[56:59], v[156:159], v[28:31], v[56:59]
    s_and_b32 s6, s6, 3
    s_mul_i32 s6, s6, 3
    s_add_u32 s6, s6, s72
    s_add_u32 s6, s6, 2
    v_mfma_f32_16x16x32_bf16 v[60:63], v[160:163], v[28:31], v[60:63]
    s_mul_i32 s7, s6, 20480
    s_add_u32 s98, s7, s73
    s_lshl_b32 s6, s6, 7
    s_add_u32 s6, s6, s74
    v_mfma_f32_16x16x32_bf16 v[64:67], v[164:167], v[28:31], v[64:67]
    v_writelane_b32 v11, s6, 2
    v_mfma_f32_16x16x32_bf16 v[68:71], v[168:171], v[28:31], v[68:71]
    s_waitcnt lgkmcnt(2)
    v_mfma_f32_16x16x32_bf16 v[72:75], v[172:175], v[28:31], v[72:75]
    ds_read_b128 v[28:31], v4 offset:7168
    s_waitcnt vmcnt(16)
    v_mfma_f32_16x16x32_bf16 v[72:75], v[192:195], v[16:19], v[72:75]
    v_mfma_f32_16x16x32_bf16 v[68:71], v[188:191], v[16:19], v[68:71]
    s_add_u32 s65, s68, 3
    s_and_b32 s65, s65, 3
    s_andn2_b32 s7, s68, 3
    v_mfma_f32_16x16x32_bf16 v[64:67], v[184:187], v[16:19], v[64:67]
    s_add_u32 s65, s65, s7
    s_lshl_b32 s65, s65, 17
    s_add_u32 s65, s65, s66
    v_mfma_f32_16x16x32_bf16 v[60:63], v[180:183], v[16:19], v[60:63]
    s_waitcnt lgkmcnt(2)
    s_add_u32 m0, s99, 65536
    v_mfma_f32_16x16x32_bf16 v[56:59], v[176:179], v[16:19], v[56:59]
    ds_read_b128 v[16:19], v4 offset:32768
    s_waitcnt vmcnt(10)
    v_mfma_f32_16x16x32_bf16 v[56:59], v[196:199], v[20:23], v[56:59]
    buffer_load_dwordx4 v13, s[8:11], s65 offen offset:0 sc1 lds
    v_mfma_f32_16x16x32_bf16 v[60:63], v[200:203], v[20:23], v[60:63]
    buffer_load_dwordx4 v13, s[8:11], s65 offen offset:1024 sc1 lds
    v_mfma_f32_16x16x32_bf16 v[64:67], v[204:207], v[20:23], v[64:67]
    v_mfma_f32_16x16x32_bf16 v[68:71], v[208:211], v[20:23], v[68:71]
    buffer_load_dwordx4 v13, s[8:11], s65 offen offset:2048 sc1 lds
    s_waitcnt lgkmcnt(2)
    v_mfma_f32_16x16x32_bf16 v[72:75], v[212:215], v[20:23], v[72:75]
    ds_read_b128 v[20:23], v4 offset:33792
    s_waitcnt vmcnt(8)
    v_mfma_f32_16x16x32_bf16 v[72:75], v[232:235], v[24:27], v[72:75]
    buffer_load_dwordx4 v13, s[8:11], s65 offen offset:3072 sc1 lds
    v_mfma_f32_16x16x32_bf16 v[68:71], v[228:231], v[24:27], v[68:71]
    v_mfma_f32_16x16x32_bf16 v[64:67], v[224:227], v[24:27], v[64:67]
    v_mfma_f32_16x16x32_bf16 v[60:63], v[220:223], v[24:27], v[60:63]
    s_waitcnt lgkmcnt(2)
    v_mfma_f32_16x16x32_bf16 v[56:59], v[216:219], v[24:27], v[56:59]
    ds_read_b128 v[24:27], v4 offset:34816
    s_waitcnt vmcnt(4)
    v_mfma_f32_16x16x32_bf16 v[56:59], v[236:239], v[28:31], v[56:59]
    v_mfma_f32_16x16x32_bf16 v[60:63], v[240:243], v[28:31], v[60:63]
    v_mfma_f32_16x16x32_bf16 v[64:67], v[244:247], v[28:31], v[64:67]
    v_mfma_f32_16x16x32_bf16 v[68:71], v[248:251], v[28:31], v[68:71]
    s_waitcnt lgkmcnt(2)
    v_mfma_f32_16x16x32_bf16 v[72:75], v[252:255], v[28:31], v[72:75]
    ds_read_b128 v[28:31], v4 offset:35840
    v_mfma_f32_16x16x32_bf16 v[76:79], v[96:99], v[16:19], 0
    s_sub_u32 s6, s71, 1
    s_and_b32 s6, s6, 3
    s_mul_i32 s7, s6, 5120
    v_mfma_f32_16x16x32_bf16 v[80:83], v[100:103], v[16:19], 0
    s_add_u32 s7, s7, s67
    s_cmp_eq_u32 s6, 3
    s_cselect_b32 s7, 155648, s7
    v_mfma_f32_16x16x32_bf16 v[84:87], v[104:107], v[16:19], 0
    v_add_u32 v12, s7, v52
    v_add_u32 v5, s67, v45
    v_mfma_f32_16x16x32_bf16 v[88:91], v[108:111], v[16:19], 0
    s_waitcnt lgkmcnt(2)
    v_mfma_f32_16x16x32_bf16 v[92:95], v[112:115], v[16:19], 0
    ds_read_b128 v[16:19], v4 offset:36864
    v_mfma_f32_16x16x32_bf16 v[76:79], v[116:119], v[20:23], v[76:79]
    ds_write_b128 v5, v[60:63] offset:0
    v_add_u32 v5, s67, v46
    v_mfma_f32_16x16x32_bf16 v[80:83], v[120:123], v[20:23], v[80:83]
    v_and_b32 v3, 1, v1
    v_lshlrev_b32 v3, 12, v3
    s_lshr_b32 s72, s61, 2
    s_lshl_b32 s72, s72, 6
    s_andn2_b32 s6, s4, 7
    s_add_u32 s72, s72, s6
    s_add_u32 s72, s72, s3
    s_lshl_b32 s72, s72, 7
    s_add_u32 s72, s72, 3932160
    v_mfma_f32_16x16x32_bf16 v[84:87], v[124:127], v[20:23], v[84:87]
    v_mfma_f32_16x16x32_bf16 v[88:91], v[128:131], v[20:23], v[88:91]
    s_waitcnt lgkmcnt(3)
    v_mfma_f32_16x16x32_bf16 v[92:95], v[132:135], v[20:23], v[92:95]
    ds_read_b128 v[20:23], v4 offset:37888
    v_mfma_f32_16x16x32_bf16 v[92:95], v[152:155], v[24:27], v[92:95]
    ds_write_b128 v5, v[64:67] offset:5120
    v_add_u32 v5, s67, v47
    v_mfma_f32_16x16x32_bf16 v[88:91], v[148:151], v[24:27], v[88:91]
    v_mfma_f32_16x16x32_bf16 v[84:87], v[144:147], v[24:27], v[84:87]
    buffer_load_dword v50, v3, s[8:11], s72 offen sc1
    v_mfma_f32_16x16x32_bf16 v[80:83], v[140:143], v[24:27], v[80:83]
    s_waitcnt lgkmcnt(4)
    v_mfma_f32_16x16x32_bf16 v[76:79], v[136:139], v[24:27], v[76:79]
    ds_read_b128 v[24:27], v4 offset:38912
    v_mfma_f32_16x16x32_bf16 v[76:79], v[156:159], v[28:31], v[76:79]
    ds_write_b128 v5, v[68:71] offset:10240
    v_add_u32 v5, s67, v52
    v_mfma_f32_16x16x32_bf16 v[80:83], v[160:163], v[28:31], v[80:83]
    v_mfma_f32_16x16x32_bf16 v[84:87], v[164:167], v[28:31], v[84:87]
    v_mfma_f32_16x16x32_bf16 v[88:91], v[168:171], v[28:31], v[88:91]
    s_waitcnt lgkmcnt(5)
    v_mfma_f32_16x16x32_bf16 v[92:95], v[172:175], v[28:31], v[92:95]
    ds_read_b128 v[28:31], v4 offset:39936
    v_mfma_f32_16x16x32_bf16 v[92:95], v[192:195], v[16:19], v[92:95]
    ds_write_b128 v12, v[72:75] offset:0
    v_mfma_f32_16x16x32_bf16 v[88:91], v[188:191], v[16:19], v[88:91]
    v_mfma_f32_16x16x32_bf16 v[84:87], v[184:187], v[16:19], v[84:87]
    v_mfma_f32_16x16x32_bf16 v[80:83], v[180:183], v[16:19], v[80:83]
    s_waitcnt lgkmcnt(5)
    v_mfma_f32_16x16x32_bf16 v[76:79], v[176:179], v[16:19], v[76:79]
    s_waitcnt vmcnt(0)
    s_waitcnt lgkmcnt(0)
    s_barrier
    ds_read_b128 v[32:35], v6 offset:0
    ds_read_b128 v[36:39], v6 offset:5120
    ds_read_b128 v[40:43], v6 offset:10240
    ds_read_b128 v[16:19], v7 offset:0
    v_mfma_f32_16x16x32_bf16 v[76:79], v[196:199], v[20:23], v[76:79]
    v_cmp_ne_u32 vcc, 1, v50
    s_mov_b32 s91, 0
    s_cbranch_vccnz L_t3n
    s_add_u32 s65, s61, 1
    s_and_b32 s65, s65, 3
    s_andn2_b32 s7, s61, 3
    s_add_u32 s65, s65, s7
    s_lshl_b32 s65, s65, 17
    s_add_u32 s65, s65, s66
    s_add_u32 m0, s99, 0
    s_add_u32 s65, s65, 0
    buffer_load_dwordx4 v13, s[8:11], s65 offen offset:0 sc1 lds
    buffer_load_dwordx4 v13, s[8:11], s65 offen offset:1024 sc1 lds
    buffer_load_dwordx4 v13, s[8:11], s65 offen offset:2048 sc1 lds
    buffer_load_dwordx4 v13, s[8:11], s65 offen offset:3072 sc1 lds
    s_mov_b32 s91, 1
    s_branch L_t3j
L_t3n:
    buffer_load_dword v50, v3, s[8:11], s72 offen sc1
L_t3j:
    v_mfma_f32_16x16x32_bf16 v[80:83], v[200:203], v[20:23], v[80:83]
    v_mfma_f32_16x16x32_bf16 v[84:87], v[204:207], v[20:23], v[84:87]
    s_waitcnt lgkmcnt(3)
    v_add_f32 v56, v56, v32
    v_add_f32 v57, v57, v33
    v_mfma_f32_16x16x32_bf16 v[88:91], v[208:211], v[20:23], v[88:91]
    v_add_f32 v58, v58, v34
    v_add_f32 v59, v59, v35
    v_mfma_f32_16x16x32_bf16 v[92:95], v[212:215], v[20:23], v[92:95]
    s_waitcnt lgkmcnt(2)
    ds_read_b128 v[32:35], v5 offset:0
    ds_read_b128 v[20:23], v7 offset:1024
    v_add_f32 v56, v56, v36
    v_add_f32 v57, v57, v37
    v_mfma_f32_16x16x32_bf16 v[92:95], v[232:235], v[24:27], v[92:95]
    v_add_f32 v58, v58, v38
    v_add_f32 v59, v59, v39
    v_mfma_f32_16x16x32_bf16 v[88:91], v[228:231], v[24:27], v[88:91]
    s_waitcnt lgkmcnt(3)
    ds_read_b128 v[36:39], v5 offset:5120
    v_add_f32 v56, v56, v40
    v_add_f32 v57, v57, v41
    v_mfma_f32_16x16x32_bf16 v[84:87], v[224:227], v[24:27], v[84:87]
    v_add_f32 v58, v58, v42
    v_add_f32 v59, v59, v43
    v_mfma_f32_16x16x32_bf16 v[80:83], v[220:223], v[24:27], v[80:83]
    ds_read_b128 v[40:43], v5 offset:10240
    s_waitcnt lgkmcnt(3)
    v_add_f32 v72, v72, v32
    v_add_f32 v73, v73, v33
    s_add_u32 s6, s96, 0
    v_mfma_f32_16x16x32_bf16 v[76:79], v[216:219], v[24:27], v[76:79]
    ds_read_b128 v[24:27], v7 offset:2048
    v_add_f32 v74, v74, v34
    v_add_f32 v75, v75, v35
    v_mfma_f32_16x16x32_bf16 v[76:79], v[236:239], v[28:31], v[76:79]
    buffer_store_dwordx4 v[56:59], v44, s[8:11], s6 offen sc1
    s_waitcnt lgkmcnt(2)
    v_add_f32 v72, v72, v36
    v_add_f32 v73, v73, v37
    v_mfma_f32_16x16x32_bf16 v[80:83], v[240:243], v[28:31], v[80:83]
    v_add_f32 v74, v74, v38
    v_add_f32 v75, v75, v39
    v_mfma_f32_16x16x32_bf16 v[84:87], v[244:247], v[28:31], v[84:87]
    s_waitcnt lgkmcnt(1)
    v_add_f32 v72, v72, v40
    v_add_f32 v73, v73, v41
    v_mfma_f32_16x16x32_bf16 v[88:91], v[248:251], v[28:31], v[88:91]
    v_add_f32 v74, v74, v42
    v_add_f32 v75, v75, v43
    s_cmp_lg_u32 s71, 0
    v_mfma_f32_16x16x32_bf16 v[92:95], v[252:255], v[28:31], v[92:95]
    s_cbranch_scc1 L_nost_53
    buffer_store_dwordx4 v[72:75], v52, s[8:11], s6 offen sc1
L_nost_53:
    ds_read_b128 v[28:31], v7 offset:3072
    v_mfma_f32_16x16x32_bf16 v[56:59], v[96:99], v[16:19], 0
    s_sub_u32 s6, s71, 2
    s_and_b32 s6, s6, 3
    s_mul_i32 s7, s6, 5120
    v_mfma_f32_16x16x32_bf16 v[60:63], v[100:103], v[16:19], 0
    s_add_u32 s7, s7, s67
    s_cmp_eq_u32 s6, 3
    s_cselect_b32 s7, 124928, s7
    v_mfma_f32_16x16x32_bf16 v[64:67], v[104:107], v[16:19], 0
    v_add_u32 v12, s7, v52
    v_add_u32 v5, s67, v45
    s_cmp_lg_u32 s91, 0
    s_cbranch_scc1 L_o2
    s_waitcnt vmcnt(1)
    v_cmp_ne_u32 vcc, 1, v50
    s_cbranch_vccz L_o1
    s_mov_b32 s79, 262144
L_poll_55:
    buffer_load_dword v2, v3, s[8:11], s72 offen sc1
    s_waitcnt vmcnt(0)
    v_cmp_ne_u32 vcc, 1, v2
    s_cbranch_vccz L_polldone_56
    s_sleep 1
    s_sub_u32 s79, s79, 1
    s_cmp_lg_u32 s79, 0
    s_cbranch_scc1 L_poll_55
L_polldone_56:
L_o1:
    s_add_u32 s65, s61, 1
    s_and_b32 s65, s65, 3
    s_andn2_b32 s7, s61, 3
    s_add_u32 s65, s65, s7
    s_lshl_b32 s65, s65, 17
    s_add_u32 s65, s65, s66
    s_add_u32 m0, s99, 0
    s_add_u32 s65, s65, 0
    buffer_load_dwordx4 v13, s[8:11], s65 offen offset:0 sc1 lds
    buffer_load_dwordx4 v13, s[8:11], s65 offen offset:1024 sc1 lds
    buffer_load_dwordx4 v13, s[8:11], s65 offen offset:2048 sc1 lds
    buffer_load_dwordx4 v13, s[8:11], s65 offen offset:3072 sc1 lds
L_o2:
    v_mfma_f32_16x16x32_bf16 v[68:71], v[108:111], v[16:19], 0
    v_mfma_f32_16x16x32_bf16 v[72:75], v[112:115], v[16:19], 0
    ds_read_b128 v[16:19], v7 offset:4096
    v_mfma_f32_16x16x32_bf16 v[56:59], v[116:119], v[20:23], v[56:59]
    ds_write_b128 v5, v[80:83] offset:30720
    v_add_u32 v5, s67, v46
    v_mfma_f32_16x16x32_bf16 v[60:63], v[120:123], v[20:23], v[60:63]
    s_add_u32 s65, s61, 2
    s_and_b32 s65, s65, 3
    s_andn2_b32 s7, s61, 3
    v_mfma_f32_16x16x32_bf16 v[64:67], v[124:127], v[20:23], v[64:67]
    s_add_u32 s65, s65, s7
    s_lshl_b32 s65, s65, 17
    s_add_u32 s65, s65, s66
    v_mfma_f32_16x16x32_bf16 v[68:71], v[128:131], v[20:23], v[68:71]
    s_waitcnt lgkmcnt(3)
    s_add_u32 m0, s99, 32768
    v_mfma_f32_16x16x32_bf16 v[72:75], v[132:135], v[20:23], v[72:75]
    buffer_load_dwordx4 v13, s[8:11], s65 offen offset:0 sc1 lds
    ds_read_b128 v[20:23], v7 offset:5120
    v_mfma_f32_16x16x32_bf16 v[72:75], v[152:155], v[24:27], v[72:75]
    ds_write_b128 v5, v[84:87] offset:35840
    v_add_u32 v5, s67, v47
    v_mfma_f32_16x16x32_bf16 v[68:71], v[148:151], v[24:27], v[68:71]
    buffer_load_dwordx4 v13, s[8:11], s65 offen offset:1024 sc1 lds
    v_mfma_f32_16x16x32_bf16 v[64:67], v[144:147], v[24:27], v[64:67]
    buffer_load_dwordx4 v13, s[8:11], s65 offen offset:2048 sc1 lds
    v_mfma_f32_16x16x32_bf16 v[60:63], v[140:143], v[24:27], v[60:63]
    buffer_load_dwordx4 v13, s[8:11], s65 offen offset:3072 sc1 lds
    s_waitcnt lgkmcnt(4)
    v_mfma_f32_16x16x32_bf16 v[56:59], v[136:139], v[24:27], v[56:59]
    ds_read_b128 v[24:27], v7 offset:6144
    v_mfma_f32_16x16x32_bf16 v[56:59], v[156:159], v[28:31], v[56:59]
    ds_write_b128 v5, v[88:91] offset:40960
    v_add_u32 v5, s67, v52
    v_mfma_f32_16x16x32_bf16 v[60:63], v[160:163], v[28:31], v[60:63]
    v_mfma_f32_16x16x32_bf16 v[64:67], v[164:167], v[28:31], v[64:67]
    v_mfma_f32_16x16x32_bf16 v[68:71], v[168:171], v[28:31], v[68:71]
    s_waitcnt lgkmcnt(5)
    v_mfma_f32_16x16x32_bf16 v[72:75], v[172:175], v[28:31], v[72:75]
    ds_read_b128 v[28:31], v7 offset:7168
    v_mfma_f32_16x16x32_bf16 v[72:75], v[192:195], v[16:19], v[72:75]
    ds_write_b128 v12, v[92:95] offset:30720
    v_mfma_f32_16x16x32_bf16 v[68:71], v[188:191], v[16:19], v[68:71]
    s_add_u32 s65, s61, 3
    s_and_b32 s65, s65, 3
    s_andn2_b32 s7, s61, 3
    v_mfma_f32_16x16x32_bf16 v[64:67], v[184:187], v[16:19], v[64:67]
    s_add_u32 s65, s65, s7
    s_lshl_b32 s65, s65, 17
    s_add_u32 s65, s65, s66
    v_mfma_f32_16x16x32_bf16 v[60:63], v[180:183], v[16:19], v[60:63]
    s_waitcnt lgkmcnt(5)
    s_add_u32 m0, s99, 65536
    v_mfma_f32_16x16x32_bf16 v[56:59], v[176:179], v[16:19], v[56:59]
    s_waitcnt vmcnt(4)
    s_waitcnt lgkmcnt(0)
    s_barrier
    ds_read_b128 v[32:35], v6 offset:30720
    ds_read_b128 v[36:39], v6 offset:35840
    ds_read_b128 v[40:43], v6 offset:40960
    ds_read_b128 v[16:19], v4 offset:0
    v_mfma_f32_16x16x32_bf16 v[56:59], v[196:199], v[20:23], v[56:59]
    buffer_load_dwordx4 v13, s[8:11], s65 offen offset:0 sc1 lds
    v_mfma_f32_16x16x32_bf16 v[60:63], v[200:203], v[20:23], v[60:63]
    buffer_load_dwordx4 v13, s[8:11], s65 offen offset:1024 sc1 lds
    v_mfma_f32_16x16x32_bf16 v[64:67], v[204:207], v[20:23], v[64:67]
    s_waitcnt lgkmcnt(3)
    v_add_f32 v76, v76, v32
    v_add_f32 v77, v77, v33
    v_mfma_f32_16x16x32_bf16 v[68:71], v[208:211], v[20:23], v[68:71]
    buffer_load_dwordx4 v13, s[8:11], s65 offen offset:2048 sc1 lds
    v_add_f32 v78, v78, v34
    v_add_f32 v79, v79, v35
    v_mfma_f32_16x16x32_bf16 v[72:75], v[212:215], v[20:23], v[72:75]
    s_waitcnt lgkmcnt(2)
    ds_read_b128 v[32:35], v5 offset:30720
    ds_read_b128 v[20:23], v4 offset:1024
    v_add_f32 v76, v76, v36
    v_add_f32 v77, v77, v37
    v_mfma_f32_16x16x32_bf16 v[72:75], v[232:235], v[24:27], v[72:75]
    buffer_load_dwordx4 v13, s[8:11], s65 offen offset:3072 sc1 lds
    v_add_f32 v78, v78, v38
    v_add_f32 v79, v79, v39
    v_mfma_f32_16x16x32_bf16 v[68:71], v[228:231], v[24:27], v[68:71]
    s_waitcnt lgkmcnt(3)
    ds_read_b128 v[36:39], v5 offset:35840
    v_add_f32 v76, v76, v40
    v_add_f32 v77, v77, v41
    v_mfma_f32_16x16x32_bf16 v[64:67], v[224:227], v[24:27], v[64:67]
    v_add_f32 v78, v78, v42
    v_add_f32 v79, v79, v43
    v_mfma_f32_16x16x32_bf16 v[60:63], v[220:223], v[24:27], v[60:63]
    ds_read_b128 v[40:43], v5 offset:40960
    s_waitcnt lgkmcnt(3)
    v_add_f32 v92, v92, v32
    v_add_f32 v93, v93, v33
    s_add_u32 s6, s97, 0
    v_mfma_f32_16x16x32_bf16 v[56:59], v[216:219], v[24:27], v[56:59]
    ds_read_b128 v[24:27], v4 offset:2048
    v_add_f32 v94, v94, v34
    v_add_f32 v95, v95, v35
    v_mfma_f32_16x16x32_bf16 v[56:59], v[236:239], v[28:31], v[56:59]
    buffer_store_dwordx4 v[76:79], v44, s[8:11], s6 offen sc1
    s_waitcnt lgkmcnt(2)
    v_add_f32 v92, v92, v36
    v_add_f32 v93, v93, v37
    v_mfma_f32_16x16x32_bf16 v[60:63], v[240:243], v[28:31], v[60:63]
    v_add_f32 v94, v94, v38
    v_add_f32 v95, v95, v39
    v_mfma_f32_16x16x32_bf16 v[64:67], v[244:247], v[28:31], v[64:67]
    s_waitcnt lgkmcnt(1)
    v_add_f32 v92, v92, v40
    v_add_f32 v93, v93, v41
    v_mfma_f32_16x16x32_bf16 v[68:71], v[248:251], v[28:31], v[68:71]
    v_add_f32 v94, v94, v42
    v_add_f32 v95, v95, v43
    s_cmp_lg_u32 s71, 1
    v_mfma_f32_16x16x32_bf16 v[72:75], v[252:255], v[28:31], v[72:75]
    s_cbranch_scc1 L_nost_54
    buffer_store_dwordx4 v[92:95], v52, s[8:11], s6 offen sc1
L_nost_54:
    ds_read_b128 v[28:31], v4 offset:3072
    v_mfma_f32_16x16x32_bf16 v[76:79], v[96:99], v[16:19], 0
    s_sub_u32 s6, s71, 3
    s_and_b32 s6, s6, 3
    s_mul_i32 s7, s6, 5120
    v_mfma_f32_16x16x32_bf16 v[80:83], v[100:103], v[16:19], 0
    s_add_u32 s7, s7, s67
    s_cmp_eq_u32 s6, 3
    s_cselect_b32 s7, 155648, s7
    v_mfma_f32_16x16x32_bf16 v[84:87], v[104:107], v[16:19], 0
    v_add_u32 v12, s7, v52
    v_add_u32 v5, s67, v45
    v_mfma_f32_16x16x32_bf16 v[88:91], v[108:111], v[16:19], 0
    s_mov_b32 s12, s32
    s_mov_b32 s13, s33
    s_mov_b32 s14, 0x280000
    s_mov_b32 s15, 0x20000
    v_mfma_f32_16x16x32_bf16 v[92:95], v[112:115], v[16:19], 0
    ds_read_b128 v[16:19], v4 offset:4096
    s_and_b32 s75, s4, 3
    s_mul_i32 s70, s75, 320
    s_add_u32 s73, s70, 3837952
    s_mul_i32 s72, s75, 5120
    v_mfma_f32_16x16x32_bf16 v[76:79], v[116:119], v[20:23], v[76:79]
    ds_write_b128 v5, v[60:63] offset:0
    v_add_u32 v5, s67, v46
    v_mfma_f32_16x16x32_bf16 v[80:83], v[120:123], v[20:23], v[80:83]
    v_lshrrev_b32 v2, 4, v1
    v_and_b32 v3, 15, v1
    v_mul_u32_u24 v54, 1280, v3
    v_lshl_add_u32 v54, v2, 4, v54
    v_mfma_f32_16x16x32_bf16 v[84:87], v[124:127], v[20:23], v[84:87]
    v_lshlrev_b32 v3, 4, v3
    v_lshl_add_u32 v9, v2, 9, v3
    s_lshr_b32 s100, s3, 2
    s_cselect_b32 s6, s61, s68
    v_mfma_f32_16x16x32_bf16 v[88:91], v[128:131], v[20:23], v[88:91]
    s_waitcnt lgkmcnt(3)
    s_mul_i32 s6, s6, 20480
    s_lshl_b32 s7, s76, 6
    s_add_u32 s7, s7, s6
    v_add_u32 v53, s7, v54
    v_mfma_f32_16x16x32_bf16 v[92:95], v[132:135], v[20:23], v[92:95]
    ds_read_b128 v[20:23], v4 offset:5120
    s_lshl_b32 s7, s76, 10
    s_add_u32 s7, s7, s6
    s_add_u32 s7, s7, s72
    v_add_u32 v48, s7, v13
    v_mfma_f32_16x16x32_bf16 v[92:95], v[152:155], v[24:27], v[92:95]
    ds_write_b128 v5, v[64:67] offset:5120
    v_add_u32 v5, s67, v47
    v_mfma_f32_16x16x32_bf16 v[88:91], v[148:151], v[24:27], v[88:91]
    s_mul_i32 s6, s100, 10240
    s_lshl_b32 s7, s76, 11
    s_add_u32 s6, s6, s7
    v_add_u32 v8, s6, v9
    v_mfma_f32_16x16x32_bf16 v[84:87], v[144:147], v[24:27], v[84:87]
    s_mul_i32 s6, s100, 75776
    s_sub_u32 s6, 65536, s6
    v_add_u32 v10, s6, v8
    s_lshl_b32 s7, s76, 2
    v_mfma_f32_16x16x32_bf16 v[80:83], v[140:143], v[24:27], v[80:83]
    s_waitcnt lgkmcnt(4)
    v_add_u32 v2, s7, v2
    v_cmp_lt_u32 vcc, 9, v2
    s_mul_i32 s6, s100, 86016
    s_add_u32 s6, s6, 15360
    v_mfma_f32_16x16x32_bf16 v[76:79], v[136:139], v[24:27], v[76:79]
    ds_read_b128 v[24:27], v4 offset:6144
    v_add_u32 v3, s6, v10
    v_cndmask_b32 v10, v10, v3, vcc
    s_and_b32 s100, s3, 1
    s_cselect_b32 s6, s61, s68
    v_mfma_f32_16x16x32_bf16 v[76:79], v[156:159], v[28:31], v[76:79]
    ds_write_b128 v5, v[68:71] offset:10240
    v_add_u32 v5, s67, v52
    v_mfma_f32_16x16x32_bf16 v[80:83], v[160:163], v[28:31], v[80:83]
    s_mul_i32 s6, s6, 20480
    s_add_u32 s7, s6, 256
    v_add_u32 v54, s7, v54
    s_add_u32 s7, s6, s72
    v_mfma_f32_16x16x32_bf16 v[84:87], v[164:167], v[28:31], v[84:87]
    s_add_u32 s7, s7, 4096
    v_add_u32 v49, s7, v13
    s_mul_i32 s6, s100, 10240
    s_add_u32 s6, s6, 8192
    v_mfma_f32_16x16x32_bf16 v[88:91], v[168:171], v[28:31], v[88:91]
    s_waitcnt lgkmcnt(5)
    v_add_u32 v9, s6, v9
    s_mul_i32 s6, s100, 10240
    s_add_u32 s6, s6, 80896
    v_add_u32 v55, s6, v9
    v_mfma_f32_16x16x32_bf16 v[92:95], v[172:175], v[28:31], v[92:95]
    ds_read_b128 v[28:31], v4 offset:7168
    v_mfma_f32_16x16x32_bf16 v[92:95], v[192:195], v[16:19], v[92:95]
    ds_write_b128 v12, v[72:75] offset:0
    v_mfma_f32_16x16x32_bf16 v[88:91], v[188:191], v[16:19], v[88:91]
    s_add_u32 s65, s68, 0
    s_and_b32 s65, s65, 3
    s_andn2_b32 s7, s68, 3
    v_mfma_f32_16x16x32_bf16 v[84:87], v[184:187], v[16:19], v[84:87]
    s_add_u32 s65, s65, s7
    s_lshl_b32 s65, s65, 17
    s_add_u32 s65, s65, s66
    v_mfma_f32_16x16x32_bf16 v[80:83], v[180:183], v[16:19], v[80:83]
    s_waitcnt lgkmcnt(5)
    s_add_u32 m0, s99, 0
    v_mfma_f32_16x16x32_bf16 v[76:79], v[176:179], v[16:19], v[76:79]
    s_waitcnt vmcnt(5)
    s_waitcnt lgkmcnt(0)
    s_barrier
    ds_read_b128 v[32:35], v6 offset:0
    ds_read_b128 v[36:39], v6 offset:5120
    ds_read_b128 v[40:43], v6 offset:10240
    ds_read_b128 v[16:19], v4 offset:32768
    v_mfma_f32_16x16x32_bf16 v[76:79], v[196:199], v[20:23], v[76:79]
    buffer_load_dwordx4 v13, s[8:11], s65 offen offset:0 sc1 lds
    v_mfma_f32_16x16x32_bf16 v[80:83], v[200:203], v[20:23], v[80:83]
    buffer_load_dwordx4 v13, s[8:11], s65 offen offset:1024 sc1 lds
    v_mfma_f32_16x16x32_bf16 v[84:87], v[204:207], v[20:23], v[84:87]
    s_waitcnt lgkmcnt(3)
    v_add_f32 v56, v56, v32
    v_add_f32 v57, v57, v33
    v_mfma_f32_16x16x32_bf16 v[88:91], v[208:211], v[20:23], v[88:91]
    buffer_load_dwordx4 v13, s[8:11], s65 offen offset:2048 sc1 lds
    v_add_f32 v58, v58, v34
    v_add_f32 v59, v59, v35
    v_mfma_f32_16x16x32_bf16 v[92:95], v[212:215], v[20:23], v[92:95]
    s_waitcnt lgkmcnt(2)
    ds_read_b128 v[32:35], v5 offset:0
    ds_read_b128 v[20:23], v4 offset:33792
    v_add_f32 v56, v56, v36
    v_add_f32 v57, v57, v37
    v_mfma_f32_16x16x32_bf16 v[92:95], v[232:235], v[24:27], v[92:95]
    buffer_load_dwordx4 v13, s[8:11], s65 offen offset:3072 sc1 lds
    v_add_f32 v58, v58, v38
    v_add_f32 v59, v59, v39
    v_mfma_f32_16x16x32_bf16 v[88:91], v[228:231], v[24:27], v[88:91]
    s_waitcnt lgkmcnt(3)
    ds_read_b128 v[36:39], v5 offset:5120
    v_add_f32 v56, v56, v40
    v_add_f32 v57, v57, v41
    v_mfma_f32_16x16x32_bf16 v[84:87], v[224:227], v[24:27], v[84:87]
    v_add_f32 v58, v58, v42
    v_add_f32 v59, v59, v43
    v_mfma_f32_16x16x32_bf16 v[80:83], v[220:223], v[24:27], v[80:83]
    ds_read_b128 v[40:43], v5 offset:10240
    s_waitcnt lgkmcnt(3)
    v_add_f32 v72, v72, v32
    v_add_f32 v73, v73, v33
    s_add_u32 s6, s98, 0
    v_mfma_f32_16x16x32_bf16 v[76:79], v[216:219], v[24:27], v[76:79]
    ds_read_b128 v[24:27], v4 offset:34816
    v_add_f32 v74, v74, v34
    v_add_f32 v75, v75, v35
    v_mfma_f32_16x16x32_bf16 v[76:79], v[236:239], v[28:31], v[76:79]
    buffer_store_dwordx4 v[56:59], v44, s[8:11], s6 offen sc1
    s_waitcnt lgkmcnt(2)
    v_add_f32 v72, v72, v36
    v_add_f32 v73, v73, v37
    v_mfma_f32_16x16x32_bf16 v[80:83], v[240:243], v[28:31], v[80:83]
    v_add_f32 v74, v74, v38
    v_add_f32 v75, v75, v39
    v_mfma_f32_16x16x32_bf16 v[84:87], v[244:247], v[28:31], v[84:87]
    s_waitcnt lgkmcnt(1)
    v_add_f32 v72, v72, v40
    v_add_f32 v73, v73, v41
    v_mfma_f32_16x16x32_bf16 v[88:91], v[248:251], v[28:31], v[88:91]
    v_add_f32 v74, v74, v42
    v_add_f32 v75, v75, v43
    s_cmp_lg_u32 s71, 2
    v_mfma_f32_16x16x32_bf16 v[92:95], v[252:255], v[28:31], v[92:95]
    s_cbranch_scc1 L_nost_57
    buffer_store_dwordx4 v[72:75], v52, s[8:11], s6 offen sc1
L_nost_57:
    ds_read_b128 v[28:31], v4 offset:35840
    v_mfma_f32_16x16x32_bf16 v[56:59], v[96:99], v[16:19], 0
    s_sub_u32 s6, s71, 4
    s_and_b32 s6, s6, 3
    s_mul_i32 s7, s6, 5120
    v_mfma_f32_16x16x32_bf16 v[60:63], v[100:103], v[16:19], 0
    s_add_u32 s7, s7, s67
    s_cmp_eq_u32 s6, 3
    s_cselect_b32 s7, 124928, s7
    v_mfma_f32_16x16x32_bf16 v[64:67], v[104:107], v[16:19], 0
    v_add_u32 v12, s7, v52
    v_add_u32 v5, s67, v45
    v_mfma_f32_16x16x32_bf16 v[68:71], v[108:111], v[16:19], 0
    v_mfma_f32_16x16x32_bf16 v[72:75], v[112:115], v[16:19], 0
    ds_read_b128 v[16:19], v4 offset:36864
    v_mfma_f32_16x16x32_bf16 v[56:59], v[116:119], v[20:23], v[56:59]
    ds_write_b128 v5, v[80:83] offset:30720
    v_add_u32 v5, s67, v46
    v_mfma_f32_16x16x32_bf16 v[60:63], v[120:123], v[20:23], v[60:63]
    v_mfma_f32_16x16x32_bf16 v[64:67], v[124:127], v[20:23], v[64:67]
    v_cmp_le_i32 vcc, 0, v51
    s_cbranch_vccz L_idx_okb
    v_and_b32 v3, 7, v1
    v_lshlrev_b32 v3, 2, v3
    s_mov_b32 s72, 0x3a0000
    s_mov_b32 s79, 262144
L_poll_59:
    buffer_load_dword v51, v3, s[8:11], s72 offen sc1
    s_waitcnt vmcnt(0)
    v_cmp_le_i32 vcc, 0, v51
    s_cbranch_vccz L_polldone_60
    s_sleep 2
    s_sub_u32 s79, s79, 1
    s_cmp_lg_u32 s79, 0
    s_cbranch_scc1 L_poll_59
L_polldone_60:
L_idx_okb:
    s_mov_b32 s64, 0
    v_and_b32 v2, 0x7ff, v51
    v_sub_u32 v2, 0x7ff, v2
    v_lshrrev_b32 v3, 4, v2
    v_cmp_eq_u32 vcc, s68, v3
    v_cmp_eq_u32 s[74:75], s61, v3
    s_nop 3
    s_or_b64 vcc, vcc, s[74:75]
    s_cbranch_scc0 L_notok_61
    v_readlane_b32 s84, v2, 0
    v_readlane_b32 s85, v2, 1
    v_readlane_b32 s86, v2, 2
    v_readlane_b32 s87, v2, 3
    v_readlane_b32 s88, v2, 4
    v_readlane_b32 s65, v2, 5
    v_readlane_b32 s91, v2, 6
    v_readlane_b32 s101, v2, 7
    s_lshl_b32 s7, s76, 6
    s_lshr_b32 s100, s3, 2
    s_cselect_b32 s6, s61, s68
    s_lshl_b32 s6, s6, 4
    v_and_b32 v2, 15, v1
    v_add_u32 v2, s6, v2
    s_add_u32 s7, s7, s73
    v_and_b32 v3, 48, v1
    v_add_u32 v3, s7, v3
    v_cmp_eq_u32 vcc, s84, v2
    s_nop 1
    v_cndmask_b32 v48, v48, v3, vcc
    v_add_u32 v3, 1280, v3
    v_cmp_eq_u32 vcc, s85, v2
    s_nop 1
    v_cndmask_b32 v48, v48, v3, vcc
    v_add_u32 v3, 1280, v3
    v_cmp_eq_u32 vcc, s86, v2
    s_nop 1
    v_cndmask_b32 v48, v48, v3, vcc
    v_add_u32 v3, 1280, v3
    v_cmp_eq_u32 vcc, s87, v2
    s_nop 1
    v_cndmask_b32 v48, v48, v3, vcc
    v_add_u32 v3, 1280, v3
    v_cmp_eq_u32 vcc, s88, v2
    s_nop 1
    v_cndmask_b32 v48, v48, v3, vcc
    v_add_u32 v3, 1280, v3
    v_cmp_eq_u32 vcc, s65, v2
    s_nop 1
    v_cndmask_b32 v48, v48, v3, vcc
    v_add_u32 v3, 1280, v3
    v_cmp_eq_u32 vcc, s91, v2
    s_nop 1
    v_cndmask_b32 v48, v48, v3, vcc
    v_add_u32 v3, 1280, v3
    v_cmp_eq_u32 vcc, s101, v2
    s_nop 1
    v_cndmask_b32 v48, v48, v3, vcc
    s_movk_i32 s7, 256
    s_and_b32 s100, s3, 1
    s_cselect_b32 s6, s61, s68
    s_lshl_b32 s6, s6, 4
    v_and_b32 v2, 15, v1
    v_add_u32 v2, s6, v2
    s_add_u32 s7, s7, s73
    v_and_b32 v3, 48, v1
    v_add_u32 v3, s7, v3
    v_cmp_eq_u32 vcc, s84, v2
    s_nop 1
    v_cndmask_b32 v49, v49, v3, vcc
    v_add_u32 v3, 1280, v3
    v_cmp_eq_u32 vcc, s85, v2
    s_nop 1
    v_cndmask_b32 v49, v49, v3, vcc
    v_add_u32 v3, 1280, v3
    v_cmp_eq_u32 vcc, s86, v2
    s_nop 1
    v_cndmask_b32 v49, v49, v3, vcc
    v_add_u32 v3, 1280, v3
    v_cmp_eq_u32 vcc, s87, v2
    s_nop 1
    v_cndmask_b32 v49, v49, v3, vcc
    v_add_u32 v3, 1280, v3
    v_cmp_eq_u32 vcc, s88, v2
    s_nop 1
    v_cndmask_b32 v49, v49, v3, vcc
    v_add_u32 v3, 1280, v3
    v_cmp_eq_u32 vcc, s65, v2
    s_nop 1
    v_cndmask_b32 v49, v49, v3, vcc
    v_add_u32 v3, 1280, v3
    v_cmp_eq_u32 vcc, s91, v2
    s_nop 1
    v_cndmask_b32 v49, v49, v3, vcc
    v_add_u32 v3, 1280, v3
    v_cmp_eq_u32 vcc, s101, v2
    s_nop 1
    v_cndmask_b32 v49, v49, v3, vcc
    s_mov_b32 s64, 1
L_notok_61:
    v_mfma_f32_16x16x32_bf16 v[68:71], v[128:131], v[20:23], v[68:71]
    s_waitcnt lgkmcnt(3)
    v_mfma_f32_16x16x32_bf16 v[72:75], v[132:135], v[20:23], v[72:75]
    ds_read_b128 v[20:23], v4 offset:37888
    v_mfma_f32_16x16x32_bf16 v[72:75], v[152:155], v[24:27], v[72:75]
    ds_write_b128 v5, v[84:87] offset:35840
    v_add_u32 v5, s67, v47
    v_mfma_f32_16x16x32_bf16 v[68:71], v[148:151], v[24:27], v[68:71]
    v_mfma_f32_16x16x32_bf16 v[64:67], v[144:147], v[24:27], v[64:67]
    v_mfma_f32_16x16x32_bf16 v[60:63], v[140:143], v[24:27], v[60:63]
    s_waitcnt lgkmcnt(4)
    v_mfma_f32_16x16x32_bf16 v[56:59], v[136:139], v[24:27], v[56:59]
    ds_read_b128 v[24:27], v4 offset:38912
    v_mfma_f32_16x16x32_bf16 v[56:59], v[156:159], v[28:31], v[56:59]
    ds_write_b128 v5, v[88:91] offset:40960
    v_add_u32 v5, s67, v52
    v_mfma_f32_16x16x32_bf16 v[60:63], v[160:163], v[28:31], v[60:63]
    v_mfma_f32_16x16x32_bf16 v[64:67], v[164:167], v[28:31], v[64:67]
    v_mfma_f32_16x16x32_bf16 v[68:71], v[168:171], v[28:31], v[68:71]
    s_waitcnt lgkmcnt(5)
    v_mfma_f32_16x16x32_bf16 v[72:75], v[172:175], v[28:31], v[72:75]
    ds_read_b128 v[28:31], v4 offset:39936
    v_mfma_f32_16x16x32_bf16 v[72:75], v[192:195], v[16:19], v[72:75]
    ds_write_b128 v12, v[92:95] offset:30720
    v_mfma_f32_16x16x32_bf16 v[68:71], v[188:191], v[16:19], v[68:71]
    s_add_u32 s65, s61, 0
    s_and_b32 s65, s65, 3
    s_andn2_b32 s7, s61, 3
    v_mfma_f32_16x16x32_bf16 v[64:67], v[184:187], v[16:19], v[64:67]
    s_add_u32 s65, s65, s7
    s_lshl_b32 s65, s65, 17
    s_add_u32 s65, s65, s66
    v_mfma_f32_16x16x32_bf16 v[60:63], v[180:183], v[16:19], v[60:63]
    s_waitcnt lgkmcnt(5)
    s_add_u32 m0, s99, 32768
    v_mfma_f32_16x16x32_bf16 v[56:59], v[176:179], v[16:19], v[56:59]
    s_waitcnt vmcnt(5)
    s_waitcnt lgkmcnt(0)
    s_barrier
    ds_read_b128 v[32:35], v6 offset:30720
    ds_read_b128 v[36:39], v6 offset:35840
    ds_read_b128 v[40:43], v6 offset:40960
    ds_read_b128 v[16:19], v7 offset:0
    v_mfma_f32_16x16x32_bf16 v[56:59], v[196:199], v[20:23], v[56:59]
    buffer_load_dwordx4 v13, s[8:11], s65 offen offset:0 sc1 lds
    v_mfma_f32_16x16x32_bf16 v[60:63], v[200:203], v[20:23], v[60:63]
    buffer_load_dwordx4 v13, s[8:11], s65 offen offset:1024 sc1 lds
    v_mfma_f32_16x16x32_bf16 v[64:67], v[204:207], v[20:23], v[64:67]
    s_waitcnt lgkmcnt(3)
    v_add_f32 v76, v76, v32
    v_add_f32 v77, v77, v33
    v_mfma_f32_16x16x32_bf16 v[68:71], v[208:211], v[20:23], v[68:71]
    buffer_load_dwordx4 v13, s[8:11], s65 offen offset:2048 sc1 lds
    v_add_f32 v78, v78, v34
    v_add_f32 v79, v79, v35
    v_mfma_f32_16x16x32_bf16 v[72:75], v[212:215], v[20:23], v[72:75]
    s_waitcnt lgkmcnt(2)
    ds_read_b128 v[32:35], v5 offset:30720
    ds_read_b128 v[20:23], v7 offset:1024
    v_add_f32 v76, v76, v36
    v_add_f32 v77, v77, v37
    v_mfma_f32_16x16x32_bf16 v[72:75], v[232:235], v[24:27], v[72:75]
    buffer_load_dwordx4 v13, s[8:11], s65 offen offset:3072 sc1 lds
    v_add_f32 v78, v78, v38
    v_add_f32 v79, v79, v39
    v_mfma_f32_16x16x32_bf16 v[68:71], v[228:231], v[24:27], v[68:71]
    s_waitcnt lgkmcnt(3)
    ds_read_b128 v[36:39], v5 offset:35840
    v_add_f32 v76, v76, v40
    v_add_f32 v77, v77, v41
    v_mfma_f32_16x16x32_bf16 v[64:67], v[224:227], v[24:27], v[64:67]
    v_add_f32 v78, v78, v42
    v_add_f32 v79, v79, v43
    v_mfma_f32_16x16x32_bf16 v[60:63], v[220:223], v[24:27], v[60:63]
    ds_read_b128 v[40:43], v5 offset:40960
    s_waitcnt lgkmcnt(3)
    v_add_f32 v92, v92, v32
    v_add_f32 v93, v93, v33
    s_add_u32 s6, s96, 10240
    v_mfma_f32_16x16x32_bf16 v[56:59], v[216:219], v[24:27], v[56:59]
    ds_read_b128 v[24:27], v7 offset:2048
    v_add_f32 v94, v94, v34
    v_add_f32 v95, v95, v35
    v_mfma_f32_16x16x32_bf16 v[56:59], v[236:239], v[28:31], v[56:59]
    buffer_store_dwordx4 v[76:79], v44, s[8:11], s6 offen sc1
    s_waitcnt lgkmcnt(2)
    v_add_f32 v92, v92, v36
    v_add_f32 v93, v93, v37
    v_mfma_f32_16x16x32_bf16 v[60:63], v[240:243], v[28:31], v[60:63]
    v_add_f32 v94, v94, v38
    v_add_f32 v95, v95, v39
    v_mfma_f32_16x16x32_bf16 v[64:67], v[244:247], v[28:31], v[64:67]
    s_waitcnt lgkmcnt(1)
    v_add_f32 v92, v92, v40
    v_add_f32 v93, v93, v41
    v_mfma_f32_16x16x32_bf16 v[68:71], v[248:251], v[28:31], v[68:71]
    v_add_f32 v94, v94, v42
    v_add_f32 v95, v95, v43
    s_cmp_lg_u32 s71, 3
    v_mfma_f32_16x16x32_bf16 v[72:75], v[252:255], v[28:31], v[72:75]
    s_cbranch_scc1 L_nost_58
    buffer_store_dwordx4 v[92:95], v52, s[8:11], s6 offen sc1
L_nost_58:
    ds_read_b128 v[28:31], v7 offset:3072
    v_mfma_f32_16x16x32_bf16 v[76:79], v[96:99], v[16:19], 0
    s_sub_u32 s6, s71, 5
    s_and_b32 s6, s6, 3
    s_mul_i32 s7, s6, 5120
    v_mfma_f32_16x16x32_bf16 v[80:83], v[100:103], v[16:19], 0
    s_add_u32 s7, s7, s67
    s_cmp_eq_u32 s6, 3
    s_cselect_b32 s7, 155648, s7
    v_mfma_f32_16x16x32_bf16 v[84:87], v[104:107], v[16:19], 0
    v_add_u32 v12, s7, v52
    v_add_u32 v5, s67, v45
    v_mfma_f32_16x16x32_bf16 v[88:91], v[108:111], v[16:19], 0
    v_mfma_f32_16x16x32_bf16 v[92:95], v[112:115], v[16:19], 0
    ds_read_b128 v[16:19], v7 offset:4096
    v_mfma_f32_16x16x32_bf16 v[76:79], v[116:119], v[20:23], v[76:79]
    ds_write_b128 v5, v[60:63] offset:0
    v_add_u32 v5, s67, v46
    v_mfma_f32_16x16x32_bf16 v[80:83], v[120:123], v[20:23], v[80:83]
    v_mfma_f32_16x16x32_bf16 v[84:87], v[124:127], v[20:23], v[84:87]
    v_mfma_f32_16x16x32_bf16 v[88:91], v[128:131], v[20:23], v[88:91]
    s_waitcnt lgkmcnt(3)
    v_mfma_f32_16x16x32_bf16 v[92:95], v[132:135], v[20:23], v[92:95]
    ds_read_b128 v[20:23], v7 offset:5120
    v_mfma_f32_16x16x32_bf16 v[92:95], v[152:155], v[24:27], v[92:95]
    ds_write_b128 v5, v[64:67] offset:5120
    v_add_u32 v5, s67, v47
    v_mfma_f32_16x16x32_bf16 v[88:91], v[148:151], v[24:27], v[88:91]
    v_mfma_f32_16x16x32_bf16 v[84:87], v[144:147], v[24:27], v[84:87]
    v_mfma_f32_16x16x32_bf16 v[80:83], v[140:143], v[24:27], v[80:83]
    s_waitcnt lgkmcnt(4)
    v_mfma_f32_16x16x32_bf16 v[76:79], v[136:139], v[24:27], v[76:79]
    ds_read_b128 v[24:27], v7 offset:6144
    v_mfma_f32_16x16x32_bf16 v[76:79], v[156:159], v[28:31], v[76:79]
    ds_write_b128 v5, v[68:71] offset:10240
    v_add_u32 v5, s67, v52
    v_mfma_f32_16x16x32_bf16 v[80:83], v[160:163], v[28:31], v[80:83]
    v_mfma_f32_16x16x32_bf16 v[84:87], v[164:167], v[28:31], v[84:87]
    v_mfma_f32_16x16x32_bf16 v[88:91], v[168:171], v[28:31], v[88:91]
    s_waitcnt lgkmcnt(5)
    v_mfma_f32_16x16x32_bf16 v[92:95], v[172:175], v[28:31], v[92:95]
    ds_read_b128 v[28:31], v7 offset:7168
    v_mfma_f32_16x16x32_bf16 v[92:95], v[192:195], v[16:19], v[92:95]
    ds_write_b128 v12, v[72:75] offset:0
    v_mfma_f32_16x16x32_bf16 v[88:91], v[188:191], v[16:19], v[88:91]
    v_mfma_f32_16x16x32_bf16 v[84:87], v[184:187], v[16:19], v[84:87]
    v_mfma_f32_16x16x32_bf16 v[80:83], v[180:183], v[16:19], v[80:83]
    s_waitcnt lgkmcnt(5)
    v_mfma_f32_16x16x32_bf16 v[76:79], v[176:179], v[16:19], v[76:79]
    s_waitcnt vmcnt(5)
    s_waitcnt lgkmcnt(0)
    s_barrier
    ds_read_b128 v[32:35], v6 offset:0
    ds_read_b128 v[36:39], v6 offset:5120
    ds_read_b128 v[40:43], v6 offset:10240
    ds_read_b128 v[16:19], v4 offset:0
    v_mfma_f32_16x16x32_bf16 v[76:79], v[196:199], v[20:23], v[76:79]
    v_mfma_f32_16x16x32_bf16 v[80:83], v[200:203], v[20:23], v[80:83]
    v_mfma_f32_16x16x32_bf16 v[84:87], v[204:207], v[20:23], v[84:87]
    s_waitcnt lgkmcnt(3)
    v_add_f32 v56, v56, v32
    v_add_f32 v57, v57, v33
    v_mfma_f32_16x16x32_bf16 v[88:91], v[208:211], v[20:23], v[88:91]
    v_add_f32 v58, v58, v34
    v_add_f32 v59, v59, v35
    v_mfma_f32_16x16x32_bf16 v[92:95], v[212:215], v[20:23], v[92:95]
    s_waitcnt lgkmcnt(2)
    ds_read_b128 v[32:35], v5 offset:0
    ds_read_b128 v[20:23], v4 offset:1024
    v_add_f32 v56, v56, v36
    v_add_f32 v57, v57, v37
    v_mfma_f32_16x16x32_bf16 v[92:95], v[232:235], v[24:27], v[92:95]
    v_add_f32 v58, v58, v38
    v_add_f32 v59, v59, v39
    v_mfma_f32_16x16x32_bf16 v[88:91], v[228:231], v[24:27], v[88:91]
    s_waitcnt lgkmcnt(3)
    ds_read_b128 v[36:39], v5 offset:5120
    v_add_f32 v56, v56, v40
    v_add_f32 v57, v57, v41
    v_mfma_f32_16x16x32_bf16 v[84:87], v[224:227], v[24:27], v[84:87]
    v_add_f32 v58, v58, v42
    v_add_f32 v59, v59, v43
    v_mfma_f32_16x16x32_bf16 v[80:83], v[220:223], v[24:27], v[80:83]
    ds_read_b128 v[40:43], v5 offset:10240
    s_waitcnt lgkmcnt(3)
    v_add_f32 v72, v72, v32
    v_add_f32 v73, v73, v33
    s_add_u32 s6, s97, 10240
    v_mfma_f32_16x16x32_bf16 v[76:79], v[216:219], v[24:27], v[76:79]
    ds_read_b128 v[24:27], v4 offset:2048
    v_add_f32 v74, v74, v34
    v_add_f32 v75, v75, v35
    v_mfma_f32_16x16x32_bf16 v[76:79], v[236:239], v[28:31], v[76:79]
    buffer_store_dwordx4 v[56:59], v44, s[8:11], s6 offen sc1
    s_waitcnt lgkmcnt(2)
    v_add_f32 v72, v72, v36
    v_add_f32 v73, v73, v37
    v_mfma_f32_16x16x32_bf16 v[80:83], v[240:243], v[28:31], v[80:83]
    v_add_f32 v74, v74, v38
    v_add_f32 v75, v75, v39
    v_mfma_f32_16x16x32_bf16 v[84:87], v[244:247], v[28:31], v[84:87]
    s_waitcnt lgkmcnt(1)
    v_add_f32 v72, v72, v40
    v_add_f32 v73, v73, v41
    v_mfma_f32_16x16x32_bf16 v[88:91], v[248:251], v[28:31], v[88:91]
    v_add_f32 v74, v74, v42
    v_add_f32 v75, v75, v43
    s_cmp_lg_u32 s71, 0
    v_mfma_f32_16x16x32_bf16 v[92:95], v[252:255], v[28:31], v[92:95]
    s_cbranch_scc1 L_nost_62
    buffer_store_dwordx4 v[72:75], v52, s[8:11], s6 offen sc1
L_nost_62:
    ds_read_b128 v[28:31], v4 offset:3072
    v_mfma_f32_16x16x32_bf16 v[56:59], v[96:99], v[16:19], 0
    s_sub_u32 s6, s71, 6
    s_and_b32 s6, s6, 3
    s_mul_i32 s7, s6, 5120
    v_mfma_f32_16x16x32_bf16 v[60:63], v[100:103], v[16:19], 0
    s_add_u32 s7, s7, s67
    s_cmp_eq_u32 s6, 3
    s_cselect_b32 s7, 124928, s7
    v_mfma_f32_16x16x32_bf16 v[64:67], v[104:107], v[16:19], 0
    v_add_u32 v12, s7, v52
    v_add_u32 v5, s67, v45
    v_mfma_f32_16x16x32_bf16 v[68:71], v[108:111], v[16:19], 0
    v_mfma_f32_16x16x32_bf16 v[72:75], v[112:115], v[16:19], 0
    ds_read_b128 v[16:19], v4 offset:4096
    v_mfma_f32_16x16x32_bf16 v[56:59], v[116:119], v[20:23], v[56:59]
    ds_write_b128 v5, v[80:83] offset:30720
    v_add_u32 v5, s67, v46
    v_mfma_f32_16x16x32_bf16 v[60:63], v[120:123], v[20:23], v[60:63]
    v_mfma_f32_16x16x32_bf16 v[64:67], v[124:127], v[20:23], v[64:67]
    v_mfma_f32_16x16x32_bf16 v[68:71], v[128:131], v[20:23], v[68:71]
    s_waitcnt lgkmcnt(3)
    v_mfma_f32_16x16x32_bf16 v[72:75], v[132:135], v[20:23], v[72:75]
    ds_read_b128 v[20:23], v4 offset:5120
    v_mfma_f32_16x16x32_bf16 v[72:75], v[152:155], v[24:27], v[72:75]
    ds_write_b128 v5, v[84:87] offset:35840
    v_add_u32 v5, s67, v47
    v_mfma_f32_16x16x32_bf16 v[68:71], v[148:151], v[24:27], v[68:71]
    v_mfma_f32_16x16x32_bf16 v[64:67], v[144:147], v[24:27], v[64:67]
    v_mfma_f32_16x16x32_bf16 v[60:63], v[140:143], v[24:27], v[60:63]
    s_waitcnt lgkmcnt(4)
    v_mfma_f32_16x16x32_bf16 v[56:59], v[136:139], v[24:27], v[56:59]
    ds_read_b128 v[24:27], v4 offset:6144
    v_mfma_f32_16x16x32_bf16 v[56:59], v[156:159], v[28:31], v[56:59]
    ds_write_b128 v5, v[88:91] offset:40960
    v_add_u32 v5, s67, v52
    v_mfma_f32_16x16x32_bf16 v[60:63], v[160:163], v[28:31], v[60:63]
    v_mfma_f32_16x16x32_bf16 v[64:67], v[164:167], v[28:31], v[64:67]
    v_mfma_f32_16x16x32_bf16 v[68:71], v[168:171], v[28:31], v[68:71]
    s_waitcnt lgkmcnt(5)
    v_mfma_f32_16x16x32_bf16 v[72:75], v[172:175], v[28:31], v[72:75]
    ds_read_b128 v[28:31], v4 offset:7168
    v_mfma_f32_16x16x32_bf16 v[72:75], v[192:195], v[16:19], v[72:75]
    ds_write_b128 v12, v[92:95] offset:30720
    v_mfma_f32_16x16x32_bf16 v[68:71], v[188:191], v[16:19], v[68:71]
    v_mfma_f32_16x16x32_bf16 v[64:67], v[184:187], v[16:19], v[64:67]
    v_mov_b32 v2, 1
    v_writelane_b32 v2, 2, 0
    v_mfma_f32_16x16x32_bf16 v[60:63], v[180:183], v[16:19], v[60:63]
    s_waitcnt lgkmcnt(5)
    v_mfma_f32_16x16x32_bf16 v[56:59], v[176:179], v[16:19], v[56:59]
    s_waitcnt vmcnt(1)
    buffer_store_dword v2, v11, s[8:11], 0 offen sc1
    s_waitcnt lgkmcnt(0)
    s_barrier
    ds_read_b128 v[32:35], v6 offset:30720
    ds_read_b128 v[36:39], v6 offset:35840
    ds_read_b128 v[40:43], v6 offset:40960
    ds_read_b128 v[16:19], v4 offset:32768
    v_mfma_f32_16x16x32_bf16 v[56:59], v[196:199], v[20:23], v[56:59]
    v_mfma_f32_16x16x32_bf16 v[60:63], v[200:203], v[20:23], v[60:63]
    v_mfma_f32_16x16x32_bf16 v[64:67], v[204:207], v[20:23], v[64:67]
    s_waitcnt lgkmcnt(3)
    v_add_f32 v76, v76, v32
    v_add_f32 v77, v77, v33
    v_mfma_f32_16x16x32_bf16 v[68:71], v[208:211], v[20:23], v[68:71]
    v_add_f32 v78, v78, v34
    v_add_f32 v79, v79, v35
    v_mfma_f32_16x16x32_bf16 v[72:75], v[212:215], v[20:23], v[72:75]
    s_waitcnt lgkmcnt(2)
    ds_read_b128 v[32:35], v5 offset:30720
    ds_read_b128 v[20:23], v4 offset:33792
    v_add_f32 v76, v76, v36
    v_add_f32 v77, v77, v37
    v_mfma_f32_16x16x32_bf16 v[72:75], v[232:235], v[24:27], v[72:75]
    v_add_f32 v78, v78, v38
    v_add_f32 v79, v79, v39
    v_mfma_f32_16x16x32_bf16 v[68:71], v[228:231], v[24:27], v[68:71]
    s_waitcnt lgkmcnt(3)
    ds_read_b128 v[36:39], v5 offset:35840
    v_add_f32 v76, v76, v40
    v_add_f32 v77, v77, v41
    v_mfma_f32_16x16x32_bf16 v[64:67], v[224:227], v[24:27], v[64:67]
    v_add_f32 v78, v78, v42
    v_add_f32 v79, v79, v43
    v_mfma_f32_16x16x32_bf16 v[60:63], v[220:223], v[24:27], v[60:63]
    ds_read_b128 v[40:43], v5 offset:40960
    s_waitcnt lgkmcnt(3)
    v_add_f32 v92, v92, v32
    v_add_f32 v93, v93, v33
    s_add_u32 s6, s98, 10240
    v_mfma_f32_16x16x32_bf16 v[56:59], v[216:219], v[24:27], v[56:59]
    ds_read_b128 v[24:27], v4 offset:34816
    v_add_f32 v94, v94, v34
    v_add_f32 v95, v95, v35
    v_mfma_f32_16x16x32_bf16 v[56:59], v[236:239], v[28:31], v[56:59]
    buffer_store_dwordx4 v[76:79], v44, s[8:11], s6 offen sc1
    s_waitcnt lgkmcnt(2)
    v_add_f32 v92, v92, v36
    v_add_f32 v93, v93, v37
    v_mfma_f32_16x16x32_bf16 v[60:63], v[240:243], v[28:31], v[60:63]
    v_add_f32 v94, v94, v38
    v_add_f32 v95, v95, v39
    v_mfma_f32_16x16x32_bf16 v[64:67], v[244:247], v[28:31], v[64:67]
    s_waitcnt lgkmcnt(1)
    v_add_f32 v92, v92, v40
    v_add_f32 v93, v93, v41
    v_mfma_f32_16x16x32_bf16 v[68:71], v[248:251], v[28:31], v[68:71]
    v_add_f32 v94, v94, v42
    v_add_f32 v95, v95, v43
    s_cmp_lg_u32 s71, 1
    v_mfma_f32_16x16x32_bf16 v[72:75], v[252:255], v[28:31], v[72:75]
    s_cbranch_scc1 L_nost_63
    buffer_store_dwordx4 v[92:95], v52, s[8:11], s6 offen sc1
L_nost_63:
    ds_read_b128 v[28:31], v4 offset:35840
    v_mfma_f32_16x16x32_bf16 v[76:79], v[96:99], v[16:19], 0
    v_mfma_f32_16x16x32_bf16 v[80:83], v[100:103], v[16:19], 0
    v_mfma_f32_16x16x32_bf16 v[84:87], v[104:107], v[16:19], 0
    s_mul_i32 s73, s3, 5120
    s_add_u32 s6, s73, 65536
    v_mfma_f32_16x16x32_bf16 v[88:91], v[108:111], v[16:19], 0
    v_add_u32 v5, s6, v44
    v_mfma_f32_16x16x32_bf16 v[92:95], v[112:115], v[16:19], 0
    ds_read_b128 v[16:19], v4 offset:36864
    v_mfma_f32_16x16x32_bf16 v[76:79], v[116:119], v[20:23], v[76:79]
    ds_write_b128 v5, v[56:59]
    s_add_u32 s6, s73, 65536
    v_add_u32 v5, s6, v45
    v_mfma_f32_16x16x32_bf16 v[80:83], v[120:123], v[20:23], v[80:83]
    v_mfma_f32_16x16x32_bf16 v[84:87], v[124:127], v[20:23], v[84:87]
    v_mfma_f32_16x16x32_bf16 v[88:91], v[128:131], v[20:23], v[88:91]
    s_waitcnt lgkmcnt(3)
    v_mfma_f32_16x16x32_bf16 v[92:95], v[132:135], v[20:23], v[92:95]
    ds_read_b128 v[20:23], v4 offset:37888
    v_mfma_f32_16x16x32_bf16 v[92:95], v[152:155], v[24:27], v[92:95]
    ds_write_b128 v5, v[60:63]
    s_add_u32 s6, s73, 65536
    v_add_u32 v5, s6, v46
    v_mfma_f32_16x16x32_bf16 v[88:91], v[148:151], v[24:27], v[88:91]
    v_mfma_f32_16x16x32_bf16 v[84:87], v[144:147], v[24:27], v[84:87]
    v_mov_b32 v2, 2
    s_waitcnt vmcnt(0)
    buffer_store_dword v2, v11, s[8:11], 0 offen sc1
    v_mfma_f32_16x16x32_bf16 v[80:83], v[140:143], v[24:27], v[80:83]
    s_waitcnt lgkmcnt(4)
    v_mfma_f32_16x16x32_bf16 v[76:79], v[136:139], v[24:27], v[76:79]
    ds_read_b128 v[24:27], v4 offset:38912
    s_cmp_eq_u32 s64, 0
    s_cbranch_scc1 L_nb
    v_bfe_u32 v2, v1, 1, 3
    v_and_b32 v3, 1, v1
    v_lshl_add_u32 v3, v2, 7, v3
    v_lshlrev_b32 v3, 2, v3
    s_and_b32 s6, s4, 3
    s_lshl_b32 s6, s6, 7
    s_add_u32 s6, s6, 3907584
    s_mov_b32 s79, 262144
L_poll_64:
    buffer_load_dword v2, v3, s[8:11], s6 offen sc1
    s_waitcnt vmcnt(0)
    v_cmp_ne_u32 vcc, 1, v2
    s_cbranch_vccz L_polldone_65
    s_sleep 2
    s_sub_u32 s79, s79, 1
    s_cmp_lg_u32 s79, 0
    s_cbranch_scc1 L_poll_64
L_polldone_65:
L_nb:
    buffer_load_dwordx4 v[96:99], v53, s[12:15], s70 offen
    buffer_load_dwordx4 v[100:103], v48, s[8:11], 0 offen sc1
    s_cmp_ge_u32 s3, 2
    s_cbranch_scc1 L_itskip_66
    buffer_load_dwordx4 v[104:107], v54, s[12:15], s70 offen
    buffer_load_dwordx4 v[108:111], v49, s[8:11], 0 offen sc1
L_itskip_66:
    v_mfma_f32_16x16x32_bf16 v[76:79], v[156:159], v[28:31], v[76:79]
    ds_write_b128 v5, v[64:67]
    s_add_u32 s6, s73, 65536
    v_add_u32 v5, s6, v47
    v_mfma_f32_16x16x32_bf16 v[80:83], v[160:163], v[28:31], v[80:83]
    v_mfma_f32_16x16x32_bf16 v[84:87], v[164:167], v[28:31], v[84:87]
    v_mfma_f32_16x16x32_bf16 v[88:91], v[168:171], v[28:31], v[88:91]
    s_waitcnt lgkmcnt(5)
    v_mfma_f32_16x16x32_bf16 v[92:95], v[172:175], v[28:31], v[92:95]
    ds_read_b128 v[28:31], v4 offset:39936
    v_mfma_f32_16x16x32_bf16 v[92:95], v[192:195], v[16:19], v[92:95]
    ds_write_b128 v5, v[68:71]
    s_add_u32 s6, s73, 65536
    v_add_u32 v5, s6, v52
    v_mfma_f32_16x16x32_bf16 v[88:91], v[188:191], v[16:19], v[88:91]
    v_bfe_u32 v2, v1, 3, 2
    v_min_u32 v2, 2, v2
    v_and_b32 v3, 7, v1
    v_lshlrev_b32 v3, 2, v3
    v_lshl_add_u32 v3, v2, 7, v3
    v_mfma_f32_16x16x32_bf16 v[84:87], v[184:187], v[16:19], v[84:87]
    s_bitcmp1_b32 13, s3
    s_cselect_b32 s77, 1, 2
    buffer_load_dword v50, v3, s[8:11], s63 offen sc1
    v_mfma_f32_16x16x32_bf16 v[80:83], v[180:183], v[16:19], v[80:83]
    s_waitcnt lgkmcnt(5)
    v_mfma_f32_16x16x32_bf16 v[76:79], v[176:179], v[16:19], v[76:79]
    v_mfma_f32_16x16x32_bf16 v[76:79], v[196:199], v[20:23], v[76:79]
    ds_write_b128 v5, v[72:75]
    v_mfma_f32_16x16x32_bf16 v[80:83], v[200:203], v[20:23], v[80:83]
    v_mfma_f32_16x16x32_bf16 v[84:87], v[204:207], v[20:23], v[84:87]
    v_mfma_f32_16x16x32_bf16 v[88:91], v[208:211], v[20:23], v[88:91]
    s_waitcnt lgkmcnt(4)
    v_mfma_f32_16x16x32_bf16 v[92:95], v[212:215], v[20:23], v[92:95]
    v_mfma_f32_16x16x32_bf16 v[92:95], v[232:235], v[24:27], v[92:95]
    v_mfma_f32_16x16x32_bf16 v[88:91], v[228:231], v[24:27], v[88:91]
    v_mfma_f32_16x16x32_bf16 v[84:87], v[224:227], v[24:27], v[84:87]
    v_mfma_f32_16x16x32_bf16 v[80:83], v[220:223], v[24:27], v[80:83]
    s_waitcnt lgkmcnt(2)
    s_add_u32 s6, s73, 86016
    s_cmp_lt_u32 s3, 4
    s_cselect_b32 s73, s73, s6
    v_mfma_f32_16x16x32_bf16 v[76:79], v[216:219], v[24:27], v[76:79]
    s_waitcnt vmcnt(0)
    v_cmp_gt_u32 vcc, s77, v50
    s_mov_b32 s91, 0
    s_cbranch_vccnz L_x1n
    s_add_u32 s6, s62, 0
    buffer_load_dwordx4 v[112:115], v8, s[8:11], s6 offen offset:0 sc1
    buffer_load_dwordx4 v[116:119], v8, s[8:11], s6 offen offset:256 sc1
    s_add_u32 s6, s62, 20480
    buffer_load_dwordx4 v[120:123], v8, s[8:11], s6 offen offset:0 sc1
    buffer_load_dwordx4 v[124:127], v8, s[8:11], s6 offen offset:256 sc1
    s_add_u32 s6, s62, 40960
    buffer_load_dwordx4 v[128:131], v8, s[8:11], s6 offen offset:0 sc1
    buffer_load_dwordx4 v[132:135], v8, s[8:11], s6 offen offset:256 sc1
    s_cmp_ge_u32 s3, 2
    s_cbranch_scc1 L_xi_67
    s_add_u32 s6, s62, 0
    buffer_load_dwordx4 v[136:139], v9, s[8:11], s6 offen offset:0 sc1
    buffer_load_dwordx4 v[140:143], v9, s[8:11], s6 offen offset:256 sc1
    s_add_u32 s6, s62, 20480
    buffer_load_dwordx4 v[144:147], v9, s[8:11], s6 offen offset:0 sc1
    buffer_load_dwordx4 v[148:151], v9, s[8:11], s6 offen offset:256 sc1
    s_add_u32 s6, s62, 40960
    buffer_load_dwordx4 v[152:155], v9, s[8:11], s6 offen offset:0 sc1
    buffer_load_dwordx4 v[156:159], v9, s[8:11], s6 offen offset:256 sc1
L_xi_67:
    s_mov_b32 s91, 1
    s_branch L_x1j
L_x1n:
    buffer_load_dword v50, v3, s[8:11], s63 offen sc1
L_x1j:
    v_mfma_f32_16x16x32_bf16 v[76:79], v[236:239], v[28:31], v[76:79]
    v_mfma_f32_16x16x32_bf16 v[80:83], v[240:243], v[28:31], v[80:83]
    v_mfma_f32_16x16x32_bf16 v[84:87], v[244:247], v[28:31], v[84:87]
    v_mfma_f32_16x16x32_bf16 v[88:91], v[248:251], v[28:31], v[88:91]
    v_mfma_f32_16x16x32_bf16 v[92:95], v[252:255], v[28:31], v[92:95]
    s_nop 4
    v_add_u32 v5, s73, v44
    ds_write_b128 v5, v[76:79]
    v_add_u32 v5, s73, v45
    ds_write_b128 v5, v[80:83]
    v_add_u32 v5, s73, v46
    ds_write_b128 v5, v[84:87]
    v_add_u32 v5, s73, v47
    ds_write_b128 v5, v[88:91]
    v_add_u32 v5, s73, v52
    ds_write_b128 v5, v[92:95]
    s_mov_b64 s[78:79], 0
    s_cmp_lg_u32 s91, 0
    s_cbranch_scc1 L_x2a
    s_waitcnt vmcnt(0)
    v_cmp_gt_u32 s[78:79], s77, v50
    s_nop 3
    s_cmp_lg_u64 s[78:79], 0
    s_cbranch_scc1 L_x2a
    s_add_u32 s6, s62, 0
    buffer_load_dwordx4 v[112:115], v8, s[8:11], s6 offen offset:0 sc1
    buffer_load_dwordx4 v[116:119], v8, s[8:11], s6 offen offset:256 sc1
    s_add_u32 s6, s62, 20480
    buffer_load_dwordx4 v[120:123], v8, s[8:11], s6 offen offset:0 sc1
    buffer_load_dwordx4 v[124:127], v8, s[8:11], s6 offen offset:256 sc1
    s_add_u32 s6, s62, 40960
    buffer_load_dwordx4 v[128:131], v8, s[8:11], s6 offen offset:0 sc1
    buffer_load_dwordx4 v[132:135], v8, s[8:11], s6 offen offset:256 sc1
    s_cmp_ge_u32 s3, 2
    s_cbranch_scc1 L_xi_68
    s_add_u32 s6, s62, 0
    buffer_load_dwordx4 v[136:139], v9, s[8:11], s6 offen offset:0 sc1
    buffer_load_dwordx4 v[140:143], v9, s[8:11], s6 offen offset:256 sc1
    s_add_u32 s6, s62, 20480
    buffer_load_dwordx4 v[144:147], v9, s[8:11], s6 offen offset:0 sc1
    buffer_load_dwordx4 v[148:151], v9, s[8:11], s6 offen offset:256 sc1
    s_add_u32 s6, s62, 40960
    buffer_load_dwordx4 v[152:155], v9, s[8:11], s6 offen offset:0 sc1
    buffer_load_dwordx4 v[156:159], v9, s[8:11], s6 offen offset:256 sc1
L_xi_68:
L_x2a:
    s_waitcnt lgkmcnt(0)
    s_barrier
    ds_read_b128 v[160:163], v10 offset:0
    ds_read_b128 v[164:167], v10 offset:256
    ds_read_b128 v[168:171], v10 offset:5120
    ds_read_b128 v[172:175], v10 offset:5376
    ds_read_b128 v[176:179], v10 offset:10240
    ds_read_b128 v[180:183], v10 offset:10496
    ds_read_b128 v[184:187], v10 offset:15360
    ds_read_b128 v[188:191], v10 offset:15616
    ds_read_b128 v[192:195], v55 offset:0
    ds_read_b128 v[196:199], v55 offset:256
    ds_read_b128 v[200:203], v55 offset:5120
    ds_read_b128 v[204:207], v55 offset:5376
    ds_read_b128 v[208:211], v55 offset:10240
    ds_read_b128 v[212:215], v55 offset:10496
    ds_read_b128 v[216:219], v55 offset:15360
    ds_read_b128 v[220:223], v55 offset:15616
    s_cmp_eq_u64 s[78:79], 0
    s_cbranch_scc1 L_x2b
    s_mov_b32 s79, 262144
L_poll_69:
    buffer_load_dword v2, v3, s[8:11], s63 offen sc1
    s_waitcnt vmcnt(0)
    v_cmp_gt_u32 vcc, s77, v2
    s_cbranch_vccz L_polldone_70
    s_sleep 1
    s_sub_u32 s79, s79, 1
    s_cmp_lg_u32 s79, 0
    s_cbranch_scc1 L_poll_69
L_polldone_70:
    s_add_u32 s6, s62, 0
    buffer_load_dwordx4 v[112:115], v8, s[8:11], s6 offen offset:0 sc1
    buffer_load_dwordx4 v[116:119], v8, s[8:11], s6 offen offset:256 sc1
    s_add_u32 s6, s62, 20480
    buffer_load_dwordx4 v[120:123], v8, s[8:11], s6 offen offset:0 sc1
    buffer_load_dwordx4 v[124:127], v8, s[8:11], s6 offen offset:256 sc1
    s_add_u32 s6, s62, 40960
    buffer_load_dwordx4 v[128:131], v8, s[8:11], s6 offen offset:0 sc1
    buffer_load_dwordx4 v[132:135], v8, s[8:11], s6 offen offset:256 sc1
    s_cmp_ge_u32 s3, 2
    s_cbranch_scc1 L_xi_71
    s_add_u32 s6, s62, 0
    buffer_load_dwordx4 v[136:139], v9, s[8:11], s6 offen offset:0 sc1
    buffer_load_dwordx4 v[140:143], v9, s[8:11], s6 offen offset:256 sc1
    s_add_u32 s6, s62, 20480
    buffer_load_dwordx4 v[144:147], v9, s[8:11], s6 offen offset:0 sc1
    buffer_load_dwordx4 v[148:151], v9, s[8:11], s6 offen offset:256 sc1
    s_add_u32 s6, s62, 40960
    buffer_load_dwordx4 v[152:155], v9, s[8:11], s6 offen offset:0 sc1
    buffer_load_dwordx4 v[156:159], v9, s[8:11], s6 offen offset:256 sc1
L_xi_71:
L_x2b:
    s_mov_b32 s16, s54
    s_mov_b32 s17, s55
    s_mov_b32 s18, 0x280000
    s_mov_b32 s19, 0x20000
    s_waitcnt lgkmcnt(8)
    v_pk_add_f32 v[160:161], v[160:161], v[168:169]
    v_pk_add_f32 v[162:163], v[162:163], v[170:171]
    v_pk_add_f32 v[164:165], v[164:165], v[172:173]
    v_pk_add_f32 v[166:167], v[166:167], v[174:175]
    v_pk_add_f32 v[160:161], v[160:161], v[176:177]
    v_pk_add_f32 v[162:163], v[162:163], v[178:179]
    v_pk_add_f32 v[164:165], v[164:165], v[180:181]
    v_pk_add_f32 v[166:167], v[166:167], v[182:183]
    v_pk_add_f32 v[160:161], v[160:161], v[184:185]
    v_pk_add_f32 v[162:163], v[162:163], v[186:187]
    v_pk_add_f32 v[164:165], v[164:165], v[188:189]
    v_pk_add_f32 v[166:167], v[166:167], v[190:191]
    s_waitcnt vmcnt(0)
    v_pk_add_f32 v[160:161], v[160:161], v[112:113]
    v_pk_add_f32 v[162:163], v[162:163], v[114:115]
    v_pk_add_f32 v[164:165], v[164:165], v[116:117]
    v_pk_add_f32 v[166:167], v[166:167], v[118:119]
    v_pk_add_f32 v[160:161], v[160:161], v[120:121]
    v_pk_add_f32 v[162:163], v[162:163], v[122:123]
    v_pk_add_f32 v[164:165], v[164:165], v[124:125]
    v_pk_add_f32 v[166:167], v[166:167], v[126:127]
    v_pk_add_f32 v[160:161], v[160:161], v[128:129]
    v_pk_add_f32 v[162:163], v[162:163], v[130:131]
    v_pk_add_f32 v[164:165], v[164:165], v[132:133]
    v_pk_add_f32 v[166:167], v[166:167], v[134:135]
    v_cvt_pk_bf16_f32 v2, v160, v161
    v_lshlrev_b32 v160, 16, v2
    v_and_b32 v161, 0xffff0000, v2
    v_lshlrev_b32 v2, 16, v96
    v_and_b32 v3, 0xffff0000, v96
    v_pk_add_f32 v[160:161], v[160:161], v[2:3]
    v_cvt_pk_bf16_f32 v2, v160, v161
    v_lshlrev_b32 v160, 16, v2
    v_and_b32 v161, 0xffff0000, v2
    v_lshlrev_b32 v2, 16, v100
    v_and_b32 v3, 0xffff0000, v100
    v_pk_add_f32 v[160:161], v[160:161], v[2:3]
    v_cvt_pk_bf16_f32 v224, v160, v161
    v_cvt_pk_bf16_f32 v2, v162, v163
    v_lshlrev_b32 v162, 16, v2
    v_and_b32 v163, 0xffff0000, v2
    v_lshlrev_b32 v2, 16, v97
    v_and_b32 v3, 0xffff0000, v97
    v_pk_add_f32 v[162:163], v[162:163], v[2:3]
    v_cvt_pk_bf16_f32 v2, v162, v163
    v_lshlrev_b32 v162, 16, v2
    v_and_b32 v163, 0xffff0000, v2
    v_lshlrev_b32 v2, 16, v101
    v_and_b32 v3, 0xffff0000, v101
    v_pk_add_f32 v[162:163], v[162:163], v[2:3]
    v_cvt_pk_bf16_f32 v225, v162, v163
    v_cvt_pk_bf16_f32 v2, v164, v165
    v_lshlrev_b32 v164, 16, v2
    v_and_b32 v165, 0xffff0000, v2
    v_lshlrev_b32 v2, 16, v98
    v_and_b32 v3, 0xffff0000, v98
    v_pk_add_f32 v[164:165], v[164:165], v[2:3]
    v_cvt_pk_bf16_f32 v2, v164, v165
    v_lshlrev_b32 v164, 16, v2
    v_and_b32 v165, 0xffff0000, v2
    v_lshlrev_b32 v2, 16, v102
    v_and_b32 v3, 0xffff0000, v102
    v_pk_add_f32 v[164:165], v[164:165], v[2:3]
    v_cvt_pk_bf16_f32 v226, v164, v165
    v_cvt_pk_bf16_f32 v2, v166, v167
    v_lshlrev_b32 v166, 16, v2
    v_and_b32 v167, 0xffff0000, v2
    v_lshlrev_b32 v2, 16, v99
    v_and_b32 v3, 0xffff0000, v99
    v_pk_add_f32 v[166:167], v[166:167], v[2:3]
    v_cvt_pk_bf16_f32 v2, v166, v167
    v_lshlrev_b32 v166, 16, v2
    v_and_b32 v167, 0xffff0000, v2
    v_lshlrev_b32 v2, 16, v103
    v_and_b32 v3, 0xffff0000, v103
    v_pk_add_f32 v[166:167], v[166:167], v[2:3]
    v_cvt_pk_bf16_f32 v227, v166, v167
    buffer_store_dwordx4 v[224:227], v53, s[16:19], s70 offen
    s_cmp_ge_u32 s3, 2
    s_cbranch_scc1 L_end
    s_waitcnt lgkmcnt(0)
    v_pk_add_f32 v[192:193], v[192:193], v[200:201]
    v_pk_add_f32 v[194:195], v[194:195], v[202:203]
    v_pk_add_f32 v[196:197], v[196:197], v[204:205]
    v_pk_add_f32 v[198:199], v[198:199], v[206:207]
    v_pk_add_f32 v[192:193], v[192:193], v[208:209]
    v_pk_add_f32 v[194:195], v[194:195], v[210:211]
    v_pk_add_f32 v[196:197], v[196:197], v[212:213]
    v_pk_add_f32 v[198:199], v[198:199], v[214:215]
    v_pk_add_f32 v[192:193], v[192:193], v[216:217]
    v_pk_add_f32 v[194:195], v[194:195], v[218:219]
    v_pk_add_f32 v[196:197], v[196:197], v[220:221]
    v_pk_add_f32 v[198:199], v[198:199], v[222:223]
    s_nop 0
    v_pk_add_f32 v[192:193], v[192:193], v[136:137]
    v_pk_add_f32 v[194:195], v[194:195], v[138:139]
    v_pk_add_f32 v[196:197], v[196:197], v[140:141]
    v_pk_add_f32 v[198:199], v[198:199], v[142:143]
    v_pk_add_f32 v[192:193], v[192:193], v[144:145]
    v_pk_add_f32 v[194:195], v[194:195], v[146:147]
    v_pk_add_f32 v[196:197], v[196:197], v[148:149]
    v_pk_add_f32 v[198:199], v[198:199], v[150:151]
    v_pk_add_f32 v[192:193], v[192:193], v[152:153]
    v_pk_add_f32 v[194:195], v[194:195], v[154:155]
    v_pk_add_f32 v[196:197], v[196:197], v[156:157]
    v_pk_add_f32 v[198:199], v[198:199], v[158:159]
    v_cvt_pk_bf16_f32 v2, v192, v193
    v_lshlrev_b32 v192, 16, v2
    v_and_b32 v193, 0xffff0000, v2
    v_lshlrev_b32 v2, 16, v104
    v_and_b32 v3, 0xffff0000, v104
    v_pk_add_f32 v[192:193], v[192:193], v[2:3]
    v_cvt_pk_bf16_f32 v2, v192, v193
    v_lshlrev_b32 v192, 16, v2
    v_and_b32 v193, 0xffff0000, v2
    v_lshlrev_b32 v2, 16, v108
    v_and_b32 v3, 0xffff0000, v108
    v_pk_add_f32 v[192:193], v[192:193], v[2:3]
    v_cvt_pk_bf16_f32 v228, v192, v193
    v_cvt_pk_bf16_f32 v2, v194, v195
    v_lshlrev_b32 v194, 16, v2
    v_and_b32 v195, 0xffff0000, v2
    v_lshlrev_b32 v2, 16, v105
    v_and_b32 v3, 0xffff0000, v105
    v_pk_add_f32 v[194:195], v[194:195], v[2:3]
    v_cvt_pk_bf16_f32 v2, v194, v195
    v_lshlrev_b32 v194, 16, v2
    v_and_b32 v195, 0xffff0000, v2
    v_lshlrev_b32 v2, 16, v109
    v_and_b32 v3, 0xffff0000, v109
    v_pk_add_f32 v[194:195], v[194:195], v[2:3]
    v_cvt_pk_bf16_f32 v229, v194, v195
    v_cvt_pk_bf16_f32 v2, v196, v197
    v_lshlrev_b32 v196, 16, v2
    v_and_b32 v197, 0xffff0000, v2
    v_lshlrev_b32 v2, 16, v106
    v_and_b32 v3, 0xffff0000, v106
    v_pk_add_f32 v[196:197], v[196:197], v[2:3]
    v_cvt_pk_bf16_f32 v2, v196, v197
    v_lshlrev_b32 v196, 16, v2
    v_and_b32 v197, 0xffff0000, v2
    v_lshlrev_b32 v2, 16, v110
    v_and_b32 v3, 0xffff0000, v110
    v_pk_add_f32 v[196:197], v[196:197], v[2:3]
    v_cvt_pk_bf16_f32 v230, v196, v197
    v_cvt_pk_bf16_f32 v2, v198, v199
    v_lshlrev_b32 v198, 16, v2
    v_and_b32 v199, 0xffff0000, v2
    v_lshlrev_b32 v2, 16, v107
    v_and_b32 v3, 0xffff0000, v107
    v_pk_add_f32 v[198:199], v[198:199], v[2:3]
    v_cvt_pk_bf16_f32 v2, v198, v199
    v_lshlrev_b32 v198, 16, v2
    v_and_b32 v199, 0xffff0000, v2
    v_lshlrev_b32 v2, 16, v111
    v_and_b32 v3, 0xffff0000, v111
    v_pk_add_f32 v[198:199], v[198:199], v[2:3]
    v_cvt_pk_bf16_f32 v231, v198, v199
    buffer_store_dwordx4 v[228:231], v54, s[16:19], s70 offen
L_end:
L_exit:
    s_endpgm
.section .rodata,"a"
.p2align 6
.amdhsa_kernel parallel_sum__compressed_kv_cla__moe_arch_mod__prompt_kernel
  .amdhsa_next_free_vgpr 256
  .amdhsa_next_free_sgpr 102
  .amdhsa_accum_offset 256
  .amdhsa_group_segment_fixed_size 0
  .amdhsa_kernarg_size 112
  .amdhsa_user_sgpr_count 2
  .amdhsa_user_sgpr_kernarg_segment_ptr 1
  .amdhsa_system_sgpr_workgroup_id_x 1
  .amdhsa_float_denorm_mode_32 3
.end_amdhsa_kernel
```

```asm
; @launch grid=(256,1,1) block=(512,1,1) lds=163840
.amdgcn_target "amdgcn-amd-amdhsa--gfx950"
.text
.globl parallel_sum__compressed_kv_cla__moe_arch_mod__prompt_kernel
.p2align 8
.type parallel_sum__compressed_kv_cla__moe_arch_mod__prompt_kernel,@function
parallel_sum__compressed_kv_cla__moe_arch_mod__prompt_kernel:
    s_cmp_ge_u32 s2, 256
    s_cbranch_scc1 L_exit
    s_load_dwordx16 s[32:47], s[0:1], 0
    s_load_dwordx8 s[48:55], s[0:1], 64
    s_load_dwordx4 s[56:59], s[0:1], 96
    v_lshrrev_b32 v2, 6, v0
    v_and_b32 v1, 63, v0
    v_readfirstlane_b32 s3, v2
    s_getpc_b64 s[80:81]
L_pc:
    s_lshr_b32 s6, s2, 3
    s_and_b32 s6, s6, 15
    s_lshl_b32 s6, s6, 12
    s_cmp_lt_u32 s3, 2
    s_cselect_b32 s6, 0, s6
    v_lshl_add_u32 v3, v0, 6, s6
    v_min_u32 v3, L_exit-L_pc, v3
    s_cmp_ge_u32 s3, 3
    s_cbranch_scc1 L_noct
    global_load_dword v11, v3, s[80:81]
L_noct:
    v_lshrrev_b32 v62, 5, v0
    v_and_b32 v62, 7, v62
    v_and_b32 v2, 31, v0
    v_lshlrev_b32 v2, 3, v2
    v_mul_u32_u24 v63, 1280, v62
    v_add_u32 v63, v63, v2
    s_mul_i32 s6, s2, 10240
    v_add_u32 v10, s6, v63
    s_cmp_lt_u32 s3, 4
    s_cbranch_scc1 L_st_k0
    s_waitcnt lgkmcnt(0)
    global_load_dwordx2 v[16:17], v10, s[32:33] offset:0
    global_load_dwordx2 v[18:19], v10, s[32:33] offset:256
    global_load_dwordx2 v[20:21], v10, s[32:33] offset:512
    global_load_dwordx2 v[22:23], v10, s[32:33] offset:768
    global_load_dwordx2 v[24:25], v10, s[32:33] offset:1024
    global_load_dwordx2 v[26:27], v2, s[46:47] offset:0
    global_load_dwordx2 v[28:29], v2, s[46:47] offset:256
    global_load_dwordx2 v[30:31], v2, s[46:47] offset:512
    global_load_dwordx2 v[32:33], v2, s[46:47] offset:768
    global_load_dwordx2 v[34:35], v2, s[46:47] offset:1024
    s_bfe_u32 s6, s2, 0x20003
    s_lshl_b32 s6, s6, 9
    s_bfe_u32 s7, s3, 0x10001
    s_lshl_b32 s7, s7, 8
    s_add_u32 s6, s6, s7
    s_andn2_b32 s7, s2, 31
    s_add_u32 s6, s6, s7
    s_and_b32 s72, s3, 1
    s_lshl_b32 s7, s72, 4
    s_add_u32 s6, s6, s7
    v_lshrrev_b32 v4, 3, v1
    v_add_u32 v4, s6, v4
    v_and_b32 v5, 7, v1
    v_lshlrev_b32 v5, 4, v5
    v_lshl_add_u32 v4, v4, 10, v5
    v_add_u32 v5, 8192, v4
    s_lshr_b32 s6, s2, 5
    s_lshl_b32 s6, s6, 1
    s_add_u32 s6, s6, s72
    s_lshl_b32 s6, s6, 15
    s_and_b32 s7, s2, 7
    s_lshl_b32 s7, s7, 10
    s_add_u32 s6, s6, s7
    s_bfe_u32 s7, s2, 0x20003
    s_lshl_b32 s7, s7, 8
    s_add_u32 s6, s6, s7
    v_lshrrev_b32 v6, 4, v1
    v_and_b32 v7, 15, v1
    v_lshlrev_b32 v7, 4, v7
    v_lshl_add_u32 v6, v6, 13, v7
    v_add_u32 v6, s6, v6
    s_cmp_ge_u32 s3, 6
    s_cselect_b32 s74, s40, s38
    s_cselect_b32 s75, s41, s39
    global_load_dwordx4 v[36:39], v4, s[34:35] offset:0
    global_load_dwordx4 v[36:39], v5, s[34:35] offset:0
    global_load_dwordx4 v[36:39], v6, s[74:75] nt
    v_add_u32 v6, 524288, v6
    global_load_dwordx4 v[36:39], v4, s[34:35] offset:128
    global_load_dwordx4 v[36:39], v5, s[34:35] offset:128
    global_load_dwordx4 v[36:39], v6, s[74:75] nt
    v_add_u32 v6, 524288, v6
    s_barrier
L_st_k0:
    s_and_b32 s6, s2, 7
    s_lshl_b32 s6, s6, 2
    s_lshr_b32 s7, s2, 3
    s_and_b32 s7, s7, 3
    s_add_u32 s4, s6, s7
    s_lshr_b32 s5, s2, 5
    s_and_b32 s76, s3, 3
    v_lshrrev_b32 v2, 3, v1
    v_and_b32 v3, 7, v1
    v_lshrrev_b32 v4, 4, v1
    v_xor_b32 v5, v3, v4
    v_lshlrev_b32 v5, 4, v5
    v_lshl_add_u32 v40, v2, 10, v5
    v_xor_b32 v5, 64, v40
    v_add_u32 v41, 7168, v5
    v_add_u32 v42, 14336, v40
    v_add_u32 v43, 14336, v41
    v_and_b32 v6, 15, v1
    s_lshl_b32 s6, s76, 4
    v_add_u32 v7, s6, v4
    v_lshlrev_b32 v5, 1, v4
    v_xor_b32 v5, v6, v5
    v_lshlrev_b32 v5, 4, v5
    v_lshl_add_u32 v44, v7, 13, v5
    v_add_u32 v45, 31744, v44
    v_xor_b32 v5, 0x80, v44
    v_add_u32 v46, 63488, v5
    v_add_u32 v47, 31744, v46
    s_and_b32 s6, s76, 1
    s_lshl_b32 s6, s6, 20
    s_lshr_b32 s7, s76, 1
    s_lshl_b32 s7, s7, 18
    s_add_u32 s6, s6, s7
    s_lshl_b32 s62, s5, 15
    s_add_u32 s62, s62, s6
    s_lshl_b32 s63, s4, 8
    s_lshl_b32 s64, s76, 13
    s_lshl_b32 s73, s76, 12
    s_add_u32 s73, s73, 32768
    s_andn2_b32 s100, 1, s5
    s_lshl_b32 s100, s100, 16
    s_add_u32 s64, s64, s100
    s_add_u32 s73, s73, s100
    s_waitcnt lgkmcnt(0)
    s_mov_b32 s12, s34
    s_mov_b32 s13, s35
    s_mov_b32 s14, 0x200000
    s_mov_b32 s15, 0x20000
    s_mov_b32 s16, s38
    s_mov_b32 s17, s39
    s_mov_b32 s18, 0x400000
    s_mov_b32 s19, 0x20000
    s_mov_b32 s20, s40
    s_mov_b32 s21, s41
    s_mov_b32 s22, 0x400000
    s_mov_b32 s23, 0x20000
    s_cmp_ge_u32 s3, 4
    s_cbranch_scc1 L_st_v0
    s_barrier
    s_mov_b32 m0, s64
    s_add_u32 s72, s62, 524288
    buffer_load_dwordx4 v40, s[12:15], s62 offen offset:0 lds
    buffer_load_dwordx4 v41, s[12:15], s62 offen offset:1024 lds
    buffer_load_dwordx4 v42, s[12:15], s62 offen offset:2048 lds
    buffer_load_dwordx4 v43, s[12:15], s62 offen offset:3072 lds
    s_add_u32 m0, s64, 4096
    s_add_u32 s62, s62, 128
    s_bitset0_b32 s62, 10
    buffer_load_dwordx4 v40, s[12:15], s72 offen offset:0 lds
    buffer_load_dwordx4 v41, s[12:15], s72 offen offset:1024 lds
    buffer_load_dwordx4 v42, s[12:15], s72 offen offset:2048 lds
    buffer_load_dwordx4 v43, s[12:15], s72 offen offset:3072 lds
    s_mov_b32 m0, s73
    s_xor_b32 s64, s64, 0x10000
    buffer_load_dwordx4 v44, s[16:19], s63 offen offset:0 nt lds
    buffer_load_dwordx4 v45, s[16:19], s63 offen offset:1024 nt lds
    buffer_load_dwordx4 v46, s[16:19], s63 offen offset:2048 nt lds
    buffer_load_dwordx4 v47, s[16:19], s63 offen offset:3072 nt lds
    s_add_u32 m0, s73, 16384
    s_xor_b32 s73, s73, 0x10000
    buffer_load_dwordx4 v44, s[20:23], s63 offen offset:0 nt lds
    buffer_load_dwordx4 v45, s[20:23], s63 offen offset:1024 nt lds
    buffer_load_dwordx4 v46, s[20:23], s63 offen offset:2048 nt lds
    buffer_load_dwordx4 v47, s[20:23], s63 offen offset:3072 nt lds
    s_add_u32 s63, s63, 524288
    s_bitset0_b32 s63, 22
    s_setprio 1
L_st_v0:
    s_mov_b32 s8, s58
    s_mov_b32 s9, s59
    s_mov_b32 s10, 0x5000000
    s_mov_b32 s11, 0x20000
    s_mov_b32 s24, s36
    s_mov_b32 s25, s37
    s_mov_b32 s26, 0x500000
    s_mov_b32 s27, 0x20000
    v_lshlrev_b32 v13, 4, v1
    s_lshl_b32 s6, s5, 2
    s_add_u32 s7, s6, s3
    s_sub_u32 s6, 56, s6
    s_add_u32 s6, s6, s3
    s_cmp_lt_u32 s3, 4
    s_cselect_b32 s60, s7, s6
    s_sub_u32 s6, 1, s5
    s_and_b32 s6, s6, 7
    s_lshl_b32 s6, s6, 5
    s_add_u32 s61, s6, s4
    v_and_b32 v2, 15, v1
    v_lshrrev_b32 v3, 4, v1
    s_and_b32 s6, s3, 1
    s_lshl_b32 s6, s6, 7
    v_add_u32 v4, s6, v2
    v_lshlrev_b32 v4, 7, v4
    v_add_u32 v4, s100, v4
    v_lshrrev_b32 v5, 1, v2
    v_add_u32 v6, 0, v3
    v_xor_b32 v6, v6, v5
    v_lshl_add_u32 v48, v6, 4, v4
    v_add_u32 v6, 4, v3
    v_xor_b32 v6, v6, v5
    v_lshl_add_u32 v49, v6, 4, v4
    v_lshrrev_b32 v4, 2, v2
    v_lshl_add_u32 v5, v3, 3, v4
    v_lshlrev_b32 v5, 8, v5
    v_and_b32 v6, 1, v2
    v_lshl_add_u32 v5, v6, 3, v5
    v_and_b32 v6, 1, v3
    v_lshl_or_b32 v4, v6, 2, v4
    v_lshlrev_b32 v4, 1, v4
    v_bfe_u32 v6, v2, 1, 1
    v_add_u32 v8, 131072, v5
    v_add_u32 v7, 0, v6
    v_xor_b32 v7, v7, v4
    v_lshl_add_u32 v54, v7, 4, v8
    v_add_u32 v7, 2, v6
    v_xor_b32 v7, v7, v4
    v_lshl_add_u32 v55, v7, 4, v8
    v_add_u32 v7, 4, v6
    v_xor_b32 v7, v7, v4
    v_lshl_add_u32 v56, v7, 4, v8
    v_add_u32 v7, 6, v6
    v_xor_b32 v7, v7, v4
    v_lshl_add_u32 v57, v7, 4, v8
    v_add_u32 v7, 8, v6
    v_xor_b32 v7, v7, v4
    v_lshl_add_u32 v58, v7, 4, v8
    v_add_u32 v7, 10, v6
    v_xor_b32 v7, v7, v4
    v_lshl_add_u32 v59, v7, 4, v8
    v_add_u32 v7, 12, v6
    v_xor_b32 v7, v7, v4
    v_lshl_add_u32 v60, v7, 4, v8
    v_add_u32 v7, 14, v6
    v_xor_b32 v7, v7, v4
    v_lshl_add_u32 v61, v7, 4, v8
    s_lshr_b32 s6, s3, 2
    s_lshl_b32 s6, s6, 14
    s_add_u32 s6, s6, 32768
    s_add_u32 s6, s6, s100
    v_add_u32 v5, s6, v5
    s_lshr_b32 s7, s3, 1
    s_and_b32 s7, s7, 1
    s_lshl_b32 s7, s7, 3
    s_add_u32 s6, s7, 0
    v_add_u32 v7, s6, v6
    v_xor_b32 v7, v7, v4
    v_lshl_add_u32 v50, v7, 4, v5
    s_add_u32 s6, s7, 2
    v_add_u32 v7, s6, v6
    v_xor_b32 v7, v7, v4
    v_lshl_add_u32 v51, v7, 4, v5
    s_add_u32 s6, s7, 4
    v_add_u32 v7, s6, v6
    v_xor_b32 v7, v7, v4
    v_lshl_add_u32 v52, v7, 4, v5
    s_add_u32 s6, s7, 6
    v_add_u32 v7, s6, v6
    v_xor_b32 v7, v7, v4
    v_lshl_add_u32 v53, v7, 4, v5
    v_mov_b64 v[128:129], 0
    v_mov_b64 v[130:131], 0
    v_mov_b64 v[132:133], 0
    v_mov_b64 v[134:135], 0
    v_mov_b64 v[136:137], 0
    v_mov_b64 v[138:139], 0
    v_mov_b64 v[140:141], 0
    v_mov_b64 v[142:143], 0
    v_mov_b64 v[144:145], 0
    v_mov_b64 v[146:147], 0
    v_mov_b64 v[148:149], 0
    v_mov_b64 v[150:151], 0
    v_mov_b64 v[152:153], 0
    v_mov_b64 v[154:155], 0
    v_mov_b64 v[156:157], 0
    v_mov_b64 v[158:159], 0
    v_mov_b64 v[160:161], 0
    v_mov_b64 v[162:163], 0
    v_mov_b64 v[164:165], 0
    v_mov_b64 v[166:167], 0
    v_mov_b64 v[168:169], 0
    v_mov_b64 v[170:171], 0
    v_mov_b64 v[172:173], 0
    v_mov_b64 v[174:175], 0
    v_mov_b64 v[176:177], 0
    v_mov_b64 v[178:179], 0
    v_mov_b64 v[180:181], 0
    v_mov_b64 v[182:183], 0
    v_mov_b64 v[184:185], 0
    v_mov_b64 v[186:187], 0
    v_mov_b64 v[188:189], 0
    v_mov_b64 v[190:191], 0
    v_mov_b64 v[192:193], 0
    v_mov_b64 v[194:195], 0
    v_mov_b64 v[196:197], 0
    v_mov_b64 v[198:199], 0
    v_mov_b64 v[200:201], 0
    v_mov_b64 v[202:203], 0
    v_mov_b64 v[204:205], 0
    v_mov_b64 v[206:207], 0
    v_mov_b64 v[208:209], 0
    v_mov_b64 v[210:211], 0
    v_mov_b64 v[212:213], 0
    v_mov_b64 v[214:215], 0
    v_mov_b64 v[216:217], 0
    v_mov_b64 v[218:219], 0
    v_mov_b64 v[220:221], 0
    v_mov_b64 v[222:223], 0
    v_mov_b64 v[224:225], 0
    v_mov_b64 v[226:227], 0
    v_mov_b64 v[228:229], 0
    v_mov_b64 v[230:231], 0
    v_mov_b64 v[232:233], 0
    v_mov_b64 v[234:235], 0
    v_mov_b64 v[236:237], 0
    v_mov_b64 v[238:239], 0
    v_mov_b64 v[240:241], 0
    v_mov_b64 v[242:243], 0
    v_mov_b64 v[244:245], 0
    v_mov_b64 v[246:247], 0
    v_mov_b64 v[248:249], 0
    v_mov_b64 v[250:251], 0
    v_mov_b64 v[252:253], 0
    v_mov_b64 v[254:255], 0
    v_add_u32 v12, 20480, v13
    s_mul_i32 s70, s60, 40960
    s_mov_b32 s65, 0
    s_lshl_b32 s6, s4, 20
    s_lshl_b32 s7, s5, 13
    s_add_u32 s6, s6, s7
    s_and_b32 s7, s3, 1
    s_lshl_b32 s7, s7, 16
    s_add_u32 s6, s6, s7
    s_add_u32 s67, s6, 16777216
    s_and_b32 s6, s4, 3
    s_add_u32 s6, s6, s5
    s_sub_u32 s7, s6, 5
    s_cselect_b32 s6, s6, s7
    s_sub_u32 s7, s6, 5
    s_cselect_b32 s6, s6, s7
    s_lshl_b32 s71, s6, 20
    s_lshl_b32 s7, s4, 8
    s_add_u32 s71, s71, s7
    s_lshl_b32 s7, s6, 12
    s_add_u32 s84, s70, s7
    s_add_u32 s6, s6, 1
    s_cmp_eq_u32 s6, 5
    s_cselect_b32 s6, 0, s6
    s_lshl_b32 s7, s6, 12
    s_add_u32 s85, s70, s7
    s_add_u32 s6, s6, 1
    s_cmp_eq_u32 s6, 5
    s_cselect_b32 s6, 0, s6
    s_lshl_b32 s7, s6, 12
    s_add_u32 s86, s70, s7
    s_add_u32 s6, s6, 1
    s_cmp_eq_u32 s6, 5
    s_cselect_b32 s6, 0, s6
    s_lshl_b32 s7, s6, 12
    s_add_u32 s87, s70, s7
    s_add_u32 s6, s6, 1
    s_cmp_eq_u32 s6, 5
    s_cselect_b32 s6, 0, s6
    s_lshl_b32 s7, s6, 12
    s_add_u32 s88, s70, s7
    s_lshr_b32 s7, s3, 1
    s_and_b32 s7, s7, 1
    s_cmp_ge_u32 s3, 4
    s_cbranch_scc1 L_c_v
    s_lshl_b32 s7, s7, 11
    s_add_u32 s67, s67, s7
    s_movk_i32 s68, 3072
    s_mov_b32 s69, 125952
    s_add_u32 s71, s71, 1048576
    s_sub_u32 s75, s71, 5242880
    s_cselect_b32 s71, s71, s75
    s_lshl_b32 s74, s76, 12
    s_add_u32 s74, s74, s100
    s_branch L_c_j
L_c_v:
    s_lshl_b32 s7, s7, 12
    s_add_u32 s67, s67, s7
    s_add_u32 s67, s67, 0x80000
    s_movk_i32 s68, 1024
    s_mov_b32 s69, 128000
L_c_j:
    s_cmp_ge_u32 s3, 4
    s_cbranch_scc1 L_st_v1
    s_mov_b32 m0, s64
    s_add_u32 s72, s62, 524288
    buffer_load_dwordx4 v40, s[12:15], s62 offen offset:0 lds
    buffer_load_dwordx4 v41, s[12:15], s62 offen offset:1024 lds
    buffer_load_dwordx4 v42, s[12:15], s62 offen offset:2048 lds
    buffer_load_dwordx4 v43, s[12:15], s62 offen offset:3072 lds
    s_add_u32 m0, s64, 4096
    s_add_u32 s62, s62, 128
    s_bitset0_b32 s62, 10
    buffer_load_dwordx4 v40, s[12:15], s72 offen offset:0 lds
    buffer_load_dwordx4 v41, s[12:15], s72 offen offset:1024 lds
    buffer_load_dwordx4 v42, s[12:15], s72 offen offset:2048 lds
    buffer_load_dwordx4 v43, s[12:15], s72 offen offset:3072 lds
    s_waitcnt vmcnt(8)
    s_branch L_st_j1
L_st_v1:
    s_waitcnt vmcnt(6)
    v_lshlrev_b32 v64, 16, v16
    v_and_b32 v65, 0xffff0000, v16
    v_lshlrev_b32 v66, 16, v17
    v_and_b32 v67, 0xffff0000, v17
    v_lshlrev_b32 v68, 16, v18
    v_and_b32 v69, 0xffff0000, v18
    v_lshlrev_b32 v70, 16, v19
    v_and_b32 v71, 0xffff0000, v19
    v_lshlrev_b32 v72, 16, v20
    v_and_b32 v73, 0xffff0000, v20
    v_lshlrev_b32 v74, 16, v21
    v_and_b32 v75, 0xffff0000, v21
    v_lshlrev_b32 v76, 16, v22
    v_and_b32 v77, 0xffff0000, v22
    v_lshlrev_b32 v78, 16, v23
    v_and_b32 v79, 0xffff0000, v23
    v_lshlrev_b32 v80, 16, v24
    v_and_b32 v81, 0xffff0000, v24
    v_lshlrev_b32 v82, 16, v25
    v_and_b32 v83, 0xffff0000, v25
    v_pk_add_f32 v[2:3], v[64:65], v[66:67]
    v_pk_add_f32 v[2:3], v[2:3], v[68:69]
    v_pk_add_f32 v[2:3], v[2:3], v[70:71]
    v_pk_add_f32 v[2:3], v[2:3], v[72:73]
    v_pk_add_f32 v[2:3], v[2:3], v[74:75]
    v_pk_add_f32 v[2:3], v[2:3], v[76:77]
    v_pk_add_f32 v[2:3], v[2:3], v[78:79]
    v_pk_add_f32 v[2:3], v[2:3], v[80:81]
    v_pk_add_f32 v[2:3], v[2:3], v[82:83]
    v_add_f32 v2, v2, v3
    s_nop 1
    v_add_f32_dpp v2, v2, v2 quad_perm:[1,0,3,2] row_mask:0xf bank_mask:0xf
    s_nop 1
    v_add_f32_dpp v2, v2, v2 quad_perm:[2,3,0,1] row_mask:0xf bank_mask:0xf
    s_nop 1
    v_add_f32_dpp v2, v2, v2 row_half_mirror row_mask:0xf bank_mask:0xf
    s_nop 1
    v_add_f32_dpp v2, v2, v2 row_mirror row_mask:0xf bank_mask:0xf
    v_mov_b32 v8, v2
    s_nop 1
    v_permlane16_swap_b32 v2, v8
    s_nop 1
    v_add_f32 v2, v2, v8
    s_mov_b32 s7, 0x3acccccd
    v_mul_f32 v2, s7, v2
    v_mov_b64 v[4:5], 0
    v_pk_add_f32 v[6:7], v[64:65], v[2:3] op_sel_hi:[1,0] neg_lo:[0,1] neg_hi:[0,1]
    v_pk_fma_f32 v[4:5], v[6:7], v[6:7], v[4:5]
    v_pk_add_f32 v[6:7], v[66:67], v[2:3] op_sel_hi:[1,0] neg_lo:[0,1] neg_hi:[0,1]
    v_pk_fma_f32 v[4:5], v[6:7], v[6:7], v[4:5]
    v_pk_add_f32 v[6:7], v[68:69], v[2:3] op_sel_hi:[1,0] neg_lo:[0,1] neg_hi:[0,1]
    v_pk_fma_f32 v[4:5], v[6:7], v[6:7], v[4:5]
    v_pk_add_f32 v[6:7], v[70:71], v[2:3] op_sel_hi:[1,0] neg_lo:[0,1] neg_hi:[0,1]
    v_pk_fma_f32 v[4:5], v[6:7], v[6:7], v[4:5]
    v_pk_add_f32 v[6:7], v[72:73], v[2:3] op_sel_hi:[1,0] neg_lo:[0,1] neg_hi:[0,1]
    v_pk_fma_f32 v[4:5], v[6:7], v[6:7], v[4:5]
    v_pk_add_f32 v[6:7], v[74:75], v[2:3] op_sel_hi:[1,0] neg_lo:[0,1] neg_hi:[0,1]
    v_pk_fma_f32 v[4:5], v[6:7], v[6:7], v[4:5]
    v_pk_add_f32 v[6:7], v[76:77], v[2:3] op_sel_hi:[1,0] neg_lo:[0,1] neg_hi:[0,1]
    v_pk_fma_f32 v[4:5], v[6:7], v[6:7], v[4:5]
    v_pk_add_f32 v[6:7], v[78:79], v[2:3] op_sel_hi:[1,0] neg_lo:[0,1] neg_hi:[0,1]
    v_pk_fma_f32 v[4:5], v[6:7], v[6:7], v[4:5]
    v_pk_add_f32 v[6:7], v[80:81], v[2:3] op_sel_hi:[1,0] neg_lo:[0,1] neg_hi:[0,1]
    v_pk_fma_f32 v[4:5], v[6:7], v[6:7], v[4:5]
    v_pk_add_f32 v[6:7], v[82:83], v[2:3] op_sel_hi:[1,0] neg_lo:[0,1] neg_hi:[0,1]
    v_pk_fma_f32 v[4:5], v[6:7], v[6:7], v[4:5]
    v_add_f32 v4, v4, v5
    s_nop 1
    v_add_f32_dpp v4, v4, v4 quad_perm:[1,0,3,2] row_mask:0xf bank_mask:0xf
    s_nop 1
    v_add_f32_dpp v4, v4, v4 quad_perm:[2,3,0,1] row_mask:0xf bank_mask:0xf
    s_nop 1
    v_add_f32_dpp v4, v4, v4 row_half_mirror row_mask:0xf bank_mask:0xf
    s_nop 1
    v_add_f32_dpp v4, v4, v4 row_mirror row_mask:0xf bank_mask:0xf
    v_mov_b32 v8, v4
    s_nop 1
    v_permlane16_swap_b32 v4, v8
    s_nop 1
    v_add_f32 v4, v4, v8
    v_mul_f32 v4, s7, v4
    v_cvt_pk_bf16_f32 v2, v2, v2
    v_lshlrev_b32 v2, 16, v2
    v_cvt_pk_bf16_f32 v4, v4, v4
    v_lshlrev_b32 v4, 16, v4
    v_add_f32 v4, 0x3727c5ac, v4
    v_cvt_pk_bf16_f32 v4, v4, v4
    v_lshlrev_b32 v4, 16, v4
    v_sqrt_f32 v4, v4
    s_nop 0
    v_cvt_pk_bf16_f32 v4, v4, v4
    v_lshlrev_b32 v4, 16, v4
    v_rcp_f32 v6, v4
    s_nop 0
    v_fma_f32 v5, -v4, v6, 1.0
    v_fmac_f32 v6, v5, v6
    v_mov_b32 v9, 0
    v_pk_add_f32 v[64:65], v[64:65], v[2:3] op_sel_hi:[1,0] neg_lo:[0,1] neg_hi:[0,1]
    v_cvt_pk_bf16_f32 v5, v64, v65
    v_lshlrev_b32 v64, 16, v5
    v_and_b32 v65, 0xffff0000, v5
    v_pk_mul_f32 v[64:65], v[64:65], v[6:7] op_sel_hi:[1,0]
    v_cvt_pk_bf16_f32 v16, v64, v65
    v_pk_add_f32 v[66:67], v[66:67], v[2:3] op_sel_hi:[1,0] neg_lo:[0,1] neg_hi:[0,1]
    v_cvt_pk_bf16_f32 v5, v66, v67
    v_lshlrev_b32 v66, 16, v5
    v_and_b32 v67, 0xffff0000, v5
    v_pk_mul_f32 v[66:67], v[66:67], v[6:7] op_sel_hi:[1,0]
    v_cvt_pk_bf16_f32 v17, v66, v67
    v_pk_add_f32 v[68:69], v[68:69], v[2:3] op_sel_hi:[1,0] neg_lo:[0,1] neg_hi:[0,1]
    v_cvt_pk_bf16_f32 v5, v68, v69
    v_lshlrev_b32 v68, 16, v5
    v_and_b32 v69, 0xffff0000, v5
    v_pk_mul_f32 v[68:69], v[68:69], v[6:7] op_sel_hi:[1,0]
    v_cvt_pk_bf16_f32 v18, v68, v69
    v_pk_add_f32 v[70:71], v[70:71], v[2:3] op_sel_hi:[1,0] neg_lo:[0,1] neg_hi:[0,1]
    v_cvt_pk_bf16_f32 v5, v70, v71
    v_lshlrev_b32 v70, 16, v5
    v_and_b32 v71, 0xffff0000, v5
    v_pk_mul_f32 v[70:71], v[70:71], v[6:7] op_sel_hi:[1,0]
    v_cvt_pk_bf16_f32 v19, v70, v71
    v_pk_add_f32 v[72:73], v[72:73], v[2:3] op_sel_hi:[1,0] neg_lo:[0,1] neg_hi:[0,1]
    v_cvt_pk_bf16_f32 v5, v72, v73
    v_lshlrev_b32 v72, 16, v5
    v_and_b32 v73, 0xffff0000, v5
    v_pk_mul_f32 v[72:73], v[72:73], v[6:7] op_sel_hi:[1,0]
    v_cvt_pk_bf16_f32 v20, v72, v73
    v_pk_add_f32 v[74:75], v[74:75], v[2:3] op_sel_hi:[1,0] neg_lo:[0,1] neg_hi:[0,1]
    v_cvt_pk_bf16_f32 v5, v74, v75
    v_lshlrev_b32 v74, 16, v5
    v_and_b32 v75, 0xffff0000, v5
    v_pk_mul_f32 v[74:75], v[74:75], v[6:7] op_sel_hi:[1,0]
    v_cvt_pk_bf16_f32 v21, v74, v75
    v_pk_add_f32 v[76:77], v[76:77], v[2:3] op_sel_hi:[1,0] neg_lo:[0,1] neg_hi:[0,1]
    v_cvt_pk_bf16_f32 v5, v76, v77
    v_lshlrev_b32 v76, 16, v5
    v_and_b32 v77, 0xffff0000, v5
    v_pk_mul_f32 v[76:77], v[76:77], v[6:7] op_sel_hi:[1,0]
    v_cvt_pk_bf16_f32 v22, v76, v77
    v_pk_add_f32 v[78:79], v[78:79], v[2:3] op_sel_hi:[1,0] neg_lo:[0,1] neg_hi:[0,1]
    v_cvt_pk_bf16_f32 v5, v78, v79
    v_lshlrev_b32 v78, 16, v5
    v_and_b32 v79, 0xffff0000, v5
    v_pk_mul_f32 v[78:79], v[78:79], v[6:7] op_sel_hi:[1,0]
    v_cvt_pk_bf16_f32 v23, v78, v79
    v_pk_add_f32 v[80:81], v[80:81], v[2:3] op_sel_hi:[1,0] neg_lo:[0,1] neg_hi:[0,1]
    v_cvt_pk_bf16_f32 v5, v80, v81
    v_lshlrev_b32 v80, 16, v5
    v_and_b32 v81, 0xffff0000, v5
    v_pk_mul_f32 v[80:81], v[80:81], v[6:7] op_sel_hi:[1,0]
    v_cvt_pk_bf16_f32 v24, v80, v81
    v_pk_add_f32 v[82:83], v[82:83], v[2:3] op_sel_hi:[1,0] neg_lo:[0,1] neg_hi:[0,1]
    v_cvt_pk_bf16_f32 v5, v82, v83
    v_lshlrev_b32 v82, 16, v5
    v_and_b32 v83, 0xffff0000, v5
    v_pk_mul_f32 v[82:83], v[82:83], v[6:7] op_sel_hi:[1,0]
    v_cvt_pk_bf16_f32 v25, v82, v83
    v_add_u32 v10, 131072, v63
    ds_write_b64 v10, v[16:17] offset:0
    ds_write_b64 v10, v[18:19] offset:256
    ds_write_b64 v10, v[20:21] offset:512
    ds_write_b64 v10, v[22:23] offset:768
    ds_write_b64 v10, v[24:25] offset:1024
    s_waitcnt lgkmcnt(0)
    v_mov_b32 v2, 0
    v_lshlrev_b32 v4, 16, v16
    v_lshlrev_b32 v5, 16, v26
    v_fmac_f32 v2, v4, v5
    v_and_b32 v4, 0xffff0000, v16
    v_and_b32 v5, 0xffff0000, v26
    v_fmac_f32 v2, v4, v5
    v_lshlrev_b32 v4, 16, v17
    v_lshlrev_b32 v5, 16, v27
    v_fmac_f32 v2, v4, v5
    v_and_b32 v4, 0xffff0000, v17
    v_and_b32 v5, 0xffff0000, v27
    v_fmac_f32 v2, v4, v5
    v_lshlrev_b32 v4, 16, v18
    v_lshlrev_b32 v5, 16, v28
    v_fmac_f32 v2, v4, v5
    v_and_b32 v4, 0xffff0000, v18
    v_and_b32 v5, 0xffff0000, v28
    v_fmac_f32 v2, v4, v5
    v_lshlrev_b32 v4, 16, v19
    v_lshlrev_b32 v5, 16, v29
    v_fmac_f32 v2, v4, v5
    v_and_b32 v4, 0xffff0000, v19
    v_and_b32 v5, 0xffff0000, v29
    v_fmac_f32 v2, v4, v5
    v_lshlrev_b32 v4, 16, v20
    v_lshlrev_b32 v5, 16, v30
    v_fmac_f32 v2, v4, v5
    v_and_b32 v4, 0xffff0000, v20
    v_and_b32 v5, 0xffff0000, v30
    v_fmac_f32 v2, v4, v5
    v_lshlrev_b32 v4, 16, v21
    v_lshlrev_b32 v5, 16, v31
    v_fmac_f32 v2, v4, v5
    v_and_b32 v4, 0xffff0000, v21
    v_and_b32 v5, 0xffff0000, v31
    v_fmac_f32 v2, v4, v5
    v_lshlrev_b32 v4, 16, v22
    v_lshlrev_b32 v5, 16, v32
    v_fmac_f32 v2, v4, v5
    v_and_b32 v4, 0xffff0000, v22
    v_and_b32 v5, 0xffff0000, v32
    v_fmac_f32 v2, v4, v5
    v_lshlrev_b32 v4, 16, v23
    v_lshlrev_b32 v5, 16, v33
    v_fmac_f32 v2, v4, v5
    v_and_b32 v4, 0xffff0000, v23
    v_and_b32 v5, 0xffff0000, v33
    v_fmac_f32 v2, v4, v5
    v_lshlrev_b32 v4, 16, v24
    v_lshlrev_b32 v5, 16, v34
    v_fmac_f32 v2, v4, v5
    v_and_b32 v4, 0xffff0000, v24
    v_and_b32 v5, 0xffff0000, v34
    v_fmac_f32 v2, v4, v5
    v_lshlrev_b32 v4, 16, v25
    v_lshlrev_b32 v5, 16, v35
    v_fmac_f32 v2, v4, v5
    v_and_b32 v4, 0xffff0000, v25
    v_and_b32 v5, 0xffff0000, v35
    v_fmac_f32 v2, v4, v5
    s_nop 1
    v_add_f32_dpp v2, v2, v2 quad_perm:[1,0,3,2] row_mask:0xf bank_mask:0xf
    s_nop 1
    v_add_f32_dpp v2, v2, v2 quad_perm:[2,3,0,1] row_mask:0xf bank_mask:0xf
    s_nop 1
    v_add_f32_dpp v2, v2, v2 row_half_mirror row_mask:0xf bank_mask:0xf
    s_nop 1
    v_add_f32_dpp v2, v2, v2 row_mirror row_mask:0xf bank_mask:0xf
    v_mov_b32 v8, v2
    s_nop 1
    v_permlane16_swap_b32 v2, v8
    s_nop 1
    v_add_f32 v2, v2, v8
    v_cvt_pk_bf16_f32 v2, v2, v2
    v_and_b32 v2, 0xffff, v2
    v_bfe_i32 v3, v2, 15, 1
    v_and_b32 v3, 0x7fff, v3
    v_or_b32 v3, 0x8000, v3
    v_xor_b32 v2, v2, v3
    s_lshl_b32 s7, s2, 3
    s_sub_u32 s6, 2047, s7
    v_sub_u32 v3, s6, v62
    v_lshl_or_b32 v2, v2, 11, v3
    v_lshlrev_b32 v3, 2, v62
    v_add_u32 v3, 161792, v3
    ds_write_b32 v3, v2
    s_waitcnt lgkmcnt(0)
L_st_j1:
    s_barrier
    s_cmp_ge_u32 s3, 4
    s_cbranch_scc1 L_kv_v
    ds_read_b128 v[64:67], v48 offset:0
    ds_read_b128 v[68:71], v48 offset:2048
    ds_read_b64_tr_b16 v[96:97], v50 offset:0
    ds_read_b64_tr_b16 v[98:99], v50 offset:1024
    ds_read_b64_tr_b16 v[100:101], v51 offset:0
    ds_read_b64_tr_b16 v[102:103], v51 offset:1024
    ds_read_b128 v[72:75], v48 offset:4096
    ds_read_b64_tr_b16 v[104:105], v52 offset:0
    ds_read_b64_tr_b16 v[106:107], v52 offset:1024
    ds_read_b64_tr_b16 v[108:109], v53 offset:0
    ds_read_b64_tr_b16 v[110:111], v53 offset:1024
    ds_read_b128 v[76:79], v48 offset:6144
    ds_read_b128 v[80:83], v48 offset:8192
    ds_read_b128 v[84:87], v48 offset:10240
    ds_read_b128 v[88:91], v48 offset:12288
    ds_read_b128 v[92:95], v48 offset:14336
    s_mov_b32 m0, s73
    s_xor_b32 s64, s64, 0x10000
    buffer_load_dwordx4 v44, s[16:19], s63 offen offset:0 nt lds
    buffer_load_dwordx4 v45, s[16:19], s63 offen offset:1024 nt lds
    buffer_load_dwordx4 v46, s[16:19], s63 offen offset:2048 nt lds
    buffer_load_dwordx4 v47, s[16:19], s63 offen offset:3072 nt lds
    s_add_u32 m0, s73, 16384
    s_xor_b32 s73, s73, 0x10000
    buffer_load_dwordx4 v44, s[20:23], s63 offen offset:0 nt lds
    buffer_load_dwordx4 v45, s[20:23], s63 offen offset:1024 nt lds
    buffer_load_dwordx4 v46, s[20:23], s63 offen offset:2048 nt lds
    buffer_load_dwordx4 v47, s[20:23], s63 offen offset:3072 nt lds
    s_add_u32 s63, s63, 524288
    s_bitset0_b32 s63, 22
.p2align 4
L_kloopA:
    s_waitcnt lgkmcnt(12)
    v_mfma_f32_16x16x32_bf16 v[128:131], v[96:99], v[64:67], v[128:131]
    ds_read_b64_tr_b16 v[112:113], v50 offset:8192
    s_waitcnt lgkmcnt(11)
    v_mfma_f32_16x16x32_bf16 v[132:135], v[100:103], v[64:67], v[132:135]
    ds_read_b64_tr_b16 v[114:115], v50 offset:9216
    s_waitcnt lgkmcnt(9)
    v_mfma_f32_16x16x32_bf16 v[136:139], v[104:107], v[64:67], v[136:139]
    ds_read_b64_tr_b16 v[116:117], v51 offset:8192
    s_waitcnt lgkmcnt(8)
    v_mfma_f32_16x16x32_bf16 v[140:143], v[108:111], v[64:67], v[140:143]
    ds_read_b64_tr_b16 v[118:119], v51 offset:9216
    ds_read_b128 v[64:67], v49 offset:0
    v_mfma_f32_16x16x32_bf16 v[156:159], v[108:111], v[68:71], v[156:159]
    ds_read_b64_tr_b16 v[120:121], v52 offset:8192
    v_mfma_f32_16x16x32_bf16 v[152:155], v[104:107], v[68:71], v[152:155]
    ds_read_b64_tr_b16 v[122:123], v52 offset:9216
    v_mfma_f32_16x16x32_bf16 v[148:151], v[100:103], v[68:71], v[148:151]
    ds_read_b64_tr_b16 v[124:125], v53 offset:8192
    v_mfma_f32_16x16x32_bf16 v[144:147], v[96:99], v[68:71], v[144:147]
    ds_read_b64_tr_b16 v[126:127], v53 offset:9216
    ds_read_b128 v[68:71], v49 offset:2048
    v_mfma_f32_16x16x32_bf16 v[160:163], v[96:99], v[72:75], v[160:163]
    v_mfma_f32_16x16x32_bf16 v[164:167], v[100:103], v[72:75], v[164:167]
    v_mfma_f32_16x16x32_bf16 v[168:171], v[104:107], v[72:75], v[168:171]
    v_mfma_f32_16x16x32_bf16 v[172:175], v[108:111], v[72:75], v[172:175]
    ds_read_b128 v[72:75], v49 offset:4096
    s_waitcnt lgkmcnt(15)
    v_mfma_f32_16x16x32_bf16 v[188:191], v[108:111], v[76:79], v[188:191]
    v_mfma_f32_16x16x32_bf16 v[184:187], v[104:107], v[76:79], v[184:187]
    v_mfma_f32_16x16x32_bf16 v[180:183], v[100:103], v[76:79], v[180:183]
    v_mfma_f32_16x16x32_bf16 v[176:179], v[96:99], v[76:79], v[176:179]
    ds_read_b128 v[76:79], v49 offset:6144
    s_waitcnt lgkmcnt(15)
    v_mfma_f32_16x16x32_bf16 v[192:195], v[96:99], v[80:83], v[192:195]
    v_mfma_f32_16x16x32_bf16 v[196:199], v[100:103], v[80:83], v[196:199]
    v_mfma_f32_16x16x32_bf16 v[200:203], v[104:107], v[80:83], v[200:203]
    v_mfma_f32_16x16x32_bf16 v[204:207], v[108:111], v[80:83], v[204:207]
    ds_read_b128 v[80:83], v49 offset:8192
    s_waitcnt lgkmcnt(15)
    v_mfma_f32_16x16x32_bf16 v[220:223], v[108:111], v[84:87], v[220:223]
    v_mfma_f32_16x16x32_bf16 v[216:219], v[104:107], v[84:87], v[216:219]
    v_mfma_f32_16x16x32_bf16 v[212:215], v[100:103], v[84:87], v[212:215]
    v_mfma_f32_16x16x32_bf16 v[208:211], v[96:99], v[84:87], v[208:211]
    ds_read_b128 v[84:87], v49 offset:10240
    s_waitcnt lgkmcnt(15)
    v_mfma_f32_16x16x32_bf16 v[224:227], v[96:99], v[88:91], v[224:227]
    v_mfma_f32_16x16x32_bf16 v[228:231], v[100:103], v[88:91], v[228:231]
    v_mfma_f32_16x16x32_bf16 v[232:235], v[104:107], v[88:91], v[232:235]
    v_mfma_f32_16x16x32_bf16 v[236:239], v[108:111], v[88:91], v[236:239]
    ds_read_b128 v[88:91], v49 offset:12288
    s_waitcnt lgkmcnt(15)
    v_mfma_f32_16x16x32_bf16 v[252:255], v[108:111], v[92:95], v[252:255]
    v_mfma_f32_16x16x32_bf16 v[248:251], v[104:107], v[92:95], v[248:251]
    v_mfma_f32_16x16x32_bf16 v[244:247], v[100:103], v[92:95], v[244:247]
    v_mfma_f32_16x16x32_bf16 v[240:243], v[96:99], v[92:95], v[240:243]
    ds_read_b128 v[92:95], v49 offset:14336
    s_waitcnt lgkmcnt(11)
    v_mfma_f32_16x16x32_bf16 v[128:131], v[112:115], v[64:67], v[128:131]
    v_mfma_f32_16x16x32_bf16 v[132:135], v[116:119], v[64:67], v[132:135]
    s_waitcnt lgkmcnt(9)
    v_mfma_f32_16x16x32_bf16 v[136:139], v[120:123], v[64:67], v[136:139]
    s_waitcnt lgkmcnt(7)
    v_mfma_f32_16x16x32_bf16 v[140:143], v[124:127], v[64:67], v[140:143]
    s_waitcnt lgkmcnt(6)
    v_mfma_f32_16x16x32_bf16 v[156:159], v[124:127], v[68:71], v[156:159]
    v_mfma_f32_16x16x32_bf16 v[152:155], v[120:123], v[68:71], v[152:155]
    v_mfma_f32_16x16x32_bf16 v[148:151], v[116:119], v[68:71], v[148:151]
    v_mfma_f32_16x16x32_bf16 v[144:147], v[112:115], v[68:71], v[144:147]
    v_xor_b32 v48, 0x10000, v48
    v_xor_b32 v49, 0x10000, v49
    v_xor_b32 v50, 0x10000, v50
    v_xor_b32 v51, 0x10000, v51
    v_xor_b32 v52, 0x10000, v52
    v_xor_b32 v53, 0x10000, v53
    s_waitcnt vmcnt(0) lgkmcnt(0)
    s_barrier
    ds_read_b128 v[64:67], v48 offset:0
    ds_read_b128 v[68:71], v48 offset:2048
    v_mfma_f32_16x16x32_bf16 v[160:163], v[112:115], v[72:75], v[160:163]
    ds_read_b64_tr_b16 v[96:97], v50 offset:0
    s_mov_b32 m0, s64
    s_add_u32 s72, s62, 524288
    v_mfma_f32_16x16x32_bf16 v[164:167], v[116:119], v[72:75], v[164:167]
    ds_read_b64_tr_b16 v[98:99], v50 offset:1024
    buffer_load_dwordx4 v40, s[12:15], s62 offen offset:0 lds
    v_mfma_f32_16x16x32_bf16 v[168:171], v[120:123], v[72:75], v[168:171]
    ds_read_b64_tr_b16 v[100:101], v51 offset:0
    buffer_load_dwordx4 v41, s[12:15], s62 offen offset:1024 lds
    v_mfma_f32_16x16x32_bf16 v[172:175], v[124:127], v[72:75], v[172:175]
    ds_read_b64_tr_b16 v[102:103], v51 offset:1024
    buffer_load_dwordx4 v42, s[12:15], s62 offen offset:2048 lds
    ds_read_b128 v[72:75], v48 offset:4096
    v_mfma_f32_16x16x32_bf16 v[188:191], v[124:127], v[76:79], v[188:191]
    ds_read_b64_tr_b16 v[104:105], v52 offset:0
    buffer_load_dwordx4 v43, s[12:15], s62 offen offset:3072 lds
    v_mfma_f32_16x16x32_bf16 v[184:187], v[120:123], v[76:79], v[184:187]
    ds_read_b64_tr_b16 v[106:107], v52 offset:1024
    s_add_u32 m0, s64, 4096
    s_add_u32 s62, s62, 128
    s_bitset0_b32 s62, 10
    v_mfma_f32_16x16x32_bf16 v[180:183], v[116:119], v[76:79], v[180:183]
    ds_read_b64_tr_b16 v[108:109], v53 offset:0
    buffer_load_dwordx4 v40, s[12:15], s72 offen offset:0 lds
    v_mfma_f32_16x16x32_bf16 v[176:179], v[112:115], v[76:79], v[176:179]
    ds_read_b64_tr_b16 v[110:111], v53 offset:1024
    buffer_load_dwordx4 v41, s[12:15], s72 offen offset:1024 lds
    ds_read_b128 v[76:79], v48 offset:6144
    v_mfma_f32_16x16x32_bf16 v[192:195], v[112:115], v[80:83], v[192:195]
    buffer_load_dwordx4 v42, s[12:15], s72 offen offset:2048 lds
    v_mfma_f32_16x16x32_bf16 v[196:199], v[116:119], v[80:83], v[196:199]
    buffer_load_dwordx4 v43, s[12:15], s72 offen offset:3072 lds
    v_mfma_f32_16x16x32_bf16 v[200:203], v[120:123], v[80:83], v[200:203]
    s_mov_b32 m0, s73
    s_xor_b32 s64, s64, 0x10000
    v_mfma_f32_16x16x32_bf16 v[204:207], v[124:127], v[80:83], v[204:207]
    buffer_load_dwordx4 v44, s[16:19], s63 offen offset:0 nt lds
    ds_read_b128 v[80:83], v48 offset:8192
    v_mfma_f32_16x16x32_bf16 v[220:223], v[124:127], v[84:87], v[220:223]
    buffer_load_dwordx4 v45, s[16:19], s63 offen offset:1024 nt lds
    v_mfma_f32_16x16x32_bf16 v[216:219], v[120:123], v[84:87], v[216:219]
    buffer_load_dwordx4 v46, s[16:19], s63 offen offset:2048 nt lds
    v_mfma_f32_16x16x32_bf16 v[212:215], v[116:119], v[84:87], v[212:215]
    buffer_load_dwordx4 v47, s[16:19], s63 offen offset:3072 nt lds
    v_mfma_f32_16x16x32_bf16 v[208:211], v[112:115], v[84:87], v[208:211]
    s_add_u32 m0, s73, 16384
    s_xor_b32 s73, s73, 0x10000
    ds_read_b128 v[84:87], v48 offset:10240
    v_mfma_f32_16x16x32_bf16 v[224:227], v[112:115], v[88:91], v[224:227]
    buffer_load_dwordx4 v44, s[20:23], s63 offen offset:0 nt lds
    v_mfma_f32_16x16x32_bf16 v[228:231], v[116:119], v[88:91], v[228:231]
    buffer_load_dwordx4 v45, s[20:23], s63 offen offset:1024 nt lds
    v_mfma_f32_16x16x32_bf16 v[232:235], v[120:123], v[88:91], v[232:235]
    buffer_load_dwordx4 v46, s[20:23], s63 offen offset:2048 nt lds
    v_mfma_f32_16x16x32_bf16 v[236:239], v[124:127], v[88:91], v[236:239]
    buffer_load_dwordx4 v47, s[20:23], s63 offen offset:3072 nt lds
    ds_read_b128 v[88:91], v48 offset:12288
    v_mfma_f32_16x16x32_bf16 v[252:255], v[124:127], v[92:95], v[252:255]
    s_add_u32 s63, s63, 524288
    s_bitset0_b32 s63, 22
    v_mfma_f32_16x16x32_bf16 v[248:251], v[120:123], v[92:95], v[248:251]
    v_mfma_f32_16x16x32_bf16 v[244:247], v[116:119], v[92:95], v[244:247]
    v_mfma_f32_16x16x32_bf16 v[240:243], v[112:115], v[92:95], v[240:243]
    ds_read_b128 v[92:95], v48 offset:14336
    s_add_u32 s65, s65, 1
    s_cmp_lt_u32 s65, 6
    s_cbranch_scc1 L_kloopA
.p2align 4
L_kloopB:
    s_bitcmp1_b32 128, s65
    s_cbranch_scc1 L_khook
L_khook_back:
    s_waitcnt lgkmcnt(12)
    v_mfma_f32_16x16x32_bf16 v[128:131], v[96:99], v[64:67], v[128:131]
    ds_read_b64_tr_b16 v[112:113], v50 offset:8192
    s_waitcnt lgkmcnt(11)
    v_mfma_f32_16x16x32_bf16 v[132:135], v[100:103], v[64:67], v[132:135]
    ds_read_b64_tr_b16 v[114:115], v50 offset:9216
    s_waitcnt lgkmcnt(9)
    v_mfma_f32_16x16x32_bf16 v[136:139], v[104:107], v[64:67], v[136:139]
    ds_read_b64_tr_b16 v[116:117], v51 offset:8192
    s_waitcnt lgkmcnt(8)
    v_mfma_f32_16x16x32_bf16 v[140:143], v[108:111], v[64:67], v[140:143]
    ds_read_b64_tr_b16 v[118:119], v51 offset:9216
    ds_read_b128 v[64:67], v49 offset:0
    v_mfma_f32_16x16x32_bf16 v[156:159], v[108:111], v[68:71], v[156:159]
    ds_read_b64_tr_b16 v[120:121], v52 offset:8192
    v_mfma_f32_16x16x32_bf16 v[152:155], v[104:107], v[68:71], v[152:155]
    ds_read_b64_tr_b16 v[122:123], v52 offset:9216
    v_mfma_f32_16x16x32_bf16 v[148:151], v[100:103], v[68:71], v[148:151]
    ds_read_b64_tr_b16 v[124:125], v53 offset:8192
    v_mfma_f32_16x16x32_bf16 v[144:147], v[96:99], v[68:71], v[144:147]
    ds_read_b64_tr_b16 v[126:127], v53 offset:9216
    ds_read_b128 v[68:71], v49 offset:2048
    v_mfma_f32_16x16x32_bf16 v[160:163], v[96:99], v[72:75], v[160:163]
    v_mfma_f32_16x16x32_bf16 v[164:167], v[100:103], v[72:75], v[164:167]
    v_mfma_f32_16x16x32_bf16 v[168:171], v[104:107], v[72:75], v[168:171]
    v_mfma_f32_16x16x32_bf16 v[172:175], v[108:111], v[72:75], v[172:175]
    ds_read_b128 v[72:75], v49 offset:4096
    s_waitcnt lgkmcnt(15)
    v_mfma_f32_16x16x32_bf16 v[188:191], v[108:111], v[76:79], v[188:191]
    v_mfma_f32_16x16x32_bf16 v[184:187], v[104:107], v[76:79], v[184:187]
    v_mfma_f32_16x16x32_bf16 v[180:183], v[100:103], v[76:79], v[180:183]
    v_mfma_f32_16x16x32_bf16 v[176:179], v[96:99], v[76:79], v[176:179]
    ds_read_b128 v[76:79], v49 offset:6144
    s_waitcnt lgkmcnt(15)
    v_mfma_f32_16x16x32_bf16 v[192:195], v[96:99], v[80:83], v[192:195]
    v_mfma_f32_16x16x32_bf16 v[196:199], v[100:103], v[80:83], v[196:199]
    v_mfma_f32_16x16x32_bf16 v[200:203], v[104:107], v[80:83], v[200:203]
    v_mfma_f32_16x16x32_bf16 v[204:207], v[108:111], v[80:83], v[204:207]
    ds_read_b128 v[80:83], v49 offset:8192
    s_waitcnt lgkmcnt(15)
    v_mfma_f32_16x16x32_bf16 v[220:223], v[108:111], v[84:87], v[220:223]
    v_mfma_f32_16x16x32_bf16 v[216:219], v[104:107], v[84:87], v[216:219]
    v_mfma_f32_16x16x32_bf16 v[212:215], v[100:103], v[84:87], v[212:215]
    v_mfma_f32_16x16x32_bf16 v[208:211], v[96:99], v[84:87], v[208:211]
    ds_read_b128 v[84:87], v49 offset:10240
    s_waitcnt lgkmcnt(15)
    v_mfma_f32_16x16x32_bf16 v[224:227], v[96:99], v[88:91], v[224:227]
    v_mfma_f32_16x16x32_bf16 v[228:231], v[100:103], v[88:91], v[228:231]
    v_mfma_f32_16x16x32_bf16 v[232:235], v[104:107], v[88:91], v[232:235]
    v_mfma_f32_16x16x32_bf16 v[236:239], v[108:111], v[88:91], v[236:239]
    ds_read_b128 v[88:91], v49 offset:12288
    s_waitcnt lgkmcnt(15)
    v_mfma_f32_16x16x32_bf16 v[252:255], v[108:111], v[92:95], v[252:255]
    v_mfma_f32_16x16x32_bf16 v[248:251], v[104:107], v[92:95], v[248:251]
    v_mfma_f32_16x16x32_bf16 v[244:247], v[100:103], v[92:95], v[244:247]
    v_mfma_f32_16x16x32_bf16 v[240:243], v[96:99], v[92:95], v[240:243]
    ds_read_b128 v[92:95], v49 offset:14336
    s_waitcnt lgkmcnt(11)
    v_mfma_f32_16x16x32_bf16 v[128:131], v[112:115], v[64:67], v[128:131]
    v_mfma_f32_16x16x32_bf16 v[132:135], v[116:119], v[64:67], v[132:135]
    s_waitcnt lgkmcnt(9)
    v_mfma_f32_16x16x32_bf16 v[136:139], v[120:123], v[64:67], v[136:139]
    s_waitcnt lgkmcnt(7)
    v_mfma_f32_16x16x32_bf16 v[140:143], v[124:127], v[64:67], v[140:143]
    s_waitcnt lgkmcnt(6)
    v_mfma_f32_16x16x32_bf16 v[156:159], v[124:127], v[68:71], v[156:159]
    v_mfma_f32_16x16x32_bf16 v[152:155], v[120:123], v[68:71], v[152:155]
    v_mfma_f32_16x16x32_bf16 v[148:151], v[116:119], v[68:71], v[148:151]
    v_mfma_f32_16x16x32_bf16 v[144:147], v[112:115], v[68:71], v[144:147]
    v_xor_b32 v48, 0x10000, v48
    v_xor_b32 v49, 0x10000, v49
    v_xor_b32 v50, 0x10000, v50
    v_xor_b32 v51, 0x10000, v51
    v_xor_b32 v52, 0x10000, v52
    v_xor_b32 v53, 0x10000, v53
    s_waitcnt vmcnt(0) lgkmcnt(0)
    s_barrier
    ds_read_b128 v[64:67], v48 offset:0
    ds_read_b128 v[68:71], v48 offset:2048
    v_mfma_f32_16x16x32_bf16 v[160:163], v[112:115], v[72:75], v[160:163]
    ds_read_b64_tr_b16 v[96:97], v50 offset:0
    s_mov_b32 m0, s74
    s_add_u32 s74, s74, 16384
    s_bitset0_b32 s74, 17
    v_mfma_f32_16x16x32_bf16 v[164:167], v[116:119], v[72:75], v[164:167]
    ds_read_b64_tr_b16 v[98:99], v50 offset:1024
    buffer_load_dwordx4 v44, s[24:27], s71 offen offset:0 lds
    v_mfma_f32_16x16x32_bf16 v[168:171], v[120:123], v[72:75], v[168:171]
    ds_read_b64_tr_b16 v[100:101], v51 offset:0
    buffer_load_dwordx4 v45, s[24:27], s71 offen offset:1024 lds
    v_mfma_f32_16x16x32_bf16 v[172:175], v[124:127], v[72:75], v[172:175]
    ds_read_b64_tr_b16 v[102:103], v51 offset:1024
    buffer_load_dwordx4 v46, s[24:27], s71 offen offset:2048 lds
    ds_read_b128 v[72:75], v48 offset:4096
    v_mfma_f32_16x16x32_bf16 v[188:191], v[124:127], v[76:79], v[188:191]
    ds_read_b64_tr_b16 v[104:105], v52 offset:0
    buffer_load_dwordx4 v47, s[24:27], s71 offen offset:3072 lds
    v_mfma_f32_16x16x32_bf16 v[184:187], v[120:123], v[76:79], v[184:187]
    ds_read_b64_tr_b16 v[106:107], v52 offset:1024
    s_add_u32 s71, s71, 524288
    s_sub_u32 s75, s71, 5242880
    s_cselect_b32 s71, s71, s75
    v_mfma_f32_16x16x32_bf16 v[180:183], v[116:119], v[76:79], v[180:183]
    ds_read_b64_tr_b16 v[108:109], v53 offset:0
    s_mov_b32 m0, s74
    s_add_u32 s74, s74, 16384
    s_bitset0_b32 s74, 17
    v_mfma_f32_16x16x32_bf16 v[176:179], v[112:115], v[76:79], v[176:179]
    ds_read_b64_tr_b16 v[110:111], v53 offset:1024
    buffer_load_dwordx4 v44, s[24:27], s71 offen offset:0 lds
    ds_read_b128 v[76:79], v48 offset:6144
    v_mfma_f32_16x16x32_bf16 v[192:195], v[112:115], v[80:83], v[192:195]
    buffer_load_dwordx4 v45, s[24:27], s71 offen offset:1024 lds
    v_mfma_f32_16x16x32_bf16 v[196:199], v[116:119], v[80:83], v[196:199]
    buffer_load_dwordx4 v46, s[24:27], s71 offen offset:2048 lds
    v_mfma_f32_16x16x32_bf16 v[200:203], v[120:123], v[80:83], v[200:203]
    buffer_load_dwordx4 v47, s[24:27], s71 offen offset:3072 lds
    v_mfma_f32_16x16x32_bf16 v[204:207], v[124:127], v[80:83], v[204:207]
    s_add_u32 s71, s71, 524288
    s_sub_u32 s75, s71, 5242880
    s_cselect_b32 s71, s71, s75
    ds_read_b128 v[80:83], v48 offset:8192
    v_mfma_f32_16x16x32_bf16 v[220:223], v[124:127], v[84:87], v[220:223]
    s_mov_b32 m0, s74
    s_add_u32 s74, s74, 16384
    s_bitset0_b32 s74, 17
    v_mfma_f32_16x16x32_bf16 v[216:219], v[120:123], v[84:87], v[216:219]
    buffer_load_dwordx4 v44, s[24:27], s71 offen offset:0 lds
    v_mfma_f32_16x16x32_bf16 v[212:215], v[116:119], v[84:87], v[212:215]
    buffer_load_dwordx4 v45, s[24:27], s71 offen offset:1024 lds
    v_mfma_f32_16x16x32_bf16 v[208:211], v[112:115], v[84:87], v[208:211]
    buffer_load_dwordx4 v46, s[24:27], s71 offen offset:2048 lds
    ds_read_b128 v[84:87], v48 offset:10240
    v_mfma_f32_16x16x32_bf16 v[224:227], v[112:115], v[88:91], v[224:227]
    buffer_load_dwordx4 v47, s[24:27], s71 offen offset:3072 lds
    v_mfma_f32_16x16x32_bf16 v[228:231], v[116:119], v[88:91], v[228:231]
    s_add_u32 s71, s71, 524288
    s_sub_u32 s75, s71, 5242880
    s_cselect_b32 s71, s71, s75
    v_mfma_f32_16x16x32_bf16 v[232:235], v[120:123], v[88:91], v[232:235]
    s_mov_b32 m0, s74
    s_add_u32 s74, s74, 16384
    s_bitset0_b32 s74, 17
    v_mfma_f32_16x16x32_bf16 v[236:239], v[124:127], v[88:91], v[236:239]
    buffer_load_dwordx4 v44, s[24:27], s71 offen offset:0 lds
    ds_read_b128 v[88:91], v48 offset:12288
    v_mfma_f32_16x16x32_bf16 v[252:255], v[124:127], v[92:95], v[252:255]
    buffer_load_dwordx4 v45, s[24:27], s71 offen offset:1024 lds
    v_mfma_f32_16x16x32_bf16 v[248:251], v[120:123], v[92:95], v[248:251]
    buffer_load_dwordx4 v46, s[24:27], s71 offen offset:2048 lds
    v_mfma_f32_16x16x32_bf16 v[244:247], v[116:119], v[92:95], v[244:247]
    buffer_load_dwordx4 v47, s[24:27], s71 offen offset:3072 lds
    v_mfma_f32_16x16x32_bf16 v[240:243], v[112:115], v[92:95], v[240:243]
    s_add_u32 s71, s71, 524288
    s_sub_u32 s75, s71, 5242880
    s_cselect_b32 s71, s71, s75
    ds_read_b128 v[92:95], v48 offset:14336
    s_add_u32 s65, s65, 1
    s_cmp_lt_u32 s65, 8
    s_cbranch_scc1 L_kloopB
    s_waitcnt lgkmcnt(0)
    s_nop 7
    v_cvt_pk_bf16_f32 v128, v128, v129
    v_cvt_pk_bf16_f32 v129, v130, v131
    v_cvt_pk_bf16_f32 v130, v132, v133
    v_cvt_pk_bf16_f32 v131, v134, v135
    v_cvt_pk_bf16_f32 v132, v136, v137
    v_cvt_pk_bf16_f32 v133, v138, v139
    v_cvt_pk_bf16_f32 v134, v140, v141
    v_cvt_pk_bf16_f32 v135, v142, v143
    v_cvt_pk_bf16_f32 v136, v144, v145
    v_cvt_pk_bf16_f32 v137, v146, v147
    v_cvt_pk_bf16_f32 v138, v148, v149
    v_cvt_pk_bf16_f32 v139, v150, v151
    v_cvt_pk_bf16_f32 v140, v152, v153
    v_cvt_pk_bf16_f32 v141, v154, v155
    v_cvt_pk_bf16_f32 v142, v156, v157
    v_cvt_pk_bf16_f32 v143, v158, v159
    v_cvt_pk_bf16_f32 v144, v160, v161
    v_cvt_pk_bf16_f32 v145, v162, v163
    v_cvt_pk_bf16_f32 v146, v164, v165
    v_cvt_pk_bf16_f32 v147, v166, v167
    v_cvt_pk_bf16_f32 v148, v168, v169
    v_cvt_pk_bf16_f32 v149, v170, v171
    v_cvt_pk_bf16_f32 v150, v172, v173
    v_cvt_pk_bf16_f32 v151, v174, v175
    v_cvt_pk_bf16_f32 v152, v176, v177
    v_cvt_pk_bf16_f32 v153, v178, v179
    v_cvt_pk_bf16_f32 v154, v180, v181
    v_cvt_pk_bf16_f32 v155, v182, v183
    v_cvt_pk_bf16_f32 v156, v184, v185
    v_cvt_pk_bf16_f32 v157, v186, v187
    v_cvt_pk_bf16_f32 v158, v188, v189
    v_cvt_pk_bf16_f32 v159, v190, v191
    v_cvt_pk_bf16_f32 v160, v192, v193
    v_cvt_pk_bf16_f32 v161, v194, v195
    v_cvt_pk_bf16_f32 v162, v196, v197
    v_cvt_pk_bf16_f32 v163, v198, v199
    v_cvt_pk_bf16_f32 v164, v200, v201
    v_cvt_pk_bf16_f32 v165, v202, v203
    v_cvt_pk_bf16_f32 v166, v204, v205
    v_cvt_pk_bf16_f32 v167, v206, v207
    v_cvt_pk_bf16_f32 v168, v208, v209
    v_cvt_pk_bf16_f32 v169, v210, v211
    v_cvt_pk_bf16_f32 v170, v212, v213
    v_cvt_pk_bf16_f32 v171, v214, v215
    v_cvt_pk_bf16_f32 v172, v216, v217
    v_cvt_pk_bf16_f32 v173, v218, v219
    v_cvt_pk_bf16_f32 v174, v220, v221
    v_cvt_pk_bf16_f32 v175, v222, v223
    v_cvt_pk_bf16_f32 v176, v224, v225
    v_cvt_pk_bf16_f32 v177, v226, v227
    v_cvt_pk_bf16_f32 v178, v228, v229
    v_cvt_pk_bf16_f32 v179, v230, v231
    v_cvt_pk_bf16_f32 v180, v232, v233
    v_cvt_pk_bf16_f32 v181, v234, v235
    v_cvt_pk_bf16_f32 v182, v236, v237
    v_cvt_pk_bf16_f32 v183, v238, v239
    v_cvt_pk_bf16_f32 v184, v240, v241
    v_cvt_pk_bf16_f32 v185, v242, v243
    v_cvt_pk_bf16_f32 v186, v244, v245
    v_cvt_pk_bf16_f32 v187, v246, v247
    v_cvt_pk_bf16_f32 v188, v248, v249
    v_cvt_pk_bf16_f32 v189, v250, v251
    v_cvt_pk_bf16_f32 v190, v252, v253
    v_cvt_pk_bf16_f32 v191, v254, v255
    s_waitcnt vmcnt(16)
    s_branch L_q
L_hook:
    s_cmp_eq_u32 s65, 1
    s_cbranch_scc1 L_hook1
    s_cmp_eq_u32 s65, 2
    s_cbranch_scc1 L_hook2
    s_cmp_eq_u32 s65, 4
    s_cbranch_scc1 L_hook4
    s_cmp_eq_u32 s65, 6
    s_cbranch_scc1 L_hook6
    s_cmp_lg_u32 s65, 7
    s_cbranch_scc1 L_hook_back
    buffer_load_dwordx4 v[16:19], v13, s[8:11], s84 offen offset:0 sc1
    buffer_load_dwordx4 v[20:23], v12, s[8:11], s84 offen offset:0 sc1
    buffer_load_dwordx4 v[24:27], v13, s[8:11], s84 offen offset:1024 sc1
    buffer_load_dwordx4 v[28:31], v12, s[8:11], s84 offen offset:1024 sc1
    buffer_load_dwordx4 v[32:35], v13, s[8:11], s84 offen offset:2048 sc1
    buffer_load_dwordx4 v[36:39], v12, s[8:11], s84 offen offset:2048 sc1
    s_branch L_hook_back
L_hook1:
    s_cmp_ge_u32 s76, 2
    s_cbranch_scc1 L_tch_1a
    s_and_b32 s6, s4, 3
    s_lshl_b32 s6, s6, 19
    s_lshl_b32 s7, s5, 15
    s_add_u32 s6, s6, s7
    s_lshl_b32 s7, s76, 7
    s_add_u32 s6, s6, s7
    s_add_u32 s6, s6, 512
    v_lshrrev_b32 v6, 1, v1
    v_lshlrev_b32 v6, 10, v6
    v_and_b32 v7, 1, v1
    v_lshl_add_u32 v6, v7, 6, v6
    buffer_load_dword v11, v6, s[12:15], s6 offen
    s_add_u32 s6, s6, 262144
    buffer_load_dword v11, v6, s[12:15], s6 offen
    s_branch L_tch_1c
L_tch_1a:
    v_lshrrev_b32 v6, 5, v1
    v_lshlrev_b32 v6, 6, v6
    v_bfe_u32 v7, v1, 2, 3
    v_add_u32 v6, v6, v7
    v_lshlrev_b32 v6, 13, v6
    v_and_b32 v7, 3, v1
    v_lshl_add_u32 v6, v7, 6, v6
    s_lshl_b32 s6, s4, 8
    s_lshl_b32 s7, s5, 16
    s_add_u32 s6, s6, s7
    s_add_u32 s6, s6, 2097152
    s_cmp_lg_u32 s76, 2
    s_cbranch_scc1 L_tch_1b
    buffer_load_dword v11, v6, s[16:19], s6 offen nt
    s_branch L_tch_1c
L_tch_1b:
    buffer_load_dword v11, v6, s[20:23], s6 offen nt
L_tch_1c:
    s_branch L_hook_back
L_hook2:
    s_lshr_b32 s72, s2, 1
    s_mul_i32 s72, s72, 20480
    s_and_b32 s7, s2, 1
    s_lshl_b32 s7, s7, 7
    s_add_u32 s72, s72, s7
    v_add_u32 v2, -256, v0
    v_lshrrev_b32 v3, 3, v2
    v_and_b32 v4, 7, v2
    v_mul_u32_u24 v5, 1280, v4
    v_lshl_add_u32 v5, v3, 4, v5
    v_add_u32 v5, 131072, v5
    ds_read_b128 v[16:19], v5
    v_lshlrev_b32 v5, 8, v3
    v_lshl_add_u32 v6, v4, 4, v5
    v_add_u32 v2, 0, v0
    v_lshrrev_b32 v3, 3, v2
    v_and_b32 v4, 7, v2
    v_mul_u32_u24 v5, 1280, v4
    v_lshl_add_u32 v5, v3, 4, v5
    v_add_u32 v5, 131072, v5
    ds_read_b128 v[24:27], v5
    v_lshlrev_b32 v5, 8, v3
    v_lshl_add_u32 v7, v4, 4, v5
    v_add_u32 v2, 256, v0
    v_lshrrev_b32 v3, 3, v2
    v_and_b32 v4, 7, v2
    v_mul_u32_u24 v5, 1280, v4
    v_lshl_add_u32 v5, v3, 4, v5
    v_add_u32 v5, 131072, v5
    ds_read_b128 v[32:35], v5
    v_lshlrev_b32 v5, 8, v3
    v_lshl_add_u32 v8, v4, 4, v5
    s_waitcnt lgkmcnt(0)
    buffer_store_dwordx4 v[16:19], v6, s[8:11], s72 offen sc1
    buffer_store_dwordx4 v[24:27], v7, s[8:11], s72 offen sc1
    s_cmp_ge_u32 s3, 6
    s_cbranch_scc1 L_lns
    buffer_store_dwordx4 v[32:35], v8, s[8:11], s72 offen sc1
L_lns:
    s_cmp_lt_u32 s3, 6
    s_cbranch_scc1 L_zd
    v_mov_b64 v[36:37], 0
    v_mov_b64 v[38:39], 0
    v_lshrrev_b32 v2, 3, v1
    s_cmp_eq_u32 s3, 6
    s_cbranch_scc1 L_z6
    s_lshl_b32 s6, s5, 2
    s_sub_u32 s7, 56, s6
    v_mov_b32 v3, s6
    v_mov_b32 v4, s7
    v_cmp_gt_u32 vcc, 4, v2
    s_lshl_b32 s6, s4, 7
    s_add_u32 s6, s6, 3932160
    v_cndmask_b32 v3, v4, v3, vcc
    v_add_u32 v3, v3, v2
    v_lshl_add_u32 v3, v3, 12, s6
    s_branch L_z7
L_z6:
    v_mov_b32 v3, 0x5000000
    s_lshl_b32 s6, s4, 3
    s_add_u32 s6, s6, s5
    s_lshl_b32 s6, s6, 5
    s_add_u32 s6, s6, s3
    s_lshl_b32 s6, s6, 2
    s_add_u32 s6, s6, 3866624
    s_andn2_b32 s6, s6, 127
    v_cmp_eq_u32 vcc, 0, v2
    v_mov_b32 v4, s6
    s_nop 0
    v_cndmask_b32 v3, v3, v4, vcc
    s_lshl_b32 s6, s61, 5
    s_add_u32 s6, s6, s3
    s_lshl_b32 s6, s6, 2
    s_add_u32 s6, s6, 15859712
    s_andn2_b32 s6, s6, 127
    v_cmp_eq_u32 vcc, 1, v2
    v_mov_b32 v4, s6
    s_nop 0
    v_cndmask_b32 v3, v3, v4, vcc
    s_lshl_b32 s6, s5, 5
    s_add_u32 s6, s6, s4
    s_lshl_b32 s6, s6, 5
    s_add_u32 s6, s6, s3
    s_lshl_b32 s6, s6, 2
    s_add_u32 s6, s6, 3899392
    s_andn2_b32 s6, s6, 127
    v_cmp_eq_u32 vcc, 2, v2
    v_mov_b32 v4, s6
    s_nop 0
    v_cndmask_b32 v3, v3, v4, vcc
    s_and_b32 s6, s4, 7
    s_lshl_b32 s7, s5, 3
    s_add_u32 s6, s6, s7
    s_lshr_b32 s7, s4, 3
    s_add_u32 s7, s7, 0
    s_add_u32 s7, s7, 1
    s_and_b32 s7, s7, 3
    s_lshl_b32 s6, s6, 2
    s_add_u32 s6, s6, s7
    s_mul_i32 s6, s6, 3
    s_add_u32 s6, s6, 0
    s_lshl_b32 s6, s6, 5
    s_add_u32 s6, s6, s3
    s_lshl_b32 s6, s6, 2
    s_add_u32 s6, s6, 15728640
    s_andn2_b32 s6, s6, 127
    v_cmp_eq_u32 vcc, 3, v2
    v_mov_b32 v4, s6
    s_nop 0
    v_cndmask_b32 v3, v3, v4, vcc
    s_and_b32 s6, s4, 7
    s_lshl_b32 s7, s5, 3
    s_add_u32 s6, s6, s7
    s_lshr_b32 s7, s4, 3
    s_add_u32 s7, s7, 1
    s_add_u32 s7, s7, 1
    s_and_b32 s7, s7, 3
    s_lshl_b32 s6, s6, 2
    s_add_u32 s6, s6, s7
    s_mul_i32 s6, s6, 3
    s_add_u32 s6, s6, 1
    s_lshl_b32 s6, s6, 5
    s_add_u32 s6, s6, s3
    s_lshl_b32 s6, s6, 2
    s_add_u32 s6, s6, 15728640
    s_andn2_b32 s6, s6, 127
    v_cmp_eq_u32 vcc, 4, v2
    v_mov_b32 v4, s6
    s_nop 0
    v_cndmask_b32 v3, v3, v4, vcc
    s_and_b32 s6, s4, 7
    s_lshl_b32 s7, s5, 3
    s_add_u32 s6, s6, s7
    s_lshr_b32 s7, s4, 3
    s_add_u32 s7, s7, 2
    s_add_u32 s7, s7, 1
    s_and_b32 s7, s7, 3
    s_lshl_b32 s6, s6, 2
    s_add_u32 s6, s6, s7
    s_mul_i32 s6, s6, 3
    s_add_u32 s6, s6, 2
    s_lshl_b32 s6, s6, 5
    s_add_u32 s6, s6, s3
    s_lshl_b32 s6, s6, 2
    s_add_u32 s6, s6, 15728640
    s_andn2_b32 s6, s6, 127
    v_cmp_eq_u32 vcc, 5, v2
    v_mov_b32 v4, s6
    s_nop 0
    v_cndmask_b32 v3, v3, v4, vcc
    s_mov_b32 s6, 0x5000000
    s_cmp_eq_u32 s2, 31
    s_cmov_b32 s6, 3801088
    s_andn2_b32 s6, s6, 127
    v_cmp_eq_u32 vcc, 6, v2
    v_mov_b32 v4, s6
    s_nop 0
    v_cndmask_b32 v3, v3, v4, vcc
    s_lshl_b32 s6, s2, 7
    s_add_u32 s6, s6, 2621440
    s_andn2_b32 s6, s6, 127
    v_cmp_eq_u32 vcc, 7, v2
    v_mov_b32 v4, s6
    s_nop 0
    v_cndmask_b32 v3, v3, v4, vcc
    v_add_u32 v4, 160896, v13
    s_mov_b32 exec_lo, 0
    s_mov_b32 exec_hi, 0x03000000
    ds_read_b128 v[36:39], v4
    s_mov_b64 exec, -1
    s_waitcnt lgkmcnt(0)
L_z7:
    v_and_b32 v2, 7, v1
    v_lshl_add_u32 v3, v2, 4, v3
    buffer_store_dwordx4 v[36:39], v3, s[8:11], 0 offen sc1
L_zd:
    s_cmp_ge_u32 s76, 2
    s_cbranch_scc1 L_tch_2a
    s_and_b32 s6, s4, 3
    s_lshl_b32 s6, s6, 19
    s_lshl_b32 s7, s5, 15
    s_add_u32 s6, s6, s7
    s_lshl_b32 s7, s76, 7
    s_add_u32 s6, s6, s7
    s_add_u32 s6, s6, 768
    v_lshrrev_b32 v6, 1, v1
    v_lshlrev_b32 v6, 10, v6
    v_and_b32 v7, 1, v1
    v_lshl_add_u32 v6, v7, 6, v6
    buffer_load_dword v11, v6, s[12:15], s6 offen
    s_add_u32 s6, s6, 262144
    buffer_load_dword v11, v6, s[12:15], s6 offen
    s_branch L_tch_2c
L_tch_2a:
    v_lshrrev_b32 v6, 5, v1
    v_lshlrev_b32 v6, 6, v6
    v_bfe_u32 v7, v1, 2, 3
    v_add_u32 v6, v6, v7
    v_lshlrev_b32 v6, 13, v6
    v_and_b32 v7, 3, v1
    v_lshl_add_u32 v6, v7, 6, v6
    s_lshl_b32 s6, s4, 8
    s_lshl_b32 s7, s5, 16
    s_add_u32 s6, s6, s7
    s_add_u32 s6, s6, 3145728
    s_cmp_lg_u32 s76, 2
    s_cbranch_scc1 L_tch_2b
    buffer_load_dword v11, v6, s[16:19], s6 offen nt
    s_branch L_tch_2c
L_tch_2b:
    buffer_load_dword v11, v6, s[20:23], s6 offen nt
L_tch_2c:
    s_branch L_hook_back
L_hook4:
    s_cmp_lg_u32 s3, 4
    s_cbranch_scc1 L_hook4b
    s_mov_b32 s28, s56
    s_mov_b32 s29, s57
    s_mov_b32 s30, 0x100
    s_mov_b32 s31, 0x20000
    v_mov_b32 v2, 1
    v_lshlrev_b32 v3, 8, v1
    s_and_b32 s6, s2, 31
    s_lshl_b32 s6, s6, 2
    buffer_atomic_add v2, v3, s[28:31], s6 offen offset:0 sc1
L_hook4b:
    s_lshl_b32 s74, s76, 12
    s_add_u32 s74, s74, 131072
    s_mov_b32 m0, s74
    s_add_u32 s74, s74, 16384
    buffer_load_dwordx4 v44, s[24:27], s71 offen offset:0 lds
    buffer_load_dwordx4 v45, s[24:27], s71 offen offset:1024 lds
    buffer_load_dwordx4 v46, s[24:27], s71 offen offset:2048 lds
    buffer_load_dwordx4 v47, s[24:27], s71 offen offset:3072 lds
    s_add_u32 s71, s71, 524288
    s_sub_u32 s75, s71, 5242880
    s_cselect_b32 s71, s71, s75
    s_mov_b32 m0, s74
    s_add_u32 s74, s74, 16384
    buffer_load_dwordx4 v44, s[24:27], s71 offen offset:0 lds
    buffer_load_dwordx4 v45, s[24:27], s71 offen offset:1024 lds
    buffer_load_dwordx4 v46, s[24:27], s71 offen offset:2048 lds
    buffer_load_dwordx4 v47, s[24:27], s71 offen offset:3072 lds
    s_add_u32 s71, s71, 524288
    s_sub_u32 s75, s71, 5242880
    s_cselect_b32 s71, s71, s75
    s_branch L_hook_back
L_hook6:
    s_cmp_lg_u32 s3, 5
    s_cbranch_scc1 L_hook_back
    s_mov_b32 s28, s56
    s_mov_b32 s29, s57
    s_mov_b32 s30, 0x100
    s_mov_b32 s31, 0x20000
    v_and_b32 v3, 31, v1
    v_lshlrev_b32 v3, 2, v3
    buffer_load_dword v62, v3, s[28:31], 0 offen offset:0 sc1
    s_branch L_hook_back
L_vpre:
    s_waitcnt vmcnt(0)
    s_lshl_b32 s6, s65, 4
    s_add_u32 s6, s6, s3
    s_cmp_lg_u32 s6, 0x65
    s_cbranch_scc1 L_vnow
    v_cmp_gt_u32 vcc, 8, v62
    s_cbranch_vccz L_cntok_3
    s_mov_b32 s28, s56
    s_mov_b32 s29, s57
    s_mov_b32 s30, 0x100
    s_mov_b32 s31, 0x20000
    v_and_b32 v3, 31, v1
    v_lshlrev_b32 v3, 2, v3
    s_mov_b32 s79, 262144
L_poll_4:
    buffer_load_dword v2, v3, s[28:31], 0 offen offset:0 sc1
    s_waitcnt vmcnt(0)
    v_cmp_gt_u32 vcc, 8, v2
    s_cbranch_vccz L_polldone_5
    s_sleep 8
    s_sub_u32 s79, s79, 1
    s_cmp_lg_u32 s79, 0
    s_cbranch_scc1 L_poll_4
L_polldone_5:
L_cntok_3:
    s_branch L_vnow
L_khook:
    s_cmp_lg_u32 s65, 7
    s_cbranch_scc1 L_khook_back
    buffer_load_dwordx4 v[16:19], v13, s[8:11], s84 offen offset:0 sc1
    buffer_load_dwordx4 v[20:23], v12, s[8:11], s84 offen offset:0 sc1
    buffer_load_dwordx4 v[24:27], v13, s[8:11], s84 offen offset:1024 sc1
    buffer_load_dwordx4 v[28:31], v12, s[8:11], s84 offen offset:1024 sc1
    buffer_load_dwordx4 v[32:35], v13, s[8:11], s84 offen offset:2048 sc1
    buffer_load_dwordx4 v[36:39], v12, s[8:11], s84 offen offset:2048 sc1
    s_branch L_khook_back
L_kv_v:
    ds_read_b128 v[64:67], v48 offset:0
    ds_read_b128 v[68:71], v48 offset:2048
    ds_read_b64_tr_b16 v[96:97], v50 offset:0
    ds_read_b64_tr_b16 v[98:99], v50 offset:1024
    ds_read_b64_tr_b16 v[100:101], v51 offset:0
    ds_read_b64_tr_b16 v[102:103], v51 offset:1024
    ds_read_b128 v[72:75], v48 offset:4096
    ds_read_b64_tr_b16 v[104:105], v52 offset:0
    ds_read_b64_tr_b16 v[106:107], v52 offset:1024
    ds_read_b64_tr_b16 v[108:109], v53 offset:0
    ds_read_b64_tr_b16 v[110:111], v53 offset:1024
    ds_read_b128 v[76:79], v48 offset:6144
    ds_read_b128 v[80:83], v48 offset:8192
    ds_read_b128 v[84:87], v48 offset:10240
    ds_read_b128 v[88:91], v48 offset:12288
    ds_read_b128 v[92:95], v48 offset:14336
    s_cmp_ge_u32 s76, 2
    s_cbranch_scc1 L_tch_6a
    s_and_b32 s6, s4, 3
    s_lshl_b32 s6, s6, 19
    s_lshl_b32 s7, s5, 15
    s_add_u32 s6, s6, s7
    s_lshl_b32 s7, s76, 7
    s_add_u32 s6, s6, s7
    s_add_u32 s6, s6, 256
    v_lshrrev_b32 v6, 1, v1
    v_lshlrev_b32 v6, 10, v6
    v_and_b32 v7, 1, v1
    v_lshl_add_u32 v6, v7, 6, v6
    buffer_load_dword v11, v6, s[12:15], s6 offen
    s_add_u32 s6, s6, 262144
    buffer_load_dword v11, v6, s[12:15], s6 offen
    s_branch L_tch_6c
L_tch_6a:
    v_lshrrev_b32 v6, 5, v1
    v_lshlrev_b32 v6, 6, v6
    v_bfe_u32 v7, v1, 2, 3
    v_add_u32 v6, v6, v7
    v_lshlrev_b32 v6, 13, v6
    v_and_b32 v7, 3, v1
    v_lshl_add_u32 v6, v7, 6, v6
    s_lshl_b32 s6, s4, 8
    s_lshl_b32 s7, s5, 16
    s_add_u32 s6, s6, s7
    s_add_u32 s6, s6, 1048576
    s_cmp_lg_u32 s76, 2
    s_cbranch_scc1 L_tch_6b
    buffer_load_dword v11, v6, s[16:19], s6 offen nt
    s_branch L_tch_6c
L_tch_6b:
    buffer_load_dword v11, v6, s[20:23], s6 offen nt
L_tch_6c:
.p2align 4
L_vloop:
    s_bitcmp1_b32 214, s65
    s_cbranch_scc1 L_hook
L_hook_back:
    s_waitcnt lgkmcnt(12)
    v_mfma_f32_16x16x32_bf16 v[128:131], v[64:67], v[96:99], v[128:131]
    ds_read_b64_tr_b16 v[112:113], v50 offset:8192
    s_waitcnt lgkmcnt(11)
    v_mfma_f32_16x16x32_bf16 v[132:135], v[64:67], v[100:103], v[132:135]
    ds_read_b64_tr_b16 v[114:115], v50 offset:9216
    s_waitcnt lgkmcnt(9)
    v_mfma_f32_16x16x32_bf16 v[136:139], v[64:67], v[104:107], v[136:139]
    ds_read_b64_tr_b16 v[116:117], v51 offset:8192
    s_waitcnt lgkmcnt(8)
    v_mfma_f32_16x16x32_bf16 v[140:143], v[64:67], v[108:111], v[140:143]
    ds_read_b64_tr_b16 v[118:119], v51 offset:9216
    ds_read_b128 v[64:67], v49 offset:0
    v_mfma_f32_16x16x32_bf16 v[156:159], v[68:71], v[108:111], v[156:159]
    ds_read_b64_tr_b16 v[120:121], v52 offset:8192
    v_mfma_f32_16x16x32_bf16 v[152:155], v[68:71], v[104:107], v[152:155]
    ds_read_b64_tr_b16 v[122:123], v52 offset:9216
    v_mfma_f32_16x16x32_bf16 v[148:151], v[68:71], v[100:103], v[148:151]
    ds_read_b64_tr_b16 v[124:125], v53 offset:8192
    v_mfma_f32_16x16x32_bf16 v[144:147], v[68:71], v[96:99], v[144:147]
    ds_read_b64_tr_b16 v[126:127], v53 offset:9216
    ds_read_b128 v[68:71], v49 offset:2048
    v_mfma_f32_16x16x32_bf16 v[160:163], v[72:75], v[96:99], v[160:163]
    v_mfma_f32_16x16x32_bf16 v[164:167], v[72:75], v[100:103], v[164:167]
    v_mfma_f32_16x16x32_bf16 v[168:171], v[72:75], v[104:107], v[168:171]
    v_mfma_f32_16x16x32_bf16 v[172:175], v[72:75], v[108:111], v[172:175]
    ds_read_b128 v[72:75], v49 offset:4096
    s_waitcnt lgkmcnt(15)
    v_mfma_f32_16x16x32_bf16 v[188:191], v[76:79], v[108:111], v[188:191]
    v_mfma_f32_16x16x32_bf16 v[184:187], v[76:79], v[104:107], v[184:187]
    v_mfma_f32_16x16x32_bf16 v[180:183], v[76:79], v[100:103], v[180:183]
    v_mfma_f32_16x16x32_bf16 v[176:179], v[76:79], v[96:99], v[176:179]
    ds_read_b128 v[76:79], v49 offset:6144
    s_waitcnt lgkmcnt(15)
    v_mfma_f32_16x16x32_bf16 v[192:195], v[80:83], v[96:99], v[192:195]
    v_mfma_f32_16x16x32_bf16 v[196:199], v[80:83], v[100:103], v[196:199]
    v_mfma_f32_16x16x32_bf16 v[200:203], v[80:83], v[104:107], v[200:203]
    v_mfma_f32_16x16x32_bf16 v[204:207], v[80:83], v[108:111], v[204:207]
    ds_read_b128 v[80:83], v49 offset:8192
    s_waitcnt lgkmcnt(15)
    v_mfma_f32_16x16x32_bf16 v[220:223], v[84:87], v[108:111], v[220:223]
    v_mfma_f32_16x16x32_bf16 v[216:219], v[84:87], v[104:107], v[216:219]
    v_mfma_f32_16x16x32_bf16 v[212:215], v[84:87], v[100:103], v[212:215]
    v_mfma_f32_16x16x32_bf16 v[208:211], v[84:87], v[96:99], v[208:211]
    ds_read_b128 v[84:87], v49 offset:10240
    s_waitcnt lgkmcnt(15)
    v_mfma_f32_16x16x32_bf16 v[224:227], v[88:91], v[96:99], v[224:227]
    v_mfma_f32_16x16x32_bf16 v[228:231], v[88:91], v[100:103], v[228:231]
    v_mfma_f32_16x16x32_bf16 v[232:235], v[88:91], v[104:107], v[232:235]
    v_mfma_f32_16x16x32_bf16 v[236:239], v[88:91], v[108:111], v[236:239]
    ds_read_b128 v[88:91], v49 offset:12288
    s_waitcnt lgkmcnt(15)
    v_mfma_f32_16x16x32_bf16 v[252:255], v[92:95], v[108:111], v[252:255]
    v_mfma_f32_16x16x32_bf16 v[248:251], v[92:95], v[104:107], v[248:251]
    v_mfma_f32_16x16x32_bf16 v[244:247], v[92:95], v[100:103], v[244:247]
    v_mfma_f32_16x16x32_bf16 v[240:243], v[92:95], v[96:99], v[240:243]
    ds_read_b128 v[92:95], v49 offset:14336
    s_waitcnt lgkmcnt(11)
    v_mfma_f32_16x16x32_bf16 v[128:131], v[64:67], v[112:115], v[128:131]
    v_mfma_f32_16x16x32_bf16 v[132:135], v[64:67], v[116:119], v[132:135]
    s_waitcnt lgkmcnt(9)
    v_mfma_f32_16x16x32_bf16 v[136:139], v[64:67], v[120:123], v[136:139]
    s_waitcnt lgkmcnt(7)
    v_mfma_f32_16x16x32_bf16 v[140:143], v[64:67], v[124:127], v[140:143]
    s_waitcnt lgkmcnt(6)
    v_mfma_f32_16x16x32_bf16 v[156:159], v[68:71], v[124:127], v[156:159]
    v_mfma_f32_16x16x32_bf16 v[152:155], v[68:71], v[120:123], v[152:155]
    v_mfma_f32_16x16x32_bf16 v[148:151], v[68:71], v[116:119], v[148:151]
    v_mfma_f32_16x16x32_bf16 v[144:147], v[68:71], v[112:115], v[144:147]
    v_xor_b32 v48, 0x10000, v48
    v_xor_b32 v49, 0x10000, v49
    v_xor_b32 v50, 0x10000, v50
    v_xor_b32 v51, 0x10000, v51
    v_xor_b32 v52, 0x10000, v52
    v_xor_b32 v53, 0x10000, v53
    s_bitcmp1_b32 72, s65
    s_cbranch_scc1 L_vpre
L_vnow:
    s_waitcnt lgkmcnt(0)
    s_barrier
    ds_read_b128 v[64:67], v48 offset:0
    ds_read_b128 v[68:71], v48 offset:2048
    v_mfma_f32_16x16x32_bf16 v[160:163], v[72:75], v[112:115], v[160:163]
    ds_read_b64_tr_b16 v[96:97], v50 offset:0
    v_mfma_f32_16x16x32_bf16 v[164:167], v[72:75], v[116:119], v[164:167]
    ds_read_b64_tr_b16 v[98:99], v50 offset:1024
    v_mfma_f32_16x16x32_bf16 v[168:171], v[72:75], v[120:123], v[168:171]
    ds_read_b64_tr_b16 v[100:101], v51 offset:0
    v_mfma_f32_16x16x32_bf16 v[172:175], v[72:75], v[124:127], v[172:175]
    ds_read_b64_tr_b16 v[102:103], v51 offset:1024
    ds_read_b128 v[72:75], v48 offset:4096
    v_mfma_f32_16x16x32_bf16 v[188:191], v[76:79], v[124:127], v[188:191]
    ds_read_b64_tr_b16 v[104:105], v52 offset:0
    v_mfma_f32_16x16x32_bf16 v[184:187], v[76:79], v[120:123], v[184:187]
    ds_read_b64_tr_b16 v[106:107], v52 offset:1024
    v_mfma_f32_16x16x32_bf16 v[180:183], v[76:79], v[116:119], v[180:183]
    ds_read_b64_tr_b16 v[108:109], v53 offset:0
    v_mfma_f32_16x16x32_bf16 v[176:179], v[76:79], v[112:115], v[176:179]
    ds_read_b64_tr_b16 v[110:111], v53 offset:1024
    ds_read_b128 v[76:79], v48 offset:6144
    v_mfma_f32_16x16x32_bf16 v[192:195], v[80:83], v[112:115], v[192:195]
    v_mfma_f32_16x16x32_bf16 v[196:199], v[80:83], v[116:119], v[196:199]
    v_mfma_f32_16x16x32_bf16 v[200:203], v[80:83], v[120:123], v[200:203]
    v_mfma_f32_16x16x32_bf16 v[204:207], v[80:83], v[124:127], v[204:207]
    ds_read_b128 v[80:83], v48 offset:8192
    v_mfma_f32_16x16x32_bf16 v[220:223], v[84:87], v[124:127], v[220:223]
    v_mfma_f32_16x16x32_bf16 v[216:219], v[84:87], v[120:123], v[216:219]
    v_mfma_f32_16x16x32_bf16 v[212:215], v[84:87], v[116:119], v[212:215]
    v_mfma_f32_16x16x32_bf16 v[208:211], v[84:87], v[112:115], v[208:211]
    ds_read_b128 v[84:87], v48 offset:10240
    v_mfma_f32_16x16x32_bf16 v[224:227], v[88:91], v[112:115], v[224:227]
    v_mfma_f32_16x16x32_bf16 v[228:231], v[88:91], v[116:119], v[228:231]
    v_mfma_f32_16x16x32_bf16 v[232:235], v[88:91], v[120:123], v[232:235]
    v_mfma_f32_16x16x32_bf16 v[236:239], v[88:91], v[124:127], v[236:239]
    ds_read_b128 v[88:91], v48 offset:12288
    v_mfma_f32_16x16x32_bf16 v[252:255], v[92:95], v[124:127], v[252:255]
    v_mfma_f32_16x16x32_bf16 v[248:251], v[92:95], v[120:123], v[248:251]
    v_mfma_f32_16x16x32_bf16 v[244:247], v[92:95], v[116:119], v[244:247]
    v_mfma_f32_16x16x32_bf16 v[240:243], v[92:95], v[112:115], v[240:243]
    ds_read_b128 v[92:95], v48 offset:14336
    s_add_u32 s65, s65, 1
    s_cmp_lt_u32 s65, 8
    s_cbranch_scc1 L_vloop
    s_waitcnt lgkmcnt(0)
    s_nop 7
    v_cvt_pk_bf16_f32 v128, v128, v129
    v_cvt_pk_bf16_f32 v129, v130, v131
    v_cvt_pk_bf16_f32 v130, v144, v145
    v_cvt_pk_bf16_f32 v131, v146, v147
    v_cvt_pk_bf16_f32 v132, v132, v133
    v_cvt_pk_bf16_f32 v133, v134, v135
    v_cvt_pk_bf16_f32 v134, v148, v149
    v_cvt_pk_bf16_f32 v135, v150, v151
    v_cvt_pk_bf16_f32 v136, v136, v137
    v_cvt_pk_bf16_f32 v137, v138, v139
    v_cvt_pk_bf16_f32 v138, v152, v153
    v_cvt_pk_bf16_f32 v139, v154, v155
    v_cvt_pk_bf16_f32 v140, v140, v141
    v_cvt_pk_bf16_f32 v141, v142, v143
    v_cvt_pk_bf16_f32 v142, v156, v157
    v_cvt_pk_bf16_f32 v143, v158, v159
    v_cvt_pk_bf16_f32 v144, v160, v161
    v_cvt_pk_bf16_f32 v145, v162, v163
    v_cvt_pk_bf16_f32 v146, v176, v177
    v_cvt_pk_bf16_f32 v147, v178, v179
    v_cvt_pk_bf16_f32 v148, v164, v165
    v_cvt_pk_bf16_f32 v149, v166, v167
    v_cvt_pk_bf16_f32 v150, v180, v181
    v_cvt_pk_bf16_f32 v151, v182, v183
    v_cvt_pk_bf16_f32 v152, v168, v169
    v_cvt_pk_bf16_f32 v153, v170, v171
    v_cvt_pk_bf16_f32 v154, v184, v185
    v_cvt_pk_bf16_f32 v155, v186, v187
    v_cvt_pk_bf16_f32 v156, v172, v173
    v_cvt_pk_bf16_f32 v157, v174, v175
    v_cvt_pk_bf16_f32 v158, v188, v189
    v_cvt_pk_bf16_f32 v159, v190, v191
    v_cvt_pk_bf16_f32 v160, v192, v193
    v_cvt_pk_bf16_f32 v161, v194, v195
    v_cvt_pk_bf16_f32 v162, v208, v209
    v_cvt_pk_bf16_f32 v163, v210, v211
    v_cvt_pk_bf16_f32 v164, v196, v197
    v_cvt_pk_bf16_f32 v165, v198, v199
    v_cvt_pk_bf16_f32 v166, v212, v213
    v_cvt_pk_bf16_f32 v167, v214, v215
    v_cvt_pk_bf16_f32 v168, v200, v201
    v_cvt_pk_bf16_f32 v169, v202, v203
    v_cvt_pk_bf16_f32 v170, v216, v217
    v_cvt_pk_bf16_f32 v171, v218, v219
    v_cvt_pk_bf16_f32 v172, v204, v205
    v_cvt_pk_bf16_f32 v173, v206, v207
    v_cvt_pk_bf16_f32 v174, v220, v221
    v_cvt_pk_bf16_f32 v175, v222, v223
    v_cvt_pk_bf16_f32 v176, v224, v225
    v_cvt_pk_bf16_f32 v177, v226, v227
    v_cvt_pk_bf16_f32 v178, v240, v241
    v_cvt_pk_bf16_f32 v179, v242, v243
    v_cvt_pk_bf16_f32 v180, v228, v229
    v_cvt_pk_bf16_f32 v181, v230, v231
    v_cvt_pk_bf16_f32 v182, v244, v245
    v_cvt_pk_bf16_f32 v183, v246, v247
    v_cvt_pk_bf16_f32 v184, v232, v233
    v_cvt_pk_bf16_f32 v185, v234, v235
    v_cvt_pk_bf16_f32 v186, v248, v249
    v_cvt_pk_bf16_f32 v187, v250, v251
    v_cvt_pk_bf16_f32 v188, v236, v237
    v_cvt_pk_bf16_f32 v189, v238, v239
    v_cvt_pk_bf16_f32 v190, v252, v253
    v_cvt_pk_bf16_f32 v191, v254, v255
    s_waitcnt vmcnt(0)
L_q:
    s_mov_b32 s28, s56
    s_mov_b32 s29, s57
    s_mov_b32 s30, 0x100
    s_mov_b32 s31, 0x20000
    s_lshl_b32 s6, s76, 13
    v_add_u32 v49, s6, v13
    s_lshl_b32 s6, s76, 12
    v_add_u32 v50, s6, v13
    s_lshl_b32 s77, s4, 20
    s_add_u32 s77, s77, 16777216
    s_mov_b32 s78, s100
    s_sub_u32 s101, s100, 131072
    s_mov_b32 s90, 0
    s_cmp_lt_u32 s3, 4
    s_cselect_b32 s89, 3, 2
    ds_read_b64_tr_b16 v[96:97], v54 offset:0
    ds_read_b64_tr_b16 v[98:99], v54 offset:1024
    ds_read_b64_tr_b16 v[100:101], v55 offset:0
    ds_read_b64_tr_b16 v[102:103], v55 offset:1024
    ds_read_b64_tr_b16 v[104:105], v56 offset:0
    ds_read_b64_tr_b16 v[106:107], v56 offset:1024
    ds_read_b64_tr_b16 v[108:109], v57 offset:0
    ds_read_b64_tr_b16 v[110:111], v57 offset:1024
    ds_read_b64_tr_b16 v[112:113], v58 offset:0
    ds_read_b64_tr_b16 v[114:115], v58 offset:1024
    ds_read_b64_tr_b16 v[116:117], v59 offset:0
    ds_read_b64_tr_b16 v[118:119], v59 offset:1024
    ds_read_b64_tr_b16 v[120:121], v60 offset:0
    ds_read_b64_tr_b16 v[122:123], v60 offset:1024
    ds_read_b64_tr_b16 v[124:125], v61 offset:0
    ds_read_b64_tr_b16 v[126:127], v61 offset:1024
    buffer_load_dwordx4 v[64:67], v13, s[8:11], s84 offen offset:3072 sc1
    buffer_load_dwordx4 v[68:71], v12, s[8:11], s84 offen offset:3072 sc1
    buffer_load_dwordx4 v[72:75], v13, s[8:11], s85 offen offset:0 sc1
    buffer_load_dwordx4 v[76:79], v12, s[8:11], s85 offen offset:0 sc1
    buffer_load_dwordx4 v[80:83], v13, s[8:11], s85 offen offset:1024 sc1
    buffer_load_dwordx4 v[84:87], v12, s[8:11], s85 offen offset:1024 sc1
    buffer_load_dwordx4 v[88:91], v13, s[8:11], s85 offen offset:2048 sc1
    buffer_load_dwordx4 v[92:95], v12, s[8:11], s85 offen offset:2048 sc1
    s_waitcnt lgkmcnt(14)
    v_mfma_f32_16x16x32_bf16 v[192:195], v[96:99], v[16:19], 0
    v_mfma_f32_16x16x32_bf16 v[196:199], v[96:99], v[20:23], 0
    ds_read_b64_tr_b16 v[96:97], v54 offset:8192
    s_waitcnt lgkmcnt(13)
    v_mfma_f32_16x16x32_bf16 v[204:207], v[100:103], v[20:23], 0
    ds_read_b64_tr_b16 v[98:99], v54 offset:9216
    v_mfma_f32_16x16x32_bf16 v[200:203], v[100:103], v[16:19], 0
    ds_read_b64_tr_b16 v[100:101], v55 offset:8192
    s_waitcnt lgkmcnt(13)
    v_mfma_f32_16x16x32_bf16 v[208:211], v[104:107], v[16:19], 0
    ds_read_b64_tr_b16 v[102:103], v55 offset:9216
    v_mfma_f32_16x16x32_bf16 v[212:215], v[104:107], v[20:23], 0
    ds_read_b64_tr_b16 v[104:105], v56 offset:8192
    s_waitcnt lgkmcnt(13)
    v_mfma_f32_16x16x32_bf16 v[220:223], v[108:111], v[20:23], 0
    ds_read_b64_tr_b16 v[106:107], v56 offset:9216
    buffer_store_dwordx4 v[128:131], v13, s[8:11], s67 offen sc1
    s_add_u32 s67, s67, 1024
    v_mfma_f32_16x16x32_bf16 v[216:219], v[108:111], v[16:19], 0
    ds_read_b64_tr_b16 v[108:109], v57 offset:8192
    s_waitcnt lgkmcnt(13)
    v_mfma_f32_16x16x32_bf16 v[224:227], v[112:115], v[16:19], 0
    ds_read_b64_tr_b16 v[110:111], v57 offset:9216
    v_mfma_f32_16x16x32_bf16 v[228:231], v[112:115], v[20:23], 0
    ds_read_b64_tr_b16 v[112:113], v58 offset:8192
    s_waitcnt lgkmcnt(13)
    v_mfma_f32_16x16x32_bf16 v[236:239], v[116:119], v[20:23], 0
    ds_read_b64_tr_b16 v[114:115], v58 offset:9216
    v_mfma_f32_16x16x32_bf16 v[232:235], v[116:119], v[16:19], 0
    ds_read_b64_tr_b16 v[116:117], v59 offset:8192
    s_waitcnt lgkmcnt(13)
    v_mfma_f32_16x16x32_bf16 v[240:243], v[120:123], v[16:19], 0
    ds_read_b64_tr_b16 v[118:119], v59 offset:9216
    v_mfma_f32_16x16x32_bf16 v[244:247], v[120:123], v[20:23], 0
    ds_read_b64_tr_b16 v[120:121], v60 offset:8192
    s_waitcnt lgkmcnt(13)
    v_mfma_f32_16x16x32_bf16 v[252:255], v[124:127], v[20:23], 0
    ds_read_b64_tr_b16 v[122:123], v60 offset:9216
    v_mfma_f32_16x16x32_bf16 v[248:251], v[124:127], v[16:19], 0
    ds_read_b64_tr_b16 v[124:125], v61 offset:8192
    ds_read_b64_tr_b16 v[126:127], v61 offset:9216
    buffer_load_dwordx4 v[16:19], v13, s[8:11], s85 offen offset:3072 sc1
    buffer_load_dwordx4 v[20:23], v12, s[8:11], s85 offen offset:3072 sc1
    s_waitcnt lgkmcnt(14)
    v_mfma_f32_16x16x32_bf16 v[192:195], v[96:99], v[24:27], v[192:195]
    v_mfma_f32_16x16x32_bf16 v[196:199], v[96:99], v[28:31], v[196:199]
    ds_read_b64_tr_b16 v[96:97], v54 offset:16384
    s_waitcnt lgkmcnt(13)
    v_mfma_f32_16x16x32_bf16 v[204:207], v[100:103], v[28:31], v[204:207]
    ds_read_b64_tr_b16 v[98:99], v54 offset:17408
    v_mfma_f32_16x16x32_bf16 v[200:203], v[100:103], v[24:27], v[200:203]
    ds_read_b64_tr_b16 v[100:101], v55 offset:16384
    s_waitcnt lgkmcnt(13)
    v_mfma_f32_16x16x32_bf16 v[208:211], v[104:107], v[24:27], v[208:211]
    ds_read_b64_tr_b16 v[102:103], v55 offset:17408
    v_mfma_f32_16x16x32_bf16 v[212:215], v[104:107], v[28:31], v[212:215]
    ds_read_b64_tr_b16 v[104:105], v56 offset:16384
    s_waitcnt lgkmcnt(13)
    v_mfma_f32_16x16x32_bf16 v[220:223], v[108:111], v[28:31], v[220:223]
    ds_read_b64_tr_b16 v[106:107], v56 offset:17408
    buffer_store_dwordx4 v[132:135], v13, s[8:11], s67 offen sc1
    s_add_u32 s67, s67, s68
    v_mfma_f32_16x16x32_bf16 v[216:219], v[108:111], v[24:27], v[216:219]
    ds_read_b64_tr_b16 v[108:109], v57 offset:16384
    s_waitcnt lgkmcnt(13)
    v_mfma_f32_16x16x32_bf16 v[224:227], v[112:115], v[24:27], v[224:227]
    ds_read_b64_tr_b16 v[110:111], v57 offset:17408
    v_mfma_f32_16x16x32_bf16 v[228:231], v[112:115], v[28:31], v[228:231]
    ds_read_b64_tr_b16 v[112:113], v58 offset:16384
    s_waitcnt lgkmcnt(13)
    v_mfma_f32_16x16x32_bf16 v[236:239], v[116:119], v[28:31], v[236:239]
    ds_read_b64_tr_b16 v[114:115], v58 offset:17408
    v_mfma_f32_16x16x32_bf16 v[232:235], v[116:119], v[24:27], v[232:235]
    ds_read_b64_tr_b16 v[116:117], v59 offset:16384
    s_waitcnt lgkmcnt(13)
    v_mfma_f32_16x16x32_bf16 v[240:243], v[120:123], v[24:27], v[240:243]
    ds_read_b64_tr_b16 v[118:119], v59 offset:17408
    v_mfma_f32_16x16x32_bf16 v[244:247], v[120:123], v[28:31], v[244:247]
    ds_read_b64_tr_b16 v[120:121], v60 offset:16384
    s_waitcnt lgkmcnt(13)
    v_mfma_f32_16x16x32_bf16 v[252:255], v[124:127], v[28:31], v[252:255]
    ds_read_b64_tr_b16 v[122:123], v60 offset:17408
    v_mfma_f32_16x16x32_bf16 v[248:251], v[124:127], v[24:27], v[248:251]
    ds_read_b64_tr_b16 v[124:125], v61 offset:16384
    ds_read_b64_tr_b16 v[126:127], v61 offset:17408
    buffer_load_dwordx4 v[24:27], v13, s[8:11], s86 offen offset:0 sc1
    buffer_load_dwordx4 v[28:31], v12, s[8:11], s86 offen offset:0 sc1
    s_waitcnt lgkmcnt(14)
    v_mfma_f32_16x16x32_bf16 v[192:195], v[96:99], v[32:35], v[192:195]
    v_mfma_f32_16x16x32_bf16 v[196:199], v[96:99], v[36:39], v[196:199]
    ds_read_b64_tr_b16 v[96:97], v54 offset:24576
    s_waitcnt lgkmcnt(13)
    v_mfma_f32_16x16x32_bf16 v[204:207], v[100:103], v[36:39], v[204:207]
    ds_read_b64_tr_b16 v[98:99], v54 offset:25600
    v_mfma_f32_16x16x32_bf16 v[200:203], v[100:103], v[32:35], v[200:203]
    ds_read_b64_tr_b16 v[100:101], v55 offset:24576
    s_waitcnt lgkmcnt(13)
    v_mfma_f32_16x16x32_bf16 v[208:211], v[104:107], v[32:35], v[208:211]
    ds_read_b64_tr_b16 v[102:103], v55 offset:25600
    v_mfma_f32_16x16x32_bf16 v[212:215], v[104:107], v[36:39], v[212:215]
    ds_read_b64_tr_b16 v[104:105], v56 offset:24576
    s_waitcnt lgkmcnt(13)
    v_mfma_f32_16x16x32_bf16 v[220:223], v[108:111], v[36:39], v[220:223]
    ds_read_b64_tr_b16 v[106:107], v56 offset:25600
    buffer_store_dwordx4 v[136:139], v13, s[8:11], s67 offen sc1
    s_add_u32 s67, s67, 1024
    v_mfma_f32_16x16x32_bf16 v[216:219], v[108:111], v[32:35], v[216:219]
    ds_read_b64_tr_b16 v[108:109], v57 offset:24576
    s_waitcnt lgkmcnt(13)
    v_mfma_f32_16x16x32_bf16 v[224:227], v[112:115], v[32:35], v[224:227]
    ds_read_b64_tr_b16 v[110:111], v57 offset:25600
    v_mfma_f32_16x16x32_bf16 v[228:231], v[112:115], v[36:39], v[228:231]
    ds_read_b64_tr_b16 v[112:113], v58 offset:24576
    s_waitcnt lgkmcnt(13)
    v_mfma_f32_16x16x32_bf16 v[236:239], v[116:119], v[36:39], v[236:239]
    ds_read_b64_tr_b16 v[114:115], v58 offset:25600
    v_mfma_f32_16x16x32_bf16 v[232:235], v[116:119], v[32:35], v[232:235]
    ds_read_b64_tr_b16 v[116:117], v59 offset:24576
    s_waitcnt lgkmcnt(13)
    v_mfma_f32_16x16x32_bf16 v[240:243], v[120:123], v[32:35], v[240:243]
    ds_read_b64_tr_b16 v[118:119], v59 offset:25600
    v_mfma_f32_16x16x32_bf16 v[244:247], v[120:123], v[36:39], v[244:247]
    ds_read_b64_tr_b16 v[120:121], v60 offset:24576
    s_waitcnt lgkmcnt(13)
    v_mfma_f32_16x16x32_bf16 v[252:255], v[124:127], v[36:39], v[252:255]
    ds_read_b64_tr_b16 v[122:123], v60 offset:25600
    v_mfma_f32_16x16x32_bf16 v[248:251], v[124:127], v[32:35], v[248:251]
    ds_read_b64_tr_b16 v[124:125], v61 offset:24576
    ds_read_b64_tr_b16 v[126:127], v61 offset:25600
    buffer_load_dwordx4 v[32:35], v13, s[8:11], s86 offen offset:1024 sc1
    buffer_load_dwordx4 v[36:39], v12, s[8:11], s86 offen offset:1024 sc1
    s_waitcnt vmcnt(15)
    s_waitcnt lgkmcnt(14)
    v_mfma_f32_16x16x32_bf16 v[192:195], v[96:99], v[64:67], v[192:195]
    v_add_u32 v54, s101, v54
    v_mfma_f32_16x16x32_bf16 v[196:199], v[96:99], v[68:71], v[196:199]
    ds_read_b64_tr_b16 v[96:97], v54 offset:0
    s_waitcnt lgkmcnt(13)
    v_mfma_f32_16x16x32_bf16 v[204:207], v[100:103], v[68:71], v[204:207]
    ds_read_b64_tr_b16 v[98:99], v54 offset:1024
    v_add_u32 v55, s101, v55
    v_mfma_f32_16x16x32_bf16 v[200:203], v[100:103], v[64:67], v[200:203]
    ds_read_b64_tr_b16 v[100:101], v55 offset:0
    s_waitcnt lgkmcnt(13)
    v_mfma_f32_16x16x32_bf16 v[208:211], v[104:107], v[64:67], v[208:211]
    ds_read_b64_tr_b16 v[102:103], v55 offset:1024
    v_add_u32 v56, s101, v56
    v_mfma_f32_16x16x32_bf16 v[212:215], v[104:107], v[68:71], v[212:215]
    ds_read_b64_tr_b16 v[104:105], v56 offset:0
    s_waitcnt lgkmcnt(13)
    v_mfma_f32_16x16x32_bf16 v[220:223], v[108:111], v[68:71], v[220:223]
    ds_read_b64_tr_b16 v[106:107], v56 offset:1024
    v_add_u32 v57, s101, v57
    buffer_store_dwordx4 v[140:143], v13, s[8:11], s67 offen sc1
    s_add_u32 s67, s67, s69
    v_mfma_f32_16x16x32_bf16 v[216:219], v[108:111], v[64:67], v[216:219]
    ds_read_b64_tr_b16 v[108:109], v57 offset:0
    s_waitcnt lgkmcnt(13)
    v_mfma_f32_16x16x32_bf16 v[224:227], v[112:115], v[64:67], v[224:227]
    ds_read_b64_tr_b16 v[110:111], v57 offset:1024
    v_add_u32 v58, s101, v58
    v_mfma_f32_16x16x32_bf16 v[228:231], v[112:115], v[68:71], v[228:231]
    ds_read_b64_tr_b16 v[112:113], v58 offset:0
    s_waitcnt lgkmcnt(13)
    v_mfma_f32_16x16x32_bf16 v[236:239], v[116:119], v[68:71], v[236:239]
    ds_read_b64_tr_b16 v[114:115], v58 offset:1024
    v_add_u32 v59, s101, v59
    v_mfma_f32_16x16x32_bf16 v[232:235], v[116:119], v[64:67], v[232:235]
    ds_read_b64_tr_b16 v[116:117], v59 offset:0
    s_waitcnt lgkmcnt(13)
    v_mfma_f32_16x16x32_bf16 v[240:243], v[120:123], v[64:67], v[240:243]
    ds_read_b64_tr_b16 v[118:119], v59 offset:1024
    v_add_u32 v60, s101, v60
    v_mfma_f32_16x16x32_bf16 v[244:247], v[120:123], v[68:71], v[244:247]
    ds_read_b64_tr_b16 v[120:121], v60 offset:0
    s_waitcnt lgkmcnt(13)
    v_mfma_f32_16x16x32_bf16 v[252:255], v[124:127], v[68:71], v[252:255]
    ds_read_b64_tr_b16 v[122:123], v60 offset:1024
    v_add_u32 v61, s101, v61
    v_mfma_f32_16x16x32_bf16 v[248:251], v[124:127], v[64:67], v[248:251]
    ds_read_b64_tr_b16 v[124:125], v61 offset:0
    ds_read_b64_tr_b16 v[126:127], v61 offset:1024
    buffer_load_dwordx4 v[64:67], v13, s[8:11], s86 offen offset:2048 sc1
    buffer_load_dwordx4 v[68:71], v12, s[8:11], s86 offen offset:2048 sc1
    s_waitcnt vmcnt(16)
    s_waitcnt lgkmcnt(14)
    v_mfma_f32_16x16x32_bf16 v[192:195], v[96:99], v[72:75], v[192:195]
    v_mfma_f32_16x16x32_bf16 v[196:199], v[96:99], v[76:79], v[196:199]
    ds_read_b64_tr_b16 v[96:97], v54 offset:8192
    s_waitcnt lgkmcnt(13)
    v_mfma_f32_16x16x32_bf16 v[204:207], v[100:103], v[76:79], v[204:207]
    ds_read_b64_tr_b16 v[98:99], v54 offset:9216
    v_mfma_f32_16x16x32_bf16 v[200:203], v[100:103], v[72:75], v[200:203]
    ds_read_b64_tr_b16 v[100:101], v55 offset:8192
    s_waitcnt lgkmcnt(13)
    v_mfma_f32_16x16x32_bf16 v[208:211], v[104:107], v[72:75], v[208:211]
    ds_read_b64_tr_b16 v[102:103], v55 offset:9216
    v_mfma_f32_16x16x32_bf16 v[212:215], v[104:107], v[76:79], v[212:215]
    ds_read_b64_tr_b16 v[104:105], v56 offset:8192
    s_waitcnt lgkmcnt(13)
    v_mfma_f32_16x16x32_bf16 v[220:223], v[108:111], v[76:79], v[220:223]
    ds_read_b64_tr_b16 v[106:107], v56 offset:9216
    v_mfma_f32_16x16x32_bf16 v[216:219], v[108:111], v[72:75], v[216:219]
    ds_read_b64_tr_b16 v[108:109], v57 offset:8192
    s_waitcnt lgkmcnt(13)
    v_mfma_f32_16x16x32_bf16 v[224:227], v[112:115], v[72:75], v[224:227]
    ds_read_b64_tr_b16 v[110:111], v57 offset:9216
    v_mfma_f32_16x16x32_bf16 v[228:231], v[112:115], v[76:79], v[228:231]
    ds_read_b64_tr_b16 v[112:113], v58 offset:8192
    s_waitcnt lgkmcnt(13)
    v_mfma_f32_16x16x32_bf16 v[236:239], v[116:119], v[76:79], v[236:239]
    ds_read_b64_tr_b16 v[114:115], v58 offset:9216
    v_mfma_f32_16x16x32_bf16 v[232:235], v[116:119], v[72:75], v[232:235]
    ds_read_b64_tr_b16 v[116:117], v59 offset:8192
    s_waitcnt lgkmcnt(13)
    v_mfma_f32_16x16x32_bf16 v[240:243], v[120:123], v[72:75], v[240:243]
    ds_read_b64_tr_b16 v[118:119], v59 offset:9216
    v_mfma_f32_16x16x32_bf16 v[244:247], v[120:123], v[76:79], v[244:247]
    ds_read_b64_tr_b16 v[120:121], v60 offset:8192
    s_waitcnt lgkmcnt(13)
    v_mfma_f32_16x16x32_bf16 v[252:255], v[124:127], v[76:79], v[252:255]
    ds_read_b64_tr_b16 v[122:123], v60 offset:9216
    v_mfma_f32_16x16x32_bf16 v[248:251], v[124:127], v[72:75], v[248:251]
    ds_read_b64_tr_b16 v[124:125], v61 offset:8192
    ds_read_b64_tr_b16 v[126:127], v61 offset:9216
    buffer_load_dwordx4 v[72:75], v13, s[8:11], s86 offen offset:3072 sc1
    buffer_load_dwordx4 v[76:79], v12, s[8:11], s86 offen offset:3072 sc1
    s_waitcnt vmcnt(16)
    s_waitcnt lgkmcnt(14)
    v_mfma_f32_16x16x32_bf16 v[192:195], v[96:99], v[80:83], v[192:195]
    v_mfma_f32_16x16x32_bf16 v[196:199], v[96:99], v[84:87], v[196:199]
    ds_read_b64_tr_b16 v[96:97], v54 offset:16384
    s_waitcnt lgkmcnt(13)
    v_mfma_f32_16x16x32_bf16 v[204:207], v[100:103], v[84:87], v[204:207]
    ds_read_b64_tr_b16 v[98:99], v54 offset:17408
    v_mfma_f32_16x16x32_bf16 v[200:203], v[100:103], v[80:83], v[200:203]
    ds_read_b64_tr_b16 v[100:101], v55 offset:16384
    s_waitcnt lgkmcnt(13)
    v_mfma_f32_16x16x32_bf16 v[208:211], v[104:107], v[80:83], v[208:211]
    ds_read_b64_tr_b16 v[102:103], v55 offset:17408
    v_mfma_f32_16x16x32_bf16 v[212:215], v[104:107], v[84:87], v[212:215]
    ds_read_b64_tr_b16 v[104:105], v56 offset:16384
    s_waitcnt lgkmcnt(13)
    v_mfma_f32_16x16x32_bf16 v[220:223], v[108:111], v[84:87], v[220:223]
    ds_read_b64_tr_b16 v[106:107], v56 offset:17408
    v_mfma_f32_16x16x32_bf16 v[216:219], v[108:111], v[80:83], v[216:219]
    ds_read_b64_tr_b16 v[108:109], v57 offset:16384
    s_waitcnt lgkmcnt(13)
    v_mfma_f32_16x16x32_bf16 v[224:227], v[112:115], v[80:83], v[224:227]
    ds_read_b64_tr_b16 v[110:111], v57 offset:17408
    v_mfma_f32_16x16x32_bf16 v[228:231], v[112:115], v[84:87], v[228:231]
    ds_read_b64_tr_b16 v[112:113], v58 offset:16384
    s_waitcnt lgkmcnt(13)
    v_mfma_f32_16x16x32_bf16 v[236:239], v[116:119], v[84:87], v[236:239]
    ds_read_b64_tr_b16 v[114:115], v58 offset:17408
    v_mfma_f32_16x16x32_bf16 v[232:235], v[116:119], v[80:83], v[232:235]
    ds_read_b64_tr_b16 v[116:117], v59 offset:16384
    s_waitcnt lgkmcnt(13)
    v_mfma_f32_16x16x32_bf16 v[240:243], v[120:123], v[80:83], v[240:243]
    ds_read_b64_tr_b16 v[118:119], v59 offset:17408
    v_mfma_f32_16x16x32_bf16 v[244:247], v[120:123], v[84:87], v[244:247]
    ds_read_b64_tr_b16 v[120:121], v60 offset:16384
    s_waitcnt lgkmcnt(13)
    v_mfma_f32_16x16x32_bf16 v[252:255], v[124:127], v[84:87], v[252:255]
    ds_read_b64_tr_b16 v[122:123], v60 offset:17408
    v_mfma_f32_16x16x32_bf16 v[248:251], v[124:127], v[80:83], v[248:251]
    ds_read_b64_tr_b16 v[124:125], v61 offset:16384
    ds_read_b64_tr_b16 v[126:127], v61 offset:17408
    buffer_load_dwordx4 v[80:83], v13, s[8:11], s87 offen offset:0 sc1
    buffer_load_dwordx4 v[84:87], v12, s[8:11], s87 offen offset:0 sc1
    s_waitcnt vmcnt(16)
    s_waitcnt lgkmcnt(14)
    v_mfma_f32_16x16x32_bf16 v[192:195], v[96:99], v[88:91], v[192:195]
    v_mfma_f32_16x16x32_bf16 v[196:199], v[96:99], v[92:95], v[196:199]
    ds_read_b64_tr_b16 v[96:97], v54 offset:24576
    s_waitcnt lgkmcnt(13)
    v_mfma_f32_16x16x32_bf16 v[204:207], v[100:103], v[92:95], v[204:207]
    ds_read_b64_tr_b16 v[98:99], v54 offset:25600
    v_mfma_f32_16x16x32_bf16 v[200:203], v[100:103], v[88:91], v[200:203]
    ds_read_b64_tr_b16 v[100:101], v55 offset:24576
    s_waitcnt lgkmcnt(13)
    v_mfma_f32_16x16x32_bf16 v[208:211], v[104:107], v[88:91], v[208:211]
    ds_read_b64_tr_b16 v[102:103], v55 offset:25600
    v_mfma_f32_16x16x32_bf16 v[212:215], v[104:107], v[92:95], v[212:215]
    ds_read_b64_tr_b16 v[104:105], v56 offset:24576
    s_waitcnt lgkmcnt(13)
    v_mfma_f32_16x16x32_bf16 v[220:223], v[108:111], v[92:95], v[220:223]
    ds_read_b64_tr_b16 v[106:107], v56 offset:25600
    v_mfma_f32_16x16x32_bf16 v[216:219], v[108:111], v[88:91], v[216:219]
    ds_read_b64_tr_b16 v[108:109], v57 offset:24576
    s_waitcnt lgkmcnt(13)
    v_mfma_f32_16x16x32_bf16 v[224:227], v[112:115], v[88:91], v[224:227]
    ds_read_b64_tr_b16 v[110:111], v57 offset:25600
    v_mfma_f32_16x16x32_bf16 v[228:231], v[112:115], v[92:95], v[228:231]
    ds_read_b64_tr_b16 v[112:113], v58 offset:24576
    s_waitcnt lgkmcnt(13)
    v_mfma_f32_16x16x32_bf16 v[236:239], v[116:119], v[92:95], v[236:239]
    ds_read_b64_tr_b16 v[114:115], v58 offset:25600
    v_mfma_f32_16x16x32_bf16 v[232:235], v[116:119], v[88:91], v[232:235]
    ds_read_b64_tr_b16 v[116:117], v59 offset:24576
    s_waitcnt lgkmcnt(13)
    v_mfma_f32_16x16x32_bf16 v[240:243], v[120:123], v[88:91], v[240:243]
    ds_read_b64_tr_b16 v[118:119], v59 offset:25600
    v_mfma_f32_16x16x32_bf16 v[244:247], v[120:123], v[92:95], v[244:247]
    ds_read_b64_tr_b16 v[120:121], v60 offset:24576
    s_waitcnt lgkmcnt(13)
    v_mfma_f32_16x16x32_bf16 v[252:255], v[124:127], v[92:95], v[252:255]
    ds_read_b64_tr_b16 v[122:123], v60 offset:25600
    v_mfma_f32_16x16x32_bf16 v[248:251], v[124:127], v[88:91], v[248:251]
    ds_read_b64_tr_b16 v[124:125], v61 offset:24576
    ds_read_b64_tr_b16 v[126:127], v61 offset:25600
    buffer_load_dwordx4 v[88:91], v13, s[8:11], s87 offen offset:1024 sc1
    buffer_load_dwordx4 v[92:95], v12, s[8:11], s87 offen offset:1024 sc1
    s_waitcnt vmcnt(8)
    s_lshl_b32 s6, s4, 3
    s_add_u32 s6, s6, s5
    s_lshl_b32 s6, s6, 5
    s_add_u32 s6, s6, s3
    s_lshl_b32 s6, s6, 2
    s_add_u32 s6, s6, 3866624
    v_mov_b32 v2, 1
    v_mov_b32 v3, 0x5000000
    v_writelane_b32 v3, s6, 0
    buffer_store_dword v2, v3, s[8:11], 0 offen sc1
    s_waitcnt lgkmcnt(14)
    v_mfma_f32_16x16x32_bf16 v[192:195], v[96:99], v[16:19], v[192:195]
    v_mfma_f32_16x16x32_bf16 v[196:199], v[96:99], v[20:23], v[196:199]
    ds_read_b64_tr_b16 v[96:97], v54 offset:32768
    s_waitcnt lgkmcnt(13)
    v_mfma_f32_16x16x32_bf16 v[204:207], v[100:103], v[20:23], v[204:207]
    ds_read_b64_tr_b16 v[98:99], v54 offset:33792
    v_mfma_f32_16x16x32_bf16 v[200:203], v[100:103], v[16:19], v[200:203]
    ds_read_b64_tr_b16 v[100:101], v55 offset:32768
    s_waitcnt lgkmcnt(13)
    v_mfma_f32_16x16x32_bf16 v[208:211], v[104:107], v[16:19], v[208:211]
    ds_read_b64_tr_b16 v[102:103], v55 offset:33792
    v_mfma_f32_16x16x32_bf16 v[212:215], v[104:107], v[20:23], v[212:215]
    ds_read_b64_tr_b16 v[104:105], v56 offset:32768
    s_waitcnt lgkmcnt(13)
    v_mfma_f32_16x16x32_bf16 v[220:223], v[108:111], v[20:23], v[220:223]
    ds_read_b64_tr_b16 v[106:107], v56 offset:33792
    v_mfma_f32_16x16x32_bf16 v[216:219], v[108:111], v[16:19], v[216:219]
    ds_read_b64_tr_b16 v[108:109], v57 offset:32768
    s_waitcnt lgkmcnt(13)
    v_mfma_f32_16x16x32_bf16 v[224:227], v[112:115], v[16:19], v[224:227]
    ds_read_b64_tr_b16 v[110:111], v57 offset:33792
    v_mfma_f32_16x16x32_bf16 v[228:231], v[112:115], v[20:23], v[228:231]
    ds_read_b64_tr_b16 v[112:113], v58 offset:32768
    s_waitcnt lgkmcnt(13)
    v_mfma_f32_16x16x32_bf16 v[236:239], v[116:119], v[20:23], v[236:239]
    ds_read_b64_tr_b16 v[114:115], v58 offset:33792
    v_mfma_f32_16x16x32_bf16 v[232:235], v[116:119], v[16:19], v[232:235]
    ds_read_b64_tr_b16 v[116:117], v59 offset:32768
    s_waitcnt lgkmcnt(13)
    v_mfma_f32_16x16x32_bf16 v[240:243], v[120:123], v[16:19], v[240:243]
    ds_read_b64_tr_b16 v[118:119], v59 offset:33792
    v_mfma_f32_16x16x32_bf16 v[244:247], v[120:123], v[20:23], v[244:247]
    ds_read_b64_tr_b16 v[120:121], v60 offset:32768
    s_waitcnt lgkmcnt(13)
    v_mfma_f32_16x16x32_bf16 v[252:255], v[124:127], v[20:23], v[252:255]
    ds_read_b64_tr_b16 v[122:123], v60 offset:33792
    v_mfma_f32_16x16x32_bf16 v[248:251], v[124:127], v[16:19], v[248:251]
    ds_read_b64_tr_b16 v[124:125], v61 offset:32768
    ds_read_b64_tr_b16 v[126:127], v61 offset:33792
    buffer_load_dwordx4 v[16:19], v13, s[8:11], s87 offen offset:2048 sc1
    buffer_load_dwordx4 v[20:23], v12, s[8:11], s87 offen offset:2048 sc1
    s_waitcnt lgkmcnt(14)
    v_mfma_f32_16x16x32_bf16 v[192:195], v[96:99], v[24:27], v[192:195]
    v_mfma_f32_16x16x32_bf16 v[196:199], v[96:99], v[28:31], v[196:199]
    ds_read_b64_tr_b16 v[96:97], v54 offset:40960
    s_waitcnt lgkmcnt(13)
    v_mfma_f32_16x16x32_bf16 v[204:207], v[100:103], v[28:31], v[204:207]
    ds_read_b64_tr_b16 v[98:99], v54 offset:41984
    v_mfma_f32_16x16x32_bf16 v[200:203], v[100:103], v[24:27], v[200:203]
    ds_read_b64_tr_b16 v[100:101], v55 offset:40960
    s_waitcnt lgkmcnt(13)
    v_mfma_f32_16x16x32_bf16 v[208:211], v[104:107], v[24:27], v[208:211]
    ds_read_b64_tr_b16 v[102:103], v55 offset:41984
    v_mfma_f32_16x16x32_bf16 v[212:215], v[104:107], v[28:31], v[212:215]
    ds_read_b64_tr_b16 v[104:105], v56 offset:40960
    s_waitcnt lgkmcnt(13)
    v_mfma_f32_16x16x32_bf16 v[220:223], v[108:111], v[28:31], v[220:223]
    ds_read_b64_tr_b16 v[106:107], v56 offset:41984
    v_mfma_f32_16x16x32_bf16 v[216:219], v[108:111], v[24:27], v[216:219]
    ds_read_b64_tr_b16 v[108:109], v57 offset:40960
    s_waitcnt lgkmcnt(13)
    v_mfma_f32_16x16x32_bf16 v[224:227], v[112:115], v[24:27], v[224:227]
    ds_read_b64_tr_b16 v[110:111], v57 offset:41984
    v_mfma_f32_16x16x32_bf16 v[228:231], v[112:115], v[28:31], v[228:231]
    ds_read_b64_tr_b16 v[112:113], v58 offset:40960
    s_waitcnt lgkmcnt(13)
    v_mfma_f32_16x16x32_bf16 v[236:239], v[116:119], v[28:31], v[236:239]
    ds_read_b64_tr_b16 v[114:115], v58 offset:41984
    v_mfma_f32_16x16x32_bf16 v[232:235], v[116:119], v[24:27], v[232:235]
    ds_read_b64_tr_b16 v[116:117], v59 offset:40960
    s_waitcnt lgkmcnt(13)
    v_mfma_f32_16x16x32_bf16 v[240:243], v[120:123], v[24:27], v[240:243]
    ds_read_b64_tr_b16 v[118:119], v59 offset:41984
    v_mfma_f32_16x16x32_bf16 v[244:247], v[120:123], v[28:31], v[244:247]
    ds_read_b64_tr_b16 v[120:121], v60 offset:40960
    s_waitcnt lgkmcnt(13)
    v_mfma_f32_16x16x32_bf16 v[252:255], v[124:127], v[28:31], v[252:255]
    ds_read_b64_tr_b16 v[122:123], v60 offset:41984
    v_mfma_f32_16x16x32_bf16 v[248:251], v[124:127], v[24:27], v[248:251]
    ds_read_b64_tr_b16 v[124:125], v61 offset:40960
    ds_read_b64_tr_b16 v[126:127], v61 offset:41984
    buffer_load_dwordx4 v[24:27], v13, s[8:11], s87 offen offset:3072 sc1
    buffer_load_dwordx4 v[28:31], v12, s[8:11], s87 offen offset:3072 sc1
    s_waitcnt lgkmcnt(14)
    v_mfma_f32_16x16x32_bf16 v[192:195], v[96:99], v[32:35], v[192:195]
    v_mfma_f32_16x16x32_bf16 v[196:199], v[96:99], v[36:39], v[196:199]
    ds_read_b64_tr_b16 v[96:97], v54 offset:49152
    s_waitcnt lgkmcnt(13)
    v_mfma_f32_16x16x32_bf16 v[204:207], v[100:103], v[36:39], v[204:207]
    ds_read_b64_tr_b16 v[98:99], v54 offset:50176
    v_mfma_f32_16x16x32_bf16 v[200:203], v[100:103], v[32:35], v[200:203]
    ds_read_b64_tr_b16 v[100:101], v55 offset:49152
    s_waitcnt lgkmcnt(13)
    v_mfma_f32_16x16x32_bf16 v[208:211], v[104:107], v[32:35], v[208:211]
    ds_read_b64_tr_b16 v[102:103], v55 offset:50176
    v_mfma_f32_16x16x32_bf16 v[212:215], v[104:107], v[36:39], v[212:215]
    ds_read_b64_tr_b16 v[104:105], v56 offset:49152
    s_waitcnt lgkmcnt(13)
    v_mfma_f32_16x16x32_bf16 v[220:223], v[108:111], v[36:39], v[220:223]
    ds_read_b64_tr_b16 v[106:107], v56 offset:50176
    v_mfma_f32_16x16x32_bf16 v[216:219], v[108:111], v[32:35], v[216:219]
    ds_read_b64_tr_b16 v[108:109], v57 offset:49152
    s_waitcnt lgkmcnt(13)
    v_mfma_f32_16x16x32_bf16 v[224:227], v[112:115], v[32:35], v[224:227]
    ds_read_b64_tr_b16 v[110:111], v57 offset:50176
    v_mfma_f32_16x16x32_bf16 v[228:231], v[112:115], v[36:39], v[228:231]
    ds_read_b64_tr_b16 v[112:113], v58 offset:49152
    s_waitcnt lgkmcnt(13)
    v_mfma_f32_16x16x32_bf16 v[236:239], v[116:119], v[36:39], v[236:239]
    ds_read_b64_tr_b16 v[114:115], v58 offset:50176
    v_mfma_f32_16x16x32_bf16 v[232:235], v[116:119], v[32:35], v[232:235]
    ds_read_b64_tr_b16 v[116:117], v59 offset:49152
    s_waitcnt lgkmcnt(13)
    v_mfma_f32_16x16x32_bf16 v[240:243], v[120:123], v[32:35], v[240:243]
    ds_read_b64_tr_b16 v[118:119], v59 offset:50176
    v_mfma_f32_16x16x32_bf16 v[244:247], v[120:123], v[36:39], v[244:247]
    ds_read_b64_tr_b16 v[120:121], v60 offset:49152
    s_waitcnt lgkmcnt(13)
    v_mfma_f32_16x16x32_bf16 v[252:255], v[124:127], v[36:39], v[252:255]
    ds_read_b64_tr_b16 v[122:123], v60 offset:50176
    v_mfma_f32_16x16x32_bf16 v[248:251], v[124:127], v[32:35], v[248:251]
    ds_read_b64_tr_b16 v[124:125], v61 offset:49152
    ds_read_b64_tr_b16 v[126:127], v61 offset:50176
    buffer_load_dwordx4 v[32:35], v13, s[8:11], s88 offen offset:0 sc1
    buffer_load_dwordx4 v[36:39], v12, s[8:11], s88 offen offset:0 sc1
    s_waitcnt vmcnt(13)
    s_waitcnt lgkmcnt(14)
    v_mfma_f32_16x16x32_bf16 v[192:195], v[96:99], v[64:67], v[192:195]
    v_mfma_f32_16x16x32_bf16 v[196:199], v[96:99], v[68:71], v[196:199]
    ds_read_b64_tr_b16 v[96:97], v54 offset:57344
    s_waitcnt lgkmcnt(13)
    v_mfma_f32_16x16x32_bf16 v[204:207], v[100:103], v[68:71], v[204:207]
    ds_read_b64_tr_b16 v[98:99], v54 offset:58368
    v_mfma_f32_16x16x32_bf16 v[200:203], v[100:103], v[64:67], v[200:203]
    ds_read_b64_tr_b16 v[100:101], v55 offset:57344
    s_waitcnt lgkmcnt(13)
    v_mfma_f32_16x16x32_bf16 v[208:211], v[104:107], v[64:67], v[208:211]
    ds_read_b64_tr_b16 v[102:103], v55 offset:58368
    v_mfma_f32_16x16x32_bf16 v[212:215], v[104:107], v[68:71], v[212:215]
    ds_read_b64_tr_b16 v[104:105], v56 offset:57344
    s_waitcnt lgkmcnt(13)
    v_mfma_f32_16x16x32_bf16 v[220:223], v[108:111], v[68:71], v[220:223]
    ds_read_b64_tr_b16 v[106:107], v56 offset:58368
    v_mfma_f32_16x16x32_bf16 v[216:219], v[108:111], v[64:67], v[216:219]
    ds_read_b64_tr_b16 v[108:109], v57 offset:57344
    s_waitcnt lgkmcnt(13)
    v_mfma_f32_16x16x32_bf16 v[224:227], v[112:115], v[64:67], v[224:227]
    ds_read_b64_tr_b16 v[110:111], v57 offset:58368
    v_mfma_f32_16x16x32_bf16 v[228:231], v[112:115], v[68:71], v[228:231]
    ds_read_b64_tr_b16 v[112:113], v58 offset:57344
    s_waitcnt lgkmcnt(13)
    v_mfma_f32_16x16x32_bf16 v[236:239], v[116:119], v[68:71], v[236:239]
    ds_read_b64_tr_b16 v[114:115], v58 offset:58368
    v_mfma_f32_16x16x32_bf16 v[232:235], v[116:119], v[64:67], v[232:235]
    ds_read_b64_tr_b16 v[116:117], v59 offset:57344
    s_waitcnt lgkmcnt(13)
    v_mfma_f32_16x16x32_bf16 v[240:243], v[120:123], v[64:67], v[240:243]
    ds_read_b64_tr_b16 v[118:119], v59 offset:58368
    v_mfma_f32_16x16x32_bf16 v[244:247], v[120:123], v[68:71], v[244:247]
    ds_read_b64_tr_b16 v[120:121], v60 offset:57344
    s_waitcnt lgkmcnt(13)
    v_mfma_f32_16x16x32_bf16 v[252:255], v[124:127], v[68:71], v[252:255]
    ds_read_b64_tr_b16 v[122:123], v60 offset:58368
    v_mfma_f32_16x16x32_bf16 v[248:251], v[124:127], v[64:67], v[248:251]
    ds_read_b64_tr_b16 v[124:125], v61 offset:57344
    ds_read_b64_tr_b16 v[126:127], v61 offset:58368
    buffer_load_dwordx4 v[64:67], v13, s[8:11], s88 offen offset:1024 sc1
    buffer_load_dwordx4 v[68:71], v12, s[8:11], s88 offen offset:1024 sc1
    s_waitcnt vmcnt(13)
    s_waitcnt lgkmcnt(14)
    v_mfma_f32_16x16x32_bf16 v[192:195], v[96:99], v[72:75], v[192:195]
    v_xor_b32 v54, 0x10000, v54
    v_mfma_f32_16x16x32_bf16 v[196:199], v[96:99], v[76:79], v[196:199]
    s_waitcnt lgkmcnt(12)
    v_mfma_f32_16x16x32_bf16 v[204:207], v[100:103], v[76:79], v[204:207]
    v_xor_b32 v55, 0x10000, v55
    v_mfma_f32_16x16x32_bf16 v[200:203], v[100:103], v[72:75], v[200:203]
    s_waitcnt lgkmcnt(0)
    s_barrier
    ds_read_b64_tr_b16 v[96:97], v54 offset:0
    ds_read_b64_tr_b16 v[98:99], v54 offset:1024
    ds_read_b64_tr_b16 v[100:101], v55 offset:0
    v_mfma_f32_16x16x32_bf16 v[208:211], v[104:107], v[72:75], v[208:211]
    ds_read_b64_tr_b16 v[102:103], v55 offset:1024
    v_xor_b32 v56, 0x10000, v56
    v_mfma_f32_16x16x32_bf16 v[212:215], v[104:107], v[76:79], v[212:215]
    ds_read_b64_tr_b16 v[104:105], v56 offset:0
    v_mfma_f32_16x16x32_bf16 v[220:223], v[108:111], v[76:79], v[220:223]
    ds_read_b64_tr_b16 v[106:107], v56 offset:1024
    v_xor_b32 v57, 0x10000, v57
    v_mfma_f32_16x16x32_bf16 v[216:219], v[108:111], v[72:75], v[216:219]
    ds_read_b64_tr_b16 v[108:109], v57 offset:0
    v_mfma_f32_16x16x32_bf16 v[224:227], v[112:115], v[72:75], v[224:227]
    ds_read_b64_tr_b16 v[110:111], v57 offset:1024
    v_xor_b32 v58, 0x10000, v58
    v_mfma_f32_16x16x32_bf16 v[228:231], v[112:115], v[76:79], v[228:231]
    ds_read_b64_tr_b16 v[112:113], v58 offset:0
    v_mfma_f32_16x16x32_bf16 v[236:239], v[116:119], v[76:79], v[236:239]
    ds_read_b64_tr_b16 v[114:115], v58 offset:1024
    v_xor_b32 v59, 0x10000, v59
    v_mfma_f32_16x16x32_bf16 v[232:235], v[116:119], v[72:75], v[232:235]
    ds_read_b64_tr_b16 v[116:117], v59 offset:0
    v_mfma_f32_16x16x32_bf16 v[240:243], v[120:123], v[72:75], v[240:243]
    ds_read_b64_tr_b16 v[118:119], v59 offset:1024
    v_xor_b32 v60, 0x10000, v60
    v_mfma_f32_16x16x32_bf16 v[244:247], v[120:123], v[76:79], v[244:247]
    ds_read_b64_tr_b16 v[120:121], v60 offset:0
    v_mfma_f32_16x16x32_bf16 v[252:255], v[124:127], v[76:79], v[252:255]
    ds_read_b64_tr_b16 v[122:123], v60 offset:1024
    v_xor_b32 v61, 0x10000, v61
    v_mfma_f32_16x16x32_bf16 v[248:251], v[124:127], v[72:75], v[248:251]
    ds_read_b64_tr_b16 v[124:125], v61 offset:0
    ds_read_b64_tr_b16 v[126:127], v61 offset:1024
    buffer_load_dwordx4 v[72:75], v13, s[8:11], s88 offen offset:2048 sc1
    buffer_load_dwordx4 v[76:79], v12, s[8:11], s88 offen offset:2048 sc1
    s_waitcnt vmcnt(13)
    s_waitcnt lgkmcnt(14)
    v_mfma_f32_16x16x32_bf16 v[192:195], v[96:99], v[80:83], v[192:195]
    v_mfma_f32_16x16x32_bf16 v[196:199], v[96:99], v[84:87], v[196:199]
    ds_read_b64_tr_b16 v[96:97], v54 offset:8192
    s_waitcnt lgkmcnt(13)
    v_mfma_f32_16x16x32_bf16 v[204:207], v[100:103], v[84:87], v[204:207]
    ds_read_b64_tr_b16 v[98:99], v54 offset:9216
    v_mfma_f32_16x16x32_bf16 v[200:203], v[100:103], v[80:83], v[200:203]
    ds_read_b64_tr_b16 v[100:101], v55 offset:8192
    s_waitcnt lgkmcnt(13)
    v_mfma_f32_16x16x32_bf16 v[208:211], v[104:107], v[80:83], v[208:211]
    ds_read_b64_tr_b16 v[102:103], v55 offset:9216
    v_mfma_f32_16x16x32_bf16 v[212:215], v[104:107], v[84:87], v[212:215]
    ds_read_b64_tr_b16 v[104:105], v56 offset:8192
    s_waitcnt lgkmcnt(13)
    v_mfma_f32_16x16x32_bf16 v[220:223], v[108:111], v[84:87], v[220:223]
    ds_read_b64_tr_b16 v[106:107], v56 offset:9216
    v_mfma_f32_16x16x32_bf16 v[216:219], v[108:111], v[80:83], v[216:219]
    ds_read_b64_tr_b16 v[108:109], v57 offset:8192
    s_waitcnt lgkmcnt(13)
    v_mfma_f32_16x16x32_bf16 v[224:227], v[112:115], v[80:83], v[224:227]
    ds_read_b64_tr_b16 v[110:111], v57 offset:9216
    v_mfma_f32_16x16x32_bf16 v[228:231], v[112:115], v[84:87], v[228:231]
    ds_read_b64_tr_b16 v[112:113], v58 offset:8192
    s_waitcnt lgkmcnt(13)
    v_mfma_f32_16x16x32_bf16 v[236:239], v[116:119], v[84:87], v[236:239]
    ds_read_b64_tr_b16 v[114:115], v58 offset:9216
    v_mfma_f32_16x16x32_bf16 v[232:235], v[116:119], v[80:83], v[232:235]
    ds_read_b64_tr_b16 v[116:117], v59 offset:8192
    s_waitcnt lgkmcnt(13)
    v_mfma_f32_16x16x32_bf16 v[240:243], v[120:123], v[80:83], v[240:243]
    ds_read_b64_tr_b16 v[118:119], v59 offset:9216
    v_mfma_f32_16x16x32_bf16 v[244:247], v[120:123], v[84:87], v[244:247]
    ds_read_b64_tr_b16 v[120:121], v60 offset:8192
    s_waitcnt lgkmcnt(13)
    v_mfma_f32_16x16x32_bf16 v[252:255], v[124:127], v[84:87], v[252:255]
    ds_read_b64_tr_b16 v[122:123], v60 offset:9216
    v_mfma_f32_16x16x32_bf16 v[248:251], v[124:127], v[80:83], v[248:251]
    ds_read_b64_tr_b16 v[124:125], v61 offset:8192
    ds_read_b64_tr_b16 v[126:127], v61 offset:9216
    buffer_load_dwordx4 v[80:83], v13, s[8:11], s88 offen offset:3072 sc1
    buffer_load_dwordx4 v[84:87], v12, s[8:11], s88 offen offset:3072 sc1
    s_waitcnt vmcnt(13)
    s_waitcnt lgkmcnt(14)
    v_mfma_f32_16x16x32_bf16 v[192:195], v[96:99], v[88:91], v[192:195]
    v_mfma_f32_16x16x32_bf16 v[196:199], v[96:99], v[92:95], v[196:199]
    ds_read_b64_tr_b16 v[96:97], v54 offset:16384
    s_waitcnt lgkmcnt(13)
    v_mfma_f32_16x16x32_bf16 v[204:207], v[100:103], v[92:95], v[204:207]
    ds_read_b64_tr_b16 v[98:99], v54 offset:17408
    v_mfma_f32_16x16x32_bf16 v[200:203], v[100:103], v[88:91], v[200:203]
    ds_read_b64_tr_b16 v[100:101], v55 offset:16384
    s_waitcnt lgkmcnt(13)
    v_mfma_f32_16x16x32_bf16 v[208:211], v[104:107], v[88:91], v[208:211]
    ds_read_b64_tr_b16 v[102:103], v55 offset:17408
    v_mfma_f32_16x16x32_bf16 v[212:215], v[104:107], v[92:95], v[212:215]
    ds_read_b64_tr_b16 v[104:105], v56 offset:16384
    s_waitcnt lgkmcnt(13)
    v_mfma_f32_16x16x32_bf16 v[220:223], v[108:111], v[92:95], v[220:223]
    ds_read_b64_tr_b16 v[106:107], v56 offset:17408
    v_mfma_f32_16x16x32_bf16 v[216:219], v[108:111], v[88:91], v[216:219]
    ds_read_b64_tr_b16 v[108:109], v57 offset:16384
    s_waitcnt lgkmcnt(13)
    v_mfma_f32_16x16x32_bf16 v[224:227], v[112:115], v[88:91], v[224:227]
    ds_read_b64_tr_b16 v[110:111], v57 offset:17408
    v_mfma_f32_16x16x32_bf16 v[228:231], v[112:115], v[92:95], v[228:231]
    ds_read_b64_tr_b16 v[112:113], v58 offset:16384
    s_waitcnt lgkmcnt(13)
    v_mfma_f32_16x16x32_bf16 v[236:239], v[116:119], v[92:95], v[236:239]
    ds_read_b64_tr_b16 v[114:115], v58 offset:17408
    v_mfma_f32_16x16x32_bf16 v[232:235], v[116:119], v[88:91], v[232:235]
    ds_read_b64_tr_b16 v[116:117], v59 offset:16384
    s_waitcnt lgkmcnt(13)
    v_mfma_f32_16x16x32_bf16 v[240:243], v[120:123], v[88:91], v[240:243]
    ds_read_b64_tr_b16 v[118:119], v59 offset:17408
    v_mfma_f32_16x16x32_bf16 v[244:247], v[120:123], v[92:95], v[244:247]
    ds_read_b64_tr_b16 v[120:121], v60 offset:16384
    s_waitcnt lgkmcnt(13)
    v_mfma_f32_16x16x32_bf16 v[252:255], v[124:127], v[92:95], v[252:255]
    ds_read_b64_tr_b16 v[122:123], v60 offset:17408
    v_mfma_f32_16x16x32_bf16 v[248:251], v[124:127], v[88:91], v[248:251]
    ds_read_b64_tr_b16 v[124:125], v61 offset:16384
    ds_read_b64_tr_b16 v[126:127], v61 offset:17408
    s_waitcnt vmcnt(10)
    s_waitcnt lgkmcnt(14)
    v_mfma_f32_16x16x32_bf16 v[192:195], v[96:99], v[16:19], v[192:195]
    v_mfma_f32_16x16x32_bf16 v[196:199], v[96:99], v[20:23], v[196:199]
    ds_read_b64_tr_b16 v[96:97], v54 offset:24576
    s_waitcnt lgkmcnt(13)
    v_mfma_f32_16x16x32_bf16 v[204:207], v[100:103], v[20:23], v[204:207]
    ds_read_b64_tr_b16 v[98:99], v54 offset:25600
    v_mfma_f32_16x16x32_bf16 v[200:203], v[100:103], v[16:19], v[200:203]
    ds_read_b64_tr_b16 v[100:101], v55 offset:24576
    s_waitcnt lgkmcnt(13)
    v_mfma_f32_16x16x32_bf16 v[208:211], v[104:107], v[16:19], v[208:211]
    ds_read_b64_tr_b16 v[102:103], v55 offset:25600
    v_mfma_f32_16x16x32_bf16 v[212:215], v[104:107], v[20:23], v[212:215]
    ds_read_b64_tr_b16 v[104:105], v56 offset:24576
    s_waitcnt lgkmcnt(13)
    v_mfma_f32_16x16x32_bf16 v[220:223], v[108:111], v[20:23], v[220:223]
    ds_read_b64_tr_b16 v[106:107], v56 offset:25600
    v_mfma_f32_16x16x32_bf16 v[216:219], v[108:111], v[16:19], v[216:219]
    ds_read_b64_tr_b16 v[108:109], v57 offset:24576
    s_waitcnt lgkmcnt(13)
    v_mfma_f32_16x16x32_bf16 v[224:227], v[112:115], v[16:19], v[224:227]
    ds_read_b64_tr_b16 v[110:111], v57 offset:25600
    v_mfma_f32_16x16x32_bf16 v[228:231], v[112:115], v[20:23], v[228:231]
    ds_read_b64_tr_b16 v[112:113], v58 offset:24576
    s_waitcnt lgkmcnt(13)
    v_mfma_f32_16x16x32_bf16 v[236:239], v[116:119], v[20:23], v[236:239]
    ds_read_b64_tr_b16 v[114:115], v58 offset:25600
    v_mfma_f32_16x16x32_bf16 v[232:235], v[116:119], v[16:19], v[232:235]
    ds_read_b64_tr_b16 v[116:117], v59 offset:24576
    s_waitcnt lgkmcnt(13)
    v_mfma_f32_16x16x32_bf16 v[240:243], v[120:123], v[16:19], v[240:243]
    ds_read_b64_tr_b16 v[118:119], v59 offset:25600
    v_mfma_f32_16x16x32_bf16 v[244:247], v[120:123], v[20:23], v[244:247]
    ds_read_b64_tr_b16 v[120:121], v60 offset:24576
    s_waitcnt lgkmcnt(13)
    v_mfma_f32_16x16x32_bf16 v[252:255], v[124:127], v[20:23], v[252:255]
    ds_read_b64_tr_b16 v[122:123], v60 offset:25600
    v_mfma_f32_16x16x32_bf16 v[248:251], v[124:127], v[16:19], v[248:251]
    ds_read_b64_tr_b16 v[124:125], v61 offset:24576
    ds_read_b64_tr_b16 v[126:127], v61 offset:25600
    s_waitcnt vmcnt(8)
    s_waitcnt lgkmcnt(14)
    v_mfma_f32_16x16x32_bf16 v[192:195], v[96:99], v[24:27], v[192:195]
    v_mfma_f32_16x16x32_bf16 v[196:199], v[96:99], v[28:31], v[196:199]
    ds_read_b64_tr_b16 v[96:97], v54 offset:32768
    s_waitcnt lgkmcnt(13)
    v_mfma_f32_16x16x32_bf16 v[204:207], v[100:103], v[28:31], v[204:207]
    ds_read_b64_tr_b16 v[98:99], v54 offset:33792
    v_mfma_f32_16x16x32_bf16 v[200:203], v[100:103], v[24:27], v[200:203]
    ds_read_b64_tr_b16 v[100:101], v55 offset:32768
    s_waitcnt lgkmcnt(13)
    v_mfma_f32_16x16x32_bf16 v[208:211], v[104:107], v[24:27], v[208:211]
    ds_read_b64_tr_b16 v[102:103], v55 offset:33792
    v_mfma_f32_16x16x32_bf16 v[212:215], v[104:107], v[28:31], v[212:215]
    ds_read_b64_tr_b16 v[104:105], v56 offset:32768
    s_waitcnt lgkmcnt(13)
    v_mfma_f32_16x16x32_bf16 v[220:223], v[108:111], v[28:31], v[220:223]
    ds_read_b64_tr_b16 v[106:107], v56 offset:33792
    v_mfma_f32_16x16x32_bf16 v[216:219], v[108:111], v[24:27], v[216:219]
    ds_read_b64_tr_b16 v[108:109], v57 offset:32768
    s_waitcnt lgkmcnt(13)
    v_mfma_f32_16x16x32_bf16 v[224:227], v[112:115], v[24:27], v[224:227]
    ds_read_b64_tr_b16 v[110:111], v57 offset:33792
    v_mfma_f32_16x16x32_bf16 v[228:231], v[112:115], v[28:31], v[228:231]
    ds_read_b64_tr_b16 v[112:113], v58 offset:32768
    s_waitcnt lgkmcnt(13)
    v_mfma_f32_16x16x32_bf16 v[236:239], v[116:119], v[28:31], v[236:239]
    ds_read_b64_tr_b16 v[114:115], v58 offset:33792
    v_mfma_f32_16x16x32_bf16 v[232:235], v[116:119], v[24:27], v[232:235]
    ds_read_b64_tr_b16 v[116:117], v59 offset:32768
    s_waitcnt lgkmcnt(13)
    v_mfma_f32_16x16x32_bf16 v[240:243], v[120:123], v[24:27], v[240:243]
    ds_read_b64_tr_b16 v[118:119], v59 offset:33792
    v_mfma_f32_16x16x32_bf16 v[244:247], v[120:123], v[28:31], v[244:247]
    ds_read_b64_tr_b16 v[120:121], v60 offset:32768
    s_waitcnt lgkmcnt(13)
    v_mfma_f32_16x16x32_bf16 v[252:255], v[124:127], v[28:31], v[252:255]
    ds_read_b64_tr_b16 v[122:123], v60 offset:33792
    v_mfma_f32_16x16x32_bf16 v[248:251], v[124:127], v[24:27], v[248:251]
    ds_read_b64_tr_b16 v[124:125], v61 offset:32768
    ds_read_b64_tr_b16 v[126:127], v61 offset:33792
    s_waitcnt vmcnt(0)
    s_cmp_ge_u32 s3, 4
    s_cbranch_scc1 L_q_nold
    s_lshl_b32 s7, s4, 10
    s_add_u32 s7, s7, 3866624
    v_lshrrev_b32 v2, 3, v1
    v_and_b32 v3, 7, v1
    v_lshlrev_b32 v3, 2, v3
    v_lshl_add_u32 v3, v2, 7, v3
    s_mov_b32 s79, 262144
L_poll_7:
    buffer_load_dword v2, v3, s[8:11], s7 offen sc1
    s_waitcnt vmcnt(0)
    v_cmp_gt_u32 vcc, 1, v2
    s_cbranch_vccz L_polldone_8
    s_sleep 2
    s_sub_u32 s79, s79, 1
    s_cmp_lg_u32 s79, 0
    s_cbranch_scc1 L_poll_7
L_polldone_8:
    s_lshl_b32 s6, s76, 13
    s_add_u32 s6, s6, s78
    s_add_u32 m0, s6, 0
    s_add_u32 s7, s77, 0
    buffer_load_dwordx4 v49, s[8:11], s7 offen offset:0 sc1 lds
    buffer_load_dwordx4 v49, s[8:11], s7 offen offset:1024 sc1 lds
    buffer_load_dwordx4 v49, s[8:11], s7 offen offset:2048 sc1 lds
    buffer_load_dwordx4 v49, s[8:11], s7 offen offset:3072 sc1 lds
    s_lshl_b32 s6, s76, 13
    s_add_u32 s6, s6, s78
    s_add_u32 m0, s6, 4096
    s_add_u32 s7, s77, 4096
    buffer_load_dwordx4 v49, s[8:11], s7 offen offset:0 sc1 lds
    buffer_load_dwordx4 v49, s[8:11], s7 offen offset:1024 sc1 lds
    buffer_load_dwordx4 v49, s[8:11], s7 offen offset:2048 sc1 lds
    buffer_load_dwordx4 v49, s[8:11], s7 offen offset:3072 sc1 lds
    s_lshl_b32 s6, s76, 12
    s_add_u32 s6, s6, s78
    s_add_u32 m0, s6, 49152
    s_add_u32 s7, s77, 524288
    buffer_load_dwordx4 v50, s[8:11], s7 offen offset:0 sc1 lds
    buffer_load_dwordx4 v50, s[8:11], s7 offen offset:1024 sc1 lds
    buffer_load_dwordx4 v50, s[8:11], s7 offen offset:2048 sc1 lds
    buffer_load_dwordx4 v50, s[8:11], s7 offen offset:3072 sc1 lds
L_q_nold:
    s_waitcnt lgkmcnt(14)
    v_mfma_f32_16x16x32_bf16 v[192:195], v[96:99], v[32:35], v[192:195]
    v_mfma_f32_16x16x32_bf16 v[196:199], v[96:99], v[36:39], v[196:199]
    ds_read_b64_tr_b16 v[96:97], v54 offset:40960
    s_waitcnt lgkmcnt(13)
    v_mfma_f32_16x16x32_bf16 v[204:207], v[100:103], v[36:39], v[204:207]
    ds_read_b64_tr_b16 v[98:99], v54 offset:41984
    v_mfma_f32_16x16x32_bf16 v[200:203], v[100:103], v[32:35], v[200:203]
    ds_read_b64_tr_b16 v[100:101], v55 offset:40960
    s_waitcnt lgkmcnt(13)
    v_mfma_f32_16x16x32_bf16 v[208:211], v[104:107], v[32:35], v[208:211]
    ds_read_b64_tr_b16 v[102:103], v55 offset:41984
    v_mfma_f32_16x16x32_bf16 v[212:215], v[104:107], v[36:39], v[212:215]
    ds_read_b64_tr_b16 v[104:105], v56 offset:40960
    s_waitcnt lgkmcnt(13)
    v_mfma_f32_16x16x32_bf16 v[220:223], v[108:111], v[36:39], v[220:223]
    ds_read_b64_tr_b16 v[106:107], v56 offset:41984
    buffer_store_dwordx4 v[144:147], v13, s[8:11], s67 offen sc1
    s_add_u32 s67, s67, 1024
    v_mfma_f32_16x16x32_bf16 v[216:219], v[108:111], v[32:35], v[216:219]
    ds_read_b64_tr_b16 v[108:109], v57 offset:40960
    s_waitcnt lgkmcnt(13)
    v_mfma_f32_16x16x32_bf16 v[224:227], v[112:115], v[32:35], v[224:227]
    ds_read_b64_tr_b16 v[110:111], v57 offset:41984
    v_mfma_f32_16x16x32_bf16 v[228:231], v[112:115], v[36:39], v[228:231]
    ds_read_b64_tr_b16 v[112:113], v58 offset:40960
    s_waitcnt lgkmcnt(13)
    v_mfma_f32_16x16x32_bf16 v[236:239], v[116:119], v[36:39], v[236:239]
    ds_read_b64_tr_b16 v[114:115], v58 offset:41984
    v_mfma_f32_16x16x32_bf16 v[232:235], v[116:119], v[32:35], v[232:235]
    ds_read_b64_tr_b16 v[116:117], v59 offset:40960
    s_waitcnt lgkmcnt(13)
    v_mfma_f32_16x16x32_bf16 v[240:243], v[120:123], v[32:35], v[240:243]
    ds_read_b64_tr_b16 v[118:119], v59 offset:41984
    v_mfma_f32_16x16x32_bf16 v[244:247], v[120:123], v[36:39], v[244:247]
    ds_read_b64_tr_b16 v[120:121], v60 offset:40960
    s_waitcnt lgkmcnt(13)
    v_mfma_f32_16x16x32_bf16 v[252:255], v[124:127], v[36:39], v[252:255]
    ds_read_b64_tr_b16 v[122:123], v60 offset:41984
    v_mfma_f32_16x16x32_bf16 v[248:251], v[124:127], v[32:35], v[248:251]
    ds_read_b64_tr_b16 v[124:125], v61 offset:40960
    ds_read_b64_tr_b16 v[126:127], v61 offset:41984
    s_waitcnt lgkmcnt(14)
    v_mfma_f32_16x16x32_bf16 v[192:195], v[96:99], v[64:67], v[192:195]
    v_mfma_f32_16x16x32_bf16 v[196:199], v[96:99], v[68:71], v[196:199]
    ds_read_b64_tr_b16 v[96:97], v54 offset:49152
    s_waitcnt lgkmcnt(13)
    v_mfma_f32_16x16x32_bf16 v[204:207], v[100:103], v[68:71], v[204:207]
    ds_read_b64_tr_b16 v[98:99], v54 offset:50176
    v_mfma_f32_16x16x32_bf16 v[200:203], v[100:103], v[64:67], v[200:203]
    ds_read_b64_tr_b16 v[100:101], v55 offset:49152
    s_waitcnt lgkmcnt(13)
    v_mfma_f32_16x16x32_bf16 v[208:211], v[104:107], v[64:67], v[208:211]
    ds_read_b64_tr_b16 v[102:103], v55 offset:50176
    v_mfma_f32_16x16x32_bf16 v[212:215], v[104:107], v[68:71], v[212:215]
    ds_read_b64_tr_b16 v[104:105], v56 offset:49152
    s_waitcnt lgkmcnt(13)
    v_mfma_f32_16x16x32_bf16 v[220:223], v[108:111], v[68:71], v[220:223]
    ds_read_b64_tr_b16 v[106:107], v56 offset:50176
    buffer_store_dwordx4 v[148:151], v13, s[8:11], s67 offen sc1
    s_add_u32 s67, s67, s68
    v_mfma_f32_16x16x32_bf16 v[216:219], v[108:111], v[64:67], v[216:219]
    ds_read_b64_tr_b16 v[108:109], v57 offset:49152
    s_waitcnt lgkmcnt(13)
    v_mfma_f32_16x16x32_bf16 v[224:227], v[112:115], v[64:67], v[224:227]
    ds_read_b64_tr_b16 v[110:111], v57 offset:50176
    v_mfma_f32_16x16x32_bf16 v[228:231], v[112:115], v[68:71], v[228:231]
    ds_read_b64_tr_b16 v[112:113], v58 offset:49152
    s_waitcnt lgkmcnt(13)
    v_mfma_f32_16x16x32_bf16 v[236:239], v[116:119], v[68:71], v[236:239]
    ds_read_b64_tr_b16 v[114:115], v58 offset:50176
    v_mfma_f32_16x16x32_bf16 v[232:235], v[116:119], v[64:67], v[232:235]
    ds_read_b64_tr_b16 v[116:117], v59 offset:49152
    s_waitcnt lgkmcnt(13)
    v_mfma_f32_16x16x32_bf16 v[240:243], v[120:123], v[64:67], v[240:243]
    ds_read_b64_tr_b16 v[118:119], v59 offset:50176
    v_mfma_f32_16x16x32_bf16 v[244:247], v[120:123], v[68:71], v[244:247]
    ds_read_b64_tr_b16 v[120:121], v60 offset:49152
    s_waitcnt lgkmcnt(13)
    v_mfma_f32_16x16x32_bf16 v[252:255], v[124:127], v[68:71], v[252:255]
    ds_read_b64_tr_b16 v[122:123], v60 offset:50176
    v_mfma_f32_16x16x32_bf16 v[248:251], v[124:127], v[64:67], v[248:251]
    ds_read_b64_tr_b16 v[124:125], v61 offset:49152
    ds_read_b64_tr_b16 v[126:127], v61 offset:50176
    s_waitcnt lgkmcnt(14)
    v_mfma_f32_16x16x32_bf16 v[192:195], v[96:99], v[72:75], v[192:195]
    v_mfma_f32_16x16x32_bf16 v[196:199], v[96:99], v[76:79], v[196:199]
    ds_read_b64_tr_b16 v[96:97], v54 offset:57344
    s_waitcnt lgkmcnt(13)
    v_mfma_f32_16x16x32_bf16 v[204:207], v[100:103], v[76:79], v[204:207]
    ds_read_b64_tr_b16 v[98:99], v54 offset:58368
    v_mfma_f32_16x16x32_bf16 v[200:203], v[100:103], v[72:75], v[200:203]
    ds_read_b64_tr_b16 v[100:101], v55 offset:57344
    s_waitcnt lgkmcnt(13)
    v_mfma_f32_16x16x32_bf16 v[208:211], v[104:107], v[72:75], v[208:211]
    ds_read_b64_tr_b16 v[102:103], v55 offset:58368
    v_mfma_f32_16x16x32_bf16 v[212:215], v[104:107], v[76:79], v[212:215]
    ds_read_b64_tr_b16 v[104:105], v56 offset:57344
    s_waitcnt lgkmcnt(13)
    v_mfma_f32_16x16x32_bf16 v[220:223], v[108:111], v[76:79], v[220:223]
    ds_read_b64_tr_b16 v[106:107], v56 offset:58368
    buffer_store_dwordx4 v[152:155], v13, s[8:11], s67 offen sc1
    s_add_u32 s67, s67, 1024
    v_mfma_f32_16x16x32_bf16 v[216:219], v[108:111], v[72:75], v[216:219]
    ds_read_b64_tr_b16 v[108:109], v57 offset:57344
    s_waitcnt lgkmcnt(13)
    v_mfma_f32_16x16x32_bf16 v[224:227], v[112:115], v[72:75], v[224:227]
    ds_read_b64_tr_b16 v[110:111], v57 offset:58368
    v_mfma_f32_16x16x32_bf16 v[228:231], v[112:115], v[76:79], v[228:231]
    ds_read_b64_tr_b16 v[112:113], v58 offset:57344
    s_waitcnt lgkmcnt(13)
    v_mfma_f32_16x16x32_bf16 v[236:239], v[116:119], v[76:79], v[236:239]
    ds_read_b64_tr_b16 v[114:115], v58 offset:58368
    v_mfma_f32_16x16x32_bf16 v[232:235], v[116:119], v[72:75], v[232:235]
    ds_read_b64_tr_b16 v[116:117], v59 offset:57344
    s_waitcnt lgkmcnt(13)
    v_mfma_f32_16x16x32_bf16 v[240:243], v[120:123], v[72:75], v[240:243]
    ds_read_b64_tr_b16 v[118:119], v59 offset:58368
    v_mfma_f32_16x16x32_bf16 v[244:247], v[120:123], v[76:79], v[244:247]
    ds_read_b64_tr_b16 v[120:121], v60 offset:57344
    s_waitcnt lgkmcnt(13)
    v_mfma_f32_16x16x32_bf16 v[252:255], v[124:127], v[76:79], v[252:255]
    ds_read_b64_tr_b16 v[122:123], v60 offset:58368
    v_mfma_f32_16x16x32_bf16 v[248:251], v[124:127], v[72:75], v[248:251]
    ds_read_b64_tr_b16 v[124:125], v61 offset:57344
    ds_read_b64_tr_b16 v[126:127], v61 offset:58368
    s_waitcnt lgkmcnt(14)
    v_mfma_f32_16x16x32_bf16 v[192:195], v[96:99], v[80:83], v[192:195]
    v_mfma_f32_16x16x32_bf16 v[196:199], v[96:99], v[84:87], v[196:199]
    s_waitcnt lgkmcnt(12)
    v_mfma_f32_16x16x32_bf16 v[204:207], v[100:103], v[84:87], v[204:207]
    v_mfma_f32_16x16x32_bf16 v[200:203], v[100:103], v[80:83], v[200:203]
    s_waitcnt lgkmcnt(10)
    v_mfma_f32_16x16x32_bf16 v[208:211], v[104:107], v[80:83], v[208:211]
    v_mfma_f32_16x16x32_bf16 v[212:215], v[104:107], v[84:87], v[212:215]
    s_waitcnt lgkmcnt(8)
    v_mfma_f32_16x16x32_bf16 v[220:223], v[108:111], v[84:87], v[220:223]
    buffer_store_dwordx4 v[156:159], v13, s[8:11], s67 offen sc1
    s_add_u32 s67, s67, s69
    v_mfma_f32_16x16x32_bf16 v[216:219], v[108:111], v[80:83], v[216:219]
    s_waitcnt lgkmcnt(6)
    v_mfma_f32_16x16x32_bf16 v[224:227], v[112:115], v[80:83], v[224:227]
    v_mfma_f32_16x16x32_bf16 v[228:231], v[112:115], v[84:87], v[228:231]
    s_waitcnt lgkmcnt(4)
    v_mfma_f32_16x16x32_bf16 v[236:239], v[116:119], v[84:87], v[236:239]
    v_mfma_f32_16x16x32_bf16 v[232:235], v[116:119], v[80:83], v[232:235]
    s_waitcnt lgkmcnt(2)
    v_mfma_f32_16x16x32_bf16 v[240:243], v[120:123], v[80:83], v[240:243]
    v_mfma_f32_16x16x32_bf16 v[244:247], v[120:123], v[84:87], v[244:247]
    s_waitcnt lgkmcnt(0)
    v_mfma_f32_16x16x32_bf16 v[252:255], v[124:127], v[84:87], v[252:255]
    v_mfma_f32_16x16x32_bf16 v[248:251], v[124:127], v[80:83], v[248:251]
    s_cmp_lt_u32 s3, 4
    s_cbranch_scc1 L_qb
    s_barrier
L_qb:
    s_mov_b32 s6, 0x3e0293ee
    s_nop 7
    buffer_store_dwordx4 v[160:163], v13, s[8:11], s67 offen sc1
    s_add_u32 s67, s67, 1024
    buffer_store_dwordx4 v[164:167], v13, s[8:11], s67 offen sc1
    s_add_u32 s67, s67, s68
    buffer_store_dwordx4 v[168:171], v13, s[8:11], s67 offen sc1
    s_add_u32 s67, s67, 1024
    buffer_store_dwordx4 v[172:175], v13, s[8:11], s67 offen sc1
    s_add_u32 s67, s67, s69
    v_mul_f32 v192, s6, v192
    v_mul_f32 v193, s6, v193
    v_mul_f32 v194, s6, v194
    v_mul_f32 v195, s6, v195
    v_cvt_pk_bf16_f32 v16, v192, v193
    v_cvt_pk_bf16_f32 v17, v194, v195
    v_mul_f32 v200, s6, v200
    v_mul_f32 v201, s6, v201
    v_mul_f32 v202, s6, v202
    v_mul_f32 v203, s6, v203
    v_cvt_pk_bf16_f32 v18, v200, v201
    v_cvt_pk_bf16_f32 v19, v202, v203
    v_mul_f32 v208, s6, v208
    v_mul_f32 v209, s6, v209
    v_mul_f32 v210, s6, v210
    v_mul_f32 v211, s6, v211
    v_cvt_pk_bf16_f32 v20, v208, v209
    v_cvt_pk_bf16_f32 v21, v210, v211
    v_mul_f32 v216, s6, v216
    v_mul_f32 v217, s6, v217
    v_mul_f32 v218, s6, v218
    v_mul_f32 v219, s6, v219
    v_cvt_pk_bf16_f32 v22, v216, v217
    v_cvt_pk_bf16_f32 v23, v218, v219
    v_mul_f32 v224, s6, v224
    v_mul_f32 v225, s6, v225
    v_mul_f32 v226, s6, v226
    v_mul_f32 v227, s6, v227
    v_cvt_pk_bf16_f32 v24, v224, v225
    v_cvt_pk_bf16_f32 v25, v226, v227
    v_mul_f32 v232, s6, v232
    v_mul_f32 v233, s6, v233
    v_mul_f32 v234, s6, v234
    v_mul_f32 v235, s6, v235
    v_cvt_pk_bf16_f32 v26, v232, v233
    v_cvt_pk_bf16_f32 v27, v234, v235
    v_mul_f32 v240, s6, v240
    v_mul_f32 v241, s6, v241
    v_mul_f32 v242, s6, v242
    v_mul_f32 v243, s6, v243
    v_cvt_pk_bf16_f32 v28, v240, v241
    v_cvt_pk_bf16_f32 v29, v242, v243
    v_mul_f32 v248, s6, v248
    v_mul_f32 v249, s6, v249
    v_mul_f32 v250, s6, v250
    v_mul_f32 v251, s6, v251
    v_cvt_pk_bf16_f32 v30, v248, v249
    v_cvt_pk_bf16_f32 v31, v250, v251
    v_mul_f32 v196, s6, v196
    v_mul_f32 v197, s6, v197
    v_mul_f32 v198, s6, v198
    v_mul_f32 v199, s6, v199
    v_cvt_pk_bf16_f32 v32, v196, v197
    v_cvt_pk_bf16_f32 v33, v198, v199
    v_mul_f32 v204, s6, v204
    v_mul_f32 v205, s6, v205
    v_mul_f32 v206, s6, v206
    v_mul_f32 v207, s6, v207
    v_cvt_pk_bf16_f32 v34, v204, v205
    v_cvt_pk_bf16_f32 v35, v206, v207
    v_mul_f32 v212, s6, v212
    v_mul_f32 v213, s6, v213
    v_mul_f32 v214, s6, v214
    v_mul_f32 v215, s6, v215
    v_cvt_pk_bf16_f32 v36, v212, v213
    v_cvt_pk_bf16_f32 v37, v214, v215
    v_mul_f32 v220, s6, v220
    v_mul_f32 v221, s6, v221
    v_mul_f32 v222, s6, v222
    v_mul_f32 v223, s6, v223
    v_cvt_pk_bf16_f32 v38, v220, v221
    v_cvt_pk_bf16_f32 v39, v222, v223
    v_mul_f32 v228, s6, v228
    v_mul_f32 v229, s6, v229
    v_mul_f32 v230, s6, v230
    v_mul_f32 v231, s6, v231
    v_cvt_pk_bf16_f32 v40, v228, v229
    v_cvt_pk_bf16_f32 v41, v230, v231
    v_mul_f32 v236, s6, v236
    v_mul_f32 v237, s6, v237
    v_mul_f32 v238, s6, v238
    v_mul_f32 v239, s6, v239
    v_cvt_pk_bf16_f32 v42, v236, v237
    v_cvt_pk_bf16_f32 v43, v238, v239
    v_mul_f32 v244, s6, v244
    v_mul_f32 v245, s6, v245
    v_mul_f32 v246, s6, v246
    v_mul_f32 v247, s6, v247
    v_cvt_pk_bf16_f32 v44, v244, v245
    v_cvt_pk_bf16_f32 v45, v246, v247
    v_mul_f32 v252, s6, v252
    v_mul_f32 v253, s6, v253
    v_mul_f32 v254, s6, v254
    v_mul_f32 v255, s6, v255
    v_cvt_pk_bf16_f32 v46, v252, v253
    v_cvt_pk_bf16_f32 v47, v254, v255
    v_mov_b64 v[192:193], 0
    v_mov_b64 v[194:195], 0
    v_mov_b64 v[196:197], 0
    v_mov_b64 v[198:199], 0
    v_mov_b64 v[200:201], 0
    v_mov_b64 v[202:203], 0
    v_mov_b64 v[204:205], 0
    v_mov_b64 v[206:207], 0
    v_mov_b64 v[208:209], 0
    v_mov_b64 v[210:211], 0
    v_mov_b64 v[212:213], 0
    v_mov_b64 v[214:215], 0
    v_mov_b64 v[216:217], 0
    v_mov_b64 v[218:219], 0
    v_mov_b64 v[220:221], 0
    v_mov_b64 v[222:223], 0
    v_mov_b64 v[224:225], 0
    v_mov_b64 v[226:227], 0
    v_mov_b64 v[228:229], 0
    v_mov_b64 v[230:231], 0
    v_mov_b64 v[232:233], 0
    v_mov_b64 v[234:235], 0
    v_mov_b64 v[236:237], 0
    v_mov_b64 v[238:239], 0
    v_mov_b64 v[240:241], 0
    v_mov_b64 v[242:243], 0
    v_mov_b64 v[244:245], 0
    v_mov_b64 v[246:247], 0
    v_mov_b64 v[248:249], 0
    v_mov_b64 v[250:251], 0
    v_mov_b64 v[252:253], 0
    v_mov_b64 v[254:255], 0
    v_mov_b64 v[144:145], 0
    v_mov_b64 v[146:147], 0
    v_mov_b64 v[148:149], 0
    v_mov_b64 v[150:151], 0
    v_mov_b64 v[152:153], 0
    v_mov_b64 v[154:155], 0
    v_mov_b64 v[156:157], 0
    v_mov_b64 v[158:159], 0
    v_mov_b64 v[160:161], 0
    v_mov_b64 v[162:163], 0
    v_bfe_u32 v2, v1, 1, 1
    v_lshrrev_b32 v3, 5, v1
    v_cmp_eq_u32 vcc, v2, v3
    v_mov_b32 v2, 0x3f803f80
    v_and_b32 v3, 1, v1
    v_mul_u32_u24 v3, 0xaaaa, v3
    v_add_u32 v168, 0x4444, v3
    v_cndmask_b32 v164, 0, v2, vcc
    v_cndmask_b32 v165, 0, v2, vcc
    v_cndmask_b32 v166, 0, v2, vcc
    v_cndmask_b32 v167, 0, v2, vcc
    v_add_u32 v48, s100, v13
    s_waitcnt vmcnt(8)
    s_mov_b32 s72, 0x40004000
    s_mov_b32 s65, 0
    s_sub_u32 s63, 15, s5
    s_mov_b32 s62, -1
    s_cmp_ge_u32 s3, 4
    s_cbranch_scc1 L_qb2
    s_barrier
L_qb2:
    ds_read_b128 v[96:99], v48 offset:0
    ds_read_b128 v[100:103], v48 offset:1024
    ds_read_b128 v[104:107], v48 offset:2048
    ds_read_b128 v[108:111], v48 offset:3072
    ds_read_b128 v[112:115], v48 offset:4096
    ds_read_b128 v[116:119], v48 offset:5120
    ds_read_b128 v[120:123], v48 offset:6144
    ds_read_b128 v[124:127], v48 offset:7168
    s_cmp_lg_u32 s60, 0
    s_cbranch_scc1 L_nm0
    s_call_b64 s[82:83], L_mask
L_nm0:
    s_waitcnt lgkmcnt(7)
    v_mfma_f32_16x16x32_bf16 v[64:67], v[96:99], v[16:19], v[144:147]
    v_mfma_f32_16x16x32_bf16 v[68:71], v[96:99], v[32:35], v[148:151]
    ds_read_b128 v[96:99], v48 offset:8192
    s_waitcnt lgkmcnt(7)
    v_mfma_f32_16x16x32_bf16 v[64:67], v[100:103], v[20:23], v[64:67]
    v_mfma_f32_16x16x32_bf16 v[68:71], v[100:103], v[36:39], v[68:71]
    ds_read_b128 v[100:103], v48 offset:9216
    s_waitcnt lgkmcnt(7)
    v_mfma_f32_16x16x32_bf16 v[64:67], v[104:107], v[24:27], v[64:67]
    v_mfma_f32_16x16x32_bf16 v[68:71], v[104:107], v[40:43], v[68:71]
    ds_read_b128 v[104:107], v48 offset:10240
    s_waitcnt lgkmcnt(7)
    v_mfma_f32_16x16x32_bf16 v[64:67], v[108:111], v[28:31], v[64:67]
    v_mfma_f32_16x16x32_bf16 v[68:71], v[108:111], v[44:47], v[68:71]
    ds_read_b128 v[108:111], v48 offset:11264
    s_waitcnt lgkmcnt(7)
    v_mfma_f32_16x16x32_bf16 v[72:75], v[112:115], v[16:19], v[152:155]
    v_mfma_f32_16x16x32_bf16 v[76:79], v[112:115], v[32:35], v[156:159]
    ds_read_b128 v[112:115], v48 offset:12288
    s_waitcnt lgkmcnt(7)
    v_mfma_f32_16x16x32_bf16 v[72:75], v[116:119], v[20:23], v[72:75]
    v_mfma_f32_16x16x32_bf16 v[76:79], v[116:119], v[36:39], v[76:79]
    ds_read_b128 v[116:119], v48 offset:13312
    s_waitcnt lgkmcnt(7)
    v_mfma_f32_16x16x32_bf16 v[72:75], v[120:123], v[24:27], v[72:75]
    v_mfma_f32_16x16x32_bf16 v[76:79], v[120:123], v[40:43], v[76:79]
    ds_read_b128 v[120:123], v48 offset:14336
    s_waitcnt lgkmcnt(7)
    v_mfma_f32_16x16x32_bf16 v[72:75], v[124:127], v[28:31], v[72:75]
    v_mfma_f32_16x16x32_bf16 v[76:79], v[124:127], v[44:47], v[76:79]
    ds_read_b128 v[124:127], v48 offset:15360
    s_nop 7
    v_max3_f32 v58, v64, v65, v66
    v_max3_f32 v58, v58, v67, v72
    v_max3_f32 v58, v58, v73, v74
    v_max_f32 v58, v58, v75
    v_mov_b32 v60, v58
    s_nop 1
    v_permlane16_swap_b32 v58, v60
    s_nop 1
    v_max_f32 v58, v58, v60
    v_mov_b32 v60, v58
    s_nop 1
    v_permlane32_swap_b32 v58, v60
    s_nop 1
    v_max_f32 v58, v58, v60
    v_add_f32 v58, 0x41c00000, v58
    v_sub_f32 v64, v64, v58
    v_sub_f32 v144, 0, v58
    v_sub_f32 v65, v65, v58
    v_sub_f32 v145, 0, v58
    v_sub_f32 v66, v66, v58
    v_sub_f32 v146, 0, v58
    v_sub_f32 v67, v67, v58
    v_sub_f32 v147, 0, v58
    v_sub_f32 v72, v72, v58
    v_sub_f32 v152, 0, v58
    v_sub_f32 v73, v73, v58
    v_sub_f32 v153, 0, v58
    v_sub_f32 v74, v74, v58
    v_sub_f32 v154, 0, v58
    v_sub_f32 v75, v75, v58
    v_sub_f32 v155, 0, v58
    v_max3_f32 v59, v68, v69, v70
    v_max3_f32 v59, v59, v71, v76
    v_max3_f32 v59, v59, v77, v78
    v_max_f32 v59, v59, v79
    v_mov_b32 v60, v59
    s_nop 1
    v_permlane16_swap_b32 v59, v60
    s_nop 1
    v_max_f32 v59, v59, v60
    v_mov_b32 v60, v59
    s_nop 1
    v_permlane32_swap_b32 v59, v60
    s_nop 1
    v_max_f32 v59, v59, v60
    v_add_f32 v59, 0x41c00000, v59
    v_sub_f32 v68, v68, v59
    v_sub_f32 v148, 0, v59
    v_sub_f32 v69, v69, v59
    v_sub_f32 v149, 0, v59
    v_sub_f32 v70, v70, v59
    v_sub_f32 v150, 0, v59
    v_sub_f32 v71, v71, v59
    v_sub_f32 v151, 0, v59
    v_sub_f32 v76, v76, v59
    v_sub_f32 v156, 0, v59
    v_sub_f32 v77, v77, v59
    v_sub_f32 v157, 0, v59
    v_sub_f32 v78, v78, v59
    v_sub_f32 v158, 0, v59
    v_sub_f32 v79, v79, v59
    v_sub_f32 v159, 0, v59
    s_cmp_lg_u32 s60, 1
    s_cbranch_scc1 L_nm1
    s_call_b64 s[82:83], L_mask
L_nm1:
    v_exp_f32 v58, v64
    v_exp_f32 v59, v65
    s_waitcnt lgkmcnt(7)
    v_mfma_f32_16x16x32_bf16 v[80:83], v[96:99], v[16:19], v[144:147]
    s_waitcnt lgkmcnt(6)
    v_exp_f32 v60, v66
    v_exp_f32 v61, v67
    v_mfma_f32_16x16x32_bf16 v[84:87], v[96:99], v[32:35], v[148:151]
    ds_read_b128 v[96:99], v48 offset:49152
    v_cvt_pk_bf16_f32 v128, v58, v59
    v_cvt_pk_bf16_f32 v129, v60, v61
    v_mfma_f32_16x16x32_bf16 v[84:87], v[100:103], v[36:39], v[84:87]
    s_waitcnt lgkmcnt(6)
    v_exp_f32 v58, v68
    v_exp_f32 v59, v69
    v_mfma_f32_16x16x32_bf16 v[80:83], v[100:103], v[20:23], v[80:83]
    ds_read_b128 v[100:103], v48 offset:50176
    v_cvt_pk_bf16_f32 v132, v58, v59
    v_mfma_f32_16x16x32_bf16 v[80:83], v[104:107], v[24:27], v[80:83]
    s_waitcnt lgkmcnt(6)
    v_exp_f32 v60, v70
    v_exp_f32 v61, v71
    v_mfma_f32_16x16x32_bf16 v[84:87], v[104:107], v[40:43], v[84:87]
    ds_read_b128 v[104:107], v48 offset:51200
    v_cvt_pk_bf16_f32 v133, v60, v61
    v_mfma_f32_16x16x32_bf16 v[84:87], v[108:111], v[44:47], v[84:87]
    s_waitcnt lgkmcnt(6)
    v_exp_f32 v58, v72
    v_exp_f32 v59, v73
    v_mfma_f32_16x16x32_bf16 v[80:83], v[108:111], v[28:31], v[80:83]
    ds_read_b128 v[108:111], v48 offset:52224
    v_cvt_pk_bf16_f32 v130, v58, v59
    v_mfma_f32_16x16x32_bf16 v[88:91], v[112:115], v[16:19], v[152:155]
    s_waitcnt lgkmcnt(6)
    v_exp_f32 v60, v74
    v_exp_f32 v61, v75
    v_mfma_f32_16x16x32_bf16 v[92:95], v[112:115], v[32:35], v[156:159]
    ds_read_b128 v[112:115], v48 offset:53248
    v_cvt_pk_bf16_f32 v131, v60, v61
    v_mfma_f32_16x16x32_bf16 v[92:95], v[116:119], v[36:39], v[92:95]
    s_waitcnt lgkmcnt(6)
    v_exp_f32 v58, v76
    v_exp_f32 v59, v77
    v_mfma_f32_16x16x32_bf16 v[88:91], v[116:119], v[20:23], v[88:91]
    ds_read_b128 v[116:119], v48 offset:54272
    v_cvt_pk_bf16_f32 v134, v58, v59
    v_mfma_f32_16x16x32_bf16 v[88:91], v[120:123], v[24:27], v[88:91]
    s_waitcnt lgkmcnt(6)
    v_exp_f32 v60, v78
    v_exp_f32 v61, v79
    v_mfma_f32_16x16x32_bf16 v[92:95], v[120:123], v[40:43], v[92:95]
    ds_read_b128 v[120:123], v48 offset:55296
    v_cvt_pk_bf16_f32 v135, v60, v61
    v_mfma_f32_16x16x32_bf16 v[92:95], v[124:127], v[44:47], v[92:95]
    s_waitcnt lgkmcnt(6)
    v_or3_b32 v62, v128, v129, v132
    v_or3_b32 v62, v62, v133, v130
    v_or3_b32 v62, v62, v131, v134
    v_bitop3_b32 v62, v62, v135, s72 bitop3:0xa8
    v_cmp_ne_u32 vcc, s65, v62
    v_mfma_f32_16x16x32_bf16 v[88:91], v[124:127], v[28:31], v[88:91]
    ds_read_b128 v[124:127], v48 offset:56320
    s_cbranch_vccnz L_back_9_h
L_back_9:
    s_nop 7
    v_exp_f32 v58, v80
    v_exp_f32 v59, v81
    s_call_b64 s[82:83], L_load
    s_mov_b32 s62, 0
    buffer_store_dwordx4 v[176:179], v13, s[8:11], s67 offen sc1
    s_add_u32 s67, s67, 1024
    buffer_store_dwordx4 v[180:183], v13, s[8:11], s67 offen sc1
    s_add_u32 s67, s67, s68
    buffer_store_dwordx4 v[184:187], v13, s[8:11], s67 offen sc1
    s_add_u32 s67, s67, 1024
    buffer_store_dwordx4 v[188:191], v13, s[8:11], s67 offen sc1
    s_add_u32 s67, s67, s69
    s_sub_i32 s64, s60, 2
    s_cmp_eq_u32 s60, 0
    s_cbranch_scc1 L_pv2
    s_cmp_eq_u32 s60, 1
    s_cbranch_scc1 L_tail2
    s_cmp_lg_u32 s60, 2
    s_cbranch_scc1 L_st2
    s_call_b64 s[82:83], L_mask
    s_branch L_st2
.p2align 6
L_st0:
    v_mfma_f32_16x16x32_bf16 v[192:195], v[96:99], v[128:131], v[192:195]
    s_waitcnt lgkmcnt(6)
    v_exp_f32 v60, v82
    v_mfma_f32_16x16x32_bf16 v[196:199], v[96:99], v[132:135], v[196:199]
    ds_read_b128 v[96:99], v48 offset:0
    v_cvt_pk_bf16_f32 v136, v58, v59
    v_mfma_f32_16x16x32_bf16 v[204:207], v[100:103], v[132:135], v[204:207]
    s_waitcnt lgkmcnt(6)
    v_exp_f32 v61, v83
    v_mfma_f32_16x16x32_bf16 v[200:203], v[100:103], v[128:131], v[200:203]
    s_sub_i32 s64, s64, 1
    ds_read_b128 v[100:103], v48 offset:1024
    v_cvt_pk_bf16_f32 v137, v60, v61
    v_mfma_f32_16x16x32_bf16 v[208:211], v[104:107], v[128:131], v[208:211]
    s_waitcnt lgkmcnt(6)
    v_exp_f32 v58, v84
    v_mfma_f32_16x16x32_bf16 v[212:215], v[104:107], v[132:135], v[212:215]
    ds_read_b128 v[104:107], v48 offset:2048
    v_mfma_f32_16x16x32_bf16 v[220:223], v[108:111], v[132:135], v[220:223]
    s_waitcnt lgkmcnt(6)
    v_exp_f32 v59, v85
    v_mfma_f32_16x16x32_bf16 v[216:219], v[108:111], v[128:131], v[216:219]
    s_cmp_gt_i32 s64, 0
    ds_read_b128 v[108:111], v48 offset:3072
    v_cvt_pk_bf16_f32 v140, v58, v59
    v_mfma_f32_16x16x32_bf16 v[224:227], v[112:115], v[128:131], v[224:227]
    s_waitcnt lgkmcnt(6)
    v_exp_f32 v60, v86
    v_mfma_f32_16x16x32_bf16 v[228:231], v[112:115], v[132:135], v[228:231]
    ds_read_b128 v[112:115], v48 offset:4096
    v_or3_b32 v62, v136, v137, v140
    v_mfma_f32_16x16x32_bf16 v[236:239], v[116:119], v[132:135], v[236:239]
    s_waitcnt lgkmcnt(6)
    v_exp_f32 v61, v87
    v_mfma_f32_16x16x32_bf16 v[232:235], v[116:119], v[128:131], v[232:235]
    s_cselect_b32 s65, 0, 1
    ds_read_b128 v[116:119], v48 offset:5120
    v_cvt_pk_bf16_f32 v141, v60, v61
    v_mfma_f32_16x16x32_bf16 v[240:243], v[120:123], v[128:131], v[240:243]
    s_waitcnt lgkmcnt(6)
    v_exp_f32 v58, v88
    v_mfma_f32_16x16x32_bf16 v[244:247], v[120:123], v[132:135], v[244:247]
    ds_read_b128 v[120:123], v48 offset:6144
    v_mfma_f32_16x16x32_bf16 v[252:255], v[124:127], v[132:135], v[252:255]
    s_waitcnt lgkmcnt(6)
    v_exp_f32 v59, v89
    v_mfma_f32_16x16x32_bf16 v[248:251], v[124:127], v[128:131], v[248:251]
    ds_read_b128 v[124:127], v48 offset:7168
    v_cvt_pk_bf16_f32 v138, v58, v59
    v_mfma_f32_16x16x32_bf16 v[64:67], v[96:99], v[16:19], v[144:147]
    s_waitcnt lgkmcnt(6)
    v_exp_f32 v60, v90
    v_mfma_f32_16x16x32_bf16 v[68:71], v[96:99], v[32:35], v[148:151]
    ds_read_b128 v[96:99], v48 offset:40960
    v_or3_b32 v62, v62, v141, v138
    v_mfma_f32_16x16x32_bf16 v[68:71], v[100:103], v[36:39], v[68:71]
    s_waitcnt lgkmcnt(6)
    v_exp_f32 v61, v91
    v_mfma_f32_16x16x32_bf16 v[64:67], v[100:103], v[20:23], v[64:67]
    ds_read_b128 v[100:103], v48 offset:41984
    v_cvt_pk_bf16_f32 v139, v60, v61
    v_mfma_f32_16x16x32_bf16 v[64:67], v[104:107], v[24:27], v[64:67]
    s_waitcnt lgkmcnt(6)
    v_exp_f32 v58, v92
    v_mfma_f32_16x16x32_bf16 v[68:71], v[104:107], v[40:43], v[68:71]
    ds_read_b128 v[104:107], v48 offset:43008
    v_mfma_f32_16x16x32_bf16 v[68:71], v[108:111], v[44:47], v[68:71]
    s_waitcnt lgkmcnt(6)
    v_exp_f32 v59, v93
    v_mfma_f32_16x16x32_bf16 v[64:67], v[108:111], v[28:31], v[64:67]
    ds_read_b128 v[108:111], v48 offset:44032
    v_cvt_pk_bf16_f32 v142, v58, v59
    v_mfma_f32_16x16x32_bf16 v[72:75], v[112:115], v[16:19], v[152:155]
    s_waitcnt lgkmcnt(6)
    v_exp_f32 v60, v94
    v_mfma_f32_16x16x32_bf16 v[76:79], v[112:115], v[32:35], v[156:159]
    ds_read_b128 v[112:115], v48 offset:45056
    v_or3_b32 v62, v62, v139, v142
    v_mfma_f32_16x16x32_bf16 v[76:79], v[116:119], v[36:39], v[76:79]
    s_waitcnt lgkmcnt(6)
    v_exp_f32 v61, v95
    v_mfma_f32_16x16x32_bf16 v[72:75], v[116:119], v[20:23], v[72:75]
    ds_read_b128 v[116:119], v48 offset:46080
    v_cvt_pk_bf16_f32 v143, v60, v61
    v_smfmac_f32_16x16x64_bf16 v[160:163], v[164:167], v[128:135], v168
    v_bitop3_b32 v62, v62, v143, s72 bitop3:0xa8
    v_mfma_f32_16x16x32_bf16 v[72:75], v[120:123], v[24:27], v[72:75]
    s_waitcnt lgkmcnt(6)
    v_exp_f32 v58, v64
    v_mfma_f32_16x16x32_bf16 v[76:79], v[120:123], v[40:43], v[76:79]
    ds_read_b128 v[120:123], v48 offset:47104
    v_cmp_ne_u32 vcc, s65, v62
    v_mfma_f32_16x16x32_bf16 v[76:79], v[124:127], v[44:47], v[76:79]
    s_waitcnt lgkmcnt(6)
    v_exp_f32 v59, v65
    v_mfma_f32_16x16x32_bf16 v[72:75], v[124:127], v[28:31], v[72:75]
    ds_read_b128 v[124:127], v48 offset:48128
    s_cbranch_vccnz L_back_10_h
L_back_10:
    v_mfma_f32_16x16x32_bf16 v[192:195], v[96:99], v[136:139], v[192:195]
    s_waitcnt lgkmcnt(6)
    v_exp_f32 v60, v66
    v_mfma_f32_16x16x32_bf16 v[196:199], v[96:99], v[140:143], v[196:199]
    ds_read_b128 v[96:99], v48 offset:8192
    v_cvt_pk_bf16_f32 v128, v58, v59
    v_mfma_f32_16x16x32_bf16 v[204:207], v[100:103], v[140:143], v[204:207]
    s_waitcnt lgkmcnt(6)
    v_exp_f32 v61, v67
    v_mfma_f32_16x16x32_bf16 v[200:203], v[100:103], v[136:139], v[200:203]
    s_sub_i32 s64, s64, 1
    ds_read_b128 v[100:103], v48 offset:9216
    v_cvt_pk_bf16_f32 v129, v60, v61
    v_mfma_f32_16x16x32_bf16 v[208:211], v[104:107], v[136:139], v[208:211]
    s_waitcnt lgkmcnt(6)
    v_exp_f32 v58, v68
    v_mfma_f32_16x16x32_bf16 v[212:215], v[104:107], v[140:143], v[212:215]
    ds_read_b128 v[104:107], v48 offset:10240
    v_mfma_f32_16x16x32_bf16 v[220:223], v[108:111], v[140:143], v[220:223]
    s_waitcnt lgkmcnt(6)
    v_exp_f32 v59, v69
    v_mfma_f32_16x16x32_bf16 v[216:219], v[108:111], v[136:139], v[216:219]
    s_cmp_gt_i32 s64, 0
    ds_read_b128 v[108:111], v48 offset:11264
    v_cvt_pk_bf16_f32 v132, v58, v59
    v_mfma_f32_16x16x32_bf16 v[224:227], v[112:115], v[136:139], v[224:227]
    s_waitcnt lgkmcnt(6)
    v_exp_f32 v60, v70
    v_mfma_f32_16x16x32_bf16 v[228:231], v[112:115], v[140:143], v[228:231]
    ds_read_b128 v[112:115], v48 offset:12288
    v_or3_b32 v62, v128, v129, v132
    v_mfma_f32_16x16x32_bf16 v[236:239], v[116:119], v[140:143], v[236:239]
    s_waitcnt lgkmcnt(6)
    v_exp_f32 v61, v71
    v_mfma_f32_16x16x32_bf16 v[232:235], v[116:119], v[136:139], v[232:235]
    s_cselect_b32 s65, 0, 1
    ds_read_b128 v[116:119], v48 offset:13312
    v_cvt_pk_bf16_f32 v133, v60, v61
    v_mfma_f32_16x16x32_bf16 v[240:243], v[120:123], v[136:139], v[240:243]
    s_waitcnt lgkmcnt(6)
    v_exp_f32 v58, v72
    v_mfma_f32_16x16x32_bf16 v[244:247], v[120:123], v[140:143], v[244:247]
    ds_read_b128 v[120:123], v48 offset:14336
    v_mfma_f32_16x16x32_bf16 v[252:255], v[124:127], v[140:143], v[252:255]
    s_waitcnt lgkmcnt(6)
    v_exp_f32 v59, v73
    v_mfma_f32_16x16x32_bf16 v[248:251], v[124:127], v[136:139], v[248:251]
    ds_read_b128 v[124:127], v48 offset:15360
    v_cvt_pk_bf16_f32 v130, v58, v59
    v_mfma_f32_16x16x32_bf16 v[80:83], v[96:99], v[16:19], v[144:147]
    s_waitcnt lgkmcnt(6)
    v_exp_f32 v60, v74
    v_mfma_f32_16x16x32_bf16 v[84:87], v[96:99], v[32:35], v[148:151]
    ds_read_b128 v[96:99], v48 offset:49152
    v_or3_b32 v62, v62, v133, v130
    v_mfma_f32_16x16x32_bf16 v[84:87], v[100:103], v[36:39], v[84:87]
    s_waitcnt lgkmcnt(6)
    v_exp_f32 v61, v75
    v_mfma_f32_16x16x32_bf16 v[80:83], v[100:103], v[20:23], v[80:83]
    ds_read_b128 v[100:103], v48 offset:50176
    v_cvt_pk_bf16_f32 v131, v60, v61
    v_mfma_f32_16x16x32_bf16 v[80:83], v[104:107], v[24:27], v[80:83]
    s_waitcnt lgkmcnt(6)
    v_exp_f32 v58, v76
    v_mfma_f32_16x16x32_bf16 v[84:87], v[104:107], v[40:43], v[84:87]
    ds_read_b128 v[104:107], v48 offset:51200
    v_mfma_f32_16x16x32_bf16 v[84:87], v[108:111], v[44:47], v[84:87]
    s_waitcnt lgkmcnt(6)
    v_exp_f32 v59, v77
    v_mfma_f32_16x16x32_bf16 v[80:83], v[108:111], v[28:31], v[80:83]
    ds_read_b128 v[108:111], v48 offset:52224
    v_cvt_pk_bf16_f32 v134, v58, v59
    v_mfma_f32_16x16x32_bf16 v[88:91], v[112:115], v[16:19], v[152:155]
    s_waitcnt lgkmcnt(6)
    v_exp_f32 v60, v78
    v_mfma_f32_16x16x32_bf16 v[92:95], v[112:115], v[32:35], v[156:159]
    ds_read_b128 v[112:115], v48 offset:53248
    v_or3_b32 v62, v62, v131, v134
    v_mfma_f32_16x16x32_bf16 v[92:95], v[116:119], v[36:39], v[92:95]
    s_waitcnt lgkmcnt(6)
    v_exp_f32 v61, v79
    v_mfma_f32_16x16x32_bf16 v[88:91], v[116:119], v[20:23], v[88:91]
    ds_read_b128 v[116:119], v48 offset:54272
    v_cvt_pk_bf16_f32 v135, v60, v61
    v_smfmac_f32_16x16x64_bf16 v[160:163], v[164:167], v[136:143], v168
    v_bitop3_b32 v62, v62, v135, s72 bitop3:0xa8
    v_mfma_f32_16x16x32_bf16 v[88:91], v[120:123], v[24:27], v[88:91]
    s_waitcnt lgkmcnt(6)
    v_exp_f32 v58, v80
    v_mfma_f32_16x16x32_bf16 v[92:95], v[120:123], v[40:43], v[92:95]
    ds_read_b128 v[120:123], v48 offset:55296
    v_cmp_ne_u32 vcc, s65, v62
    v_mfma_f32_16x16x32_bf16 v[92:95], v[124:127], v[44:47], v[92:95]
    s_waitcnt lgkmcnt(6)
    v_exp_f32 v59, v81
    v_mfma_f32_16x16x32_bf16 v[88:91], v[124:127], v[28:31], v[88:91]
    ds_read_b128 v[124:127], v48 offset:56320
    s_cbranch_vccnz L_back_11_h
L_back_11:
L_st2:
    v_mfma_f32_16x16x32_bf16 v[192:195], v[96:99], v[128:131], v[192:195]
    s_waitcnt lgkmcnt(6)
    v_exp_f32 v60, v82
    v_mfma_f32_16x16x32_bf16 v[196:199], v[96:99], v[132:135], v[196:199]
    ds_read_b128 v[96:99], v48 offset:16384
    v_cvt_pk_bf16_f32 v136, v58, v59
    v_mfma_f32_16x16x32_bf16 v[204:207], v[100:103], v[132:135], v[204:207]
    s_waitcnt lgkmcnt(6)
    v_exp_f32 v61, v83
    v_mfma_f32_16x16x32_bf16 v[200:203], v[100:103], v[128:131], v[200:203]
    s_sub_i32 s64, s64, 1
    ds_read_b128 v[100:103], v48 offset:17408
    v_cvt_pk_bf16_f32 v137, v60, v61
    v_mfma_f32_16x16x32_bf16 v[208:211], v[104:107], v[128:131], v[208:211]
    s_waitcnt lgkmcnt(6)
    v_exp_f32 v58, v84
    v_mfma_f32_16x16x32_bf16 v[212:215], v[104:107], v[132:135], v[212:215]
    ds_read_b128 v[104:107], v48 offset:18432
    v_mfma_f32_16x16x32_bf16 v[220:223], v[108:111], v[132:135], v[220:223]
    s_waitcnt lgkmcnt(6)
    v_exp_f32 v59, v85
    v_mfma_f32_16x16x32_bf16 v[216:219], v[108:111], v[128:131], v[216:219]
    s_cmp_gt_i32 s64, 0
    ds_read_b128 v[108:111], v48 offset:19456
    v_cvt_pk_bf16_f32 v140, v58, v59
    v_mfma_f32_16x16x32_bf16 v[224:227], v[112:115], v[128:131], v[224:227]
    s_waitcnt lgkmcnt(6)
    v_exp_f32 v60, v86
    v_mfma_f32_16x16x32_bf16 v[228:231], v[112:115], v[132:135], v[228:231]
    ds_read_b128 v[112:115], v48 offset:20480
    v_or3_b32 v62, v136, v137, v140
    v_mfma_f32_16x16x32_bf16 v[236:239], v[116:119], v[132:135], v[236:239]
    s_waitcnt lgkmcnt(6)
    v_exp_f32 v61, v87
    v_mfma_f32_16x16x32_bf16 v[232:235], v[116:119], v[128:131], v[232:235]
    s_cselect_b32 s65, 0, 1
    ds_read_b128 v[116:119], v48 offset:21504
    v_cvt_pk_bf16_f32 v141, v60, v61
    v_mfma_f32_16x16x32_bf16 v[240:243], v[120:123], v[128:131], v[240:243]
    s_waitcnt lgkmcnt(6)
    v_exp_f32 v58, v88
    v_mfma_f32_16x16x32_bf16 v[244:247], v[120:123], v[132:135], v[244:247]
    ds_read_b128 v[120:123], v48 offset:22528
    v_mfma_f32_16x16x32_bf16 v[252:255], v[124:127], v[132:135], v[252:255]
    s_waitcnt lgkmcnt(6)
    v_exp_f32 v59, v89
    v_mfma_f32_16x16x32_bf16 v[248:251], v[124:127], v[128:131], v[248:251]
    ds_read_b128 v[124:127], v48 offset:23552
    v_cvt_pk_bf16_f32 v138, v58, v59
    v_mfma_f32_16x16x32_bf16 v[64:67], v[96:99], v[16:19], v[144:147]
    s_waitcnt lgkmcnt(6)
    v_exp_f32 v60, v90
    v_mfma_f32_16x16x32_bf16 v[68:71], v[96:99], v[32:35], v[148:151]
    ds_read_b128 v[96:99], v48 offset:57344
    v_or3_b32 v62, v62, v141, v138
    v_mfma_f32_16x16x32_bf16 v[68:71], v[100:103], v[36:39], v[68:71]
    s_waitcnt lgkmcnt(6)
    v_exp_f32 v61, v91
    v_mfma_f32_16x16x32_bf16 v[64:67], v[100:103], v[20:23], v[64:67]
    ds_read_b128 v[100:103], v48 offset:58368
    v_cvt_pk_bf16_f32 v139, v60, v61
    v_mfma_f32_16x16x32_bf16 v[64:67], v[104:107], v[24:27], v[64:67]
    s_waitcnt lgkmcnt(6)
    v_exp_f32 v58, v92
    v_mfma_f32_16x16x32_bf16 v[68:71], v[104:107], v[40:43], v[68:71]
    ds_read_b128 v[104:107], v48 offset:59392
    v_mfma_f32_16x16x32_bf16 v[68:71], v[108:111], v[44:47], v[68:71]
    s_waitcnt lgkmcnt(6)
    v_exp_f32 v59, v93
    v_mfma_f32_16x16x32_bf16 v[64:67], v[108:111], v[28:31], v[64:67]
    ds_read_b128 v[108:111], v48 offset:60416
    v_cvt_pk_bf16_f32 v142, v58, v59
    v_mfma_f32_16x16x32_bf16 v[72:75], v[112:115], v[16:19], v[152:155]
    s_waitcnt lgkmcnt(6)
    v_exp_f32 v60, v94
    v_mfma_f32_16x16x32_bf16 v[76:79], v[112:115], v[32:35], v[156:159]
    ds_read_b128 v[112:115], v48 offset:61440
    v_or3_b32 v62, v62, v139, v142
    v_mfma_f32_16x16x32_bf16 v[76:79], v[116:119], v[36:39], v[76:79]
    s_waitcnt lgkmcnt(6)
    v_exp_f32 v61, v95
    v_mfma_f32_16x16x32_bf16 v[72:75], v[116:119], v[20:23], v[72:75]
    ds_read_b128 v[116:119], v48 offset:62464
    v_cvt_pk_bf16_f32 v143, v60, v61
    v_smfmac_f32_16x16x64_bf16 v[160:163], v[164:167], v[128:135], v168
    v_bitop3_b32 v62, v62, v143, s72 bitop3:0xa8
    v_mfma_f32_16x16x32_bf16 v[72:75], v[120:123], v[24:27], v[72:75]
    s_waitcnt lgkmcnt(6)
    v_exp_f32 v58, v64
    v_mfma_f32_16x16x32_bf16 v[76:79], v[120:123], v[40:43], v[76:79]
    ds_read_b128 v[120:123], v48 offset:63488
    v_cmp_ne_u32 vcc, s65, v62
    v_mfma_f32_16x16x32_bf16 v[76:79], v[124:127], v[44:47], v[76:79]
    s_waitcnt lgkmcnt(6)
    v_exp_f32 v59, v65
    v_mfma_f32_16x16x32_bf16 v[72:75], v[124:127], v[28:31], v[72:75]
    ds_read_b128 v[124:127], v48 offset:64512
    s_cbranch_vccnz L_back_12_h
L_back_12:
    v_mfma_f32_16x16x32_bf16 v[192:195], v[96:99], v[136:139], v[192:195]
    s_waitcnt lgkmcnt(6)
    v_exp_f32 v60, v66
    v_mfma_f32_16x16x32_bf16 v[196:199], v[96:99], v[140:143], v[196:199]
    ds_read_b128 v[96:99], v48 offset:24576
    v_cvt_pk_bf16_f32 v128, v58, v59
    v_mfma_f32_16x16x32_bf16 v[204:207], v[100:103], v[140:143], v[204:207]
    s_waitcnt lgkmcnt(6)
    v_exp_f32 v61, v67
    v_mfma_f32_16x16x32_bf16 v[200:203], v[100:103], v[136:139], v[200:203]
    s_sub_i32 s64, s64, 1
    ds_read_b128 v[100:103], v48 offset:25600
    v_cvt_pk_bf16_f32 v129, v60, v61
    v_mfma_f32_16x16x32_bf16 v[208:211], v[104:107], v[136:139], v[208:211]
    s_waitcnt lgkmcnt(6)
    v_exp_f32 v58, v68
    v_mfma_f32_16x16x32_bf16 v[212:215], v[104:107], v[140:143], v[212:215]
    ds_read_b128 v[104:107], v48 offset:26624
    v_mfma_f32_16x16x32_bf16 v[220:223], v[108:111], v[140:143], v[220:223]
    s_waitcnt lgkmcnt(6)
    v_exp_f32 v59, v69
    v_mfma_f32_16x16x32_bf16 v[216:219], v[108:111], v[136:139], v[216:219]
    s_cmp_gt_i32 s64, 0
    ds_read_b128 v[108:111], v48 offset:27648
    v_cvt_pk_bf16_f32 v132, v58, v59
    v_mfma_f32_16x16x32_bf16 v[224:227], v[112:115], v[136:139], v[224:227]
    s_waitcnt lgkmcnt(6)
    v_exp_f32 v60, v70
    v_mfma_f32_16x16x32_bf16 v[228:231], v[112:115], v[140:143], v[228:231]
    ds_read_b128 v[112:115], v48 offset:28672
    v_or3_b32 v62, v128, v129, v132
    v_mfma_f32_16x16x32_bf16 v[236:239], v[116:119], v[140:143], v[236:239]
    s_waitcnt lgkmcnt(6)
    v_exp_f32 v61, v71
    v_mfma_f32_16x16x32_bf16 v[232:235], v[116:119], v[136:139], v[232:235]
    s_cselect_b32 s65, 0, 1
    ds_read_b128 v[116:119], v48 offset:29696
    v_cvt_pk_bf16_f32 v133, v60, v61
    v_mfma_f32_16x16x32_bf16 v[240:243], v[120:123], v[136:139], v[240:243]
    s_waitcnt lgkmcnt(6)
    v_exp_f32 v58, v72
    v_mfma_f32_16x16x32_bf16 v[244:247], v[120:123], v[140:143], v[244:247]
    ds_read_b128 v[120:123], v48 offset:30720
    v_mfma_f32_16x16x32_bf16 v[252:255], v[124:127], v[140:143], v[252:255]
    s_waitcnt lgkmcnt(6)
    v_exp_f32 v59, v73
    v_mfma_f32_16x16x32_bf16 v[248:251], v[124:127], v[136:139], v[248:251]
    ds_read_b128 v[124:127], v48 offset:31744
    v_cvt_pk_bf16_f32 v130, v58, v59
    v_mfma_f32_16x16x32_bf16 v[80:83], v[96:99], v[16:19], v[144:147]
    s_waitcnt lgkmcnt(6)
    v_exp_f32 v60, v74
    v_mfma_f32_16x16x32_bf16 v[84:87], v[96:99], v[32:35], v[148:151]
    s_cmp_lg_u32 s89, 0
    v_or3_b32 v62, v62, v133, v130
    v_xor_b32 v48, 0x10000, v48
    v_mfma_f32_16x16x32_bf16 v[84:87], v[100:103], v[36:39], v[84:87]
    s_waitcnt lgkmcnt(5)
    v_exp_f32 v61, v75
    v_mfma_f32_16x16x32_bf16 v[80:83], v[100:103], v[20:23], v[80:83]
    s_waitcnt lgkmcnt(0)
    v_cvt_pk_bf16_f32 v131, v60, v61
    v_smfmac_f32_16x16x64_bf16 v[160:163], v[164:167], v[136:143], v168
    s_cbranch_scc1 L_ldback_13_c
    s_barrier
L_ldback_13:
    s_add_i32 s62, s62, 1
    ds_read_b128 v[96:99], v48 offset:32768
    ds_read_b128 v[100:103], v48 offset:33792
    v_mfma_f32_16x16x32_bf16 v[80:83], v[104:107], v[24:27], v[80:83]
    v_exp_f32 v58, v76
    v_mfma_f32_16x16x32_bf16 v[84:87], v[104:107], v[40:43], v[84:87]
    ds_read_b128 v[104:107], v48 offset:34816
    v_mfma_f32_16x16x32_bf16 v[84:87], v[108:111], v[44:47], v[84:87]
    v_exp_f32 v59, v77
    v_mfma_f32_16x16x32_bf16 v[80:83], v[108:111], v[28:31], v[80:83]
    ds_read_b128 v[108:111], v48 offset:35840
    v_cvt_pk_bf16_f32 v134, v58, v59
    v_mfma_f32_16x16x32_bf16 v[88:91], v[112:115], v[16:19], v[152:155]
    v_exp_f32 v60, v78
    v_mfma_f32_16x16x32_bf16 v[92:95], v[112:115], v[32:35], v[156:159]
    ds_read_b128 v[112:115], v48 offset:36864
    v_or3_b32 v62, v62, v131, v134
    v_mfma_f32_16x16x32_bf16 v[92:95], v[116:119], v[36:39], v[92:95]
    v_exp_f32 v61, v79
    v_mfma_f32_16x16x32_bf16 v[88:91], v[116:119], v[20:23], v[88:91]
    ds_read_b128 v[116:119], v48 offset:37888
    v_cvt_pk_bf16_f32 v135, v60, v61
    v_mfma_f32_16x16x32_bf16 v[88:91], v[120:123], v[24:27], v[88:91]
    v_exp_f32 v58, v80
    v_mfma_f32_16x16x32_bf16 v[92:95], v[120:123], v[40:43], v[92:95]
    ds_read_b128 v[120:123], v48 offset:38912
    v_bitop3_b32 v62, v62, v135, s72 bitop3:0xa8
    v_cmp_ne_u32 vcc, s65, v62
    v_mfma_f32_16x16x32_bf16 v[92:95], v[124:127], v[44:47], v[92:95]
    s_waitcnt lgkmcnt(6)
    v_exp_f32 v59, v81
    v_mfma_f32_16x16x32_bf16 v[88:91], v[124:127], v[28:31], v[88:91]
    ds_read_b128 v[124:127], v48 offset:39936
    s_cbranch_vccz L_st0
    s_branch L_back_14_h
L_tail0:
    s_mov_b32 s65, 0
    v_mfma_f32_16x16x32_bf16 v[192:195], v[96:99], v[128:131], v[192:195]
    s_waitcnt lgkmcnt(6)
    v_exp_f32 v60, v82
    v_exp_f32 v61, v83
    v_mfma_f32_16x16x32_bf16 v[196:199], v[96:99], v[132:135], v[196:199]
    ds_read_b128 v[96:99], v48 offset:40960
    v_cvt_pk_bf16_f32 v136, v58, v59
    v_cvt_pk_bf16_f32 v137, v60, v61
    v_mfma_f32_16x16x32_bf16 v[204:207], v[100:103], v[132:135], v[204:207]
    s_waitcnt lgkmcnt(6)
    v_exp_f32 v58, v84
    v_exp_f32 v59, v85
    v_mfma_f32_16x16x32_bf16 v[200:203], v[100:103], v[128:131], v[200:203]
    ds_read_b128 v[100:103], v48 offset:41984
    v_cvt_pk_bf16_f32 v140, v58, v59
    v_smfmac_f32_16x16x64_bf16 v[160:163], v[164:167], v[128:135], v168
    v_mfma_f32_16x16x32_bf16 v[208:211], v[104:107], v[128:131], v[208:211]
    s_waitcnt lgkmcnt(6)
    v_exp_f32 v60, v86
    v_exp_f32 v61, v87
    v_mfma_f32_16x16x32_bf16 v[212:215], v[104:107], v[132:135], v[212:215]
    ds_read_b128 v[104:107], v48 offset:43008
    v_cvt_pk_bf16_f32 v141, v60, v61
    v_mfma_f32_16x16x32_bf16 v[220:223], v[108:111], v[132:135], v[220:223]
    s_waitcnt lgkmcnt(6)
    v_exp_f32 v58, v88
    v_exp_f32 v59, v89
    v_mfma_f32_16x16x32_bf16 v[216:219], v[108:111], v[128:131], v[216:219]
    ds_read_b128 v[108:111], v48 offset:44032
    v_cvt_pk_bf16_f32 v138, v58, v59
    v_mfma_f32_16x16x32_bf16 v[224:227], v[112:115], v[128:131], v[224:227]
    s_waitcnt lgkmcnt(6)
    v_exp_f32 v60, v90
    v_exp_f32 v61, v91
    v_mfma_f32_16x16x32_bf16 v[228:231], v[112:115], v[132:135], v[228:231]
    ds_read_b128 v[112:115], v48 offset:45056
    v_cvt_pk_bf16_f32 v139, v60, v61
    v_mfma_f32_16x16x32_bf16 v[236:239], v[116:119], v[132:135], v[236:239]
    s_waitcnt lgkmcnt(6)
    v_exp_f32 v58, v92
    v_exp_f32 v59, v93
    v_mfma_f32_16x16x32_bf16 v[232:235], v[116:119], v[128:131], v[232:235]
    ds_read_b128 v[116:119], v48 offset:46080
    v_cvt_pk_bf16_f32 v142, v58, v59
    v_mfma_f32_16x16x32_bf16 v[240:243], v[120:123], v[128:131], v[240:243]
    s_waitcnt lgkmcnt(6)
    v_exp_f32 v60, v94
    v_exp_f32 v61, v95
    v_mfma_f32_16x16x32_bf16 v[244:247], v[120:123], v[132:135], v[244:247]
    ds_read_b128 v[120:123], v48 offset:47104
    v_cvt_pk_bf16_f32 v143, v60, v61
    v_mfma_f32_16x16x32_bf16 v[252:255], v[124:127], v[132:135], v[252:255]
    s_waitcnt lgkmcnt(6)
    v_or3_b32 v62, v136, v137, v140
    v_or3_b32 v62, v62, v141, v138
    v_or3_b32 v62, v62, v139, v142
    v_bitop3_b32 v62, v62, v143, s72 bitop3:0xa8
    v_cmp_ne_u32 vcc, s65, v62
    v_mfma_f32_16x16x32_bf16 v[248:251], v[124:127], v[128:131], v[248:251]
    ds_read_b128 v[124:127], v48 offset:48128
    s_cbranch_vccnz L_back_15_h
L_back_15:
L_pv1:
    v_mfma_f32_16x16x32_bf16 v[192:195], v[96:99], v[136:139], v[192:195]
    s_waitcnt lgkmcnt(6)
    v_mfma_f32_16x16x32_bf16 v[196:199], v[96:99], v[140:143], v[196:199]
    v_mfma_f32_16x16x32_bf16 v[204:207], v[100:103], v[140:143], v[204:207]
    s_waitcnt lgkmcnt(5)
    v_mfma_f32_16x16x32_bf16 v[200:203], v[100:103], v[136:139], v[200:203]
    v_smfmac_f32_16x16x64_bf16 v[160:163], v[164:167], v[136:143], v168
    v_mfma_f32_16x16x32_bf16 v[208:211], v[104:107], v[136:139], v[208:211]
    s_waitcnt lgkmcnt(4)
    v_mfma_f32_16x16x32_bf16 v[212:215], v[104:107], v[140:143], v[212:215]
    v_mfma_f32_16x16x32_bf16 v[220:223], v[108:111], v[140:143], v[220:223]
    s_waitcnt lgkmcnt(3)
    v_mfma_f32_16x16x32_bf16 v[216:219], v[108:111], v[136:139], v[216:219]
    v_mfma_f32_16x16x32_bf16 v[224:227], v[112:115], v[136:139], v[224:227]
    s_waitcnt lgkmcnt(2)
    v_mfma_f32_16x16x32_bf16 v[228:231], v[112:115], v[140:143], v[228:231]
    v_mfma_f32_16x16x32_bf16 v[236:239], v[116:119], v[140:143], v[236:239]
    s_waitcnt lgkmcnt(1)
    v_mfma_f32_16x16x32_bf16 v[232:235], v[116:119], v[136:139], v[232:235]
    v_mfma_f32_16x16x32_bf16 v[240:243], v[120:123], v[136:139], v[240:243]
    s_waitcnt lgkmcnt(0)
    v_mfma_f32_16x16x32_bf16 v[244:247], v[120:123], v[140:143], v[244:247]
    v_mfma_f32_16x16x32_bf16 v[252:255], v[124:127], v[140:143], v[252:255]
    v_mfma_f32_16x16x32_bf16 v[248:251], v[124:127], v[136:139], v[248:251]
    s_branch L_fin
L_tail1:
    s_mov_b32 s65, 0
    v_mfma_f32_16x16x32_bf16 v[192:195], v[96:99], v[136:139], v[192:195]
    s_waitcnt lgkmcnt(6)
    v_exp_f32 v60, v66
    v_exp_f32 v61, v67
    v_mfma_f32_16x16x32_bf16 v[196:199], v[96:99], v[140:143], v[196:199]
    ds_read_b128 v[96:99], v48 offset:49152
    v_cvt_pk_bf16_f32 v128, v58, v59
    v_cvt_pk_bf16_f32 v129, v60, v61
    v_mfma_f32_16x16x32_bf16 v[204:207], v[100:103], v[140:143], v[204:207]
    s_waitcnt lgkmcnt(6)
    v_exp_f32 v58, v68
    v_exp_f32 v59, v69
    v_mfma_f32_16x16x32_bf16 v[200:203], v[100:103], v[136:139], v[200:203]
    ds_read_b128 v[100:103], v48 offset:50176
    v_cvt_pk_bf16_f32 v132, v58, v59
    v_smfmac_f32_16x16x64_bf16 v[160:163], v[164:167], v[136:143], v168
    v_mfma_f32_16x16x32_bf16 v[208:211], v[104:107], v[136:139], v[208:211]
    s_waitcnt lgkmcnt(6)
    v_exp_f32 v60, v70
    v_exp_f32 v61, v71
    v_mfma_f32_16x16x32_bf16 v[212:215], v[104:107], v[140:143], v[212:215]
    ds_read_b128 v[104:107], v48 offset:51200
    v_cvt_pk_bf16_f32 v133, v60, v61
    v_mfma_f32_16x16x32_bf16 v[220:223], v[108:111], v[140:143], v[220:223]
    s_waitcnt lgkmcnt(6)
    v_exp_f32 v58, v72
    v_exp_f32 v59, v73
    v_mfma_f32_16x16x32_bf16 v[216:219], v[108:111], v[136:139], v[216:219]
    ds_read_b128 v[108:111], v48 offset:52224
    v_cvt_pk_bf16_f32 v130, v58, v59
    v_mfma_f32_16x16x32_bf16 v[224:227], v[112:115], v[136:139], v[224:227]
    s_waitcnt lgkmcnt(6)
    v_exp_f32 v60, v74
    v_exp_f32 v61, v75
    v_mfma_f32_16x16x32_bf16 v[228:231], v[112:115], v[140:143], v[228:231]
    ds_read_b128 v[112:115], v48 offset:53248
    v_cvt_pk_bf16_f32 v131, v60, v61
    v_mfma_f32_16x16x32_bf16 v[236:239], v[116:119], v[140:143], v[236:239]
    s_waitcnt lgkmcnt(6)
    v_exp_f32 v58, v76
    v_exp_f32 v59, v77
    v_mfma_f32_16x16x32_bf16 v[232:235], v[116:119], v[136:139], v[232:235]
    ds_read_b128 v[116:119], v48 offset:54272
    v_cvt_pk_bf16_f32 v134, v58, v59
    v_mfma_f32_16x16x32_bf16 v[240:243], v[120:123], v[136:139], v[240:243]
    s_waitcnt lgkmcnt(6)
    v_exp_f32 v60, v78
    v_exp_f32 v61, v79
    v_mfma_f32_16x16x32_bf16 v[244:247], v[120:123], v[140:143], v[244:247]
    ds_read_b128 v[120:123], v48 offset:55296
    v_cvt_pk_bf16_f32 v135, v60, v61
    v_mfma_f32_16x16x32_bf16 v[252:255], v[124:127], v[140:143], v[252:255]
    s_waitcnt lgkmcnt(6)
    v_or3_b32 v62, v128, v129, v132
    v_or3_b32 v62, v62, v133, v130
    v_or3_b32 v62, v62, v131, v134
    v_bitop3_b32 v62, v62, v135, s72 bitop3:0xa8
    v_cmp_ne_u32 vcc, s65, v62
    v_mfma_f32_16x16x32_bf16 v[248:251], v[124:127], v[136:139], v[248:251]
    ds_read_b128 v[124:127], v48 offset:56320
    s_cbranch_vccnz L_back_16_h
L_back_16:
L_pv2:
    v_mfma_f32_16x16x32_bf16 v[192:195], v[96:99], v[128:131], v[192:195]
    s_waitcnt lgkmcnt(6)
    v_mfma_f32_16x16x32_bf16 v[196:199], v[96:99], v[132:135], v[196:199]
    v_mfma_f32_16x16x32_bf16 v[204:207], v[100:103], v[132:135], v[204:207]
    s_waitcnt lgkmcnt(5)
    v_mfma_f32_16x16x32_bf16 v[200:203], v[100:103], v[128:131], v[200:203]
    v_smfmac_f32_16x16x64_bf16 v[160:163], v[164:167], v[128:135], v168
    v_mfma_f32_16x16x32_bf16 v[208:211], v[104:107], v[128:131], v[208:211]
    s_waitcnt lgkmcnt(4)
    v_mfma_f32_16x16x32_bf16 v[212:215], v[104:107], v[132:135], v[212:215]
    v_mfma_f32_16x16x32_bf16 v[220:223], v[108:111], v[132:135], v[220:223]
    s_waitcnt lgkmcnt(3)
    v_mfma_f32_16x16x32_bf16 v[216:219], v[108:111], v[128:131], v[216:219]
    v_mfma_f32_16x16x32_bf16 v[224:227], v[112:115], v[128:131], v[224:227]
    s_waitcnt lgkmcnt(2)
    v_mfma_f32_16x16x32_bf16 v[228:231], v[112:115], v[132:135], v[228:231]
    v_mfma_f32_16x16x32_bf16 v[236:239], v[116:119], v[132:135], v[236:239]
    s_waitcnt lgkmcnt(1)
    v_mfma_f32_16x16x32_bf16 v[232:235], v[116:119], v[128:131], v[232:235]
    v_mfma_f32_16x16x32_bf16 v[240:243], v[120:123], v[128:131], v[240:243]
    s_waitcnt lgkmcnt(0)
    v_mfma_f32_16x16x32_bf16 v[244:247], v[120:123], v[132:135], v[244:247]
    v_mfma_f32_16x16x32_bf16 v[252:255], v[124:127], v[132:135], v[252:255]
    v_mfma_f32_16x16x32_bf16 v[248:251], v[124:127], v[128:131], v[248:251]
    s_cmp_eq_u32 s60, 0
    s_cbranch_scc1 L_fin
    s_waitcnt vmcnt(0) lgkmcnt(0)
    s_call_b64 s[82:83], L_pend
    s_barrier
    s_call_b64 s[82:83], L_load
    s_add_i32 s62, s62, 1
    s_branch L_fin
L_tail2:
    s_mov_b32 s65, 0
    v_mfma_f32_16x16x32_bf16 v[192:195], v[96:99], v[128:131], v[192:195]
    s_waitcnt lgkmcnt(6)
    v_exp_f32 v60, v82
    v_exp_f32 v61, v83
    v_mfma_f32_16x16x32_bf16 v[196:199], v[96:99], v[132:135], v[196:199]
    ds_read_b128 v[96:99], v48 offset:57344
    v_cvt_pk_bf16_f32 v136, v58, v59
    v_cvt_pk_bf16_f32 v137, v60, v61
    v_mfma_f32_16x16x32_bf16 v[204:207], v[100:103], v[132:135], v[204:207]
    s_waitcnt lgkmcnt(6)
    v_exp_f32 v58, v84
    v_exp_f32 v59, v85
    v_mfma_f32_16x16x32_bf16 v[200:203], v[100:103], v[128:131], v[200:203]
    ds_read_b128 v[100:103], v48 offset:58368
    v_cvt_pk_bf16_f32 v140, v58, v59
    v_smfmac_f32_16x16x64_bf16 v[160:163], v[164:167], v[128:135], v168
    v_mfma_f32_16x16x32_bf16 v[208:211], v[104:107], v[128:131], v[208:211]
    s_waitcnt lgkmcnt(6)
    v_exp_f32 v60, v86
    v_exp_f32 v61, v87
    v_mfma_f32_16x16x32_bf16 v[212:215], v[104:107], v[132:135], v[212:215]
    ds_read_b128 v[104:107], v48 offset:59392
    v_cvt_pk_bf16_f32 v141, v60, v61
    v_mfma_f32_16x16x32_bf16 v[220:223], v[108:111], v[132:135], v[220:223]
    s_waitcnt lgkmcnt(6)
    v_exp_f32 v58, v88
    v_exp_f32 v59, v89
    v_mfma_f32_16x16x32_bf16 v[216:219], v[108:111], v[128:131], v[216:219]
    ds_read_b128 v[108:111], v48 offset:60416
    v_cvt_pk_bf16_f32 v138, v58, v59
    v_mfma_f32_16x16x32_bf16 v[224:227], v[112:115], v[128:131], v[224:227]
    s_waitcnt lgkmcnt(6)
    v_exp_f32 v60, v90
    v_exp_f32 v61, v91
    v_mfma_f32_16x16x32_bf16 v[228:231], v[112:115], v[132:135], v[228:231]
    ds_read_b128 v[112:115], v48 offset:61440
    v_cvt_pk_bf16_f32 v139, v60, v61
    v_mfma_f32_16x16x32_bf16 v[236:239], v[116:119], v[132:135], v[236:239]
    s_waitcnt lgkmcnt(6)
    v_exp_f32 v58, v92
    v_exp_f32 v59, v93
    v_mfma_f32_16x16x32_bf16 v[232:235], v[116:119], v[128:131], v[232:235]
    ds_read_b128 v[116:119], v48 offset:62464
    v_cvt_pk_bf16_f32 v142, v58, v59
    v_mfma_f32_16x16x32_bf16 v[240:243], v[120:123], v[128:131], v[240:243]
    s_waitcnt lgkmcnt(6)
    v_exp_f32 v60, v94
    v_exp_f32 v61, v95
    v_mfma_f32_16x16x32_bf16 v[244:247], v[120:123], v[132:135], v[244:247]
    ds_read_b128 v[120:123], v48 offset:63488
    v_cvt_pk_bf16_f32 v143, v60, v61
    v_mfma_f32_16x16x32_bf16 v[252:255], v[124:127], v[132:135], v[252:255]
    s_waitcnt lgkmcnt(6)
    v_or3_b32 v62, v136, v137, v140
    v_or3_b32 v62, v62, v141, v138
    v_or3_b32 v62, v62, v139, v142
    v_bitop3_b32 v62, v62, v143, s72 bitop3:0xa8
    v_cmp_ne_u32 vcc, s65, v62
    v_mfma_f32_16x16x32_bf16 v[248:251], v[124:127], v[128:131], v[248:251]
    ds_read_b128 v[124:127], v48 offset:64512
    s_cbranch_vccnz L_back_18_h
L_back_18:
L_pv3:
    v_mfma_f32_16x16x32_bf16 v[192:195], v[96:99], v[136:139], v[192:195]
    s_waitcnt lgkmcnt(6)
    v_mfma_f32_16x16x32_bf16 v[196:199], v[96:99], v[140:143], v[196:199]
    v_xor_b32 v48, 0x10000, v48
    v_mfma_f32_16x16x32_bf16 v[204:207], v[100:103], v[140:143], v[204:207]
    s_waitcnt lgkmcnt(5)
    v_mfma_f32_16x16x32_bf16 v[200:203], v[100:103], v[136:139], v[200:203]
    v_smfmac_f32_16x16x64_bf16 v[160:163], v[164:167], v[136:143], v168
    s_waitcnt vmcnt(0) lgkmcnt(0)
    s_call_b64 s[82:83], L_pend
    s_barrier
    s_call_b64 s[82:83], L_load
    s_add_i32 s62, s62, 1
    v_mfma_f32_16x16x32_bf16 v[208:211], v[104:107], v[136:139], v[208:211]
    v_mfma_f32_16x16x32_bf16 v[212:215], v[104:107], v[140:143], v[212:215]
    v_mfma_f32_16x16x32_bf16 v[220:223], v[108:111], v[140:143], v[220:223]
    v_mfma_f32_16x16x32_bf16 v[216:219], v[108:111], v[136:139], v[216:219]
    v_mfma_f32_16x16x32_bf16 v[224:227], v[112:115], v[136:139], v[224:227]
    v_mfma_f32_16x16x32_bf16 v[228:231], v[112:115], v[140:143], v[228:231]
    v_mfma_f32_16x16x32_bf16 v[236:239], v[116:119], v[140:143], v[236:239]
    v_mfma_f32_16x16x32_bf16 v[232:235], v[116:119], v[136:139], v[232:235]
    v_mfma_f32_16x16x32_bf16 v[240:243], v[120:123], v[136:139], v[240:243]
    v_mfma_f32_16x16x32_bf16 v[244:247], v[120:123], v[140:143], v[244:247]
    v_mfma_f32_16x16x32_bf16 v[252:255], v[124:127], v[140:143], v[252:255]
    v_mfma_f32_16x16x32_bf16 v[248:251], v[124:127], v[136:139], v[248:251]
    s_branch L_fin
L_tail3:
    s_mov_b32 s65, 0
    v_mfma_f32_16x16x32_bf16 v[192:195], v[96:99], v[136:139], v[192:195]
    s_waitcnt lgkmcnt(6)
    v_exp_f32 v60, v66
    v_exp_f32 v61, v67
    v_mfma_f32_16x16x32_bf16 v[196:199], v[96:99], v[140:143], v[196:199]
    v_cvt_pk_bf16_f32 v128, v58, v59
    v_cvt_pk_bf16_f32 v129, v60, v61
    v_xor_b32 v48, 0x10000, v48
    v_mfma_f32_16x16x32_bf16 v[204:207], v[100:103], v[140:143], v[204:207]
    s_waitcnt lgkmcnt(5)
    v_exp_f32 v58, v68
    v_exp_f32 v59, v69
    v_mfma_f32_16x16x32_bf16 v[200:203], v[100:103], v[136:139], v[200:203]
    v_cvt_pk_bf16_f32 v132, v58, v59
    v_smfmac_f32_16x16x64_bf16 v[160:163], v[164:167], v[136:143], v168
    s_waitcnt vmcnt(0) lgkmcnt(0)
    s_call_b64 s[82:83], L_pend
    s_barrier
    s_call_b64 s[82:83], L_load
    s_add_i32 s62, s62, 1
    ds_read_b128 v[96:99], v48 offset:32768
    ds_read_b128 v[100:103], v48 offset:33792
    v_mfma_f32_16x16x32_bf16 v[208:211], v[104:107], v[136:139], v[208:211]
    v_exp_f32 v60, v70
    v_exp_f32 v61, v71
    v_mfma_f32_16x16x32_bf16 v[212:215], v[104:107], v[140:143], v[212:215]
    ds_read_b128 v[104:107], v48 offset:34816
    v_cvt_pk_bf16_f32 v133, v60, v61
    v_mfma_f32_16x16x32_bf16 v[220:223], v[108:111], v[140:143], v[220:223]
    v_exp_f32 v58, v72
    v_exp_f32 v59, v73
    v_mfma_f32_16x16x32_bf16 v[216:219], v[108:111], v[136:139], v[216:219]
    ds_read_b128 v[108:111], v48 offset:35840
    v_cvt_pk_bf16_f32 v130, v58, v59
    v_mfma_f32_16x16x32_bf16 v[224:227], v[112:115], v[136:139], v[224:227]
    v_exp_f32 v60, v74
    v_exp_f32 v61, v75
    v_mfma_f32_16x16x32_bf16 v[228:231], v[112:115], v[140:143], v[228:231]
    ds_read_b128 v[112:115], v48 offset:36864
    v_cvt_pk_bf16_f32 v131, v60, v61
    v_mfma_f32_16x16x32_bf16 v[236:239], v[116:119], v[140:143], v[236:239]
    v_exp_f32 v58, v76
    v_exp_f32 v59, v77
    v_mfma_f32_16x16x32_bf16 v[232:235], v[116:119], v[136:139], v[232:235]
    ds_read_b128 v[116:119], v48 offset:37888
    v_cvt_pk_bf16_f32 v134, v58, v59
    v_mfma_f32_16x16x32_bf16 v[240:243], v[120:123], v[136:139], v[240:243]
    v_exp_f32 v60, v78
    v_exp_f32 v61, v79
    v_mfma_f32_16x16x32_bf16 v[244:247], v[120:123], v[140:143], v[244:247]
    ds_read_b128 v[120:123], v48 offset:38912
    v_cvt_pk_bf16_f32 v135, v60, v61
    v_mfma_f32_16x16x32_bf16 v[252:255], v[124:127], v[140:143], v[252:255]
    s_waitcnt lgkmcnt(6)
    v_or3_b32 v62, v128, v129, v132
    v_or3_b32 v62, v62, v133, v130
    v_or3_b32 v62, v62, v131, v134
    v_bitop3_b32 v62, v62, v135, s72 bitop3:0xa8
    v_cmp_ne_u32 vcc, s65, v62
    v_mfma_f32_16x16x32_bf16 v[248:251], v[124:127], v[136:139], v[248:251]
    ds_read_b128 v[124:127], v48 offset:39936
    s_cbranch_vccnz L_back_21_h
L_back_21:
L_pv0:
    v_mfma_f32_16x16x32_bf16 v[192:195], v[96:99], v[128:131], v[192:195]
    s_waitcnt lgkmcnt(6)
    v_mfma_f32_16x16x32_bf16 v[196:199], v[96:99], v[132:135], v[196:199]
    v_mfma_f32_16x16x32_bf16 v[204:207], v[100:103], v[132:135], v[204:207]
    s_waitcnt lgkmcnt(5)
    v_mfma_f32_16x16x32_bf16 v[200:203], v[100:103], v[128:131], v[200:203]
    v_smfmac_f32_16x16x64_bf16 v[160:163], v[164:167], v[128:135], v168
    v_mfma_f32_16x16x32_bf16 v[208:211], v[104:107], v[128:131], v[208:211]
    s_waitcnt lgkmcnt(4)
    v_mfma_f32_16x16x32_bf16 v[212:215], v[104:107], v[132:135], v[212:215]
    v_mfma_f32_16x16x32_bf16 v[220:223], v[108:111], v[132:135], v[220:223]
    s_waitcnt lgkmcnt(3)
    v_mfma_f32_16x16x32_bf16 v[216:219], v[108:111], v[128:131], v[216:219]
    v_mfma_f32_16x16x32_bf16 v[224:227], v[112:115], v[128:131], v[224:227]
    s_waitcnt lgkmcnt(2)
    v_mfma_f32_16x16x32_bf16 v[228:231], v[112:115], v[132:135], v[228:231]
    v_mfma_f32_16x16x32_bf16 v[236:239], v[116:119], v[132:135], v[236:239]
    s_waitcnt lgkmcnt(1)
    v_mfma_f32_16x16x32_bf16 v[232:235], v[116:119], v[128:131], v[232:235]
    v_mfma_f32_16x16x32_bf16 v[240:243], v[120:123], v[128:131], v[240:243]
    s_waitcnt lgkmcnt(0)
    v_mfma_f32_16x16x32_bf16 v[244:247], v[120:123], v[132:135], v[244:247]
    v_mfma_f32_16x16x32_bf16 v[252:255], v[124:127], v[132:135], v[252:255]
    v_mfma_f32_16x16x32_bf16 v[248:251], v[124:127], v[128:131], v[248:251]
L_fin:
    v_and_b32 v3, 7, v1
    v_lshlrev_b32 v3, 2, v3
    s_mov_b32 s72, 0x3a0000
    buffer_load_dword v51, v3, s[8:11], s72 offen sc1
    v_add_f32 v56, v160, v161
    v_rcp_f32 v56, v56
    v_add_f32 v57, v162, v163
    v_rcp_f32 v57, v57
    s_lshl_b32 s6, s60, 18
    s_lshl_b32 s7, s4, 12
    s_add_u32 s6, s6, s7
    s_add_u32 s6, s6, 50331648
    s_nop 4
    v_mul_f32 v192, v56, v192
    v_mul_f32 v193, v56, v193
    v_mul_f32 v194, v56, v194
    v_mul_f32 v195, v56, v195
    v_cvt_pk_bf16_f32 v16, v192, v193
    v_cvt_pk_bf16_f32 v17, v194, v195
    v_mul_f32 v200, v56, v200
    v_mul_f32 v201, v56, v201
    v_mul_f32 v202, v56, v202
    v_mul_f32 v203, v56, v203
    v_cvt_pk_bf16_f32 v18, v200, v201
    v_cvt_pk_bf16_f32 v19, v202, v203
    buffer_store_dwordx4 v[16:19], v13, s[8:11], s6 offen offset:0 sc1
    v_mul_f32 v208, v56, v208
    v_mul_f32 v209, v56, v209
    v_mul_f32 v210, v56, v210
    v_mul_f32 v211, v56, v211
    v_cvt_pk_bf16_f32 v20, v208, v209
    v_cvt_pk_bf16_f32 v21, v210, v211
    v_mul_f32 v216, v56, v216
    v_mul_f32 v217, v56, v217
    v_mul_f32 v218, v56, v218
    v_mul_f32 v219, v56, v219
    v_cvt_pk_bf16_f32 v22, v216, v217
    v_cvt_pk_bf16_f32 v23, v218, v219
    buffer_store_dwordx4 v[20:23], v13, s[8:11], s6 offen offset:1024 sc1
    v_mul_f32 v224, v56, v224
    v_mul_f32 v225, v56, v225
    v_mul_f32 v226, v56, v226
    v_mul_f32 v227, v56, v227
    v_cvt_pk_bf16_f32 v24, v224, v225
    v_cvt_pk_bf16_f32 v25, v226, v227
    v_mul_f32 v232, v56, v232
    v_mul_f32 v233, v56, v233
    v_mul_f32 v234, v56, v234
    v_mul_f32 v235, v56, v235
    v_cvt_pk_bf16_f32 v26, v232, v233
    v_cvt_pk_bf16_f32 v27, v234, v235
    buffer_store_dwordx4 v[24:27], v13, s[8:11], s6 offen offset:2048 sc1
    v_mul_f32 v240, v56, v240
    v_mul_f32 v241, v56, v241
    v_mul_f32 v242, v56, v242
    v_mul_f32 v243, v56, v243
    v_cvt_pk_bf16_f32 v28, v240, v241
    v_cvt_pk_bf16_f32 v29, v242, v243
    v_mul_f32 v248, v56, v248
    v_mul_f32 v249, v56, v249
    v_mul_f32 v250, v56, v250
    v_mul_f32 v251, v56, v251
    v_cvt_pk_bf16_f32 v30, v248, v249
    v_cvt_pk_bf16_f32 v31, v250, v251
    buffer_store_dwordx4 v[28:31], v13, s[8:11], s6 offen offset:3072 sc1
    s_add_u32 s6, s6, 0x20000
    v_mul_f32 v196, v57, v196
    v_mul_f32 v197, v57, v197
    v_mul_f32 v198, v57, v198
    v_mul_f32 v199, v57, v199
    v_cvt_pk_bf16_f32 v32, v196, v197
    v_cvt_pk_bf16_f32 v33, v198, v199
    v_mul_f32 v204, v57, v204
    v_mul_f32 v205, v57, v205
    v_mul_f32 v206, v57, v206
    v_mul_f32 v207, v57, v207
    v_cvt_pk_bf16_f32 v34, v204, v205
    v_cvt_pk_bf16_f32 v35, v206, v207
    buffer_store_dwordx4 v[32:35], v13, s[8:11], s6 offen offset:0 sc1
    v_mul_f32 v212, v57, v212
    v_mul_f32 v213, v57, v213
    v_mul_f32 v214, v57, v214
    v_mul_f32 v215, v57, v215
    v_cvt_pk_bf16_f32 v36, v212, v213
    v_cvt_pk_bf16_f32 v37, v214, v215
    v_mul_f32 v220, v57, v220
    v_mul_f32 v221, v57, v221
    v_mul_f32 v222, v57, v222
    v_mul_f32 v223, v57, v223
    v_cvt_pk_bf16_f32 v38, v220, v221
    v_cvt_pk_bf16_f32 v39, v222, v223
    buffer_store_dwordx4 v[36:39], v13, s[8:11], s6 offen offset:1024 sc1
    v_mul_f32 v228, v57, v228
    v_mul_f32 v229, v57, v229
    v_mul_f32 v230, v57, v230
    v_mul_f32 v231, v57, v231
    v_cvt_pk_bf16_f32 v40, v228, v229
    v_cvt_pk_bf16_f32 v41, v230, v231
    v_mul_f32 v236, v57, v236
    v_mul_f32 v237, v57, v237
    v_mul_f32 v238, v57, v238
    v_mul_f32 v239, v57, v239
    v_cvt_pk_bf16_f32 v42, v236, v237
    v_cvt_pk_bf16_f32 v43, v238, v239
    buffer_store_dwordx4 v[40:43], v13, s[8:11], s6 offen offset:2048 sc1
    v_mul_f32 v244, v57, v244
    v_mul_f32 v245, v57, v245
    v_mul_f32 v246, v57, v246
    v_mul_f32 v247, v57, v247
    v_cvt_pk_bf16_f32 v44, v244, v245
    v_cvt_pk_bf16_f32 v45, v246, v247
    v_mul_f32 v252, v57, v252
    v_mul_f32 v253, v57, v253
    v_mul_f32 v254, v57, v254
    v_mul_f32 v255, v57, v255
    v_cvt_pk_bf16_f32 v46, v252, v253
    v_cvt_pk_bf16_f32 v47, v254, v255
    buffer_store_dwordx4 v[44:47], v13, s[8:11], s6 offen offset:3072 sc1
    s_sub_i32 s6, s63, 4
    s_cmp_gt_i32 s62, s6
    s_cbranch_scc1 L_pre
    s_waitcnt vmcnt(8)
    s_call_b64 s[82:83], L_pend
    s_barrier
    s_waitcnt vmcnt(0)
    s_lshl_b32 s6, s60, 5
    s_add_u32 s6, s6, s4
    s_lshl_b32 s6, s6, 7
    s_add_u32 s6, s6, 3932160
    v_mov_b32 v2, 1
    v_mov_b32 v3, 0x5000000
    v_writelane_b32 v3, s6, 0
    buffer_store_dword v2, v3, s[8:11], 0 offen sc1
    s_call_b64 s[82:83], L_load
    s_add_i32 s62, s62, 1
    s_lshl_b32 s6, s3, 8
    s_add_u32 s6, s6, s2
    s_cmp_eq_u32 s6, 31
    s_cbranch_scc1 L_top
L_idle:
    s_sub_i32 s6, s63, 5
    s_cmp_gt_i32 s62, s6
    s_cbranch_scc1 L_pre
    s_waitcnt vmcnt(0) lgkmcnt(0)
    s_call_b64 s[82:83], L_pend
    s_barrier
    s_call_b64 s[82:83], L_load
    s_add_i32 s62, s62, 1
    s_cmp_lt_u32 s61, 54
    s_cbranch_scc1 L_moe
    s_branch L_idle
L_pre:
    s_cmp_lt_u32 s3, 4
    s_cbranch_scc1 L_pre1
    s_barrier
    s_lshl_b32 s7, s76, 13
    s_add_u32 s7, s7, 0x10000
    v_add_u32 v3, s7, v13
    v_add_u32 v2, 0x10000, v3
    s_lshl_b32 s7, s76, 12
    s_add_u32 s7, s7, 0x10000
    v_add_u32 v12, s7, v13
    ds_read_b128 v[96:99], v2 offset:0
    ds_read_b128 v[100:103], v2 offset:1024
    ds_read_b128 v[104:107], v2 offset:2048
    ds_read_b128 v[108:111], v2 offset:3072
    ds_read_b128 v[112:115], v2 offset:4096
    ds_read_b128 v[116:119], v2 offset:5120
    ds_read_b128 v[120:123], v2 offset:6144
    ds_read_b128 v[124:127], v2 offset:7168
    ds_read_b128 v[128:131], v3 offset:0
    ds_read_b128 v[132:135], v3 offset:1024
    ds_read_b128 v[136:139], v3 offset:2048
    ds_read_b128 v[140:143], v3 offset:3072
    s_add_u32 s6, s76, 0
    s_and_b32 s6, s6, 3
    s_lshl_b32 s6, s6, 10
    v_add_u32 v44, s6, v13
    s_add_u32 s6, s76, 1
    s_and_b32 s6, s6, 3
    s_lshl_b32 s6, s6, 10
    v_add_u32 v45, s6, v13
    s_add_u32 s6, s76, 2
    s_and_b32 s6, s6, 3
    s_lshl_b32 s6, s6, 10
    v_add_u32 v46, s6, v13
    s_add_u32 s6, s76, 3
    s_and_b32 s6, s6, 3
    s_lshl_b32 s6, s6, 10
    v_add_u32 v47, s6, v13
    v_add_u32 v52, 4096, v13
    s_lshr_b32 s69, s4, 3
    s_lshl_b32 s69, s69, 2
    s_add_u32 s69, s69, s76
    s_mul_i32 s69, s69, 327680
    s_and_b32 s7, s4, 3
    s_mul_i32 s7, s7, 10240
    s_add_u32 s69, s69, s7
    s_add_u32 s69, s69, 4199424
    s_and_b32 s6, s4, 4
    s_lshr_b32 s7, s4, 3
    s_add_u32 s6, s6, s7
    s_lshl_b32 s7, s5, 3
    s_add_u32 s68, s6, s7
    s_sub_u32 s7, 120, s7
    s_add_u32 s61, s6, s7
    s_lshr_b32 s6, s4, 3
    s_lshl_b32 s6, s6, 15
    s_lshl_b32 s99, s3, 12
    s_add_u32 s66, s6, s99
    s_add_u32 s66, s66, 50331648
    s_lshl_b32 s6, s76, 13
    v_add_u32 v4, s6, v13
    v_add_u32 v7, 65536, v4
    ds_read_b128 v[144:147], v3 offset:4096
    ds_read_b128 v[148:151], v3 offset:5120
    ds_read_b128 v[152:155], v3 offset:6144
    ds_read_b128 v[156:159], v3 offset:7168
    ds_read_b128 v[160:163], v12 offset:49152
    ds_read_b128 v[164:167], v12 offset:50176
    ds_read_b128 v[168:171], v12 offset:51200
    ds_read_b128 v[172:175], v12 offset:52224
    s_waitcnt lgkmcnt(0)
    s_barrier
    s_add_u32 s75, s69, 163840
    buffer_load_dwordx4 v[176:179], v44, s[8:11], s75 offen sc1
    buffer_load_dwordx4 v[180:183], v45, s[8:11], s75 offen sc1
    buffer_load_dwordx4 v[184:187], v46, s[8:11], s75 offen sc1
    buffer_load_dwordx4 v[188:191], v47, s[8:11], s75 offen sc1
    buffer_load_dwordx4 v[192:195], v52, s[8:11], s75 offen sc1
    s_branch L_adone
L_pre1:
    s_mov_b32 s28, s56
    s_mov_b32 s29, s57
    s_mov_b32 s30, 0x100
    s_mov_b32 s31, 0x20000
    v_and_b32 v3, 31, v1
    v_lshlrev_b32 v3, 2, v3
    buffer_load_dword v12, v3, s[28:31], 0 offen offset:128 sc1
    v_and_b32 v3, 7, v1
    v_lshlrev_b32 v3, 2, v3
    s_mov_b32 s72, 0x3a0000
    buffer_load_dword v51, v3, s[8:11], s72 offen sc1
    s_add_u32 s6, s76, 0
    s_and_b32 s6, s6, 3
    s_lshl_b32 s6, s6, 10
    v_add_u32 v44, s6, v13
    s_add_u32 s6, s76, 1
    s_and_b32 s6, s6, 3
    s_lshl_b32 s6, s6, 10
    v_add_u32 v45, s6, v13
    s_add_u32 s6, s76, 2
    s_and_b32 s6, s6, 3
    s_lshl_b32 s6, s6, 10
    v_add_u32 v46, s6, v13
    s_add_u32 s6, s76, 3
    s_and_b32 s6, s6, 3
    s_lshl_b32 s6, s6, 10
    v_add_u32 v47, s6, v13
    v_add_u32 v52, 4096, v13
    s_lshr_b32 s69, s4, 3
    s_lshl_b32 s69, s69, 2
    s_add_u32 s69, s69, s76
    s_mul_i32 s69, s69, 327680
    s_and_b32 s7, s4, 3
    s_mul_i32 s7, s7, 10240
    s_add_u32 s69, s69, s7
    s_add_u32 s69, s69, 4194304
    s_and_b32 s6, s4, 4
    s_lshr_b32 s7, s4, 3
    s_add_u32 s6, s6, s7
    s_lshl_b32 s7, s5, 3
    s_add_u32 s68, s6, s7
    s_sub_u32 s7, 120, s7
    s_add_u32 s61, s6, s7
    s_sub_i32 s6, s63, 4
    s_cmp_gt_i32 s62, s6
    s_cbranch_scc1 L_wpoll
    s_cmp_eq_i32 s62, s63
    s_cbranch_scc1 L_lw0
    s_waitcnt vmcnt(0)
L_lw0:
    s_waitcnt vmcnt(20)
    s_call_b64 s[82:83], L_pend
    s_barrier
    s_call_b64 s[82:83], L_load
    s_add_i32 s62, s62, 1
L_e2:
    v_cmp_gt_u32 vcc, 4, v12
    s_cbranch_vccz L_wok
L_wpoll:
    s_mov_b32 s28, s56
    s_mov_b32 s29, s57
    s_mov_b32 s30, 0x100
    s_mov_b32 s31, 0x20000
    v_and_b32 v3, 31, v1
    v_lshlrev_b32 v3, 2, v3
    s_mov_b32 s79, 262144
L_poll_25:
    buffer_load_dword v2, v3, s[28:31], 0 offen offset:128 sc1
    s_waitcnt vmcnt(0)
    v_cmp_gt_u32 vcc, 4, v2
    s_cbranch_vccz L_polldone_26
    s_sleep 8
    s_sub_u32 s79, s79, 1
    s_cmp_lg_u32 s79, 0
    s_cbranch_scc1 L_poll_25
L_polldone_26:
    s_lshl_b32 s6, s60, 5
    s_add_u32 s6, s6, s4
    s_lshl_b32 s6, s6, 7
    s_add_u32 s6, s6, 3932160
    v_mov_b32 v2, 1
    v_mov_b32 v3, 0x5000000
    v_writelane_b32 v3, s6, 0
    buffer_store_dword v2, v3, s[8:11], 0 offen sc1
L_wok:
    s_mov_b32 s90, 1
    s_add_u32 s75, s69, 0
    buffer_load_dwordx4 v[96:99], v44, s[8:11], s75 offen sc1
    buffer_load_dwordx4 v[100:103], v45, s[8:11], s75 offen sc1
    buffer_load_dwordx4 v[104:107], v46, s[8:11], s75 offen sc1
    buffer_load_dwordx4 v[108:111], v47, s[8:11], s75 offen sc1
    buffer_load_dwordx4 v[112:115], v52, s[8:11], s75 offen sc1
    s_add_u32 s75, s69, 40960
    buffer_load_dwordx4 v[116:119], v44, s[8:11], s75 offen sc1
    buffer_load_dwordx4 v[120:123], v45, s[8:11], s75 offen sc1
    buffer_load_dwordx4 v[124:127], v46, s[8:11], s75 offen sc1
    buffer_load_dwordx4 v[128:131], v47, s[8:11], s75 offen sc1
    buffer_load_dwordx4 v[132:135], v52, s[8:11], s75 offen sc1
    s_add_u32 s75, s69, 81920
    buffer_load_dwordx4 v[136:139], v44, s[8:11], s75 offen sc1
    buffer_load_dwordx4 v[140:143], v45, s[8:11], s75 offen sc1
    buffer_load_dwordx4 v[144:147], v46, s[8:11], s75 offen sc1
    buffer_load_dwordx4 v[148:151], v47, s[8:11], s75 offen sc1
    buffer_load_dwordx4 v[152:155], v52, s[8:11], s75 offen sc1
    s_add_u32 s75, s69, 122880
    buffer_load_dwordx4 v[156:159], v44, s[8:11], s75 offen sc1
    buffer_load_dwordx4 v[160:163], v45, s[8:11], s75 offen sc1
    buffer_load_dwordx4 v[164:167], v46, s[8:11], s75 offen sc1
    buffer_load_dwordx4 v[168:171], v47, s[8:11], s75 offen sc1
    buffer_load_dwordx4 v[172:175], v52, s[8:11], s75 offen sc1
    s_cmp_gt_i32 s62, s63
    s_cbranch_scc1 L_e3
    s_cmp_eq_i32 s62, s63
    s_cbranch_scc1 L_lw1
    s_waitcnt vmcnt(20)
L_lw1:
    s_waitcnt vmcnt(20)
    s_call_b64 s[82:83], L_pend
    s_barrier
    s_call_b64 s[82:83], L_load
    s_add_i32 s62, s62, 1
L_e3:
    s_add_u32 s75, s69, 163840
    buffer_load_dwordx4 v[176:179], v44, s[8:11], s75 offen sc1
    buffer_load_dwordx4 v[180:183], v45, s[8:11], s75 offen sc1
    buffer_load_dwordx4 v[184:187], v46, s[8:11], s75 offen sc1
    buffer_load_dwordx4 v[188:191], v47, s[8:11], s75 offen sc1
    buffer_load_dwordx4 v[192:195], v52, s[8:11], s75 offen sc1
    s_add_u32 s75, s69, 204800
    buffer_load_dwordx4 v[196:199], v44, s[8:11], s75 offen sc1
    buffer_load_dwordx4 v[200:203], v45, s[8:11], s75 offen sc1
    buffer_load_dwordx4 v[204:207], v46, s[8:11], s75 offen sc1
    buffer_load_dwordx4 v[208:211], v47, s[8:11], s75 offen sc1
    buffer_load_dwordx4 v[212:215], v52, s[8:11], s75 offen sc1
    s_cmp_gt_i32 s62, s63
    s_cbranch_scc1 L_e4
    s_cmp_eq_i32 s62, s63
    s_cbranch_scc1 L_lw2
    s_waitcnt vmcnt(10)
L_lw2:
    s_waitcnt vmcnt(20)
    s_call_b64 s[82:83], L_pend
    s_barrier
    s_call_b64 s[82:83], L_load
    s_add_i32 s62, s62, 1
L_e4:
    s_lshr_b32 s7, s3, 1
    s_lshl_b32 s7, s7, 4
    s_add_u32 s6, s5, s7
    s_cmp_lg_u32 s6, 2
    s_cbranch_scc1 L_yl0
    v_min_u32 v3, 53, v1
    v_lshlrev_b32 v3, 7, v3
    s_mov_b32 s72, 0xf20000
    buffer_load_dwordx4 v[16:19], v3, s[8:11], s72 offen sc1
L_yl0:
    s_add_u32 s75, s69, 245760
    buffer_load_dwordx4 v[216:219], v44, s[8:11], s75 offen sc1
    buffer_load_dwordx4 v[220:223], v45, s[8:11], s75 offen sc1
    buffer_load_dwordx4 v[224:227], v46, s[8:11], s75 offen sc1
    buffer_load_dwordx4 v[228:231], v47, s[8:11], s75 offen sc1
    buffer_load_dwordx4 v[232:235], v52, s[8:11], s75 offen sc1
    s_add_u32 s75, s69, 286720
    buffer_load_dwordx4 v[236:239], v44, s[8:11], s75 offen sc1
    buffer_load_dwordx4 v[240:243], v45, s[8:11], s75 offen sc1
    buffer_load_dwordx4 v[244:247], v46, s[8:11], s75 offen sc1
    buffer_load_dwordx4 v[248:251], v47, s[8:11], s75 offen sc1
    buffer_load_dwordx4 v[252:255], v52, s[8:11], s75 offen sc1
    s_cmp_gt_i32 s62, s63
    s_cbranch_scc1 L_e5
    s_cmp_eq_i32 s62, s63
    s_cbranch_scc1 L_lw3
    s_waitcnt vmcnt(10)
L_lw3:
    s_waitcnt vmcnt(20)
    s_call_b64 s[82:83], L_pend
    s_barrier
    s_call_b64 s[82:83], L_load
    s_add_i32 s62, s62, 1
L_e5:
    s_mov_b32 s101, 0
    s_lshr_b32 s7, s3, 1
    s_lshl_b32 s7, s7, 4
    s_add_u32 s6, s5, s7
    s_cmp_lg_u32 s6, 2
    s_cbranch_scc1 L_yl1
    v_and_b32 v16, v16, v17
    v_and_b32 v16, v16, v18
    v_and_b32 v16, v16, v19
    v_cmp_ne_u32 vcc, 1, v16
    s_cbranch_vccnz L_yl1
    s_call_b64 s[80:81], L_yld
L_yl1:
    v_and_b32 v3, 1, v1
    v_lshlrev_b32 v3, 12, v3
    v_and_b32 v2, 2, v1
    v_lshl_add_u32 v3, v2, 8, v3
    s_lshr_b32 s72, s68, 2
    s_lshl_b32 s72, s72, 6
    s_andn2_b32 s6, s4, 7
    s_add_u32 s72, s72, s6
    s_add_u32 s72, s72, s3
    s_lshl_b32 s72, s72, 7
    s_add_u32 s72, s72, 3932160
    buffer_load_dword v50, v3, s[8:11], s72 offen sc1
    s_cmp_gt_i32 s62, s63
    s_cbranch_scc1 L_e6
    s_waitcnt vmcnt(20)
    s_call_b64 s[82:83], L_pend
    s_barrier
    s_call_b64 s[82:83], L_load
    s_add_i32 s62, s62, 1
L_e6:
    s_lshr_b32 s7, s3, 1
    s_lshl_b32 s7, s7, 4
    s_add_u32 s6, s5, s7
    s_cmp_lg_u32 s6, 2
    s_cbranch_scc1 L_yd
    s_cmp_lg_u32 s101, 0
    s_cbranch_scc1 L_yf
    v_min_u32 v3, 53, v1
    v_lshlrev_b32 v3, 7, v3
    s_mov_b32 s72, 0xf20000
    s_mov_b32 s79, 262144
L_poll_31:
    buffer_load_dwordx4 v[16:19], v3, s[8:11], s72 offen sc1
    s_waitcnt vmcnt(0)
    v_and_b32 v16, v16, v17
    v_and_b32 v16, v16, v18
    v_and_b32 v16, v16, v19
    v_cmp_ne_u32 vcc, 1, v16
    s_cbranch_vccz L_polldone_32
    s_sleep 16
    s_sub_u32 s79, s79, 1
    s_cmp_lg_u32 s79, 0
    s_cbranch_scc1 L_poll_31
L_polldone_32:
    s_call_b64 s[80:81], L_yld
L_yf:
    s_bfe_u32 s6, s98, 0x10000b
    s_xor_b32 s7, s6, 0xffff
    s_bitcmp1_b32 s6, 15
    s_bitset0_b32 s6, 15
    s_cselect_b32 s6, s6, s7
    s_lshl_b32 s6, s6, 16
    v_mov_b32 v9, s6
    v_mul_f32 v9, 0xbfb8aa3b, v9
    v_exp_f32 v9, v9
    s_nop 0
    v_add_f32 v9, 1.0, v9
    v_rcp_f32 v9, v9
    s_nop 0
    v_cvt_pk_bf16_f32 v9, v9, v9
    v_lshlrev_b32 v9, 16, v9
    v_lshlrev_b32 v10, 2, v1
    v_mov_b32 v3, 0x5000000
    s_waitcnt vmcnt(0)
    v_pk_add_f32 v[16:17], v[16:17], v[20:21]
    v_pk_add_f32 v[18:19], v[18:19], v[22:23]
    v_pk_add_f32 v[16:17], v[16:17], v[24:25]
    v_pk_add_f32 v[18:19], v[18:19], v[26:27]
    v_pk_add_f32 v[16:17], v[16:17], v[28:29]
    v_pk_add_f32 v[18:19], v[18:19], v[30:31]
    v_pk_add_f32 v[16:17], v[16:17], v[32:33]
    v_pk_add_f32 v[18:19], v[18:19], v[34:35]
    v_pk_add_f32 v[16:17], v[16:17], v[36:37]
    v_pk_add_f32 v[18:19], v[18:19], v[38:39]
    v_pk_add_f32 v[16:17], v[16:17], v[40:41]
    v_pk_add_f32 v[18:19], v[18:19], v[42:43]
    v_pk_add_f32 v[16:17], v[16:17], v[56:57]
    v_pk_add_f32 v[18:19], v[18:19], v[58:59]
    v_pk_add_f32 v[16:17], v[16:17], v[60:61]
    v_pk_add_f32 v[18:19], v[18:19], v[62:63]
    v_pk_add_f32 v[16:17], v[16:17], v[64:65]
    v_pk_add_f32 v[18:19], v[18:19], v[66:67]
    v_pk_add_f32 v[16:17], v[16:17], v[68:69]
    v_pk_add_f32 v[18:19], v[18:19], v[70:71]
    v_pk_add_f32 v[16:17], v[16:17], v[72:73]
    v_pk_add_f32 v[18:19], v[18:19], v[74:75]
    v_pk_add_f32 v[16:17], v[16:17], v[76:77]
    v_pk_add_f32 v[18:19], v[18:19], v[78:79]
    v_pk_add_f32 v[16:17], v[16:17], v[80:81]
    v_pk_add_f32 v[18:19], v[18:19], v[82:83]
    v_pk_add_f32 v[16:17], v[16:17], v[84:85]
    v_pk_add_f32 v[18:19], v[18:19], v[86:87]
    v_pk_add_f32 v[16:17], v[16:17], v[88:89]
    v_pk_add_f32 v[18:19], v[18:19], v[90:91]
    v_pk_add_f32 v[16:17], v[16:17], v[92:93]
    v_pk_add_f32 v[18:19], v[18:19], v[94:95]
    v_pk_add_f32 v[16:17], v[16:17], v[4:5]
    v_pk_add_f32 v[18:19], v[18:19], v[6:7]
    ds_bpermute_b32 v20, v10, v16 offset:80
    ds_bpermute_b32 v21, v10, v17 offset:80
    ds_bpermute_b32 v22, v10, v18 offset:80
    ds_bpermute_b32 v23, v10, v19 offset:80
    ds_bpermute_b32 v24, v10, v16 offset:160
    ds_bpermute_b32 v25, v10, v17 offset:160
    ds_bpermute_b32 v26, v10, v18 offset:160
    ds_bpermute_b32 v27, v10, v19 offset:160
    s_waitcnt lgkmcnt(0)
    v_add_f32 v16, v16, v20
    v_add_f32 v16, v16, v24
    v_cvt_pk_bf16_f32 v16, v16, v16
    v_lshlrev_b32 v16, 16, v16
    v_mul_f32 v16, v16, v9
    v_cvt_pk_bf16_f32 v16, v16, v16
    v_lshlrev_b32 v16, 16, v16
    v_lshlrev_b32 v8, 16, v54
    v_add_f32 v16, v16, v8
    v_add_f32 v17, v17, v21
    v_add_f32 v17, v17, v25
    v_cvt_pk_bf16_f32 v17, v17, v17
    v_lshlrev_b32 v17, 16, v17
    v_mul_f32 v17, v17, v9
    v_cvt_pk_bf16_f32 v17, v17, v17
    v_lshlrev_b32 v17, 16, v17
    v_and_b32 v8, 0xffff0000, v54
    v_add_f32 v17, v17, v8
    v_add_f32 v18, v18, v22
    v_add_f32 v18, v18, v26
    v_cvt_pk_bf16_f32 v18, v18, v18
    v_lshlrev_b32 v18, 16, v18
    v_mul_f32 v18, v18, v9
    v_cvt_pk_bf16_f32 v18, v18, v18
    v_lshlrev_b32 v18, 16, v18
    v_lshlrev_b32 v8, 16, v55
    v_add_f32 v18, v18, v8
    v_add_f32 v19, v19, v23
    v_add_f32 v19, v19, v27
    v_cvt_pk_bf16_f32 v19, v19, v19
    v_lshlrev_b32 v19, 16, v19
    v_mul_f32 v19, v19, v9
    v_cvt_pk_bf16_f32 v19, v19, v19
    v_lshlrev_b32 v19, 16, v19
    v_and_b32 v8, 0xffff0000, v55
    v_add_f32 v19, v19, v8
    v_cvt_pk_bf16_f32 v20, v16, v17
    v_cvt_pk_bf16_f32 v21, v18, v19
    v_lshlrev_b32 v2, 3, v1
    v_cmp_lt_u32 vcc, 19, v1
    s_mul_i32 s6, s96, 1280
    s_mul_i32 s7, s97, 160
    v_cndmask_b32 v2, v2, v3, vcc
    s_add_u32 s6, s6, s7
    s_add_u32 s6, s6, 3837952
    buffer_store_dwordx2 v[20:21], v2, s[8:11], s6 offen sc1
L_yd:
    s_lshr_b32 s6, s4, 3
    s_lshl_b32 s6, s6, 15
    s_lshl_b32 s99, s3, 12
    s_add_u32 s66, s6, s99
    s_add_u32 s66, s66, 50331648
    s_lshl_b32 s6, s76, 13
    v_add_u32 v4, s6, v13
    v_add_u32 v7, 65536, v4
    s_waitcnt vmcnt(0)
    v_cmp_ne_u32 vcc, 1, v50
    s_cbranch_vccz L_ce
    v_and_b32 v3, 1, v1
    v_lshlrev_b32 v3, 12, v3
    v_and_b32 v2, 2, v1
    v_lshl_add_u32 v3, v2, 8, v3
    s_lshr_b32 s72, s68, 2
    s_lshl_b32 s72, s72, 6
    s_andn2_b32 s6, s4, 7
    s_add_u32 s72, s72, s6
    s_add_u32 s72, s72, s3
    s_lshl_b32 s72, s72, 7
    s_add_u32 s72, s72, 3932160
    s_mov_b32 s79, 262144
L_poll_33:
    buffer_load_dword v2, v3, s[8:11], s72 offen sc1
    s_waitcnt vmcnt(0)
    v_cmp_ne_u32 vcc, 1, v2
    s_cbranch_vccz L_polldone_34
    s_sleep 4
    s_sub_u32 s79, s79, 1
    s_cmp_lg_u32 s79, 0
    s_cbranch_scc1 L_poll_33
L_polldone_34:
L_ce:
    s_add_u32 s65, s68, 1
    s_and_b32 s65, s65, 3
    s_andn2_b32 s7, s68, 3
    s_add_u32 s65, s65, s7
    s_lshl_b32 s65, s65, 17
    s_add_u32 s65, s65, s66
    s_add_u32 m0, s99, 0
    s_add_u32 s65, s65, 0
    buffer_load_dwordx4 v13, s[8:11], s65 offen offset:0 sc1 lds
    buffer_load_dwordx4 v13, s[8:11], s65 offen offset:1024 sc1 lds
    buffer_load_dwordx4 v13, s[8:11], s65 offen offset:2048 sc1 lds
    buffer_load_dwordx4 v13, s[8:11], s65 offen offset:3072 sc1 lds
    s_add_u32 s65, s68, 1
    s_and_b32 s65, s65, 3
    s_andn2_b32 s7, s68, 3
    s_add_u32 s65, s65, s7
    s_lshl_b32 s65, s65, 17
    s_add_u32 s65, s65, s66
    s_add_u32 m0, s99, 16384
    s_add_u32 s65, s65, 16384
    buffer_load_dwordx4 v13, s[8:11], s65 offen offset:0 sc1 lds
    buffer_load_dwordx4 v13, s[8:11], s65 offen offset:1024 sc1 lds
    buffer_load_dwordx4 v13, s[8:11], s65 offen offset:2048 sc1 lds
    buffer_load_dwordx4 v13, s[8:11], s65 offen offset:3072 sc1 lds
    s_add_u32 s65, s68, 2
    s_and_b32 s65, s65, 3
    s_andn2_b32 s7, s68, 3
    s_add_u32 s65, s65, s7
    s_lshl_b32 s65, s65, 17
    s_add_u32 s65, s65, s66
    s_add_u32 m0, s99, 32768
    s_add_u32 s65, s65, 0
    buffer_load_dwordx4 v13, s[8:11], s65 offen offset:0 sc1 lds
    buffer_load_dwordx4 v13, s[8:11], s65 offen offset:1024 sc1 lds
    buffer_load_dwordx4 v13, s[8:11], s65 offen offset:2048 sc1 lds
    buffer_load_dwordx4 v13, s[8:11], s65 offen offset:3072 sc1 lds
    s_add_u32 s65, s68, 2
    s_and_b32 s65, s65, 3
    s_andn2_b32 s7, s68, 3
    s_add_u32 s65, s65, s7
    s_lshl_b32 s65, s65, 17
    s_add_u32 s65, s65, s66
    s_add_u32 m0, s99, 49152
    s_add_u32 s65, s65, 16384
    buffer_load_dwordx4 v13, s[8:11], s65 offen offset:0 sc1 lds
    buffer_load_dwordx4 v13, s[8:11], s65 offen offset:1024 sc1 lds
    buffer_load_dwordx4 v13, s[8:11], s65 offen offset:2048 sc1 lds
    buffer_load_dwordx4 v13, s[8:11], s65 offen offset:3072 sc1 lds
    s_lshr_b32 s7, s3, 1
    s_lshl_b32 s7, s7, 4
    s_add_u32 s6, s5, s7
    s_cmp_lg_u32 s6, 2
    s_cbranch_scc1 L_yg
    s_lshl_b32 s6, s5, 5
    s_add_u32 s6, s6, s4
    s_lshl_b32 s6, s6, 5
    s_add_u32 s6, s6, s3
    s_lshl_b32 s6, s6, 2
    s_add_u32 s6, s6, 3899392
    v_mov_b32 v2, 1
    v_mov_b32 v3, 0x5000000
    v_writelane_b32 v3, s6, 0
    buffer_store_dword v2, v3, s[8:11], 0 offen sc1
    s_waitcnt vmcnt(1)
    s_branch L_ye
L_yg:
    s_waitcnt vmcnt(0)
L_ye:
    s_setprio 0
    s_barrier
    s_branch L_adone
L_yld:
    v_cmp_le_i32 vcc, 0, v51
    s_cbranch_vccz L_idx_oka
    v_and_b32 v3, 7, v1
    v_lshlrev_b32 v3, 2, v3
    s_mov_b32 s72, 0x3a0000
    s_mov_b32 s79, 262144
L_poll_35:
    buffer_load_dword v51, v3, s[8:11], s72 offen sc1
    s_waitcnt vmcnt(0)
    v_cmp_le_i32 vcc, 0, v51
    s_cbranch_vccz L_polldone_36
    s_sleep 2
    s_sub_u32 s79, s79, 1
    s_cmp_lg_u32 s79, 0
    s_cbranch_scc1 L_poll_35
L_polldone_36:
L_idx_oka:
    s_lshr_b32 s96, s4, 2
    s_and_b32 s97, s4, 3
    s_lshl_b32 s97, s97, 1
    s_add_u32 s97, s97, s3
    s_mov_b32 m0, s96
    s_nop 3
    v_readlane_b32 s98, v51, m0
    s_nop 3
    s_and_b32 s100, s98, 0x7ff
    s_sub_u32 s100, 0x7ff, s100
    v_mul_u32_u24 v2, 13, v1
    v_lshrrev_b32 v2, 8, v2
    v_mul_u32_u24 v3, 20, v2
    v_sub_u32 v8, v1, v3
    s_mov_b32 s6, 368640
    v_mul_lo_u32 v2, v2, s6
    v_lshl_add_u32 v2, v8, 4, v2
    v_cmp_lt_u32 vcc, 59, v1
    v_mov_b32 v3, 0x5000000
    s_nop 0
    v_cndmask_b32 v2, v2, v3, vcc
    s_mul_i32 s6, s96, 2560
    s_mul_i32 s7, s97, 320
    s_add_u32 s6, s6, s7
    s_add_u32 s6, s6, 2686976
    buffer_load_dwordx4 v[16:19], v2, s[8:11], s6 offen sc1
    s_add_u32 s6, s6, 20480
    buffer_load_dwordx4 v[20:23], v2, s[8:11], s6 offen sc1
    s_add_u32 s6, s6, 20480
    buffer_load_dwordx4 v[24:27], v2, s[8:11], s6 offen sc1
    s_add_u32 s6, s6, 20480
    buffer_load_dwordx4 v[28:31], v2, s[8:11], s6 offen sc1
    s_add_u32 s6, s6, 20480
    buffer_load_dwordx4 v[32:35], v2, s[8:11], s6 offen sc1
    s_add_u32 s6, s6, 20480
    buffer_load_dwordx4 v[36:39], v2, s[8:11], s6 offen sc1
    s_add_u32 s6, s6, 20480
    buffer_load_dwordx4 v[40:43], v2, s[8:11], s6 offen sc1
    s_add_u32 s6, s6, 20480
    buffer_load_dwordx4 v[56:59], v2, s[8:11], s6 offen sc1
    s_add_u32 s6, s6, 20480
    buffer_load_dwordx4 v[60:63], v2, s[8:11], s6 offen sc1
    s_add_u32 s6, s6, 20480
    buffer_load_dwordx4 v[64:67], v2, s[8:11], s6 offen sc1
    s_add_u32 s6, s6, 20480
    buffer_load_dwordx4 v[68:71], v2, s[8:11], s6 offen sc1
    s_add_u32 s6, s6, 20480
    buffer_load_dwordx4 v[72:75], v2, s[8:11], s6 offen sc1
    s_add_u32 s6, s6, 20480
    buffer_load_dwordx4 v[76:79], v2, s[8:11], s6 offen sc1
    s_add_u32 s6, s6, 20480
    buffer_load_dwordx4 v[80:83], v2, s[8:11], s6 offen sc1
    s_add_u32 s6, s6, 20480
    buffer_load_dwordx4 v[84:87], v2, s[8:11], s6 offen sc1
    s_add_u32 s6, s6, 20480
    buffer_load_dwordx4 v[88:91], v2, s[8:11], s6 offen sc1
    s_add_u32 s6, s6, 20480
    buffer_load_dwordx4 v[92:95], v2, s[8:11], s6 offen sc1
    s_add_u32 s6, s6, 20480
    buffer_load_dwordx4 v[4:7], v2, s[8:11], s6 offen sc1
    s_add_u32 s6, s6, 20480
    s_lshr_b32 s6, s100, 4
    s_mul_i32 s6, s6, 20480
    s_and_b32 s7, s100, 15
    s_lshl_b32 s7, s7, 4
    s_add_u32 s6, s6, s7
    s_mul_i32 s7, s97, 2560
    s_add_u32 s6, s6, s7
    v_lshrrev_b32 v9, 1, v8
    v_lshlrev_b32 v9, 8, v9
    v_and_b32 v10, 1, v8
    v_lshl_add_u32 v9, v10, 3, v9
    buffer_load_dwordx2 v[54:55], v9, s[8:11], s6 offen sc1
    s_mov_b32 s101, 1
    s_setpc_b64 s[80:81]
L_moe:
    s_add_u32 s6, s62, s5
    s_cmp_lg_u32 s6, 5
    s_cbranch_scc1 L_idle
    s_mov_b32 s12, s48
    s_mov_b32 s13, s49
    s_mov_b32 s14, 0x21c000
    s_mov_b32 s15, 0x20000
    s_cmp_ge_u32 s3, 2
    s_cselect_b32 s12, s50, s12
    s_cselect_b32 s13, s51, s13
    s_mov_b32 s16, s52
    s_mov_b32 s17, s53
    s_mov_b32 s18, 0x21c000
    s_mov_b32 s19, 0x20000
    v_lshrrev_b32 v3, 2, v1
    v_mul_u32_u24 v3, 3456, v3
    v_and_b32 v4, 3, v1
    v_lshl_add_u32 v16, v4, 4, v3
    v_lshrrev_b32 v3, 3, v1
    v_mul_u32_u24 v3, 1280, v3
    v_and_b32 v4, 7, v1
    v_lshl_add_u32 v18, v4, 4, v3
    s_and_b32 s7, s3, 1
    s_mul_i32 s84, s7, 1105920
    s_lshl_b32 s6, s61, 6
    s_add_u32 s84, s84, s6
    s_lshl_b32 s85, s3, 13
    s_add_u32 s85, s85, 131072
    s_mul_i32 s86, s61, 40960
    s_lshl_b32 s6, s3, 7
    s_add_u32 s86, s86, s6
    s_add_u32 m0, s85, 0
    s_nop 0
    buffer_load_dwordx4 v16, s[12:15], s84 offen lds
    s_add_u32 s84, s84, 55296
    s_add_u32 m0, s85, 1024
    s_nop 0
    buffer_load_dwordx4 v16, s[12:15], s84 offen lds
    s_add_u32 s84, s84, 55296
    s_add_u32 m0, s85, 2048
    s_nop 0
    buffer_load_dwordx4 v16, s[12:15], s84 offen lds
    s_add_u32 s84, s84, 55296
    s_add_u32 m0, s85, 3072
    s_nop 0
    buffer_load_dwordx4 v16, s[12:15], s84 offen lds
    s_add_u32 s84, s84, 55296
    s_add_u32 m0, s85, 4096
    s_nop 0
    buffer_load_dwordx4 v16, s[12:15], s84 offen lds
    s_add_u32 s84, s84, 55296
    s_add_u32 m0, s85, 5120
    s_nop 0
    buffer_load_dwordx4 v16, s[12:15], s84 offen lds
    s_add_u32 s84, s84, 55296
    s_add_u32 m0, s85, 6144
    s_nop 0
    buffer_load_dwordx4 v16, s[12:15], s84 offen lds
    s_add_u32 s84, s84, 55296
    s_add_u32 m0, s85, 7168
    s_nop 0
    buffer_load_dwordx4 v16, s[12:15], s84 offen lds
    s_add_u32 s84, s84, 55296
    v_lshrrev_b32 v7, 4, v1
    v_and_b32 v2, 15, v1
    v_lshrrev_b32 v3, 2, v2
    v_lshl_add_u32 v8, v7, 3, v3
    v_lshlrev_b32 v8, 6, v8
    v_and_b32 v4, 3, v2
    v_lshl_add_u32 v8, v4, 3, v8
    v_add_u32 v17, s85, v8
    v_lshl_add_u32 v8, v7, 2, v3
    v_lshlrev_b32 v8, 7, v8
    v_lshl_add_u32 v8, v4, 3, v8
    s_add_u32 s6, s85, 4096
    v_add_u32 v19, s6, v8
    v_mul_u32_u24 v3, 2560, v2
    v_lshl_add_u32 v3, v7, 4, v3
    v_mov_b32 v4, 0x5000000
    v_cmp_gt_u32 vcc, 8, v2
    s_mul_i32 s87, s61, 20480
    s_lshl_b32 s7, s3, 8
    s_add_u32 s87, s87, s7
    s_add_u32 s87, s87, 2686976
    v_cndmask_b32 v20, v4, v3, vcc
    s_and_b32 s7, s3, 1
    s_mul_i32 s88, s7, 10240
    s_add_u32 s88, s88, 12582912
    s_waitcnt vmcnt(0) lgkmcnt(0)
    s_call_b64 s[82:83], L_pend
    s_barrier
    ds_read_b64_tr_b16 v[104:105], v17 offset:0
    ds_read_b64_tr_b16 v[106:107], v17 offset:256
    ds_read_b64_tr_b16 v[108:109], v17 offset:32
    ds_read_b64_tr_b16 v[110:111], v17 offset:288
    ds_read_b64_tr_b16 v[112:113], v17 offset:2048
    ds_read_b64_tr_b16 v[114:115], v17 offset:2304
    ds_read_b64_tr_b16 v[116:117], v17 offset:2080
    ds_read_b64_tr_b16 v[118:119], v17 offset:2336
    s_waitcnt lgkmcnt(0)
    ds_read_b64_tr_b16 v[120:121], v17 offset:4096
    ds_read_b64_tr_b16 v[122:123], v17 offset:4352
    ds_read_b64_tr_b16 v[124:125], v17 offset:4128
    ds_read_b64_tr_b16 v[126:127], v17 offset:4384
    ds_read_b64_tr_b16 v[128:129], v17 offset:6144
    ds_read_b64_tr_b16 v[130:131], v17 offset:6400
    ds_read_b64_tr_b16 v[132:133], v17 offset:6176
    ds_read_b64_tr_b16 v[134:135], v17 offset:6432
    s_waitcnt lgkmcnt(0)
    s_add_u32 m0, s85, 0
    s_nop 0
    buffer_load_dwordx4 v16, s[12:15], s84 offen lds
    s_add_u32 s84, s84, 55296
    s_add_u32 m0, s85, 1024
    s_nop 0
    buffer_load_dwordx4 v16, s[12:15], s84 offen lds
    s_add_u32 s84, s84, 55296
    s_add_u32 m0, s85, 2048
    s_nop 0
    buffer_load_dwordx4 v16, s[12:15], s84 offen lds
    s_add_u32 s84, s84, 55296
    s_add_u32 m0, s85, 3072
    s_nop 0
    buffer_load_dwordx4 v16, s[12:15], s84 offen lds
    s_add_u32 s84, s84, 55296
    s_add_u32 m0, s85, 4096
    s_nop 0
    buffer_load_dwordx4 v16, s[12:15], s84 offen lds
    s_add_u32 s84, s84, 55296
    s_add_u32 m0, s85, 5120
    s_nop 0
    buffer_load_dwordx4 v16, s[12:15], s84 offen lds
    s_add_u32 s84, s84, 55296
    s_add_u32 m0, s85, 6144
    s_nop 0
    buffer_load_dwordx4 v16, s[12:15], s84 offen lds
    s_add_u32 s84, s84, 55296
    s_add_u32 m0, s85, 7168
    s_nop 0
    buffer_load_dwordx4 v16, s[12:15], s84 offen lds
    s_add_u32 s84, s84, 55296
    s_call_b64 s[82:83], L_load
    s_add_i32 s62, s62, 1
    v_and_b32 v3, 7, v1
    v_lshlrev_b32 v3, 2, v3
    s_mov_b32 s72, 0x3a0000
    buffer_load_dword v51, v3, s[8:11], s72 offen sc1
    s_waitcnt vmcnt(0) lgkmcnt(0)
    s_call_b64 s[82:83], L_pend
    s_barrier
    ds_read_b64_tr_b16 v[136:137], v17 offset:0
    ds_read_b64_tr_b16 v[138:139], v17 offset:256
    ds_read_b64_tr_b16 v[140:141], v17 offset:32
    ds_read_b64_tr_b16 v[142:143], v17 offset:288
    ds_read_b64_tr_b16 v[144:145], v17 offset:2048
    ds_read_b64_tr_b16 v[146:147], v17 offset:2304
    ds_read_b64_tr_b16 v[148:149], v17 offset:2080
    ds_read_b64_tr_b16 v[150:151], v17 offset:2336
    s_waitcnt lgkmcnt(0)
    ds_read_b64_tr_b16 v[152:153], v17 offset:4096
    ds_read_b64_tr_b16 v[154:155], v17 offset:4352
    ds_read_b64_tr_b16 v[156:157], v17 offset:4128
    ds_read_b64_tr_b16 v[158:159], v17 offset:4384
    ds_read_b64_tr_b16 v[160:161], v17 offset:6144
    ds_read_b64_tr_b16 v[162:163], v17 offset:6400
    ds_read_b64_tr_b16 v[164:165], v17 offset:6176
    ds_read_b64_tr_b16 v[166:167], v17 offset:6432
    s_waitcnt lgkmcnt(0)
    s_add_u32 m0, s85, 0
    s_nop 0
    buffer_load_dwordx4 v16, s[12:15], s84 offen lds
    s_add_u32 s84, s84, 55296
    s_add_u32 m0, s85, 1024
    s_nop 0
    buffer_load_dwordx4 v16, s[12:15], s84 offen lds
    s_add_u32 s84, s84, 55296
    s_add_u32 m0, s85, 2048
    s_nop 0
    buffer_load_dwordx4 v16, s[12:15], s84 offen lds
    s_add_u32 s84, s84, 55296
    s_add_u32 m0, s85, 3072
    s_nop 0
    buffer_load_dwordx4 v16, s[12:15], s84 offen lds
    s_add_u32 s84, s84, 55296
    s_add_u32 m0, s85, 4096
    s_add_u32 s6, s86, 0
    buffer_load_dwordx4 v18, s[16:19], s6 offen lds
    s_add_u32 m0, s85, 5120
    s_add_u32 s6, s86, 10240
    buffer_load_dwordx4 v18, s[16:19], s6 offen lds
    s_add_u32 m0, s85, 6144
    s_add_u32 s6, s86, 20480
    buffer_load_dwordx4 v18, s[16:19], s6 offen lds
    s_add_u32 m0, s85, 7168
    s_add_u32 s6, s86, 30720
    buffer_load_dwordx4 v18, s[16:19], s6 offen lds
    s_add_u32 s86, s86, 512
    s_call_b64 s[82:83], L_load
    s_add_i32 s62, s62, 1
    v_cmp_le_i32 vcc, 0, v51
    s_cbranch_vccz L_idx_okm
    v_and_b32 v3, 7, v1
    v_lshlrev_b32 v3, 2, v3
    s_mov_b32 s72, 0x3a0000
    s_mov_b32 s79, 262144
L_poll_39:
    buffer_load_dword v51, v3, s[8:11], s72 offen sc1
    s_waitcnt vmcnt(0)
    v_cmp_le_i32 vcc, 0, v51
    s_cbranch_vccz L_polldone_40
    s_sleep 2
    s_sub_u32 s79, s79, 1
    s_cmp_lg_u32 s79, 0
    s_cbranch_scc1 L_poll_39
L_polldone_40:
L_idx_okm:
    buffer_load_dwordx4 v[64:67], v13, s[8:11], s88 offen sc1
    s_add_u32 s88, s88, 1024
    buffer_load_dwordx4 v[68:71], v13, s[8:11], s88 offen sc1
    s_add_u32 s88, s88, 1024
    buffer_load_dwordx4 v[72:75], v13, s[8:11], s88 offen sc1
    s_add_u32 s88, s88, 1024
    buffer_load_dwordx4 v[76:79], v13, s[8:11], s88 offen sc1
    s_add_u32 s88, s88, 1024
    buffer_load_dwordx4 v[80:83], v13, s[8:11], s88 offen sc1
    s_add_u32 s88, s88, 1024
    buffer_load_dwordx4 v[84:87], v13, s[8:11], s88 offen sc1
    s_add_u32 s88, s88, 1024
    buffer_load_dwordx4 v[88:91], v13, s[8:11], s88 offen sc1
    s_add_u32 s88, s88, 1024
    buffer_load_dwordx4 v[92:95], v13, s[8:11], s88 offen sc1
    s_add_u32 s88, s88, 1024
    buffer_load_dwordx4 v[96:99], v13, s[8:11], s88 offen sc1
    s_add_u32 s88, s88, 1024
    buffer_load_dwordx4 v[100:103], v13, s[8:11], s88 offen sc1
    s_add_u32 s88, s88, 1024
    s_waitcnt vmcnt(10) lgkmcnt(0)
    s_call_b64 s[82:83], L_pend
    s_barrier
    ds_read_b64_tr_b16 v[168:169], v17 offset:0
    ds_read_b64_tr_b16 v[170:171], v17 offset:256
    ds_read_b64_tr_b16 v[172:173], v17 offset:32
    ds_read_b64_tr_b16 v[174:175], v17 offset:288
    ds_read_b64_tr_b16 v[176:177], v17 offset:2048
    ds_read_b64_tr_b16 v[178:179], v17 offset:2304
    ds_read_b64_tr_b16 v[180:181], v17 offset:2080
    ds_read_b64_tr_b16 v[182:183], v17 offset:2336
    s_waitcnt lgkmcnt(0)
    ds_read_b64_tr_b16 v[32:33], v19 offset:0
    ds_read_b64_tr_b16 v[34:35], v19 offset:2048
    ds_read_b64_tr_b16 v[36:37], v19 offset:32
    ds_read_b64_tr_b16 v[38:39], v19 offset:2080
    ds_read_b64_tr_b16 v[40:41], v19 offset:64
    ds_read_b64_tr_b16 v[42:43], v19 offset:2112
    ds_read_b64_tr_b16 v[44:45], v19 offset:96
    ds_read_b64_tr_b16 v[46:47], v19 offset:2144
    s_waitcnt lgkmcnt(0)
    s_add_u32 m0, s85, 4096
    s_add_u32 s6, s86, 0
    buffer_load_dwordx4 v18, s[16:19], s6 offen lds
    s_add_u32 m0, s85, 5120
    s_add_u32 s6, s86, 10240
    buffer_load_dwordx4 v18, s[16:19], s6 offen lds
    s_add_u32 m0, s85, 6144
    s_add_u32 s6, s86, 20480
    buffer_load_dwordx4 v18, s[16:19], s6 offen lds
    s_add_u32 m0, s85, 7168
    s_add_u32 s6, s86, 30720
    buffer_load_dwordx4 v18, s[16:19], s6 offen lds
    s_add_u32 s86, s86, 512
    s_call_b64 s[82:83], L_load
    s_add_i32 s62, s62, 1
    s_waitcnt vmcnt(20)
    v_mfma_f32_16x16x32_bf16 v[24:27], v[104:107], v[64:67], 0
    v_mfma_f32_16x16x32_bf16 v[28:31], v[108:111], v[64:67], 0
    v_mfma_f32_16x16x32_bf16 v[24:27], v[112:115], v[68:71], v[24:27]
    v_mfma_f32_16x16x32_bf16 v[28:31], v[116:119], v[68:71], v[28:31]
    v_mfma_f32_16x16x32_bf16 v[24:27], v[120:123], v[72:75], v[24:27]
    v_mfma_f32_16x16x32_bf16 v[28:31], v[124:127], v[72:75], v[28:31]
    v_mfma_f32_16x16x32_bf16 v[24:27], v[128:131], v[76:79], v[24:27]
    v_mfma_f32_16x16x32_bf16 v[28:31], v[132:135], v[76:79], v[28:31]
    v_mfma_f32_16x16x32_bf16 v[24:27], v[136:139], v[80:83], v[24:27]
    v_mfma_f32_16x16x32_bf16 v[28:31], v[140:143], v[80:83], v[28:31]
    v_mfma_f32_16x16x32_bf16 v[24:27], v[144:147], v[84:87], v[24:27]
    v_mfma_f32_16x16x32_bf16 v[28:31], v[148:151], v[84:87], v[28:31]
    v_mfma_f32_16x16x32_bf16 v[24:27], v[152:155], v[88:91], v[24:27]
    v_mfma_f32_16x16x32_bf16 v[28:31], v[156:159], v[88:91], v[28:31]
    v_mfma_f32_16x16x32_bf16 v[24:27], v[160:163], v[92:95], v[24:27]
    v_mfma_f32_16x16x32_bf16 v[28:31], v[164:167], v[92:95], v[28:31]
    v_mfma_f32_16x16x32_bf16 v[24:27], v[168:171], v[96:99], v[24:27]
    v_mfma_f32_16x16x32_bf16 v[28:31], v[172:175], v[96:99], v[28:31]
    v_mfma_f32_16x16x32_bf16 v[24:27], v[176:179], v[100:103], v[24:27]
    v_mfma_f32_16x16x32_bf16 v[28:31], v[180:183], v[100:103], v[28:31]
    v_add_u32 v10, s85, v13
    s_nop 7
    ds_write_b128 v10, v[24:27]
    ds_write_b128 v10, v[28:31] offset:1024
    s_waitcnt vmcnt(0) lgkmcnt(0)
    s_call_b64 s[82:83], L_pend
    s_barrier
    ds_read_b64_tr_b16 v[240:241], v19 offset:0
    ds_read_b64_tr_b16 v[242:243], v19 offset:2048
    ds_read_b64_tr_b16 v[244:245], v19 offset:32
    ds_read_b64_tr_b16 v[246:247], v19 offset:2080
    ds_read_b64_tr_b16 v[248:249], v19 offset:64
    ds_read_b64_tr_b16 v[250:251], v19 offset:2112
    ds_read_b64_tr_b16 v[252:253], v19 offset:96
    ds_read_b64_tr_b16 v[254:255], v19 offset:2144
    s_lshr_b32 s6, s3, 1
    s_lshl_b32 s6, s6, 10
    s_and_b32 s7, s3, 1
    s_lshl_b32 s7, s7, 3
    s_add_u32 s6, s6, s7
    s_add_u32 s6, s6, 131072
    v_add_u32 v10, s6, v13
    s_waitcnt lgkmcnt(0)
    ds_read_b64 v[184:185], v10 offset:0
    ds_read_b64 v[186:187], v10 offset:8192
    ds_read_b64 v[188:189], v10 offset:16384
    ds_read_b64 v[190:191], v10 offset:24576
    s_cmp_ge_u32 s3, 2
    s_cbranch_scc1 L_moe4b
    s_add_u32 m0, s85, 4096
    s_add_u32 s6, s86, 0
    buffer_load_dwordx4 v18, s[16:19], s6 offen lds
    s_add_u32 m0, s85, 5120
    s_add_u32 s6, s86, 10240
    buffer_load_dwordx4 v18, s[16:19], s6 offen lds
    s_add_u32 m0, s85, 6144
    s_add_u32 s6, s86, 20480
    buffer_load_dwordx4 v18, s[16:19], s6 offen lds
    s_add_u32 m0, s85, 7168
    s_add_u32 s6, s86, 30720
    buffer_load_dwordx4 v18, s[16:19], s6 offen lds
    s_add_u32 s86, s86, 512
L_moe4b:
    s_call_b64 s[82:83], L_load
    s_add_i32 s62, s62, 1
    s_waitcnt lgkmcnt(0)
    s_mov_b32 s6, 0xbfb8aa3b
    v_add_f32 v184, v184, v186
    v_add_f32 v188, v188, v190
    v_add_f32 v185, v185, v187
    v_add_f32 v189, v189, v191
    v_cvt_pk_bf16_f32 v185, v184, v185
    v_lshlrev_b32 v184, 16, v185
    v_and_b32 v185, 0xffff0000, v185
    v_cvt_pk_bf16_f32 v189, v188, v189
    v_lshlrev_b32 v188, 16, v189
    v_and_b32 v189, 0xffff0000, v189
    v_mul_f32 v2, s6, v184
    v_mul_f32 v3, s6, v185
    v_exp_f32 v2, v2
    v_exp_f32 v3, v3
    s_nop 0
    v_add_f32 v2, 1.0, v2
    v_add_f32 v3, 1.0, v3
    v_rcp_f32 v2, v2
    v_rcp_f32 v3, v3
    s_nop 0
    v_mul_f32 v184, v184, v2
    v_mul_f32 v185, v185, v3
    v_cvt_pk_bf16_f32 v185, v184, v185
    v_lshlrev_b32 v184, 16, v185
    v_and_b32 v185, 0xffff0000, v185
    v_mul_f32 v184, v184, v188
    v_mul_f32 v185, v185, v189
    v_cvt_pk_bf16_f32 v2, v184, v185
    s_lshl_b32 s6, s3, 2
    s_add_u32 s6, s6, 133120
    v_add_u32 v10, s6, v13
    ds_write_b32 v10, v2
    s_waitcnt vmcnt(0) lgkmcnt(0)
    s_call_b64 s[82:83], L_pend
    s_barrier
    v_add_u32 v10, 133120, v13
    ds_read_b128 v[24:27], v10
    ds_read_b64_tr_b16 v[104:105], v19 offset:0
    ds_read_b64_tr_b16 v[106:107], v19 offset:2048
    ds_read_b64_tr_b16 v[108:109], v19 offset:32
    ds_read_b64_tr_b16 v[110:111], v19 offset:2080
    ds_read_b64_tr_b16 v[112:113], v19 offset:64
    ds_read_b64_tr_b16 v[114:115], v19 offset:2112
    ds_read_b64_tr_b16 v[116:117], v19 offset:96
    ds_read_b64_tr_b16 v[118:119], v19 offset:2144
    s_call_b64 s[82:83], L_load
    s_add_i32 s62, s62, 1
    s_waitcnt lgkmcnt(0)
    v_mfma_f32_16x16x32_bf16 v[216:219], v[32:35], v[24:27], 0
    v_mfma_f32_16x16x32_bf16 v[220:223], v[36:39], v[24:27], 0
    v_mfma_f32_16x16x32_bf16 v[224:227], v[40:43], v[24:27], 0
    v_mfma_f32_16x16x32_bf16 v[228:231], v[44:47], v[24:27], 0
    s_nop 7
    buffer_store_dwordx4 v[216:219], v20, s[8:11], s87 offen offset:0 sc1
    buffer_store_dwordx4 v[220:223], v20, s[8:11], s87 offen offset:64 sc1
    buffer_store_dwordx4 v[224:227], v20, s[8:11], s87 offen offset:128 sc1
    buffer_store_dwordx4 v[228:231], v20, s[8:11], s87 offen offset:192 sc1
    s_nop 1
    v_mfma_f32_16x16x32_bf16 v[216:219], v[240:243], v[24:27], 0
    v_mfma_f32_16x16x32_bf16 v[220:223], v[244:247], v[24:27], 0
    v_mfma_f32_16x16x32_bf16 v[224:227], v[248:251], v[24:27], 0
    v_mfma_f32_16x16x32_bf16 v[228:231], v[252:255], v[24:27], 0
    s_nop 7
    buffer_store_dwordx4 v[216:219], v20, s[8:11], s87 offen offset:1024 sc1
    buffer_store_dwordx4 v[220:223], v20, s[8:11], s87 offen offset:1088 sc1
    buffer_store_dwordx4 v[224:227], v20, s[8:11], s87 offen offset:1152 sc1
    buffer_store_dwordx4 v[228:231], v20, s[8:11], s87 offen offset:1216 sc1
    s_nop 1
    s_cmp_ge_u32 s3, 2
    s_cbranch_scc1 L_moe5b
    v_mfma_f32_16x16x32_bf16 v[216:219], v[104:107], v[24:27], 0
    v_mfma_f32_16x16x32_bf16 v[220:223], v[108:111], v[24:27], 0
    v_mfma_f32_16x16x32_bf16 v[224:227], v[112:115], v[24:27], 0
    v_mfma_f32_16x16x32_bf16 v[228:231], v[116:119], v[24:27], 0
    s_nop 7
    buffer_store_dwordx4 v[216:219], v20, s[8:11], s87 offen offset:2048 sc1
    buffer_store_dwordx4 v[220:223], v20, s[8:11], s87 offen offset:2112 sc1
    buffer_store_dwordx4 v[224:227], v20, s[8:11], s87 offen offset:2176 sc1
    buffer_store_dwordx4 v[228:231], v20, s[8:11], s87 offen offset:2240 sc1
    s_nop 1
L_moe5b:
    s_waitcnt vmcnt(8) lgkmcnt(0)
    s_call_b64 s[82:83], L_pend
    s_barrier
    s_waitcnt vmcnt(0)
    s_lshl_b32 s6, s61, 5
    s_add_u32 s6, s6, s3
    s_lshl_b32 s6, s6, 2
    s_add_u32 s6, s6, 15859712
    v_mov_b32 v2, 1
    v_mov_b32 v3, 0x5000000
    v_writelane_b32 v3, s6, 0
    buffer_store_dword v2, v3, s[8:11], 0 offen sc1
    s_call_b64 s[82:83], L_load
    s_add_i32 s62, s62, 1
    s_branch L_idle
L_top:
    s_mov_b32 s6, 0x280000
    v_lshrrev_b32 v2, 1, v1
    v_and_b32 v3, 1, v1
    v_lshlrev_b32 v3, 4, v3
    v_lshl_add_u32 v2, v2, 7, v3
    buffer_load_dwordx4 v[64:67], v2, s[8:11], s6 offen sc1
    s_add_u32 s6, s6, 4096
    buffer_load_dwordx4 v[68:71], v2, s[8:11], s6 offen sc1
    s_add_u32 s6, s6, 4096
    buffer_load_dwordx4 v[72:75], v2, s[8:11], s6 offen sc1
    s_add_u32 s6, s6, 4096
    buffer_load_dwordx4 v[76:79], v2, s[8:11], s6 offen sc1
    s_add_u32 s6, s6, 4096
    buffer_load_dwordx4 v[80:83], v2, s[8:11], s6 offen sc1
    s_add_u32 s6, s6, 4096
    buffer_load_dwordx4 v[84:87], v2, s[8:11], s6 offen sc1
    s_add_u32 s6, s6, 4096
    buffer_load_dwordx4 v[88:91], v2, s[8:11], s6 offen sc1
    s_add_u32 s6, s6, 4096
    buffer_load_dwordx4 v[92:95], v2, s[8:11], s6 offen sc1
    s_add_u32 s6, s6, 4096
    s_waitcnt vmcnt(0)
    v_mov_b32 v24, 0
    s_mov_b32 s7, 0
    s_mov_b32 s84, 0
L_top_l:
    v_max3_u32 v4, v64, v65, v66
    v_max3_u32 v5, v67, v68, v69
    v_max3_u32 v4, v4, v70, v71
    v_max3_u32 v5, v5, v72, v73
    v_max3_u32 v4, v4, v74, v75
    v_max3_u32 v5, v5, v76, v77
    v_max3_u32 v4, v4, v78, v79
    v_max3_u32 v5, v5, v80, v81
    v_max3_u32 v4, v4, v82, v83
    v_max3_u32 v5, v5, v84, v85
    v_max3_u32 v4, v4, v86, v87
    v_max3_u32 v5, v5, v88, v89
    v_max3_u32 v4, v4, v90, v91
    v_max3_u32 v5, v5, v92, v93
    v_max3_u32 v4, v4, v94, v95
    v_max_u32 v4, v4, v5
    s_nop 1
    v_max_u32_dpp v4, v4, v4 quad_perm:[1,0,3,2] row_mask:0xf bank_mask:0xf
    s_nop 1
    v_max_u32_dpp v4, v4, v4 quad_perm:[2,3,0,1] row_mask:0xf bank_mask:0xf
    s_nop 1
    v_max_u32_dpp v4, v4, v4 row_half_mirror row_mask:0xf bank_mask:0xf
    s_nop 1
    v_max_u32_dpp v4, v4, v4 row_mirror row_mask:0xf bank_mask:0xf
    s_nop 1
    v_max_u32_dpp v4, v4, v4 row_bcast:15 row_mask:0xa bank_mask:0xf
    s_nop 1
    v_max_u32_dpp v4, v4, v4 row_bcast:31 row_mask:0xc bank_mask:0xf
    s_nop 1
    v_readlane_b32 s6, v4, 63
    s_mov_b32 m0, s7
    s_nop 3
    s_add_u32 s84, s84, s6
    v_writelane_b32 v24, s84, m0
    v_subrev_u32 v64, s6, v64
    v_subrev_u32 v65, s6, v65
    v_subrev_u32 v66, s6, v66
    v_subrev_u32 v67, s6, v67
    v_subrev_u32 v68, s6, v68
    v_subrev_u32 v69, s6, v69
    v_subrev_u32 v70, s6, v70
    v_subrev_u32 v71, s6, v71
    v_subrev_u32 v72, s6, v72
    v_subrev_u32 v73, s6, v73
    v_subrev_u32 v74, s6, v74
    v_subrev_u32 v75, s6, v75
    v_subrev_u32 v76, s6, v76
    v_subrev_u32 v77, s6, v77
    v_subrev_u32 v78, s6, v78
    v_subrev_u32 v79, s6, v79
    v_subrev_u32 v80, s6, v80
    v_subrev_u32 v81, s6, v81
    v_subrev_u32 v82, s6, v82
    v_subrev_u32 v83, s6, v83
    v_subrev_u32 v84, s6, v84
    v_subrev_u32 v85, s6, v85
    v_subrev_u32 v86, s6, v86
    v_subrev_u32 v87, s6, v87
    v_subrev_u32 v88, s6, v88
    v_subrev_u32 v89, s6, v89
    v_subrev_u32 v90, s6, v90
    v_subrev_u32 v91, s6, v91
    v_subrev_u32 v92, s6, v92
    v_subrev_u32 v93, s6, v93
    v_subrev_u32 v94, s6, v94
    v_subrev_u32 v95, s6, v95
    s_add_u32 s7, s7, 1
    s_cmp_lt_u32 s7, 8
    s_cbranch_scc1 L_top_l
    v_and_b32 v2, 7, v1
    v_lshlrev_b32 v2, 2, v2
    ds_bpermute_b32 v4, v2, v24
    s_waitcnt lgkmcnt(0)
    v_and_b32 v4, 0x7ff, v4
    v_sub_u32 v4, 0x7ff, v4
    v_lshrrev_b32 v5, 4, v4
    v_mul_u32_u24 v5, 20480, v5
    v_and_b32 v4, 15, v4
    v_lshl_add_u32 v5, v4, 4, v5
    v_lshrrev_b32 v7, 4, v1
    v_lshl_add_u32 v5, v7, 8, v5
    v_mov_b32 v6, 0x5000000
    v_and_b32 v2, 8, v1
    v_cmp_eq_u32 vcc, 0, v2
    s_mov_b32 s6, 0
    s_nop 0
    v_cndmask_b32 v5, v6, v5, vcc
    buffer_load_dwordx4 v[64:67], v5, s[8:11], s6 offen offset:0 sc1
    buffer_load_dwordx4 v[68:71], v5, s[8:11], s6 offen offset:1024 sc1
    buffer_load_dwordx4 v[72:75], v5, s[8:11], s6 offen offset:2048 sc1
    buffer_load_dwordx4 v[76:79], v5, s[8:11], s6 offen offset:3072 sc1
    s_add_u32 s6, s6, 4096
    buffer_load_dwordx4 v[80:83], v5, s[8:11], s6 offen offset:0 sc1
    buffer_load_dwordx4 v[84:87], v5, s[8:11], s6 offen offset:1024 sc1
    buffer_load_dwordx4 v[88:91], v5, s[8:11], s6 offen offset:2048 sc1
    buffer_load_dwordx4 v[92:95], v5, s[8:11], s6 offen offset:3072 sc1
    s_add_u32 s6, s6, 4096
    buffer_load_dwordx4 v[96:99], v5, s[8:11], s6 offen offset:0 sc1
    buffer_load_dwordx4 v[100:103], v5, s[8:11], s6 offen offset:1024 sc1
    buffer_load_dwordx4 v[104:107], v5, s[8:11], s6 offen offset:2048 sc1
    buffer_load_dwordx4 v[108:111], v5, s[8:11], s6 offen offset:3072 sc1
    s_add_u32 s6, s6, 4096
    buffer_load_dwordx4 v[112:115], v5, s[8:11], s6 offen offset:0 sc1
    buffer_load_dwordx4 v[116:119], v5, s[8:11], s6 offen offset:1024 sc1
    buffer_load_dwordx4 v[120:123], v5, s[8:11], s6 offen offset:2048 sc1
    buffer_load_dwordx4 v[124:127], v5, s[8:11], s6 offen offset:3072 sc1
    s_add_u32 s6, s6, 4096
    buffer_load_dwordx4 v[128:131], v5, s[8:11], s6 offen offset:0 sc1
    buffer_load_dwordx4 v[132:135], v5, s[8:11], s6 offen offset:1024 sc1
    buffer_load_dwordx4 v[136:139], v5, s[8:11], s6 offen offset:2048 sc1
    buffer_load_dwordx4 v[140:143], v5, s[8:11], s6 offen offset:3072 sc1
    s_waitcnt vmcnt(20)
    s_call_b64 s[82:83], L_pend
    s_barrier
    s_waitcnt vmcnt(0)
    s_mov_b32 s6, 0xc00000
    buffer_store_dwordx4 v[64:67], v13, s[8:11], s6 offen offset:0 sc1
    buffer_store_dwordx4 v[68:71], v13, s[8:11], s6 offen offset:1024 sc1
    buffer_store_dwordx4 v[72:75], v13, s[8:11], s6 offen offset:2048 sc1
    buffer_store_dwordx4 v[76:79], v13, s[8:11], s6 offen offset:3072 sc1
    s_add_u32 s6, s6, 4096
    buffer_store_dwordx4 v[80:83], v13, s[8:11], s6 offen offset:0 sc1
    buffer_store_dwordx4 v[84:87], v13, s[8:11], s6 offen offset:1024 sc1
    buffer_store_dwordx4 v[88:91], v13, s[8:11], s6 offen offset:2048 sc1
    buffer_store_dwordx4 v[92:95], v13, s[8:11], s6 offen offset:3072 sc1
    s_add_u32 s6, s6, 4096
    buffer_store_dwordx4 v[96:99], v13, s[8:11], s6 offen offset:0 sc1
    buffer_store_dwordx4 v[100:103], v13, s[8:11], s6 offen offset:1024 sc1
    buffer_store_dwordx4 v[104:107], v13, s[8:11], s6 offen offset:2048 sc1
    buffer_store_dwordx4 v[108:111], v13, s[8:11], s6 offen offset:3072 sc1
    s_add_u32 s6, s6, 4096
    buffer_store_dwordx4 v[112:115], v13, s[8:11], s6 offen offset:0 sc1
    buffer_store_dwordx4 v[116:119], v13, s[8:11], s6 offen offset:1024 sc1
    buffer_store_dwordx4 v[120:123], v13, s[8:11], s6 offen offset:2048 sc1
    buffer_store_dwordx4 v[124:127], v13, s[8:11], s6 offen offset:3072 sc1
    s_add_u32 s6, s6, 4096
    buffer_store_dwordx4 v[128:131], v13, s[8:11], s6 offen offset:0 sc1
    buffer_store_dwordx4 v[132:135], v13, s[8:11], s6 offen offset:1024 sc1
    buffer_store_dwordx4 v[136:139], v13, s[8:11], s6 offen offset:2048 sc1
    buffer_store_dwordx4 v[140:143], v13, s[8:11], s6 offen offset:3072 sc1
    s_call_b64 s[82:83], L_load
    s_add_i32 s62, s62, 1
    s_waitcnt vmcnt(16)
    v_or_b32 v24, 0x80000000, v24
    v_lshlrev_b32 v5, 2, v1
    v_mov_b32 v6, 0x5000000
    v_cmp_gt_u32 vcc, 8, v1
    s_mov_b32 s6, 0x3a0000
    s_nop 0
    v_cndmask_b32 v5, v6, v5, vcc
    buffer_store_dword v24, v5, s[8:11], s6 offen sc1
    s_branch L_idle
L_back_9_h:
    v_cmp_ne_u32 vcc, 0, v62
    s_cbranch_vccz L_back_9_n
    s_call_b64 s[80:81], L_rare0
L_back_9_n:
    s_branch L_back_9
L_back_10_h:
    v_cmp_ne_u32 vcc, 0, v62
    s_cbranch_vccz L_back_10_n
    s_call_b64 s[80:81], L_rare1
    v_exp_f32 v58, v64
    v_exp_f32 v59, v65
L_back_10_n:
    s_cmp_lt_i32 s64, 0
    s_cbranch_scc1 L_tail1
    s_cmp_gt_i32 s64, 0
    s_cbranch_scc1 L_back_10
    s_call_b64 s[82:83], L_mask
    s_branch L_back_10
L_back_11_h:
    v_cmp_ne_u32 vcc, 0, v62
    s_cbranch_vccz L_back_11_n
    s_call_b64 s[80:81], L_rare0
    v_exp_f32 v58, v80
    v_exp_f32 v59, v81
L_back_11_n:
    s_cmp_lt_i32 s64, 0
    s_cbranch_scc1 L_tail2
    s_cmp_gt_i32 s64, 0
    s_cbranch_scc1 L_back_11
    s_call_b64 s[82:83], L_mask
    s_branch L_back_11
L_back_12_h:
    v_cmp_ne_u32 vcc, 0, v62
    s_cbranch_vccz L_back_12_n
    s_call_b64 s[80:81], L_rare1
    v_exp_f32 v58, v64
    v_exp_f32 v59, v65
L_back_12_n:
    s_cmp_lt_i32 s64, 0
    s_cbranch_scc1 L_tail3
    s_cmp_gt_i32 s64, 0
    s_cbranch_scc1 L_back_12
    s_call_b64 s[82:83], L_mask
    s_branch L_back_12
L_ldback_13_c:
    s_waitcnt vmcnt(0) lgkmcnt(0)
    s_call_b64 s[82:83], L_pend
    s_barrier
    s_call_b64 s[82:83], L_load
    s_branch L_ldback_13
L_back_14_h:
    v_cmp_ne_u32 vcc, 0, v62
    s_cbranch_vccz L_back_14_n
    s_call_b64 s[80:81], L_rare0
    v_exp_f32 v58, v80
    v_exp_f32 v59, v81
L_back_14_n:
    s_cmp_lt_i32 s64, 0
    s_cbranch_scc1 L_tail0
    s_cmp_gt_i32 s64, 0
    s_cbranch_scc1 L_st0
    s_call_b64 s[82:83], L_mask
    s_branch L_st0
L_back_15_h:
    v_cmp_ne_u32 vcc, 0, v62
    s_cbranch_vccz L_back_15_n
    s_call_b64 s[80:81], L_rare1
L_back_15_n:
    s_branch L_back_15
L_back_16_h:
    v_cmp_ne_u32 vcc, 0, v62
    s_cbranch_vccz L_back_16_n
    s_call_b64 s[80:81], L_rare0
L_back_16_n:
    s_branch L_back_16
L_back_18_h:
    v_cmp_ne_u32 vcc, 0, v62
    s_cbranch_vccz L_back_18_n
    s_call_b64 s[80:81], L_rare1
L_back_18_n:
    s_branch L_back_18
L_back_21_h:
    v_cmp_ne_u32 vcc, 0, v62
    s_cbranch_vccz L_back_21_n
    s_call_b64 s[80:81], L_rare0
L_back_21_n:
    s_branch L_back_21
L_load:
    s_bitcmp1_b32 s89, 0
    s_cbranch_scc0 L_load_r
    s_add_u32 s77, s77, 32768
    s_xor_b32 s78, s78, 0x10000
    s_add_i32 s73, s62, 1
    s_cmp_gt_i32 s73, s63
    s_cbranch_scc1 L_load_r
    s_cmp_eq_i32 s73, s63
    s_cbranch_scc1 L_load_v
    s_cmp_lg_i32 s73, 3
    s_cbranch_scc1 L_load_k
    v_cmp_gt_u32 vcc, 2, v12
    s_cbranch_vccz L_load_k
    s_lshl_b32 s7, s4, 10
    s_add_u32 s7, s7, 3866624
    v_lshrrev_b32 v2, 3, v1
    v_and_b32 v3, 7, v1
    v_lshlrev_b32 v3, 2, v3
    v_lshl_add_u32 v3, v2, 7, v3
    s_mov_b32 s79, 262144
L_poll_46:
    buffer_load_dword v2, v3, s[8:11], s7 offen sc1
    s_waitcnt vmcnt(0)
    v_cmp_gt_u32 vcc, 2, v2
    s_cbranch_vccz L_polldone_47
    s_sleep 2
    s_sub_u32 s79, s79, 1
    s_cmp_lg_u32 s79, 0
    s_cbranch_scc1 L_poll_46
L_polldone_47:
L_load_k:
    s_lshl_b32 s6, s76, 13
    s_add_u32 s6, s6, s78
    s_add_u32 m0, s6, 0
    s_add_u32 s7, s77, 0
    buffer_load_dwordx4 v49, s[8:11], s7 offen offset:0 sc1 lds
    buffer_load_dwordx4 v49, s[8:11], s7 offen offset:1024 sc1 lds
    buffer_load_dwordx4 v49, s[8:11], s7 offen offset:2048 sc1 lds
    buffer_load_dwordx4 v49, s[8:11], s7 offen offset:3072 sc1 lds
    s_lshl_b32 s6, s76, 13
    s_add_u32 s6, s6, s78
    s_add_u32 m0, s6, 4096
    s_add_u32 s7, s77, 4096
    buffer_load_dwordx4 v49, s[8:11], s7 offen offset:0 sc1 lds
    buffer_load_dwordx4 v49, s[8:11], s7 offen offset:1024 sc1 lds
    buffer_load_dwordx4 v49, s[8:11], s7 offen offset:2048 sc1 lds
    buffer_load_dwordx4 v49, s[8:11], s7 offen offset:3072 sc1 lds
    s_lshl_b32 s6, s76, 12
    s_add_u32 s6, s6, s78
    s_add_u32 m0, s6, 49152
    s_add_u32 s7, s77, 524288
    buffer_load_dwordx4 v50, s[8:11], s7 offen offset:0 sc1 lds
    buffer_load_dwordx4 v50, s[8:11], s7 offen offset:1024 sc1 lds
    buffer_load_dwordx4 v50, s[8:11], s7 offen offset:2048 sc1 lds
    buffer_load_dwordx4 v50, s[8:11], s7 offen offset:3072 sc1 lds
L_load_v:
    s_lshl_b32 s6, s76, 12
    s_add_u32 s6, s6, s78
    s_add_u32 m0, s6, 32768
    s_add_u32 s7, s77, 507904
    buffer_load_dwordx4 v50, s[8:11], s7 offen offset:0 sc1 lds
    buffer_load_dwordx4 v50, s[8:11], s7 offen offset:1024 sc1 lds
    buffer_load_dwordx4 v50, s[8:11], s7 offen offset:2048 sc1 lds
    buffer_load_dwordx4 v50, s[8:11], s7 offen offset:3072 sc1 lds
    s_cmp_eq_i32 s73, s63
    s_cbranch_scc1 L_xa
    s_cmp_lg_i32 s73, 2
    s_cbranch_scc1 L_nolook
    s_lshl_b32 s7, s4, 10
    s_add_u32 s7, s7, 3866624
    v_lshrrev_b32 v2, 3, v1
    v_and_b32 v3, 7, v1
    v_lshlrev_b32 v3, 2, v3
    v_lshl_add_u32 v3, v2, 7, v3
    buffer_load_dword v12, v3, s[8:11], s7 offen sc1
L_nolook:
    s_bitcmp1_b32 120, s5
    s_cbranch_scc0 L_wb
    s_sub_i32 s6, s62, 0
    s_cmp_gt_u32 s6, 4
    s_cbranch_scc0 L_wsel
L_wb:
    s_sub_u32 s6, s5, 4
    s_cmp_ge_u32 s6, 4
    s_cbranch_scc1 L_load_r
    s_sub_i32 s79, s73, 1
    s_cmp_lt_u32 s79, 2
    s_cbranch_scc1 L_x3
L_load_r:
    s_setpc_b64 s[82:83]
L_pend:
    s_bitcmp1_b32 s89, 1
    s_cbranch_scc0 L_load_a
    s_cmp_lt_i32 s62, 0
    s_cbranch_scc1 L_load_a
    s_lshl_b32 s6, s4, 3
    s_add_u32 s6, s6, s5
    s_lshl_b32 s6, s6, 5
    s_add_u32 s6, s6, s3
    s_lshl_b32 s6, s6, 2
    s_add_u32 s6, s6, 3866624
    v_mov_b32 v2, 2
    v_mov_b32 v3, 0x5000000
    v_writelane_b32 v3, s6, 0
    buffer_store_dword v2, v3, s[8:11], 0 offen sc1
    s_and_b32 s89, s89, 1
L_load_a:
    s_setpc_b64 s[82:83]
L_wsel:
    s_bfm_b32 s7, s5, 0
    s_and_b32 s7, s7, 120
    s_bcnt1_i32_b32 s7, s7
    s_lshl_b32 s7, s7, 5
    s_and_b32 s91, s2, 31
    s_add_u32 s91, s91, s7
    s_lshl_b32 s91, s91, 1
    s_lshr_b32 s7, s6, 1
    s_add_u32 s91, s91, s7
    s_cmp_eq_u32 s6, 4
    s_cbranch_scc1 L_w2
    s_bitcmp1_b32 s6, 0
    s_cbranch_scc1 L_w1
L_w0:
    s_mov_b32 s28, s42
    s_mov_b32 s29, s43
    s_mov_b32 s30, 0x500000
    s_mov_b32 s31, 0x20000
    s_lshr_b32 s75, s91, 1
    s_mul_i32 s75, s75, 40960
    s_and_b32 s6, s91, 1
    s_mul_i32 s6, s6, 640
    s_add_u32 s75, s75, s6
    s_movk_i32 s7, 1639
    s_mul_i32 s74, s76, 5120
    s_add_u32 s74, s74, 141312
    s_mul_i32 s6, s76, 320
    v_add_u32 v9, s6, v1
    v_add_u32 v2, 0, v9
    v_mul_lo_u32 v3, v2, s7
    v_lshrrev_b32 v3, 16, v3
    v_mul_u32_u24 v4, 40, v3
    v_sub_u32 v4, v2, v4
    v_mul_u32_u24 v3, 1280, v3
    v_lshl_add_u32 v3, v4, 4, v3
    s_add_u32 m0, s74, 0
    s_nop 0
    buffer_load_dwordx4 v3, s[28:31], s75 offen nt lds
    v_add_u32 v2, 64, v9
    v_mul_lo_u32 v3, v2, s7
    v_lshrrev_b32 v3, 16, v3
    v_mul_u32_u24 v4, 40, v3
    v_sub_u32 v4, v2, v4
    v_mul_u32_u24 v3, 1280, v3
    v_lshl_add_u32 v3, v4, 4, v3
    s_add_u32 m0, s74, 1024
    s_nop 0
    buffer_load_dwordx4 v3, s[28:31], s75 offen nt lds
    v_add_u32 v2, 128, v9
    v_mul_lo_u32 v3, v2, s7
    v_lshrrev_b32 v3, 16, v3
    v_mul_u32_u24 v4, 40, v3
    v_sub_u32 v4, v2, v4
    v_mul_u32_u24 v3, 1280, v3
    v_lshl_add_u32 v3, v4, 4, v3
    s_add_u32 m0, s74, 2048
    s_nop 0
    buffer_load_dwordx4 v3, s[28:31], s75 offen nt lds
    v_add_u32 v2, 192, v9
    v_mul_lo_u32 v3, v2, s7
    v_lshrrev_b32 v3, 16, v3
    v_mul_u32_u24 v4, 40, v3
    v_sub_u32 v4, v2, v4
    v_mul_u32_u24 v3, 1280, v3
    v_lshl_add_u32 v3, v4, 4, v3
    s_add_u32 m0, s74, 3072
    s_nop 0
    buffer_load_dwordx4 v3, s[28:31], s75 offen nt lds
    v_add_u32 v2, 256, v9
    v_mul_lo_u32 v3, v2, s7
    v_lshrrev_b32 v3, 16, v3
    v_mul_u32_u24 v4, 40, v3
    v_sub_u32 v4, v2, v4
    v_mul_u32_u24 v3, 1280, v3
    v_lshl_add_u32 v3, v4, 4, v3
    s_add_u32 m0, s74, 4096
    s_nop 0
    buffer_load_dwordx4 v3, s[28:31], s75 offen nt lds
    s_branch L_wb
L_w1:
    v_and_b32 v2, 15, v1
    v_lshrrev_b32 v3, 4, v1
    v_lshrrev_b32 v4, 2, v2
    v_lshl_add_u32 v4, v3, 2, v4
    v_mul_u32_u24 v4, 640, v4
    v_and_b32 v2, 3, v2
    v_lshl_add_u32 v4, v2, 3, v4
    s_mul_i32 s6, s76, 160
    s_add_u32 s6, s6, 141312
    v_add_u32 v4, s6, v4
    s_mul_i32 s6, s91, 20480
    s_mul_i32 s7, s76, 5120
    s_add_u32 s6, s6, s7
    s_add_u32 s6, s6, 4194304
    s_add_u32 s7, s6, 4096
    ds_read_b64_tr_b16 v[172:173], v4 offset:0
    ds_read_b64_tr_b16 v[174:175], v4 offset:10240
    ds_read_b64_tr_b16 v[176:177], v4 offset:32
    ds_read_b64_tr_b16 v[178:179], v4 offset:10272
    ds_read_b64_tr_b16 v[180:181], v4 offset:64
    ds_read_b64_tr_b16 v[182:183], v4 offset:10304
    ds_read_b64_tr_b16 v[184:185], v4 offset:96
    ds_read_b64_tr_b16 v[186:187], v4 offset:10336
    ds_read_b64_tr_b16 v[188:189], v4 offset:128
    ds_read_b64_tr_b16 v[190:191], v4 offset:10368
    s_waitcnt lgkmcnt(0)
    buffer_store_dwordx4 v[172:175], v13, s[8:11], s6 offen offset:0 sc1
    buffer_store_dwordx4 v[176:179], v13, s[8:11], s6 offen offset:1024 sc1
    buffer_store_dwordx4 v[180:183], v13, s[8:11], s6 offen offset:2048 sc1
    buffer_store_dwordx4 v[184:187], v13, s[8:11], s6 offen offset:3072 sc1
    buffer_store_dwordx4 v[188:191], v13, s[8:11], s7 offen offset:0 sc1
    s_branch L_wb
L_w2:
    s_cmp_lg_u32 s3, 0
    s_cbranch_scc1 L_wb
    s_mov_b32 s28, s56
    s_mov_b32 s29, s57
    s_mov_b32 s30, 0x100
    s_mov_b32 s31, 0x20000
    v_mov_b32 v2, 1
    v_lshlrev_b32 v3, 8, v1
    s_and_b32 s6, s2, 31
    s_lshl_b32 s6, s6, 2
    buffer_atomic_add v2, v3, s[28:31], s6 offen offset:128 sc1
    s_branch L_wb
L_xa:
    s_cmp_lg_u32 s90, 0
    s_cbranch_scc1 L_xa1
    s_mov_b32 s28, s56
    s_mov_b32 s29, s57
    s_mov_b32 s30, 0x100
    s_mov_b32 s31, 0x20000
    v_and_b32 v3, 31, v1
    v_lshlrev_b32 v3, 2, v3
    s_mov_b32 s79, 262144
L_poll_48:
    buffer_load_dword v2, v3, s[28:31], 0 offen offset:128 sc1
    s_waitcnt vmcnt(0)
    v_cmp_gt_u32 vcc, 4, v2
    s_cbranch_vccz L_polldone_49
    s_sleep 8
    s_sub_u32 s79, s79, 1
    s_cmp_lg_u32 s79, 0
    s_cbranch_scc1 L_poll_48
L_polldone_49:
L_xa1:
    s_lshr_b32 s74, s4, 3
    s_lshl_b32 s74, s74, 2
    s_add_u32 s74, s74, s76
    s_mul_i32 s74, s74, 327680
    s_and_b32 s7, s4, 3
    s_mul_i32 s7, s7, 10240
    s_add_u32 s74, s74, s7
    s_add_u32 s74, s74, 4199424
    s_add_u32 s6, s76, 0
    s_and_b32 s6, s6, 3
    s_lshl_b32 s6, s6, 10
    s_add_u32 s84, s6, s74
    s_add_u32 s6, s76, 1
    s_and_b32 s6, s6, 3
    s_lshl_b32 s6, s6, 10
    s_add_u32 s85, s6, s74
    s_add_u32 s6, s76, 2
    s_and_b32 s6, s6, 3
    s_lshl_b32 s6, s6, 10
    s_add_u32 s86, s6, s74
    s_add_u32 s6, s76, 3
    s_and_b32 s6, s6, 3
    s_lshl_b32 s6, s6, 10
    s_add_u32 s87, s6, s74
    s_add_u32 s88, s74, 4096
    s_lshl_b32 s73, s3, 13
    s_add_u32 s75, s73, s78
    s_add_u32 m0, s73, 131072
    s_add_u32 s7, s84, 0
    buffer_load_dwordx4 v13, s[8:11], s7 offen sc1 lds
    s_add_u32 m0, s73, 132096
    s_add_u32 s7, s85, 0
    buffer_load_dwordx4 v13, s[8:11], s7 offen sc1 lds
    s_add_u32 m0, s73, 133120
    s_add_u32 s7, s86, 0
    buffer_load_dwordx4 v13, s[8:11], s7 offen sc1 lds
    s_add_u32 m0, s73, 134144
    s_add_u32 s7, s87, 0
    buffer_load_dwordx4 v13, s[8:11], s7 offen sc1 lds
    s_add_u32 m0, s73, 135168
    s_add_u32 s7, s88, 0
    buffer_load_dwordx4 v13, s[8:11], s7 offen sc1 lds
    s_add_u32 m0, s73, 136192
    s_add_u32 s7, s84, 40960
    buffer_load_dwordx4 v13, s[8:11], s7 offen sc1 lds
    s_add_u32 m0, s73, 137216
    s_add_u32 s7, s85, 40960
    buffer_load_dwordx4 v13, s[8:11], s7 offen sc1 lds
    s_add_u32 m0, s73, 138240
    s_add_u32 s7, s86, 40960
    buffer_load_dwordx4 v13, s[8:11], s7 offen sc1 lds
    s_add_u32 m0, s75, 0
    s_add_u32 s7, s87, 40960
    buffer_load_dwordx4 v13, s[8:11], s7 offen sc1 lds
    s_add_u32 m0, s75, 1024
    s_add_u32 s7, s88, 40960
    buffer_load_dwordx4 v13, s[8:11], s7 offen sc1 lds
    s_add_u32 m0, s75, 2048
    s_add_u32 s7, s84, 81920
    buffer_load_dwordx4 v13, s[8:11], s7 offen sc1 lds
    s_add_u32 m0, s75, 3072
    s_add_u32 s7, s85, 81920
    buffer_load_dwordx4 v13, s[8:11], s7 offen sc1 lds
    s_add_u32 m0, s75, 4096
    s_add_u32 s7, s86, 81920
    buffer_load_dwordx4 v13, s[8:11], s7 offen sc1 lds
    s_add_u32 m0, s75, 5120
    s_add_u32 s7, s87, 81920
    buffer_load_dwordx4 v13, s[8:11], s7 offen sc1 lds
    s_add_u32 m0, s75, 6144
    s_add_u32 s7, s88, 81920
    buffer_load_dwordx4 v13, s[8:11], s7 offen sc1 lds
    s_add_u32 m0, s75, 7168
    s_add_u32 s7, s84, 122880
    buffer_load_dwordx4 v13, s[8:11], s7 offen sc1 lds
    s_lshl_b32 s75, s3, 12
    s_add_u32 s75, s75, s78
    s_add_u32 m0, s75, 49152
    s_add_u32 s7, s85, 122880
    buffer_load_dwordx4 v13, s[8:11], s7 offen sc1 lds
    s_add_u32 m0, s75, 50176
    s_add_u32 s7, s86, 122880
    buffer_load_dwordx4 v13, s[8:11], s7 offen sc1 lds
    s_add_u32 m0, s75, 51200
    s_add_u32 s7, s87, 122880
    buffer_load_dwordx4 v13, s[8:11], s7 offen sc1 lds
    s_add_u32 m0, s75, 52224
    s_add_u32 s7, s88, 122880
    buffer_load_dwordx4 v13, s[8:11], s7 offen sc1 lds
    s_setpc_b64 s[82:83]
L_x3:
    s_mov_b32 s12, s48
    s_mov_b32 s13, s49
    s_mov_b32 s14, 0x21c000
    s_mov_b32 s15, 0x20000
    s_cmp_eq_u32 s3, 3
    s_cbranch_scc1 L_load_r
    s_cmp_eq_u32 s3, 1
    s_cselect_b32 s12, s50, s12
    s_cselect_b32 s13, s51, s13
    s_cmp_eq_u32 s3, 2
    s_cselect_b32 s12, s52, s12
    s_cselect_b32 s13, s53, s13
    s_mov_b32 s73, 3456
    s_cmov_b32 s73, 256
    s_mov_b32 s75, 256
    s_cmov_b32 s75, 163840
    s_lshr_b32 s6, s2, 3
    s_sub_u32 s6, s6, 16
    s_mul_i32 s6, s6, 40
    v_lshrrev_b32 v2, 2, v1
    v_add_u32 v2, s6, v2
    v_mul_lo_u32 v2, v2, s73
    v_and_b32 v3, 3, v1
    v_lshl_add_u32 v2, v3, 6, v2
    s_xor_b32 s79, s79, 1
    s_lshl_b32 s6, s79, 3
    s_lshr_b32 s7, s4, 2
    s_add_u32 s6, s6, s7
    s_mul_i32 s6, s6, s75
    v_mov_b32 v3, 0x5000000
    v_cmp_gt_u32 vcc, 32, v1
    s_lshl_b32 s73, s73, 4
    s_nop 0
    v_cndmask_b32 v3, v3, v2, vcc
    buffer_load_dword v11, v2, s[12:15], s6 offen
    s_add_u32 s7, s6, s73
    buffer_load_dword v11, v2, s[12:15], s7 offen
    s_add_u32 s7, s7, s73
    buffer_load_dword v11, v3, s[12:15], s7 offen
    s_setpc_b64 s[82:83]
L_mask:
    v_and_b32 v2, 15, v1
    v_lshrrev_b32 v3, 4, v1
    v_lshlrev_b32 v3, 2, v3
    v_sub_u32 v2, v2, v3
    v_mov_b32 v3, 0xff800000
    v_cmp_gt_i32 vcc, 0, v2
    v_mov_b32 v152, v3
    s_nop 0
    v_cndmask_b32 v144, v144, v3, vcc
    v_cndmask_b32 v156, v156, v3, vcc
    v_cmp_gt_i32 vcc, 1, v2
    v_mov_b32 v153, v3
    s_nop 0
    v_cndmask_b32 v145, v145, v3, vcc
    v_cndmask_b32 v157, v157, v3, vcc
    v_cmp_gt_i32 vcc, 2, v2
    v_mov_b32 v154, v3
    s_nop 0
    v_cndmask_b32 v146, v146, v3, vcc
    v_cndmask_b32 v158, v158, v3, vcc
    v_cmp_gt_i32 vcc, 3, v2
    v_mov_b32 v155, v3
    s_nop 0
    v_cndmask_b32 v147, v147, v3, vcc
    v_cndmask_b32 v159, v159, v3, vcc
    s_nop 1
    s_setpc_b64 s[82:83]
L_rare0:
    s_nop 15
    v_max_f32 v62, v64, v65
    v_max3_f32 v62, v62, v66, v67
    v_max3_f32 v62, v62, v72, v73
    v_max3_f32 v62, v62, v74, v75
    v_mov_b32 v58, v62
    s_nop 1
    v_permlane16_swap_b32 v62, v58
    s_nop 1
    v_max_f32 v62, v62, v58
    v_mov_b32 v58, v62
    s_nop 1
    v_permlane32_swap_b32 v62, v58
    s_nop 1
    v_max_f32 v62, v62, v58
    v_add_f32 v62, 0x41c00000, v62
    v_max_f32 v62, 0, v62
    v_exp_f32 v58, -v62
    v_sub_f32 v64, v64, v62
    v_sub_f32 v80, v80, v62
    v_sub_f32 v144, v144, v62
    v_sub_f32 v65, v65, v62
    v_sub_f32 v81, v81, v62
    v_sub_f32 v145, v145, v62
    v_sub_f32 v66, v66, v62
    v_sub_f32 v82, v82, v62
    v_sub_f32 v146, v146, v62
    v_sub_f32 v67, v67, v62
    v_sub_f32 v83, v83, v62
    v_sub_f32 v147, v147, v62
    v_sub_f32 v72, v72, v62
    v_sub_f32 v88, v88, v62
    v_sub_f32 v152, v152, v62
    v_sub_f32 v73, v73, v62
    v_sub_f32 v89, v89, v62
    v_sub_f32 v153, v153, v62
    v_sub_f32 v74, v74, v62
    v_sub_f32 v90, v90, v62
    v_sub_f32 v154, v154, v62
    v_sub_f32 v75, v75, v62
    v_sub_f32 v91, v91, v62
    v_sub_f32 v155, v155, v62
    v_mul_f32 v160, v58, v160
    v_mul_f32 v161, v58, v161
    v_mul_f32 v192, v58, v192
    v_mul_f32 v193, v58, v193
    v_mul_f32 v194, v58, v194
    v_mul_f32 v195, v58, v195
    v_mul_f32 v200, v58, v200
    v_mul_f32 v201, v58, v201
    v_mul_f32 v202, v58, v202
    v_mul_f32 v203, v58, v203
    v_mul_f32 v208, v58, v208
    v_mul_f32 v209, v58, v209
    v_mul_f32 v210, v58, v210
    v_mul_f32 v211, v58, v211
    v_mul_f32 v216, v58, v216
    v_mul_f32 v217, v58, v217
    v_mul_f32 v218, v58, v218
    v_mul_f32 v219, v58, v219
    v_mul_f32 v224, v58, v224
    v_mul_f32 v225, v58, v225
    v_mul_f32 v226, v58, v226
    v_mul_f32 v227, v58, v227
    v_mul_f32 v232, v58, v232
    v_mul_f32 v233, v58, v233
    v_mul_f32 v234, v58, v234
    v_mul_f32 v235, v58, v235
    v_mul_f32 v240, v58, v240
    v_mul_f32 v241, v58, v241
    v_mul_f32 v242, v58, v242
    v_mul_f32 v243, v58, v243
    v_mul_f32 v248, v58, v248
    v_mul_f32 v249, v58, v249
    v_mul_f32 v250, v58, v250
    v_mul_f32 v251, v58, v251
    v_max_f32 v62, v68, v69
    v_max3_f32 v62, v62, v70, v71
    v_max3_f32 v62, v62, v76, v77
    v_max3_f32 v62, v62, v78, v79
    v_mov_b32 v58, v62
    s_nop 1
    v_permlane16_swap_b32 v62, v58
    s_nop 1
    v_max_f32 v62, v62, v58
    v_mov_b32 v58, v62
    s_nop 1
    v_permlane32_swap_b32 v62, v58
    s_nop 1
    v_max_f32 v62, v62, v58
    v_add_f32 v62, 0x41c00000, v62
    v_max_f32 v62, 0, v62
    v_exp_f32 v58, -v62
    v_sub_f32 v68, v68, v62
    v_sub_f32 v84, v84, v62
    v_sub_f32 v148, v148, v62
    v_sub_f32 v69, v69, v62
    v_sub_f32 v85, v85, v62
    v_sub_f32 v149, v149, v62
    v_sub_f32 v70, v70, v62
    v_sub_f32 v86, v86, v62
    v_sub_f32 v150, v150, v62
    v_sub_f32 v71, v71, v62
    v_sub_f32 v87, v87, v62
    v_sub_f32 v151, v151, v62
    v_sub_f32 v76, v76, v62
    v_sub_f32 v92, v92, v62
    v_sub_f32 v156, v156, v62
    v_sub_f32 v77, v77, v62
    v_sub_f32 v93, v93, v62
    v_sub_f32 v157, v157, v62
    v_sub_f32 v78, v78, v62
    v_sub_f32 v94, v94, v62
    v_sub_f32 v158, v158, v62
    v_sub_f32 v79, v79, v62
    v_sub_f32 v95, v95, v62
    v_sub_f32 v159, v159, v62
    v_mul_f32 v162, v58, v162
    v_mul_f32 v163, v58, v163
    v_mul_f32 v196, v58, v196
    v_mul_f32 v197, v58, v197
    v_mul_f32 v198, v58, v198
    v_mul_f32 v199, v58, v199
    v_mul_f32 v204, v58, v204
    v_mul_f32 v205, v58, v205
    v_mul_f32 v206, v58, v206
    v_mul_f32 v207, v58, v207
    v_mul_f32 v212, v58, v212
    v_mul_f32 v213, v58, v213
    v_mul_f32 v214, v58, v214
    v_mul_f32 v215, v58, v215
    v_mul_f32 v220, v58, v220
    v_mul_f32 v221, v58, v221
    v_mul_f32 v222, v58, v222
    v_mul_f32 v223, v58, v223
    v_mul_f32 v228, v58, v228
    v_mul_f32 v229, v58, v229
    v_mul_f32 v230, v58, v230
    v_mul_f32 v231, v58, v231
    v_mul_f32 v236, v58, v236
    v_mul_f32 v237, v58, v237
    v_mul_f32 v238, v58, v238
    v_mul_f32 v239, v58, v239
    v_mul_f32 v244, v58, v244
    v_mul_f32 v245, v58, v245
    v_mul_f32 v246, v58, v246
    v_mul_f32 v247, v58, v247
    v_mul_f32 v252, v58, v252
    v_mul_f32 v253, v58, v253
    v_mul_f32 v254, v58, v254
    v_mul_f32 v255, v58, v255
    v_exp_f32 v58, v64
    s_nop 0
    v_exp_f32 v59, v65
    s_nop 0
    v_cvt_pk_bf16_f32 v128, v58, v59
    v_exp_f32 v60, v66
    s_nop 0
    v_exp_f32 v61, v67
    s_nop 0
    v_cvt_pk_bf16_f32 v129, v60, v61
    v_exp_f32 v58, v68
    s_nop 0
    v_exp_f32 v59, v69
    s_nop 0
    v_cvt_pk_bf16_f32 v132, v58, v59
    v_exp_f32 v60, v70
    s_nop 0
    v_exp_f32 v61, v71
    s_nop 0
    v_cvt_pk_bf16_f32 v133, v60, v61
    v_exp_f32 v58, v72
    s_nop 0
    v_exp_f32 v59, v73
    s_nop 0
    v_cvt_pk_bf16_f32 v130, v58, v59
    v_exp_f32 v60, v74
    s_nop 0
    v_exp_f32 v61, v75
    s_nop 0
    v_cvt_pk_bf16_f32 v131, v60, v61
    v_exp_f32 v58, v76
    s_nop 0
    v_exp_f32 v59, v77
    s_nop 0
    v_cvt_pk_bf16_f32 v134, v58, v59
    v_exp_f32 v60, v78
    s_nop 0
    v_exp_f32 v61, v79
    s_nop 0
    v_cvt_pk_bf16_f32 v135, v60, v61
    s_nop 1
    s_setpc_b64 s[80:81]
L_rare1:
    s_nop 15
    v_max_f32 v62, v80, v81
    v_max3_f32 v62, v62, v82, v83
    v_max3_f32 v62, v62, v88, v89
    v_max3_f32 v62, v62, v90, v91
    v_mov_b32 v58, v62
    s_nop 1
    v_permlane16_swap_b32 v62, v58
    s_nop 1
    v_max_f32 v62, v62, v58
    v_mov_b32 v58, v62
    s_nop 1
    v_permlane32_swap_b32 v62, v58
    s_nop 1
    v_max_f32 v62, v62, v58
    v_add_f32 v62, 0x41c00000, v62
    v_max_f32 v62, 0, v62
    v_exp_f32 v58, -v62
    v_sub_f32 v64, v64, v62
    v_sub_f32 v80, v80, v62
    v_sub_f32 v144, v144, v62
    v_sub_f32 v65, v65, v62
    v_sub_f32 v81, v81, v62
    v_sub_f32 v145, v145, v62
    v_sub_f32 v66, v66, v62
    v_sub_f32 v82, v82, v62
    v_sub_f32 v146, v146, v62
    v_sub_f32 v67, v67, v62
    v_sub_f32 v83, v83, v62
    v_sub_f32 v147, v147, v62
    v_sub_f32 v72, v72, v62
    v_sub_f32 v88, v88, v62
    v_sub_f32 v152, v152, v62
    v_sub_f32 v73, v73, v62
    v_sub_f32 v89, v89, v62
    v_sub_f32 v153, v153, v62
    v_sub_f32 v74, v74, v62
    v_sub_f32 v90, v90, v62
    v_sub_f32 v154, v154, v62
    v_sub_f32 v75, v75, v62
    v_sub_f32 v91, v91, v62
    v_sub_f32 v155, v155, v62
    v_mul_f32 v160, v58, v160
    v_mul_f32 v161, v58, v161
    v_mul_f32 v192, v58, v192
    v_mul_f32 v193, v58, v193
    v_mul_f32 v194, v58, v194
    v_mul_f32 v195, v58, v195
    v_mul_f32 v200, v58, v200
    v_mul_f32 v201, v58, v201
    v_mul_f32 v202, v58, v202
    v_mul_f32 v203, v58, v203
    v_mul_f32 v208, v58, v208
    v_mul_f32 v209, v58, v209
    v_mul_f32 v210, v58, v210
    v_mul_f32 v211, v58, v211
    v_mul_f32 v216, v58, v216
    v_mul_f32 v217, v58, v217
    v_mul_f32 v218, v58, v218
    v_mul_f32 v219, v58, v219
    v_mul_f32 v224, v58, v224
    v_mul_f32 v225, v58, v225
    v_mul_f32 v226, v58, v226
    v_mul_f32 v227, v58, v227
    v_mul_f32 v232, v58, v232
    v_mul_f32 v233, v58, v233
    v_mul_f32 v234, v58, v234
    v_mul_f32 v235, v58, v235
    v_mul_f32 v240, v58, v240
    v_mul_f32 v241, v58, v241
    v_mul_f32 v242, v58, v242
    v_mul_f32 v243, v58, v243
    v_mul_f32 v248, v58, v248
    v_mul_f32 v249, v58, v249
    v_mul_f32 v250, v58, v250
    v_mul_f32 v251, v58, v251
    v_max_f32 v62, v84, v85
    v_max3_f32 v62, v62, v86, v87
    v_max3_f32 v62, v62, v92, v93
    v_max3_f32 v62, v62, v94, v95
    v_mov_b32 v58, v62
    s_nop 1
    v_permlane16_swap_b32 v62, v58
    s_nop 1
    v_max_f32 v62, v62, v58
    v_mov_b32 v58, v62
    s_nop 1
    v_permlane32_swap_b32 v62, v58
    s_nop 1
    v_max_f32 v62, v62, v58
    v_add_f32 v62, 0x41c00000, v62
    v_max_f32 v62, 0, v62
    v_exp_f32 v58, -v62
    v_sub_f32 v68, v68, v62
    v_sub_f32 v84, v84, v62
    v_sub_f32 v148, v148, v62
    v_sub_f32 v69, v69, v62
    v_sub_f32 v85, v85, v62
    v_sub_f32 v149, v149, v62
    v_sub_f32 v70, v70, v62
    v_sub_f32 v86, v86, v62
    v_sub_f32 v150, v150, v62
    v_sub_f32 v71, v71, v62
    v_sub_f32 v87, v87, v62
    v_sub_f32 v151, v151, v62
    v_sub_f32 v76, v76, v62
    v_sub_f32 v92, v92, v62
    v_sub_f32 v156, v156, v62
    v_sub_f32 v77, v77, v62
    v_sub_f32 v93, v93, v62
    v_sub_f32 v157, v157, v62
    v_sub_f32 v78, v78, v62
    v_sub_f32 v94, v94, v62
    v_sub_f32 v158, v158, v62
    v_sub_f32 v79, v79, v62
    v_sub_f32 v95, v95, v62
    v_sub_f32 v159, v159, v62
    v_mul_f32 v162, v58, v162
    v_mul_f32 v163, v58, v163
    v_mul_f32 v196, v58, v196
    v_mul_f32 v197, v58, v197
    v_mul_f32 v198, v58, v198
    v_mul_f32 v199, v58, v199
    v_mul_f32 v204, v58, v204
    v_mul_f32 v205, v58, v205
    v_mul_f32 v206, v58, v206
    v_mul_f32 v207, v58, v207
    v_mul_f32 v212, v58, v212
    v_mul_f32 v213, v58, v213
    v_mul_f32 v214, v58, v214
    v_mul_f32 v215, v58, v215
    v_mul_f32 v220, v58, v220
    v_mul_f32 v221, v58, v221
    v_mul_f32 v222, v58, v222
    v_mul_f32 v223, v58, v223
    v_mul_f32 v228, v58, v228
    v_mul_f32 v229, v58, v229
    v_mul_f32 v230, v58, v230
    v_mul_f32 v231, v58, v231
    v_mul_f32 v236, v58, v236
    v_mul_f32 v237, v58, v237
    v_mul_f32 v238, v58, v238
    v_mul_f32 v239, v58, v239
    v_mul_f32 v244, v58, v244
    v_mul_f32 v245, v58, v245
    v_mul_f32 v246, v58, v246
    v_mul_f32 v247, v58, v247
    v_mul_f32 v252, v58, v252
    v_mul_f32 v253, v58, v253
    v_mul_f32 v254, v58, v254
    v_mul_f32 v255, v58, v255
    v_exp_f32 v58, v80
    s_nop 0
    v_exp_f32 v59, v81
    s_nop 0
    v_cvt_pk_bf16_f32 v136, v58, v59
    v_exp_f32 v60, v82
    s_nop 0
    v_exp_f32 v61, v83
    s_nop 0
    v_cvt_pk_bf16_f32 v137, v60, v61
    v_exp_f32 v58, v84
    s_nop 0
    v_exp_f32 v59, v85
    s_nop 0
    v_cvt_pk_bf16_f32 v140, v58, v59
    v_exp_f32 v60, v86
    s_nop 0
    v_exp_f32 v61, v87
    s_nop 0
    v_cvt_pk_bf16_f32 v141, v60, v61
    v_exp_f32 v58, v88
    s_nop 0
    v_exp_f32 v59, v89
    s_nop 0
    v_cvt_pk_bf16_f32 v138, v58, v59
    v_exp_f32 v60, v90
    s_nop 0
    v_exp_f32 v61, v91
    s_nop 0
    v_cvt_pk_bf16_f32 v139, v60, v61
    v_exp_f32 v58, v92
    s_nop 0
    v_exp_f32 v59, v93
    s_nop 0
    v_cvt_pk_bf16_f32 v142, v58, v59
    v_exp_f32 v60, v94
    s_nop 0
    v_exp_f32 v61, v95
    s_nop 0
    v_cvt_pk_bf16_f32 v143, v60, v61
    s_nop 1
    s_setpc_b64 s[80:81]
L_adone:
    ds_read_b128 v[16:19], v4 offset:0
    ds_read_b128 v[20:23], v4 offset:1024
    ds_read_b128 v[24:27], v4 offset:2048
    ds_read_b128 v[28:31], v4 offset:3072
    s_waitcnt lgkmcnt(3)
    v_mfma_f32_16x16x32_bf16 v[56:59], v[96:99], v[16:19], 0
    s_cmp_lt_u32 s3, 4
    s_cbranch_scc1 L_nowl_50
    s_waitcnt vmcnt(5)
    s_lshl_b32 s6, s60, 5
    s_add_u32 s6, s6, s4
    s_lshl_b32 s6, s6, 7
    s_add_u32 s6, s6, 3932160
    v_mov_b32 v2, 1
    v_mov_b32 v3, 0x5000000
    v_writelane_b32 v3, s6, 0
    buffer_store_dword v2, v3, s[8:11], 0 offen sc1
    s_add_u32 s75, s69, 204800
    buffer_load_dwordx4 v[196:199], v44, s[8:11], s75 offen sc1
    buffer_load_dwordx4 v[200:203], v45, s[8:11], s75 offen sc1
    buffer_load_dwordx4 v[204:207], v46, s[8:11], s75 offen sc1
    buffer_load_dwordx4 v[208:211], v47, s[8:11], s75 offen sc1
    buffer_load_dwordx4 v[212:215], v52, s[8:11], s75 offen sc1
L_nowl_50:
    v_mfma_f32_16x16x32_bf16 v[60:63], v[100:103], v[16:19], 0
    s_cmp_lt_u32 s3, 4
    s_cbranch_scc1 L_nowl_51
    s_add_u32 s75, s69, 245760
    buffer_load_dwordx4 v[216:219], v44, s[8:11], s75 offen sc1
    buffer_load_dwordx4 v[220:223], v45, s[8:11], s75 offen sc1
    buffer_load_dwordx4 v[224:227], v46, s[8:11], s75 offen sc1
    buffer_load_dwordx4 v[228:231], v47, s[8:11], s75 offen sc1
    buffer_load_dwordx4 v[232:235], v52, s[8:11], s75 offen sc1
L_nowl_51:
    v_mfma_f32_16x16x32_bf16 v[64:67], v[104:107], v[16:19], 0
    s_cmp_lt_u32 s3, 4
    s_cbranch_scc1 L_nowl_52
    s_add_u32 s75, s69, 286720
    buffer_load_dwordx4 v[236:239], v44, s[8:11], s75 offen sc1
    buffer_load_dwordx4 v[240:243], v45, s[8:11], s75 offen sc1
    buffer_load_dwordx4 v[244:247], v46, s[8:11], s75 offen sc1
    buffer_load_dwordx4 v[248:251], v47, s[8:11], s75 offen sc1
    buffer_load_dwordx4 v[252:255], v52, s[8:11], s75 offen sc1
L_nowl_52:
    v_mfma_f32_16x16x32_bf16 v[68:71], v[108:111], v[16:19], 0
    s_waitcnt lgkmcnt(2)
    s_cmp_ge_u32 s3, 4
    s_cbranch_scc1 L_o0
    s_waitcnt vmcnt(0)
    s_barrier
L_o0:
    v_mfma_f32_16x16x32_bf16 v[72:75], v[112:115], v[16:19], 0
    ds_read_b128 v[16:19], v4 offset:4096
    s_lshr_b32 s6, s3, 2
    s_mul_i32 s67, s6, 15360
    s_add_u32 s67, s67, 98304
    v_add_u32 v6, s67, v44
    v_mfma_f32_16x16x32_bf16 v[56:59], v[116:119], v[20:23], v[56:59]
    s_mul_i32 s73, s6, 5120
    s_add_u32 s73, s73, 67108864
    s_lshl_b32 s6, s6, 1
    s_sub_u32 s71, s76, s6
    v_mfma_f32_16x16x32_bf16 v[60:63], v[120:123], v[20:23], v[60:63]
    s_and_b32 s71, s71, 3
    v_mov_b32 v11, 0x5000000
    s_lshl_b32 s74, s3, 2
    s_add_u32 s74, s74, 15728640
    v_mfma_f32_16x16x32_bf16 v[64:67], v[124:127], v[20:23], v[64:67]
    s_and_b32 s72, s4, 7
    s_lshl_b32 s7, s5, 3
    s_add_u32 s72, s72, s7
    s_mul_i32 s72, s72, 12
    v_mfma_f32_16x16x32_bf16 v[68:71], v[128:131], v[20:23], v[68:71]
    s_waitcnt lgkmcnt(2)
    s_lshr_b32 s75, s4, 3
    s_mul_i32 s7, s75, 3
    s_add_u32 s7, s7, s72
    s_mul_i32 s62, s7, 20480
    v_mfma_f32_16x16x32_bf16 v[72:75], v[132:135], v[20:23], v[72:75]
    ds_read_b128 v[20:23], v4 offset:5120
    s_add_u32 s62, s62, 67108864
    s_lshl_b32 s7, s7, 7
    s_add_u32 s63, s7, 15728640
    s_add_u32 s6, s75, 1
    v_mfma_f32_16x16x32_bf16 v[72:75], v[152:155], v[24:27], v[72:75]
    s_and_b32 s6, s6, 3
    s_mul_i32 s6, s6, 3
    s_add_u32 s6, s6, s72
    s_add_u32 s6, s6, 0
    v_mfma_f32_16x16x32_bf16 v[68:71], v[148:151], v[24:27], v[68:71]
    s_mul_i32 s7, s6, 20480
    s_add_u32 s96, s7, s73
    s_lshl_b32 s6, s6, 7
    s_add_u32 s6, s6, s74
    v_mfma_f32_16x16x32_bf16 v[64:67], v[144:147], v[24:27], v[64:67]
    v_writelane_b32 v11, s6, 0
    s_add_u32 s6, s75, 2
    s_and_b32 s6, s6, 3
    s_mul_i32 s6, s6, 3
    v_mfma_f32_16x16x32_bf16 v[60:63], v[140:143], v[24:27], v[60:63]
    s_waitcnt lgkmcnt(2)
    s_add_u32 s6, s6, s72
    s_add_u32 s6, s6, 1
    s_mul_i32 s7, s6, 20480
    s_add_u32 s97, s7, s73
    v_mfma_f32_16x16x32_bf16 v[56:59], v[136:139], v[24:27], v[56:59]
    ds_read_b128 v[24:27], v4 offset:6144
    s_lshl_b32 s6, s6, 7
    s_add_u32 s6, s6, s74
    v_writelane_b32 v11, s6, 1
    s_add_u32 s6, s75, 3
    v_mfma_f32_16x16x32_bf16 v[56:59], v[156:159], v[28:31], v[56:59]
    s_and_b32 s6, s6, 3
    s_mul_i32 s6, s6, 3
    s_add_u32 s6, s6, s72
    s_add_u32 s6, s6, 2
    v_mfma_f32_16x16x32_bf16 v[60:63], v[160:163], v[28:31], v[60:63]
    s_mul_i32 s7, s6, 20480
    s_add_u32 s98, s7, s73
    s_lshl_b32 s6, s6, 7
    s_add_u32 s6, s6, s74
    v_mfma_f32_16x16x32_bf16 v[64:67], v[164:167], v[28:31], v[64:67]
    v_writelane_b32 v11, s6, 2
    v_mfma_f32_16x16x32_bf16 v[68:71], v[168:171], v[28:31], v[68:71]
    s_waitcnt lgkmcnt(2)
    v_mfma_f32_16x16x32_bf16 v[72:75], v[172:175], v[28:31], v[72:75]
    ds_read_b128 v[28:31], v4 offset:7168
    s_waitcnt vmcnt(16)
    v_mfma_f32_16x16x32_bf16 v[72:75], v[192:195], v[16:19], v[72:75]
    v_mfma_f32_16x16x32_bf16 v[68:71], v[188:191], v[16:19], v[68:71]
    s_add_u32 s65, s68, 3
    s_and_b32 s65, s65, 3
    s_andn2_b32 s7, s68, 3
    v_mfma_f32_16x16x32_bf16 v[64:67], v[184:187], v[16:19], v[64:67]
    s_add_u32 s65, s65, s7
    s_lshl_b32 s65, s65, 17
    s_add_u32 s65, s65, s66
    v_mfma_f32_16x16x32_bf16 v[60:63], v[180:183], v[16:19], v[60:63]
    s_waitcnt lgkmcnt(2)
    s_add_u32 m0, s99, 65536
    v_mfma_f32_16x16x32_bf16 v[56:59], v[176:179], v[16:19], v[56:59]
    ds_read_b128 v[16:19], v4 offset:32768
    s_waitcnt vmcnt(10)
    v_mfma_f32_16x16x32_bf16 v[56:59], v[196:199], v[20:23], v[56:59]
    buffer_load_dwordx4 v13, s[8:11], s65 offen offset:0 sc1 lds
    v_mfma_f32_16x16x32_bf16 v[60:63], v[200:203], v[20:23], v[60:63]
    buffer_load_dwordx4 v13, s[8:11], s65 offen offset:1024 sc1 lds
    v_mfma_f32_16x16x32_bf16 v[64:67], v[204:207], v[20:23], v[64:67]
    v_mfma_f32_16x16x32_bf16 v[68:71], v[208:211], v[20:23], v[68:71]
    buffer_load_dwordx4 v13, s[8:11], s65 offen offset:2048 sc1 lds
    s_waitcnt lgkmcnt(2)
    v_mfma_f32_16x16x32_bf16 v[72:75], v[212:215], v[20:23], v[72:75]
    ds_read_b128 v[20:23], v4 offset:33792
    s_waitcnt vmcnt(8)
    v_mfma_f32_16x16x32_bf16 v[72:75], v[232:235], v[24:27], v[72:75]
    buffer_load_dwordx4 v13, s[8:11], s65 offen offset:3072 sc1 lds
    v_mfma_f32_16x16x32_bf16 v[68:71], v[228:231], v[24:27], v[68:71]
    v_mfma_f32_16x16x32_bf16 v[64:67], v[224:227], v[24:27], v[64:67]
    v_mfma_f32_16x16x32_bf16 v[60:63], v[220:223], v[24:27], v[60:63]
    s_waitcnt lgkmcnt(2)
    v_mfma_f32_16x16x32_bf16 v[56:59], v[216:219], v[24:27], v[56:59]
    ds_read_b128 v[24:27], v4 offset:34816
    s_waitcnt vmcnt(4)
    v_mfma_f32_16x16x32_bf16 v[56:59], v[236:239], v[28:31], v[56:59]
    v_mfma_f32_16x16x32_bf16 v[60:63], v[240:243], v[28:31], v[60:63]
    v_mfma_f32_16x16x32_bf16 v[64:67], v[244:247], v[28:31], v[64:67]
    v_mfma_f32_16x16x32_bf16 v[68:71], v[248:251], v[28:31], v[68:71]
    s_waitcnt lgkmcnt(2)
    v_mfma_f32_16x16x32_bf16 v[72:75], v[252:255], v[28:31], v[72:75]
    ds_read_b128 v[28:31], v4 offset:35840
    v_mfma_f32_16x16x32_bf16 v[76:79], v[96:99], v[16:19], 0
    s_sub_u32 s6, s71, 1
    s_and_b32 s6, s6, 3
    s_mul_i32 s7, s6, 5120
    v_mfma_f32_16x16x32_bf16 v[80:83], v[100:103], v[16:19], 0
    s_add_u32 s7, s7, s67
    s_cmp_eq_u32 s6, 3
    s_cselect_b32 s7, 155648, s7
    v_mfma_f32_16x16x32_bf16 v[84:87], v[104:107], v[16:19], 0
    v_add_u32 v12, s7, v52
    v_add_u32 v5, s67, v45
    v_mfma_f32_16x16x32_bf16 v[88:91], v[108:111], v[16:19], 0
    s_waitcnt lgkmcnt(2)
    v_mfma_f32_16x16x32_bf16 v[92:95], v[112:115], v[16:19], 0
    ds_read_b128 v[16:19], v4 offset:36864
    v_mfma_f32_16x16x32_bf16 v[76:79], v[116:119], v[20:23], v[76:79]
    ds_write_b128 v5, v[60:63] offset:0
    v_add_u32 v5, s67, v46
    v_mfma_f32_16x16x32_bf16 v[80:83], v[120:123], v[20:23], v[80:83]
    v_and_b32 v3, 1, v1
    v_lshlrev_b32 v3, 12, v3
    s_lshr_b32 s72, s61, 2
    s_lshl_b32 s72, s72, 6
    s_andn2_b32 s6, s4, 7
    s_add_u32 s72, s72, s6
    s_add_u32 s72, s72, s3
    s_lshl_b32 s72, s72, 7
    s_add_u32 s72, s72, 3932160
    v_mfma_f32_16x16x32_bf16 v[84:87], v[124:127], v[20:23], v[84:87]
    v_mfma_f32_16x16x32_bf16 v[88:91], v[128:131], v[20:23], v[88:91]
    s_waitcnt lgkmcnt(3)
    v_mfma_f32_16x16x32_bf16 v[92:95], v[132:135], v[20:23], v[92:95]
    ds_read_b128 v[20:23], v4 offset:37888
    v_mfma_f32_16x16x32_bf16 v[92:95], v[152:155], v[24:27], v[92:95]
    ds_write_b128 v5, v[64:67] offset:5120
    v_add_u32 v5, s67, v47
    v_mfma_f32_16x16x32_bf16 v[88:91], v[148:151], v[24:27], v[88:91]
    v_mfma_f32_16x16x32_bf16 v[84:87], v[144:147], v[24:27], v[84:87]
    buffer_load_dword v50, v3, s[8:11], s72 offen sc1
    v_mfma_f32_16x16x32_bf16 v[80:83], v[140:143], v[24:27], v[80:83]
    s_waitcnt lgkmcnt(4)
    v_mfma_f32_16x16x32_bf16 v[76:79], v[136:139], v[24:27], v[76:79]
    ds_read_b128 v[24:27], v4 offset:38912
    v_mfma_f32_16x16x32_bf16 v[76:79], v[156:159], v[28:31], v[76:79]
    ds_write_b128 v5, v[68:71] offset:10240
    v_add_u32 v5, s67, v52
    v_mfma_f32_16x16x32_bf16 v[80:83], v[160:163], v[28:31], v[80:83]
    v_mfma_f32_16x16x32_bf16 v[84:87], v[164:167], v[28:31], v[84:87]
    v_mfma_f32_16x16x32_bf16 v[88:91], v[168:171], v[28:31], v[88:91]
    s_waitcnt lgkmcnt(5)
    v_mfma_f32_16x16x32_bf16 v[92:95], v[172:175], v[28:31], v[92:95]
    ds_read_b128 v[28:31], v4 offset:39936
    v_mfma_f32_16x16x32_bf16 v[92:95], v[192:195], v[16:19], v[92:95]
    ds_write_b128 v12, v[72:75] offset:0
    v_mfma_f32_16x16x32_bf16 v[88:91], v[188:191], v[16:19], v[88:91]
    v_mfma_f32_16x16x32_bf16 v[84:87], v[184:187], v[16:19], v[84:87]
    v_mfma_f32_16x16x32_bf16 v[80:83], v[180:183], v[16:19], v[80:83]
    s_waitcnt lgkmcnt(5)
    v_mfma_f32_16x16x32_bf16 v[76:79], v[176:179], v[16:19], v[76:79]
    s_waitcnt vmcnt(0)
    s_waitcnt lgkmcnt(0)
    s_barrier
    ds_read_b128 v[32:35], v6 offset:0
    ds_read_b128 v[36:39], v6 offset:5120
    ds_read_b128 v[40:43], v6 offset:10240
    ds_read_b128 v[16:19], v7 offset:0
    v_mfma_f32_16x16x32_bf16 v[76:79], v[196:199], v[20:23], v[76:79]
    v_cmp_ne_u32 vcc, 1, v50
    s_mov_b32 s91, 0
    s_cbranch_vccnz L_t3n
    s_add_u32 s65, s61, 1
    s_and_b32 s65, s65, 3
    s_andn2_b32 s7, s61, 3
    s_add_u32 s65, s65, s7
    s_lshl_b32 s65, s65, 17
    s_add_u32 s65, s65, s66
    s_add_u32 m0, s99, 0
    s_add_u32 s65, s65, 0
    buffer_load_dwordx4 v13, s[8:11], s65 offen offset:0 sc1 lds
    buffer_load_dwordx4 v13, s[8:11], s65 offen offset:1024 sc1 lds
    buffer_load_dwordx4 v13, s[8:11], s65 offen offset:2048 sc1 lds
    buffer_load_dwordx4 v13, s[8:11], s65 offen offset:3072 sc1 lds
    s_mov_b32 s91, 1
    s_branch L_t3j
L_t3n:
    buffer_load_dword v50, v3, s[8:11], s72 offen sc1
L_t3j:
    v_mfma_f32_16x16x32_bf16 v[80:83], v[200:203], v[20:23], v[80:83]
    v_mfma_f32_16x16x32_bf16 v[84:87], v[204:207], v[20:23], v[84:87]
    s_waitcnt lgkmcnt(3)
    v_add_f32 v56, v56, v32
    v_add_f32 v57, v57, v33
    v_mfma_f32_16x16x32_bf16 v[88:91], v[208:211], v[20:23], v[88:91]
    v_add_f32 v58, v58, v34
    v_add_f32 v59, v59, v35
    v_mfma_f32_16x16x32_bf16 v[92:95], v[212:215], v[20:23], v[92:95]
    s_waitcnt lgkmcnt(2)
    ds_read_b128 v[32:35], v5 offset:0
    ds_read_b128 v[20:23], v7 offset:1024
    v_add_f32 v56, v56, v36
    v_add_f32 v57, v57, v37
    v_mfma_f32_16x16x32_bf16 v[92:95], v[232:235], v[24:27], v[92:95]
    v_add_f32 v58, v58, v38
    v_add_f32 v59, v59, v39
    v_mfma_f32_16x16x32_bf16 v[88:91], v[228:231], v[24:27], v[88:91]
    s_waitcnt lgkmcnt(3)
    ds_read_b128 v[36:39], v5 offset:5120
    v_add_f32 v56, v56, v40
    v_add_f32 v57, v57, v41
    v_mfma_f32_16x16x32_bf16 v[84:87], v[224:227], v[24:27], v[84:87]
    v_add_f32 v58, v58, v42
    v_add_f32 v59, v59, v43
    v_mfma_f32_16x16x32_bf16 v[80:83], v[220:223], v[24:27], v[80:83]
    ds_read_b128 v[40:43], v5 offset:10240
    s_waitcnt lgkmcnt(3)
    v_add_f32 v72, v72, v32
    v_add_f32 v73, v73, v33
    s_add_u32 s6, s96, 0
    v_mfma_f32_16x16x32_bf16 v[76:79], v[216:219], v[24:27], v[76:79]
    ds_read_b128 v[24:27], v7 offset:2048
    v_add_f32 v74, v74, v34
    v_add_f32 v75, v75, v35
    v_mfma_f32_16x16x32_bf16 v[76:79], v[236:239], v[28:31], v[76:79]
    buffer_store_dwordx4 v[56:59], v44, s[8:11], s6 offen sc1
    s_waitcnt lgkmcnt(2)
    v_add_f32 v72, v72, v36
    v_add_f32 v73, v73, v37
    v_mfma_f32_16x16x32_bf16 v[80:83], v[240:243], v[28:31], v[80:83]
    v_add_f32 v74, v74, v38
    v_add_f32 v75, v75, v39
    v_mfma_f32_16x16x32_bf16 v[84:87], v[244:247], v[28:31], v[84:87]
    s_waitcnt lgkmcnt(1)
    v_add_f32 v72, v72, v40
    v_add_f32 v73, v73, v41
    v_mfma_f32_16x16x32_bf16 v[88:91], v[248:251], v[28:31], v[88:91]
    v_add_f32 v74, v74, v42
    v_add_f32 v75, v75, v43
    s_cmp_lg_u32 s71, 0
    v_mfma_f32_16x16x32_bf16 v[92:95], v[252:255], v[28:31], v[92:95]
    s_cbranch_scc1 L_nost_53
    buffer_store_dwordx4 v[72:75], v52, s[8:11], s6 offen sc1
L_nost_53:
    ds_read_b128 v[28:31], v7 offset:3072
    v_mfma_f32_16x16x32_bf16 v[56:59], v[96:99], v[16:19], 0
    s_sub_u32 s6, s71, 2
    s_and_b32 s6, s6, 3
    s_mul_i32 s7, s6, 5120
    v_mfma_f32_16x16x32_bf16 v[60:63], v[100:103], v[16:19], 0
    s_add_u32 s7, s7, s67
    s_cmp_eq_u32 s6, 3
    s_cselect_b32 s7, 124928, s7
    v_mfma_f32_16x16x32_bf16 v[64:67], v[104:107], v[16:19], 0
    v_add_u32 v12, s7, v52
    v_add_u32 v5, s67, v45
    s_cmp_lg_u32 s91, 0
    s_cbranch_scc1 L_o2
    s_waitcnt vmcnt(1)
    v_cmp_ne_u32 vcc, 1, v50
    s_cbranch_vccz L_o1
    s_mov_b32 s79, 262144
L_poll_55:
    buffer_load_dword v2, v3, s[8:11], s72 offen sc1
    s_waitcnt vmcnt(0)
    v_cmp_ne_u32 vcc, 1, v2
    s_cbranch_vccz L_polldone_56
    s_sleep 1
    s_sub_u32 s79, s79, 1
    s_cmp_lg_u32 s79, 0
    s_cbranch_scc1 L_poll_55
L_polldone_56:
L_o1:
    s_add_u32 s65, s61, 1
    s_and_b32 s65, s65, 3
    s_andn2_b32 s7, s61, 3
    s_add_u32 s65, s65, s7
    s_lshl_b32 s65, s65, 17
    s_add_u32 s65, s65, s66
    s_add_u32 m0, s99, 0
    s_add_u32 s65, s65, 0
    buffer_load_dwordx4 v13, s[8:11], s65 offen offset:0 sc1 lds
    buffer_load_dwordx4 v13, s[8:11], s65 offen offset:1024 sc1 lds
    buffer_load_dwordx4 v13, s[8:11], s65 offen offset:2048 sc1 lds
    buffer_load_dwordx4 v13, s[8:11], s65 offen offset:3072 sc1 lds
L_o2:
    v_mfma_f32_16x16x32_bf16 v[68:71], v[108:111], v[16:19], 0
    v_mfma_f32_16x16x32_bf16 v[72:75], v[112:115], v[16:19], 0
    ds_read_b128 v[16:19], v7 offset:4096
    v_mfma_f32_16x16x32_bf16 v[56:59], v[116:119], v[20:23], v[56:59]
    ds_write_b128 v5, v[80:83] offset:30720
    v_add_u32 v5, s67, v46
    v_mfma_f32_16x16x32_bf16 v[60:63], v[120:123], v[20:23], v[60:63]
    s_add_u32 s65, s61, 2
    s_and_b32 s65, s65, 3
    s_andn2_b32 s7, s61, 3
    v_mfma_f32_16x16x32_bf16 v[64:67], v[124:127], v[20:23], v[64:67]
    s_add_u32 s65, s65, s7
    s_lshl_b32 s65, s65, 17
    s_add_u32 s65, s65, s66
    v_mfma_f32_16x16x32_bf16 v[68:71], v[128:131], v[20:23], v[68:71]
    s_waitcnt lgkmcnt(3)
    s_add_u32 m0, s99, 32768
    v_mfma_f32_16x16x32_bf16 v[72:75], v[132:135], v[20:23], v[72:75]
    buffer_load_dwordx4 v13, s[8:11], s65 offen offset:0 sc1 lds
    ds_read_b128 v[20:23], v7 offset:5120
    v_mfma_f32_16x16x32_bf16 v[72:75], v[152:155], v[24:27], v[72:75]
    ds_write_b128 v5, v[84:87] offset:35840
    v_add_u32 v5, s67, v47
    v_mfma_f32_16x16x32_bf16 v[68:71], v[148:151], v[24:27], v[68:71]
    buffer_load_dwordx4 v13, s[8:11], s65 offen offset:1024 sc1 lds
    v_mfma_f32_16x16x32_bf16 v[64:67], v[144:147], v[24:27], v[64:67]
    buffer_load_dwordx4 v13, s[8:11], s65 offen offset:2048 sc1 lds
    v_mfma_f32_16x16x32_bf16 v[60:63], v[140:143], v[24:27], v[60:63]
    buffer_load_dwordx4 v13, s[8:11], s65 offen offset:3072 sc1 lds
    s_waitcnt lgkmcnt(4)
    v_mfma_f32_16x16x32_bf16 v[56:59], v[136:139], v[24:27], v[56:59]
    ds_read_b128 v[24:27], v7 offset:6144
    v_mfma_f32_16x16x32_bf16 v[56:59], v[156:159], v[28:31], v[56:59]
    ds_write_b128 v5, v[88:91] offset:40960
    v_add_u32 v5, s67, v52
    v_mfma_f32_16x16x32_bf16 v[60:63], v[160:163], v[28:31], v[60:63]
    v_mfma_f32_16x16x32_bf16 v[64:67], v[164:167], v[28:31], v[64:67]
    v_mfma_f32_16x16x32_bf16 v[68:71], v[168:171], v[28:31], v[68:71]
    s_waitcnt lgkmcnt(5)
    v_mfma_f32_16x16x32_bf16 v[72:75], v[172:175], v[28:31], v[72:75]
    ds_read_b128 v[28:31], v7 offset:7168
    v_mfma_f32_16x16x32_bf16 v[72:75], v[192:195], v[16:19], v[72:75]
    ds_write_b128 v12, v[92:95] offset:30720
    v_mfma_f32_16x16x32_bf16 v[68:71], v[188:191], v[16:19], v[68:71]
    s_add_u32 s65, s61, 3
    s_and_b32 s65, s65, 3
    s_andn2_b32 s7, s61, 3
    v_mfma_f32_16x16x32_bf16 v[64:67], v[184:187], v[16:19], v[64:67]
    s_add_u32 s65, s65, s7
    s_lshl_b32 s65, s65, 17
    s_add_u32 s65, s65, s66
    v_mfma_f32_16x16x32_bf16 v[60:63], v[180:183], v[16:19], v[60:63]
    s_waitcnt lgkmcnt(5)
    s_add_u32 m0, s99, 65536
    v_mfma_f32_16x16x32_bf16 v[56:59], v[176:179], v[16:19], v[56:59]
    s_waitcnt vmcnt(4)
    s_waitcnt lgkmcnt(0)
    s_barrier
    ds_read_b128 v[32:35], v6 offset:30720
    ds_read_b128 v[36:39], v6 offset:35840
    ds_read_b128 v[40:43], v6 offset:40960
    ds_read_b128 v[16:19], v4 offset:0
    v_mfma_f32_16x16x32_bf16 v[56:59], v[196:199], v[20:23], v[56:59]
    buffer_load_dwordx4 v13, s[8:11], s65 offen offset:0 sc1 lds
    v_mfma_f32_16x16x32_bf16 v[60:63], v[200:203], v[20:23], v[60:63]
    buffer_load_dwordx4 v13, s[8:11], s65 offen offset:1024 sc1 lds
    v_mfma_f32_16x16x32_bf16 v[64:67], v[204:207], v[20:23], v[64:67]
    s_waitcnt lgkmcnt(3)
    v_add_f32 v76, v76, v32
    v_add_f32 v77, v77, v33
    v_mfma_f32_16x16x32_bf16 v[68:71], v[208:211], v[20:23], v[68:71]
    buffer_load_dwordx4 v13, s[8:11], s65 offen offset:2048 sc1 lds
    v_add_f32 v78, v78, v34
    v_add_f32 v79, v79, v35
    v_mfma_f32_16x16x32_bf16 v[72:75], v[212:215], v[20:23], v[72:75]
    s_waitcnt lgkmcnt(2)
    ds_read_b128 v[32:35], v5 offset:30720
    ds_read_b128 v[20:23], v4 offset:1024
    v_add_f32 v76, v76, v36
    v_add_f32 v77, v77, v37
    v_mfma_f32_16x16x32_bf16 v[72:75], v[232:235], v[24:27], v[72:75]
    buffer_load_dwordx4 v13, s[8:11], s65 offen offset:3072 sc1 lds
    v_add_f32 v78, v78, v38
    v_add_f32 v79, v79, v39
    v_mfma_f32_16x16x32_bf16 v[68:71], v[228:231], v[24:27], v[68:71]
    s_waitcnt lgkmcnt(3)
    ds_read_b128 v[36:39], v5 offset:35840
    v_add_f32 v76, v76, v40
    v_add_f32 v77, v77, v41
    v_mfma_f32_16x16x32_bf16 v[64:67], v[224:227], v[24:27], v[64:67]
    v_add_f32 v78, v78, v42
    v_add_f32 v79, v79, v43
    v_mfma_f32_16x16x32_bf16 v[60:63], v[220:223], v[24:27], v[60:63]
    ds_read_b128 v[40:43], v5 offset:40960
    s_waitcnt lgkmcnt(3)
    v_add_f32 v92, v92, v32
    v_add_f32 v93, v93, v33
    s_add_u32 s6, s97, 0
    v_mfma_f32_16x16x32_bf16 v[56:59], v[216:219], v[24:27], v[56:59]
    ds_read_b128 v[24:27], v4 offset:2048
    v_add_f32 v94, v94, v34
    v_add_f32 v95, v95, v35
    v_mfma_f32_16x16x32_bf16 v[56:59], v[236:239], v[28:31], v[56:59]
    buffer_store_dwordx4 v[76:79], v44, s[8:11], s6 offen sc1
    s_waitcnt lgkmcnt(2)
    v_add_f32 v92, v92, v36
    v_add_f32 v93, v93, v37
    v_mfma_f32_16x16x32_bf16 v[60:63], v[240:243], v[28:31], v[60:63]
    v_add_f32 v94, v94, v38
    v_add_f32 v95, v95, v39
    v_mfma_f32_16x16x32_bf16 v[64:67], v[244:247], v[28:31], v[64:67]
    s_waitcnt lgkmcnt(1)
    v_add_f32 v92, v92, v40
    v_add_f32 v93, v93, v41
    v_mfma_f32_16x16x32_bf16 v[68:71], v[248:251], v[28:31], v[68:71]
    v_add_f32 v94, v94, v42
    v_add_f32 v95, v95, v43
    s_cmp_lg_u32 s71, 1
    v_mfma_f32_16x16x32_bf16 v[72:75], v[252:255], v[28:31], v[72:75]
    s_cbranch_scc1 L_nost_54
    buffer_store_dwordx4 v[92:95], v52, s[8:11], s6 offen sc1
L_nost_54:
    ds_read_b128 v[28:31], v4 offset:3072
    v_mfma_f32_16x16x32_bf16 v[76:79], v[96:99], v[16:19], 0
    s_sub_u32 s6, s71, 3
    s_and_b32 s6, s6, 3
    s_mul_i32 s7, s6, 5120
    v_mfma_f32_16x16x32_bf16 v[80:83], v[100:103], v[16:19], 0
    s_add_u32 s7, s7, s67
    s_cmp_eq_u32 s6, 3
    s_cselect_b32 s7, 155648, s7
    v_mfma_f32_16x16x32_bf16 v[84:87], v[104:107], v[16:19], 0
    v_add_u32 v12, s7, v52
    v_add_u32 v5, s67, v45
    v_mfma_f32_16x16x32_bf16 v[88:91], v[108:111], v[16:19], 0
    s_mov_b32 s12, s32
    s_mov_b32 s13, s33
    s_mov_b32 s14, 0x280000
    s_mov_b32 s15, 0x20000
    v_mfma_f32_16x16x32_bf16 v[92:95], v[112:115], v[16:19], 0
    ds_read_b128 v[16:19], v4 offset:4096
    s_and_b32 s75, s4, 3
    s_mul_i32 s70, s75, 320
    s_add_u32 s73, s70, 3837952
    s_mul_i32 s72, s75, 5120
    v_mfma_f32_16x16x32_bf16 v[76:79], v[116:119], v[20:23], v[76:79]
    ds_write_b128 v5, v[60:63] offset:0
    v_add_u32 v5, s67, v46
    v_mfma_f32_16x16x32_bf16 v[80:83], v[120:123], v[20:23], v[80:83]
    v_lshrrev_b32 v2, 4, v1
    v_and_b32 v3, 15, v1
    v_mul_u32_u24 v54, 1280, v3
    v_lshl_add_u32 v54, v2, 4, v54
    v_mfma_f32_16x16x32_bf16 v[84:87], v[124:127], v[20:23], v[84:87]
    v_lshlrev_b32 v3, 4, v3
    v_lshl_add_u32 v9, v2, 9, v3
    s_lshr_b32 s100, s3, 2
    s_cselect_b32 s6, s61, s68
    v_mfma_f32_16x16x32_bf16 v[88:91], v[128:131], v[20:23], v[88:91]
    s_waitcnt lgkmcnt(3)
    s_mul_i32 s6, s6, 20480
    s_lshl_b32 s7, s76, 6
    s_add_u32 s7, s7, s6
    v_add_u32 v53, s7, v54
    v_mfma_f32_16x16x32_bf16 v[92:95], v[132:135], v[20:23], v[92:95]
    ds_read_b128 v[20:23], v4 offset:5120
    s_lshl_b32 s7, s76, 10
    s_add_u32 s7, s7, s6
    s_add_u32 s7, s7, s72
    v_add_u32 v48, s7, v13
    v_mfma_f32_16x16x32_bf16 v[92:95], v[152:155], v[24:27], v[92:95]
    ds_write_b128 v5, v[64:67] offset:5120
    v_add_u32 v5, s67, v47
    v_mfma_f32_16x16x32_bf16 v[88:91], v[148:151], v[24:27], v[88:91]
    s_mul_i32 s6, s100, 10240
    s_lshl_b32 s7, s76, 11
    s_add_u32 s6, s6, s7
    v_add_u32 v8, s6, v9
    v_mfma_f32_16x16x32_bf16 v[84:87], v[144:147], v[24:27], v[84:87]
    s_mul_i32 s6, s100, 75776
    s_sub_u32 s6, 65536, s6
    v_add_u32 v10, s6, v8
    s_lshl_b32 s7, s76, 2
    v_mfma_f32_16x16x32_bf16 v[80:83], v[140:143], v[24:27], v[80:83]
    s_waitcnt lgkmcnt(4)
    v_add_u32 v2, s7, v2
    v_cmp_lt_u32 vcc, 9, v2
    s_mul_i32 s6, s100, 86016
    s_add_u32 s6, s6, 15360
    v_mfma_f32_16x16x32_bf16 v[76:79], v[136:139], v[24:27], v[76:79]
    ds_read_b128 v[24:27], v4 offset:6144
    v_add_u32 v3, s6, v10
    v_cndmask_b32 v10, v10, v3, vcc
    s_and_b32 s100, s3, 1
    s_cselect_b32 s6, s61, s68
    v_mfma_f32_16x16x32_bf16 v[76:79], v[156:159], v[28:31], v[76:79]
    ds_write_b128 v5, v[68:71] offset:10240
    v_add_u32 v5, s67, v52
    v_mfma_f32_16x16x32_bf16 v[80:83], v[160:163], v[28:31], v[80:83]
    s_mul_i32 s6, s6, 20480
    s_add_u32 s7, s6, 256
    v_add_u32 v54, s7, v54
    s_add_u32 s7, s6, s72
    v_mfma_f32_16x16x32_bf16 v[84:87], v[164:167], v[28:31], v[84:87]
    s_add_u32 s7, s7, 4096
    v_add_u32 v49, s7, v13
    s_mul_i32 s6, s100, 10240
    s_add_u32 s6, s6, 8192
    v_mfma_f32_16x16x32_bf16 v[88:91], v[168:171], v[28:31], v[88:91]
    s_waitcnt lgkmcnt(5)
    v_add_u32 v9, s6, v9
    s_mul_i32 s6, s100, 10240
    s_add_u32 s6, s6, 80896
    v_add_u32 v55, s6, v9
    v_mfma_f32_16x16x32_bf16 v[92:95], v[172:175], v[28:31], v[92:95]
    ds_read_b128 v[28:31], v4 offset:7168
    v_mfma_f32_16x16x32_bf16 v[92:95], v[192:195], v[16:19], v[92:95]
    ds_write_b128 v12, v[72:75] offset:0
    v_mfma_f32_16x16x32_bf16 v[88:91], v[188:191], v[16:19], v[88:91]
    s_add_u32 s65, s68, 0
    s_and_b32 s65, s65, 3
    s_andn2_b32 s7, s68, 3
    v_mfma_f32_16x16x32_bf16 v[84:87], v[184:187], v[16:19], v[84:87]
    s_add_u32 s65, s65, s7
    s_lshl_b32 s65, s65, 17
    s_add_u32 s65, s65, s66
    v_mfma_f32_16x16x32_bf16 v[80:83], v[180:183], v[16:19], v[80:83]
    s_waitcnt lgkmcnt(5)
    s_add_u32 m0, s99, 0
    v_mfma_f32_16x16x32_bf16 v[76:79], v[176:179], v[16:19], v[76:79]
    s_waitcnt vmcnt(5)
    s_waitcnt lgkmcnt(0)
    s_barrier
    ds_read_b128 v[32:35], v6 offset:0
    ds_read_b128 v[36:39], v6 offset:5120
    ds_read_b128 v[40:43], v6 offset:10240
    ds_read_b128 v[16:19], v4 offset:32768
    v_mfma_f32_16x16x32_bf16 v[76:79], v[196:199], v[20:23], v[76:79]
    buffer_load_dwordx4 v13, s[8:11], s65 offen offset:0 sc1 lds
    v_mfma_f32_16x16x32_bf16 v[80:83], v[200:203], v[20:23], v[80:83]
    buffer_load_dwordx4 v13, s[8:11], s65 offen offset:1024 sc1 lds
    v_mfma_f32_16x16x32_bf16 v[84:87], v[204:207], v[20:23], v[84:87]
    s_waitcnt lgkmcnt(3)
    v_add_f32 v56, v56, v32
    v_add_f32 v57, v57, v33
    v_mfma_f32_16x16x32_bf16 v[88:91], v[208:211], v[20:23], v[88:91]
    buffer_load_dwordx4 v13, s[8:11], s65 offen offset:2048 sc1 lds
    v_add_f32 v58, v58, v34
    v_add_f32 v59, v59, v35
    v_mfma_f32_16x16x32_bf16 v[92:95], v[212:215], v[20:23], v[92:95]
    s_waitcnt lgkmcnt(2)
    ds_read_b128 v[32:35], v5 offset:0
    ds_read_b128 v[20:23], v4 offset:33792
    v_add_f32 v56, v56, v36
    v_add_f32 v57, v57, v37
    v_mfma_f32_16x16x32_bf16 v[92:95], v[232:235], v[24:27], v[92:95]
    buffer_load_dwordx4 v13, s[8:11], s65 offen offset:3072 sc1 lds
    v_add_f32 v58, v58, v38
    v_add_f32 v59, v59, v39
    v_mfma_f32_16x16x32_bf16 v[88:91], v[228:231], v[24:27], v[88:91]
    s_waitcnt lgkmcnt(3)
    ds_read_b128 v[36:39], v5 offset:5120
    v_add_f32 v56, v56, v40
    v_add_f32 v57, v57, v41
    v_mfma_f32_16x16x32_bf16 v[84:87], v[224:227], v[24:27], v[84:87]
    v_add_f32 v58, v58, v42
    v_add_f32 v59, v59, v43
    v_mfma_f32_16x16x32_bf16 v[80:83], v[220:223], v[24:27], v[80:83]
    ds_read_b128 v[40:43], v5 offset:10240
    s_waitcnt lgkmcnt(3)
    v_add_f32 v72, v72, v32
    v_add_f32 v73, v73, v33
    s_add_u32 s6, s98, 0
    v_mfma_f32_16x16x32_bf16 v[76:79], v[216:219], v[24:27], v[76:79]
    ds_read_b128 v[24:27], v4 offset:34816
    v_add_f32 v74, v74, v34
    v_add_f32 v75, v75, v35
    v_mfma_f32_16x16x32_bf16 v[76:79], v[236:239], v[28:31], v[76:79]
    buffer_store_dwordx4 v[56:59], v44, s[8:11], s6 offen sc1
    s_waitcnt lgkmcnt(2)
    v_add_f32 v72, v72, v36
    v_add_f32 v73, v73, v37
    v_mfma_f32_16x16x32_bf16 v[80:83], v[240:243], v[28:31], v[80:83]
    v_add_f32 v74, v74, v38
    v_add_f32 v75, v75, v39
    v_mfma_f32_16x16x32_bf16 v[84:87], v[244:247], v[28:31], v[84:87]
    s_waitcnt lgkmcnt(1)
    v_add_f32 v72, v72, v40
    v_add_f32 v73, v73, v41
    v_mfma_f32_16x16x32_bf16 v[88:91], v[248:251], v[28:31], v[88:91]
    v_add_f32 v74, v74, v42
    v_add_f32 v75, v75, v43
    s_cmp_lg_u32 s71, 2
    v_mfma_f32_16x16x32_bf16 v[92:95], v[252:255], v[28:31], v[92:95]
    s_cbranch_scc1 L_nost_57
    buffer_store_dwordx4 v[72:75], v52, s[8:11], s6 offen sc1
L_nost_57:
    ds_read_b128 v[28:31], v4 offset:35840
    v_mfma_f32_16x16x32_bf16 v[56:59], v[96:99], v[16:19], 0
    s_sub_u32 s6, s71, 4
    s_and_b32 s6, s6, 3
    s_mul_i32 s7, s6, 5120
    v_mfma_f32_16x16x32_bf16 v[60:63], v[100:103], v[16:19], 0
    s_add_u32 s7, s7, s67
    s_cmp_eq_u32 s6, 3
    s_cselect_b32 s7, 124928, s7
    v_mfma_f32_16x16x32_bf16 v[64:67], v[104:107], v[16:19], 0
    v_add_u32 v12, s7, v52
    v_add_u32 v5, s67, v45
    v_mfma_f32_16x16x32_bf16 v[68:71], v[108:111], v[16:19], 0
    v_mfma_f32_16x16x32_bf16 v[72:75], v[112:115], v[16:19], 0
    ds_read_b128 v[16:19], v4 offset:36864
    v_mfma_f32_16x16x32_bf16 v[56:59], v[116:119], v[20:23], v[56:59]
    ds_write_b128 v5, v[80:83] offset:30720
    v_add_u32 v5, s67, v46
    v_mfma_f32_16x16x32_bf16 v[60:63], v[120:123], v[20:23], v[60:63]
    v_mfma_f32_16x16x32_bf16 v[64:67], v[124:127], v[20:23], v[64:67]
    v_cmp_le_i32 vcc, 0, v51
    s_cbranch_vccz L_idx_okb
    v_and_b32 v3, 7, v1
    v_lshlrev_b32 v3, 2, v3
    s_mov_b32 s72, 0x3a0000
    s_mov_b32 s79, 262144
L_poll_59:
    buffer_load_dword v51, v3, s[8:11], s72 offen sc1
    s_waitcnt vmcnt(0)
    v_cmp_le_i32 vcc, 0, v51
    s_cbranch_vccz L_polldone_60
    s_sleep 2
    s_sub_u32 s79, s79, 1
    s_cmp_lg_u32 s79, 0
    s_cbranch_scc1 L_poll_59
L_polldone_60:
L_idx_okb:
    s_mov_b32 s64, 0
    v_and_b32 v2, 0x7ff, v51
    v_sub_u32 v2, 0x7ff, v2
    v_lshrrev_b32 v3, 4, v2
    v_cmp_eq_u32 vcc, s68, v3
    v_cmp_eq_u32 s[74:75], s61, v3
    s_nop 3
    s_or_b64 vcc, vcc, s[74:75]
    s_cbranch_scc0 L_notok_61
    v_readlane_b32 s84, v2, 0
    v_readlane_b32 s85, v2, 1
    v_readlane_b32 s86, v2, 2
    v_readlane_b32 s87, v2, 3
    v_readlane_b32 s88, v2, 4
    v_readlane_b32 s65, v2, 5
    v_readlane_b32 s91, v2, 6
    v_readlane_b32 s101, v2, 7
    s_lshl_b32 s7, s76, 6
    s_lshr_b32 s100, s3, 2
    s_cselect_b32 s6, s61, s68
    s_lshl_b32 s6, s6, 4
    v_and_b32 v2, 15, v1
    v_add_u32 v2, s6, v2
    s_add_u32 s7, s7, s73
    v_and_b32 v3, 48, v1
    v_add_u32 v3, s7, v3
    v_cmp_eq_u32 vcc, s84, v2
    s_nop 1
    v_cndmask_b32 v48, v48, v3, vcc
    v_add_u32 v3, 1280, v3
    v_cmp_eq_u32 vcc, s85, v2
    s_nop 1
    v_cndmask_b32 v48, v48, v3, vcc
    v_add_u32 v3, 1280, v3
    v_cmp_eq_u32 vcc, s86, v2
    s_nop 1
    v_cndmask_b32 v48, v48, v3, vcc
    v_add_u32 v3, 1280, v3
    v_cmp_eq_u32 vcc, s87, v2
    s_nop 1
    v_cndmask_b32 v48, v48, v3, vcc
    v_add_u32 v3, 1280, v3
    v_cmp_eq_u32 vcc, s88, v2
    s_nop 1
    v_cndmask_b32 v48, v48, v3, vcc
    v_add_u32 v3, 1280, v3
    v_cmp_eq_u32 vcc, s65, v2
    s_nop 1
    v_cndmask_b32 v48, v48, v3, vcc
    v_add_u32 v3, 1280, v3
    v_cmp_eq_u32 vcc, s91, v2
    s_nop 1
    v_cndmask_b32 v48, v48, v3, vcc
    v_add_u32 v3, 1280, v3
    v_cmp_eq_u32 vcc, s101, v2
    s_nop 1
    v_cndmask_b32 v48, v48, v3, vcc
    s_movk_i32 s7, 256
    s_and_b32 s100, s3, 1
    s_cselect_b32 s6, s61, s68
    s_lshl_b32 s6, s6, 4
    v_and_b32 v2, 15, v1
    v_add_u32 v2, s6, v2
    s_add_u32 s7, s7, s73
    v_and_b32 v3, 48, v1
    v_add_u32 v3, s7, v3
    v_cmp_eq_u32 vcc, s84, v2
    s_nop 1
    v_cndmask_b32 v49, v49, v3, vcc
    v_add_u32 v3, 1280, v3
    v_cmp_eq_u32 vcc, s85, v2
    s_nop 1
    v_cndmask_b32 v49, v49, v3, vcc
    v_add_u32 v3, 1280, v3
    v_cmp_eq_u32 vcc, s86, v2
    s_nop 1
    v_cndmask_b32 v49, v49, v3, vcc
    v_add_u32 v3, 1280, v3
    v_cmp_eq_u32 vcc, s87, v2
    s_nop 1
    v_cndmask_b32 v49, v49, v3, vcc
    v_add_u32 v3, 1280, v3
    v_cmp_eq_u32 vcc, s88, v2
    s_nop 1
    v_cndmask_b32 v49, v49, v3, vcc
    v_add_u32 v3, 1280, v3
    v_cmp_eq_u32 vcc, s65, v2
    s_nop 1
    v_cndmask_b32 v49, v49, v3, vcc
    v_add_u32 v3, 1280, v3
    v_cmp_eq_u32 vcc, s91, v2
    s_nop 1
    v_cndmask_b32 v49, v49, v3, vcc
    v_add_u32 v3, 1280, v3
    v_cmp_eq_u32 vcc, s101, v2
    s_nop 1
    v_cndmask_b32 v49, v49, v3, vcc
    s_mov_b32 s64, 1
L_notok_61:
    v_mfma_f32_16x16x32_bf16 v[68:71], v[128:131], v[20:23], v[68:71]
    s_waitcnt lgkmcnt(3)
    v_mfma_f32_16x16x32_bf16 v[72:75], v[132:135], v[20:23], v[72:75]
    ds_read_b128 v[20:23], v4 offset:37888
    v_mfma_f32_16x16x32_bf16 v[72:75], v[152:155], v[24:27], v[72:75]
    ds_write_b128 v5, v[84:87] offset:35840
    v_add_u32 v5, s67, v47
    v_mfma_f32_16x16x32_bf16 v[68:71], v[148:151], v[24:27], v[68:71]
    v_mfma_f32_16x16x32_bf16 v[64:67], v[144:147], v[24:27], v[64:67]
    v_mfma_f32_16x16x32_bf16 v[60:63], v[140:143], v[24:27], v[60:63]
    s_waitcnt lgkmcnt(4)
    v_mfma_f32_16x16x32_bf16 v[56:59], v[136:139], v[24:27], v[56:59]
    ds_read_b128 v[24:27], v4 offset:38912
    v_mfma_f32_16x16x32_bf16 v[56:59], v[156:159], v[28:31], v[56:59]
    ds_write_b128 v5, v[88:91] offset:40960
    v_add_u32 v5, s67, v52
    v_mfma_f32_16x16x32_bf16 v[60:63], v[160:163], v[28:31], v[60:63]
    v_mfma_f32_16x16x32_bf16 v[64:67], v[164:167], v[28:31], v[64:67]
    v_mfma_f32_16x16x32_bf16 v[68:71], v[168:171], v[28:31], v[68:71]
    s_waitcnt lgkmcnt(5)
    v_mfma_f32_16x16x32_bf16 v[72:75], v[172:175], v[28:31], v[72:75]
    ds_read_b128 v[28:31], v4 offset:39936
    v_mfma_f32_16x16x32_bf16 v[72:75], v[192:195], v[16:19], v[72:75]
    ds_write_b128 v12, v[92:95] offset:30720
    v_mfma_f32_16x16x32_bf16 v[68:71], v[188:191], v[16:19], v[68:71]
    s_add_u32 s65, s61, 0
    s_and_b32 s65, s65, 3
    s_andn2_b32 s7, s61, 3
    v_mfma_f32_16x16x32_bf16 v[64:67], v[184:187], v[16:19], v[64:67]
    s_add_u32 s65, s65, s7
    s_lshl_b32 s65, s65, 17
    s_add_u32 s65, s65, s66
    v_mfma_f32_16x16x32_bf16 v[60:63], v[180:183], v[16:19], v[60:63]
    s_waitcnt lgkmcnt(5)
    s_add_u32 m0, s99, 32768
    v_mfma_f32_16x16x32_bf16 v[56:59], v[176:179], v[16:19], v[56:59]
    s_waitcnt vmcnt(5)
    s_waitcnt lgkmcnt(0)
    s_barrier
    ds_read_b128 v[32:35], v6 offset:30720
    ds_read_b128 v[36:39], v6 offset:35840
    ds_read_b128 v[40:43], v6 offset:40960
    ds_read_b128 v[16:19], v7 offset:0
    v_mfma_f32_16x16x32_bf16 v[56:59], v[196:199], v[20:23], v[56:59]
    buffer_load_dwordx4 v13, s[8:11], s65 offen offset:0 sc1 lds
    v_mfma_f32_16x16x32_bf16 v[60:63], v[200:203], v[20:23], v[60:63]
    buffer_load_dwordx4 v13, s[8:11], s65 offen offset:1024 sc1 lds
    v_mfma_f32_16x16x32_bf16 v[64:67], v[204:207], v[20:23], v[64:67]
    s_waitcnt lgkmcnt(3)
    v_add_f32 v76, v76, v32
    v_add_f32 v77, v77, v33
    v_mfma_f32_16x16x32_bf16 v[68:71], v[208:211], v[20:23], v[68:71]
    buffer_load_dwordx4 v13, s[8:11], s65 offen offset:2048 sc1 lds
    v_add_f32 v78, v78, v34
    v_add_f32 v79, v79, v35
    v_mfma_f32_16x16x32_bf16 v[72:75], v[212:215], v[20:23], v[72:75]
    s_waitcnt lgkmcnt(2)
    ds_read_b128 v[32:35], v5 offset:30720
    ds_read_b128 v[20:23], v7 offset:1024
    v_add_f32 v76, v76, v36
    v_add_f32 v77, v77, v37
    v_mfma_f32_16x16x32_bf16 v[72:75], v[232:235], v[24:27], v[72:75]
    buffer_load_dwordx4 v13, s[8:11], s65 offen offset:3072 sc1 lds
    v_add_f32 v78, v78, v38
    v_add_f32 v79, v79, v39
    v_mfma_f32_16x16x32_bf16 v[68:71], v[228:231], v[24:27], v[68:71]
    s_waitcnt lgkmcnt(3)
    ds_read_b128 v[36:39], v5 offset:35840
    v_add_f32 v76, v76, v40
    v_add_f32 v77, v77, v41
    v_mfma_f32_16x16x32_bf16 v[64:67], v[224:227], v[24:27], v[64:67]
    v_add_f32 v78, v78, v42
    v_add_f32 v79, v79, v43
    v_mfma_f32_16x16x32_bf16 v[60:63], v[220:223], v[24:27], v[60:63]
    ds_read_b128 v[40:43], v5 offset:40960
    s_waitcnt lgkmcnt(3)
    v_add_f32 v92, v92, v32
    v_add_f32 v93, v93, v33
    s_add_u32 s6, s96, 10240
    v_mfma_f32_16x16x32_bf16 v[56:59], v[216:219], v[24:27], v[56:59]
    ds_read_b128 v[24:27], v7 offset:2048
    v_add_f32 v94, v94, v34
    v_add_f32 v95, v95, v35
    v_mfma_f32_16x16x32_bf16 v[56:59], v[236:239], v[28:31], v[56:59]
    buffer_store_dwordx4 v[76:79], v44, s[8:11], s6 offen sc1
    s_waitcnt lgkmcnt(2)
    v_add_f32 v92, v92, v36
    v_add_f32 v93, v93, v37
    v_mfma_f32_16x16x32_bf16 v[60:63], v[240:243], v[28:31], v[60:63]
    v_add_f32 v94, v94, v38
    v_add_f32 v95, v95, v39
    v_mfma_f32_16x16x32_bf16 v[64:67], v[244:247], v[28:31], v[64:67]
    s_waitcnt lgkmcnt(1)
    v_add_f32 v92, v92, v40
    v_add_f32 v93, v93, v41
    v_mfma_f32_16x16x32_bf16 v[68:71], v[248:251], v[28:31], v[68:71]
    v_add_f32 v94, v94, v42
    v_add_f32 v95, v95, v43
    s_cmp_lg_u32 s71, 3
    v_mfma_f32_16x16x32_bf16 v[72:75], v[252:255], v[28:31], v[72:75]
    s_cbranch_scc1 L_nost_58
    buffer_store_dwordx4 v[92:95], v52, s[8:11], s6 offen sc1
L_nost_58:
    ds_read_b128 v[28:31], v7 offset:3072
    v_mfma_f32_16x16x32_bf16 v[76:79], v[96:99], v[16:19], 0
    s_sub_u32 s6, s71, 5
    s_and_b32 s6, s6, 3
    s_mul_i32 s7, s6, 5120
    v_mfma_f32_16x16x32_bf16 v[80:83], v[100:103], v[16:19], 0
    s_add_u32 s7, s7, s67
    s_cmp_eq_u32 s6, 3
    s_cselect_b32 s7, 155648, s7
    v_mfma_f32_16x16x32_bf16 v[84:87], v[104:107], v[16:19], 0
    v_add_u32 v12, s7, v52
    v_add_u32 v5, s67, v45
    v_mfma_f32_16x16x32_bf16 v[88:91], v[108:111], v[16:19], 0
    v_mfma_f32_16x16x32_bf16 v[92:95], v[112:115], v[16:19], 0
    ds_read_b128 v[16:19], v7 offset:4096
    v_mfma_f32_16x16x32_bf16 v[76:79], v[116:119], v[20:23], v[76:79]
    ds_write_b128 v5, v[60:63] offset:0
    v_add_u32 v5, s67, v46
    v_mfma_f32_16x16x32_bf16 v[80:83], v[120:123], v[20:23], v[80:83]
    v_mfma_f32_16x16x32_bf16 v[84:87], v[124:127], v[20:23], v[84:87]
    v_mfma_f32_16x16x32_bf16 v[88:91], v[128:131], v[20:23], v[88:91]
    s_waitcnt lgkmcnt(3)
    v_mfma_f32_16x16x32_bf16 v[92:95], v[132:135], v[20:23], v[92:95]
    ds_read_b128 v[20:23], v7 offset:5120
    v_mfma_f32_16x16x32_bf16 v[92:95], v[152:155], v[24:27], v[92:95]
    ds_write_b128 v5, v[64:67] offset:5120
    v_add_u32 v5, s67, v47
    v_mfma_f32_16x16x32_bf16 v[88:91], v[148:151], v[24:27], v[88:91]
    v_mfma_f32_16x16x32_bf16 v[84:87], v[144:147], v[24:27], v[84:87]
    v_mfma_f32_16x16x32_bf16 v[80:83], v[140:143], v[24:27], v[80:83]
    s_waitcnt lgkmcnt(4)
    v_mfma_f32_16x16x32_bf16 v[76:79], v[136:139], v[24:27], v[76:79]
    ds_read_b128 v[24:27], v7 offset:6144
    v_mfma_f32_16x16x32_bf16 v[76:79], v[156:159], v[28:31], v[76:79]
    ds_write_b128 v5, v[68:71] offset:10240
    v_add_u32 v5, s67, v52
    v_mfma_f32_16x16x32_bf16 v[80:83], v[160:163], v[28:31], v[80:83]
    v_mfma_f32_16x16x32_bf16 v[84:87], v[164:167], v[28:31], v[84:87]
    v_mfma_f32_16x16x32_bf16 v[88:91], v[168:171], v[28:31], v[88:91]
    s_waitcnt lgkmcnt(5)
    v_mfma_f32_16x16x32_bf16 v[92:95], v[172:175], v[28:31], v[92:95]
    ds_read_b128 v[28:31], v7 offset:7168
    v_mfma_f32_16x16x32_bf16 v[92:95], v[192:195], v[16:19], v[92:95]
    ds_write_b128 v12, v[72:75] offset:0
    v_mfma_f32_16x16x32_bf16 v[88:91], v[188:191], v[16:19], v[88:91]
    v_mfma_f32_16x16x32_bf16 v[84:87], v[184:187], v[16:19], v[84:87]
    v_mfma_f32_16x16x32_bf16 v[80:83], v[180:183], v[16:19], v[80:83]
    s_waitcnt lgkmcnt(5)
    v_mfma_f32_16x16x32_bf16 v[76:79], v[176:179], v[16:19], v[76:79]
    s_waitcnt vmcnt(5)
    s_waitcnt lgkmcnt(0)
    s_barrier
    ds_read_b128 v[32:35], v6 offset:0
    ds_read_b128 v[36:39], v6 offset:5120
    ds_read_b128 v[40:43], v6 offset:10240
    ds_read_b128 v[16:19], v4 offset:0
    v_mfma_f32_16x16x32_bf16 v[76:79], v[196:199], v[20:23], v[76:79]
    v_mfma_f32_16x16x32_bf16 v[80:83], v[200:203], v[20:23], v[80:83]
    v_mfma_f32_16x16x32_bf16 v[84:87], v[204:207], v[20:23], v[84:87]
    s_waitcnt lgkmcnt(3)
    v_add_f32 v56, v56, v32
    v_add_f32 v57, v57, v33
    v_mfma_f32_16x16x32_bf16 v[88:91], v[208:211], v[20:23], v[88:91]
    v_add_f32 v58, v58, v34
    v_add_f32 v59, v59, v35
    v_mfma_f32_16x16x32_bf16 v[92:95], v[212:215], v[20:23], v[92:95]
    s_waitcnt lgkmcnt(2)
    ds_read_b128 v[32:35], v5 offset:0
    ds_read_b128 v[20:23], v4 offset:1024
    v_add_f32 v56, v56, v36
    v_add_f32 v57, v57, v37
    v_mfma_f32_16x16x32_bf16 v[92:95], v[232:235], v[24:27], v[92:95]
    v_add_f32 v58, v58, v38
    v_add_f32 v59, v59, v39
    v_mfma_f32_16x16x32_bf16 v[88:91], v[228:231], v[24:27], v[88:91]
    s_waitcnt lgkmcnt(3)
    ds_read_b128 v[36:39], v5 offset:5120
    v_add_f32 v56, v56, v40
    v_add_f32 v57, v57, v41
    v_mfma_f32_16x16x32_bf16 v[84:87], v[224:227], v[24:27], v[84:87]
    v_add_f32 v58, v58, v42
    v_add_f32 v59, v59, v43
    v_mfma_f32_16x16x32_bf16 v[80:83], v[220:223], v[24:27], v[80:83]
    ds_read_b128 v[40:43], v5 offset:10240
    s_waitcnt lgkmcnt(3)
    v_add_f32 v72, v72, v32
    v_add_f32 v73, v73, v33
    s_add_u32 s6, s97, 10240
    v_mfma_f32_16x16x32_bf16 v[76:79], v[216:219], v[24:27], v[76:79]
    ds_read_b128 v[24:27], v4 offset:2048
    v_add_f32 v74, v74, v34
    v_add_f32 v75, v75, v35
    v_mfma_f32_16x16x32_bf16 v[76:79], v[236:239], v[28:31], v[76:79]
    buffer_store_dwordx4 v[56:59], v44, s[8:11], s6 offen sc1
    s_waitcnt lgkmcnt(2)
    v_add_f32 v72, v72, v36
    v_add_f32 v73, v73, v37
    v_mfma_f32_16x16x32_bf16 v[80:83], v[240:243], v[28:31], v[80:83]
    v_add_f32 v74, v74, v38
    v_add_f32 v75, v75, v39
    v_mfma_f32_16x16x32_bf16 v[84:87], v[244:247], v[28:31], v[84:87]
    s_waitcnt lgkmcnt(1)
    v_add_f32 v72, v72, v40
    v_add_f32 v73, v73, v41
    v_mfma_f32_16x16x32_bf16 v[88:91], v[248:251], v[28:31], v[88:91]
    v_add_f32 v74, v74, v42
    v_add_f32 v75, v75, v43
    s_cmp_lg_u32 s71, 0
    v_mfma_f32_16x16x32_bf16 v[92:95], v[252:255], v[28:31], v[92:95]
    s_cbranch_scc1 L_nost_62
    buffer_store_dwordx4 v[72:75], v52, s[8:11], s6 offen sc1
L_nost_62:
    ds_read_b128 v[28:31], v4 offset:3072
    v_mfma_f32_16x16x32_bf16 v[56:59], v[96:99], v[16:19], 0
    s_sub_u32 s6, s71, 6
    s_and_b32 s6, s6, 3
    s_mul_i32 s7, s6, 5120
    v_mfma_f32_16x16x32_bf16 v[60:63], v[100:103], v[16:19], 0
    s_add_u32 s7, s7, s67
    s_cmp_eq_u32 s6, 3
    s_cselect_b32 s7, 124928, s7
    v_mfma_f32_16x16x32_bf16 v[64:67], v[104:107], v[16:19], 0
    v_add_u32 v12, s7, v52
    v_add_u32 v5, s67, v45
    v_mfma_f32_16x16x32_bf16 v[68:71], v[108:111], v[16:19], 0
    ds_write_b128 v5, v[80:83] offset:30720
    v_add_u32 v5, s67, v46
    v_mfma_f32_16x16x32_bf16 v[72:75], v[112:115], v[16:19], 0
    ds_read_b128 v[16:19], v4 offset:4096
    v_mfma_f32_16x16x32_bf16 v[56:59], v[116:119], v[20:23], v[56:59]
    v_mfma_f32_16x16x32_bf16 v[60:63], v[120:123], v[20:23], v[60:63]
    ds_write_b128 v5, v[84:87] offset:35840
    v_add_u32 v5, s67, v47
    v_mfma_f32_16x16x32_bf16 v[64:67], v[124:127], v[20:23], v[64:67]
    v_mfma_f32_16x16x32_bf16 v[68:71], v[128:131], v[20:23], v[68:71]
    s_waitcnt lgkmcnt(4)
    v_mfma_f32_16x16x32_bf16 v[72:75], v[132:135], v[20:23], v[72:75]
    ds_read_b128 v[20:23], v4 offset:5120
    ds_write_b128 v5, v[88:91] offset:40960
    v_add_u32 v5, s67, v52
    v_mfma_f32_16x16x32_bf16 v[72:75], v[152:155], v[24:27], v[72:75]
    v_mfma_f32_16x16x32_bf16 v[68:71], v[148:151], v[24:27], v[68:71]
    v_mfma_f32_16x16x32_bf16 v[64:67], v[144:147], v[24:27], v[64:67]
    ds_write_b128 v12, v[92:95] offset:30720
    v_mov_b32 v2, 1
    v_writelane_b32 v2, 2, 0
    v_mfma_f32_16x16x32_bf16 v[60:63], v[140:143], v[24:27], v[60:63]
    s_waitcnt lgkmcnt(6)
    v_mfma_f32_16x16x32_bf16 v[56:59], v[136:139], v[24:27], v[56:59]
    ds_read_b128 v[24:27], v4 offset:6144
    s_waitcnt vmcnt(1)
    buffer_store_dword v2, v11, s[8:11], 0 offen sc1
    s_waitcnt lgkmcnt(0)
    s_barrier
    ds_read_b128 v[32:35], v6 offset:30720
    ds_read_b128 v[36:39], v6 offset:35840
    ds_read_b128 v[40:43], v6 offset:40960
    v_mfma_f32_16x16x32_bf16 v[56:59], v[156:159], v[28:31], v[56:59]
    v_mfma_f32_16x16x32_bf16 v[60:63], v[160:163], v[28:31], v[60:63]
    v_mfma_f32_16x16x32_bf16 v[64:67], v[164:167], v[28:31], v[64:67]
    s_waitcnt lgkmcnt(2)
    v_add_f32 v76, v76, v32
    v_add_f32 v77, v77, v33
    v_mfma_f32_16x16x32_bf16 v[68:71], v[168:171], v[28:31], v[68:71]
    v_add_f32 v78, v78, v34
    v_add_f32 v79, v79, v35
    v_mfma_f32_16x16x32_bf16 v[72:75], v[172:175], v[28:31], v[72:75]
    s_waitcnt lgkmcnt(1)
    ds_read_b128 v[32:35], v5 offset:30720
    ds_read_b128 v[28:31], v4 offset:7168
    v_add_f32 v76, v76, v36
    v_add_f32 v77, v77, v37
    v_mfma_f32_16x16x32_bf16 v[72:75], v[192:195], v[16:19], v[72:75]
    v_add_f32 v78, v78, v38
    v_add_f32 v79, v79, v39
    v_mfma_f32_16x16x32_bf16 v[68:71], v[188:191], v[16:19], v[68:71]
    s_waitcnt lgkmcnt(2)
    ds_read_b128 v[36:39], v5 offset:35840
    v_add_f32 v76, v76, v40
    v_add_f32 v77, v77, v41
    v_mfma_f32_16x16x32_bf16 v[64:67], v[184:187], v[16:19], v[64:67]
    v_add_f32 v78, v78, v42
    v_add_f32 v79, v79, v43
    v_mfma_f32_16x16x32_bf16 v[60:63], v[180:183], v[16:19], v[60:63]
    ds_read_b128 v[40:43], v5 offset:40960
    s_waitcnt lgkmcnt(3)
    v_add_f32 v92, v92, v32
    v_add_f32 v93, v93, v33
    s_add_u32 s6, s98, 10240
    v_mfma_f32_16x16x32_bf16 v[56:59], v[176:179], v[16:19], v[56:59]
    v_add_f32 v94, v94, v34
    v_add_f32 v95, v95, v35
    ds_read_b128 v[16:19], v4 offset:32768
    v_mfma_f32_16x16x32_bf16 v[56:59], v[196:199], v[20:23], v[56:59]
    buffer_store_dwordx4 v[76:79], v44, s[8:11], s6 offen sc1
    s_waitcnt lgkmcnt(2)
    v_add_f32 v92, v92, v36
    v_add_f32 v93, v93, v37
    v_mfma_f32_16x16x32_bf16 v[60:63], v[200:203], v[20:23], v[60:63]
    v_add_f32 v94, v94, v38
    v_add_f32 v95, v95, v39
    v_mfma_f32_16x16x32_bf16 v[64:67], v[204:207], v[20:23], v[64:67]
    s_waitcnt lgkmcnt(1)
    v_add_f32 v92, v92, v40
    v_add_f32 v93, v93, v41
    v_mfma_f32_16x16x32_bf16 v[68:71], v[208:211], v[20:23], v[68:71]
    v_add_f32 v94, v94, v42
    v_add_f32 v95, v95, v43
    s_cmp_lg_u32 s71, 1
    v_mfma_f32_16x16x32_bf16 v[72:75], v[212:215], v[20:23], v[72:75]
    s_cbranch_scc1 L_nost_63
    buffer_store_dwordx4 v[92:95], v52, s[8:11], s6 offen sc1
L_nost_63:
    ds_read_b128 v[20:23], v4 offset:33792
    v_mfma_f32_16x16x32_bf16 v[72:75], v[232:235], v[24:27], v[72:75]
    v_mfma_f32_16x16x32_bf16 v[68:71], v[228:231], v[24:27], v[68:71]
    v_mfma_f32_16x16x32_bf16 v[64:67], v[224:227], v[24:27], v[64:67]
    v_mfma_f32_16x16x32_bf16 v[60:63], v[220:223], v[24:27], v[60:63]
    v_mfma_f32_16x16x32_bf16 v[56:59], v[216:219], v[24:27], v[56:59]
    ds_read_b128 v[24:27], v4 offset:34816
    v_mfma_f32_16x16x32_bf16 v[56:59], v[236:239], v[28:31], v[56:59]
    v_mfma_f32_16x16x32_bf16 v[60:63], v[240:243], v[28:31], v[60:63]
    v_mfma_f32_16x16x32_bf16 v[64:67], v[244:247], v[28:31], v[64:67]
    v_mfma_f32_16x16x32_bf16 v[68:71], v[248:251], v[28:31], v[68:71]
    s_waitcnt lgkmcnt(2)
    v_mfma_f32_16x16x32_bf16 v[72:75], v[252:255], v[28:31], v[72:75]
    ds_read_b128 v[28:31], v4 offset:35840
    v_mfma_f32_16x16x32_bf16 v[76:79], v[96:99], v[16:19], 0
    v_mfma_f32_16x16x32_bf16 v[80:83], v[100:103], v[16:19], 0
    s_barrier
    v_mfma_f32_16x16x32_bf16 v[84:87], v[104:107], v[16:19], 0
    s_mul_i32 s73, s3, 5120
    s_add_u32 s6, s73, 65536
    v_mfma_f32_16x16x32_bf16 v[88:91], v[108:111], v[16:19], 0
    s_waitcnt lgkmcnt(2)
    v_add_u32 v5, s6, v44
    v_mfma_f32_16x16x32_bf16 v[92:95], v[112:115], v[16:19], 0
    ds_read_b128 v[16:19], v4 offset:36864
    v_mfma_f32_16x16x32_bf16 v[76:79], v[116:119], v[20:23], v[76:79]
    ds_write_b128 v5, v[56:59]
    s_add_u32 s6, s73, 65536
    v_add_u32 v5, s6, v45
    v_mfma_f32_16x16x32_bf16 v[80:83], v[120:123], v[20:23], v[80:83]
    v_mov_b32 v2, 2
    s_waitcnt vmcnt(0)
    buffer_store_dword v2, v11, s[8:11], 0 offen sc1
    v_mfma_f32_16x16x32_bf16 v[84:87], v[124:127], v[20:23], v[84:87]
    v_mfma_f32_16x16x32_bf16 v[88:91], v[128:131], v[20:23], v[88:91]
    s_waitcnt lgkmcnt(3)
    s_cmp_eq_u32 s64, 0
    s_cbranch_scc1 L_nb
    v_bfe_u32 v2, v1, 1, 3
    v_and_b32 v3, 1, v1
    v_lshl_add_u32 v3, v2, 7, v3
    v_lshlrev_b32 v3, 2, v3
    s_and_b32 s6, s4, 3
    s_lshl_b32 s6, s6, 7
    s_add_u32 s6, s6, 3907584
    s_mov_b32 s79, 262144
L_poll_64:
    buffer_load_dword v2, v3, s[8:11], s6 offen sc1
    s_waitcnt vmcnt(0)
    v_cmp_ne_u32 vcc, 1, v2
    s_cbranch_vccz L_polldone_65
    s_sleep 2
    s_sub_u32 s79, s79, 1
    s_cmp_lg_u32 s79, 0
    s_cbranch_scc1 L_poll_64
L_polldone_65:
L_nb:
    buffer_load_dwordx4 v[96:99], v53, s[12:15], s70 offen
    buffer_load_dwordx4 v[100:103], v48, s[8:11], 0 offen sc1
    s_cmp_ge_u32 s3, 2
    s_cbranch_scc1 L_itskip_66
    buffer_load_dwordx4 v[104:107], v54, s[12:15], s70 offen
    buffer_load_dwordx4 v[108:111], v49, s[8:11], 0 offen sc1
L_itskip_66:
    v_mfma_f32_16x16x32_bf16 v[92:95], v[132:135], v[20:23], v[92:95]
    ds_read_b128 v[20:23], v4 offset:37888
    v_mfma_f32_16x16x32_bf16 v[92:95], v[152:155], v[24:27], v[92:95]
    ds_write_b128 v5, v[60:63]
    s_add_u32 s6, s73, 65536
    v_add_u32 v5, s6, v46
    v_mfma_f32_16x16x32_bf16 v[88:91], v[148:151], v[24:27], v[88:91]
    v_mfma_f32_16x16x32_bf16 v[84:87], v[144:147], v[24:27], v[84:87]
    v_mfma_f32_16x16x32_bf16 v[80:83], v[140:143], v[24:27], v[80:83]
    s_waitcnt lgkmcnt(4)
    v_mfma_f32_16x16x32_bf16 v[76:79], v[136:139], v[24:27], v[76:79]
    ds_read_b128 v[24:27], v4 offset:38912
    v_mfma_f32_16x16x32_bf16 v[76:79], v[156:159], v[28:31], v[76:79]
    ds_write_b128 v5, v[64:67]
    s_add_u32 s6, s73, 65536
    v_add_u32 v5, s6, v47
    v_mfma_f32_16x16x32_bf16 v[80:83], v[160:163], v[28:31], v[80:83]
    v_mfma_f32_16x16x32_bf16 v[84:87], v[164:167], v[28:31], v[84:87]
    v_bfe_u32 v2, v1, 3, 2
    v_min_u32 v2, 2, v2
    v_and_b32 v3, 7, v1
    v_lshlrev_b32 v3, 2, v3
    v_lshl_add_u32 v3, v2, 7, v3
    v_mfma_f32_16x16x32_bf16 v[88:91], v[168:171], v[28:31], v[88:91]
    s_waitcnt lgkmcnt(5)
    s_bitcmp1_b32 13, s3
    s_cselect_b32 s77, 1, 2
    buffer_load_dword v50, v3, s[8:11], s63 offen sc1
    v_mfma_f32_16x16x32_bf16 v[92:95], v[172:175], v[28:31], v[92:95]
    ds_read_b128 v[28:31], v4 offset:39936
    v_mfma_f32_16x16x32_bf16 v[92:95], v[192:195], v[16:19], v[92:95]
    ds_write_b128 v5, v[68:71]
    s_add_u32 s6, s73, 65536
    v_add_u32 v5, s6, v52
    v_mfma_f32_16x16x32_bf16 v[88:91], v[188:191], v[16:19], v[88:91]
    v_mfma_f32_16x16x32_bf16 v[84:87], v[184:187], v[16:19], v[84:87]
    v_mfma_f32_16x16x32_bf16 v[80:83], v[180:183], v[16:19], v[80:83]
    s_waitcnt lgkmcnt(5)
    v_mfma_f32_16x16x32_bf16 v[76:79], v[176:179], v[16:19], v[76:79]
    v_mfma_f32_16x16x32_bf16 v[76:79], v[196:199], v[20:23], v[76:79]
    ds_write_b128 v5, v[72:75]
    v_mfma_f32_16x16x32_bf16 v[80:83], v[200:203], v[20:23], v[80:83]
    v_mfma_f32_16x16x32_bf16 v[84:87], v[204:207], v[20:23], v[84:87]
    v_mfma_f32_16x16x32_bf16 v[88:91], v[208:211], v[20:23], v[88:91]
    s_waitcnt lgkmcnt(4)
    v_mfma_f32_16x16x32_bf16 v[92:95], v[212:215], v[20:23], v[92:95]
    v_mfma_f32_16x16x32_bf16 v[92:95], v[232:235], v[24:27], v[92:95]
    s_waitcnt vmcnt(0)
    v_cmp_gt_u32 vcc, s77, v50
    s_mov_b32 s91, 0
    s_cbranch_vccnz L_x1n
    s_add_u32 s6, s62, 0
    buffer_load_dwordx4 v[112:115], v8, s[8:11], s6 offen offset:0 sc1
    buffer_load_dwordx4 v[116:119], v8, s[8:11], s6 offen offset:256 sc1
    s_add_u32 s6, s62, 20480
    buffer_load_dwordx4 v[120:123], v8, s[8:11], s6 offen offset:0 sc1
    buffer_load_dwordx4 v[124:127], v8, s[8:11], s6 offen offset:256 sc1
    s_add_u32 s6, s62, 40960
    buffer_load_dwordx4 v[128:131], v8, s[8:11], s6 offen offset:0 sc1
    buffer_load_dwordx4 v[132:135], v8, s[8:11], s6 offen offset:256 sc1
    s_cmp_ge_u32 s3, 2
    s_cbranch_scc1 L_xi_67
    s_add_u32 s6, s62, 0
    buffer_load_dwordx4 v[136:139], v9, s[8:11], s6 offen offset:0 sc1
    buffer_load_dwordx4 v[140:143], v9, s[8:11], s6 offen offset:256 sc1
    s_add_u32 s6, s62, 20480
    buffer_load_dwordx4 v[144:147], v9, s[8:11], s6 offen offset:0 sc1
    buffer_load_dwordx4 v[148:151], v9, s[8:11], s6 offen offset:256 sc1
    s_add_u32 s6, s62, 40960
    buffer_load_dwordx4 v[152:155], v9, s[8:11], s6 offen offset:0 sc1
    buffer_load_dwordx4 v[156:159], v9, s[8:11], s6 offen offset:256 sc1
L_xi_67:
    s_mov_b32 s91, 1
    s_branch L_x1j
L_x1n:
    buffer_load_dword v50, v3, s[8:11], s63 offen sc1
L_x1j:
    v_mfma_f32_16x16x32_bf16 v[88:91], v[228:231], v[24:27], v[88:91]
    v_mfma_f32_16x16x32_bf16 v[84:87], v[224:227], v[24:27], v[84:87]
    v_mfma_f32_16x16x32_bf16 v[80:83], v[220:223], v[24:27], v[80:83]
    s_waitcnt lgkmcnt(2)
    s_add_u32 s6, s73, 86016
    s_cmp_lt_u32 s3, 4
    s_cselect_b32 s73, s73, s6
    v_mfma_f32_16x16x32_bf16 v[76:79], v[216:219], v[24:27], v[76:79]
    v_mfma_f32_16x16x32_bf16 v[76:79], v[236:239], v[28:31], v[76:79]
    v_mfma_f32_16x16x32_bf16 v[80:83], v[240:243], v[28:31], v[80:83]
    v_mfma_f32_16x16x32_bf16 v[84:87], v[244:247], v[28:31], v[84:87]
    v_mfma_f32_16x16x32_bf16 v[88:91], v[248:251], v[28:31], v[88:91]
    v_mfma_f32_16x16x32_bf16 v[92:95], v[252:255], v[28:31], v[92:95]
    s_nop 4
    v_add_u32 v5, s73, v44
    ds_write_b128 v5, v[76:79]
    v_add_u32 v5, s73, v45
    ds_write_b128 v5, v[80:83]
    v_add_u32 v5, s73, v46
    ds_write_b128 v5, v[84:87]
    v_add_u32 v5, s73, v47
    ds_write_b128 v5, v[88:91]
    v_add_u32 v5, s73, v52
    ds_write_b128 v5, v[92:95]
    s_mov_b64 s[78:79], 0
    s_cmp_lg_u32 s91, 0
    s_cbranch_scc1 L_x2a
    s_waitcnt vmcnt(0)
    v_cmp_gt_u32 s[78:79], s77, v50
    s_nop 3
    s_cmp_lg_u64 s[78:79], 0
    s_cbranch_scc1 L_x2a
    s_add_u32 s6, s62, 0
    buffer_load_dwordx4 v[112:115], v8, s[8:11], s6 offen offset:0 sc1
    buffer_load_dwordx4 v[116:119], v8, s[8:11], s6 offen offset:256 sc1
    s_add_u32 s6, s62, 20480
    buffer_load_dwordx4 v[120:123], v8, s[8:11], s6 offen offset:0 sc1
    buffer_load_dwordx4 v[124:127], v8, s[8:11], s6 offen offset:256 sc1
    s_add_u32 s6, s62, 40960
    buffer_load_dwordx4 v[128:131], v8, s[8:11], s6 offen offset:0 sc1
    buffer_load_dwordx4 v[132:135], v8, s[8:11], s6 offen offset:256 sc1
    s_cmp_ge_u32 s3, 2
    s_cbranch_scc1 L_xi_68
    s_add_u32 s6, s62, 0
    buffer_load_dwordx4 v[136:139], v9, s[8:11], s6 offen offset:0 sc1
    buffer_load_dwordx4 v[140:143], v9, s[8:11], s6 offen offset:256 sc1
    s_add_u32 s6, s62, 20480
    buffer_load_dwordx4 v[144:147], v9, s[8:11], s6 offen offset:0 sc1
    buffer_load_dwordx4 v[148:151], v9, s[8:11], s6 offen offset:256 sc1
    s_add_u32 s6, s62, 40960
    buffer_load_dwordx4 v[152:155], v9, s[8:11], s6 offen offset:0 sc1
    buffer_load_dwordx4 v[156:159], v9, s[8:11], s6 offen offset:256 sc1
L_xi_68:
L_x2a:
    s_waitcnt lgkmcnt(0)
    s_barrier
    ds_read_b128 v[160:163], v10 offset:0
    ds_read_b128 v[164:167], v10 offset:256
    ds_read_b128 v[168:171], v10 offset:5120
    ds_read_b128 v[172:175], v10 offset:5376
    ds_read_b128 v[176:179], v10 offset:10240
    ds_read_b128 v[180:183], v10 offset:10496
    ds_read_b128 v[184:187], v10 offset:15360
    ds_read_b128 v[188:191], v10 offset:15616
    ds_read_b128 v[192:195], v55 offset:0
    ds_read_b128 v[196:199], v55 offset:256
    ds_read_b128 v[200:203], v55 offset:5120
    ds_read_b128 v[204:207], v55 offset:5376
    ds_read_b128 v[208:211], v55 offset:10240
    ds_read_b128 v[212:215], v55 offset:10496
    ds_read_b128 v[216:219], v55 offset:15360
    ds_read_b128 v[220:223], v55 offset:15616
    s_cmp_eq_u64 s[78:79], 0
    s_cbranch_scc1 L_x2b
    s_mov_b32 s79, 262144
L_poll_69:
    buffer_load_dword v2, v3, s[8:11], s63 offen sc1
    s_waitcnt vmcnt(0)
    v_cmp_gt_u32 vcc, s77, v2
    s_cbranch_vccz L_polldone_70
    s_sleep 1
    s_sub_u32 s79, s79, 1
    s_cmp_lg_u32 s79, 0
    s_cbranch_scc1 L_poll_69
L_polldone_70:
    s_add_u32 s6, s62, 0
    buffer_load_dwordx4 v[112:115], v8, s[8:11], s6 offen offset:0 sc1
    buffer_load_dwordx4 v[116:119], v8, s[8:11], s6 offen offset:256 sc1
    s_add_u32 s6, s62, 20480
    buffer_load_dwordx4 v[120:123], v8, s[8:11], s6 offen offset:0 sc1
    buffer_load_dwordx4 v[124:127], v8, s[8:11], s6 offen offset:256 sc1
    s_add_u32 s6, s62, 40960
    buffer_load_dwordx4 v[128:131], v8, s[8:11], s6 offen offset:0 sc1
    buffer_load_dwordx4 v[132:135], v8, s[8:11], s6 offen offset:256 sc1
    s_cmp_ge_u32 s3, 2
    s_cbranch_scc1 L_xi_71
    s_add_u32 s6, s62, 0
    buffer_load_dwordx4 v[136:139], v9, s[8:11], s6 offen offset:0 sc1
    buffer_load_dwordx4 v[140:143], v9, s[8:11], s6 offen offset:256 sc1
    s_add_u32 s6, s62, 20480
    buffer_load_dwordx4 v[144:147], v9, s[8:11], s6 offen offset:0 sc1
    buffer_load_dwordx4 v[148:151], v9, s[8:11], s6 offen offset:256 sc1
    s_add_u32 s6, s62, 40960
    buffer_load_dwordx4 v[152:155], v9, s[8:11], s6 offen offset:0 sc1
    buffer_load_dwordx4 v[156:159], v9, s[8:11], s6 offen offset:256 sc1
L_xi_71:
L_x2b:
    s_mov_b32 s16, s54
    s_mov_b32 s17, s55
    s_mov_b32 s18, 0x280000
    s_mov_b32 s19, 0x20000
    s_waitcnt lgkmcnt(8)
    v_pk_add_f32 v[160:161], v[160:161], v[168:169]
    v_pk_add_f32 v[162:163], v[162:163], v[170:171]
    v_pk_add_f32 v[164:165], v[164:165], v[172:173]
    v_pk_add_f32 v[166:167], v[166:167], v[174:175]
    v_pk_add_f32 v[160:161], v[160:161], v[176:177]
    v_pk_add_f32 v[162:163], v[162:163], v[178:179]
    v_pk_add_f32 v[164:165], v[164:165], v[180:181]
    v_pk_add_f32 v[166:167], v[166:167], v[182:183]
    v_pk_add_f32 v[160:161], v[160:161], v[184:185]
    v_pk_add_f32 v[162:163], v[162:163], v[186:187]
    v_pk_add_f32 v[164:165], v[164:165], v[188:189]
    v_pk_add_f32 v[166:167], v[166:167], v[190:191]
    s_waitcnt vmcnt(0)
    v_pk_add_f32 v[160:161], v[160:161], v[112:113]
    v_pk_add_f32 v[162:163], v[162:163], v[114:115]
    v_pk_add_f32 v[164:165], v[164:165], v[116:117]
    v_pk_add_f32 v[166:167], v[166:167], v[118:119]
    v_pk_add_f32 v[160:161], v[160:161], v[120:121]
    v_pk_add_f32 v[162:163], v[162:163], v[122:123]
    v_pk_add_f32 v[164:165], v[164:165], v[124:125]
    v_pk_add_f32 v[166:167], v[166:167], v[126:127]
    v_pk_add_f32 v[160:161], v[160:161], v[128:129]
    v_pk_add_f32 v[162:163], v[162:163], v[130:131]
    v_pk_add_f32 v[164:165], v[164:165], v[132:133]
    v_pk_add_f32 v[166:167], v[166:167], v[134:135]
    v_cvt_pk_bf16_f32 v2, v160, v161
    v_lshlrev_b32 v160, 16, v2
    v_and_b32 v161, 0xffff0000, v2
    v_lshlrev_b32 v2, 16, v96
    v_and_b32 v3, 0xffff0000, v96
    v_pk_add_f32 v[160:161], v[160:161], v[2:3]
    v_cvt_pk_bf16_f32 v2, v160, v161
    v_lshlrev_b32 v160, 16, v2
    v_and_b32 v161, 0xffff0000, v2
    v_lshlrev_b32 v2, 16, v100
    v_and_b32 v3, 0xffff0000, v100
    v_pk_add_f32 v[160:161], v[160:161], v[2:3]
    v_cvt_pk_bf16_f32 v224, v160, v161
    v_cvt_pk_bf16_f32 v2, v162, v163
    v_lshlrev_b32 v162, 16, v2
    v_and_b32 v163, 0xffff0000, v2
    v_lshlrev_b32 v2, 16, v97
    v_and_b32 v3, 0xffff0000, v97
    v_pk_add_f32 v[162:163], v[162:163], v[2:3]
    v_cvt_pk_bf16_f32 v2, v162, v163
    v_lshlrev_b32 v162, 16, v2
    v_and_b32 v163, 0xffff0000, v2
    v_lshlrev_b32 v2, 16, v101
    v_and_b32 v3, 0xffff0000, v101
    v_pk_add_f32 v[162:163], v[162:163], v[2:3]
    v_cvt_pk_bf16_f32 v225, v162, v163
    v_cvt_pk_bf16_f32 v2, v164, v165
    v_lshlrev_b32 v164, 16, v2
    v_and_b32 v165, 0xffff0000, v2
    v_lshlrev_b32 v2, 16, v98
    v_and_b32 v3, 0xffff0000, v98
    v_pk_add_f32 v[164:165], v[164:165], v[2:3]
    v_cvt_pk_bf16_f32 v2, v164, v165
    v_lshlrev_b32 v164, 16, v2
    v_and_b32 v165, 0xffff0000, v2
    v_lshlrev_b32 v2, 16, v102
    v_and_b32 v3, 0xffff0000, v102
    v_pk_add_f32 v[164:165], v[164:165], v[2:3]
    v_cvt_pk_bf16_f32 v226, v164, v165
    v_cvt_pk_bf16_f32 v2, v166, v167
    v_lshlrev_b32 v166, 16, v2
    v_and_b32 v167, 0xffff0000, v2
    v_lshlrev_b32 v2, 16, v99
    v_and_b32 v3, 0xffff0000, v99
    v_pk_add_f32 v[166:167], v[166:167], v[2:3]
    v_cvt_pk_bf16_f32 v2, v166, v167
    v_lshlrev_b32 v166, 16, v2
    v_and_b32 v167, 0xffff0000, v2
    v_lshlrev_b32 v2, 16, v103
    v_and_b32 v3, 0xffff0000, v103
    v_pk_add_f32 v[166:167], v[166:167], v[2:3]
    v_cvt_pk_bf16_f32 v227, v166, v167
    buffer_store_dwordx4 v[224:227], v53, s[16:19], s70 offen
    s_cmp_ge_u32 s3, 2
    s_cbranch_scc1 L_end
    s_waitcnt lgkmcnt(0)
    v_pk_add_f32 v[192:193], v[192:193], v[200:201]
    v_pk_add_f32 v[194:195], v[194:195], v[202:203]
    v_pk_add_f32 v[196:197], v[196:197], v[204:205]
    v_pk_add_f32 v[198:199], v[198:199], v[206:207]
    v_pk_add_f32 v[192:193], v[192:193], v[208:209]
    v_pk_add_f32 v[194:195], v[194:195], v[210:211]
    v_pk_add_f32 v[196:197], v[196:197], v[212:213]
    v_pk_add_f32 v[198:199], v[198:199], v[214:215]
    v_pk_add_f32 v[192:193], v[192:193], v[216:217]
    v_pk_add_f32 v[194:195], v[194:195], v[218:219]
    v_pk_add_f32 v[196:197], v[196:197], v[220:221]
    v_pk_add_f32 v[198:199], v[198:199], v[222:223]
    s_nop 0
    v_pk_add_f32 v[192:193], v[192:193], v[136:137]
    v_pk_add_f32 v[194:195], v[194:195], v[138:139]
    v_pk_add_f32 v[196:197], v[196:197], v[140:141]
    v_pk_add_f32 v[198:199], v[198:199], v[142:143]
    v_pk_add_f32 v[192:193], v[192:193], v[144:145]
    v_pk_add_f32 v[194:195], v[194:195], v[146:147]
    v_pk_add_f32 v[196:197], v[196:197], v[148:149]
    v_pk_add_f32 v[198:199], v[198:199], v[150:151]
    v_pk_add_f32 v[192:193], v[192:193], v[152:153]
    v_pk_add_f32 v[194:195], v[194:195], v[154:155]
    v_pk_add_f32 v[196:197], v[196:197], v[156:157]
    v_pk_add_f32 v[198:199], v[198:199], v[158:159]
    v_cvt_pk_bf16_f32 v2, v192, v193
    v_lshlrev_b32 v192, 16, v2
    v_and_b32 v193, 0xffff0000, v2
    v_lshlrev_b32 v2, 16, v104
    v_and_b32 v3, 0xffff0000, v104
    v_pk_add_f32 v[192:193], v[192:193], v[2:3]
    v_cvt_pk_bf16_f32 v2, v192, v193
    v_lshlrev_b32 v192, 16, v2
    v_and_b32 v193, 0xffff0000, v2
    v_lshlrev_b32 v2, 16, v108
    v_and_b32 v3, 0xffff0000, v108
    v_pk_add_f32 v[192:193], v[192:193], v[2:3]
    v_cvt_pk_bf16_f32 v228, v192, v193
    v_cvt_pk_bf16_f32 v2, v194, v195
    v_lshlrev_b32 v194, 16, v2
    v_and_b32 v195, 0xffff0000, v2
    v_lshlrev_b32 v2, 16, v105
    v_and_b32 v3, 0xffff0000, v105
    v_pk_add_f32 v[194:195], v[194:195], v[2:3]
    v_cvt_pk_bf16_f32 v2, v194, v195
    v_lshlrev_b32 v194, 16, v2
    v_and_b32 v195, 0xffff0000, v2
    v_lshlrev_b32 v2, 16, v109
    v_and_b32 v3, 0xffff0000, v109
    v_pk_add_f32 v[194:195], v[194:195], v[2:3]
    v_cvt_pk_bf16_f32 v229, v194, v195
    v_cvt_pk_bf16_f32 v2, v196, v197
    v_lshlrev_b32 v196, 16, v2
    v_and_b32 v197, 0xffff0000, v2
    v_lshlrev_b32 v2, 16, v106
    v_and_b32 v3, 0xffff0000, v106
    v_pk_add_f32 v[196:197], v[196:197], v[2:3]
    v_cvt_pk_bf16_f32 v2, v196, v197
    v_lshlrev_b32 v196, 16, v2
    v_and_b32 v197, 0xffff0000, v2
    v_lshlrev_b32 v2, 16, v110
    v_and_b32 v3, 0xffff0000, v110
    v_pk_add_f32 v[196:197], v[196:197], v[2:3]
    v_cvt_pk_bf16_f32 v230, v196, v197
    v_cvt_pk_bf16_f32 v2, v198, v199
    v_lshlrev_b32 v198, 16, v2
    v_and_b32 v199, 0xffff0000, v2
    v_lshlrev_b32 v2, 16, v107
    v_and_b32 v3, 0xffff0000, v107
    v_pk_add_f32 v[198:199], v[198:199], v[2:3]
    v_cvt_pk_bf16_f32 v2, v198, v199
    v_lshlrev_b32 v198, 16, v2
    v_and_b32 v199, 0xffff0000, v2
    v_lshlrev_b32 v2, 16, v111
    v_and_b32 v3, 0xffff0000, v111
    v_pk_add_f32 v[198:199], v[198:199], v[2:3]
    v_cvt_pk_bf16_f32 v231, v198, v199
    buffer_store_dwordx4 v[228:231], v54, s[16:19], s70 offen
L_end:
L_exit:
    s_endpgm
.section .rodata,"a"
.p2align 6
.amdhsa_kernel parallel_sum__compressed_kv_cla__moe_arch_mod__prompt_kernel
  .amdhsa_next_free_vgpr 256
  .amdhsa_next_free_sgpr 102
  .amdhsa_accum_offset 256
  .amdhsa_group_segment_fixed_size 0
  .amdhsa_kernarg_size 112
  .amdhsa_user_sgpr_count 2
  .amdhsa_user_sgpr_kernarg_segment_ptr 1
  .amdhsa_system_sgpr_workgroup_id_x 1
  .amdhsa_float_denorm_mode_32 3
.end_amdhsa_kernel
```
